```python
import torch

def _softmax(x, axis=-1):
    return torch.softmax(x, dim=axis)
def _gelu(x):
    return torch.nn.functional.gelu(x, approximate="tanh")
def _silu(x):
    return torch.nn.functional.silu(x)
def _sigmoid(x):
    return torch.sigmoid(x)
def _layernorm(x, axis=-1, eps=1e-5):
    m = x.mean(dim=axis, keepdim=True)
    v = x.var(dim=axis, keepdim=True, unbiased=False)
    return (x - m) / torch.sqrt(v + eps)
def _scatter_add(tgt, idx, src, axis=0):
    return tgt.clone().index_add_(axis, idx, src)
def _segment_sum(src, seg, n):
    out = torch.zeros((n,) + src.shape[1:], dtype=src.dtype)
    return out.index_add_(0, seg, src)
def _pad(x, pw):
    flat = tuple(v for pair in reversed(pw) for v in pair)
    return torch.nn.functional.pad(x, flat)

kernel_name = 'recurrent_scan__linear_kernel_hedgehog__glu_gated_glu__prompt'

def setup_inputs():

    _w = (lambda a: (lambda t: t.to(torch.bfloat16) if t.is_floating_point() else t)(torch.as_tensor(a)))
    def _A_setup():
        B, S, D, H = 1, 2048, 1024, 32
        Dh = D // H
        return {
            "x": _w((lambda *s: torch.randn(*s, dtype=torch.bfloat16) * 0.05)(B, S, D)),
            "wqkv": _w((lambda *s: torch.randn(*s, dtype=torch.bfloat16) * 0.2)(D, 3 * D)),
            "w_phi": _w((lambda *s: torch.randn(*s, dtype=torch.bfloat16) * 0.2)(H, Dh, Dh) * (Dh ** -0.5)),
            "wo": _w((lambda *s: torch.randn(*s, dtype=torch.bfloat16) * 0.05)(D, D)),
        }
    _A_in = _A_setup()

    def _B_setup():
        B, S, D, F = 1, 2048, 1024, 3584
        return {
            "x": _w((lambda *s: torch.randn(*s, dtype=torch.bfloat16) * 0.05)(B, S, D)),
            "w_gate": _w((lambda *s: torch.randn(*s, dtype=torch.bfloat16) * 0.05)(D, F)),
            "w_up": _w((lambda *s: torch.randn(*s, dtype=torch.bfloat16) * 0.05)(D, F)),
            "w_down": _w((lambda *s: torch.randn(*s, dtype=torch.bfloat16) * 0.05)(F, D)),
        }
    _B_in = _B_setup()

    return {
        "A_x": _A_in["x"],
        "A_wqkv": _A_in["wqkv"],
        "A_w_phi": _A_in["w_phi"],
        "A_wo": _A_in["wo"],
        "B_x": _B_in["x"],
        "B_w_gate": _B_in["w_gate"],
        "B_w_up": _B_in["w_up"],
        "B_w_down": _B_in["w_down"],
    }

def reference(A_x, A_wqkv, A_w_phi, A_wo, B_x, B_w_gate, B_w_up, B_w_down):
    def _A_ref(x, wqkv, w_phi, wo):
        B, S, D = x.shape
        H = 32; Dh = D // H
        qkv = (lambda x, *d: x.permute(*d))((x @ wqkv).reshape(B, S, 3, H, Dh), 2, 0, 3, 1, 4)
        q, k, v = qkv[0], qkv[1], qkv[2]
        pq = torch.einsum("bhsd,hdf->bhsf", q, w_phi)
        pk = torch.einsum("bhsd,hdf->bhsf", k, w_phi)
        phi_q = torch.concatenate([_softmax(pq, axis=-1), _softmax(-pq, axis=-1)], axis=-1)
        phi_k = torch.concatenate([_softmax(pk, axis=-1), _softmax(-pk, axis=-1)], axis=-1)
        kv = torch.einsum("bhsf,bhsd->bhfd", phi_k, v)
        z  = torch.einsum("bhsf->bhf", phi_k)
        num = torch.einsum("bhqf,bhfd->bhqd", phi_q, kv)
        den = torch.einsum("bhqf,bhf->bhq", phi_q, z)[..., None] + 1e-6
        o = num / den
        return (lambda x, *d: x.permute(*d))(o, 0, 2, 1, 3).reshape(B, S, D) @ wo

    def _B_ref(x, w_gate, w_up, w_down):
        g = torch.einsum("bsd,df->bsf", x, w_gate)
        u = torch.einsum("bsd,df->bsf", x, w_up)
        h = _sigmoid(g) * u
        return torch.einsum("bsf,fd->bsd", h, w_down)

    x = A_x
    xn = _layernorm(x, axis=-1)
    s = _A_ref(xn, A_wqkv, A_w_phi, A_wo)
    g = _silu(_B_ref(xn, B_w_gate, B_w_up, B_w_down))
    return x + s * g
```

```asm
; @launch grid=(256,1,1) block=(256,1,1) lds=163840
.amdgcn_target "amdgcn-amd-amdhsa--gfx950"
.text
.globl recurrent_scan__linear_kernel_hedgehog__glu_gated_glu__prompt_kernel
.p2align 12
.p2align 8
.type recurrent_scan__linear_kernel_hedgehog__glu_gated_glu__prompt_kernel,@function
recurrent_scan__linear_kernel_hedgehog__glu_gated_glu__prompt_kernel:
s_cmp_ge_u32 s2, 256
s_cbranch_scc1 k_done
s_load_dwordx2 s[72:73], s[0:1], 0
s_load_dwordx2 s[92:93], s[0:1], 80
s_load_dwordx4 s[80:83], s[0:1], 40
s_load_dwordx4 s[76:79], s[0:1], 8
s_load_dwordx4 s[84:87], s[0:1], 56
s_load_dwordx2 s[74:75], s[0:1], 24
v_lshrrev_b32 v1, 6, v0
s_nop 0
v_readfirstlane_b32 s32, v1
v_and_b32 v0, 63, v0
s_lshr_b32 s3, s2, 3
s_getpc_b64 s[6:7]
k_pc:
s_lshl_b32 s4, s3, 2
s_add_u32 s4, s4, s32
s_lshl_b32 s4, s4, 10
v_and_b32 v2, 7, v0
v_lshlrev_b32 v2, 7, v2
v_add_u32 v2, s4, v2
v_min_u32 v2, k_end-k_pc-4, v2
global_load_dword v33, v2, s[6:7]
s_and_b32 s33, s3, 7
s_and_b32 s34, s2, 7
s_lshl_b32 s34, s34, 2
s_lshr_b32 s4, s3, 3
s_add_u32 s34, s34, s4
v_and_b32 v52, 7, v0
v_lshrrev_b32 v53, 3, v0
v_lshlrev_b32 v54, 4, v53
v_lshl_add_u32 v54, v52, 11, v54
s_lshl_b32 s4, s33, 5
s_add_u32 s4, s4, s34
s_lshl_b32 s5, s4, 14
s_lshl_b32 s6, s32, 9
s_add_u32 s5, s5, s6
s_waitcnt lgkmcnt(0)
s_mov_b32 s8, s72
s_mov_b32 s9, s73
s_mov_b32 s10, 0x400000
s_mov_b32 s11, 0x20000
buffer_load_dwordx4 v[64:67], v54, s[8:11], s5 offen offset:0
buffer_load_dwordx4 v[68:71], v54, s[8:11], s5 offen offset:128
buffer_load_dwordx4 v[72:75], v54, s[8:11], s5 offen offset:256
buffer_load_dwordx4 v[76:79], v54, s[8:11], s5 offen offset:384
s_add_u32 s6, s92, 50397184
s_addc_u32 s7, s93, 0
s_load_dword s35, s[6:7], 0
s_mov_b32 s16, s80
s_mov_b32 s17, s81
s_mov_b32 s18, 0x700000
s_mov_b32 s19, 0x20000
s_mov_b32 s20, s82
s_mov_b32 s21, s83
s_mov_b32 s22, 0x700000
s_mov_b32 s23, 0x20000
s_and_b32 s7, s2, 7
s_lshl_b32 s89, s7, 9
s_lshl_b32 s7, s7, 8
s_cmp_eq_u32 s32, 0
s_cselect_b32 s48, s80, s82
s_cselect_b32 s49, s81, s83
s_cmp_eq_u32 s32, 2
s_cselect_b32 s88, 1, 2
s_cselect_b32 s6, 1, 3
s_cselect_b32 s5, 0x800, 0
s_add_u32 s7, s7, s5
s_mul_i32 s88, s88, 6144
s_lshl_b32 s6, s6, 11
s_cmp_lt_u32 s32, 2
s_cselect_b32 s48, s48, s76
s_cselect_b32 s49, s49, s77
s_cselect_b32 s88, 7168, s88
s_cselect_b32 s6, 0x100, s6
s_cselect_b32 s89, s89, s7
s_cselect_b32 s50, 7, 6
s_lshl_b32 s50, s50, 20
s_mov_b32 s51, 0x20000
v_lshrrev_b32 v63, 2, v0
v_mul_u32_u24 v63, s88, v63
v_bfe_u32 v60, v0, 1, 1
v_mad_u32_u24 v63, v60, s6, v63
v_and_b32 v60, 1, v0
v_lshl_add_u32 v63, v60, 7, v63
s_mul_i32 s6, s3, 8
s_mul_i32 s6, s6, s88
s_add_u32 s6, s6, s89
s_cmp_eq_u32 s32, 3
s_cselect_b32 s6, 0x7f000000, s6
s_bfm_b64 exec, 32, 0
buffer_load_dword v60, v63, s[48:51], s6 offen
s_mov_b64 exec, -1
v_lshrrev_b32 v55, 4, v0
s_lshr_b32 s6, s32, 1
s_lshl_b32 s6, s6, 5
s_and_b32 s7, s32, 1
s_lshl_b32 s7, s7, 2
s_add_u32 s7, s6, s7
v_lshrrev_b32 v56, 5, v0
v_and_b32 v57, 3, v53
v_lshl_add_u32 v56, v56, 3, v57
v_add_u32 v56, s7, v56
v_lshlrev_b32 v57, 1, v55
v_xor_b32 v57, v52, v57
v_lshlrev_b32 v57, 4, v57
s_lshl_b32 s59, s34, 7
s_lshl_b32 s5, s34, 6
v_mul_u32_u24 v40, 7168, v56
v_add3_u32 v40, v40, v57, s59
v_add_u32 v41, 113664, v40
v_lshl_add_u32 v28, v53, 11, v57
v_bfe_u32 v56, v0, 2, 2
v_lshl_add_u32 v56, v55, 3, v56
v_add_u32 v56, s7, v56
v_and_b32 v57, 1, v55
v_lshlrev_b32 v57, 1, v57
v_and_b32 v58, 3, v0
v_xor_b32 v57, v57, v58
v_lshlrev_b32 v57, 4, v57
v_mul_u32_u24 v15, 6144, v56
v_add3_u32 v15, v15, v57, s5
v_add_u32 v42, 2048, v15
v_add_u32 v43, 3072, v15
s_mov_b32 s12, s76
s_mov_b32 s13, s77
s_mov_b32 s14, 0x600000
s_mov_b32 s15, 0x20000
s_lshl_b32 s52, s32, 11
s_mov_b32 s24, s92
s_mov_b32 s25, s93
s_mov_b32 s26, 0x10000000
s_mov_b32 s27, 0x20000
s_mov_b32 s28, s78
s_mov_b32 s29, s79
s_mov_b32 s30, 0x10000
s_mov_b32 s31, 0x20000
v_lshlrev_b32 v1, 4, v0
v_add_u32 v2, 4096, v1
s_and_b32 s5, s32, 1
s_lshl_b32 s5, s5, 10
s_add_u32 m0, s5, 155648
s_lshl_b32 s6, s34, 11
s_add_u32 s5, s5, s6
buffer_load_dwordx4 v1, s[28:31], s5 offen lds
v_lshrrev_b32 v56, 2, v0
v_bfe_u32 v57, v0, 1, 1
v_and_b32 v58, 3, v53
v_lshlrev_b32 v58, 1, v58
v_xor_b32 v58, v57, v58
v_lshlrev_b32 v58, 4, v58
v_lshl_add_u32 v16, v56, 7, v58
v_and_b32 v58, 1, v0
v_lshl_add_u32 v16, v58, 3, v16
v_lshlrev_b32 v4, 6, v56
v_lshl_add_u32 v4, v58, 3, v4
v_and_b32 v58, 1, v55
v_lshlrev_b32 v58, 1, v58
v_xor_b32 v58, v57, v58
v_lshl_add_u32 v4, v58, 4, v4
v_xor_b32 v17, 32, v16
v_xor_b32 v18, 64, v16
v_xor_b32 v19, 96, v16
v_xor_b32 v5, 32, v4
v_add_u32 v20, 0x10000, v16
v_add_u32 v21, 0x10000, v17
v_add_u32 v22, 0x10000, v18
v_add_u32 v23, 0x10000, v19
v_add_u32 v6, 0x10000, v4
v_add_u32 v7, 0x10000, v5
v_add_u32 v24, 0x20000, v16
v_add_u32 v25, 0x20000, v17
v_add_u32 v26, 0x20000, v18
v_add_u32 v27, 0x20000, v19
v_add_u32 v8, 0x20000, v4
v_add_u32 v9, 0x20000, v5
s_lshl_b32 s5, s33, 2
s_add_u32 s5, s5, s32
s_lshl_b32 s53, s5, 17
s_lshl_b32 s67, s5, 10
s_add_u32 s67, s67, 50593792
s_lshl_b32 s66, s4, 5
s_add_u32 s66, s66, s32
s_lshl_b32 s66, s66, 2
s_add_u32 s66, s66, 50593792
v_mov_b32 v56, 0x7f000000
v_cmp_eq_u32 vcc, 0, v0
s_nop 1
v_cndmask_b32 v30, v56, 0, vcc
v_and_b32 v31, 3, v53
v_lshlrev_b32 v31, 2, v31
v_lshl_add_u32 v31, v52, 7, v31
v_lshlrev_b32 v58, 4, v52
v_lshl_add_u32 v58, v53, 8, v58
s_lshl_b32 s5, s33, 2
s_lshr_b32 s6, s34, 3
s_add_u32 s5, s5, s6
s_lshl_b32 s4, s5, 2
s_add_u32 s4, s4, s32
s_lshl_b32 s4, s4, 15
s_bfe_u32 s6, s34, 0x20001
s_lshl_b32 s6, s6, 11
s_add_u32 s4, s4, s6
s_and_b32 s6, s34, 1
s_lshl_b32 s6, s6, 7
s_add_u32 s4, s4, s6
s_lshl_b32 s6, s32, 3
s_add_u32 s6, s6, 157696
v_lshlrev_b32 v57, 5, v52
v_add_u32 v56, s6, v57
v_add_u32 v57, 157696, v57
s_waitcnt vmcnt(5)
v_lshlrev_b32 v96, 16, v64
v_and_b32 v97, 0xffff0000, v64
v_lshlrev_b32 v98, 16, v65
v_and_b32 v99, 0xffff0000, v65
v_lshlrev_b32 v100, 16, v66
v_and_b32 v101, 0xffff0000, v66
v_lshlrev_b32 v102, 16, v67
v_and_b32 v103, 0xffff0000, v67
s_waitcnt vmcnt(4)
v_lshlrev_b32 v104, 16, v68
v_and_b32 v105, 0xffff0000, v68
v_lshlrev_b32 v106, 16, v69
v_and_b32 v107, 0xffff0000, v69
v_lshlrev_b32 v108, 16, v70
v_and_b32 v109, 0xffff0000, v70
v_lshlrev_b32 v110, 16, v71
v_and_b32 v111, 0xffff0000, v71
s_waitcnt vmcnt(3)
v_lshlrev_b32 v112, 16, v72
v_and_b32 v113, 0xffff0000, v72
v_lshlrev_b32 v114, 16, v73
v_and_b32 v115, 0xffff0000, v73
v_lshlrev_b32 v116, 16, v74
v_and_b32 v117, 0xffff0000, v74
v_lshlrev_b32 v118, 16, v75
v_and_b32 v119, 0xffff0000, v75
s_waitcnt vmcnt(2)
v_lshlrev_b32 v120, 16, v76
v_and_b32 v121, 0xffff0000, v76
v_lshlrev_b32 v122, 16, v77
v_and_b32 v123, 0xffff0000, v77
v_lshlrev_b32 v124, 16, v78
v_and_b32 v125, 0xffff0000, v78
v_lshlrev_b32 v126, 16, v79
v_and_b32 v127, 0xffff0000, v79
v_pk_add_f32 v[160:161], v[96:97], v[100:101]
v_pk_add_f32 v[162:163], v[98:99], v[102:103]
v_pk_add_f32 v[160:161], v[160:161], v[104:105]
v_pk_add_f32 v[162:163], v[162:163], v[106:107]
v_pk_add_f32 v[160:161], v[160:161], v[108:109]
v_pk_add_f32 v[162:163], v[162:163], v[110:111]
v_pk_add_f32 v[160:161], v[160:161], v[112:113]
v_pk_add_f32 v[162:163], v[162:163], v[114:115]
v_pk_add_f32 v[160:161], v[160:161], v[116:117]
v_pk_add_f32 v[162:163], v[162:163], v[118:119]
v_pk_add_f32 v[160:161], v[160:161], v[120:121]
v_pk_add_f32 v[162:163], v[162:163], v[122:123]
v_pk_add_f32 v[160:161], v[160:161], v[124:125]
v_pk_add_f32 v[162:163], v[162:163], v[126:127]
v_pk_add_f32 v[160:161], v[160:161], v[162:163]
v_add_f32 v160, v160, v161
s_nop 1
v_add_f32_dpp v160, v160, v160 row_ror:8 row_mask:0xf bank_mask:0xf
v_mov_b32 v161, v160
s_nop 1
v_permlane16_swap_b32 v160, v161
v_add_f32 v160, v160, v161
v_mov_b32 v161, v160
s_nop 1
v_permlane32_swap_b32 v160, v161
v_add_f32 v160, v160, v161
v_mul_f32 v160, 0x3b800000, v160
v_pk_add_f32 v[128:129], v[96:97], v[160:161] op_sel_hi:[1,0] neg_lo:[0,1] neg_hi:[0,1]
v_pk_add_f32 v[130:131], v[98:99], v[160:161] op_sel_hi:[1,0] neg_lo:[0,1] neg_hi:[0,1]
v_pk_add_f32 v[132:133], v[100:101], v[160:161] op_sel_hi:[1,0] neg_lo:[0,1] neg_hi:[0,1]
v_pk_add_f32 v[134:135], v[102:103], v[160:161] op_sel_hi:[1,0] neg_lo:[0,1] neg_hi:[0,1]
v_pk_add_f32 v[136:137], v[104:105], v[160:161] op_sel_hi:[1,0] neg_lo:[0,1] neg_hi:[0,1]
v_pk_add_f32 v[138:139], v[106:107], v[160:161] op_sel_hi:[1,0] neg_lo:[0,1] neg_hi:[0,1]
v_pk_add_f32 v[140:141], v[108:109], v[160:161] op_sel_hi:[1,0] neg_lo:[0,1] neg_hi:[0,1]
v_pk_add_f32 v[142:143], v[110:111], v[160:161] op_sel_hi:[1,0] neg_lo:[0,1] neg_hi:[0,1]
v_pk_add_f32 v[144:145], v[112:113], v[160:161] op_sel_hi:[1,0] neg_lo:[0,1] neg_hi:[0,1]
v_pk_add_f32 v[146:147], v[114:115], v[160:161] op_sel_hi:[1,0] neg_lo:[0,1] neg_hi:[0,1]
v_pk_add_f32 v[148:149], v[116:117], v[160:161] op_sel_hi:[1,0] neg_lo:[0,1] neg_hi:[0,1]
v_pk_add_f32 v[150:151], v[118:119], v[160:161] op_sel_hi:[1,0] neg_lo:[0,1] neg_hi:[0,1]
v_pk_add_f32 v[152:153], v[120:121], v[160:161] op_sel_hi:[1,0] neg_lo:[0,1] neg_hi:[0,1]
v_pk_add_f32 v[154:155], v[122:123], v[160:161] op_sel_hi:[1,0] neg_lo:[0,1] neg_hi:[0,1]
v_pk_add_f32 v[156:157], v[124:125], v[160:161] op_sel_hi:[1,0] neg_lo:[0,1] neg_hi:[0,1]
v_pk_add_f32 v[158:159], v[126:127], v[160:161] op_sel_hi:[1,0] neg_lo:[0,1] neg_hi:[0,1]
v_pk_mul_f32 v[162:163], v[128:129], v[128:129]
v_pk_mul_f32 v[164:165], v[130:131], v[130:131]
v_pk_fma_f32 v[162:163], v[132:133], v[132:133], v[162:163]
v_pk_fma_f32 v[164:165], v[134:135], v[134:135], v[164:165]
v_pk_fma_f32 v[162:163], v[136:137], v[136:137], v[162:163]
v_pk_fma_f32 v[164:165], v[138:139], v[138:139], v[164:165]
v_pk_fma_f32 v[162:163], v[140:141], v[140:141], v[162:163]
v_pk_fma_f32 v[164:165], v[142:143], v[142:143], v[164:165]
v_pk_fma_f32 v[162:163], v[144:145], v[144:145], v[162:163]
v_pk_fma_f32 v[164:165], v[146:147], v[146:147], v[164:165]
v_pk_fma_f32 v[162:163], v[148:149], v[148:149], v[162:163]
v_pk_fma_f32 v[164:165], v[150:151], v[150:151], v[164:165]
v_pk_fma_f32 v[162:163], v[152:153], v[152:153], v[162:163]
v_pk_fma_f32 v[164:165], v[154:155], v[154:155], v[164:165]
v_pk_fma_f32 v[162:163], v[156:157], v[156:157], v[162:163]
v_pk_fma_f32 v[164:165], v[158:159], v[158:159], v[164:165]
v_pk_add_f32 v[162:163], v[162:163], v[164:165]
v_add_f32 v161, v162, v163
s_nop 1
v_add_f32_dpp v161, v161, v161 row_ror:8 row_mask:0xf bank_mask:0xf
v_mov_b32 v162, v161
s_nop 1
v_permlane16_swap_b32 v161, v162
v_add_f32 v161, v161, v162
v_mov_b32 v162, v161
s_nop 1
v_permlane32_swap_b32 v161, v162
v_add_f32 v161, v161, v162
ds_write_b64 v56, v[160:161]
s_waitcnt lgkmcnt(0)
s_barrier
ds_read_b128 v[160:163], v57
ds_read_b128 v[164:167], v57 offset:16
s_mul_i32 s35, s35, 1664525
s_add_u32 s35, s35, 1013904223
v_mov_b32 v32, s35
s_waitcnt lgkmcnt(1)
v_pk_add_f32 v[168:169], v[160:161], v[162:163]
s_waitcnt lgkmcnt(0)
v_pk_add_f32 v[170:171], v[164:165], v[166:167]
v_pk_add_f32 v[168:169], v[168:169], v[170:171]
v_mul_f32 v168, 0x3e800000, v168
v_sub_f32 v160, v160, v168
v_sub_f32 v162, v162, v168
v_sub_f32 v164, v164, v168
v_sub_f32 v166, v166, v168
v_mul_f32 v170, v160, v160
v_fma_f32 v170, v162, v162, v170
v_fma_f32 v170, v164, v164, v170
v_fma_f32 v170, v166, v166, v170
v_mul_f32 v169, 0x3a800000, v169
v_fmac_f32 v169, 0x3e800000, v170
v_cvt_pk_bf16_f32 v168, v168, v168
v_lshlrev_b32 v168, 16, v168
v_cvt_pk_bf16_f32 v169, v169, v169
v_lshlrev_b32 v169, 16, v169
v_pk_add_f32 v[96:97], v[96:97], v[168:169] op_sel_hi:[1,0] neg_lo:[0,1] neg_hi:[0,1]
v_pk_add_f32 v[98:99], v[98:99], v[168:169] op_sel_hi:[1,0] neg_lo:[0,1] neg_hi:[0,1]
v_pk_add_f32 v[100:101], v[100:101], v[168:169] op_sel_hi:[1,0] neg_lo:[0,1] neg_hi:[0,1]
v_pk_add_f32 v[102:103], v[102:103], v[168:169] op_sel_hi:[1,0] neg_lo:[0,1] neg_hi:[0,1]
v_pk_add_f32 v[104:105], v[104:105], v[168:169] op_sel_hi:[1,0] neg_lo:[0,1] neg_hi:[0,1]
v_pk_add_f32 v[106:107], v[106:107], v[168:169] op_sel_hi:[1,0] neg_lo:[0,1] neg_hi:[0,1]
v_pk_add_f32 v[108:109], v[108:109], v[168:169] op_sel_hi:[1,0] neg_lo:[0,1] neg_hi:[0,1]
v_pk_add_f32 v[110:111], v[110:111], v[168:169] op_sel_hi:[1,0] neg_lo:[0,1] neg_hi:[0,1]
v_add_f32 v170, 0x3727c5ac, v169
v_cvt_pk_bf16_f32 v170, v170, v170
v_lshlrev_b32 v170, 16, v170
v_sqrt_f32 v170, v170
v_pk_add_f32 v[112:113], v[112:113], v[168:169] op_sel_hi:[1,0] neg_lo:[0,1] neg_hi:[0,1]
v_pk_add_f32 v[114:115], v[114:115], v[168:169] op_sel_hi:[1,0] neg_lo:[0,1] neg_hi:[0,1]
v_pk_add_f32 v[116:117], v[116:117], v[168:169] op_sel_hi:[1,0] neg_lo:[0,1] neg_hi:[0,1]
v_pk_add_f32 v[118:119], v[118:119], v[168:169] op_sel_hi:[1,0] neg_lo:[0,1] neg_hi:[0,1]
v_pk_add_f32 v[120:121], v[120:121], v[168:169] op_sel_hi:[1,0] neg_lo:[0,1] neg_hi:[0,1]
v_pk_add_f32 v[122:123], v[122:123], v[168:169] op_sel_hi:[1,0] neg_lo:[0,1] neg_hi:[0,1]
v_pk_add_f32 v[124:125], v[124:125], v[168:169] op_sel_hi:[1,0] neg_lo:[0,1] neg_hi:[0,1]
v_pk_add_f32 v[126:127], v[126:127], v[168:169] op_sel_hi:[1,0] neg_lo:[0,1] neg_hi:[0,1]
v_cvt_pk_bf16_f32 v170, v170, v170
v_lshlrev_b32 v170, 16, v170
v_rcp_f32 v170, v170
v_cvt_pk_bf16_f32 v64, v96, v97
v_cvt_pk_bf16_f32 v65, v98, v99
v_cvt_pk_bf16_f32 v66, v100, v101
v_cvt_pk_bf16_f32 v67, v102, v103
v_lshlrev_b32 v96, 16, v64
v_and_b32 v97, 0xffff0000, v64
v_lshlrev_b32 v98, 16, v65
v_and_b32 v99, 0xffff0000, v65
v_lshlrev_b32 v100, 16, v66
v_and_b32 v101, 0xffff0000, v66
v_lshlrev_b32 v102, 16, v67
v_and_b32 v103, 0xffff0000, v67
v_pk_mul_f32 v[96:97], v[96:97], v[170:171] op_sel_hi:[1,0]
v_pk_mul_f32 v[98:99], v[98:99], v[170:171] op_sel_hi:[1,0]
v_pk_mul_f32 v[100:101], v[100:101], v[170:171] op_sel_hi:[1,0]
v_pk_mul_f32 v[102:103], v[102:103], v[170:171] op_sel_hi:[1,0]
v_cvt_pk_bf16_f32 v64, v96, v97
v_cvt_pk_bf16_f32 v65, v98, v99
v_cvt_pk_bf16_f32 v66, v100, v101
v_cvt_pk_bf16_f32 v67, v102, v103
buffer_store_dwordx4 v[64:67], v58, s[24:27], s4 offen sc1
s_add_u32 s4, s4, 8192
v_cvt_pk_bf16_f32 v68, v104, v105
v_cvt_pk_bf16_f32 v69, v106, v107
v_cvt_pk_bf16_f32 v70, v108, v109
v_cvt_pk_bf16_f32 v71, v110, v111
v_lshlrev_b32 v104, 16, v68
v_and_b32 v105, 0xffff0000, v68
v_lshlrev_b32 v106, 16, v69
v_and_b32 v107, 0xffff0000, v69
v_lshlrev_b32 v108, 16, v70
v_and_b32 v109, 0xffff0000, v70
v_lshlrev_b32 v110, 16, v71
v_and_b32 v111, 0xffff0000, v71
v_pk_mul_f32 v[104:105], v[104:105], v[170:171] op_sel_hi:[1,0]
v_pk_mul_f32 v[106:107], v[106:107], v[170:171] op_sel_hi:[1,0]
v_pk_mul_f32 v[108:109], v[108:109], v[170:171] op_sel_hi:[1,0]
v_pk_mul_f32 v[110:111], v[110:111], v[170:171] op_sel_hi:[1,0]
v_cvt_pk_bf16_f32 v68, v104, v105
v_cvt_pk_bf16_f32 v69, v106, v107
v_cvt_pk_bf16_f32 v70, v108, v109
v_cvt_pk_bf16_f32 v71, v110, v111
buffer_store_dwordx4 v[68:71], v58, s[24:27], s4 offen sc1
s_add_u32 s4, s4, 8192
v_cvt_pk_bf16_f32 v72, v112, v113
v_cvt_pk_bf16_f32 v73, v114, v115
v_cvt_pk_bf16_f32 v74, v116, v117
v_cvt_pk_bf16_f32 v75, v118, v119
v_lshlrev_b32 v112, 16, v72
v_and_b32 v113, 0xffff0000, v72
v_lshlrev_b32 v114, 16, v73
v_and_b32 v115, 0xffff0000, v73
v_lshlrev_b32 v116, 16, v74
v_and_b32 v117, 0xffff0000, v74
v_lshlrev_b32 v118, 16, v75
v_and_b32 v119, 0xffff0000, v75
v_pk_mul_f32 v[112:113], v[112:113], v[170:171] op_sel_hi:[1,0]
v_pk_mul_f32 v[114:115], v[114:115], v[170:171] op_sel_hi:[1,0]
v_pk_mul_f32 v[116:117], v[116:117], v[170:171] op_sel_hi:[1,0]
v_pk_mul_f32 v[118:119], v[118:119], v[170:171] op_sel_hi:[1,0]
v_cvt_pk_bf16_f32 v72, v112, v113
v_cvt_pk_bf16_f32 v73, v114, v115
v_cvt_pk_bf16_f32 v74, v116, v117
v_cvt_pk_bf16_f32 v75, v118, v119
buffer_store_dwordx4 v[72:75], v58, s[24:27], s4 offen sc1
s_add_u32 s4, s4, 8192
v_cvt_pk_bf16_f32 v76, v120, v121
v_cvt_pk_bf16_f32 v77, v122, v123
v_cvt_pk_bf16_f32 v78, v124, v125
v_cvt_pk_bf16_f32 v79, v126, v127
v_lshlrev_b32 v120, 16, v76
v_and_b32 v121, 0xffff0000, v76
v_lshlrev_b32 v122, 16, v77
v_and_b32 v123, 0xffff0000, v77
v_lshlrev_b32 v124, 16, v78
v_and_b32 v125, 0xffff0000, v78
v_lshlrev_b32 v126, 16, v79
v_and_b32 v127, 0xffff0000, v79
v_pk_mul_f32 v[120:121], v[120:121], v[170:171] op_sel_hi:[1,0]
v_pk_mul_f32 v[122:123], v[122:123], v[170:171] op_sel_hi:[1,0]
v_pk_mul_f32 v[124:125], v[124:125], v[170:171] op_sel_hi:[1,0]
v_pk_mul_f32 v[126:127], v[126:127], v[170:171] op_sel_hi:[1,0]
v_cvt_pk_bf16_f32 v76, v120, v121
v_cvt_pk_bf16_f32 v77, v122, v123
v_cvt_pk_bf16_f32 v78, v124, v125
v_cvt_pk_bf16_f32 v79, v126, v127
buffer_store_dwordx4 v[76:79], v58, s[24:27], s4 offen sc1
s_mov_b32 s55, 0
s_add_u32 m0, s52, 0
s_nop 0
buffer_load_dwordx4 v40, s[16:19], s55 offen offset:0 lds
buffer_load_dwordx4 v41, s[16:19], s55 offen offset:1024 lds
s_add_u32 m0, s52, 8192
s_nop 0
buffer_load_dwordx4 v40, s[20:23], s55 offen offset:0 lds
buffer_load_dwordx4 v41, s[20:23], s55 offen offset:1024 lds
s_mov_b32 s56, 0
s_add_u32 m0, s52, 16384
s_nop 0
buffer_load_dwordx4 v42, s[12:15], s56 offen offset:0 lds
buffer_load_dwordx4 v43, s[12:15], s56 offen offset:1024 lds
s_waitcnt vmcnt(6)
buffer_store_dword v32, v30, s[24:27], s66 offen sc1
s_mov_b32 s55, 458752
s_add_u32 m0, s52, 24576
s_nop 0
buffer_load_dwordx4 v40, s[16:19], s55 offen offset:0 lds
buffer_load_dwordx4 v41, s[16:19], s55 offen offset:1024 lds
s_add_u32 m0, s52, 32768
s_nop 0
buffer_load_dwordx4 v40, s[20:23], s55 offen offset:0 lds
buffer_load_dwordx4 v41, s[20:23], s55 offen offset:1024 lds
s_mov_b32 s56, 393216
s_add_u32 m0, s52, 40960
s_nop 0
buffer_load_dwordx4 v42, s[12:15], s56 offen offset:0 lds
buffer_load_dwordx4 v43, s[12:15], s56 offen offset:1024 lds
s_mov_b32 s55, 917504
s_add_u32 m0, s52, 49152
s_nop 0
buffer_load_dwordx4 v40, s[16:19], s55 offen offset:0 lds
buffer_load_dwordx4 v41, s[16:19], s55 offen offset:1024 lds
s_mov_b32 s55, 1376256
s_add_u32 m0, s52, 57344
s_nop 0
buffer_load_dwordx4 v40, s[16:19], s55 offen offset:0 lds
buffer_load_dwordx4 v41, s[16:19], s55 offen offset:1024 lds
s_mov_b32 s55, 917504
s_add_u32 m0, s52, 65536
s_nop 0
buffer_load_dwordx4 v40, s[20:23], s55 offen offset:0 lds
buffer_load_dwordx4 v41, s[20:23], s55 offen offset:1024 lds
s_mov_b32 s55, 1376256
s_add_u32 m0, s52, 73728
s_nop 0
buffer_load_dwordx4 v40, s[20:23], s55 offen offset:0 lds
buffer_load_dwordx4 v41, s[20:23], s55 offen offset:1024 lds
s_mov_b32 s56, 786432
s_add_u32 m0, s52, 81920
s_nop 0
buffer_load_dwordx4 v42, s[12:15], s56 offen offset:0 lds
buffer_load_dwordx4 v43, s[12:15], s56 offen offset:1024 lds
s_mov_b32 s56, 1179648
s_add_u32 m0, s52, 90112
s_nop 0
buffer_load_dwordx4 v42, s[12:15], s56 offen offset:0 lds
buffer_load_dwordx4 v43, s[12:15], s56 offen offset:1024 lds
s_mov_b64 exec, 0
s_cmp_eq_u32 s32, 0
s_cbranch_scc1 pg_0
s_cmp_eq_u32 s32, 1
s_cbranch_scc1 pg_1
s_cmp_eq_u32 s32, 2
s_cbranch_scc1 pg_2
s_branch pg_3
pg_t8:
s_bitcmp1_b32 s2, 0
s_cbranch_scc1 pg_8_b
s_branch pg_8
pg_t9:
s_bitcmp1_b32 s2, 0
s_cbranch_scc1 pg_9_b
s_branch pg_9
pg_t10:
s_bitcmp1_b32 s2, 0
s_cbranch_scc1 pg_10_b
s_branch pg_10
pg_t11:
s_bitcmp1_b32 s2, 0
s_cbranch_scc1 pg_11_b
s_branch pg_11
.p2align 12
pg_back0:
s_mov_b64 exec, -1
s_getpc_b64 s[92:93]
k_pc2:
s_lshl2_add_u32 s101, s3, s32
s_lshl_b32 s101, s101, 6
s_add_u32 s92, s92, s101
s_addc_u32 s93, s93, 0
s_mov_b32 s98, 131072
ln_poll:
s_sleep 6
buffer_load_dword v33, v31, s[24:27], s67 offen sc1
s_waitcnt vmcnt(0)
v_cmp_ne_u32 vcc, v33, v32
s_sub_u32 s98, s98, 1
s_cbranch_scc1 ln_ok
s_cbranch_vccnz ln_poll
ln_ok:
s_add_u32 s54, s53, 0
buffer_load_dwordx4 a[128:131], v1, s[24:27], s54 offen offset:0 sc1
buffer_load_dwordx4 a[132:135], v1, s[24:27], s54 offen offset:1024 sc1
buffer_load_dwordx4 a[136:139], v1, s[24:27], s54 offen offset:2048 sc1
buffer_load_dwordx4 a[140:143], v1, s[24:27], s54 offen offset:3072 sc1
buffer_load_dwordx4 a[144:147], v2, s[24:27], s54 offen offset:0 sc1
buffer_load_dwordx4 a[148:151], v2, s[24:27], s54 offen offset:1024 sc1
buffer_load_dwordx4 a[152:155], v2, s[24:27], s54 offen offset:2048 sc1
buffer_load_dwordx4 a[156:159], v2, s[24:27], s54 offen offset:3072 sc1
s_add_u32 s54, s53, 8192
buffer_load_dwordx4 a[160:163], v1, s[24:27], s54 offen offset:0 sc1
buffer_load_dwordx4 a[164:167], v1, s[24:27], s54 offen offset:1024 sc1
buffer_load_dwordx4 a[168:171], v1, s[24:27], s54 offen offset:2048 sc1
buffer_load_dwordx4 a[172:175], v1, s[24:27], s54 offen offset:3072 sc1
buffer_load_dwordx4 a[176:179], v2, s[24:27], s54 offen offset:0 sc1
buffer_load_dwordx4 a[180:183], v2, s[24:27], s54 offen offset:1024 sc1
buffer_load_dwordx4 a[184:187], v2, s[24:27], s54 offen offset:2048 sc1
buffer_load_dwordx4 a[188:191], v2, s[24:27], s54 offen offset:3072 sc1
s_waitcnt vmcnt(36)
s_barrier
ds_read_b64_tr_b16 a[224:225], v16 offset:0
ds_read_b64_tr_b16 a[226:227], v16 offset:2048
ds_read_b64_tr_b16 a[228:229], v16 offset:4096
ds_read_b64_tr_b16 a[230:231], v16 offset:6144
ds_read_b64_tr_b16 a[232:233], v17 offset:0
ds_read_b64_tr_b16 a[234:235], v17 offset:2048
ds_read_b64_tr_b16 a[236:237], v17 offset:4096
ds_read_b64_tr_b16 a[238:239], v17 offset:6144
ds_read_b64_tr_b16 a[240:241], v18 offset:0
ds_read_b64_tr_b16 a[242:243], v18 offset:2048
ds_read_b64_tr_b16 a[244:245], v18 offset:4096
ds_read_b64_tr_b16 a[246:247], v18 offset:6144
s_waitcnt vmcnt(8) lgkmcnt(8)
v_mfma_f32_16x16x32_bf16 v[64:67], a[224:227], a[128:131], 0
s_add_u32 s54, s53, 16384
ds_read_b64_tr_b16 a[248:249], v19 offset:0
v_lshrrev_b32 v60, 4, v0
v_mfma_f32_16x16x32_bf16 v[64:67], a[228:231], a[132:135], v[64:67]
buffer_load_dwordx4 a[192:195], v1, s[24:27], s54 offen offset:0 sc1
v_mfma_f32_16x16x32_bf16 v[80:83], a[228:231], a[140:143], 0
s_and_b32 s5, s32, 1
ds_read_b64_tr_b16 a[250:251], v19 offset:2048
v_min_u32 v60, 1, v60
v_mfma_f32_16x16x32_bf16 v[80:83], a[224:227], a[136:139], v[80:83]
s_lshl_b32 s100, s5, 12
v_lshl_add_u32 v63, v60, 30, v63
v_add_u32 v56, 0, v0
v_mfma_f32_16x16x32_bf16 v[96:99], a[224:227], a[144:147], 0
s_cmp_eq_u32 s32, 3
s_cselect_b32 s90, 0, 8
ds_read_b64_tr_b16 a[252:253], v19 offset:4096
v_mfma_f32_16x16x32_bf16 v[96:99], a[228:231], a[148:151], v[96:99]
buffer_load_dwordx4 a[196:199], v1, s[24:27], s54 offen offset:1024 sc1
v_mfma_f32_16x16x32_bf16 v[112:115], a[228:231], a[156:159], 0
s_lshl_b32 s90, s90, 5
ds_read_b64_tr_b16 a[254:255], v19 offset:6144
v_mul_u32_u24 v57, 171, v56
v_mfma_f32_16x16x32_bf16 v[112:115], a[224:227], a[152:155], v[112:115]
s_waitcnt lgkmcnt(8)
v_lshrrev_b32 v57, 10, v57
v_mul_u32_u24 v58, 6, v57
v_mfma_f32_16x16x32_bf16 v[116:119], a[232:235], a[152:155], 0
s_mul_i32 s91, s3, 4
ds_read_b64_tr_b16 a[96:97], v16 offset:8192
v_sub_u32 v56, v56, v58
v_mfma_f32_16x16x32_bf16 v[116:119], a[236:239], a[156:159], v[116:119]
s_add_u32 s90, s90, s91
v_cmp_gt_u32 vcc, 4, v56
v_lshrrev_b32 v59, 4, v57
v_mfma_f32_16x16x32_bf16 v[100:103], a[236:239], a[148:151], 0
buffer_load_dwordx4 a[200:203], v1, s[24:27], s54 offen offset:2048 sc1
v_mfma_f32_16x16x32_bf16 v[100:103], a[232:235], a[144:147], v[100:103]
s_mul_i32 s90, s90, s88
ds_read_b64_tr_b16 a[98:99], v16 offset:10240
s_add_u32 s90, s90, s89
v_mfma_f32_16x16x32_bf16 v[84:87], a[232:235], a[136:139], 0
s_mul_i32 s91, s88, 128
ds_read_b64_tr_b16 a[100:101], v16 offset:12288
s_mul_i32 s5, s5, 229376
v_mfma_f32_16x16x32_bf16 v[84:87], a[236:239], a[140:143], v[84:87]
s_lshr_b32 s6, s34, 1
s_mul_i32 s6, s6, 192
s_add_u32 s5, s5, s6
v_mfma_f32_16x16x32_bf16 v[68:71], a[236:239], a[132:135], 0
s_and_b32 s7, s34, 1
ds_read_b64_tr_b16 a[102:103], v16 offset:14336
s_lshl_b32 s6, s7, 3
v_mfma_f32_16x16x32_bf16 v[68:71], a[232:235], a[128:131], v[68:71]
s_waitcnt lgkmcnt(8)
s_sub_u32 s4, s7, 4
v_lshl_add_u32 v58, v56, 1, s4
v_mfma_f32_16x16x32_bf16 v[128:131], a[240:243], a[128:131], 0
buffer_load_dword v61, v63, s[48:51], s90 offen
v_mfma_f32_16x16x32_bf16 v[128:131], a[244:247], a[132:135], v[128:131]
s_add_u32 s90, s90, s91
ds_read_b64_tr_b16 a[104:105], v17 offset:8192
v_add_u32 v56, s6, v56
v_mfma_f32_16x16x32_bf16 v[144:147], a[244:247], a[140:143], 0
ds_read_b64_tr_b16 a[106:107], v17 offset:10240
v_cndmask_b32 v56, v58, v56, vcc
v_mfma_f32_16x16x32_bf16 v[144:147], a[240:243], a[136:139], v[144:147]
v_bfe_u32 v58, v57, 2, 2
v_lshl_add_u32 v58, v58, 1, v59
v_mfma_f32_16x16x32_bf16 v[160:163], a[240:243], a[144:147], 0
ds_read_b64_tr_b16 a[108:109], v17 offset:12288
v_and_b32 v57, 3, v57
v_mfma_f32_16x16x32_bf16 v[160:163], a[244:247], a[148:151], v[160:163]
v_lshl_add_u32 v57, v58, 2, v57
v_mul_u32_u24 v57, 7168, v57
v_mfma_f32_16x16x32_bf16 v[176:179], a[244:247], a[156:159], 0
ds_read_b64_tr_b16 a[110:111], v17 offset:14336
v_lshl_add_u32 v57, v56, 4, v57
v_mfma_f32_16x16x32_bf16 v[176:179], a[240:243], a[152:155], v[176:179]
s_waitcnt lgkmcnt(8)
v_add_u32 v57, 3072, v57
v_add_u32 v13, s5, v57
v_mfma_f32_16x16x32_bf16 v[180:183], a[248:251], a[152:155], 0
ds_read_b64_tr_b16 a[224:225], v18 offset:8192
v_add_u32 v56, 64, v0
v_mfma_f32_16x16x32_bf16 v[180:183], a[252:255], a[156:159], v[180:183]
v_mul_u32_u24 v57, 171, v56
v_lshrrev_b32 v57, 10, v57
v_mfma_f32_16x16x32_bf16 v[164:167], a[252:255], a[148:151], 0
ds_read_b64_tr_b16 a[226:227], v18 offset:10240
v_mul_u32_u24 v58, 6, v57
v_mfma_f32_16x16x32_bf16 v[164:167], a[248:251], a[144:147], v[164:167]
buffer_load_dwordx4 a[204:207], v1, s[24:27], s54 offen offset:3072 sc1
v_mfma_f32_16x16x32_bf16 v[148:151], a[248:251], a[136:139], 0
ds_read_b64_tr_b16 a[228:229], v18 offset:12288
v_sub_u32 v56, v56, v58
v_mfma_f32_16x16x32_bf16 v[148:151], a[252:255], a[140:143], v[148:151]
v_cmp_gt_u32 vcc, 4, v56
v_lshl_add_u32 v58, v56, 1, s4
v_mfma_f32_16x16x32_bf16 v[132:135], a[252:255], a[132:135], 0
ds_read_b64_tr_b16 a[230:231], v18 offset:14336
v_add_u32 v56, s6, v56
v_mfma_f32_16x16x32_bf16 v[132:135], a[248:251], a[128:131], v[132:135]
s_waitcnt lgkmcnt(8)
v_cndmask_b32 v56, v58, v56, vcc
v_bfe_u32 v58, v57, 2, 2
v_mfma_f32_16x16x32_bf16 v[72:75], a[96:99], a[128:131], 0
buffer_load_dwordx4 a[208:211], v2, s[24:27], s54 offen offset:0 sc1
v_mfma_f32_16x16x32_bf16 v[72:75], a[100:103], a[132:135], v[72:75]
ds_read_b64_tr_b16 a[232:233], v19 offset:8192
v_lshrrev_b32 v59, 4, v57
v_mfma_f32_16x16x32_bf16 v[88:91], a[100:103], a[140:143], 0
ds_read_b64_tr_b16 a[234:235], v19 offset:10240
v_lshl_add_u32 v58, v58, 1, v59
v_mfma_f32_16x16x32_bf16 v[88:91], a[96:99], a[136:139], v[88:91]
v_and_b32 v57, 3, v57
v_lshl_add_u32 v57, v58, 2, v57
v_mfma_f32_16x16x32_bf16 v[104:107], a[96:99], a[144:147], 0
ds_read_b64_tr_b16 a[236:237], v19 offset:12288
v_mul_u32_u24 v57, 7168, v57
v_mfma_f32_16x16x32_bf16 v[104:107], a[100:103], a[148:151], v[104:107]
v_lshl_add_u32 v57, v56, 4, v57
v_add_u32 v57, 2048, v57
v_mfma_f32_16x16x32_bf16 v[120:123], a[100:103], a[156:159], 0
buffer_load_dwordx4 a[212:215], v2, s[24:27], s54 offen offset:1024 sc1
v_mfma_f32_16x16x32_bf16 v[120:123], a[96:99], a[152:155], v[120:123]
s_waitcnt lgkmcnt(7)
ds_read_b64_tr_b16 a[238:239], v19 offset:14336
v_add_u32 v14, s5, v57
v_mfma_f32_16x16x32_bf16 v[124:127], a[104:107], a[152:155], 0
ds_read_b64_tr_b16 a[240:241], v4 offset:16384
v_add_u32 v56, 128, v0
v_mfma_f32_16x16x32_bf16 v[124:127], a[108:111], a[156:159], v[124:127]
v_mul_u32_u24 v57, 171, v56
v_lshrrev_b32 v57, 10, v57
v_mfma_f32_16x16x32_bf16 v[108:111], a[108:111], a[148:151], 0
ds_read_b64_tr_b16 a[242:243], v4 offset:18432
v_mul_u32_u24 v58, 6, v57
v_mfma_f32_16x16x32_bf16 v[108:111], a[104:107], a[144:147], v[108:111]
buffer_load_dwordx4 a[216:219], v2, s[24:27], s54 offen offset:2048 sc1
v_mfma_f32_16x16x32_bf16 v[92:95], a[104:107], a[136:139], 0
ds_read_b64_tr_b16 a[244:245], v4 offset:20480
v_sub_u32 v56, v56, v58
v_mfma_f32_16x16x32_bf16 v[92:95], a[108:111], a[140:143], v[92:95]
v_cmp_gt_u32 vcc, 4, v56
v_lshl_add_u32 v58, v56, 1, s4
v_mfma_f32_16x16x32_bf16 v[76:79], a[108:111], a[132:135], 0
ds_read_b64_tr_b16 a[246:247], v4 offset:22528
v_add_u32 v56, s6, v56
v_mfma_f32_16x16x32_bf16 v[76:79], a[104:107], a[128:131], v[76:79]
s_waitcnt lgkmcnt(8)
v_cndmask_b32 v56, v58, v56, vcc
v_bfe_u32 v58, v57, 2, 2
v_mfma_f32_16x16x32_bf16 v[136:139], a[224:227], a[128:131], 0
ds_read_b64_tr_b16 a[248:249], v5 offset:16384
v_lshrrev_b32 v59, 4, v57
v_mfma_f32_16x16x32_bf16 v[136:139], a[228:231], a[132:135], v[136:139]
buffer_load_dwordx4 a[220:223], v2, s[24:27], s54 offen offset:3072 sc1
v_mfma_f32_16x16x32_bf16 v[152:155], a[228:231], a[140:143], 0
s_add_u32 s54, s53, 24576
ds_read_b64_tr_b16 a[250:251], v5 offset:18432
v_lshl_add_u32 v58, v58, 1, v59
v_mfma_f32_16x16x32_bf16 v[152:155], a[224:227], a[136:139], v[152:155]
v_and_b32 v57, 3, v57
v_lshl_add_u32 v57, v58, 2, v57
v_mfma_f32_16x16x32_bf16 v[168:171], a[224:227], a[144:147], 0
ds_read_b64_tr_b16 a[252:253], v5 offset:20480
v_mul_u32_u24 v57, 7168, v57
v_mfma_f32_16x16x32_bf16 v[168:171], a[228:231], a[148:151], v[168:171]
v_lshl_add_u32 v57, v56, 4, v57
v_add_u32 v57, 1024, v57
v_mfma_f32_16x16x32_bf16 v[184:187], a[228:231], a[156:159], 0
buffer_load_dwordx4 a[0:3], v1, s[24:27], s54 offen offset:0 sc1
v_mfma_f32_16x16x32_bf16 v[184:187], a[224:227], a[152:155], v[184:187]
s_waitcnt lgkmcnt(7)
ds_read_b64_tr_b16 a[254:255], v5 offset:22528
v_add_u32 v3, s5, v57
v_mfma_f32_16x16x32_bf16 v[188:191], a[232:235], a[152:155], 0
s_cmp_lt_u32 s32, 2
s_cselect_b32 s36, s80, s82
s_cselect_b32 s37, s81, s83
ds_read_b64_tr_b16 a[96:97], v4 offset:17408
v_mfma_f32_16x16x32_bf16 v[188:191], a[236:239], a[156:159], v[188:191]
s_mov_b32 s38, 7340032
v_lshrrev_b32 v56, 2, v0
v_mul_u32_u24 v56, 96, v56
v_mfma_f32_16x16x32_bf16 v[172:175], a[236:239], a[148:151], 0
s_mov_b32 s39, 0x20000
ds_read_b64_tr_b16 a[98:99], v4 offset:19456
v_and_b32 v57, 3, v0
v_mfma_f32_16x16x32_bf16 v[172:175], a[232:235], a[144:147], v[172:175]
s_lshr_b32 s5, s32, 1
v_lshl_add_u32 v10, v57, 3, v56
s_lshl_b32 s5, s5, 4
v_mfma_f32_16x16x32_bf16 v[156:159], a[232:235], a[136:139], 0
buffer_load_dwordx4 a[4:7], v1, s[24:27], s54 offen offset:1024 sc1
v_mfma_f32_16x16x32_bf16 v[156:159], a[236:239], a[140:143], v[156:159]
s_or_b32 s99, s5, 0x100000
ds_read_b64_tr_b16 a[100:101], v4 offset:21504
s_mov_b32 s40, s84
v_mfma_f32_16x16x32_bf16 v[140:143], a[236:239], a[132:135], 0
s_mov_b32 s41, s85
ds_read_b64_tr_b16 a[102:103], v4 offset:23552
s_mov_b32 s42, 0x700000
v_mfma_f32_16x16x32_bf16 v[140:143], a[232:235], a[128:131], v[140:143]
s_waitcnt lgkmcnt(8)
s_mov_b32 s43, 0x20000
s_mov_b32 s44, s74
v_mfma_f32_16x16x32_bf16 v[192:195], a[240:243], a[128:131], 0
s_mov_b32 s45, s75
ds_read_b64_tr_b16 a[104:105], v5 offset:17408
s_mov_b32 s46, 0x200000
v_mfma_f32_16x16x32_bf16 v[192:195], a[244:247], a[132:135], v[192:195]
buffer_load_dwordx4 a[8:11], v1, s[24:27], s54 offen offset:2048 sc1
v_mfma_f32_16x16x32_bf16 v[200:203], a[244:247], a[140:143], 0
s_mov_b32 s47, 0x20000
ds_read_b64_tr_b16 a[106:107], v5 offset:19456
s_bfe_u32 s5, s2, 0x20001
v_mfma_f32_16x16x32_bf16 v[200:203], a[240:243], a[136:139], v[200:203]
s_lshl_b32 s5, s5, 2
s_and_b32 s6, s3, 3
s_add_u32 s5, s5, s6
v_mfma_f32_16x16x32_bf16 v[208:211], a[240:243], a[144:147], 0
s_lshl_b32 s5, s5, 2
ds_read_b64_tr_b16 a[108:109], v5 offset:21504
s_add_u32 s69, s5, s32
v_mfma_f32_16x16x32_bf16 v[208:211], a[244:247], a[148:151], v[208:211]
s_lshr_b32 s4, s3, 2
s_lshl_b32 s4, s4, 2
s_lshr_b32 s4, 0x70643215, s4
v_mfma_f32_16x16x32_bf16 v[216:219], a[244:247], a[156:159], 0
s_and_b32 s4, s4, 7
ds_read_b64_tr_b16 a[110:111], v5 offset:23552
v_add_u32 v11, 0x10000, v10
v_mfma_f32_16x16x32_bf16 v[216:219], a[240:243], a[152:155], v[216:219]
s_waitcnt vmcnt(41) lgkmcnt(8)
s_barrier
v_mfma_f32_16x16x32_bf16 v[220:223], a[248:251], a[152:155], 0
buffer_load_dwordx4 a[12:15], v1, s[24:27], s54 offen offset:3072 sc1
v_mfma_f32_16x16x32_bf16 v[220:223], a[252:255], a[156:159], v[220:223]
s_add_u32 s6, s6, s4
ds_read_b64_tr_b16 a[224:225], v16 offset:24576
v_add_u32 v12, 0x20000, v10
v_mfma_f32_16x16x32_bf16 v[212:215], a[252:255], a[148:151], 0
s_and_b32 s6, s6, 3
ds_read_b64_tr_b16 a[226:227], v16 offset:26624
s_lshl_b32 s6, s6, 3
v_mfma_f32_16x16x32_bf16 v[212:215], a[248:251], a[144:147], v[212:215]
s_or_b32 s64, s6, 0x80000
s_lshr_b32 s5, s4, 0
s_lshl_b32 s5, s5, 0
v_mfma_f32_16x16x32_bf16 v[204:207], a[248:251], a[136:139], 0
buffer_load_dwordx4 a[16:19], v2, s[24:27], s54 offen offset:0 sc1
v_mfma_f32_16x16x32_bf16 v[204:207], a[252:255], a[140:143], v[204:207]
s_add_u32 s5, s5, s4
ds_read_b64_tr_b16 a[228:229], v16 offset:28672
s_lshl_b32 s5, s5, 7
v_mfma_f32_16x16x32_bf16 v[196:199], a[252:255], a[132:135], 0
s_lshl_b32 s6, s32, 15
ds_read_b64_tr_b16 a[230:231], v16 offset:30720
s_add_u32 s6, s6, s5
v_mfma_f32_16x16x32_bf16 v[196:199], a[248:251], a[128:131], v[196:199]
s_waitcnt lgkmcnt(8)
v_add_u32 v28, s6, v28
v_add_u32 v29, 15360, v28
v_mfma_f32_16x16x32_bf16 v[224:227], a[128:131], a[96:99], 0
s_and_b32 s4, s2, 1
ds_read_b64_tr_b16 a[232:233], v17 offset:24576
s_lshl_b32 s6, s4, 7
v_mfma_f32_16x16x32_bf16 v[224:227], a[132:135], a[100:103], v[224:227]
buffer_load_dwordx4 a[20:23], v2, s[24:27], s54 offen offset:1024 sc1
v_mfma_f32_16x16x32_bf16 v[228:231], a[140:143], a[100:103], 0
s_add_u32 s5, s5, s6
ds_read_b64_tr_b16 a[234:235], v17 offset:26624
s_lshl_b32 s65, s69, 16
v_mfma_f32_16x16x32_bf16 v[228:231], a[136:139], a[96:99], v[228:231]
s_add_u32 s65, s65, s5
s_mul_i32 s63, s69, 294912
s_add_u32 s71, s63, 17006592
v_mfma_f32_16x16x32_bf16 v[232:235], a[144:147], a[96:99], 0
s_add_u32 s63, s63, 16777216
ds_read_b64_tr_b16 a[236:237], v17 offset:28672
s_lshr_b32 s62, s69, 1
v_mfma_f32_16x16x32_bf16 v[232:235], a[148:151], a[100:103], v[232:235]
s_lshl_b32 s62, s62, 9
s_add_u32 s62, s62, 50331648
v_and_b32 v31, 31, v0
v_mfma_f32_16x16x32_bf16 v[236:239], a[156:159], a[100:103], 0
s_lshl_b32 s5, s33, 2
ds_read_b64_tr_b16 a[238:239], v17 offset:30720
v_lshlrev_b32 v31, 2, v31
v_mfma_f32_16x16x32_bf16 v[236:239], a[152:155], a[96:99], v[236:239]
s_waitcnt lgkmcnt(8)
buffer_load_dwordx4 a[24:27], v2, s[24:27], s54 offen offset:2048 sc1
v_mfma_f32_16x16x32_bf16 v[252:255], a[152:155], a[104:107], 0
s_add_u32 s5, s5, s32
ds_read_b64_tr_b16 a[240:241], v18 offset:24576
v_and_b32 v56, 1, v55
v_mfma_f32_16x16x32_bf16 v[252:255], a[156:159], a[108:111], v[252:255]
s_lshl_b32 s61, s5, 7
v_lshlrev_b32 v56, 5, v56
v_lshrrev_b32 v57, 1, v55
v_mfma_f32_16x16x32_bf16 v[248:251], a[148:151], a[108:111], 0
s_add_u32 s61, s61, s34
ds_read_b64_tr_b16 a[242:243], v18 offset:26624
v_lshl_add_u32 v56, v57, 4, v56
v_mfma_f32_16x16x32_bf16 v[248:251], a[144:147], a[104:107], v[248:251]
s_lshl_b32 s61, s61, 2
v_and_b32 v57, 15, v0
v_lshl_add_u32 v34, v57, 11, v56
v_mfma_f32_16x16x32_bf16 v[244:247], a[136:139], a[104:107], 0
buffer_load_dwordx4 a[28:31], v2, s[24:27], s54 offen offset:3072 sc1
v_mfma_f32_16x16x32_bf16 v[244:247], a[140:143], a[108:111], v[244:247]
s_mov_b32 s55, 1835008
ds_read_b64_tr_b16 a[244:245], v18 offset:28672
v_bfe_u32 v56, v0, 2, 2
v_mfma_f32_16x16x32_bf16 v[240:243], a[132:135], a[108:111], 0
s_add_u32 m0, s52, 98304
ds_read_b64_tr_b16 a[246:247], v18 offset:30720
v_cmp_eq_u32 vcc, v56, v55
v_mfma_f32_16x16x32_bf16 v[240:243], a[128:131], a[104:107], v[240:243]
s_waitcnt vmcnt(17) lgkmcnt(8)
v_and_b32 v56, 1, v0
v_lshlrev_b32 v56, 4, v56
v_mfma_f32_16x16x32_bf16 v[64:67], a[224:227], a[160:163], v[64:67]
s_add_u32 s61, s61, 50331648
ds_read_b64_tr_b16 a[248:249], v19 offset:24576
v_mov_b32 v57, 0x3f80
v_mfma_f32_16x16x32_bf16 v[64:67], a[228:231], a[164:167], v[64:67]
s_mul_i32 s69, s5, 589824
v_lshlrev_b32 v56, v56, v57
v_cndmask_b32 v56, 0, v56, vcc
v_mfma_f32_16x16x32_bf16 v[80:83], a[228:231], a[172:175], v[80:83]
buffer_load_dwordx4 v40, s[16:19], s55 offen offset:0 lds
v_mfma_f32_16x16x32_bf16 v[80:83], a[224:227], a[168:171], v[80:83]
s_add_u32 s69, s69, 16777216
ds_read_b64_tr_b16 a[250:251], v19 offset:26624
v_and_b32 v57, 2, v0
v_mfma_f32_16x16x32_bf16 v[96:99], a[224:227], a[176:179], v[96:99]
s_lshl_b32 s59, s59, 5
ds_read_b64_tr_b16 a[252:253], v19 offset:28672
v_cmp_eq_u32 vcc, 0, v57
v_mfma_f32_16x16x32_bf16 v[96:99], a[228:231], a[180:183], v[96:99]
s_add_u32 s59, s59, s69
v_cndmask_b32 v38, 0, v56, vcc
v_cndmask_b32 v39, v56, 0, vcc
v_mfma_f32_16x16x32_bf16 v[112:115], a[228:231], a[188:191], v[112:115]
s_lshr_b32 s5, s34, 1
ds_read_b64_tr_b16 a[254:255], v19 offset:30720
v_mov_b32 v48, 0x3f803f80
v_mfma_f32_16x16x32_bf16 v[112:115], a[224:227], a[184:187], v[112:115]
s_waitcnt lgkmcnt(8)
buffer_load_dwordx4 v41, s[16:19], s55 offen offset:1024 lds
v_mfma_f32_16x16x32_bf16 v[116:119], a[232:235], a[184:187], v[116:119]
s_mov_b32 s55, 2293760
ds_read_b64_tr_b16 a[96:97], v16 offset:32768
v_mov_b32 v49, 0x3f803f80
v_mfma_f32_16x16x32_bf16 v[116:119], a[236:239], a[188:191], v[116:119]
s_add_u32 m0, s52, 106496
v_mov_b32 v50, 0x3f803f80
v_mov_b32 v51, 0x3f803f80
v_mfma_f32_16x16x32_bf16 v[100:103], a[236:239], a[180:183], v[100:103]
s_mul_i32 s5, s5, 6144
ds_read_b64_tr_b16 a[98:99], v16 offset:34816
s_add_u32 s5, s5, s69
v_mfma_f32_16x16x32_bf16 v[100:103], a[232:235], a[176:179], v[100:103]
s_add_u32 s5, s5, 131072
s_lshl_b32 s6, s7, 12
s_add_u32 s60, s5, s6
v_mfma_f32_16x16x32_bf16 v[84:87], a[232:235], a[168:171], v[84:87]
s_lshl_b32 s6, s7, 9
ds_read_b64_tr_b16 a[100:101], v16 offset:36864
s_add_u32 s5, s5, s6
v_mfma_f32_16x16x32_bf16 v[84:87], a[236:239], a[172:175], v[84:87]
buffer_load_dword v61, v63, s[48:51], s90 offen
v_mfma_f32_16x16x32_bf16 v[68:71], a[236:239], a[164:167], v[68:71]
s_add_u32 s90, s90, s91
ds_read_b64_tr_b16 a[102:103], v16 offset:38912
s_add_u32 s66, s5, 2048
v_mfma_f32_16x16x32_bf16 v[68:71], a[232:235], a[160:163], v[68:71]
s_waitcnt lgkmcnt(8)
s_lshl_b32 s68, s34, 2
s_add_u32 s68, s68, s32
v_mfma_f32_16x16x32_bf16 v[128:131], a[240:243], a[160:163], v[128:131]
s_mov_b32 s57, 0xbfb8aa3b
ds_read_b64_tr_b16 a[104:105], v17 offset:32768
s_mov_b32 s58, 0x3fb8aa3b
v_mfma_f32_16x16x32_bf16 v[128:131], a[244:247], a[164:167], v[128:131]
s_load_dword s101, s[92:93], 4088
v_mfma_f32_16x16x32_bf16 v[144:147], a[244:247], a[172:175], v[144:147]
ds_read_b64_tr_b16 a[106:107], v17 offset:34816
v_mfma_f32_16x16x32_bf16 v[144:147], a[240:243], a[168:171], v[144:147]
v_mfma_f32_16x16x32_bf16 v[160:163], a[240:243], a[176:179], v[160:163]
ds_read_b64_tr_b16 a[108:109], v17 offset:36864
v_mfma_f32_16x16x32_bf16 v[160:163], a[244:247], a[180:183], v[160:163]
v_mfma_f32_16x16x32_bf16 v[176:179], a[244:247], a[188:191], v[176:179]
ds_read_b64_tr_b16 a[110:111], v17 offset:38912
v_mfma_f32_16x16x32_bf16 v[176:179], a[240:243], a[184:187], v[176:179]
s_waitcnt lgkmcnt(8)
v_mfma_f32_16x16x32_bf16 v[180:183], a[248:251], a[184:187], v[180:183]
buffer_load_dwordx4 v40, s[16:19], s55 offen offset:0 lds
v_mfma_f32_16x16x32_bf16 v[180:183], a[252:255], a[188:191], v[180:183]
ds_read_b64_tr_b16 a[224:225], v18 offset:32768
v_mfma_f32_16x16x32_bf16 v[164:167], a[252:255], a[180:183], v[164:167]
ds_read_b64_tr_b16 a[226:227], v18 offset:34816
v_mfma_f32_16x16x32_bf16 v[164:167], a[248:251], a[176:179], v[164:167]
v_mfma_f32_16x16x32_bf16 v[148:151], a[248:251], a[168:171], v[148:151]
ds_read_b64_tr_b16 a[228:229], v18 offset:36864
v_mfma_f32_16x16x32_bf16 v[148:151], a[252:255], a[172:175], v[148:151]
buffer_load_dwordx4 v41, s[16:19], s55 offen offset:1024 lds
v_mfma_f32_16x16x32_bf16 v[132:135], a[252:255], a[164:167], v[132:135]
s_mov_b32 s55, 1835008
ds_read_b64_tr_b16 a[230:231], v18 offset:38912
s_add_u32 m0, s52, 114688
v_mfma_f32_16x16x32_bf16 v[132:135], a[248:251], a[160:163], v[132:135]
s_waitcnt lgkmcnt(8)
v_mfma_f32_16x16x32_bf16 v[72:75], a[96:99], a[160:163], v[72:75]
ds_read_b64_tr_b16 a[232:233], v19 offset:32768
v_mfma_f32_16x16x32_bf16 v[72:75], a[100:103], a[164:167], v[72:75]
v_mfma_f32_16x16x32_bf16 v[88:91], a[100:103], a[172:175], v[88:91]
ds_read_b64_tr_b16 a[234:235], v19 offset:34816
v_mfma_f32_16x16x32_bf16 v[88:91], a[96:99], a[168:171], v[88:91]
buffer_load_dwordx4 v40, s[20:23], s55 offen offset:0 lds
v_mfma_f32_16x16x32_bf16 v[104:107], a[96:99], a[176:179], v[104:107]
ds_read_b64_tr_b16 a[236:237], v19 offset:36864
v_mfma_f32_16x16x32_bf16 v[104:107], a[100:103], a[180:183], v[104:107]
v_mfma_f32_16x16x32_bf16 v[120:123], a[100:103], a[188:191], v[120:123]
ds_read_b64_tr_b16 a[238:239], v19 offset:38912
v_mfma_f32_16x16x32_bf16 v[120:123], a[96:99], a[184:187], v[120:123]
s_waitcnt lgkmcnt(8)
v_mfma_f32_16x16x32_bf16 v[124:127], a[104:107], a[184:187], v[124:127]
buffer_load_dwordx4 v41, s[20:23], s55 offen offset:1024 lds
v_mfma_f32_16x16x32_bf16 v[124:127], a[108:111], a[188:191], v[124:127]
s_mov_b32 s55, 2293760
ds_read_b64_tr_b16 a[240:241], v4 offset:40960
s_add_u32 m0, s52, 122880
v_mfma_f32_16x16x32_bf16 v[108:111], a[108:111], a[180:183], v[108:111]
ds_read_b64_tr_b16 a[242:243], v4 offset:43008
v_mfma_f32_16x16x32_bf16 v[108:111], a[104:107], a[176:179], v[108:111]
v_mfma_f32_16x16x32_bf16 v[92:95], a[104:107], a[168:171], v[92:95]
ds_read_b64_tr_b16 a[244:245], v4 offset:45056
v_mfma_f32_16x16x32_bf16 v[92:95], a[108:111], a[172:175], v[92:95]
v_mfma_f32_16x16x32_bf16 v[76:79], a[108:111], a[164:167], v[76:79]
buffer_load_dwordx4 v40, s[20:23], s55 offen offset:0 lds
v_mfma_f32_16x16x32_bf16 v[76:79], a[104:107], a[160:163], v[76:79]
s_waitcnt lgkmcnt(7)
ds_read_b64_tr_b16 a[246:247], v4 offset:47104
v_mfma_f32_16x16x32_bf16 v[136:139], a[224:227], a[160:163], v[136:139]
ds_read_b64_tr_b16 a[248:249], v5 offset:40960
v_mfma_f32_16x16x32_bf16 v[136:139], a[228:231], a[164:167], v[136:139]
v_mfma_f32_16x16x32_bf16 v[152:155], a[228:231], a[172:175], v[152:155]
ds_read_b64_tr_b16 a[250:251], v5 offset:43008
v_mfma_f32_16x16x32_bf16 v[152:155], a[224:227], a[168:171], v[152:155]
buffer_load_dwordx4 v41, s[20:23], s55 offen offset:1024 lds
v_mfma_f32_16x16x32_bf16 v[168:171], a[224:227], a[176:179], v[168:171]
s_mov_b32 s56, 1572864
ds_read_b64_tr_b16 a[252:253], v5 offset:45056
s_add_u32 m0, s52, 131072
v_mfma_f32_16x16x32_bf16 v[168:171], a[228:231], a[180:183], v[168:171]
v_mfma_f32_16x16x32_bf16 v[184:187], a[228:231], a[188:191], v[184:187]
ds_read_b64_tr_b16 a[254:255], v5 offset:47104
v_mfma_f32_16x16x32_bf16 v[184:187], a[224:227], a[184:187], v[184:187]
s_waitcnt lgkmcnt(8)
v_mfma_f32_16x16x32_bf16 v[188:191], a[232:235], a[184:187], v[188:191]
ds_read_b64_tr_b16 a[96:97], v4 offset:41984
v_mfma_f32_16x16x32_bf16 v[188:191], a[236:239], a[188:191], v[188:191]
buffer_load_dwordx4 v42, s[12:15], s56 offen offset:0 lds
v_mfma_f32_16x16x32_bf16 v[172:175], a[236:239], a[180:183], v[172:175]
ds_read_b64_tr_b16 a[98:99], v4 offset:44032
v_mfma_f32_16x16x32_bf16 v[172:175], a[232:235], a[176:179], v[172:175]
v_mfma_f32_16x16x32_bf16 v[156:159], a[232:235], a[168:171], v[156:159]
ds_read_b64_tr_b16 a[100:101], v4 offset:46080
v_mfma_f32_16x16x32_bf16 v[156:159], a[236:239], a[172:175], v[156:159]
v_mfma_f32_16x16x32_bf16 v[140:143], a[236:239], a[164:167], v[140:143]
ds_read_b64_tr_b16 a[102:103], v4 offset:48128
v_mfma_f32_16x16x32_bf16 v[140:143], a[232:235], a[160:163], v[140:143]
s_waitcnt lgkmcnt(8)
v_mfma_f32_16x16x32_bf16 v[192:195], a[240:243], a[160:163], v[192:195]
ds_read_b64_tr_b16 a[104:105], v5 offset:41984
v_mfma_f32_16x16x32_bf16 v[192:195], a[244:247], a[164:167], v[192:195]
v_mfma_f32_16x16x32_bf16 v[200:203], a[244:247], a[172:175], v[200:203]
ds_read_b64_tr_b16 a[106:107], v5 offset:44032
v_mfma_f32_16x16x32_bf16 v[200:203], a[240:243], a[168:171], v[200:203]
v_mfma_f32_16x16x32_bf16 v[208:211], a[240:243], a[176:179], v[208:211]
buffer_load_dwordx4 v43, s[12:15], s56 offen offset:1024 lds
v_mfma_f32_16x16x32_bf16 v[208:211], a[244:247], a[180:183], v[208:211]
s_mov_b32 s56, 1966080
ds_read_b64_tr_b16 a[108:109], v5 offset:46080
s_add_u32 m0, s52, 139264
v_mfma_f32_16x16x32_bf16 v[216:219], a[244:247], a[188:191], v[216:219]
ds_read_b64_tr_b16 a[110:111], v5 offset:48128
v_mfma_f32_16x16x32_bf16 v[216:219], a[240:243], a[184:187], v[216:219]
s_waitcnt vmcnt(45) lgkmcnt(8)
s_barrier
v_mfma_f32_16x16x32_bf16 v[220:223], a[248:251], a[184:187], v[220:223]
ds_read_b64_tr_b16 a[224:225], v16 offset:49152
v_mfma_f32_16x16x32_bf16 v[220:223], a[252:255], a[188:191], v[220:223]
v_mfma_f32_16x16x32_bf16 v[212:215], a[252:255], a[180:183], v[212:215]
ds_read_b64_tr_b16 a[226:227], v16 offset:51200
v_mfma_f32_16x16x32_bf16 v[212:215], a[248:251], a[176:179], v[212:215]
v_mfma_f32_16x16x32_bf16 v[204:207], a[248:251], a[168:171], v[204:207]
ds_read_b64_tr_b16 a[228:229], v16 offset:53248
v_mfma_f32_16x16x32_bf16 v[204:207], a[252:255], a[172:175], v[204:207]
v_mfma_f32_16x16x32_bf16 v[196:199], a[252:255], a[164:167], v[196:199]
buffer_load_dwordx4 v42, s[12:15], s56 offen offset:0 lds
v_mfma_f32_16x16x32_bf16 v[196:199], a[248:251], a[160:163], v[196:199]
s_waitcnt lgkmcnt(7)
ds_read_b64_tr_b16 a[230:231], v16 offset:55296
v_mfma_f32_16x16x32_bf16 v[224:227], a[160:163], a[96:99], v[224:227]
ds_read_b64_tr_b16 a[232:233], v16 offset:57344
v_mfma_f32_16x16x32_bf16 v[224:227], a[164:167], a[100:103], v[224:227]
v_mfma_f32_16x16x32_bf16 v[228:231], a[172:175], a[100:103], v[228:231]
ds_read_b64_tr_b16 a[234:235], v16 offset:59392
v_mfma_f32_16x16x32_bf16 v[228:231], a[168:171], a[96:99], v[228:231]
v_mfma_f32_16x16x32_bf16 v[232:235], a[176:179], a[96:99], v[232:235]
ds_read_b64_tr_b16 a[236:237], v16 offset:61440
v_mfma_f32_16x16x32_bf16 v[232:235], a[180:183], a[100:103], v[232:235]
v_mfma_f32_16x16x32_bf16 v[236:239], a[188:191], a[100:103], v[236:239]
ds_read_b64_tr_b16 a[238:239], v16 offset:63488
v_mfma_f32_16x16x32_bf16 v[236:239], a[184:187], a[96:99], v[236:239]
s_waitcnt lgkmcnt(8)
v_mfma_f32_16x16x32_bf16 v[252:255], a[184:187], a[104:107], v[252:255]
ds_read_b64_tr_b16 a[240:241], v17 offset:49152
v_mfma_f32_16x16x32_bf16 v[252:255], a[188:191], a[108:111], v[252:255]
buffer_load_dwordx4 v43, s[12:15], s56 offen offset:1024 lds
v_mfma_f32_16x16x32_bf16 v[248:251], a[180:183], a[108:111], v[248:251]
s_add_u32 s54, s53, 32768
ds_read_b64_tr_b16 a[242:243], v17 offset:51200
ds_read_b64_tr_b16 a[244:245], v17 offset:53248
v_mfma_f32_16x16x32_bf16 v[248:251], a[176:179], a[104:107], v[248:251]
ds_read_b64_tr_b16 a[246:247], v17 offset:55296
v_mfma_f32_16x16x32_bf16 v[244:247], a[168:171], a[104:107], v[244:247]
ds_read_b64_tr_b16 a[248:249], v17 offset:57344
v_mfma_f32_16x16x32_bf16 v[244:247], a[172:175], a[108:111], v[244:247]
ds_read_b64_tr_b16 a[250:251], v17 offset:59392
v_mfma_f32_16x16x32_bf16 v[240:243], a[164:167], a[108:111], v[240:243]
ds_read_b64_tr_b16 a[252:253], v17 offset:61440
v_mfma_f32_16x16x32_bf16 v[240:243], a[160:163], a[104:107], v[240:243]
s_waitcnt vmcnt(13) lgkmcnt(7)
ds_read_b64_tr_b16 a[254:255], v17 offset:63488
v_mfma_f32_16x16x32_bf16 v[64:67], a[224:227], a[192:195], v[64:67]
pg_0:
s_cbranch_execz pg_4
ds_read_b64_tr_b16 a[96:97], v18 offset:49152
v_mfma_f32_16x16x32_bf16 v[64:67], a[228:231], a[196:199], v[64:67]
v_mfma_f32_16x16x32_bf16 v[64:67], a[232:235], a[0:3], v[64:67]
ds_read_b64_tr_b16 a[98:99], v18 offset:51200
v_mfma_f32_16x16x32_bf16 v[64:67], a[236:239], a[4:7], v[64:67]
v_mfma_f32_16x16x32_bf16 v[80:83], a[236:239], a[12:15], v[80:83]
buffer_load_dwordx4 a[128:131], v1, s[24:27], s54 offen offset:0 sc1
v_mfma_f32_16x16x32_bf16 v[80:83], a[232:235], a[8:11], v[80:83]
ds_read_b64_tr_b16 a[100:101], v18 offset:53248
v_mfma_f32_16x16x32_bf16 v[80:83], a[228:231], a[204:207], v[80:83]
ds_read_b64_tr_b16 a[102:103], v18 offset:55296
v_mfma_f32_16x16x32_bf16 v[80:83], a[224:227], a[200:203], v[80:83]
v_mfma_f32_16x16x32_bf16 v[96:99], a[224:227], a[208:211], v[96:99]
ds_read_b64_tr_b16 a[104:105], v18 offset:57344
v_mfma_f32_16x16x32_bf16 v[96:99], a[228:231], a[212:215], v[96:99]
v_mfma_f32_16x16x32_bf16 v[96:99], a[232:235], a[16:19], v[96:99]
buffer_load_dword v61, v63, s[48:51], s90 offen
v_mfma_f32_16x16x32_bf16 v[96:99], a[236:239], a[20:23], v[96:99]
s_add_u32 s90, s90, s91
ds_read_b64_tr_b16 a[106:107], v18 offset:59392
v_mfma_f32_16x16x32_bf16 v[112:115], a[236:239], a[28:31], v[112:115]
ds_read_b64_tr_b16 a[108:109], v18 offset:61440
v_mfma_f32_16x16x32_bf16 v[112:115], a[232:235], a[24:27], v[112:115]
v_mfma_f32_16x16x32_bf16 v[112:115], a[228:231], a[220:223], v[112:115]
ds_read_b64_tr_b16 a[110:111], v18 offset:63488
v_mfma_f32_16x16x32_bf16 v[112:115], a[224:227], a[216:219], v[112:115]
s_waitcnt lgkmcnt(8)
v_mfma_f32_16x16x32_bf16 v[116:119], a[240:243], a[216:219], v[116:119]
ds_read_b64_tr_b16 a[224:225], v19 offset:49152
v_mfma_f32_16x16x32_bf16 v[116:119], a[244:247], a[220:223], v[116:119]
v_mfma_f32_16x16x32_bf16 v[116:119], a[248:251], a[24:27], v[116:119]
ds_read_b64_tr_b16 a[226:227], v19 offset:51200
v_mfma_f32_16x16x32_bf16 v[116:119], a[252:255], a[28:31], v[116:119]
v_mfma_f32_16x16x32_bf16 v[100:103], a[252:255], a[20:23], v[100:103]
ds_read_b64_tr_b16 a[228:229], v19 offset:53248
v_mfma_f32_16x16x32_bf16 v[100:103], a[248:251], a[16:19], v[100:103]
buffer_load_dwordx4 a[132:135], v1, s[24:27], s54 offen offset:1024 sc1
v_mfma_f32_16x16x32_bf16 v[100:103], a[244:247], a[212:215], v[100:103]
ds_read_b64_tr_b16 a[230:231], v19 offset:55296
v_mfma_f32_16x16x32_bf16 v[100:103], a[240:243], a[208:211], v[100:103]
v_mfma_f32_16x16x32_bf16 v[84:87], a[240:243], a[200:203], v[84:87]
ds_read_b64_tr_b16 a[232:233], v19 offset:57344
v_mfma_f32_16x16x32_bf16 v[84:87], a[244:247], a[204:207], v[84:87]
v_mfma_f32_16x16x32_bf16 v[84:87], a[248:251], a[8:11], v[84:87]
buffer_load_dwordx4 a[136:139], v1, s[24:27], s54 offen offset:2048 sc1
v_mfma_f32_16x16x32_bf16 v[84:87], a[252:255], a[12:15], v[84:87]
ds_read_b64_tr_b16 a[234:235], v19 offset:59392
v_mfma_f32_16x16x32_bf16 v[68:71], a[252:255], a[4:7], v[68:71]
ds_read_b64_tr_b16 a[236:237], v19 offset:61440
v_mfma_f32_16x16x32_bf16 v[68:71], a[248:251], a[0:3], v[68:71]
v_mfma_f32_16x16x32_bf16 v[68:71], a[244:247], a[196:199], v[68:71]
ds_read_b64_tr_b16 a[238:239], v19 offset:63488
v_mfma_f32_16x16x32_bf16 v[68:71], a[240:243], a[192:195], v[68:71]
s_waitcnt lgkmcnt(8)
v_mfma_f32_16x16x32_bf16 v[128:131], a[96:99], a[192:195], v[128:131]
buffer_load_dwordx4 a[140:143], v1, s[24:27], s54 offen offset:3072 sc1
v_mfma_f32_16x16x32_bf16 v[128:131], a[100:103], a[196:199], v[128:131]
ds_read_b64_tr_b16 a[240:241], v20 offset:0
v_mfma_f32_16x16x32_bf16 v[128:131], a[104:107], a[0:3], v[128:131]
ds_read_b64_tr_b16 a[242:243], v20 offset:2048
v_mfma_f32_16x16x32_bf16 v[128:131], a[108:111], a[4:7], v[128:131]
v_mfma_f32_16x16x32_bf16 v[144:147], a[108:111], a[12:15], v[144:147]
ds_read_b64_tr_b16 a[244:245], v20 offset:4096
v_mfma_f32_16x16x32_bf16 v[144:147], a[104:107], a[8:11], v[144:147]
buffer_load_dwordx4 a[144:147], v2, s[24:27], s54 offen offset:0 sc1
v_mfma_f32_16x16x32_bf16 v[144:147], a[100:103], a[204:207], v[144:147]
ds_read_b64_tr_b16 a[246:247], v20 offset:6144
v_mfma_f32_16x16x32_bf16 v[144:147], a[96:99], a[200:203], v[144:147]
v_mfma_f32_16x16x32_bf16 v[160:163], a[96:99], a[208:211], v[160:163]
ds_read_b64_tr_b16 a[248:249], v20 offset:8192
v_mfma_f32_16x16x32_bf16 v[160:163], a[100:103], a[212:215], v[160:163]
v_mfma_f32_16x16x32_bf16 v[160:163], a[104:107], a[16:19], v[160:163]
ds_read_b64_tr_b16 a[250:251], v20 offset:10240
v_mfma_f32_16x16x32_bf16 v[160:163], a[108:111], a[20:23], v[160:163]
buffer_load_dwordx4 a[148:151], v2, s[24:27], s54 offen offset:1024 sc1
v_mfma_f32_16x16x32_bf16 v[176:179], a[108:111], a[28:31], v[176:179]
ds_read_b64_tr_b16 a[252:253], v20 offset:12288
v_mfma_f32_16x16x32_bf16 v[176:179], a[104:107], a[24:27], v[176:179]
v_mfma_f32_16x16x32_bf16 v[176:179], a[100:103], a[220:223], v[176:179]
ds_read_b64_tr_b16 a[254:255], v20 offset:14336
v_mfma_f32_16x16x32_bf16 v[176:179], a[96:99], a[216:219], v[176:179]
s_waitcnt lgkmcnt(8)
v_mfma_f32_16x16x32_bf16 v[180:183], a[224:227], a[216:219], v[180:183]
buffer_load_dwordx4 a[152:155], v2, s[24:27], s54 offen offset:2048 sc1
v_mfma_f32_16x16x32_bf16 v[180:183], a[228:231], a[220:223], v[180:183]
ds_read_b64_tr_b16 a[96:97], v21 offset:0
v_mfma_f32_16x16x32_bf16 v[180:183], a[232:235], a[24:27], v[180:183]
ds_read_b64_tr_b16 a[98:99], v21 offset:2048
v_mfma_f32_16x16x32_bf16 v[180:183], a[236:239], a[28:31], v[180:183]
v_mfma_f32_16x16x32_bf16 v[164:167], a[236:239], a[20:23], v[164:167]
ds_read_b64_tr_b16 a[100:101], v21 offset:4096
v_mfma_f32_16x16x32_bf16 v[164:167], a[232:235], a[16:19], v[164:167]
v_mfma_f32_16x16x32_bf16 v[164:167], a[228:231], a[212:215], v[164:167]
buffer_load_dwordx4 a[156:159], v2, s[24:27], s54 offen offset:3072 sc1
v_mfma_f32_16x16x32_bf16 v[164:167], a[224:227], a[208:211], v[164:167]
s_add_u32 s54, s53, 40960
ds_read_b64_tr_b16 a[102:103], v21 offset:6144
v_mfma_f32_16x16x32_bf16 v[148:151], a[224:227], a[200:203], v[148:151]
ds_read_b64_tr_b16 a[104:105], v21 offset:8192
v_mfma_f32_16x16x32_bf16 v[148:151], a[228:231], a[204:207], v[148:151]
v_mfma_f32_16x16x32_bf16 v[148:151], a[232:235], a[8:11], v[148:151]
ds_read_b64_tr_b16 a[106:107], v21 offset:10240
v_mfma_f32_16x16x32_bf16 v[148:151], a[236:239], a[12:15], v[148:151]
buffer_load_dwordx4 a[160:163], v1, s[24:27], s54 offen offset:0 sc1
v_mfma_f32_16x16x32_bf16 v[132:135], a[236:239], a[4:7], v[132:135]
ds_read_b64_tr_b16 a[108:109], v21 offset:12288
v_mfma_f32_16x16x32_bf16 v[132:135], a[232:235], a[0:3], v[132:135]
v_mfma_f32_16x16x32_bf16 v[132:135], a[228:231], a[196:199], v[132:135]
ds_read_b64_tr_b16 a[110:111], v21 offset:14336
v_mfma_f32_16x16x32_bf16 v[132:135], a[224:227], a[192:195], v[132:135]
s_waitcnt lgkmcnt(8)
v_mfma_f32_16x16x32_bf16 v[72:75], a[240:243], a[192:195], v[72:75]
ds_read_b64_tr_b16 a[224:225], v22 offset:0
v_mfma_f32_16x16x32_bf16 v[72:75], a[244:247], a[196:199], v[72:75]
buffer_load_dwordx4 a[164:167], v1, s[24:27], s54 offen offset:1024 sc1
v_mfma_f32_16x16x32_bf16 v[72:75], a[248:251], a[0:3], v[72:75]
ds_read_b64_tr_b16 a[226:227], v22 offset:2048
v_mfma_f32_16x16x32_bf16 v[72:75], a[252:255], a[4:7], v[72:75]
v_mfma_f32_16x16x32_bf16 v[88:91], a[252:255], a[12:15], v[88:91]
ds_read_b64_tr_b16 a[228:229], v22 offset:4096
v_mfma_f32_16x16x32_bf16 v[88:91], a[248:251], a[8:11], v[88:91]
v_mfma_f32_16x16x32_bf16 v[88:91], a[244:247], a[204:207], v[88:91]
buffer_load_dwordx4 a[168:171], v1, s[24:27], s54 offen offset:2048 sc1
v_mfma_f32_16x16x32_bf16 v[88:91], a[240:243], a[200:203], v[88:91]
ds_read_b64_tr_b16 a[230:231], v22 offset:6144
v_mfma_f32_16x16x32_bf16 v[104:107], a[240:243], a[208:211], v[104:107]
ds_read_b64_tr_b16 a[232:233], v22 offset:8192
v_mfma_f32_16x16x32_bf16 v[104:107], a[244:247], a[212:215], v[104:107]
v_mfma_f32_16x16x32_bf16 v[104:107], a[248:251], a[16:19], v[104:107]
ds_read_b64_tr_b16 a[234:235], v22 offset:10240
v_mfma_f32_16x16x32_bf16 v[104:107], a[252:255], a[20:23], v[104:107]
v_mfma_f32_16x16x32_bf16 v[120:123], a[252:255], a[28:31], v[120:123]
buffer_load_dwordx4 a[172:175], v1, s[24:27], s54 offen offset:3072 sc1
v_mfma_f32_16x16x32_bf16 v[120:123], a[248:251], a[24:27], v[120:123]
ds_read_b64_tr_b16 a[236:237], v22 offset:12288
v_mfma_f32_16x16x32_bf16 v[120:123], a[244:247], a[220:223], v[120:123]
ds_read_b64_tr_b16 a[238:239], v22 offset:14336
v_mfma_f32_16x16x32_bf16 v[120:123], a[240:243], a[216:219], v[120:123]
s_waitcnt lgkmcnt(8)
v_mfma_f32_16x16x32_bf16 v[124:127], a[96:99], a[216:219], v[124:127]
ds_read_b64_tr_b16 a[240:241], v23 offset:0
v_mfma_f32_16x16x32_bf16 v[124:127], a[100:103], a[220:223], v[124:127]
buffer_load_dwordx4 a[176:179], v2, s[24:27], s54 offen offset:0 sc1
v_mfma_f32_16x16x32_bf16 v[124:127], a[104:107], a[24:27], v[124:127]
ds_read_b64_tr_b16 a[242:243], v23 offset:2048
v_mfma_f32_16x16x32_bf16 v[124:127], a[108:111], a[28:31], v[124:127]
v_mfma_f32_16x16x32_bf16 v[108:111], a[108:111], a[20:23], v[108:111]
ds_read_b64_tr_b16 a[244:245], v23 offset:4096
v_mfma_f32_16x16x32_bf16 v[108:111], a[104:107], a[16:19], v[108:111]
v_mfma_f32_16x16x32_bf16 v[108:111], a[100:103], a[212:215], v[108:111]
ds_read_b64_tr_b16 a[246:247], v23 offset:6144
v_mfma_f32_16x16x32_bf16 v[108:111], a[96:99], a[208:211], v[108:111]
buffer_load_dwordx4 a[180:183], v2, s[24:27], s54 offen offset:1024 sc1
v_mfma_f32_16x16x32_bf16 v[92:95], a[96:99], a[200:203], v[92:95]
ds_read_b64_tr_b16 a[248:249], v23 offset:8192
v_mfma_f32_16x16x32_bf16 v[92:95], a[100:103], a[204:207], v[92:95]
v_mfma_f32_16x16x32_bf16 v[92:95], a[104:107], a[8:11], v[92:95]
ds_read_b64_tr_b16 a[250:251], v23 offset:10240
v_mfma_f32_16x16x32_bf16 v[92:95], a[108:111], a[12:15], v[92:95]
v_mfma_f32_16x16x32_bf16 v[76:79], a[108:111], a[4:7], v[76:79]
buffer_load_dwordx4 a[184:187], v2, s[24:27], s54 offen offset:2048 sc1
v_mfma_f32_16x16x32_bf16 v[76:79], a[104:107], a[0:3], v[76:79]
ds_read_b64_tr_b16 a[252:253], v23 offset:12288
v_mfma_f32_16x16x32_bf16 v[76:79], a[100:103], a[196:199], v[76:79]
ds_read_b64_tr_b16 a[254:255], v23 offset:14336
v_mfma_f32_16x16x32_bf16 v[76:79], a[96:99], a[192:195], v[76:79]
s_waitcnt lgkmcnt(8)
v_mfma_f32_16x16x32_bf16 v[136:139], a[224:227], a[192:195], v[136:139]
ds_read_b64_tr_b16 a[96:97], v6 offset:16384
v_mfma_f32_16x16x32_bf16 v[136:139], a[228:231], a[196:199], v[136:139]
v_mfma_f32_16x16x32_bf16 v[136:139], a[232:235], a[0:3], v[136:139]
buffer_load_dwordx4 a[188:191], v2, s[24:27], s54 offen offset:3072 sc1
v_mfma_f32_16x16x32_bf16 v[136:139], a[236:239], a[4:7], v[136:139]
s_mov_b32 s55, 2752512
ds_read_b64_tr_b16 a[98:99], v6 offset:18432
s_add_u32 m0, s52, 147456
v_mfma_f32_16x16x32_bf16 v[152:155], a[236:239], a[12:15], v[152:155]
ds_read_b64_tr_b16 a[100:101], v6 offset:20480
v_mfma_f32_16x16x32_bf16 v[152:155], a[232:235], a[8:11], v[152:155]
v_mfma_f32_16x16x32_bf16 v[152:155], a[228:231], a[204:207], v[152:155]
ds_read_b64_tr_b16 a[102:103], v6 offset:22528
v_mfma_f32_16x16x32_bf16 v[152:155], a[224:227], a[200:203], v[152:155]
buffer_load_dword v61, v63, s[48:51], s90 offen
v_mfma_f32_16x16x32_bf16 v[168:171], a[224:227], a[208:211], v[168:171]
s_add_u32 s90, s90, s91
ds_read_b64_tr_b16 a[104:105], v6 offset:24576
v_mfma_f32_16x16x32_bf16 v[168:171], a[228:231], a[212:215], v[168:171]
v_mfma_f32_16x16x32_bf16 v[168:171], a[232:235], a[16:19], v[168:171]
ds_read_b64_tr_b16 a[106:107], v6 offset:26624
v_mfma_f32_16x16x32_bf16 v[168:171], a[236:239], a[20:23], v[168:171]
v_mfma_f32_16x16x32_bf16 v[184:187], a[236:239], a[28:31], v[184:187]
ds_read_b64_tr_b16 a[108:109], v6 offset:28672
v_mfma_f32_16x16x32_bf16 v[184:187], a[232:235], a[24:27], v[184:187]
v_mfma_f32_16x16x32_bf16 v[184:187], a[228:231], a[220:223], v[184:187]
ds_read_b64_tr_b16 a[110:111], v6 offset:30720
v_mfma_f32_16x16x32_bf16 v[184:187], a[224:227], a[216:219], v[184:187]
s_waitcnt lgkmcnt(8)
v_mfma_f32_16x16x32_bf16 v[188:191], a[240:243], a[216:219], v[188:191]
ds_read_b64_tr_b16 a[224:225], v7 offset:16384
v_mfma_f32_16x16x32_bf16 v[188:191], a[244:247], a[220:223], v[188:191]
v_mfma_f32_16x16x32_bf16 v[188:191], a[248:251], a[24:27], v[188:191]
buffer_load_dwordx4 v40, s[16:19], s55 offen offset:0 lds
v_mfma_f32_16x16x32_bf16 v[188:191], a[252:255], a[28:31], v[188:191]
ds_read_b64_tr_b16 a[226:227], v7 offset:18432
v_mfma_f32_16x16x32_bf16 v[172:175], a[252:255], a[20:23], v[172:175]
ds_read_b64_tr_b16 a[228:229], v7 offset:20480
v_mfma_f32_16x16x32_bf16 v[172:175], a[248:251], a[16:19], v[172:175]
v_mfma_f32_16x16x32_bf16 v[172:175], a[244:247], a[212:215], v[172:175]
ds_read_b64_tr_b16 a[230:231], v7 offset:22528
v_mfma_f32_16x16x32_bf16 v[172:175], a[240:243], a[208:211], v[172:175]
v_mfma_f32_16x16x32_bf16 v[156:159], a[240:243], a[200:203], v[156:159]
buffer_load_dwordx4 v41, s[16:19], s55 offen offset:1024 lds
v_mfma_f32_16x16x32_bf16 v[156:159], a[244:247], a[204:207], v[156:159]
s_mov_b32 s55, 3211264
ds_read_b64_tr_b16 a[232:233], v7 offset:24576
s_add_u32 m0, s52, 0
v_mfma_f32_16x16x32_bf16 v[156:159], a[248:251], a[8:11], v[156:159]
ds_read_b64_tr_b16 a[234:235], v7 offset:26624
v_mfma_f32_16x16x32_bf16 v[156:159], a[252:255], a[12:15], v[156:159]
v_mfma_f32_16x16x32_bf16 v[140:143], a[252:255], a[4:7], v[140:143]
ds_read_b64_tr_b16 a[236:237], v7 offset:28672
v_mfma_f32_16x16x32_bf16 v[140:143], a[248:251], a[0:3], v[140:143]
buffer_load_dwordx4 v40, s[16:19], s55 offen offset:0 lds
v_mfma_f32_16x16x32_bf16 v[140:143], a[244:247], a[196:199], v[140:143]
ds_read_b64_tr_b16 a[238:239], v7 offset:30720
v_mfma_f32_16x16x32_bf16 v[140:143], a[240:243], a[192:195], v[140:143]
s_waitcnt lgkmcnt(8)
v_mfma_f32_16x16x32_bf16 v[192:195], a[96:99], a[192:195], v[192:195]
ds_read_b64_tr_b16 a[240:241], v6 offset:17408
v_mfma_f32_16x16x32_bf16 v[192:195], a[100:103], a[196:199], v[192:195]
v_mfma_f32_16x16x32_bf16 v[192:195], a[104:107], a[0:3], v[192:195]
ds_read_b64_tr_b16 a[242:243], v6 offset:19456
v_mfma_f32_16x16x32_bf16 v[192:195], a[108:111], a[4:7], v[192:195]
buffer_load_dwordx4 v41, s[16:19], s55 offen offset:1024 lds
v_mfma_f32_16x16x32_bf16 v[200:203], a[108:111], a[12:15], v[200:203]
s_mov_b32 s55, 2752512
ds_read_b64_tr_b16 a[244:245], v6 offset:21504
s_add_u32 m0, s52, 8192
v_mfma_f32_16x16x32_bf16 v[200:203], a[104:107], a[8:11], v[200:203]
v_mfma_f32_16x16x32_bf16 v[200:203], a[100:103], a[204:207], v[200:203]
ds_read_b64_tr_b16 a[246:247], v6 offset:23552
v_mfma_f32_16x16x32_bf16 v[200:203], a[96:99], a[200:203], v[200:203]
v_mfma_f32_16x16x32_bf16 v[208:211], a[96:99], a[208:211], v[208:211]
buffer_load_dwordx4 v40, s[20:23], s55 offen offset:0 lds
v_mfma_f32_16x16x32_bf16 v[208:211], a[100:103], a[212:215], v[208:211]
ds_read_b64_tr_b16 a[248:249], v6 offset:25600
v_mfma_f32_16x16x32_bf16 v[208:211], a[104:107], a[16:19], v[208:211]
ds_read_b64_tr_b16 a[250:251], v6 offset:27648
v_mfma_f32_16x16x32_bf16 v[208:211], a[108:111], a[20:23], v[208:211]
v_mfma_f32_16x16x32_bf16 v[216:219], a[108:111], a[28:31], v[216:219]
ds_read_b64_tr_b16 a[252:253], v6 offset:29696
v_mfma_f32_16x16x32_bf16 v[216:219], a[104:107], a[24:27], v[216:219]
v_mfma_f32_16x16x32_bf16 v[216:219], a[100:103], a[220:223], v[216:219]
buffer_load_dwordx4 v41, s[20:23], s55 offen offset:1024 lds
v_mfma_f32_16x16x32_bf16 v[216:219], a[96:99], a[216:219], v[216:219]
s_waitcnt lgkmcnt(7)
ds_read_b64_tr_b16 a[254:255], v6 offset:31744
s_mov_b32 s55, 3211264
v_mfma_f32_16x16x32_bf16 v[220:223], a[224:227], a[216:219], v[220:223]
s_add_u32 m0, s52, 16384
ds_read_b64_tr_b16 a[96:97], v7 offset:17408
v_mfma_f32_16x16x32_bf16 v[220:223], a[228:231], a[220:223], v[220:223]
v_mfma_f32_16x16x32_bf16 v[220:223], a[232:235], a[24:27], v[220:223]
ds_read_b64_tr_b16 a[98:99], v7 offset:19456
v_mfma_f32_16x16x32_bf16 v[220:223], a[236:239], a[28:31], v[220:223]
buffer_load_dwordx4 v40, s[20:23], s55 offen offset:0 lds
v_mfma_f32_16x16x32_bf16 v[212:215], a[236:239], a[20:23], v[212:215]
ds_read_b64_tr_b16 a[100:101], v7 offset:21504
v_mfma_f32_16x16x32_bf16 v[212:215], a[232:235], a[16:19], v[212:215]
s_load_dword s101, s[92:93], 8184
v_mfma_f32_16x16x32_bf16 v[212:215], a[228:231], a[212:215], v[212:215]
ds_read_b64_tr_b16 a[102:103], v7 offset:23552
v_mfma_f32_16x16x32_bf16 v[212:215], a[224:227], a[208:211], v[212:215]
v_mfma_f32_16x16x32_bf16 v[204:207], a[224:227], a[200:203], v[204:207]
ds_read_b64_tr_b16 a[104:105], v7 offset:25600
v_mfma_f32_16x16x32_bf16 v[204:207], a[228:231], a[204:207], v[204:207]
buffer_load_dwordx4 v41, s[20:23], s55 offen offset:1024 lds
v_mfma_f32_16x16x32_bf16 v[204:207], a[232:235], a[8:11], v[204:207]
s_mov_b32 s56, 2359296
ds_read_b64_tr_b16 a[106:107], v7 offset:27648
s_add_u32 m0, s52, 24576
v_mfma_f32_16x16x32_bf16 v[204:207], a[236:239], a[12:15], v[204:207]
v_mfma_f32_16x16x32_bf16 v[196:199], a[236:239], a[4:7], v[196:199]
ds_read_b64_tr_b16 a[108:109], v7 offset:29696
v_mfma_f32_16x16x32_bf16 v[196:199], a[232:235], a[0:3], v[196:199]
v_mfma_f32_16x16x32_bf16 v[196:199], a[228:231], a[196:199], v[196:199]
buffer_load_dwordx4 v42, s[12:15], s56 offen offset:0 lds
v_mfma_f32_16x16x32_bf16 v[196:199], a[224:227], a[192:195], v[196:199]
s_waitcnt vmcnt(27) lgkmcnt(7)
s_barrier
v_mfma_f32_16x16x32_bf16 v[224:227], a[192:195], a[240:243], v[224:227]
ds_read_b64_tr_b16 a[110:111], v7 offset:31744
ds_read_b64_tr_b16 a[224:225], v20 offset:32768
v_mfma_f32_16x16x32_bf16 v[224:227], a[196:199], a[244:247], v[224:227]
v_mfma_f32_16x16x32_bf16 v[224:227], a[0:3], a[248:251], v[224:227]
ds_read_b64_tr_b16 a[226:227], v20 offset:34816
v_mfma_f32_16x16x32_bf16 v[224:227], a[4:7], a[252:255], v[224:227]
v_mfma_f32_16x16x32_bf16 v[228:231], a[12:15], a[252:255], v[228:231]
ds_read_b64_tr_b16 a[228:229], v20 offset:36864
v_mfma_f32_16x16x32_bf16 v[228:231], a[8:11], a[248:251], v[228:231]
v_mfma_f32_16x16x32_bf16 v[228:231], a[204:207], a[244:247], v[228:231]
ds_read_b64_tr_b16 a[230:231], v20 offset:38912
v_mfma_f32_16x16x32_bf16 v[228:231], a[200:203], a[240:243], v[228:231]
v_mfma_f32_16x16x32_bf16 v[232:235], a[208:211], a[240:243], v[232:235]
buffer_load_dwordx4 v43, s[12:15], s56 offen offset:1024 lds
v_mfma_f32_16x16x32_bf16 v[232:235], a[212:215], a[244:247], v[232:235]
s_mov_b32 s56, 2752512
ds_read_b64_tr_b16 a[232:233], v20 offset:40960
s_add_u32 m0, s52, 32768
v_mfma_f32_16x16x32_bf16 v[232:235], a[16:19], a[248:251], v[232:235]
ds_read_b64_tr_b16 a[234:235], v20 offset:43008
v_mfma_f32_16x16x32_bf16 v[232:235], a[20:23], a[252:255], v[232:235]
v_mfma_f32_16x16x32_bf16 v[236:239], a[28:31], a[252:255], v[236:239]
ds_read_b64_tr_b16 a[236:237], v20 offset:45056
v_mfma_f32_16x16x32_bf16 v[236:239], a[24:27], a[248:251], v[236:239]
v_mfma_f32_16x16x32_bf16 v[236:239], a[220:223], a[244:247], v[236:239]
ds_read_b64_tr_b16 a[238:239], v20 offset:47104
v_mfma_f32_16x16x32_bf16 v[236:239], a[216:219], a[240:243], v[236:239]
s_waitcnt lgkmcnt(8)
v_mfma_f32_16x16x32_bf16 v[252:255], a[216:219], a[96:99], v[252:255]
ds_read_b64_tr_b16 a[240:241], v21 offset:32768
v_mfma_f32_16x16x32_bf16 v[252:255], a[220:223], a[100:103], v[252:255]
v_mfma_f32_16x16x32_bf16 v[252:255], a[24:27], a[104:107], v[252:255]
ds_read_b64_tr_b16 a[242:243], v21 offset:34816
v_mfma_f32_16x16x32_bf16 v[252:255], a[28:31], a[108:111], v[252:255]
buffer_load_dwordx4 v42, s[12:15], s56 offen offset:0 lds
v_mfma_f32_16x16x32_bf16 v[248:251], a[20:23], a[108:111], v[248:251]
ds_read_b64_tr_b16 a[244:245], v21 offset:36864
v_mfma_f32_16x16x32_bf16 v[248:251], a[16:19], a[104:107], v[248:251]
v_mfma_f32_16x16x32_bf16 v[248:251], a[212:215], a[100:103], v[248:251]
ds_read_b64_tr_b16 a[246:247], v21 offset:38912
v_mfma_f32_16x16x32_bf16 v[248:251], a[208:211], a[96:99], v[248:251]
v_mfma_f32_16x16x32_bf16 v[244:247], a[200:203], a[96:99], v[244:247]
ds_read_b64_tr_b16 a[248:249], v21 offset:40960
v_mfma_f32_16x16x32_bf16 v[244:247], a[204:207], a[100:103], v[244:247]
v_mfma_f32_16x16x32_bf16 v[244:247], a[8:11], a[104:107], v[244:247]
ds_read_b64_tr_b16 a[250:251], v21 offset:43008
v_mfma_f32_16x16x32_bf16 v[244:247], a[12:15], a[108:111], v[244:247]
v_mfma_f32_16x16x32_bf16 v[240:243], a[4:7], a[108:111], v[240:243]
ds_read_b64_tr_b16 a[252:253], v21 offset:45056
v_mfma_f32_16x16x32_bf16 v[240:243], a[0:3], a[104:107], v[240:243]
v_mfma_f32_16x16x32_bf16 v[240:243], a[196:199], a[100:103], v[240:243]
buffer_load_dwordx4 v43, s[12:15], s56 offen offset:1024 lds
v_mfma_f32_16x16x32_bf16 v[240:243], a[192:195], a[96:99], v[240:243]
s_waitcnt vmcnt(13) lgkmcnt(7)
ds_read_b64_tr_b16 a[254:255], v21 offset:47104
s_add_u32 s54, s53, 49152
v_mfma_f32_16x16x32_bf16 v[64:67], a[224:227], a[128:131], v[64:67]
ds_read_b64_tr_b16 a[96:97], v22 offset:32768
v_mfma_f32_16x16x32_bf16 v[64:67], a[228:231], a[132:135], v[64:67]
v_mfma_f32_16x16x32_bf16 v[64:67], a[232:235], a[160:163], v[64:67]
ds_read_b64_tr_b16 a[98:99], v22 offset:34816
v_mfma_f32_16x16x32_bf16 v[64:67], a[236:239], a[164:167], v[64:67]
v_mfma_f32_16x16x32_bf16 v[80:83], a[236:239], a[172:175], v[80:83]
ds_read_b64_tr_b16 a[100:101], v22 offset:36864
v_mfma_f32_16x16x32_bf16 v[80:83], a[232:235], a[168:171], v[80:83]
v_mfma_f32_16x16x32_bf16 v[80:83], a[228:231], a[140:143], v[80:83]
ds_read_b64_tr_b16 a[102:103], v22 offset:38912
v_mfma_f32_16x16x32_bf16 v[80:83], a[224:227], a[136:139], v[80:83]
v_mfma_f32_16x16x32_bf16 v[96:99], a[224:227], a[144:147], v[96:99]
ds_read_b64_tr_b16 a[104:105], v22 offset:40960
v_mfma_f32_16x16x32_bf16 v[96:99], a[228:231], a[148:151], v[96:99]
buffer_load_dword v61, v63, s[48:51], s90 offen
v_mfma_f32_16x16x32_bf16 v[96:99], a[232:235], a[176:179], v[96:99]
s_add_u32 s90, s90, s91
ds_read_b64_tr_b16 a[106:107], v22 offset:43008
v_mfma_f32_16x16x32_bf16 v[96:99], a[236:239], a[180:183], v[96:99]
v_mfma_f32_16x16x32_bf16 v[112:115], a[236:239], a[188:191], v[112:115]
ds_read_b64_tr_b16 a[108:109], v22 offset:45056
v_mfma_f32_16x16x32_bf16 v[112:115], a[232:235], a[184:187], v[112:115]
v_mfma_f32_16x16x32_bf16 v[112:115], a[228:231], a[156:159], v[112:115]
ds_read_b64_tr_b16 a[110:111], v22 offset:47104
v_mfma_f32_16x16x32_bf16 v[112:115], a[224:227], a[152:155], v[112:115]
s_waitcnt lgkmcnt(8)
v_mfma_f32_16x16x32_bf16 v[116:119], a[240:243], a[152:155], v[116:119]
ds_read_b64_tr_b16 a[224:225], v23 offset:32768
v_mfma_f32_16x16x32_bf16 v[116:119], a[244:247], a[156:159], v[116:119]
v_mfma_f32_16x16x32_bf16 v[116:119], a[248:251], a[184:187], v[116:119]
ds_read_b64_tr_b16 a[226:227], v23 offset:34816
v_mfma_f32_16x16x32_bf16 v[116:119], a[252:255], a[188:191], v[116:119]
v_mfma_f32_16x16x32_bf16 v[100:103], a[252:255], a[180:183], v[100:103]
buffer_load_dwordx4 a[32:35], v1, s[24:27], s54 offen offset:0 sc1
v_mfma_f32_16x16x32_bf16 v[100:103], a[248:251], a[176:179], v[100:103]
ds_read_b64_tr_b16 a[228:229], v23 offset:36864
v_mfma_f32_16x16x32_bf16 v[100:103], a[244:247], a[148:151], v[100:103]
ds_read_b64_tr_b16 a[230:231], v23 offset:38912
v_mfma_f32_16x16x32_bf16 v[100:103], a[240:243], a[144:147], v[100:103]
v_mfma_f32_16x16x32_bf16 v[84:87], a[240:243], a[136:139], v[84:87]
ds_read_b64_tr_b16 a[232:233], v23 offset:40960
v_mfma_f32_16x16x32_bf16 v[84:87], a[244:247], a[140:143], v[84:87]
v_mfma_f32_16x16x32_bf16 v[84:87], a[248:251], a[168:171], v[84:87]
buffer_load_dwordx4 a[36:39], v1, s[24:27], s54 offen offset:1024 sc1
v_mfma_f32_16x16x32_bf16 v[84:87], a[252:255], a[172:175], v[84:87]
ds_read_b64_tr_b16 a[234:235], v23 offset:43008
v_mfma_f32_16x16x32_bf16 v[68:71], a[252:255], a[164:167], v[68:71]
ds_read_b64_tr_b16 a[236:237], v23 offset:45056
v_mfma_f32_16x16x32_bf16 v[68:71], a[248:251], a[160:163], v[68:71]
v_mfma_f32_16x16x32_bf16 v[68:71], a[244:247], a[132:135], v[68:71]
ds_read_b64_tr_b16 a[238:239], v23 offset:47104
v_mfma_f32_16x16x32_bf16 v[68:71], a[240:243], a[128:131], v[68:71]
s_waitcnt lgkmcnt(8)
buffer_load_dwordx4 a[40:43], v1, s[24:27], s54 offen offset:2048 sc1
v_mfma_f32_16x16x32_bf16 v[128:131], a[96:99], a[128:131], v[128:131]
ds_read_b64_tr_b16 a[240:241], v20 offset:49152
v_mfma_f32_16x16x32_bf16 v[128:131], a[100:103], a[132:135], v[128:131]
v_mfma_f32_16x16x32_bf16 v[128:131], a[104:107], a[160:163], v[128:131]
ds_read_b64_tr_b16 a[242:243], v20 offset:51200
v_mfma_f32_16x16x32_bf16 v[128:131], a[108:111], a[164:167], v[128:131]
v_mfma_f32_16x16x32_bf16 v[144:147], a[108:111], a[172:175], v[144:147]
ds_read_b64_tr_b16 a[244:245], v20 offset:53248
v_mfma_f32_16x16x32_bf16 v[144:147], a[104:107], a[168:171], v[144:147]
buffer_load_dwordx4 a[44:47], v1, s[24:27], s54 offen offset:3072 sc1
v_mfma_f32_16x16x32_bf16 v[144:147], a[100:103], a[140:143], v[144:147]
ds_read_b64_tr_b16 a[246:247], v20 offset:55296
v_mfma_f32_16x16x32_bf16 v[144:147], a[96:99], a[136:139], v[144:147]
v_mfma_f32_16x16x32_bf16 v[160:163], a[96:99], a[144:147], v[160:163]
ds_read_b64_tr_b16 a[248:249], v20 offset:57344
v_mfma_f32_16x16x32_bf16 v[160:163], a[100:103], a[148:151], v[160:163]
v_mfma_f32_16x16x32_bf16 v[160:163], a[104:107], a[176:179], v[160:163]
buffer_load_dwordx4 a[48:51], v2, s[24:27], s54 offen offset:0 sc1
v_mfma_f32_16x16x32_bf16 v[160:163], a[108:111], a[180:183], v[160:163]
ds_read_b64_tr_b16 a[250:251], v20 offset:59392
v_mfma_f32_16x16x32_bf16 v[176:179], a[108:111], a[188:191], v[176:179]
ds_read_b64_tr_b16 a[252:253], v20 offset:61440
v_mfma_f32_16x16x32_bf16 v[176:179], a[104:107], a[184:187], v[176:179]
v_mfma_f32_16x16x32_bf16 v[176:179], a[100:103], a[156:159], v[176:179]
ds_read_b64_tr_b16 a[254:255], v20 offset:63488
v_mfma_f32_16x16x32_bf16 v[176:179], a[96:99], a[152:155], v[176:179]
s_waitcnt lgkmcnt(8)
v_mfma_f32_16x16x32_bf16 v[180:183], a[224:227], a[152:155], v[180:183]
buffer_load_dwordx4 a[52:55], v2, s[24:27], s54 offen offset:1024 sc1
v_mfma_f32_16x16x32_bf16 v[180:183], a[228:231], a[156:159], v[180:183]
ds_read_b64_tr_b16 a[96:97], v21 offset:49152
v_mfma_f32_16x16x32_bf16 v[180:183], a[232:235], a[184:187], v[180:183]
ds_read_b64_tr_b16 a[98:99], v21 offset:51200
v_mfma_f32_16x16x32_bf16 v[180:183], a[236:239], a[188:191], v[180:183]
v_mfma_f32_16x16x32_bf16 v[164:167], a[236:239], a[180:183], v[164:167]
ds_read_b64_tr_b16 a[100:101], v21 offset:53248
v_mfma_f32_16x16x32_bf16 v[164:167], a[232:235], a[176:179], v[164:167]
buffer_load_dwordx4 a[56:59], v2, s[24:27], s54 offen offset:2048 sc1
v_mfma_f32_16x16x32_bf16 v[164:167], a[228:231], a[148:151], v[164:167]
ds_read_b64_tr_b16 a[102:103], v21 offset:55296
v_mfma_f32_16x16x32_bf16 v[164:167], a[224:227], a[144:147], v[164:167]
v_mfma_f32_16x16x32_bf16 v[148:151], a[224:227], a[136:139], v[148:151]
ds_read_b64_tr_b16 a[104:105], v21 offset:57344
v_mfma_f32_16x16x32_bf16 v[148:151], a[228:231], a[140:143], v[148:151]
v_mfma_f32_16x16x32_bf16 v[148:151], a[232:235], a[168:171], v[148:151]
ds_read_b64_tr_b16 a[106:107], v21 offset:59392
v_mfma_f32_16x16x32_bf16 v[148:151], a[236:239], a[172:175], v[148:151]
buffer_load_dwordx4 a[60:63], v2, s[24:27], s54 offen offset:3072 sc1
v_mfma_f32_16x16x32_bf16 v[132:135], a[236:239], a[164:167], v[132:135]
s_add_u32 s54, s53, 57344
ds_read_b64_tr_b16 a[108:109], v21 offset:61440
v_mfma_f32_16x16x32_bf16 v[132:135], a[232:235], a[160:163], v[132:135]
v_mfma_f32_16x16x32_bf16 v[132:135], a[228:231], a[132:135], v[132:135]
ds_read_b64_tr_b16 a[110:111], v21 offset:63488
v_mfma_f32_16x16x32_bf16 v[132:135], a[224:227], a[128:131], v[132:135]
s_waitcnt lgkmcnt(8)
v_mfma_f32_16x16x32_bf16 v[72:75], a[240:243], a[128:131], v[72:75]
buffer_load_dwordx4 a[192:195], v1, s[24:27], s54 offen offset:0 sc1
v_mfma_f32_16x16x32_bf16 v[72:75], a[244:247], a[132:135], v[72:75]
ds_read_b64_tr_b16 a[224:225], v22 offset:49152
v_mfma_f32_16x16x32_bf16 v[72:75], a[248:251], a[160:163], v[72:75]
ds_read_b64_tr_b16 a[226:227], v22 offset:51200
v_mfma_f32_16x16x32_bf16 v[72:75], a[252:255], a[164:167], v[72:75]
v_mfma_f32_16x16x32_bf16 v[88:91], a[252:255], a[172:175], v[88:91]
ds_read_b64_tr_b16 a[228:229], v22 offset:53248
v_mfma_f32_16x16x32_bf16 v[88:91], a[248:251], a[168:171], v[88:91]
v_mfma_f32_16x16x32_bf16 v[88:91], a[244:247], a[140:143], v[88:91]
buffer_load_dwordx4 a[196:199], v1, s[24:27], s54 offen offset:1024 sc1
v_mfma_f32_16x16x32_bf16 v[88:91], a[240:243], a[136:139], v[88:91]
ds_read_b64_tr_b16 a[230:231], v22 offset:55296
v_mfma_f32_16x16x32_bf16 v[104:107], a[240:243], a[144:147], v[104:107]
ds_read_b64_tr_b16 a[232:233], v22 offset:57344
v_mfma_f32_16x16x32_bf16 v[104:107], a[244:247], a[148:151], v[104:107]
v_mfma_f32_16x16x32_bf16 v[104:107], a[248:251], a[176:179], v[104:107]
ds_read_b64_tr_b16 a[234:235], v22 offset:59392
v_mfma_f32_16x16x32_bf16 v[104:107], a[252:255], a[180:183], v[104:107]
buffer_load_dwordx4 a[200:203], v1, s[24:27], s54 offen offset:2048 sc1
v_mfma_f32_16x16x32_bf16 v[120:123], a[252:255], a[188:191], v[120:123]
ds_read_b64_tr_b16 a[236:237], v22 offset:61440
v_mfma_f32_16x16x32_bf16 v[120:123], a[248:251], a[184:187], v[120:123]
v_mfma_f32_16x16x32_bf16 v[120:123], a[244:247], a[156:159], v[120:123]
ds_read_b64_tr_b16 a[238:239], v22 offset:63488
v_mfma_f32_16x16x32_bf16 v[120:123], a[240:243], a[152:155], v[120:123]
s_waitcnt lgkmcnt(8)
v_mfma_f32_16x16x32_bf16 v[124:127], a[96:99], a[152:155], v[124:127]
ds_read_b64_tr_b16 a[240:241], v23 offset:49152
v_mfma_f32_16x16x32_bf16 v[124:127], a[100:103], a[156:159], v[124:127]
buffer_load_dwordx4 a[204:207], v1, s[24:27], s54 offen offset:3072 sc1
v_mfma_f32_16x16x32_bf16 v[124:127], a[104:107], a[184:187], v[124:127]
ds_read_b64_tr_b16 a[242:243], v23 offset:51200
v_mfma_f32_16x16x32_bf16 v[124:127], a[108:111], a[188:191], v[124:127]
v_mfma_f32_16x16x32_bf16 v[108:111], a[108:111], a[180:183], v[108:111]
ds_read_b64_tr_b16 a[244:245], v23 offset:53248
v_mfma_f32_16x16x32_bf16 v[108:111], a[104:107], a[176:179], v[108:111]
v_mfma_f32_16x16x32_bf16 v[108:111], a[100:103], a[148:151], v[108:111]
buffer_load_dwordx4 a[208:211], v2, s[24:27], s54 offen offset:0 sc1
v_mfma_f32_16x16x32_bf16 v[108:111], a[96:99], a[144:147], v[108:111]
ds_read_b64_tr_b16 a[246:247], v23 offset:55296
v_mfma_f32_16x16x32_bf16 v[92:95], a[96:99], a[136:139], v[92:95]
ds_read_b64_tr_b16 a[248:249], v23 offset:57344
v_mfma_f32_16x16x32_bf16 v[92:95], a[100:103], a[140:143], v[92:95]
v_mfma_f32_16x16x32_bf16 v[92:95], a[104:107], a[168:171], v[92:95]
ds_read_b64_tr_b16 a[250:251], v23 offset:59392
v_mfma_f32_16x16x32_bf16 v[92:95], a[108:111], a[172:175], v[92:95]
v_mfma_f32_16x16x32_bf16 v[76:79], a[108:111], a[164:167], v[76:79]
buffer_load_dwordx4 a[212:215], v2, s[24:27], s54 offen offset:1024 sc1
v_mfma_f32_16x16x32_bf16 v[76:79], a[104:107], a[160:163], v[76:79]
ds_read_b64_tr_b16 a[252:253], v23 offset:61440
v_mfma_f32_16x16x32_bf16 v[76:79], a[100:103], a[132:135], v[76:79]
ds_read_b64_tr_b16 a[254:255], v23 offset:63488
v_mfma_f32_16x16x32_bf16 v[76:79], a[96:99], a[128:131], v[76:79]
s_waitcnt lgkmcnt(8)
v_mfma_f32_16x16x32_bf16 v[136:139], a[224:227], a[128:131], v[136:139]
ds_read_b64_tr_b16 a[96:97], v8 offset:0
v_mfma_f32_16x16x32_bf16 v[136:139], a[228:231], a[132:135], v[136:139]
buffer_load_dwordx4 a[216:219], v2, s[24:27], s54 offen offset:2048 sc1
v_mfma_f32_16x16x32_bf16 v[136:139], a[232:235], a[160:163], v[136:139]
ds_read_b64_tr_b16 a[98:99], v8 offset:2048
v_mfma_f32_16x16x32_bf16 v[136:139], a[236:239], a[164:167], v[136:139]
v_mfma_f32_16x16x32_bf16 v[152:155], a[236:239], a[172:175], v[152:155]
ds_read_b64_tr_b16 a[100:101], v8 offset:4096
v_mfma_f32_16x16x32_bf16 v[152:155], a[232:235], a[168:171], v[152:155]
pg_1:
s_cbranch_execz pg_5
v_mfma_f32_16x16x32_bf16 v[152:155], a[228:231], a[140:143], v[152:155]
ds_read_b64_tr_b16 a[102:103], v8 offset:6144
v_mfma_f32_16x16x32_bf16 v[152:155], a[224:227], a[136:139], v[152:155]
buffer_load_dword v61, v63, s[48:51], s90 offen
v_mfma_f32_16x16x32_bf16 v[168:171], a[224:227], a[144:147], v[168:171]
s_add_u32 s90, s90, s91
ds_read_b64_tr_b16 a[104:105], v8 offset:8192
v_mfma_f32_16x16x32_bf16 v[168:171], a[228:231], a[148:151], v[168:171]
v_mfma_f32_16x16x32_bf16 v[168:171], a[232:235], a[176:179], v[168:171]
ds_read_b64_tr_b16 a[106:107], v8 offset:10240
v_mfma_f32_16x16x32_bf16 v[168:171], a[236:239], a[180:183], v[168:171]
v_mfma_f32_16x16x32_bf16 v[184:187], a[236:239], a[188:191], v[184:187]
ds_read_b64_tr_b16 a[108:109], v8 offset:12288
v_mfma_f32_16x16x32_bf16 v[184:187], a[232:235], a[184:187], v[184:187]
v_mfma_f32_16x16x32_bf16 v[184:187], a[228:231], a[156:159], v[184:187]
ds_read_b64_tr_b16 a[110:111], v8 offset:14336
v_mfma_f32_16x16x32_bf16 v[184:187], a[224:227], a[152:155], v[184:187]
s_waitcnt lgkmcnt(8)
v_mfma_f32_16x16x32_bf16 v[188:191], a[240:243], a[152:155], v[188:191]
ds_read_b64_tr_b16 a[224:225], v9 offset:0
v_mfma_f32_16x16x32_bf16 v[188:191], a[244:247], a[156:159], v[188:191]
v_mfma_f32_16x16x32_bf16 v[188:191], a[248:251], a[184:187], v[188:191]
buffer_load_dwordx4 a[220:223], v2, s[24:27], s54 offen offset:3072 sc1
v_mfma_f32_16x16x32_bf16 v[188:191], a[252:255], a[188:191], v[188:191]
s_mov_b32 s55, 3670016
ds_read_b64_tr_b16 a[226:227], v9 offset:2048
s_add_u32 m0, s52, 40960
v_mfma_f32_16x16x32_bf16 v[172:175], a[252:255], a[180:183], v[172:175]
ds_read_b64_tr_b16 a[228:229], v9 offset:4096
v_mfma_f32_16x16x32_bf16 v[172:175], a[248:251], a[176:179], v[172:175]
v_mfma_f32_16x16x32_bf16 v[172:175], a[244:247], a[148:151], v[172:175]
ds_read_b64_tr_b16 a[230:231], v9 offset:6144
v_mfma_f32_16x16x32_bf16 v[172:175], a[240:243], a[144:147], v[172:175]
buffer_load_dwordx4 v40, s[16:19], s55 offen offset:0 lds
v_mfma_f32_16x16x32_bf16 v[156:159], a[240:243], a[136:139], v[156:159]
ds_read_b64_tr_b16 a[232:233], v9 offset:8192
v_mfma_f32_16x16x32_bf16 v[156:159], a[244:247], a[140:143], v[156:159]
v_mfma_f32_16x16x32_bf16 v[156:159], a[248:251], a[168:171], v[156:159]
ds_read_b64_tr_b16 a[234:235], v9 offset:10240
v_mfma_f32_16x16x32_bf16 v[156:159], a[252:255], a[172:175], v[156:159]
v_mfma_f32_16x16x32_bf16 v[140:143], a[252:255], a[164:167], v[140:143]
ds_read_b64_tr_b16 a[236:237], v9 offset:12288
v_mfma_f32_16x16x32_bf16 v[140:143], a[248:251], a[160:163], v[140:143]
buffer_load_dwordx4 v41, s[16:19], s55 offen offset:1024 lds
v_mfma_f32_16x16x32_bf16 v[140:143], a[244:247], a[132:135], v[140:143]
s_mov_b32 s55, 4128768
ds_read_b64_tr_b16 a[238:239], v9 offset:14336
s_add_u32 m0, s52, 49152
v_mfma_f32_16x16x32_bf16 v[140:143], a[240:243], a[128:131], v[140:143]
s_waitcnt lgkmcnt(8)
v_mfma_f32_16x16x32_bf16 v[192:195], a[96:99], a[128:131], v[192:195]
ds_read_b64_tr_b16 a[240:241], v8 offset:1024
v_mfma_f32_16x16x32_bf16 v[192:195], a[100:103], a[132:135], v[192:195]
v_mfma_f32_16x16x32_bf16 v[192:195], a[104:107], a[160:163], v[192:195]
buffer_load_dwordx4 v40, s[16:19], s55 offen offset:0 lds
v_mfma_f32_16x16x32_bf16 v[192:195], a[108:111], a[164:167], v[192:195]
ds_read_b64_tr_b16 a[242:243], v8 offset:3072
v_mfma_f32_16x16x32_bf16 v[200:203], a[108:111], a[172:175], v[200:203]
ds_read_b64_tr_b16 a[244:245], v8 offset:5120
v_mfma_f32_16x16x32_bf16 v[200:203], a[104:107], a[168:171], v[200:203]
v_mfma_f32_16x16x32_bf16 v[200:203], a[100:103], a[140:143], v[200:203]
ds_read_b64_tr_b16 a[246:247], v8 offset:7168
v_mfma_f32_16x16x32_bf16 v[200:203], a[96:99], a[136:139], v[200:203]
v_mfma_f32_16x16x32_bf16 v[208:211], a[96:99], a[144:147], v[208:211]
buffer_load_dwordx4 v41, s[16:19], s55 offen offset:1024 lds
v_mfma_f32_16x16x32_bf16 v[208:211], a[100:103], a[148:151], v[208:211]
s_mov_b32 s55, 3670016
ds_read_b64_tr_b16 a[248:249], v8 offset:9216
s_add_u32 m0, s52, 57344
v_mfma_f32_16x16x32_bf16 v[208:211], a[104:107], a[176:179], v[208:211]
ds_read_b64_tr_b16 a[250:251], v8 offset:11264
v_mfma_f32_16x16x32_bf16 v[208:211], a[108:111], a[180:183], v[208:211]
v_mfma_f32_16x16x32_bf16 v[216:219], a[108:111], a[188:191], v[216:219]
ds_read_b64_tr_b16 a[252:253], v8 offset:13312
v_mfma_f32_16x16x32_bf16 v[216:219], a[104:107], a[184:187], v[216:219]
buffer_load_dwordx4 v40, s[20:23], s55 offen offset:0 lds
v_mfma_f32_16x16x32_bf16 v[216:219], a[100:103], a[156:159], v[216:219]
ds_read_b64_tr_b16 a[254:255], v8 offset:15360
v_mfma_f32_16x16x32_bf16 v[216:219], a[96:99], a[152:155], v[216:219]
s_waitcnt lgkmcnt(8)
v_mfma_f32_16x16x32_bf16 v[220:223], a[224:227], a[152:155], v[220:223]
ds_read_b64_tr_b16 a[96:97], v9 offset:1024
v_mfma_f32_16x16x32_bf16 v[220:223], a[228:231], a[156:159], v[220:223]
v_mfma_f32_16x16x32_bf16 v[220:223], a[232:235], a[184:187], v[220:223]
ds_read_b64_tr_b16 a[98:99], v9 offset:3072
v_mfma_f32_16x16x32_bf16 v[220:223], a[236:239], a[188:191], v[220:223]
buffer_load_dwordx4 v41, s[20:23], s55 offen offset:1024 lds
v_mfma_f32_16x16x32_bf16 v[212:215], a[236:239], a[180:183], v[212:215]
s_mov_b32 s55, 4128768
ds_read_b64_tr_b16 a[100:101], v9 offset:5120
s_add_u32 m0, s52, 65536
v_mfma_f32_16x16x32_bf16 v[212:215], a[232:235], a[176:179], v[212:215]
v_mfma_f32_16x16x32_bf16 v[212:215], a[228:231], a[148:151], v[212:215]
ds_read_b64_tr_b16 a[102:103], v9 offset:7168
v_mfma_f32_16x16x32_bf16 v[212:215], a[224:227], a[144:147], v[212:215]
v_mfma_f32_16x16x32_bf16 v[204:207], a[224:227], a[136:139], v[204:207]
buffer_load_dwordx4 v40, s[20:23], s55 offen offset:0 lds
v_mfma_f32_16x16x32_bf16 v[204:207], a[228:231], a[140:143], v[204:207]
ds_read_b64_tr_b16 a[104:105], v9 offset:9216
v_mfma_f32_16x16x32_bf16 v[204:207], a[232:235], a[168:171], v[204:207]
ds_read_b64_tr_b16 a[106:107], v9 offset:11264
v_mfma_f32_16x16x32_bf16 v[204:207], a[236:239], a[172:175], v[204:207]
v_mfma_f32_16x16x32_bf16 v[196:199], a[236:239], a[164:167], v[196:199]
ds_read_b64_tr_b16 a[108:109], v9 offset:13312
v_mfma_f32_16x16x32_bf16 v[196:199], a[232:235], a[160:163], v[196:199]
v_mfma_f32_16x16x32_bf16 v[196:199], a[228:231], a[132:135], v[196:199]
buffer_load_dwordx4 v41, s[20:23], s55 offen offset:1024 lds
v_mfma_f32_16x16x32_bf16 v[196:199], a[224:227], a[128:131], v[196:199]
s_waitcnt vmcnt(26) lgkmcnt(7)
s_barrier
v_mfma_f32_16x16x32_bf16 v[224:227], a[128:131], a[240:243], v[224:227]
s_mov_b32 s56, 3145728
ds_read_b64_tr_b16 a[110:111], v9 offset:15360
ds_read_b64_tr_b16 a[224:225], v24 offset:16384
v_mfma_f32_16x16x32_bf16 v[224:227], a[132:135], a[244:247], v[224:227]
s_add_u32 m0, s52, 73728
v_mfma_f32_16x16x32_bf16 v[224:227], a[160:163], a[248:251], v[224:227]
buffer_load_dwordx4 v42, s[12:15], s56 offen offset:0 lds
v_mfma_f32_16x16x32_bf16 v[224:227], a[164:167], a[252:255], v[224:227]
ds_read_b64_tr_b16 a[226:227], v24 offset:18432
v_mfma_f32_16x16x32_bf16 v[228:231], a[172:175], a[252:255], v[228:231]
ds_read_b64_tr_b16 a[228:229], v24 offset:20480
v_mfma_f32_16x16x32_bf16 v[228:231], a[168:171], a[248:251], v[228:231]
v_mfma_f32_16x16x32_bf16 v[228:231], a[140:143], a[244:247], v[228:231]
ds_read_b64_tr_b16 a[230:231], v24 offset:22528
v_mfma_f32_16x16x32_bf16 v[228:231], a[136:139], a[240:243], v[228:231]
v_mfma_f32_16x16x32_bf16 v[232:235], a[144:147], a[240:243], v[232:235]
ds_read_b64_tr_b16 a[232:233], v16 offset:0
v_mfma_f32_16x16x32_bf16 v[232:235], a[148:151], a[244:247], v[232:235]
v_mfma_f32_16x16x32_bf16 v[232:235], a[176:179], a[248:251], v[232:235]
ds_read_b64_tr_b16 a[234:235], v16 offset:2048
v_mfma_f32_16x16x32_bf16 v[232:235], a[180:183], a[252:255], v[232:235]
v_mfma_f32_16x16x32_bf16 v[236:239], a[188:191], a[252:255], v[236:239]
ds_read_b64_tr_b16 a[236:237], v16 offset:4096
v_mfma_f32_16x16x32_bf16 v[236:239], a[184:187], a[248:251], v[236:239]
buffer_load_dwordx4 v43, s[12:15], s56 offen offset:1024 lds
v_mfma_f32_16x16x32_bf16 v[236:239], a[156:159], a[244:247], v[236:239]
s_mov_b32 s56, 3538944
ds_read_b64_tr_b16 a[238:239], v16 offset:6144
s_add_u32 m0, s52, 81920
v_mfma_f32_16x16x32_bf16 v[236:239], a[152:155], a[240:243], v[236:239]
s_waitcnt lgkmcnt(8)
v_mfma_f32_16x16x32_bf16 v[252:255], a[152:155], a[96:99], v[252:255]
ds_read_b64_tr_b16 a[240:241], v25 offset:16384
v_mfma_f32_16x16x32_bf16 v[252:255], a[156:159], a[100:103], v[252:255]
v_mfma_f32_16x16x32_bf16 v[252:255], a[184:187], a[104:107], v[252:255]
ds_read_b64_tr_b16 a[242:243], v25 offset:18432
v_mfma_f32_16x16x32_bf16 v[252:255], a[188:191], a[108:111], v[252:255]
v_mfma_f32_16x16x32_bf16 v[248:251], a[180:183], a[108:111], v[248:251]
ds_read_b64_tr_b16 a[244:245], v25 offset:20480
v_mfma_f32_16x16x32_bf16 v[248:251], a[176:179], a[104:107], v[248:251]
v_mfma_f32_16x16x32_bf16 v[248:251], a[148:151], a[100:103], v[248:251]
ds_read_b64_tr_b16 a[246:247], v25 offset:22528
v_mfma_f32_16x16x32_bf16 v[248:251], a[144:147], a[96:99], v[248:251]
v_mfma_f32_16x16x32_bf16 v[244:247], a[136:139], a[96:99], v[244:247]
buffer_load_dwordx4 v42, s[12:15], s56 offen offset:0 lds
v_mfma_f32_16x16x32_bf16 v[244:247], a[140:143], a[100:103], v[244:247]
ds_read_b64_tr_b16 a[248:249], v17 offset:0
v_mfma_f32_16x16x32_bf16 v[244:247], a[168:171], a[104:107], v[244:247]
ds_read_b64_tr_b16 a[250:251], v17 offset:2048
v_mfma_f32_16x16x32_bf16 v[244:247], a[172:175], a[108:111], v[244:247]
v_mfma_f32_16x16x32_bf16 v[240:243], a[164:167], a[108:111], v[240:243]
ds_read_b64_tr_b16 a[252:253], v17 offset:4096
v_mfma_f32_16x16x32_bf16 v[240:243], a[160:163], a[104:107], v[240:243]
v_mfma_f32_16x16x32_bf16 v[240:243], a[132:135], a[100:103], v[240:243]
ds_read_b64_tr_b16 a[254:255], v17 offset:6144
v_mfma_f32_16x16x32_bf16 v[240:243], a[128:131], a[96:99], v[240:243]
s_waitcnt vmcnt(11) lgkmcnt(8)
v_mfma_f32_16x16x32_bf16 v[64:67], a[224:227], a[32:35], v[64:67]
s_and_b32 s90, s32, 1
ds_read_b64_tr_b16 a[96:97], v26 offset:16384
v_lshrrev_b32 v56, 2, v0
v_mfma_f32_16x16x32_bf16 v[64:67], a[228:231], a[36:39], v[64:67]
s_lshl1_add_u32 s90, s3, s90
v_mul_u32_u24 v56, 7168, v56
v_and_b32 v57, 3, v0
v_mfma_f32_16x16x32_bf16 v[64:67], a[232:235], a[192:195], v[64:67]
s_mul_i32 s90, s90, 28672
ds_read_b64_tr_b16 a[98:99], v26 offset:18432
v_min_u32 v57, 2, v57
v_mfma_f32_16x16x32_bf16 v[64:67], a[236:239], a[196:199], v[64:67]
buffer_load_dwordx4 v43, s[12:15], s56 offen offset:1024 lds
v_mfma_f32_16x16x32_bf16 v[80:83], a[236:239], a[204:207], v[80:83]
s_add_u32 s54, s53, 65536
ds_read_b64_tr_b16 a[100:101], v26 offset:20480
v_lshl_add_u32 v56, v57, 7, v56
v_mfma_f32_16x16x32_bf16 v[80:83], a[232:235], a[200:203], v[80:83]
s_and_b32 s91, s2, 7
v_lshlrev_b32 v57, 7, v0
v_lshrrev_b32 v60, 4, v0
v_mfma_f32_16x16x32_bf16 v[80:83], a[228:231], a[44:47], v[80:83]
s_mul_i32 s91, s91, 384
ds_read_b64_tr_b16 a[102:103], v26 offset:22528
v_min_u32 v60, 1, v60
v_mfma_f32_16x16x32_bf16 v[80:83], a[224:227], a[40:43], v[80:83]
s_add_u32 s90, s90, s91
v_lshl_add_u32 v56, v60, 30, v56
v_lshrrev_b32 v60, 4, v0
v_mfma_f32_16x16x32_bf16 v[96:99], a[224:227], a[48:51], v[96:99]
s_add_u32 s90, s90, 5509120
ds_read_b64_tr_b16 a[104:105], v18 offset:0
v_min_u32 v60, 1, v60
v_mfma_f32_16x16x32_bf16 v[96:99], a[228:231], a[52:55], v[96:99]
v_lshl_add_u32 v57, v60, 30, v57
v_mfma_f32_16x16x32_bf16 v[96:99], a[232:235], a[208:211], v[96:99]
ds_read_b64_tr_b16 a[106:107], v18 offset:2048
v_mfma_f32_16x16x32_bf16 v[96:99], a[236:239], a[212:215], v[96:99]
v_mfma_f32_16x16x32_bf16 v[112:115], a[236:239], a[220:223], v[112:115]
ds_read_b64_tr_b16 a[108:109], v18 offset:4096
v_mfma_f32_16x16x32_bf16 v[112:115], a[232:235], a[216:219], v[112:115]
v_mfma_f32_16x16x32_bf16 v[112:115], a[228:231], a[60:63], v[112:115]
buffer_load_dword v61, v56, s[36:39], s90 offen
v_mfma_f32_16x16x32_bf16 v[112:115], a[224:227], a[56:59], v[112:115]
s_waitcnt lgkmcnt(7)
ds_read_b64_tr_b16 a[110:111], v18 offset:6144
s_sub_u32 s90, s90, 1835008
v_mfma_f32_16x16x32_bf16 v[116:119], a[240:243], a[56:59], v[116:119]
ds_read_b64_tr_b16 a[224:225], v27 offset:16384
v_mfma_f32_16x16x32_bf16 v[116:119], a[244:247], a[60:63], v[116:119]
v_mfma_f32_16x16x32_bf16 v[116:119], a[248:251], a[216:219], v[116:119]
ds_read_b64_tr_b16 a[226:227], v27 offset:18432
v_mfma_f32_16x16x32_bf16 v[116:119], a[252:255], a[220:223], v[116:119]
v_mfma_f32_16x16x32_bf16 v[100:103], a[252:255], a[212:215], v[100:103]
ds_read_b64_tr_b16 a[228:229], v27 offset:20480
v_mfma_f32_16x16x32_bf16 v[100:103], a[248:251], a[208:211], v[100:103]
v_mfma_f32_16x16x32_bf16 v[100:103], a[244:247], a[52:55], v[100:103]
ds_read_b64_tr_b16 a[230:231], v27 offset:22528
v_mfma_f32_16x16x32_bf16 v[100:103], a[240:243], a[48:51], v[100:103]
v_mfma_f32_16x16x32_bf16 v[84:87], a[240:243], a[40:43], v[84:87]
ds_read_b64_tr_b16 a[232:233], v19 offset:0
v_mfma_f32_16x16x32_bf16 v[84:87], a[244:247], a[44:47], v[84:87]
buffer_load_dwordx4 a[128:131], v1, s[24:27], s54 offen offset:0 sc1
v_mfma_f32_16x16x32_bf16 v[84:87], a[248:251], a[200:203], v[84:87]
ds_read_b64_tr_b16 a[234:235], v19 offset:2048
v_mfma_f32_16x16x32_bf16 v[84:87], a[252:255], a[204:207], v[84:87]
v_mfma_f32_16x16x32_bf16 v[68:71], a[252:255], a[196:199], v[68:71]
ds_read_b64_tr_b16 a[236:237], v19 offset:4096
v_mfma_f32_16x16x32_bf16 v[68:71], a[248:251], a[192:195], v[68:71]
v_mfma_f32_16x16x32_bf16 v[68:71], a[244:247], a[36:39], v[68:71]
ds_read_b64_tr_b16 a[238:239], v19 offset:6144
v_mfma_f32_16x16x32_bf16 v[68:71], a[240:243], a[32:35], v[68:71]
s_waitcnt lgkmcnt(8)
buffer_load_dwordx4 a[132:135], v1, s[24:27], s54 offen offset:1024 sc1
v_mfma_f32_16x16x32_bf16 v[128:131], a[96:99], a[32:35], v[128:131]
ds_read_b64_tr_b16 a[240:241], v16 offset:8192
v_mfma_f32_16x16x32_bf16 v[128:131], a[100:103], a[36:39], v[128:131]
v_mfma_f32_16x16x32_bf16 v[128:131], a[104:107], a[192:195], v[128:131]
ds_read_b64_tr_b16 a[242:243], v16 offset:10240
v_mfma_f32_16x16x32_bf16 v[128:131], a[108:111], a[196:199], v[128:131]
v_mfma_f32_16x16x32_bf16 v[144:147], a[108:111], a[204:207], v[144:147]
buffer_load_dwordx4 a[136:139], v1, s[24:27], s54 offen offset:2048 sc1
v_mfma_f32_16x16x32_bf16 v[144:147], a[104:107], a[200:203], v[144:147]
ds_read_b64_tr_b16 a[244:245], v16 offset:12288
v_mfma_f32_16x16x32_bf16 v[144:147], a[100:103], a[44:47], v[144:147]
ds_read_b64_tr_b16 a[246:247], v16 offset:14336
v_mfma_f32_16x16x32_bf16 v[144:147], a[96:99], a[40:43], v[144:147]
v_mfma_f32_16x16x32_bf16 v[160:163], a[96:99], a[48:51], v[160:163]
ds_read_b64_tr_b16 a[248:249], v16 offset:16384
v_mfma_f32_16x16x32_bf16 v[160:163], a[100:103], a[52:55], v[160:163]
v_mfma_f32_16x16x32_bf16 v[160:163], a[104:107], a[208:211], v[160:163]
buffer_load_dwordx4 a[140:143], v1, s[24:27], s54 offen offset:3072 sc1
v_mfma_f32_16x16x32_bf16 v[160:163], a[108:111], a[212:215], v[160:163]
ds_read_b64_tr_b16 a[250:251], v16 offset:18432
v_mfma_f32_16x16x32_bf16 v[176:179], a[108:111], a[220:223], v[176:179]
ds_read_b64_tr_b16 a[252:253], v16 offset:20480
v_mfma_f32_16x16x32_bf16 v[176:179], a[104:107], a[216:219], v[176:179]
v_mfma_f32_16x16x32_bf16 v[176:179], a[100:103], a[60:63], v[176:179]
ds_read_b64_tr_b16 a[254:255], v16 offset:22528
v_mfma_f32_16x16x32_bf16 v[176:179], a[96:99], a[56:59], v[176:179]
s_waitcnt lgkmcnt(8)
buffer_load_dwordx4 a[144:147], v2, s[24:27], s54 offen offset:0 sc1
v_mfma_f32_16x16x32_bf16 v[180:183], a[224:227], a[56:59], v[180:183]
s_load_dword s101, s[92:93], 12280
ds_read_b64_tr_b16 a[96:97], v17 offset:8192
v_mfma_f32_16x16x32_bf16 v[180:183], a[228:231], a[60:63], v[180:183]
v_mfma_f32_16x16x32_bf16 v[180:183], a[232:235], a[216:219], v[180:183]
ds_read_b64_tr_b16 a[98:99], v17 offset:10240
v_mfma_f32_16x16x32_bf16 v[180:183], a[236:239], a[220:223], v[180:183]
v_mfma_f32_16x16x32_bf16 v[164:167], a[236:239], a[212:215], v[164:167]
ds_read_b64_tr_b16 a[100:101], v17 offset:12288
v_mfma_f32_16x16x32_bf16 v[164:167], a[232:235], a[208:211], v[164:167]
buffer_load_dwordx4 a[148:151], v2, s[24:27], s54 offen offset:1024 sc1
v_mfma_f32_16x16x32_bf16 v[164:167], a[228:231], a[52:55], v[164:167]
ds_read_b64_tr_b16 a[102:103], v17 offset:14336
v_mfma_f32_16x16x32_bf16 v[164:167], a[224:227], a[48:51], v[164:167]
v_mfma_f32_16x16x32_bf16 v[148:151], a[224:227], a[40:43], v[148:151]
ds_read_b64_tr_b16 a[104:105], v17 offset:16384
v_mfma_f32_16x16x32_bf16 v[148:151], a[228:231], a[44:47], v[148:151]
v_mfma_f32_16x16x32_bf16 v[148:151], a[232:235], a[200:203], v[148:151]
buffer_load_dwordx4 a[152:155], v2, s[24:27], s54 offen offset:2048 sc1
v_mfma_f32_16x16x32_bf16 v[148:151], a[236:239], a[204:207], v[148:151]
ds_read_b64_tr_b16 a[106:107], v17 offset:18432
v_mfma_f32_16x16x32_bf16 v[132:135], a[236:239], a[196:199], v[132:135]
ds_read_b64_tr_b16 a[108:109], v17 offset:20480
v_mfma_f32_16x16x32_bf16 v[132:135], a[232:235], a[192:195], v[132:135]
v_mfma_f32_16x16x32_bf16 v[132:135], a[228:231], a[36:39], v[132:135]
ds_read_b64_tr_b16 a[110:111], v17 offset:22528
v_mfma_f32_16x16x32_bf16 v[132:135], a[224:227], a[32:35], v[132:135]
s_waitcnt lgkmcnt(8)
v_mfma_f32_16x16x32_bf16 v[72:75], a[240:243], a[32:35], v[72:75]
buffer_load_dwordx4 a[156:159], v2, s[24:27], s54 offen offset:3072 sc1
v_mfma_f32_16x16x32_bf16 v[72:75], a[244:247], a[36:39], v[72:75]
s_add_u32 s54, s53, 73728
ds_read_b64_tr_b16 a[224:225], v18 offset:8192
v_mfma_f32_16x16x32_bf16 v[72:75], a[248:251], a[192:195], v[72:75]
ds_read_b64_tr_b16 a[226:227], v18 offset:10240
v_mfma_f32_16x16x32_bf16 v[72:75], a[252:255], a[196:199], v[72:75]
v_mfma_f32_16x16x32_bf16 v[88:91], a[252:255], a[204:207], v[88:91]
ds_read_b64_tr_b16 a[228:229], v18 offset:12288
v_mfma_f32_16x16x32_bf16 v[88:91], a[248:251], a[200:203], v[88:91]
buffer_load_dwordx4 a[160:163], v1, s[24:27], s54 offen offset:0 sc1
v_mfma_f32_16x16x32_bf16 v[88:91], a[244:247], a[44:47], v[88:91]
ds_read_b64_tr_b16 a[230:231], v18 offset:14336
v_mfma_f32_16x16x32_bf16 v[88:91], a[240:243], a[40:43], v[88:91]
v_mfma_f32_16x16x32_bf16 v[104:107], a[240:243], a[48:51], v[104:107]
ds_read_b64_tr_b16 a[232:233], v18 offset:16384
v_mfma_f32_16x16x32_bf16 v[104:107], a[244:247], a[52:55], v[104:107]
v_mfma_f32_16x16x32_bf16 v[104:107], a[248:251], a[208:211], v[104:107]
ds_read_b64_tr_b16 a[234:235], v18 offset:18432
v_mfma_f32_16x16x32_bf16 v[104:107], a[252:255], a[212:215], v[104:107]
buffer_load_dwordx4 a[164:167], v1, s[24:27], s54 offen offset:1024 sc1
v_mfma_f32_16x16x32_bf16 v[120:123], a[252:255], a[220:223], v[120:123]
ds_read_b64_tr_b16 a[236:237], v18 offset:20480
v_mfma_f32_16x16x32_bf16 v[120:123], a[248:251], a[216:219], v[120:123]
v_mfma_f32_16x16x32_bf16 v[120:123], a[244:247], a[60:63], v[120:123]
ds_read_b64_tr_b16 a[238:239], v18 offset:22528
v_mfma_f32_16x16x32_bf16 v[120:123], a[240:243], a[56:59], v[120:123]
s_waitcnt lgkmcnt(8)
v_mfma_f32_16x16x32_bf16 v[124:127], a[96:99], a[56:59], v[124:127]
buffer_load_dwordx4 a[168:171], v1, s[24:27], s54 offen offset:2048 sc1
v_mfma_f32_16x16x32_bf16 v[124:127], a[100:103], a[60:63], v[124:127]
ds_read_b64_tr_b16 a[240:241], v19 offset:8192
v_mfma_f32_16x16x32_bf16 v[124:127], a[104:107], a[216:219], v[124:127]
ds_read_b64_tr_b16 a[242:243], v19 offset:10240
v_mfma_f32_16x16x32_bf16 v[124:127], a[108:111], a[220:223], v[124:127]
v_mfma_f32_16x16x32_bf16 v[108:111], a[108:111], a[212:215], v[108:111]
ds_read_b64_tr_b16 a[244:245], v19 offset:12288
v_mfma_f32_16x16x32_bf16 v[108:111], a[104:107], a[208:211], v[108:111]
v_mfma_f32_16x16x32_bf16 v[108:111], a[100:103], a[52:55], v[108:111]
buffer_load_dwordx4 a[172:175], v1, s[24:27], s54 offen offset:3072 sc1
v_mfma_f32_16x16x32_bf16 v[108:111], a[96:99], a[48:51], v[108:111]
ds_read_b64_tr_b16 a[246:247], v19 offset:14336
v_mfma_f32_16x16x32_bf16 v[92:95], a[96:99], a[40:43], v[92:95]
ds_read_b64_tr_b16 a[248:249], v19 offset:16384
v_mfma_f32_16x16x32_bf16 v[92:95], a[100:103], a[44:47], v[92:95]
v_mfma_f32_16x16x32_bf16 v[92:95], a[104:107], a[200:203], v[92:95]
ds_read_b64_tr_b16 a[250:251], v19 offset:18432
v_mfma_f32_16x16x32_bf16 v[92:95], a[108:111], a[204:207], v[92:95]
buffer_load_dwordx4 a[176:179], v2, s[24:27], s54 offen offset:0 sc1
v_mfma_f32_16x16x32_bf16 v[76:79], a[108:111], a[196:199], v[76:79]
ds_read_b64_tr_b16 a[252:253], v19 offset:20480
v_mfma_f32_16x16x32_bf16 v[76:79], a[104:107], a[192:195], v[76:79]
v_mfma_f32_16x16x32_bf16 v[76:79], a[100:103], a[36:39], v[76:79]
ds_read_b64_tr_b16 a[254:255], v19 offset:22528
v_mfma_f32_16x16x32_bf16 v[76:79], a[96:99], a[32:35], v[76:79]
s_waitcnt lgkmcnt(8)
v_mfma_f32_16x16x32_bf16 v[136:139], a[224:227], a[32:35], v[136:139]
ds_read_b64_tr_b16 a[96:97], v4 offset:24576
v_mfma_f32_16x16x32_bf16 v[136:139], a[228:231], a[36:39], v[136:139]
buffer_load_dwordx4 a[180:183], v2, s[24:27], s54 offen offset:1024 sc1
v_mfma_f32_16x16x32_bf16 v[136:139], a[232:235], a[192:195], v[136:139]
ds_read_b64_tr_b16 a[98:99], v4 offset:26624
v_mfma_f32_16x16x32_bf16 v[136:139], a[236:239], a[196:199], v[136:139]
v_mfma_f32_16x16x32_bf16 v[152:155], a[236:239], a[204:207], v[152:155]
ds_read_b64_tr_b16 a[100:101], v4 offset:28672
v_mfma_f32_16x16x32_bf16 v[152:155], a[232:235], a[200:203], v[152:155]
v_mfma_f32_16x16x32_bf16 v[152:155], a[228:231], a[44:47], v[152:155]
buffer_load_dwordx4 a[184:187], v2, s[24:27], s54 offen offset:2048 sc1
v_mfma_f32_16x16x32_bf16 v[152:155], a[224:227], a[40:43], v[152:155]
ds_read_b64_tr_b16 a[102:103], v4 offset:30720
v_mfma_f32_16x16x32_bf16 v[168:171], a[224:227], a[48:51], v[168:171]
ds_read_b64_tr_b16 a[104:105], v4 offset:32768
v_mfma_f32_16x16x32_bf16 v[168:171], a[228:231], a[52:55], v[168:171]
v_mfma_f32_16x16x32_bf16 v[168:171], a[232:235], a[208:211], v[168:171]
ds_read_b64_tr_b16 a[106:107], v4 offset:34816
v_mfma_f32_16x16x32_bf16 v[168:171], a[236:239], a[212:215], v[168:171]
v_mfma_f32_16x16x32_bf16 v[184:187], a[236:239], a[220:223], v[184:187]
buffer_load_dword v61, v56, s[36:39], s90 offen
v_mfma_f32_16x16x32_bf16 v[184:187], a[232:235], a[216:219], v[184:187]
s_sub_u32 s90, s90, 1835008
ds_read_b64_tr_b16 a[108:109], v4 offset:36864
v_mfma_f32_16x16x32_bf16 v[184:187], a[228:231], a[60:63], v[184:187]
ds_read_b64_tr_b16 a[110:111], v4 offset:38912
v_mfma_f32_16x16x32_bf16 v[184:187], a[224:227], a[56:59], v[184:187]
s_waitcnt lgkmcnt(8)
v_mfma_f32_16x16x32_bf16 v[188:191], a[240:243], a[56:59], v[188:191]
ds_read_b64_tr_b16 a[224:225], v5 offset:24576
v_mfma_f32_16x16x32_bf16 v[188:191], a[244:247], a[60:63], v[188:191]
v_mfma_f32_16x16x32_bf16 v[188:191], a[248:251], a[216:219], v[188:191]
ds_read_b64_tr_b16 a[226:227], v5 offset:26624
v_mfma_f32_16x16x32_bf16 v[188:191], a[252:255], a[220:223], v[188:191]
v_mfma_f32_16x16x32_bf16 v[172:175], a[252:255], a[212:215], v[172:175]
ds_read_b64_tr_b16 a[228:229], v5 offset:28672
v_mfma_f32_16x16x32_bf16 v[172:175], a[248:251], a[208:211], v[172:175]
v_mfma_f32_16x16x32_bf16 v[172:175], a[244:247], a[52:55], v[172:175]
ds_read_b64_tr_b16 a[230:231], v5 offset:30720
v_mfma_f32_16x16x32_bf16 v[172:175], a[240:243], a[48:51], v[172:175]
buffer_load_dwordx4 a[188:191], v2, s[24:27], s54 offen offset:3072 sc1
v_mfma_f32_16x16x32_bf16 v[156:159], a[240:243], a[40:43], v[156:159]
s_mov_b32 s55, 4587520
ds_read_b64_tr_b16 a[232:233], v5 offset:32768
s_add_u32 m0, s52, 90112
v_mfma_f32_16x16x32_bf16 v[156:159], a[244:247], a[44:47], v[156:159]
v_mfma_f32_16x16x32_bf16 v[156:159], a[248:251], a[200:203], v[156:159]
ds_read_b64_tr_b16 a[234:235], v5 offset:34816
v_mfma_f32_16x16x32_bf16 v[156:159], a[252:255], a[204:207], v[156:159]
v_mfma_f32_16x16x32_bf16 v[140:143], a[252:255], a[196:199], v[140:143]
buffer_load_dwordx4 v40, s[16:19], s55 offen offset:0 lds
v_mfma_f32_16x16x32_bf16 v[140:143], a[248:251], a[192:195], v[140:143]
ds_read_b64_tr_b16 a[236:237], v5 offset:36864
v_mfma_f32_16x16x32_bf16 v[140:143], a[244:247], a[36:39], v[140:143]
ds_read_b64_tr_b16 a[238:239], v5 offset:38912
v_mfma_f32_16x16x32_bf16 v[140:143], a[240:243], a[32:35], v[140:143]
s_waitcnt lgkmcnt(8)
v_mfma_f32_16x16x32_bf16 v[192:195], a[96:99], a[32:35], v[192:195]
ds_read_b64_tr_b16 a[240:241], v4 offset:25600
v_mfma_f32_16x16x32_bf16 v[192:195], a[100:103], a[36:39], v[192:195]
v_mfma_f32_16x16x32_bf16 v[192:195], a[104:107], a[192:195], v[192:195]
buffer_load_dwordx4 v41, s[16:19], s55 offen offset:1024 lds
v_mfma_f32_16x16x32_bf16 v[192:195], a[108:111], a[196:199], v[192:195]
s_mov_b32 s55, 5046272
ds_read_b64_tr_b16 a[242:243], v4 offset:27648
s_add_u32 m0, s52, 98304
v_mfma_f32_16x16x32_bf16 v[200:203], a[108:111], a[204:207], v[200:203]
ds_read_b64_tr_b16 a[244:245], v4 offset:29696
v_mfma_f32_16x16x32_bf16 v[200:203], a[104:107], a[200:203], v[200:203]
v_mfma_f32_16x16x32_bf16 v[200:203], a[100:103], a[44:47], v[200:203]
ds_read_b64_tr_b16 a[246:247], v4 offset:31744
v_mfma_f32_16x16x32_bf16 v[200:203], a[96:99], a[40:43], v[200:203]
buffer_load_dwordx4 v40, s[16:19], s55 offen offset:0 lds
v_mfma_f32_16x16x32_bf16 v[208:211], a[96:99], a[48:51], v[208:211]
ds_read_b64_tr_b16 a[248:249], v4 offset:33792
v_mfma_f32_16x16x32_bf16 v[208:211], a[100:103], a[52:55], v[208:211]
v_mfma_f32_16x16x32_bf16 v[208:211], a[104:107], a[208:211], v[208:211]
ds_read_b64_tr_b16 a[250:251], v4 offset:35840
v_mfma_f32_16x16x32_bf16 v[208:211], a[108:111], a[212:215], v[208:211]
v_mfma_f32_16x16x32_bf16 v[216:219], a[108:111], a[220:223], v[216:219]
ds_read_b64_tr_b16 a[252:253], v4 offset:37888
v_mfma_f32_16x16x32_bf16 v[216:219], a[104:107], a[216:219], v[216:219]
buffer_load_dwordx4 v41, s[16:19], s55 offen offset:1024 lds
v_mfma_f32_16x16x32_bf16 v[216:219], a[100:103], a[60:63], v[216:219]
s_mov_b32 s55, 4587520
ds_read_b64_tr_b16 a[254:255], v4 offset:39936
s_add_u32 m0, s52, 106496
v_mfma_f32_16x16x32_bf16 v[216:219], a[96:99], a[56:59], v[216:219]
s_waitcnt lgkmcnt(8)
v_mfma_f32_16x16x32_bf16 v[220:223], a[224:227], a[56:59], v[220:223]
ds_read_b64_tr_b16 a[96:97], v5 offset:25600
v_mfma_f32_16x16x32_bf16 v[220:223], a[228:231], a[60:63], v[220:223]
v_mfma_f32_16x16x32_bf16 v[220:223], a[232:235], a[216:219], v[220:223]
buffer_load_dwordx4 v40, s[20:23], s55 offen offset:0 lds
v_mfma_f32_16x16x32_bf16 v[220:223], a[236:239], a[220:223], v[220:223]
ds_read_b64_tr_b16 a[98:99], v5 offset:27648
v_mfma_f32_16x16x32_bf16 v[212:215], a[236:239], a[212:215], v[212:215]
ds_read_b64_tr_b16 a[100:101], v5 offset:29696
v_mfma_f32_16x16x32_bf16 v[212:215], a[232:235], a[208:211], v[212:215]
v_mfma_f32_16x16x32_bf16 v[212:215], a[228:231], a[52:55], v[212:215]
ds_read_b64_tr_b16 a[102:103], v5 offset:31744
v_mfma_f32_16x16x32_bf16 v[212:215], a[224:227], a[48:51], v[212:215]
v_mfma_f32_16x16x32_bf16 v[204:207], a[224:227], a[40:43], v[204:207]
buffer_load_dwordx4 v41, s[20:23], s55 offen offset:1024 lds
v_mfma_f32_16x16x32_bf16 v[204:207], a[228:231], a[44:47], v[204:207]
s_mov_b32 s55, 5046272
ds_read_b64_tr_b16 a[104:105], v5 offset:33792
s_add_u32 m0, s52, 114688
v_mfma_f32_16x16x32_bf16 v[204:207], a[232:235], a[200:203], v[204:207]
ds_read_b64_tr_b16 a[106:107], v5 offset:35840
v_mfma_f32_16x16x32_bf16 v[204:207], a[236:239], a[204:207], v[204:207]
v_mfma_f32_16x16x32_bf16 v[196:199], a[236:239], a[196:199], v[196:199]
ds_read_b64_tr_b16 a[108:109], v5 offset:37888
v_mfma_f32_16x16x32_bf16 v[196:199], a[232:235], a[192:195], v[196:199]
buffer_load_dwordx4 v40, s[20:23], s55 offen offset:0 lds
v_mfma_f32_16x16x32_bf16 v[196:199], a[228:231], a[36:39], v[196:199]
ds_read_b64_tr_b16 a[110:111], v5 offset:39936
v_mfma_f32_16x16x32_bf16 v[196:199], a[224:227], a[32:35], v[196:199]
s_waitcnt vmcnt(25) lgkmcnt(8)
s_barrier
v_mfma_f32_16x16x32_bf16 v[224:227], a[32:35], a[240:243], v[224:227]
ds_read_b64_tr_b16 a[224:225], v16 offset:40960
v_mfma_f32_16x16x32_bf16 v[224:227], a[36:39], a[244:247], v[224:227]
v_mfma_f32_16x16x32_bf16 v[224:227], a[192:195], a[248:251], v[224:227]
buffer_load_dwordx4 v41, s[20:23], s55 offen offset:1024 lds
v_mfma_f32_16x16x32_bf16 v[224:227], a[196:199], a[252:255], v[224:227]
s_mov_b32 s56, 3932160
ds_read_b64_tr_b16 a[226:227], v16 offset:43008
s_add_u32 m0, s52, 122880
v_mfma_f32_16x16x32_bf16 v[228:231], a[204:207], a[252:255], v[228:231]
ds_read_b64_tr_b16 a[228:229], v16 offset:45056
v_mfma_f32_16x16x32_bf16 v[228:231], a[200:203], a[248:251], v[228:231]
v_mfma_f32_16x16x32_bf16 v[228:231], a[44:47], a[244:247], v[228:231]
ds_read_b64_tr_b16 a[230:231], v16 offset:47104
v_mfma_f32_16x16x32_bf16 v[228:231], a[40:43], a[240:243], v[228:231]
buffer_load_dwordx4 v42, s[12:15], s56 offen offset:0 lds
v_mfma_f32_16x16x32_bf16 v[232:235], a[48:51], a[240:243], v[232:235]
ds_read_b64_tr_b16 a[232:233], v16 offset:49152
v_mfma_f32_16x16x32_bf16 v[232:235], a[52:55], a[244:247], v[232:235]
v_mfma_f32_16x16x32_bf16 v[232:235], a[208:211], a[248:251], v[232:235]
ds_read_b64_tr_b16 a[234:235], v16 offset:51200
v_mfma_f32_16x16x32_bf16 v[232:235], a[212:215], a[252:255], v[232:235]
v_mfma_f32_16x16x32_bf16 v[236:239], a[220:223], a[252:255], v[236:239]
ds_read_b64_tr_b16 a[236:237], v16 offset:53248
v_mfma_f32_16x16x32_bf16 v[236:239], a[216:219], a[248:251], v[236:239]
v_mfma_f32_16x16x32_bf16 v[236:239], a[60:63], a[244:247], v[236:239]
ds_read_b64_tr_b16 a[238:239], v16 offset:55296
v_mfma_f32_16x16x32_bf16 v[236:239], a[56:59], a[240:243], v[236:239]
s_waitcnt lgkmcnt(8)
v_mfma_f32_16x16x32_bf16 v[252:255], a[56:59], a[96:99], v[252:255]
ds_read_b64_tr_b16 a[240:241], v17 offset:40960
v_mfma_f32_16x16x32_bf16 v[252:255], a[60:63], a[100:103], v[252:255]
v_mfma_f32_16x16x32_bf16 v[252:255], a[216:219], a[104:107], v[252:255]
buffer_load_dwordx4 v43, s[12:15], s56 offen offset:1024 lds
v_mfma_f32_16x16x32_bf16 v[252:255], a[220:223], a[108:111], v[252:255]
s_mov_b32 s56, 4325376
ds_read_b64_tr_b16 a[242:243], v17 offset:43008
s_add_u32 m0, s52, 131072
v_mfma_f32_16x16x32_bf16 v[248:251], a[212:215], a[108:111], v[248:251]
ds_read_b64_tr_b16 a[244:245], v17 offset:45056
v_mfma_f32_16x16x32_bf16 v[248:251], a[208:211], a[104:107], v[248:251]
v_mfma_f32_16x16x32_bf16 v[248:251], a[52:55], a[100:103], v[248:251]
ds_read_b64_tr_b16 a[246:247], v17 offset:47104
v_mfma_f32_16x16x32_bf16 v[248:251], a[48:51], a[96:99], v[248:251]
v_mfma_f32_16x16x32_bf16 v[244:247], a[40:43], a[96:99], v[244:247]
ds_read_b64_tr_b16 a[248:249], v17 offset:49152
v_mfma_f32_16x16x32_bf16 v[244:247], a[44:47], a[100:103], v[244:247]
v_mfma_f32_16x16x32_bf16 v[244:247], a[200:203], a[104:107], v[244:247]
ds_read_b64_tr_b16 a[250:251], v17 offset:51200
v_mfma_f32_16x16x32_bf16 v[244:247], a[204:207], a[108:111], v[244:247]
pg_2:
s_cbranch_execz pg_6
v_mfma_f32_16x16x32_bf16 v[240:243], a[196:199], a[108:111], v[240:243]
ds_read_b64_tr_b16 a[252:253], v17 offset:53248
v_mfma_f32_16x16x32_bf16 v[240:243], a[192:195], a[104:107], v[240:243]
buffer_load_dwordx4 v42, s[12:15], s56 offen offset:0 lds
v_mfma_f32_16x16x32_bf16 v[240:243], a[36:39], a[100:103], v[240:243]
ds_read_b64_tr_b16 a[254:255], v17 offset:55296
v_mfma_f32_16x16x32_bf16 v[240:243], a[32:35], a[96:99], v[240:243]
s_waitcnt vmcnt(11) lgkmcnt(8)
v_mfma_f32_16x16x32_bf16 v[64:67], a[224:227], a[128:131], v[64:67]
ds_read_b64_tr_b16 a[96:97], v18 offset:40960
v_mfma_f32_16x16x32_bf16 v[64:67], a[228:231], a[132:135], v[64:67]
v_mfma_f32_16x16x32_bf16 v[64:67], a[232:235], a[160:163], v[64:67]
ds_read_b64_tr_b16 a[98:99], v18 offset:43008
v_mfma_f32_16x16x32_bf16 v[64:67], a[236:239], a[164:167], v[64:67]
v_mfma_f32_16x16x32_bf16 v[80:83], a[236:239], a[172:175], v[80:83]
ds_read_b64_tr_b16 a[100:101], v18 offset:45056
v_mfma_f32_16x16x32_bf16 v[80:83], a[232:235], a[168:171], v[80:83]
v_mfma_f32_16x16x32_bf16 v[80:83], a[228:231], a[140:143], v[80:83]
ds_read_b64_tr_b16 a[102:103], v18 offset:47104
v_mfma_f32_16x16x32_bf16 v[80:83], a[224:227], a[136:139], v[80:83]
v_mfma_f32_16x16x32_bf16 v[96:99], a[224:227], a[144:147], v[96:99]
buffer_load_dword v61, v56, s[36:39], s90 offen
v_mfma_f32_16x16x32_bf16 v[96:99], a[228:231], a[148:151], v[96:99]
s_sub_u32 s90, s90, 1835008
ds_read_b64_tr_b16 a[104:105], v18 offset:49152
v_mfma_f32_16x16x32_bf16 v[96:99], a[232:235], a[176:179], v[96:99]
ds_read_b64_tr_b16 a[106:107], v18 offset:51200
v_mfma_f32_16x16x32_bf16 v[96:99], a[236:239], a[180:183], v[96:99]
v_mfma_f32_16x16x32_bf16 v[112:115], a[236:239], a[188:191], v[112:115]
ds_read_b64_tr_b16 a[108:109], v18 offset:53248
v_mfma_f32_16x16x32_bf16 v[112:115], a[232:235], a[184:187], v[112:115]
v_mfma_f32_16x16x32_bf16 v[112:115], a[228:231], a[156:159], v[112:115]
ds_read_b64_tr_b16 a[110:111], v18 offset:55296
v_mfma_f32_16x16x32_bf16 v[112:115], a[224:227], a[152:155], v[112:115]
s_waitcnt lgkmcnt(8)
v_mfma_f32_16x16x32_bf16 v[116:119], a[240:243], a[152:155], v[116:119]
ds_read_b64_tr_b16 a[224:225], v19 offset:40960
v_mfma_f32_16x16x32_bf16 v[116:119], a[244:247], a[156:159], v[116:119]
v_mfma_f32_16x16x32_bf16 v[116:119], a[248:251], a[184:187], v[116:119]
ds_read_b64_tr_b16 a[226:227], v19 offset:43008
v_mfma_f32_16x16x32_bf16 v[116:119], a[252:255], a[188:191], v[116:119]
buffer_load_dwordx4 v43, s[12:15], s56 offen offset:1024 lds
v_mfma_f32_16x16x32_bf16 v[100:103], a[252:255], a[180:183], v[100:103]
s_add_u32 s54, s53, 81920
ds_read_b64_tr_b16 a[228:229], v19 offset:45056
v_mfma_f32_16x16x32_bf16 v[100:103], a[248:251], a[176:179], v[100:103]
v_mfma_f32_16x16x32_bf16 v[100:103], a[244:247], a[148:151], v[100:103]
ds_read_b64_tr_b16 a[230:231], v19 offset:47104
v_mfma_f32_16x16x32_bf16 v[100:103], a[240:243], a[144:147], v[100:103]
v_mfma_f32_16x16x32_bf16 v[84:87], a[240:243], a[136:139], v[84:87]
ds_read_b64_tr_b16 a[232:233], v19 offset:49152
v_mfma_f32_16x16x32_bf16 v[84:87], a[244:247], a[140:143], v[84:87]
v_mfma_f32_16x16x32_bf16 v[84:87], a[248:251], a[168:171], v[84:87]
ds_read_b64_tr_b16 a[234:235], v19 offset:51200
v_mfma_f32_16x16x32_bf16 v[84:87], a[252:255], a[172:175], v[84:87]
v_mfma_f32_16x16x32_bf16 v[68:71], a[252:255], a[164:167], v[68:71]
ds_read_b64_tr_b16 a[236:237], v19 offset:53248
v_mfma_f32_16x16x32_bf16 v[68:71], a[248:251], a[160:163], v[68:71]
v_mfma_f32_16x16x32_bf16 v[68:71], a[244:247], a[132:135], v[68:71]
buffer_load_dwordx4 a[0:3], v1, s[24:27], s54 offen offset:0 sc1
v_mfma_f32_16x16x32_bf16 v[68:71], a[240:243], a[128:131], v[68:71]
s_waitcnt lgkmcnt(7)
ds_read_b64_tr_b16 a[238:239], v19 offset:55296
v_mfma_f32_16x16x32_bf16 v[128:131], a[96:99], a[128:131], v[128:131]
ds_read_b64_tr_b16 a[240:241], v16 offset:57344
v_mfma_f32_16x16x32_bf16 v[128:131], a[100:103], a[132:135], v[128:131]
v_mfma_f32_16x16x32_bf16 v[128:131], a[104:107], a[160:163], v[128:131]
ds_read_b64_tr_b16 a[242:243], v16 offset:59392
v_mfma_f32_16x16x32_bf16 v[128:131], a[108:111], a[164:167], v[128:131]
v_mfma_f32_16x16x32_bf16 v[144:147], a[108:111], a[172:175], v[144:147]
buffer_load_dwordx4 a[4:7], v1, s[24:27], s54 offen offset:1024 sc1
v_mfma_f32_16x16x32_bf16 v[144:147], a[104:107], a[168:171], v[144:147]
ds_read_b64_tr_b16 a[244:245], v16 offset:61440
v_mfma_f32_16x16x32_bf16 v[144:147], a[100:103], a[140:143], v[144:147]
ds_read_b64_tr_b16 a[246:247], v16 offset:63488
v_mfma_f32_16x16x32_bf16 v[144:147], a[96:99], a[136:139], v[144:147]
v_mfma_f32_16x16x32_bf16 v[160:163], a[96:99], a[144:147], v[160:163]
ds_read_b64_tr_b16 a[248:249], v20 offset:0
v_mfma_f32_16x16x32_bf16 v[160:163], a[100:103], a[148:151], v[160:163]
buffer_load_dwordx4 a[8:11], v1, s[24:27], s54 offen offset:2048 sc1
v_mfma_f32_16x16x32_bf16 v[160:163], a[104:107], a[176:179], v[160:163]
ds_read_b64_tr_b16 a[250:251], v20 offset:2048
v_mfma_f32_16x16x32_bf16 v[160:163], a[108:111], a[180:183], v[160:163]
v_mfma_f32_16x16x32_bf16 v[176:179], a[108:111], a[188:191], v[176:179]
ds_read_b64_tr_b16 a[252:253], v20 offset:4096
v_mfma_f32_16x16x32_bf16 v[176:179], a[104:107], a[184:187], v[176:179]
v_mfma_f32_16x16x32_bf16 v[176:179], a[100:103], a[156:159], v[176:179]
ds_read_b64_tr_b16 a[254:255], v20 offset:6144
v_mfma_f32_16x16x32_bf16 v[176:179], a[96:99], a[152:155], v[176:179]
s_waitcnt lgkmcnt(8)
buffer_load_dwordx4 a[12:15], v1, s[24:27], s54 offen offset:3072 sc1
v_mfma_f32_16x16x32_bf16 v[180:183], a[224:227], a[152:155], v[180:183]
ds_read_b64_tr_b16 a[96:97], v17 offset:57344
v_mfma_f32_16x16x32_bf16 v[180:183], a[228:231], a[156:159], v[180:183]
v_mfma_f32_16x16x32_bf16 v[180:183], a[232:235], a[184:187], v[180:183]
ds_read_b64_tr_b16 a[98:99], v17 offset:59392
v_mfma_f32_16x16x32_bf16 v[180:183], a[236:239], a[188:191], v[180:183]
v_mfma_f32_16x16x32_bf16 v[164:167], a[236:239], a[180:183], v[164:167]
buffer_load_dwordx4 a[16:19], v2, s[24:27], s54 offen offset:0 sc1
v_mfma_f32_16x16x32_bf16 v[164:167], a[232:235], a[176:179], v[164:167]
ds_read_b64_tr_b16 a[100:101], v17 offset:61440
v_mfma_f32_16x16x32_bf16 v[164:167], a[228:231], a[148:151], v[164:167]
ds_read_b64_tr_b16 a[102:103], v17 offset:63488
v_mfma_f32_16x16x32_bf16 v[164:167], a[224:227], a[144:147], v[164:167]
v_mfma_f32_16x16x32_bf16 v[148:151], a[224:227], a[136:139], v[148:151]
ds_read_b64_tr_b16 a[104:105], v21 offset:0
v_mfma_f32_16x16x32_bf16 v[148:151], a[228:231], a[140:143], v[148:151]
v_mfma_f32_16x16x32_bf16 v[148:151], a[232:235], a[168:171], v[148:151]
buffer_load_dwordx4 a[20:23], v2, s[24:27], s54 offen offset:1024 sc1
v_mfma_f32_16x16x32_bf16 v[148:151], a[236:239], a[172:175], v[148:151]
ds_read_b64_tr_b16 a[106:107], v21 offset:2048
v_mfma_f32_16x16x32_bf16 v[132:135], a[236:239], a[164:167], v[132:135]
ds_read_b64_tr_b16 a[108:109], v21 offset:4096
v_mfma_f32_16x16x32_bf16 v[132:135], a[232:235], a[160:163], v[132:135]
v_mfma_f32_16x16x32_bf16 v[132:135], a[228:231], a[132:135], v[132:135]
ds_read_b64_tr_b16 a[110:111], v21 offset:6144
v_mfma_f32_16x16x32_bf16 v[132:135], a[224:227], a[128:131], v[132:135]
s_waitcnt lgkmcnt(8)
buffer_load_dwordx4 a[24:27], v2, s[24:27], s54 offen offset:2048 sc1
v_mfma_f32_16x16x32_bf16 v[72:75], a[240:243], a[128:131], v[72:75]
ds_read_b64_tr_b16 a[224:225], v18 offset:57344
v_mfma_f32_16x16x32_bf16 v[72:75], a[244:247], a[132:135], v[72:75]
v_mfma_f32_16x16x32_bf16 v[72:75], a[248:251], a[160:163], v[72:75]
ds_read_b64_tr_b16 a[226:227], v18 offset:59392
v_mfma_f32_16x16x32_bf16 v[72:75], a[252:255], a[164:167], v[72:75]
v_mfma_f32_16x16x32_bf16 v[88:91], a[252:255], a[172:175], v[88:91]
ds_read_b64_tr_b16 a[228:229], v18 offset:61440
v_mfma_f32_16x16x32_bf16 v[88:91], a[248:251], a[168:171], v[88:91]
buffer_load_dwordx4 a[28:31], v2, s[24:27], s54 offen offset:3072 sc1
v_mfma_f32_16x16x32_bf16 v[88:91], a[244:247], a[140:143], v[88:91]
s_add_u32 s54, s53, 90112
ds_read_b64_tr_b16 a[230:231], v18 offset:63488
v_mfma_f32_16x16x32_bf16 v[88:91], a[240:243], a[136:139], v[88:91]
v_mfma_f32_16x16x32_bf16 v[104:107], a[240:243], a[144:147], v[104:107]
ds_read_b64_tr_b16 a[232:233], v22 offset:0
v_mfma_f32_16x16x32_bf16 v[104:107], a[244:247], a[148:151], v[104:107]
v_mfma_f32_16x16x32_bf16 v[104:107], a[248:251], a[176:179], v[104:107]
buffer_load_dwordx4 a[32:35], v1, s[24:27], s54 offen offset:0 sc1
v_mfma_f32_16x16x32_bf16 v[104:107], a[252:255], a[180:183], v[104:107]
ds_read_b64_tr_b16 a[234:235], v22 offset:2048
v_mfma_f32_16x16x32_bf16 v[120:123], a[252:255], a[188:191], v[120:123]
ds_read_b64_tr_b16 a[236:237], v22 offset:4096
v_mfma_f32_16x16x32_bf16 v[120:123], a[248:251], a[184:187], v[120:123]
v_mfma_f32_16x16x32_bf16 v[120:123], a[244:247], a[156:159], v[120:123]
ds_read_b64_tr_b16 a[238:239], v22 offset:6144
v_mfma_f32_16x16x32_bf16 v[120:123], a[240:243], a[152:155], v[120:123]
s_waitcnt lgkmcnt(8)
v_mfma_f32_16x16x32_bf16 v[124:127], a[96:99], a[152:155], v[124:127]
buffer_load_dwordx4 a[36:39], v1, s[24:27], s54 offen offset:1024 sc1
v_mfma_f32_16x16x32_bf16 v[124:127], a[100:103], a[156:159], v[124:127]
ds_read_b64_tr_b16 a[240:241], v19 offset:57344
v_mfma_f32_16x16x32_bf16 v[124:127], a[104:107], a[184:187], v[124:127]
ds_read_b64_tr_b16 a[242:243], v19 offset:59392
v_mfma_f32_16x16x32_bf16 v[124:127], a[108:111], a[188:191], v[124:127]
v_mfma_f32_16x16x32_bf16 v[108:111], a[108:111], a[180:183], v[108:111]
ds_read_b64_tr_b16 a[244:245], v19 offset:61440
v_mfma_f32_16x16x32_bf16 v[108:111], a[104:107], a[176:179], v[108:111]
buffer_load_dwordx4 a[40:43], v1, s[24:27], s54 offen offset:2048 sc1
v_mfma_f32_16x16x32_bf16 v[108:111], a[100:103], a[148:151], v[108:111]
ds_read_b64_tr_b16 a[246:247], v19 offset:63488
v_mfma_f32_16x16x32_bf16 v[108:111], a[96:99], a[144:147], v[108:111]
v_mfma_f32_16x16x32_bf16 v[92:95], a[96:99], a[136:139], v[92:95]
ds_read_b64_tr_b16 a[248:249], v23 offset:0
v_mfma_f32_16x16x32_bf16 v[92:95], a[100:103], a[140:143], v[92:95]
v_mfma_f32_16x16x32_bf16 v[92:95], a[104:107], a[168:171], v[92:95]
ds_read_b64_tr_b16 a[250:251], v23 offset:2048
v_mfma_f32_16x16x32_bf16 v[92:95], a[108:111], a[172:175], v[92:95]
buffer_load_dwordx4 a[44:47], v1, s[24:27], s54 offen offset:3072 sc1
v_mfma_f32_16x16x32_bf16 v[76:79], a[108:111], a[164:167], v[76:79]
ds_read_b64_tr_b16 a[252:253], v23 offset:4096
v_mfma_f32_16x16x32_bf16 v[76:79], a[104:107], a[160:163], v[76:79]
v_mfma_f32_16x16x32_bf16 v[76:79], a[100:103], a[132:135], v[76:79]
ds_read_b64_tr_b16 a[254:255], v23 offset:6144
v_mfma_f32_16x16x32_bf16 v[76:79], a[96:99], a[128:131], v[76:79]
s_waitcnt lgkmcnt(8)
v_mfma_f32_16x16x32_bf16 v[136:139], a[224:227], a[128:131], v[136:139]
buffer_load_dwordx4 a[48:51], v2, s[24:27], s54 offen offset:0 sc1
v_mfma_f32_16x16x32_bf16 v[136:139], a[228:231], a[132:135], v[136:139]
ds_read_b64_tr_b16 a[96:97], v6 offset:8192
v_mfma_f32_16x16x32_bf16 v[136:139], a[232:235], a[160:163], v[136:139]
ds_read_b64_tr_b16 a[98:99], v6 offset:10240
v_mfma_f32_16x16x32_bf16 v[136:139], a[236:239], a[164:167], v[136:139]
v_mfma_f32_16x16x32_bf16 v[152:155], a[236:239], a[172:175], v[152:155]
ds_read_b64_tr_b16 a[100:101], v6 offset:12288
v_mfma_f32_16x16x32_bf16 v[152:155], a[232:235], a[168:171], v[152:155]
v_mfma_f32_16x16x32_bf16 v[152:155], a[228:231], a[140:143], v[152:155]
buffer_load_dword v61, v56, s[36:39], s90 offen
v_mfma_f32_16x16x32_bf16 v[152:155], a[224:227], a[136:139], v[152:155]
s_sub_u32 s90, s90, 1835008
ds_read_b64_tr_b16 a[102:103], v6 offset:14336
v_mfma_f32_16x16x32_bf16 v[168:171], a[224:227], a[144:147], v[168:171]
ds_read_b64_tr_b16 a[104:105], v6 offset:16384
v_mfma_f32_16x16x32_bf16 v[168:171], a[228:231], a[148:151], v[168:171]
v_mfma_f32_16x16x32_bf16 v[168:171], a[232:235], a[176:179], v[168:171]
ds_read_b64_tr_b16 a[106:107], v6 offset:18432
v_mfma_f32_16x16x32_bf16 v[168:171], a[236:239], a[180:183], v[168:171]
v_mfma_f32_16x16x32_bf16 v[184:187], a[236:239], a[188:191], v[184:187]
ds_read_b64_tr_b16 a[108:109], v6 offset:20480
v_mfma_f32_16x16x32_bf16 v[184:187], a[232:235], a[184:187], v[184:187]
v_mfma_f32_16x16x32_bf16 v[184:187], a[228:231], a[156:159], v[184:187]
ds_read_b64_tr_b16 a[110:111], v6 offset:22528
v_mfma_f32_16x16x32_bf16 v[184:187], a[224:227], a[152:155], v[184:187]
s_waitcnt lgkmcnt(8)
v_mfma_f32_16x16x32_bf16 v[188:191], a[240:243], a[152:155], v[188:191]
ds_read_b64_tr_b16 a[224:225], v7 offset:8192
v_mfma_f32_16x16x32_bf16 v[188:191], a[244:247], a[156:159], v[188:191]
buffer_load_dwordx4 a[52:55], v2, s[24:27], s54 offen offset:1024 sc1
v_mfma_f32_16x16x32_bf16 v[188:191], a[248:251], a[184:187], v[188:191]
ds_read_b64_tr_b16 a[226:227], v7 offset:10240
v_mfma_f32_16x16x32_bf16 v[188:191], a[252:255], a[188:191], v[188:191]
v_mfma_f32_16x16x32_bf16 v[172:175], a[252:255], a[180:183], v[172:175]
ds_read_b64_tr_b16 a[228:229], v7 offset:12288
v_mfma_f32_16x16x32_bf16 v[172:175], a[248:251], a[176:179], v[172:175]
v_mfma_f32_16x16x32_bf16 v[172:175], a[244:247], a[148:151], v[172:175]
buffer_load_dwordx4 a[56:59], v2, s[24:27], s54 offen offset:2048 sc1
v_mfma_f32_16x16x32_bf16 v[172:175], a[240:243], a[144:147], v[172:175]
ds_read_b64_tr_b16 a[230:231], v7 offset:14336
v_mfma_f32_16x16x32_bf16 v[156:159], a[240:243], a[136:139], v[156:159]
ds_read_b64_tr_b16 a[232:233], v7 offset:16384
v_mfma_f32_16x16x32_bf16 v[156:159], a[244:247], a[140:143], v[156:159]
v_mfma_f32_16x16x32_bf16 v[156:159], a[248:251], a[168:171], v[156:159]
ds_read_b64_tr_b16 a[234:235], v7 offset:18432
v_mfma_f32_16x16x32_bf16 v[156:159], a[252:255], a[172:175], v[156:159]
v_mfma_f32_16x16x32_bf16 v[140:143], a[252:255], a[164:167], v[140:143]
buffer_load_dwordx4 a[60:63], v2, s[24:27], s54 offen offset:3072 sc1
v_mfma_f32_16x16x32_bf16 v[140:143], a[248:251], a[160:163], v[140:143]
s_mov_b32 s55, 5505024
ds_read_b64_tr_b16 a[236:237], v7 offset:20480
s_add_u32 m0, s52, 139264
v_mfma_f32_16x16x32_bf16 v[140:143], a[244:247], a[132:135], v[140:143]
ds_read_b64_tr_b16 a[238:239], v7 offset:22528
v_mfma_f32_16x16x32_bf16 v[140:143], a[240:243], a[128:131], v[140:143]
s_waitcnt lgkmcnt(8)
v_mfma_f32_16x16x32_bf16 v[192:195], a[96:99], a[128:131], v[192:195]
ds_read_b64_tr_b16 a[240:241], v6 offset:9216
v_mfma_f32_16x16x32_bf16 v[192:195], a[100:103], a[132:135], v[192:195]
buffer_load_dwordx4 v40, s[16:19], s55 offen offset:0 lds
v_mfma_f32_16x16x32_bf16 v[192:195], a[104:107], a[160:163], v[192:195]
ds_read_b64_tr_b16 a[242:243], v6 offset:11264
v_mfma_f32_16x16x32_bf16 v[192:195], a[108:111], a[164:167], v[192:195]
v_mfma_f32_16x16x32_bf16 v[200:203], a[108:111], a[172:175], v[200:203]
ds_read_b64_tr_b16 a[244:245], v6 offset:13312
v_mfma_f32_16x16x32_bf16 v[200:203], a[104:107], a[168:171], v[200:203]
v_mfma_f32_16x16x32_bf16 v[200:203], a[100:103], a[140:143], v[200:203]
ds_read_b64_tr_b16 a[246:247], v6 offset:15360
v_mfma_f32_16x16x32_bf16 v[200:203], a[96:99], a[136:139], v[200:203]
buffer_load_dwordx4 v41, s[16:19], s55 offen offset:1024 lds
v_mfma_f32_16x16x32_bf16 v[208:211], a[96:99], a[144:147], v[208:211]
s_mov_b32 s55, 5963776
ds_read_b64_tr_b16 a[248:249], v6 offset:17408
s_add_u32 m0, s52, 147456
v_mfma_f32_16x16x32_bf16 v[208:211], a[100:103], a[148:151], v[208:211]
v_mfma_f32_16x16x32_bf16 v[208:211], a[104:107], a[176:179], v[208:211]
ds_read_b64_tr_b16 a[250:251], v6 offset:19456
v_mfma_f32_16x16x32_bf16 v[208:211], a[108:111], a[180:183], v[208:211]
v_mfma_f32_16x16x32_bf16 v[216:219], a[108:111], a[188:191], v[216:219]
buffer_load_dwordx4 v40, s[16:19], s55 offen offset:0 lds
v_mfma_f32_16x16x32_bf16 v[216:219], a[104:107], a[184:187], v[216:219]
ds_read_b64_tr_b16 a[252:253], v6 offset:21504
v_mfma_f32_16x16x32_bf16 v[216:219], a[100:103], a[156:159], v[216:219]
ds_read_b64_tr_b16 a[254:255], v6 offset:23552
v_mfma_f32_16x16x32_bf16 v[216:219], a[96:99], a[152:155], v[216:219]
s_waitcnt lgkmcnt(8)
v_mfma_f32_16x16x32_bf16 v[220:223], a[224:227], a[152:155], v[220:223]
ds_read_b64_tr_b16 a[96:97], v7 offset:9216
v_mfma_f32_16x16x32_bf16 v[220:223], a[228:231], a[156:159], v[220:223]
s_load_dword s101, s[92:93], 16376
v_mfma_f32_16x16x32_bf16 v[220:223], a[232:235], a[184:187], v[220:223]
buffer_load_dwordx4 v41, s[16:19], s55 offen offset:1024 lds
v_mfma_f32_16x16x32_bf16 v[220:223], a[236:239], a[188:191], v[220:223]
s_mov_b32 s55, 5505024
ds_read_b64_tr_b16 a[98:99], v7 offset:11264
s_add_u32 m0, s52, 0
v_mfma_f32_16x16x32_bf16 v[212:215], a[236:239], a[180:183], v[212:215]
ds_read_b64_tr_b16 a[100:101], v7 offset:13312
v_mfma_f32_16x16x32_bf16 v[212:215], a[232:235], a[176:179], v[212:215]
v_mfma_f32_16x16x32_bf16 v[212:215], a[228:231], a[148:151], v[212:215]
ds_read_b64_tr_b16 a[102:103], v7 offset:15360
v_mfma_f32_16x16x32_bf16 v[212:215], a[224:227], a[144:147], v[212:215]
buffer_load_dwordx4 v40, s[20:23], s55 offen offset:0 lds
v_mfma_f32_16x16x32_bf16 v[204:207], a[224:227], a[136:139], v[204:207]
ds_read_b64_tr_b16 a[104:105], v7 offset:17408
v_mfma_f32_16x16x32_bf16 v[204:207], a[228:231], a[140:143], v[204:207]
v_mfma_f32_16x16x32_bf16 v[204:207], a[232:235], a[168:171], v[204:207]
ds_read_b64_tr_b16 a[106:107], v7 offset:19456
v_mfma_f32_16x16x32_bf16 v[204:207], a[236:239], a[172:175], v[204:207]
v_mfma_f32_16x16x32_bf16 v[196:199], a[236:239], a[164:167], v[196:199]
ds_read_b64_tr_b16 a[108:109], v7 offset:21504
v_mfma_f32_16x16x32_bf16 v[196:199], a[232:235], a[160:163], v[196:199]
buffer_load_dwordx4 v41, s[20:23], s55 offen offset:1024 lds
v_mfma_f32_16x16x32_bf16 v[196:199], a[228:231], a[132:135], v[196:199]
s_mov_b32 s55, 5963776
ds_read_b64_tr_b16 a[110:111], v7 offset:23552
s_add_u32 m0, s52, 8192
v_mfma_f32_16x16x32_bf16 v[196:199], a[224:227], a[128:131], v[196:199]
s_waitcnt vmcnt(23) lgkmcnt(8)
s_barrier
v_mfma_f32_16x16x32_bf16 v[224:227], a[128:131], a[240:243], v[224:227]
ds_read_b64_tr_b16 a[224:225], v20 offset:24576
v_mfma_f32_16x16x32_bf16 v[224:227], a[132:135], a[244:247], v[224:227]
v_mfma_f32_16x16x32_bf16 v[224:227], a[160:163], a[248:251], v[224:227]
buffer_load_dwordx4 v40, s[20:23], s55 offen offset:0 lds
v_mfma_f32_16x16x32_bf16 v[224:227], a[164:167], a[252:255], v[224:227]
ds_read_b64_tr_b16 a[226:227], v20 offset:26624
v_mfma_f32_16x16x32_bf16 v[228:231], a[172:175], a[252:255], v[228:231]
ds_read_b64_tr_b16 a[228:229], v20 offset:28672
v_mfma_f32_16x16x32_bf16 v[228:231], a[168:171], a[248:251], v[228:231]
v_mfma_f32_16x16x32_bf16 v[228:231], a[140:143], a[244:247], v[228:231]
ds_read_b64_tr_b16 a[230:231], v20 offset:30720
v_mfma_f32_16x16x32_bf16 v[228:231], a[136:139], a[240:243], v[228:231]
buffer_load_dwordx4 v41, s[20:23], s55 offen offset:1024 lds
v_mfma_f32_16x16x32_bf16 v[232:235], a[144:147], a[240:243], v[232:235]
s_mov_b32 s56, 4718592
ds_read_b64_tr_b16 a[232:233], v20 offset:32768
s_add_u32 m0, s52, 16384
v_mfma_f32_16x16x32_bf16 v[232:235], a[148:151], a[244:247], v[232:235]
v_mfma_f32_16x16x32_bf16 v[232:235], a[176:179], a[248:251], v[232:235]
ds_read_b64_tr_b16 a[234:235], v20 offset:34816
v_mfma_f32_16x16x32_bf16 v[232:235], a[180:183], a[252:255], v[232:235]
v_mfma_f32_16x16x32_bf16 v[236:239], a[188:191], a[252:255], v[236:239]
ds_read_b64_tr_b16 a[236:237], v20 offset:36864
v_mfma_f32_16x16x32_bf16 v[236:239], a[184:187], a[248:251], v[236:239]
buffer_load_dwordx4 v42, s[12:15], s56 offen offset:0 lds
v_mfma_f32_16x16x32_bf16 v[236:239], a[156:159], a[244:247], v[236:239]
ds_read_b64_tr_b16 a[238:239], v20 offset:38912
v_mfma_f32_16x16x32_bf16 v[236:239], a[152:155], a[240:243], v[236:239]
s_waitcnt lgkmcnt(8)
v_mfma_f32_16x16x32_bf16 v[252:255], a[152:155], a[96:99], v[252:255]
ds_read_b64_tr_b16 a[240:241], v21 offset:24576
v_mfma_f32_16x16x32_bf16 v[252:255], a[156:159], a[100:103], v[252:255]
v_mfma_f32_16x16x32_bf16 v[252:255], a[184:187], a[104:107], v[252:255]
ds_read_b64_tr_b16 a[242:243], v21 offset:26624
v_mfma_f32_16x16x32_bf16 v[252:255], a[188:191], a[108:111], v[252:255]
v_mfma_f32_16x16x32_bf16 v[248:251], a[180:183], a[108:111], v[248:251]
ds_read_b64_tr_b16 a[244:245], v21 offset:28672
v_mfma_f32_16x16x32_bf16 v[248:251], a[176:179], a[104:107], v[248:251]
v_mfma_f32_16x16x32_bf16 v[248:251], a[148:151], a[100:103], v[248:251]
ds_read_b64_tr_b16 a[246:247], v21 offset:30720
v_mfma_f32_16x16x32_bf16 v[248:251], a[144:147], a[96:99], v[248:251]
v_mfma_f32_16x16x32_bf16 v[244:247], a[136:139], a[96:99], v[244:247]
buffer_load_dwordx4 v43, s[12:15], s56 offen offset:1024 lds
v_mfma_f32_16x16x32_bf16 v[244:247], a[140:143], a[100:103], v[244:247]
s_mov_b32 s56, 5111808
ds_read_b64_tr_b16 a[248:249], v21 offset:32768
s_add_u32 m0, s52, 24576
v_mfma_f32_16x16x32_bf16 v[244:247], a[168:171], a[104:107], v[244:247]
ds_read_b64_tr_b16 a[250:251], v21 offset:34816
v_mfma_f32_16x16x32_bf16 v[244:247], a[172:175], a[108:111], v[244:247]
v_mfma_f32_16x16x32_bf16 v[240:243], a[164:167], a[108:111], v[240:243]
ds_read_b64_tr_b16 a[252:253], v21 offset:36864
v_mfma_f32_16x16x32_bf16 v[240:243], a[160:163], a[104:107], v[240:243]
v_mfma_f32_16x16x32_bf16 v[240:243], a[132:135], a[100:103], v[240:243]
ds_read_b64_tr_b16 a[254:255], v21 offset:38912
s_lshl2_add_u32 s90, s2, s32
v_mfma_f32_16x16x32_bf16 v[240:243], a[128:131], a[96:99], v[240:243]
s_waitcnt vmcnt(10) lgkmcnt(8)
s_mul_i32 s90, s90, 2048
v_mfma_f32_16x16x32_bf16 v[64:67], a[224:227], a[0:3], v[64:67]
ds_read_b64_tr_b16 a[96:97], v22 offset:24576
v_mfma_f32_16x16x32_bf16 v[64:67], a[228:231], a[4:7], v[64:67]
v_mfma_f32_16x16x32_bf16 v[64:67], a[232:235], a[32:35], v[64:67]
ds_read_b64_tr_b16 a[98:99], v22 offset:26624
v_mfma_f32_16x16x32_bf16 v[64:67], a[236:239], a[36:39], v[64:67]
buffer_load_dword v61, v57, s[40:43], s90 offen
v_mfma_f32_16x16x32_bf16 v[80:83], a[236:239], a[44:47], v[80:83]
s_add_u32 s90, s90, 2097152
ds_read_b64_tr_b16 a[100:101], v22 offset:28672
v_mfma_f32_16x16x32_bf16 v[80:83], a[232:235], a[40:43], v[80:83]
v_mfma_f32_16x16x32_bf16 v[80:83], a[228:231], a[12:15], v[80:83]
ds_read_b64_tr_b16 a[102:103], v22 offset:30720
v_mfma_f32_16x16x32_bf16 v[80:83], a[224:227], a[8:11], v[80:83]
v_mfma_f32_16x16x32_bf16 v[96:99], a[224:227], a[16:19], v[96:99]
ds_read_b64_tr_b16 a[104:105], v22 offset:32768
v_mfma_f32_16x16x32_bf16 v[96:99], a[228:231], a[20:23], v[96:99]
v_mfma_f32_16x16x32_bf16 v[96:99], a[232:235], a[48:51], v[96:99]
ds_read_b64_tr_b16 a[106:107], v22 offset:34816
v_mfma_f32_16x16x32_bf16 v[96:99], a[236:239], a[52:55], v[96:99]
v_mfma_f32_16x16x32_bf16 v[112:115], a[236:239], a[60:63], v[112:115]
ds_read_b64_tr_b16 a[108:109], v22 offset:36864
v_mfma_f32_16x16x32_bf16 v[112:115], a[232:235], a[56:59], v[112:115]
v_mfma_f32_16x16x32_bf16 v[112:115], a[228:231], a[28:31], v[112:115]
buffer_load_dwordx4 v42, s[12:15], s56 offen offset:0 lds
v_mfma_f32_16x16x32_bf16 v[112:115], a[224:227], a[24:27], v[112:115]
s_waitcnt lgkmcnt(7)
ds_read_b64_tr_b16 a[110:111], v22 offset:38912
v_mfma_f32_16x16x32_bf16 v[116:119], a[240:243], a[24:27], v[116:119]
ds_read_b64_tr_b16 a[224:225], v23 offset:24576
v_mfma_f32_16x16x32_bf16 v[116:119], a[244:247], a[28:31], v[116:119]
v_mfma_f32_16x16x32_bf16 v[116:119], a[248:251], a[56:59], v[116:119]
ds_read_b64_tr_b16 a[226:227], v23 offset:26624
v_mfma_f32_16x16x32_bf16 v[116:119], a[252:255], a[60:63], v[116:119]
v_mfma_f32_16x16x32_bf16 v[100:103], a[252:255], a[52:55], v[100:103]
ds_read_b64_tr_b16 a[228:229], v23 offset:28672
v_mfma_f32_16x16x32_bf16 v[100:103], a[248:251], a[48:51], v[100:103]
v_mfma_f32_16x16x32_bf16 v[100:103], a[244:247], a[20:23], v[100:103]
ds_read_b64_tr_b16 a[230:231], v23 offset:30720
v_mfma_f32_16x16x32_bf16 v[100:103], a[240:243], a[16:19], v[100:103]
v_mfma_f32_16x16x32_bf16 v[84:87], a[240:243], a[8:11], v[84:87]
ds_read_b64_tr_b16 a[232:233], v23 offset:32768
v_mfma_f32_16x16x32_bf16 v[84:87], a[244:247], a[12:15], v[84:87]
buffer_load_dwordx4 v43, s[12:15], s56 offen offset:1024 lds
v_mfma_f32_16x16x32_bf16 v[84:87], a[248:251], a[40:43], v[84:87]
s_add_u32 s54, s53, 98304
ds_read_b64_tr_b16 a[234:235], v23 offset:34816
v_mfma_f32_16x16x32_bf16 v[84:87], a[252:255], a[44:47], v[84:87]
v_mfma_f32_16x16x32_bf16 v[68:71], a[252:255], a[36:39], v[68:71]
ds_read_b64_tr_b16 a[236:237], v23 offset:36864
v_mfma_f32_16x16x32_bf16 v[68:71], a[248:251], a[32:35], v[68:71]
v_mfma_f32_16x16x32_bf16 v[68:71], a[244:247], a[4:7], v[68:71]
ds_read_b64_tr_b16 a[238:239], v23 offset:38912
v_mfma_f32_16x16x32_bf16 v[68:71], a[240:243], a[0:3], v[68:71]
s_waitcnt lgkmcnt(8)
v_mfma_f32_16x16x32_bf16 v[128:131], a[96:99], a[0:3], v[128:131]
ds_read_b64_tr_b16 a[240:241], v20 offset:40960
v_mfma_f32_16x16x32_bf16 v[128:131], a[100:103], a[4:7], v[128:131]
v_mfma_f32_16x16x32_bf16 v[128:131], a[104:107], a[32:35], v[128:131]
ds_read_b64_tr_b16 a[242:243], v20 offset:43008
v_mfma_f32_16x16x32_bf16 v[128:131], a[108:111], a[36:39], v[128:131]
v_mfma_f32_16x16x32_bf16 v[144:147], a[108:111], a[44:47], v[144:147]
buffer_load_dwordx4 a[64:67], v1, s[24:27], s54 offen offset:0 sc1
v_mfma_f32_16x16x32_bf16 v[144:147], a[104:107], a[40:43], v[144:147]
ds_read_b64_tr_b16 a[244:245], v20 offset:45056
v_mfma_f32_16x16x32_bf16 v[144:147], a[100:103], a[12:15], v[144:147]
ds_read_b64_tr_b16 a[246:247], v20 offset:47104
v_mfma_f32_16x16x32_bf16 v[144:147], a[96:99], a[8:11], v[144:147]
v_mfma_f32_16x16x32_bf16 v[160:163], a[96:99], a[16:19], v[160:163]
ds_read_b64_tr_b16 a[248:249], v20 offset:49152
v_mfma_f32_16x16x32_bf16 v[160:163], a[100:103], a[20:23], v[160:163]
buffer_load_dwordx4 a[68:71], v1, s[24:27], s54 offen offset:1024 sc1
v_mfma_f32_16x16x32_bf16 v[160:163], a[104:107], a[48:51], v[160:163]
ds_read_b64_tr_b16 a[250:251], v20 offset:51200
v_mfma_f32_16x16x32_bf16 v[160:163], a[108:111], a[52:55], v[160:163]
v_mfma_f32_16x16x32_bf16 v[176:179], a[108:111], a[60:63], v[176:179]
ds_read_b64_tr_b16 a[252:253], v20 offset:53248
v_mfma_f32_16x16x32_bf16 v[176:179], a[104:107], a[56:59], v[176:179]
v_mfma_f32_16x16x32_bf16 v[176:179], a[100:103], a[28:31], v[176:179]
ds_read_b64_tr_b16 a[254:255], v20 offset:55296
v_mfma_f32_16x16x32_bf16 v[176:179], a[96:99], a[24:27], v[176:179]
s_waitcnt lgkmcnt(8)
buffer_load_dwordx4 a[72:75], v1, s[24:27], s54 offen offset:2048 sc1
v_mfma_f32_16x16x32_bf16 v[180:183], a[224:227], a[24:27], v[180:183]
ds_read_b64_tr_b16 a[96:97], v21 offset:40960
v_mfma_f32_16x16x32_bf16 v[180:183], a[228:231], a[28:31], v[180:183]
v_mfma_f32_16x16x32_bf16 v[180:183], a[232:235], a[56:59], v[180:183]
ds_read_b64_tr_b16 a[98:99], v21 offset:43008
v_mfma_f32_16x16x32_bf16 v[180:183], a[236:239], a[60:63], v[180:183]
v_mfma_f32_16x16x32_bf16 v[164:167], a[236:239], a[52:55], v[164:167]
buffer_load_dwordx4 a[76:79], v1, s[24:27], s54 offen offset:3072 sc1
v_mfma_f32_16x16x32_bf16 v[164:167], a[232:235], a[48:51], v[164:167]
ds_read_b64_tr_b16 a[100:101], v21 offset:45056
v_mfma_f32_16x16x32_bf16 v[164:167], a[228:231], a[20:23], v[164:167]
ds_read_b64_tr_b16 a[102:103], v21 offset:47104
v_mfma_f32_16x16x32_bf16 v[164:167], a[224:227], a[16:19], v[164:167]
v_mfma_f32_16x16x32_bf16 v[148:151], a[224:227], a[8:11], v[148:151]
ds_read_b64_tr_b16 a[104:105], v21 offset:49152
v_mfma_f32_16x16x32_bf16 v[148:151], a[228:231], a[12:15], v[148:151]
v_mfma_f32_16x16x32_bf16 v[148:151], a[232:235], a[40:43], v[148:151]
buffer_load_dwordx4 a[80:83], v2, s[24:27], s54 offen offset:0 sc1
v_mfma_f32_16x16x32_bf16 v[148:151], a[236:239], a[44:47], v[148:151]
ds_read_b64_tr_b16 a[106:107], v21 offset:51200
v_mfma_f32_16x16x32_bf16 v[132:135], a[236:239], a[36:39], v[132:135]
ds_read_b64_tr_b16 a[108:109], v21 offset:53248
v_mfma_f32_16x16x32_bf16 v[132:135], a[232:235], a[32:35], v[132:135]
v_mfma_f32_16x16x32_bf16 v[132:135], a[228:231], a[4:7], v[132:135]
ds_read_b64_tr_b16 a[110:111], v21 offset:55296
v_mfma_f32_16x16x32_bf16 v[132:135], a[224:227], a[0:3], v[132:135]
s_waitcnt lgkmcnt(8)
buffer_load_dwordx4 a[84:87], v2, s[24:27], s54 offen offset:1024 sc1
v_mfma_f32_16x16x32_bf16 v[72:75], a[240:243], a[0:3], v[72:75]
ds_read_b64_tr_b16 a[224:225], v22 offset:40960
v_mfma_f32_16x16x32_bf16 v[72:75], a[244:247], a[4:7], v[72:75]
v_mfma_f32_16x16x32_bf16 v[72:75], a[248:251], a[32:35], v[72:75]
ds_read_b64_tr_b16 a[226:227], v22 offset:43008
v_mfma_f32_16x16x32_bf16 v[72:75], a[252:255], a[36:39], v[72:75]
v_mfma_f32_16x16x32_bf16 v[88:91], a[252:255], a[44:47], v[88:91]
ds_read_b64_tr_b16 a[228:229], v22 offset:45056
v_mfma_f32_16x16x32_bf16 v[88:91], a[248:251], a[40:43], v[88:91]
buffer_load_dwordx4 a[88:91], v2, s[24:27], s54 offen offset:2048 sc1
v_mfma_f32_16x16x32_bf16 v[88:91], a[244:247], a[12:15], v[88:91]
ds_read_b64_tr_b16 a[230:231], v22 offset:47104
v_mfma_f32_16x16x32_bf16 v[88:91], a[240:243], a[8:11], v[88:91]
v_mfma_f32_16x16x32_bf16 v[104:107], a[240:243], a[16:19], v[104:107]
ds_read_b64_tr_b16 a[232:233], v22 offset:49152
v_mfma_f32_16x16x32_bf16 v[104:107], a[244:247], a[20:23], v[104:107]
v_mfma_f32_16x16x32_bf16 v[104:107], a[248:251], a[48:51], v[104:107]
buffer_load_dwordx4 a[92:95], v2, s[24:27], s54 offen offset:3072 sc1
v_mfma_f32_16x16x32_bf16 v[104:107], a[252:255], a[52:55], v[104:107]
s_add_u32 s54, s53, 106496
ds_read_b64_tr_b16 a[234:235], v22 offset:51200
v_mfma_f32_16x16x32_bf16 v[120:123], a[252:255], a[60:63], v[120:123]
ds_read_b64_tr_b16 a[236:237], v22 offset:53248
v_mfma_f32_16x16x32_bf16 v[120:123], a[248:251], a[56:59], v[120:123]
v_mfma_f32_16x16x32_bf16 v[120:123], a[244:247], a[28:31], v[120:123]
ds_read_b64_tr_b16 a[238:239], v22 offset:55296
v_mfma_f32_16x16x32_bf16 v[120:123], a[240:243], a[24:27], v[120:123]
s_waitcnt lgkmcnt(8)
v_mfma_f32_16x16x32_bf16 v[124:127], a[96:99], a[24:27], v[124:127]
buffer_load_dwordx4 a[128:131], v1, s[24:27], s54 offen offset:0 sc1
v_mfma_f32_16x16x32_bf16 v[124:127], a[100:103], a[28:31], v[124:127]
ds_read_b64_tr_b16 a[240:241], v23 offset:40960
v_mfma_f32_16x16x32_bf16 v[124:127], a[104:107], a[56:59], v[124:127]
ds_read_b64_tr_b16 a[242:243], v23 offset:43008
v_mfma_f32_16x16x32_bf16 v[124:127], a[108:111], a[60:63], v[124:127]
v_mfma_f32_16x16x32_bf16 v[108:111], a[108:111], a[52:55], v[108:111]
ds_read_b64_tr_b16 a[244:245], v23 offset:45056
v_mfma_f32_16x16x32_bf16 v[108:111], a[104:107], a[48:51], v[108:111]
buffer_load_dword v61, v57, s[40:43], s90 offen
v_mfma_f32_16x16x32_bf16 v[108:111], a[100:103], a[20:23], v[108:111]
s_add_u32 s90, s90, 2097152
ds_read_b64_tr_b16 a[246:247], v23 offset:47104
v_mfma_f32_16x16x32_bf16 v[108:111], a[96:99], a[16:19], v[108:111]
v_mfma_f32_16x16x32_bf16 v[92:95], a[96:99], a[8:11], v[92:95]
ds_read_b64_tr_b16 a[248:249], v23 offset:49152
v_mfma_f32_16x16x32_bf16 v[92:95], a[100:103], a[12:15], v[92:95]
v_mfma_f32_16x16x32_bf16 v[92:95], a[104:107], a[40:43], v[92:95]
ds_read_b64_tr_b16 a[250:251], v23 offset:51200
v_mfma_f32_16x16x32_bf16 v[92:95], a[108:111], a[44:47], v[92:95]
v_mfma_f32_16x16x32_bf16 v[76:79], a[108:111], a[36:39], v[76:79]
ds_read_b64_tr_b16 a[252:253], v23 offset:53248
v_mfma_f32_16x16x32_bf16 v[76:79], a[104:107], a[32:35], v[76:79]
v_mfma_f32_16x16x32_bf16 v[76:79], a[100:103], a[4:7], v[76:79]
ds_read_b64_tr_b16 a[254:255], v23 offset:55296
v_mfma_f32_16x16x32_bf16 v[76:79], a[96:99], a[0:3], v[76:79]
s_waitcnt lgkmcnt(8)
v_mfma_f32_16x16x32_bf16 v[136:139], a[224:227], a[0:3], v[136:139]
buffer_load_dwordx4 a[132:135], v1, s[24:27], s54 offen offset:1024 sc1
v_mfma_f32_16x16x32_bf16 v[136:139], a[228:231], a[4:7], v[136:139]
pg_3:
s_cbranch_execz pg_7
ds_read_b64_tr_b16 a[96:97], v6 offset:57344
v_mfma_f32_16x16x32_bf16 v[136:139], a[232:235], a[32:35], v[136:139]
ds_read_b64_tr_b16 a[98:99], v6 offset:59392
v_mfma_f32_16x16x32_bf16 v[136:139], a[236:239], a[36:39], v[136:139]
v_mfma_f32_16x16x32_bf16 v[152:155], a[236:239], a[44:47], v[152:155]
ds_read_b64_tr_b16 a[100:101], v6 offset:61440
v_mfma_f32_16x16x32_bf16 v[152:155], a[232:235], a[40:43], v[152:155]
v_mfma_f32_16x16x32_bf16 v[152:155], a[228:231], a[12:15], v[152:155]
buffer_load_dwordx4 a[136:139], v1, s[24:27], s54 offen offset:2048 sc1
v_mfma_f32_16x16x32_bf16 v[152:155], a[224:227], a[8:11], v[152:155]
ds_read_b64_tr_b16 a[102:103], v6 offset:63488
v_mfma_f32_16x16x32_bf16 v[168:171], a[224:227], a[16:19], v[168:171]
ds_read_b64_tr_b16 a[104:105], v8 offset:0
v_mfma_f32_16x16x32_bf16 v[168:171], a[228:231], a[20:23], v[168:171]
v_mfma_f32_16x16x32_bf16 v[168:171], a[232:235], a[48:51], v[168:171]
ds_read_b64_tr_b16 a[106:107], v8 offset:2048
v_mfma_f32_16x16x32_bf16 v[168:171], a[236:239], a[52:55], v[168:171]
buffer_load_dwordx4 a[140:143], v1, s[24:27], s54 offen offset:3072 sc1
v_mfma_f32_16x16x32_bf16 v[184:187], a[236:239], a[60:63], v[184:187]
ds_read_b64_tr_b16 a[108:109], v8 offset:4096
v_mfma_f32_16x16x32_bf16 v[184:187], a[232:235], a[56:59], v[184:187]
v_mfma_f32_16x16x32_bf16 v[184:187], a[228:231], a[28:31], v[184:187]
ds_read_b64_tr_b16 a[110:111], v8 offset:6144
v_mfma_f32_16x16x32_bf16 v[184:187], a[224:227], a[24:27], v[184:187]
s_waitcnt lgkmcnt(8)
v_mfma_f32_16x16x32_bf16 v[188:191], a[240:243], a[24:27], v[188:191]
ds_read_b64_tr_b16 a[224:225], v7 offset:57344
v_mfma_f32_16x16x32_bf16 v[188:191], a[244:247], a[28:31], v[188:191]
buffer_load_dwordx4 a[144:147], v2, s[24:27], s54 offen offset:0 sc1
v_mfma_f32_16x16x32_bf16 v[188:191], a[248:251], a[56:59], v[188:191]
ds_read_b64_tr_b16 a[226:227], v7 offset:59392
v_mfma_f32_16x16x32_bf16 v[188:191], a[252:255], a[60:63], v[188:191]
v_mfma_f32_16x16x32_bf16 v[172:175], a[252:255], a[52:55], v[172:175]
ds_read_b64_tr_b16 a[228:229], v7 offset:61440
v_mfma_f32_16x16x32_bf16 v[172:175], a[248:251], a[48:51], v[172:175]
v_mfma_f32_16x16x32_bf16 v[172:175], a[244:247], a[20:23], v[172:175]
buffer_load_dwordx4 a[148:151], v2, s[24:27], s54 offen offset:1024 sc1
v_mfma_f32_16x16x32_bf16 v[172:175], a[240:243], a[16:19], v[172:175]
ds_read_b64_tr_b16 a[230:231], v7 offset:63488
v_mfma_f32_16x16x32_bf16 v[156:159], a[240:243], a[8:11], v[156:159]
ds_read_b64_tr_b16 a[232:233], v9 offset:0
v_mfma_f32_16x16x32_bf16 v[156:159], a[244:247], a[12:15], v[156:159]
v_mfma_f32_16x16x32_bf16 v[156:159], a[248:251], a[40:43], v[156:159]
ds_read_b64_tr_b16 a[234:235], v9 offset:2048
v_mfma_f32_16x16x32_bf16 v[156:159], a[252:255], a[44:47], v[156:159]
v_mfma_f32_16x16x32_bf16 v[140:143], a[252:255], a[36:39], v[140:143]
buffer_load_dwordx4 a[152:155], v2, s[24:27], s54 offen offset:2048 sc1
v_mfma_f32_16x16x32_bf16 v[140:143], a[248:251], a[32:35], v[140:143]
ds_read_b64_tr_b16 a[236:237], v9 offset:4096
v_mfma_f32_16x16x32_bf16 v[140:143], a[244:247], a[4:7], v[140:143]
ds_read_b64_tr_b16 a[238:239], v9 offset:6144
v_mfma_f32_16x16x32_bf16 v[140:143], a[240:243], a[0:3], v[140:143]
s_waitcnt lgkmcnt(8)
v_mfma_f32_16x16x32_bf16 v[192:195], a[96:99], a[0:3], v[192:195]
ds_read_b64_tr_b16 a[240:241], v6 offset:58368
v_mfma_f32_16x16x32_bf16 v[192:195], a[100:103], a[4:7], v[192:195]
buffer_load_dwordx4 a[156:159], v2, s[24:27], s54 offen offset:3072 sc1
v_mfma_f32_16x16x32_bf16 v[192:195], a[104:107], a[32:35], v[192:195]
s_mov_b32 s55, 6422528
ds_read_b64_tr_b16 a[242:243], v6 offset:60416
s_add_u32 m0, s52, 32768
v_mfma_f32_16x16x32_bf16 v[192:195], a[108:111], a[36:39], v[192:195]
v_mfma_f32_16x16x32_bf16 v[200:203], a[108:111], a[44:47], v[200:203]
ds_read_b64_tr_b16 a[244:245], v6 offset:62464
v_mfma_f32_16x16x32_bf16 v[200:203], a[104:107], a[40:43], v[200:203]
v_mfma_f32_16x16x32_bf16 v[200:203], a[100:103], a[12:15], v[200:203]
ds_read_b64_tr_b16 a[246:247], v6 offset:64512
v_mfma_f32_16x16x32_bf16 v[200:203], a[96:99], a[8:11], v[200:203]
buffer_load_dwordx4 v40, s[16:19], s55 offen offset:0 lds
v_mfma_f32_16x16x32_bf16 v[208:211], a[96:99], a[16:19], v[208:211]
ds_read_b64_tr_b16 a[248:249], v8 offset:1024
v_mfma_f32_16x16x32_bf16 v[208:211], a[100:103], a[20:23], v[208:211]
v_mfma_f32_16x16x32_bf16 v[208:211], a[104:107], a[48:51], v[208:211]
ds_read_b64_tr_b16 a[250:251], v8 offset:3072
v_mfma_f32_16x16x32_bf16 v[208:211], a[108:111], a[52:55], v[208:211]
v_mfma_f32_16x16x32_bf16 v[216:219], a[108:111], a[60:63], v[216:219]
buffer_load_dwordx4 v41, s[16:19], s55 offen offset:1024 lds
v_mfma_f32_16x16x32_bf16 v[216:219], a[104:107], a[56:59], v[216:219]
s_mov_b32 s55, 6881280
ds_read_b64_tr_b16 a[252:253], v8 offset:5120
s_add_u32 m0, s52, 40960
v_mfma_f32_16x16x32_bf16 v[216:219], a[100:103], a[28:31], v[216:219]
ds_read_b64_tr_b16 a[254:255], v8 offset:7168
v_mfma_f32_16x16x32_bf16 v[216:219], a[96:99], a[24:27], v[216:219]
s_waitcnt lgkmcnt(8)
v_mfma_f32_16x16x32_bf16 v[220:223], a[224:227], a[24:27], v[220:223]
ds_read_b64_tr_b16 a[96:97], v7 offset:58368
v_mfma_f32_16x16x32_bf16 v[220:223], a[228:231], a[28:31], v[220:223]
v_mfma_f32_16x16x32_bf16 v[220:223], a[232:235], a[56:59], v[220:223]
buffer_load_dwordx4 v40, s[16:19], s55 offen offset:0 lds
v_mfma_f32_16x16x32_bf16 v[220:223], a[236:239], a[60:63], v[220:223]
ds_read_b64_tr_b16 a[98:99], v7 offset:60416
v_mfma_f32_16x16x32_bf16 v[212:215], a[236:239], a[52:55], v[212:215]
ds_read_b64_tr_b16 a[100:101], v7 offset:62464
v_mfma_f32_16x16x32_bf16 v[212:215], a[232:235], a[48:51], v[212:215]
v_mfma_f32_16x16x32_bf16 v[212:215], a[228:231], a[20:23], v[212:215]
ds_read_b64_tr_b16 a[102:103], v7 offset:64512
v_mfma_f32_16x16x32_bf16 v[212:215], a[224:227], a[16:19], v[212:215]
buffer_load_dwordx4 v41, s[16:19], s55 offen offset:1024 lds
v_mfma_f32_16x16x32_bf16 v[204:207], a[224:227], a[8:11], v[204:207]
s_mov_b32 s55, 6422528
ds_read_b64_tr_b16 a[104:105], v9 offset:1024
s_add_u32 m0, s52, 49152
v_mfma_f32_16x16x32_bf16 v[204:207], a[228:231], a[12:15], v[204:207]
v_mfma_f32_16x16x32_bf16 v[204:207], a[232:235], a[40:43], v[204:207]
ds_read_b64_tr_b16 a[106:107], v9 offset:3072
v_mfma_f32_16x16x32_bf16 v[204:207], a[236:239], a[44:47], v[204:207]
v_mfma_f32_16x16x32_bf16 v[196:199], a[236:239], a[36:39], v[196:199]
ds_read_b64_tr_b16 a[108:109], v9 offset:5120
v_mfma_f32_16x16x32_bf16 v[196:199], a[232:235], a[32:35], v[196:199]
buffer_load_dwordx4 v40, s[20:23], s55 offen offset:0 lds
v_mfma_f32_16x16x32_bf16 v[196:199], a[228:231], a[4:7], v[196:199]
ds_read_b64_tr_b16 a[110:111], v9 offset:7168
v_mfma_f32_16x16x32_bf16 v[196:199], a[224:227], a[0:3], v[196:199]
s_waitcnt vmcnt(22) lgkmcnt(8)
s_barrier
v_mfma_f32_16x16x32_bf16 v[224:227], a[0:3], a[240:243], v[224:227]
ds_read_b64_tr_b16 a[224:225], v24 offset:8192
v_mfma_f32_16x16x32_bf16 v[224:227], a[4:7], a[244:247], v[224:227]
buffer_load_dwordx4 v41, s[20:23], s55 offen offset:1024 lds
v_mfma_f32_16x16x32_bf16 v[224:227], a[32:35], a[248:251], v[224:227]
s_mov_b32 s55, 6881280
ds_read_b64_tr_b16 a[226:227], v24 offset:10240
s_add_u32 m0, s52, 57344
v_mfma_f32_16x16x32_bf16 v[224:227], a[36:39], a[252:255], v[224:227]
v_mfma_f32_16x16x32_bf16 v[228:231], a[44:47], a[252:255], v[228:231]
ds_read_b64_tr_b16 a[228:229], v24 offset:12288
v_mfma_f32_16x16x32_bf16 v[228:231], a[40:43], a[248:251], v[228:231]
v_mfma_f32_16x16x32_bf16 v[228:231], a[12:15], a[244:247], v[228:231]
ds_read_b64_tr_b16 a[230:231], v24 offset:14336
v_mfma_f32_16x16x32_bf16 v[228:231], a[8:11], a[240:243], v[228:231]
buffer_load_dword v61, v57, s[40:43], s90 offen
v_mfma_f32_16x16x32_bf16 v[232:235], a[16:19], a[240:243], v[232:235]
s_add_u32 s90, s90, 2097152
ds_read_b64_tr_b16 a[232:233], v24 offset:16384
v_mfma_f32_16x16x32_bf16 v[232:235], a[20:23], a[244:247], v[232:235]
v_mfma_f32_16x16x32_bf16 v[232:235], a[48:51], a[248:251], v[232:235]
ds_read_b64_tr_b16 a[234:235], v24 offset:18432
v_mfma_f32_16x16x32_bf16 v[232:235], a[52:55], a[252:255], v[232:235]
v_mfma_f32_16x16x32_bf16 v[236:239], a[60:63], a[252:255], v[236:239]
ds_read_b64_tr_b16 a[236:237], v24 offset:20480
v_mfma_f32_16x16x32_bf16 v[236:239], a[56:59], a[248:251], v[236:239]
v_mfma_f32_16x16x32_bf16 v[236:239], a[28:31], a[244:247], v[236:239]
ds_read_b64_tr_b16 a[238:239], v24 offset:22528
v_mfma_f32_16x16x32_bf16 v[236:239], a[24:27], a[240:243], v[236:239]
s_waitcnt lgkmcnt(8)
v_mfma_f32_16x16x32_bf16 v[252:255], a[24:27], a[96:99], v[252:255]
ds_read_b64_tr_b16 a[240:241], v25 offset:8192
v_mfma_f32_16x16x32_bf16 v[252:255], a[28:31], a[100:103], v[252:255]
v_mfma_f32_16x16x32_bf16 v[252:255], a[56:59], a[104:107], v[252:255]
buffer_load_dwordx4 v40, s[20:23], s55 offen offset:0 lds
v_mfma_f32_16x16x32_bf16 v[252:255], a[60:63], a[108:111], v[252:255]
ds_read_b64_tr_b16 a[242:243], v25 offset:10240
v_mfma_f32_16x16x32_bf16 v[248:251], a[52:55], a[108:111], v[248:251]
ds_read_b64_tr_b16 a[244:245], v25 offset:12288
v_mfma_f32_16x16x32_bf16 v[248:251], a[48:51], a[104:107], v[248:251]
v_mfma_f32_16x16x32_bf16 v[248:251], a[20:23], a[100:103], v[248:251]
ds_read_b64_tr_b16 a[246:247], v25 offset:14336
v_mfma_f32_16x16x32_bf16 v[248:251], a[16:19], a[96:99], v[248:251]
buffer_load_dwordx4 v41, s[20:23], s55 offen offset:1024 lds
v_mfma_f32_16x16x32_bf16 v[244:247], a[8:11], a[96:99], v[244:247]
s_mov_b32 s56, 5505024
ds_read_b64_tr_b16 a[248:249], v25 offset:16384
s_add_u32 m0, s52, 65536
v_mfma_f32_16x16x32_bf16 v[244:247], a[12:15], a[100:103], v[244:247]
v_mfma_f32_16x16x32_bf16 v[244:247], a[40:43], a[104:107], v[244:247]
ds_read_b64_tr_b16 a[250:251], v25 offset:18432
v_mfma_f32_16x16x32_bf16 v[244:247], a[44:47], a[108:111], v[244:247]
v_mfma_f32_16x16x32_bf16 v[240:243], a[36:39], a[108:111], v[240:243]
ds_read_b64_tr_b16 a[252:253], v25 offset:20480
v_mfma_f32_16x16x32_bf16 v[240:243], a[32:35], a[104:107], v[240:243]
buffer_load_dwordx4 v42, s[12:15], s56 offen offset:0 lds
v_mfma_f32_16x16x32_bf16 v[240:243], a[4:7], a[100:103], v[240:243]
ds_read_b64_tr_b16 a[254:255], v25 offset:22528
v_mfma_f32_16x16x32_bf16 v[240:243], a[0:3], a[96:99], v[240:243]
s_waitcnt vmcnt(10) lgkmcnt(8)
v_mfma_f32_16x16x32_bf16 v[64:67], a[224:227], a[64:67], v[64:67]
ds_read_b64_tr_b16 a[96:97], v26 offset:8192
v_mfma_f32_16x16x32_bf16 v[64:67], a[228:231], a[68:71], v[64:67]
v_mfma_f32_16x16x32_bf16 v[64:67], a[232:235], a[128:131], v[64:67]
ds_read_b64_tr_b16 a[98:99], v26 offset:10240
v_mfma_f32_16x16x32_bf16 v[64:67], a[236:239], a[132:135], v[64:67]
v_mfma_f32_16x16x32_bf16 v[80:83], a[236:239], a[140:143], v[80:83]
ds_read_b64_tr_b16 a[100:101], v26 offset:12288
v_mfma_f32_16x16x32_bf16 v[80:83], a[232:235], a[136:139], v[80:83]
v_mfma_f32_16x16x32_bf16 v[80:83], a[228:231], a[76:79], v[80:83]
ds_read_b64_tr_b16 a[102:103], v26 offset:14336
v_mfma_f32_16x16x32_bf16 v[80:83], a[224:227], a[72:75], v[80:83]
v_mfma_f32_16x16x32_bf16 v[96:99], a[224:227], a[80:83], v[96:99]
buffer_load_dwordx4 v43, s[12:15], s56 offen offset:1024 lds
v_mfma_f32_16x16x32_bf16 v[96:99], a[228:231], a[84:87], v[96:99]
s_mov_b32 s56, 5898240
ds_read_b64_tr_b16 a[104:105], v26 offset:16384
s_add_u32 m0, s52, 73728
v_mfma_f32_16x16x32_bf16 v[96:99], a[232:235], a[144:147], v[96:99]
ds_read_b64_tr_b16 a[106:107], v26 offset:18432
v_mfma_f32_16x16x32_bf16 v[96:99], a[236:239], a[148:151], v[96:99]
v_mfma_f32_16x16x32_bf16 v[112:115], a[236:239], a[156:159], v[112:115]
ds_read_b64_tr_b16 a[108:109], v26 offset:20480
v_mfma_f32_16x16x32_bf16 v[112:115], a[232:235], a[152:155], v[112:115]
v_mfma_f32_16x16x32_bf16 v[112:115], a[228:231], a[92:95], v[112:115]
ds_read_b64_tr_b16 a[110:111], v26 offset:22528
v_mfma_f32_16x16x32_bf16 v[112:115], a[224:227], a[88:91], v[112:115]
s_waitcnt lgkmcnt(8)
v_mfma_f32_16x16x32_bf16 v[116:119], a[240:243], a[88:91], v[116:119]
ds_read_b64_tr_b16 a[224:225], v27 offset:8192
v_mfma_f32_16x16x32_bf16 v[116:119], a[244:247], a[92:95], v[116:119]
v_mfma_f32_16x16x32_bf16 v[116:119], a[248:251], a[152:155], v[116:119]
ds_read_b64_tr_b16 a[226:227], v27 offset:10240
v_mfma_f32_16x16x32_bf16 v[116:119], a[252:255], a[156:159], v[116:119]
buffer_load_dwordx4 v42, s[12:15], s56 offen offset:0 lds
v_mfma_f32_16x16x32_bf16 v[100:103], a[252:255], a[148:151], v[100:103]
ds_read_b64_tr_b16 a[228:229], v27 offset:12288
v_mfma_f32_16x16x32_bf16 v[100:103], a[248:251], a[144:147], v[100:103]
v_mfma_f32_16x16x32_bf16 v[100:103], a[244:247], a[84:87], v[100:103]
ds_read_b64_tr_b16 a[230:231], v27 offset:14336
v_mfma_f32_16x16x32_bf16 v[100:103], a[240:243], a[80:83], v[100:103]
v_mfma_f32_16x16x32_bf16 v[84:87], a[240:243], a[72:75], v[84:87]
ds_read_b64_tr_b16 a[232:233], v27 offset:16384
v_mfma_f32_16x16x32_bf16 v[84:87], a[244:247], a[76:79], v[84:87]
v_mfma_f32_16x16x32_bf16 v[84:87], a[248:251], a[136:139], v[84:87]
ds_read_b64_tr_b16 a[234:235], v27 offset:18432
v_mfma_f32_16x16x32_bf16 v[84:87], a[252:255], a[140:143], v[84:87]
v_mfma_f32_16x16x32_bf16 v[68:71], a[252:255], a[132:135], v[68:71]
ds_read_b64_tr_b16 a[236:237], v27 offset:20480
v_mfma_f32_16x16x32_bf16 v[68:71], a[248:251], a[128:131], v[68:71]
v_mfma_f32_16x16x32_bf16 v[68:71], a[244:247], a[68:71], v[68:71]
buffer_load_dwordx4 v43, s[12:15], s56 offen offset:1024 lds
v_mfma_f32_16x16x32_bf16 v[68:71], a[240:243], a[64:67], v[68:71]
s_waitcnt lgkmcnt(7)
ds_read_b64_tr_b16 a[238:239], v27 offset:22528
s_add_u32 s54, s53, 114688
v_mfma_f32_16x16x32_bf16 v[128:131], a[96:99], a[64:67], v[128:131]
ds_read_b64_tr_b16 a[240:241], v16 offset:0
v_mfma_f32_16x16x32_bf16 v[128:131], a[100:103], a[68:71], v[128:131]
v_mfma_f32_16x16x32_bf16 v[128:131], a[104:107], a[128:131], v[128:131]
ds_read_b64_tr_b16 a[242:243], v16 offset:2048
v_mfma_f32_16x16x32_bf16 v[128:131], a[108:111], a[132:135], v[128:131]
v_mfma_f32_16x16x32_bf16 v[144:147], a[108:111], a[140:143], v[144:147]
ds_read_b64_tr_b16 a[244:245], v16 offset:4096
v_mfma_f32_16x16x32_bf16 v[144:147], a[104:107], a[136:139], v[144:147]
v_mfma_f32_16x16x32_bf16 v[144:147], a[100:103], a[76:79], v[144:147]
ds_read_b64_tr_b16 a[246:247], v16 offset:6144
v_mfma_f32_16x16x32_bf16 v[144:147], a[96:99], a[72:75], v[144:147]
v_mfma_f32_16x16x32_bf16 v[160:163], a[96:99], a[80:83], v[160:163]
ds_read_b64_tr_b16 a[248:249], v16 offset:8192
v_mfma_f32_16x16x32_bf16 v[160:163], a[100:103], a[84:87], v[160:163]
buffer_load_dwordx4 a[160:163], v1, s[24:27], s54 offen offset:0 sc1
v_mfma_f32_16x16x32_bf16 v[160:163], a[104:107], a[144:147], v[160:163]
ds_read_b64_tr_b16 a[250:251], v16 offset:10240
v_mfma_f32_16x16x32_bf16 v[160:163], a[108:111], a[148:151], v[160:163]
v_mfma_f32_16x16x32_bf16 v[176:179], a[108:111], a[156:159], v[176:179]
ds_read_b64_tr_b16 a[252:253], v16 offset:12288
v_mfma_f32_16x16x32_bf16 v[176:179], a[104:107], a[152:155], v[176:179]
v_mfma_f32_16x16x32_bf16 v[176:179], a[100:103], a[92:95], v[176:179]
buffer_load_dwordx4 a[164:167], v1, s[24:27], s54 offen offset:1024 sc1
v_mfma_f32_16x16x32_bf16 v[176:179], a[96:99], a[88:91], v[176:179]
s_waitcnt lgkmcnt(7)
ds_read_b64_tr_b16 a[254:255], v16 offset:14336
v_mfma_f32_16x16x32_bf16 v[180:183], a[224:227], a[88:91], v[180:183]
ds_read_b64_tr_b16 a[96:97], v17 offset:0
v_mfma_f32_16x16x32_bf16 v[180:183], a[228:231], a[92:95], v[180:183]
s_load_dword s101, s[92:93], 20472
v_mfma_f32_16x16x32_bf16 v[180:183], a[232:235], a[152:155], v[180:183]
ds_read_b64_tr_b16 a[98:99], v17 offset:2048
v_mfma_f32_16x16x32_bf16 v[180:183], a[236:239], a[156:159], v[180:183]
v_mfma_f32_16x16x32_bf16 v[164:167], a[236:239], a[148:151], v[164:167]
buffer_load_dwordx4 a[168:171], v1, s[24:27], s54 offen offset:2048 sc1
v_mfma_f32_16x16x32_bf16 v[164:167], a[232:235], a[144:147], v[164:167]
ds_read_b64_tr_b16 a[100:101], v17 offset:4096
v_mfma_f32_16x16x32_bf16 v[164:167], a[228:231], a[84:87], v[164:167]
ds_read_b64_tr_b16 a[102:103], v17 offset:6144
v_mfma_f32_16x16x32_bf16 v[164:167], a[224:227], a[80:83], v[164:167]
v_mfma_f32_16x16x32_bf16 v[148:151], a[224:227], a[72:75], v[148:151]
ds_read_b64_tr_b16 a[104:105], v17 offset:8192
v_mfma_f32_16x16x32_bf16 v[148:151], a[228:231], a[76:79], v[148:151]
buffer_load_dword v61, v57, s[40:43], s90 offen
v_mfma_f32_16x16x32_bf16 v[148:151], a[232:235], a[136:139], v[148:151]
s_add_u32 s90, s90, 2097152
ds_read_b64_tr_b16 a[106:107], v17 offset:10240
v_mfma_f32_16x16x32_bf16 v[148:151], a[236:239], a[140:143], v[148:151]
v_mfma_f32_16x16x32_bf16 v[132:135], a[236:239], a[132:135], v[132:135]
ds_read_b64_tr_b16 a[108:109], v17 offset:12288
v_mfma_f32_16x16x32_bf16 v[132:135], a[232:235], a[128:131], v[132:135]
v_mfma_f32_16x16x32_bf16 v[132:135], a[228:231], a[68:71], v[132:135]
ds_read_b64_tr_b16 a[110:111], v17 offset:14336
v_mfma_f32_16x16x32_bf16 v[132:135], a[224:227], a[64:67], v[132:135]
s_waitcnt lgkmcnt(8)
v_mfma_f32_16x16x32_bf16 v[72:75], a[240:243], a[64:67], v[72:75]
ds_read_b64_tr_b16 a[224:225], v18 offset:0
v_mfma_f32_16x16x32_bf16 v[72:75], a[244:247], a[68:71], v[72:75]
v_mfma_f32_16x16x32_bf16 v[72:75], a[248:251], a[128:131], v[72:75]
ds_read_b64_tr_b16 a[226:227], v18 offset:2048
v_mfma_f32_16x16x32_bf16 v[72:75], a[252:255], a[132:135], v[72:75]
v_mfma_f32_16x16x32_bf16 v[88:91], a[252:255], a[140:143], v[88:91]
buffer_load_dwordx4 a[172:175], v1, s[24:27], s54 offen offset:3072 sc1
v_mfma_f32_16x16x32_bf16 v[88:91], a[248:251], a[136:139], v[88:91]
ds_read_b64_tr_b16 a[228:229], v18 offset:4096
v_mfma_f32_16x16x32_bf16 v[88:91], a[244:247], a[76:79], v[88:91]
ds_read_b64_tr_b16 a[230:231], v18 offset:6144
v_mfma_f32_16x16x32_bf16 v[88:91], a[240:243], a[72:75], v[88:91]
v_mfma_f32_16x16x32_bf16 v[104:107], a[240:243], a[80:83], v[104:107]
ds_read_b64_tr_b16 a[232:233], v18 offset:8192
v_mfma_f32_16x16x32_bf16 v[104:107], a[244:247], a[84:87], v[104:107]
v_mfma_f32_16x16x32_bf16 v[104:107], a[248:251], a[144:147], v[104:107]
buffer_load_dwordx4 a[176:179], v2, s[24:27], s54 offen offset:0 sc1
v_mfma_f32_16x16x32_bf16 v[104:107], a[252:255], a[148:151], v[104:107]
ds_read_b64_tr_b16 a[234:235], v18 offset:10240
v_mfma_f32_16x16x32_bf16 v[120:123], a[252:255], a[156:159], v[120:123]
ds_read_b64_tr_b16 a[236:237], v18 offset:12288
v_mfma_f32_16x16x32_bf16 v[120:123], a[248:251], a[152:155], v[120:123]
v_mfma_f32_16x16x32_bf16 v[120:123], a[244:247], a[92:95], v[120:123]
ds_read_b64_tr_b16 a[238:239], v18 offset:14336
v_mfma_f32_16x16x32_bf16 v[120:123], a[240:243], a[88:91], v[120:123]
s_waitcnt lgkmcnt(8)
buffer_load_dwordx4 a[180:183], v2, s[24:27], s54 offen offset:1024 sc1
v_mfma_f32_16x16x32_bf16 v[124:127], a[96:99], a[88:91], v[124:127]
ds_read_b64_tr_b16 a[240:241], v19 offset:0
v_mfma_f32_16x16x32_bf16 v[124:127], a[100:103], a[92:95], v[124:127]
v_mfma_f32_16x16x32_bf16 v[124:127], a[104:107], a[152:155], v[124:127]
ds_read_b64_tr_b16 a[242:243], v19 offset:2048
v_mfma_f32_16x16x32_bf16 v[124:127], a[108:111], a[156:159], v[124:127]
v_mfma_f32_16x16x32_bf16 v[108:111], a[108:111], a[148:151], v[108:111]
ds_read_b64_tr_b16 a[244:245], v19 offset:4096
v_mfma_f32_16x16x32_bf16 v[108:111], a[104:107], a[144:147], v[108:111]
buffer_load_dwordx4 a[184:187], v2, s[24:27], s54 offen offset:2048 sc1
v_mfma_f32_16x16x32_bf16 v[108:111], a[100:103], a[84:87], v[108:111]
ds_read_b64_tr_b16 a[246:247], v19 offset:6144
v_mfma_f32_16x16x32_bf16 v[108:111], a[96:99], a[80:83], v[108:111]
v_mfma_f32_16x16x32_bf16 v[92:95], a[96:99], a[72:75], v[92:95]
ds_read_b64_tr_b16 a[248:249], v19 offset:8192
v_mfma_f32_16x16x32_bf16 v[92:95], a[100:103], a[76:79], v[92:95]
v_mfma_f32_16x16x32_bf16 v[92:95], a[104:107], a[136:139], v[92:95]
buffer_load_dwordx4 a[188:191], v2, s[24:27], s54 offen offset:3072 sc1
v_mfma_f32_16x16x32_bf16 v[92:95], a[108:111], a[140:143], v[92:95]
s_add_u32 s54, s53, 122880
ds_read_b64_tr_b16 a[250:251], v19 offset:10240
v_mfma_f32_16x16x32_bf16 v[76:79], a[108:111], a[132:135], v[76:79]
ds_read_b64_tr_b16 a[252:253], v19 offset:12288
v_mfma_f32_16x16x32_bf16 v[76:79], a[104:107], a[128:131], v[76:79]
v_mfma_f32_16x16x32_bf16 v[76:79], a[100:103], a[68:71], v[76:79]
ds_read_b64_tr_b16 a[254:255], v19 offset:14336
v_mfma_f32_16x16x32_bf16 v[76:79], a[96:99], a[64:67], v[76:79]
s_waitcnt lgkmcnt(8)
v_mfma_f32_16x16x32_bf16 v[136:139], a[224:227], a[64:67], v[136:139]
buffer_load_dwordx4 a[192:195], v1, s[24:27], s54 offen offset:0 sc1
v_mfma_f32_16x16x32_bf16 v[136:139], a[228:231], a[68:71], v[136:139]
ds_read_b64_tr_b16 a[96:97], v4 offset:16384
v_mfma_f32_16x16x32_bf16 v[136:139], a[232:235], a[128:131], v[136:139]
ds_read_b64_tr_b16 a[98:99], v4 offset:18432
v_mfma_f32_16x16x32_bf16 v[136:139], a[236:239], a[132:135], v[136:139]
v_mfma_f32_16x16x32_bf16 v[152:155], a[236:239], a[140:143], v[152:155]
ds_read_b64_tr_b16 a[100:101], v4 offset:20480
v_mfma_f32_16x16x32_bf16 v[152:155], a[232:235], a[136:139], v[152:155]
buffer_load_dwordx4 a[196:199], v1, s[24:27], s54 offen offset:1024 sc1
v_mfma_f32_16x16x32_bf16 v[152:155], a[228:231], a[76:79], v[152:155]
ds_read_b64_tr_b16 a[102:103], v4 offset:22528
v_mfma_f32_16x16x32_bf16 v[152:155], a[224:227], a[72:75], v[152:155]
v_mfma_f32_16x16x32_bf16 v[168:171], a[224:227], a[80:83], v[168:171]
ds_read_b64_tr_b16 a[104:105], v4 offset:24576
v_mfma_f32_16x16x32_bf16 v[168:171], a[228:231], a[84:87], v[168:171]
v_mfma_f32_16x16x32_bf16 v[168:171], a[232:235], a[144:147], v[168:171]
ds_read_b64_tr_b16 a[106:107], v4 offset:26624
v_mfma_f32_16x16x32_bf16 v[168:171], a[236:239], a[148:151], v[168:171]
buffer_load_dwordx4 a[200:203], v1, s[24:27], s54 offen offset:2048 sc1
v_mfma_f32_16x16x32_bf16 v[184:187], a[236:239], a[156:159], v[184:187]
ds_read_b64_tr_b16 a[108:109], v4 offset:28672
v_mfma_f32_16x16x32_bf16 v[184:187], a[232:235], a[152:155], v[184:187]
v_mfma_f32_16x16x32_bf16 v[184:187], a[228:231], a[92:95], v[184:187]
ds_read_b64_tr_b16 a[110:111], v4 offset:30720
v_mfma_f32_16x16x32_bf16 v[184:187], a[224:227], a[88:91], v[184:187]
s_waitcnt lgkmcnt(8)
v_mfma_f32_16x16x32_bf16 v[188:191], a[240:243], a[88:91], v[188:191]
buffer_load_dwordx4 a[204:207], v1, s[24:27], s54 offen offset:3072 sc1
v_mfma_f32_16x16x32_bf16 v[188:191], a[244:247], a[92:95], v[188:191]
ds_read_b64_tr_b16 a[224:225], v5 offset:16384
v_mfma_f32_16x16x32_bf16 v[188:191], a[248:251], a[152:155], v[188:191]
ds_read_b64_tr_b16 a[226:227], v5 offset:18432
v_mfma_f32_16x16x32_bf16 v[188:191], a[252:255], a[156:159], v[188:191]
v_mfma_f32_16x16x32_bf16 v[172:175], a[252:255], a[148:151], v[172:175]
ds_read_b64_tr_b16 a[228:229], v5 offset:20480
v_mfma_f32_16x16x32_bf16 v[172:175], a[248:251], a[144:147], v[172:175]
v_mfma_f32_16x16x32_bf16 v[172:175], a[244:247], a[84:87], v[172:175]
buffer_load_dwordx4 a[208:211], v2, s[24:27], s54 offen offset:0 sc1
v_mfma_f32_16x16x32_bf16 v[172:175], a[240:243], a[80:83], v[172:175]
ds_read_b64_tr_b16 a[230:231], v5 offset:22528
v_mfma_f32_16x16x32_bf16 v[156:159], a[240:243], a[72:75], v[156:159]
ds_read_b64_tr_b16 a[232:233], v5 offset:24576
v_mfma_f32_16x16x32_bf16 v[156:159], a[244:247], a[76:79], v[156:159]
v_mfma_f32_16x16x32_bf16 v[156:159], a[248:251], a[136:139], v[156:159]
ds_read_b64_tr_b16 a[234:235], v5 offset:26624
v_mfma_f32_16x16x32_bf16 v[156:159], a[252:255], a[140:143], v[156:159]
buffer_load_dwordx4 a[212:215], v2, s[24:27], s54 offen offset:1024 sc1
v_mfma_f32_16x16x32_bf16 v[140:143], a[252:255], a[132:135], v[140:143]
ds_read_b64_tr_b16 a[236:237], v5 offset:28672
v_mfma_f32_16x16x32_bf16 v[140:143], a[248:251], a[128:131], v[140:143]
v_mfma_f32_16x16x32_bf16 v[140:143], a[244:247], a[68:71], v[140:143]
ds_read_b64_tr_b16 a[238:239], v5 offset:30720
v_mfma_f32_16x16x32_bf16 v[140:143], a[240:243], a[64:67], v[140:143]
s_waitcnt lgkmcnt(8)
v_mfma_f32_16x16x32_bf16 v[192:195], a[96:99], a[64:67], v[192:195]
ds_read_b64_tr_b16 a[240:241], v4 offset:17408
v_mfma_f32_16x16x32_bf16 v[192:195], a[100:103], a[68:71], v[192:195]
buffer_load_dwordx4 a[216:219], v2, s[24:27], s54 offen offset:2048 sc1
v_mfma_f32_16x16x32_bf16 v[192:195], a[104:107], a[128:131], v[192:195]
ds_read_b64_tr_b16 a[242:243], v4 offset:19456
v_mfma_f32_16x16x32_bf16 v[192:195], a[108:111], a[132:135], v[192:195]
v_mfma_f32_16x16x32_bf16 v[200:203], a[108:111], a[140:143], v[200:203]
ds_read_b64_tr_b16 a[244:245], v4 offset:21504
v_mfma_f32_16x16x32_bf16 v[200:203], a[104:107], a[136:139], v[200:203]
v_mfma_f32_16x16x32_bf16 v[200:203], a[100:103], a[76:79], v[200:203]
buffer_load_dwordx4 a[220:223], v2, s[24:27], s54 offen offset:3072 sc1
v_mfma_f32_16x16x32_bf16 v[200:203], a[96:99], a[72:75], v[200:203]
s_bfe_u32 s55, 0x16001400, s99
ds_read_b64_tr_b16 a[246:247], v4 offset:23552
s_lshl4_add_u32 m0, s55, s100
v_mfma_f32_16x16x32_bf16 v[208:211], a[96:99], a[80:83], v[208:211]
s_mov_b32 s55, 6881280
ds_read_b64_tr_b16 a[248:249], v4 offset:25600
s_mov_b32 s56, 5898240
v_mfma_f32_16x16x32_bf16 v[208:211], a[100:103], a[84:87], v[208:211]
v_mfma_f32_16x16x32_bf16 v[208:211], a[104:107], a[144:147], v[208:211]
s_lshl2_add_u32 s90, s2, s32
ds_read_b64_tr_b16 a[250:251], v4 offset:27648
s_mul_i32 s90, s90, 2048
v_mfma_f32_16x16x32_bf16 v[208:211], a[108:111], a[148:151], v[208:211]
v_mfma_f32_16x16x32_bf16 v[216:219], a[108:111], a[156:159], v[216:219]
buffer_load_dword v61, v57, s[44:47], s90 offen
v_mfma_f32_16x16x32_bf16 v[216:219], a[104:107], a[152:155], v[216:219]
s_add_u32 s90, s90, 2097152
ds_read_b64_tr_b16 a[252:253], v4 offset:29696
v_mfma_f32_16x16x32_bf16 v[216:219], a[100:103], a[92:95], v[216:219]
ds_read_b64_tr_b16 a[254:255], v4 offset:31744
v_mfma_f32_16x16x32_bf16 v[216:219], a[96:99], a[88:91], v[216:219]
s_waitcnt lgkmcnt(8)
v_mfma_f32_16x16x32_bf16 v[220:223], a[224:227], a[88:91], v[220:223]
ds_read_b64_tr_b16 a[96:97], v5 offset:17408
v_mfma_f32_16x16x32_bf16 v[220:223], a[228:231], a[92:95], v[220:223]
v_mfma_f32_16x16x32_bf16 v[220:223], a[232:235], a[152:155], v[220:223]
ds_read_b64_tr_b16 a[98:99], v5 offset:19456
v_mfma_f32_16x16x32_bf16 v[220:223], a[236:239], a[156:159], v[220:223]
v_mfma_f32_16x16x32_bf16 v[212:215], a[236:239], a[148:151], v[212:215]
ds_read_b64_tr_b16 a[100:101], v5 offset:21504
v_mfma_f32_16x16x32_bf16 v[212:215], a[232:235], a[144:147], v[212:215]
v_mfma_f32_16x16x32_bf16 v[212:215], a[228:231], a[84:87], v[212:215]
ds_read_b64_tr_b16 a[102:103], v5 offset:23552
v_mfma_f32_16x16x32_bf16 v[212:215], a[224:227], a[80:83], v[212:215]
buffer_load_dwordx4 v15, s[12:15], s56 offen offset:0 lds
v_mfma_f32_16x16x32_bf16 v[204:207], a[224:227], a[72:75], v[204:207]
ds_read_b64_tr_b16 a[104:105], v5 offset:25600
v_mfma_f32_16x16x32_bf16 v[204:207], a[228:231], a[76:79], v[204:207]
v_mfma_f32_16x16x32_bf16 v[204:207], a[232:235], a[136:139], v[204:207]
ds_read_b64_tr_b16 a[106:107], v5 offset:27648
v_mfma_f32_16x16x32_bf16 v[204:207], a[236:239], a[140:143], v[204:207]
v_mfma_f32_16x16x32_bf16 v[196:199], a[236:239], a[132:135], v[196:199]
ds_read_b64_tr_b16 a[108:109], v5 offset:29696
v_mfma_f32_16x16x32_bf16 v[196:199], a[232:235], a[128:131], v[196:199]
v_mfma_f32_16x16x32_bf16 v[196:199], a[228:231], a[68:71], v[196:199]
ds_read_b64_tr_b16 a[110:111], v5 offset:31744
v_mfma_f32_16x16x32_bf16 v[196:199], a[224:227], a[64:67], v[196:199]
s_waitcnt vmcnt(19) lgkmcnt(8)
s_barrier
v_mfma_f32_16x16x32_bf16 v[224:227], a[64:67], a[240:243], v[224:227]
ds_read_b64_tr_b16 a[224:225], v16 offset:32768
v_mfma_f32_16x16x32_bf16 v[224:227], a[68:71], a[244:247], v[224:227]
buffer_load_dwordx4 v13, s[36:39], s55 offen offset:1024 lds
v_mfma_f32_16x16x32_bf16 v[224:227], a[128:131], a[248:251], v[224:227]
ds_read_b64_tr_b16 a[226:227], v16 offset:34816
v_mfma_f32_16x16x32_bf16 v[224:227], a[132:135], a[252:255], v[224:227]
v_mfma_f32_16x16x32_bf16 v[228:231], a[140:143], a[252:255], v[228:231]
ds_read_b64_tr_b16 a[228:229], v16 offset:36864
v_mfma_f32_16x16x32_bf16 v[228:231], a[136:139], a[248:251], v[228:231]
v_mfma_f32_16x16x32_bf16 v[228:231], a[76:79], a[244:247], v[228:231]
ds_read_b64_tr_b16 a[230:231], v16 offset:38912
v_mfma_f32_16x16x32_bf16 v[228:231], a[72:75], a[240:243], v[228:231]
v_mfma_f32_16x16x32_bf16 v[232:235], a[80:83], a[240:243], v[232:235]
ds_read_b64_tr_b16 a[232:233], v16 offset:40960
v_mfma_f32_16x16x32_bf16 v[232:235], a[84:87], a[244:247], v[232:235]
v_mfma_f32_16x16x32_bf16 v[232:235], a[144:147], a[248:251], v[232:235]
ds_read_b64_tr_b16 a[234:235], v16 offset:43008
v_mfma_f32_16x16x32_bf16 v[232:235], a[148:151], a[252:255], v[232:235]
v_mfma_f32_16x16x32_bf16 v[236:239], a[156:159], a[252:255], v[236:239]
buffer_load_dwordx4 v14, s[36:39], s55 offen offset:2048 lds
v_mfma_f32_16x16x32_bf16 v[236:239], a[152:155], a[248:251], v[236:239]
ds_read_b64_tr_b16 a[236:237], v16 offset:45056
v_mfma_f32_16x16x32_bf16 v[236:239], a[92:95], a[244:247], v[236:239]
ds_read_b64_tr_b16 a[238:239], v16 offset:47104
v_mfma_f32_16x16x32_bf16 v[236:239], a[88:91], a[240:243], v[236:239]
s_waitcnt lgkmcnt(8)
v_mfma_f32_16x16x32_bf16 v[252:255], a[88:91], a[96:99], v[252:255]
ds_read_b64_tr_b16 a[240:241], v17 offset:32768
v_mfma_f32_16x16x32_bf16 v[252:255], a[92:95], a[100:103], v[252:255]
v_mfma_f32_16x16x32_bf16 v[252:255], a[152:155], a[104:107], v[252:255]
ds_read_b64_tr_b16 a[242:243], v17 offset:34816
v_mfma_f32_16x16x32_bf16 v[252:255], a[156:159], a[108:111], v[252:255]
v_mfma_f32_16x16x32_bf16 v[248:251], a[148:151], a[108:111], v[248:251]
ds_read_b64_tr_b16 a[244:245], v17 offset:36864
v_mfma_f32_16x16x32_bf16 v[248:251], a[144:147], a[104:107], v[248:251]
v_mfma_f32_16x16x32_bf16 v[248:251], a[84:87], a[100:103], v[248:251]
ds_read_b64_tr_b16 a[246:247], v17 offset:38912
v_mfma_f32_16x16x32_bf16 v[248:251], a[80:83], a[96:99], v[248:251]
buffer_load_dwordx4 v3, s[36:39], s55 offen offset:3072 lds
v_mfma_f32_16x16x32_bf16 v[244:247], a[72:75], a[96:99], v[244:247]
s_bfe_u32 s55, 0x1a001800, s99
ds_read_b64_tr_b16 a[248:249], v17 offset:40960
s_lshl4_add_u32 m0, s55, s100
v_mfma_f32_16x16x32_bf16 v[244:247], a[76:79], a[100:103], v[244:247]
s_mov_b32 s55, 6422528
s_mov_b32 s56, 5505024
v_mfma_f32_16x16x32_bf16 v[244:247], a[136:139], a[104:107], v[244:247]
ds_read_b64_tr_b16 a[250:251], v17 offset:43008
v_mfma_f32_16x16x32_bf16 v[244:247], a[140:143], a[108:111], v[244:247]
v_mfma_f32_16x16x32_bf16 v[240:243], a[132:135], a[108:111], v[240:243]
ds_read_b64_tr_b16 a[252:253], v17 offset:45056
v_mfma_f32_16x16x32_bf16 v[240:243], a[128:131], a[104:107], v[240:243]
v_mfma_f32_16x16x32_bf16 v[240:243], a[68:71], a[100:103], v[240:243]
ds_read_b64_tr_b16 a[254:255], v17 offset:47104
v_mfma_f32_16x16x32_bf16 v[240:243], a[64:67], a[96:99], v[240:243]
s_waitcnt vmcnt(5) lgkmcnt(8)
v_mfma_f32_16x16x32_bf16 v[64:67], a[224:227], a[160:163], v[64:67]
pg_4:
s_cbranch_execz pg_t8
ds_read_b64_tr_b16 a[96:97], v18 offset:32768
v_mfma_f32_16x16x32_bf16 v[64:67], a[228:231], a[164:167], v[64:67]
v_mfma_f32_16x16x32_bf16 v[64:67], a[232:235], a[192:195], v[64:67]
buffer_load_dwordx4 v15, s[12:15], s56 offen offset:0 lds
v_mfma_f32_16x16x32_bf16 v[64:67], a[236:239], a[196:199], v[64:67]
ds_read_b64_tr_b16 a[98:99], v18 offset:34816
v_mfma_f32_16x16x32_bf16 v[80:83], a[236:239], a[204:207], v[80:83]
ds_read_b64_tr_b16 a[100:101], v18 offset:36864
v_mfma_f32_16x16x32_bf16 v[80:83], a[232:235], a[200:203], v[80:83]
v_mfma_f32_16x16x32_bf16 v[80:83], a[228:231], a[172:175], v[80:83]
ds_read_b64_tr_b16 a[102:103], v18 offset:38912
v_mfma_f32_16x16x32_bf16 v[80:83], a[224:227], a[168:171], v[80:83]
v_mfma_f32_16x16x32_bf16 v[96:99], a[224:227], a[176:179], v[96:99]
ds_read_b64_tr_b16 a[104:105], v18 offset:40960
v_mfma_f32_16x16x32_bf16 v[96:99], a[228:231], a[180:183], v[96:99]
v_mfma_f32_16x16x32_bf16 v[96:99], a[232:235], a[208:211], v[96:99]
ds_read_b64_tr_b16 a[106:107], v18 offset:43008
v_mfma_f32_16x16x32_bf16 v[96:99], a[236:239], a[212:215], v[96:99]
v_mfma_f32_16x16x32_bf16 v[112:115], a[236:239], a[220:223], v[112:115]
ds_read_b64_tr_b16 a[108:109], v18 offset:45056
v_mfma_f32_16x16x32_bf16 v[112:115], a[232:235], a[216:219], v[112:115]
buffer_load_dwordx4 v13, s[36:39], s55 offen offset:1024 lds
v_mfma_f32_16x16x32_bf16 v[112:115], a[228:231], a[188:191], v[112:115]
ds_read_b64_tr_b16 a[110:111], v18 offset:47104
v_mfma_f32_16x16x32_bf16 v[112:115], a[224:227], a[184:187], v[112:115]
s_waitcnt lgkmcnt(8)
v_mfma_f32_16x16x32_bf16 v[116:119], a[240:243], a[184:187], v[116:119]
ds_read_b64_tr_b16 a[224:225], v19 offset:32768
v_mfma_f32_16x16x32_bf16 v[116:119], a[244:247], a[188:191], v[116:119]
v_mfma_f32_16x16x32_bf16 v[116:119], a[248:251], a[216:219], v[116:119]
ds_read_b64_tr_b16 a[226:227], v19 offset:34816
v_mfma_f32_16x16x32_bf16 v[116:119], a[252:255], a[220:223], v[116:119]
v_mfma_f32_16x16x32_bf16 v[100:103], a[252:255], a[212:215], v[100:103]
ds_read_b64_tr_b16 a[228:229], v19 offset:36864
v_mfma_f32_16x16x32_bf16 v[100:103], a[248:251], a[208:211], v[100:103]
v_mfma_f32_16x16x32_bf16 v[100:103], a[244:247], a[180:183], v[100:103]
ds_read_b64_tr_b16 a[230:231], v19 offset:38912
v_mfma_f32_16x16x32_bf16 v[100:103], a[240:243], a[176:179], v[100:103]
v_mfma_f32_16x16x32_bf16 v[84:87], a[240:243], a[168:171], v[84:87]
buffer_load_dwordx4 v14, s[36:39], s55 offen offset:2048 lds
v_mfma_f32_16x16x32_bf16 v[84:87], a[244:247], a[172:175], v[84:87]
ds_read_b64_tr_b16 a[232:233], v19 offset:40960
v_mfma_f32_16x16x32_bf16 v[84:87], a[248:251], a[200:203], v[84:87]
ds_read_b64_tr_b16 a[234:235], v19 offset:43008
v_mfma_f32_16x16x32_bf16 v[84:87], a[252:255], a[204:207], v[84:87]
v_mfma_f32_16x16x32_bf16 v[68:71], a[252:255], a[196:199], v[68:71]
ds_read_b64_tr_b16 a[236:237], v19 offset:45056
s_mov_b32 s48, s86
v_mfma_f32_16x16x32_bf16 v[68:71], a[248:251], a[192:195], v[68:71]
s_mov_b32 s49, s87
s_mov_b32 s50, 0x400000
s_mov_b32 s51, 0x20000
v_mfma_f32_16x16x32_bf16 v[68:71], a[244:247], a[164:167], v[68:71]
ds_read_b64_tr_b16 a[238:239], v19 offset:47104
v_mfma_f32_16x16x32_bf16 v[68:71], a[240:243], a[160:163], v[68:71]
s_waitcnt lgkmcnt(8)
v_mfma_f32_16x16x32_bf16 v[128:131], a[96:99], a[160:163], v[128:131]
ds_read_b64_tr_b16 a[240:241], v16 offset:49152
v_mfma_f32_16x16x32_bf16 v[128:131], a[100:103], a[164:167], v[128:131]
v_mfma_f32_16x16x32_bf16 v[128:131], a[104:107], a[192:195], v[128:131]
ds_read_b64_tr_b16 a[242:243], v16 offset:51200
v_mfma_f32_16x16x32_bf16 v[128:131], a[108:111], a[196:199], v[128:131]
buffer_load_dwordx4 v3, s[36:39], s55 offen offset:3072 lds
v_mfma_f32_16x16x32_bf16 v[144:147], a[108:111], a[204:207], v[144:147]
s_bfe_u32 s55, 0x1e001c00, s99
ds_read_b64_tr_b16 a[244:245], v16 offset:53248
s_lshl4_add_u32 m0, s55, s100
v_mfma_f32_16x16x32_bf16 v[144:147], a[104:107], a[200:203], v[144:147]
s_mov_b32 s55, 5963776
s_mov_b32 s56, 5111808
v_mfma_f32_16x16x32_bf16 v[144:147], a[100:103], a[172:175], v[144:147]
ds_read_b64_tr_b16 a[246:247], v16 offset:55296
v_mfma_f32_16x16x32_bf16 v[144:147], a[96:99], a[168:171], v[144:147]
v_mfma_f32_16x16x32_bf16 v[160:163], a[96:99], a[176:179], v[160:163]
ds_read_b64_tr_b16 a[248:249], v16 offset:57344
v_mfma_f32_16x16x32_bf16 v[160:163], a[100:103], a[180:183], v[160:163]
v_mfma_f32_16x16x32_bf16 v[160:163], a[104:107], a[208:211], v[160:163]
ds_read_b64_tr_b16 a[250:251], v16 offset:59392
v_mfma_f32_16x16x32_bf16 v[160:163], a[108:111], a[212:215], v[160:163]
v_mfma_f32_16x16x32_bf16 v[176:179], a[108:111], a[220:223], v[176:179]
ds_read_b64_tr_b16 a[252:253], v16 offset:61440
v_mfma_f32_16x16x32_bf16 v[176:179], a[104:107], a[216:219], v[176:179]
v_mfma_f32_16x16x32_bf16 v[176:179], a[100:103], a[188:191], v[176:179]
buffer_load_dwordx4 v15, s[12:15], s56 offen offset:0 lds
v_mfma_f32_16x16x32_bf16 v[176:179], a[96:99], a[184:187], v[176:179]
s_waitcnt lgkmcnt(7)
ds_read_b64_tr_b16 a[254:255], v16 offset:63488
v_mfma_f32_16x16x32_bf16 v[180:183], a[224:227], a[184:187], v[180:183]
ds_read_b64_tr_b16 a[96:97], v17 offset:49152
v_mfma_f32_16x16x32_bf16 v[180:183], a[228:231], a[188:191], v[180:183]
v_mfma_f32_16x16x32_bf16 v[180:183], a[232:235], a[216:219], v[180:183]
ds_read_b64_tr_b16 a[98:99], v17 offset:51200
v_mfma_f32_16x16x32_bf16 v[180:183], a[236:239], a[220:223], v[180:183]
v_mfma_f32_16x16x32_bf16 v[164:167], a[236:239], a[212:215], v[164:167]
ds_read_b64_tr_b16 a[100:101], v17 offset:53248
v_mfma_f32_16x16x32_bf16 v[164:167], a[232:235], a[208:211], v[164:167]
v_mfma_f32_16x16x32_bf16 v[164:167], a[228:231], a[180:183], v[164:167]
ds_read_b64_tr_b16 a[102:103], v17 offset:55296
v_mfma_f32_16x16x32_bf16 v[164:167], a[224:227], a[176:179], v[164:167]
v_mfma_f32_16x16x32_bf16 v[148:151], a[224:227], a[168:171], v[148:151]
ds_read_b64_tr_b16 a[104:105], v17 offset:57344
v_mfma_f32_16x16x32_bf16 v[148:151], a[228:231], a[172:175], v[148:151]
buffer_load_dwordx4 v13, s[36:39], s55 offen offset:1024 lds
v_mfma_f32_16x16x32_bf16 v[148:151], a[232:235], a[200:203], v[148:151]
ds_read_b64_tr_b16 a[106:107], v17 offset:59392
v_mfma_f32_16x16x32_bf16 v[148:151], a[236:239], a[204:207], v[148:151]
v_mfma_f32_16x16x32_bf16 v[132:135], a[236:239], a[196:199], v[132:135]
ds_read_b64_tr_b16 a[108:109], v17 offset:61440
v_mfma_f32_16x16x32_bf16 v[132:135], a[232:235], a[192:195], v[132:135]
v_mfma_f32_16x16x32_bf16 v[132:135], a[228:231], a[164:167], v[132:135]
ds_read_b64_tr_b16 a[110:111], v17 offset:63488
v_mfma_f32_16x16x32_bf16 v[132:135], a[224:227], a[160:163], v[132:135]
s_waitcnt lgkmcnt(8)
v_mfma_f32_16x16x32_bf16 v[72:75], a[240:243], a[160:163], v[72:75]
ds_read_b64_tr_b16 a[224:225], v18 offset:49152
v_mfma_f32_16x16x32_bf16 v[72:75], a[244:247], a[164:167], v[72:75]
v_mfma_f32_16x16x32_bf16 v[72:75], a[248:251], a[192:195], v[72:75]
ds_read_b64_tr_b16 a[226:227], v18 offset:51200
v_mfma_f32_16x16x32_bf16 v[72:75], a[252:255], a[196:199], v[72:75]
v_mfma_f32_16x16x32_bf16 v[88:91], a[252:255], a[204:207], v[88:91]
buffer_load_dwordx4 v14, s[36:39], s55 offen offset:2048 lds
v_mfma_f32_16x16x32_bf16 v[88:91], a[248:251], a[200:203], v[88:91]
ds_read_b64_tr_b16 a[228:229], v18 offset:53248
v_mfma_f32_16x16x32_bf16 v[88:91], a[244:247], a[172:175], v[88:91]
ds_read_b64_tr_b16 a[230:231], v18 offset:55296
v_mfma_f32_16x16x32_bf16 v[88:91], a[240:243], a[168:171], v[88:91]
v_mfma_f32_16x16x32_bf16 v[104:107], a[240:243], a[176:179], v[104:107]
ds_read_b64_tr_b16 a[232:233], v18 offset:57344
v_mfma_f32_16x16x32_bf16 v[104:107], a[244:247], a[180:183], v[104:107]
v_mfma_f32_16x16x32_bf16 v[104:107], a[248:251], a[208:211], v[104:107]
ds_read_b64_tr_b16 a[234:235], v18 offset:59392
v_mfma_f32_16x16x32_bf16 v[104:107], a[252:255], a[212:215], v[104:107]
v_mfma_f32_16x16x32_bf16 v[120:123], a[252:255], a[220:223], v[120:123]
ds_read_b64_tr_b16 a[236:237], v18 offset:61440
v_mfma_f32_16x16x32_bf16 v[120:123], a[248:251], a[216:219], v[120:123]
v_mfma_f32_16x16x32_bf16 v[120:123], a[244:247], a[188:191], v[120:123]
ds_read_b64_tr_b16 a[238:239], v18 offset:63488
v_mfma_f32_16x16x32_bf16 v[120:123], a[240:243], a[184:187], v[120:123]
s_waitcnt lgkmcnt(8)
buffer_load_dwordx4 v3, s[36:39], s55 offen offset:3072 lds
v_mfma_f32_16x16x32_bf16 v[124:127], a[96:99], a[184:187], v[124:127]
s_bfe_u32 s55, 0x22002000, s99
ds_read_b64_tr_b16 a[240:241], v19 offset:49152
s_lshl4_add_u32 m0, s55, s100
v_mfma_f32_16x16x32_bf16 v[124:127], a[100:103], a[188:191], v[124:127]
s_mov_b32 s55, 5505024
s_mov_b32 s56, 4718592
v_mfma_f32_16x16x32_bf16 v[124:127], a[104:107], a[216:219], v[124:127]
ds_read_b64_tr_b16 a[242:243], v19 offset:51200
v_mfma_f32_16x16x32_bf16 v[124:127], a[108:111], a[220:223], v[124:127]
v_mfma_f32_16x16x32_bf16 v[108:111], a[108:111], a[212:215], v[108:111]
ds_read_b64_tr_b16 a[244:245], v19 offset:53248
v_mfma_f32_16x16x32_bf16 v[108:111], a[104:107], a[208:211], v[108:111]
v_mfma_f32_16x16x32_bf16 v[108:111], a[100:103], a[180:183], v[108:111]
ds_read_b64_tr_b16 a[246:247], v19 offset:55296
v_mfma_f32_16x16x32_bf16 v[108:111], a[96:99], a[176:179], v[108:111]
v_mfma_f32_16x16x32_bf16 v[92:95], a[96:99], a[168:171], v[92:95]
ds_read_b64_tr_b16 a[248:249], v19 offset:57344
v_mfma_f32_16x16x32_bf16 v[92:95], a[100:103], a[172:175], v[92:95]
v_mfma_f32_16x16x32_bf16 v[92:95], a[104:107], a[200:203], v[92:95]
buffer_load_dwordx4 v15, s[12:15], s56 offen offset:0 lds
v_mfma_f32_16x16x32_bf16 v[92:95], a[108:111], a[204:207], v[92:95]
ds_read_b64_tr_b16 a[250:251], v19 offset:59392
v_mfma_f32_16x16x32_bf16 v[76:79], a[108:111], a[196:199], v[76:79]
ds_read_b64_tr_b16 a[252:253], v19 offset:61440
v_mfma_f32_16x16x32_bf16 v[76:79], a[104:107], a[192:195], v[76:79]
v_mfma_f32_16x16x32_bf16 v[76:79], a[100:103], a[164:167], v[76:79]
ds_read_b64_tr_b16 a[254:255], v19 offset:63488
v_mfma_f32_16x16x32_bf16 v[76:79], a[96:99], a[160:163], v[76:79]
s_waitcnt lgkmcnt(8)
v_mfma_f32_16x16x32_bf16 v[136:139], a[224:227], a[160:163], v[136:139]
ds_read_b64_tr_b16 a[96:97], v6 offset:0
v_mfma_f32_16x16x32_bf16 v[136:139], a[228:231], a[164:167], v[136:139]
v_mfma_f32_16x16x32_bf16 v[136:139], a[232:235], a[192:195], v[136:139]
ds_read_b64_tr_b16 a[98:99], v6 offset:2048
v_mfma_f32_16x16x32_bf16 v[136:139], a[236:239], a[196:199], v[136:139]
v_mfma_f32_16x16x32_bf16 v[152:155], a[236:239], a[204:207], v[152:155]
ds_read_b64_tr_b16 a[100:101], v6 offset:4096
v_mfma_f32_16x16x32_bf16 v[152:155], a[232:235], a[200:203], v[152:155]
buffer_load_dwordx4 v13, s[36:39], s55 offen offset:1024 lds
v_mfma_f32_16x16x32_bf16 v[152:155], a[228:231], a[172:175], v[152:155]
ds_read_b64_tr_b16 a[102:103], v6 offset:6144
v_mfma_f32_16x16x32_bf16 v[152:155], a[224:227], a[168:171], v[152:155]
v_mfma_f32_16x16x32_bf16 v[168:171], a[224:227], a[176:179], v[168:171]
ds_read_b64_tr_b16 a[104:105], v6 offset:8192
v_mfma_f32_16x16x32_bf16 v[168:171], a[228:231], a[180:183], v[168:171]
v_mfma_f32_16x16x32_bf16 v[168:171], a[232:235], a[208:211], v[168:171]
ds_read_b64_tr_b16 a[106:107], v6 offset:10240
v_mfma_f32_16x16x32_bf16 v[168:171], a[236:239], a[212:215], v[168:171]
v_mfma_f32_16x16x32_bf16 v[184:187], a[236:239], a[220:223], v[184:187]
ds_read_b64_tr_b16 a[108:109], v6 offset:12288
v_mfma_f32_16x16x32_bf16 v[184:187], a[232:235], a[216:219], v[184:187]
v_mfma_f32_16x16x32_bf16 v[184:187], a[228:231], a[188:191], v[184:187]
ds_read_b64_tr_b16 a[110:111], v6 offset:14336
v_mfma_f32_16x16x32_bf16 v[184:187], a[224:227], a[184:187], v[184:187]
s_waitcnt lgkmcnt(8)
v_mfma_f32_16x16x32_bf16 v[188:191], a[240:243], a[184:187], v[188:191]
buffer_load_dwordx4 v14, s[36:39], s55 offen offset:2048 lds
v_mfma_f32_16x16x32_bf16 v[188:191], a[244:247], a[188:191], v[188:191]
ds_read_b64_tr_b16 a[224:225], v7 offset:0
v_mfma_f32_16x16x32_bf16 v[188:191], a[248:251], a[216:219], v[188:191]
ds_read_b64_tr_b16 a[226:227], v7 offset:2048
v_mfma_f32_16x16x32_bf16 v[188:191], a[252:255], a[220:223], v[188:191]
v_mfma_f32_16x16x32_bf16 v[172:175], a[252:255], a[212:215], v[172:175]
ds_read_b64_tr_b16 a[228:229], v7 offset:4096
v_mfma_f32_16x16x32_bf16 v[172:175], a[248:251], a[208:211], v[172:175]
v_mfma_f32_16x16x32_bf16 v[172:175], a[244:247], a[180:183], v[172:175]
ds_read_b64_tr_b16 a[230:231], v7 offset:6144
v_mfma_f32_16x16x32_bf16 v[172:175], a[240:243], a[176:179], v[172:175]
v_mfma_f32_16x16x32_bf16 v[156:159], a[240:243], a[168:171], v[156:159]
ds_read_b64_tr_b16 a[232:233], v7 offset:8192
v_mfma_f32_16x16x32_bf16 v[156:159], a[244:247], a[172:175], v[156:159]
v_mfma_f32_16x16x32_bf16 v[156:159], a[248:251], a[200:203], v[156:159]
ds_read_b64_tr_b16 a[234:235], v7 offset:10240
v_mfma_f32_16x16x32_bf16 v[156:159], a[252:255], a[204:207], v[156:159]
buffer_load_dwordx4 v3, s[36:39], s55 offen offset:3072 lds
v_mfma_f32_16x16x32_bf16 v[140:143], a[252:255], a[196:199], v[140:143]
s_bfe_u32 s55, 0x2400, s99
ds_read_b64_tr_b16 a[236:237], v7 offset:12288
s_lshl4_add_u32 m0, s55, s100
v_mfma_f32_16x16x32_bf16 v[140:143], a[248:251], a[192:195], v[140:143]
s_mov_b32 s55, 5046272
s_mov_b32 s56, 4325376
v_mfma_f32_16x16x32_bf16 v[140:143], a[244:247], a[164:167], v[140:143]
ds_read_b64_tr_b16 a[238:239], v7 offset:14336
v_mfma_f32_16x16x32_bf16 v[140:143], a[240:243], a[160:163], v[140:143]
s_waitcnt lgkmcnt(8)
v_mfma_f32_16x16x32_bf16 v[192:195], a[96:99], a[160:163], v[192:195]
ds_read_b64_tr_b16 a[240:241], v6 offset:1024
v_mfma_f32_16x16x32_bf16 v[192:195], a[100:103], a[164:167], v[192:195]
v_mfma_f32_16x16x32_bf16 v[192:195], a[104:107], a[192:195], v[192:195]
ds_read_b64_tr_b16 a[242:243], v6 offset:3072
v_mfma_f32_16x16x32_bf16 v[192:195], a[108:111], a[196:199], v[192:195]
v_mfma_f32_16x16x32_bf16 v[200:203], a[108:111], a[204:207], v[200:203]
ds_read_b64_tr_b16 a[244:245], v6 offset:5120
v_mfma_f32_16x16x32_bf16 v[200:203], a[104:107], a[200:203], v[200:203]
v_mfma_f32_16x16x32_bf16 v[200:203], a[100:103], a[172:175], v[200:203]
buffer_load_dwordx4 v15, s[12:15], s56 offen offset:0 lds
v_mfma_f32_16x16x32_bf16 v[200:203], a[96:99], a[168:171], v[200:203]
ds_read_b64_tr_b16 a[246:247], v6 offset:7168
v_mfma_f32_16x16x32_bf16 v[208:211], a[96:99], a[176:179], v[208:211]
ds_read_b64_tr_b16 a[248:249], v6 offset:9216
v_mfma_f32_16x16x32_bf16 v[208:211], a[100:103], a[180:183], v[208:211]
v_mfma_f32_16x16x32_bf16 v[208:211], a[104:107], a[208:211], v[208:211]
ds_read_b64_tr_b16 a[250:251], v6 offset:11264
v_mfma_f32_16x16x32_bf16 v[208:211], a[108:111], a[212:215], v[208:211]
v_mfma_f32_16x16x32_bf16 v[216:219], a[108:111], a[220:223], v[216:219]
ds_read_b64_tr_b16 a[252:253], v6 offset:13312
v_mfma_f32_16x16x32_bf16 v[216:219], a[104:107], a[216:219], v[216:219]
v_mfma_f32_16x16x32_bf16 v[216:219], a[100:103], a[188:191], v[216:219]
ds_read_b64_tr_b16 a[254:255], v6 offset:15360
v_mfma_f32_16x16x32_bf16 v[216:219], a[96:99], a[184:187], v[216:219]
s_waitcnt lgkmcnt(8)
v_mfma_f32_16x16x32_bf16 v[220:223], a[224:227], a[184:187], v[220:223]
ds_read_b64_tr_b16 a[96:97], v7 offset:1024
v_mfma_f32_16x16x32_bf16 v[220:223], a[228:231], a[188:191], v[220:223]
buffer_load_dwordx4 v13, s[36:39], s55 offen offset:1024 lds
v_mfma_f32_16x16x32_bf16 v[220:223], a[232:235], a[216:219], v[220:223]
ds_read_b64_tr_b16 a[98:99], v7 offset:3072
v_mfma_f32_16x16x32_bf16 v[220:223], a[236:239], a[220:223], v[220:223]
v_mfma_f32_16x16x32_bf16 v[212:215], a[236:239], a[212:215], v[212:215]
ds_read_b64_tr_b16 a[100:101], v7 offset:5120
v_mfma_f32_16x16x32_bf16 v[212:215], a[232:235], a[208:211], v[212:215]
v_mfma_f32_16x16x32_bf16 v[212:215], a[228:231], a[180:183], v[212:215]
ds_read_b64_tr_b16 a[102:103], v7 offset:7168
v_mfma_f32_16x16x32_bf16 v[212:215], a[224:227], a[176:179], v[212:215]
v_mfma_f32_16x16x32_bf16 v[204:207], a[224:227], a[168:171], v[204:207]
s_load_dword s101, s[92:93], 24568
ds_read_b64_tr_b16 a[104:105], v7 offset:9216
v_mfma_f32_16x16x32_bf16 v[204:207], a[228:231], a[172:175], v[204:207]
v_mfma_f32_16x16x32_bf16 v[204:207], a[232:235], a[200:203], v[204:207]
ds_read_b64_tr_b16 a[106:107], v7 offset:11264
v_mfma_f32_16x16x32_bf16 v[204:207], a[236:239], a[204:207], v[204:207]
v_mfma_f32_16x16x32_bf16 v[196:199], a[236:239], a[196:199], v[196:199]
buffer_load_dwordx4 v14, s[36:39], s55 offen offset:2048 lds
v_mfma_f32_16x16x32_bf16 v[196:199], a[232:235], a[192:195], v[196:199]
ds_read_b64_tr_b16 a[108:109], v7 offset:13312
v_mfma_f32_16x16x32_bf16 v[196:199], a[228:231], a[164:167], v[196:199]
ds_read_b64_tr_b16 a[110:111], v7 offset:15360
v_mfma_f32_16x16x32_bf16 v[196:199], a[224:227], a[160:163], v[196:199]
s_waitcnt vmcnt(15) lgkmcnt(8)
s_barrier
v_mfma_f32_16x16x32_bf16 v[224:227], a[160:163], a[240:243], v[224:227]
ds_read_b64_tr_b16 a[224:225], v6 offset:16384
v_mfma_f32_16x16x32_bf16 v[224:227], a[164:167], a[244:247], v[224:227]
v_mfma_f32_16x16x32_bf16 v[224:227], a[192:195], a[248:251], v[224:227]
v_mfma_f32_16x16x32_bf16 v[224:227], a[196:199], a[252:255], v[224:227]
v_mfma_f32_16x16x32_bf16 v[228:231], a[204:207], a[252:255], v[228:231]
ds_read_b64_tr_b16 a[226:227], v6 offset:20480
v_mfma_f32_16x16x32_bf16 v[228:231], a[200:203], a[248:251], v[228:231]
v_mfma_f32_16x16x32_bf16 v[228:231], a[172:175], a[244:247], v[228:231]
buffer_load_dwordx4 v3, s[36:39], s55 offen offset:3072 lds
v_mfma_f32_16x16x32_bf16 v[228:231], a[168:171], a[240:243], v[228:231]
s_bfe_u32 s55, 0x4000200, s99
s_lshl4_add_u32 m0, s55, s100
s_mov_b32 s55, 4587520
v_mfma_f32_16x16x32_bf16 v[232:235], a[176:179], a[240:243], v[232:235]
s_mov_b32 s56, 3932160
ds_read_b64_tr_b16 a[228:229], v6 offset:24576
v_mfma_f32_16x16x32_bf16 v[232:235], a[180:183], a[244:247], v[232:235]
v_mfma_f32_16x16x32_bf16 v[232:235], a[208:211], a[248:251], v[232:235]
v_mfma_f32_16x16x32_bf16 v[232:235], a[212:215], a[252:255], v[232:235]
v_mfma_f32_16x16x32_bf16 v[236:239], a[220:223], a[252:255], v[236:239]
ds_read_b64_tr_b16 a[230:231], v6 offset:28672
v_mfma_f32_16x16x32_bf16 v[236:239], a[216:219], a[248:251], v[236:239]
v_mfma_f32_16x16x32_bf16 v[236:239], a[188:191], a[244:247], v[236:239]
v_mfma_f32_16x16x32_bf16 v[236:239], a[184:187], a[240:243], v[236:239]
s_waitcnt lgkmcnt(4)
v_mfma_f32_16x16x32_bf16 v[252:255], a[184:187], a[96:99], v[252:255]
ds_read_b64_tr_b16 a[232:233], v7 offset:16384
v_mfma_f32_16x16x32_bf16 v[252:255], a[188:191], a[100:103], v[252:255]
buffer_load_dwordx4 v15, s[12:15], s56 offen offset:0 lds
v_mfma_f32_16x16x32_bf16 v[252:255], a[216:219], a[104:107], v[252:255]
ds_read_b64_tr_b16 a[234:235], v7 offset:20480
v_mfma_f32_16x16x32_bf16 v[252:255], a[220:223], a[108:111], v[252:255]
v_mfma_f32_16x16x32_bf16 v[248:251], a[212:215], a[108:111], v[248:251]
ds_read_b64_tr_b16 a[236:237], v7 offset:24576
v_mfma_f32_16x16x32_bf16 v[248:251], a[208:211], a[104:107], v[248:251]
v_mfma_f32_16x16x32_bf16 v[248:251], a[180:183], a[100:103], v[248:251]
ds_read_b64_tr_b16 a[238:239], v7 offset:28672
v_mfma_f32_16x16x32_bf16 v[248:251], a[176:179], a[96:99], v[248:251]
v_mfma_f32_16x16x32_bf16 v[244:247], a[168:171], a[96:99], v[244:247]
ds_read_b64_tr_b16 a[240:241], v11 offset:17408
v_mfma_f32_16x16x32_bf16 v[244:247], a[172:175], a[100:103], v[244:247]
v_mfma_f32_16x16x32_bf16 v[244:247], a[200:203], a[104:107], v[244:247]
ds_read_b64_tr_b16 a[242:243], v11 offset:18944
v_mfma_f32_16x16x32_bf16 v[244:247], a[204:207], a[108:111], v[244:247]
v_mfma_f32_16x16x32_bf16 v[240:243], a[196:199], a[108:111], v[240:243]
buffer_load_dwordx4 v13, s[36:39], s55 offen offset:1024 lds
v_mfma_f32_16x16x32_bf16 v[240:243], a[192:195], a[104:107], v[240:243]
ds_read_b64_tr_b16 a[244:245], v11 offset:21504
v_mfma_f32_16x16x32_bf16 v[240:243], a[164:167], a[100:103], v[240:243]
ds_read_b64_tr_b16 a[246:247], v11 offset:23040
v_mfma_f32_16x16x32_bf16 v[240:243], a[160:163], a[96:99], v[240:243]
s_waitcnt lgkmcnt(8)
v_mfma_f32_16x16x32_bf16 a[64:67], a[224:227], a[192:195], 0
ds_read_b64_tr_b16 a[248:249], v11 offset:17440
v_mfma_f32_16x16x32_bf16 a[64:67], a[228:231], a[196:199], a[64:67]
v_mul_f32 v160, s57, v160
v_mul_f32 v161, s57, v161
v_mfma_f32_16x16x32_bf16 a[72:75], a[228:231], a[204:207], 0
ds_read_b64_tr_b16 a[250:251], v11 offset:18976
v_mul_f32 v162, s57, v162
v_mfma_f32_16x16x32_bf16 a[72:75], a[224:227], a[200:203], a[72:75]
v_exp_f32 v160, v160
v_mfma_f32_16x16x32_bf16 a[80:83], a[224:227], a[208:211], 0
ds_read_b64_tr_b16 a[252:253], v11 offset:21536
v_mul_f32 v163, s57, v163
v_mfma_f32_16x16x32_bf16 a[80:83], a[228:231], a[212:215], a[80:83]
v_exp_f32 v161, v161
v_mfma_f32_16x16x32_bf16 a[88:91], a[228:231], a[220:223], 0
ds_read_b64_tr_b16 a[254:255], v11 offset:23072
v_mul_f32 v164, s57, v164
v_mfma_f32_16x16x32_bf16 a[88:91], a[224:227], a[216:219], a[88:91]
s_waitcnt lgkmcnt(8)
buffer_load_dwordx4 v14, s[36:39], s55 offen offset:2048 lds
v_mul_f32 v165, s57, v165
v_mfma_f32_16x16x32_bf16 a[92:95], a[232:235], a[216:219], 0
ds_read_b64_tr_b16 a[224:225], v11 offset:17472
v_mul_f32 v166, s57, v166
v_mfma_f32_16x16x32_bf16 a[92:95], a[236:239], a[220:223], a[92:95]
v_exp_f32 v162, v162
v_mfma_f32_16x16x32_bf16 a[84:87], a[236:239], a[212:215], 0
ds_read_b64_tr_b16 a[226:227], v11 offset:19008
v_mul_f32 v167, s57, v167
v_mfma_f32_16x16x32_bf16 a[84:87], a[232:235], a[208:211], a[84:87]
v_exp_f32 v163, v163
v_mfma_f32_16x16x32_bf16 a[76:79], a[232:235], a[200:203], 0
ds_read_b64_tr_b16 a[228:229], v11 offset:21568
v_add_f32 v160, 1.0, v160
v_mfma_f32_16x16x32_bf16 a[76:79], a[236:239], a[204:207], a[76:79]
v_exp_f32 v164, v164
v_mfma_f32_16x16x32_bf16 a[68:71], a[236:239], a[196:199], 0
ds_read_b64_tr_b16 a[230:231], v11 offset:23104
v_add_f32 v161, 1.0, v161
v_mfma_f32_16x16x32_bf16 a[68:71], a[232:235], a[192:195], a[68:71]
s_waitcnt lgkmcnt(8)
v_exp_f32 v165, v165
v_add_f32 v162, 1.0, v162
v_mfma_f32_16x16x32_bf16 a[0:3], a[240:243], a[192:195], 0
buffer_load_dwordx4 v3, s[36:39], s55 offen offset:3072 lds
v_mfma_f32_16x16x32_bf16 a[0:3], a[244:247], a[196:199], a[0:3]
s_bfe_u32 s55, 0x8000600, s99
ds_read_b64_tr_b16 a[232:233], v11 offset:25600
v_add_f32 v163, 1.0, v163
v_mfma_f32_16x16x32_bf16 a[16:19], a[244:247], a[204:207], 0
s_lshl4_add_u32 m0, s55, s100
ds_read_b64_tr_b16 a[234:235], v11 offset:27136
v_add_f32 v164, 1.0, v164
v_mfma_f32_16x16x32_bf16 a[16:19], a[240:243], a[200:203], a[16:19]
s_mov_b32 s55, 4128768
v_exp_f32 v166, v166
v_mfma_f32_16x16x32_bf16 a[32:35], a[240:243], a[208:211], 0
s_mov_b32 s56, 3538944
ds_read_b64_tr_b16 a[236:237], v11 offset:29696
v_add_f32 v165, 1.0, v165
v_mfma_f32_16x16x32_bf16 a[32:35], a[244:247], a[212:215], a[32:35]
v_exp_f32 v167, v167
v_mfma_f32_16x16x32_bf16 a[48:51], a[244:247], a[220:223], 0
ds_read_b64_tr_b16 a[238:239], v11 offset:31232
v_add_f32 v166, 1.0, v166
v_mfma_f32_16x16x32_bf16 a[48:51], a[240:243], a[216:219], a[48:51]
s_waitcnt lgkmcnt(8)
v_add_f32 v167, 1.0, v167
v_rcp_f32 v160, v160
v_mfma_f32_16x16x32_bf16 a[52:55], a[248:251], a[216:219], 0
buffer_load_dwordx4 v15, s[12:15], s56 offen offset:0 lds
v_mfma_f32_16x16x32_bf16 a[52:55], a[252:255], a[220:223], a[52:55]
ds_read_b64_tr_b16 a[240:241], v11 offset:25632
v_mul_f32 v176, s57, v176
v_mfma_f32_16x16x32_bf16 a[36:39], a[252:255], a[212:215], 0
ds_read_b64_tr_b16 a[242:243], v11 offset:27168
v_mul_f32 v177, s57, v177
v_mfma_f32_16x16x32_bf16 a[36:39], a[248:251], a[208:211], a[36:39]
v_rcp_f32 v161, v161
v_mfma_f32_16x16x32_bf16 a[20:23], a[248:251], a[200:203], 0
ds_read_b64_tr_b16 a[244:245], v11 offset:29728
v_mul_f32 v178, s57, v178
v_mfma_f32_16x16x32_bf16 a[20:23], a[252:255], a[204:207], a[20:23]
v_rcp_f32 v162, v162
v_mfma_f32_16x16x32_bf16 a[4:7], a[252:255], a[196:199], 0
ds_read_b64_tr_b16 a[246:247], v11 offset:31264
v_mul_f32 v179, s57, v179
v_mfma_f32_16x16x32_bf16 a[4:7], a[248:251], a[192:195], a[4:7]
s_waitcnt lgkmcnt(8)
v_rcp_f32 v163, v163
v_mul_f32 v180, s57, v180
v_mfma_f32_16x16x32_bf16 a[96:99], a[224:227], a[192:195], 0
ds_read_b64_tr_b16 a[248:249], v11 offset:25664
v_mul_f32 v181, s57, v181
v_mfma_f32_16x16x32_bf16 a[96:99], a[228:231], a[196:199], a[96:99]
buffer_load_dwordx4 v13, s[36:39], s55 offen offset:1024 lds
v_mfma_f32_16x16x32_bf16 a[104:107], a[228:231], a[204:207], 0
ds_read_b64_tr_b16 a[250:251], v11 offset:27200
v_mul_f32 v182, s57, v182
v_mfma_f32_16x16x32_bf16 a[104:107], a[224:227], a[200:203], a[104:107]
v_rcp_f32 v164, v164
v_mfma_f32_16x16x32_bf16 a[112:115], a[224:227], a[208:211], 0
ds_read_b64_tr_b16 a[252:253], v11 offset:29760
v_mul_f32 v183, s57, v183
v_mfma_f32_16x16x32_bf16 a[112:115], a[228:231], a[212:215], a[112:115]
v_rcp_f32 v165, v165
v_mfma_f32_16x16x32_bf16 a[120:123], a[228:231], a[220:223], 0
ds_read_b64_tr_b16 a[254:255], v11 offset:31296
v_mul_f32 v160, v160, v168
v_mfma_f32_16x16x32_bf16 a[120:123], a[224:227], a[216:219], a[120:123]
s_waitcnt vmcnt(18) lgkmcnt(8)
s_barrier
v_mul_f32 v161, v161, v169
v_mfma_f32_16x16x32_bf16 a[56:59], a[232:235], a[216:219], 0
ds_read_b64_tr_b16 a[224:225], v6 offset:32768
v_mul_f32 v162, v162, v170
v_mfma_f32_16x16x32_bf16 a[56:59], a[236:239], a[220:223], a[56:59]
buffer_load_dwordx4 v14, s[36:39], s55 offen offset:2048 lds
v_mfma_f32_16x16x32_bf16 a[40:43], a[236:239], a[212:215], 0
s_add_u32 s4, s59, 294912
ds_read_b64_tr_b16 a[226:227], v6 offset:36864
v_mul_f32 v163, v163, v171
v_mfma_f32_16x16x32_bf16 a[40:43], a[232:235], a[208:211], a[40:43]
v_rcp_f32 v166, v166
v_mfma_f32_16x16x32_bf16 a[24:27], a[232:235], a[200:203], 0
ds_read_b64_tr_b16 a[228:229], v6 offset:40960
v_mul_f32 v164, v164, v172
v_mfma_f32_16x16x32_bf16 a[24:27], a[236:239], a[204:207], a[24:27]
v_rcp_f32 v167, v167
v_mfma_f32_16x16x32_bf16 a[8:11], a[236:239], a[196:199], 0
ds_read_b64_tr_b16 a[230:231], v6 offset:45056
v_mul_f32 v165, v165, v173
v_mfma_f32_16x16x32_bf16 a[8:11], a[232:235], a[192:195], a[8:11]
s_waitcnt lgkmcnt(8)
v_exp_f32 v176, v176
v_mul_f32 v166, v166, v174
v_mfma_f32_16x16x32_bf16 a[12:15], a[240:243], a[192:195], 0
ds_read_b64_tr_b16 a[232:233], v7 offset:32768
v_mul_f32 v167, v167, v175
v_mfma_f32_16x16x32_bf16 a[12:15], a[244:247], a[196:199], a[12:15]
v_exp_f32 v177, v177
v_mfma_f32_16x16x32_bf16 a[28:31], a[244:247], a[204:207], 0
buffer_load_dwordx4 v3, s[36:39], s55 offen offset:3072 lds
v_mfma_f32_16x16x32_bf16 a[28:31], a[240:243], a[200:203], a[28:31]
s_bfe_u32 s55, 0xc000a00, s99
ds_read_b64_tr_b16 a[234:235], v7 offset:36864
v_cvt_pk_bf16_f32 v160, v160, v161
v_mfma_f32_16x16x32_bf16 a[44:47], a[240:243], a[208:211], 0
s_lshl4_add_u32 m0, s55, s100
ds_read_b64_tr_b16 a[236:237], v7 offset:40960
v_add_f32 v176, 1.0, v176
v_mfma_f32_16x16x32_bf16 a[44:47], a[244:247], a[212:215], a[44:47]
s_mov_b32 s55, 3670016
v_exp_f32 v178, v178
v_mfma_f32_16x16x32_bf16 a[60:63], a[244:247], a[220:223], 0
s_mov_b32 s56, 3145728
ds_read_b64_tr_b16 a[238:239], v7 offset:45056
v_cvt_pk_bf16_f32 v161, v162, v163
v_mfma_f32_16x16x32_bf16 a[60:63], a[240:243], a[216:219], a[60:63]
s_waitcnt lgkmcnt(8)
v_exp_f32 v179, v179
v_add_f32 v177, 1.0, v177
v_mfma_f32_16x16x32_bf16 a[124:127], a[248:251], a[216:219], 0
ds_read_b64_tr_b16 a[240:241], v11 offset:33792
v_cvt_pk_bf16_f32 v162, v164, v165
v_mfma_f32_16x16x32_bf16 a[124:127], a[252:255], a[220:223], a[124:127]
v_exp_f32 v180, v180
v_mfma_f32_16x16x32_bf16 a[116:119], a[252:255], a[212:215], 0
buffer_load_dwordx4 v15, s[12:15], s56 offen offset:0 lds
v_mfma_f32_16x16x32_bf16 a[116:119], a[248:251], a[208:211], a[116:119]
ds_read_b64_tr_b16 a[242:243], v11 offset:35328
v_add_f32 v178, 1.0, v178
v_mfma_f32_16x16x32_bf16 a[108:111], a[248:251], a[200:203], 0
ds_read_b64_tr_b16 a[244:245], v11 offset:37888
v_cvt_pk_bf16_f32 v163, v166, v167
v_mfma_f32_16x16x32_bf16 a[108:111], a[252:255], a[204:207], a[108:111]
v_exp_f32 v181, v181
v_mfma_f32_16x16x32_bf16 a[100:103], a[252:255], a[196:199], 0
ds_read_b64_tr_b16 a[246:247], v11 offset:39424
v_add_f32 v179, 1.0, v179
v_mfma_f32_16x16x32_bf16 a[100:103], a[248:251], a[192:195], a[100:103]
s_waitcnt lgkmcnt(8)
v_exp_f32 v182, v182
v_add_f32 v180, 1.0, v180
v_mfma_f32_16x16x32_bf16 a[64:67], a[224:227], a[160:163], a[64:67]
ds_read_b64_tr_b16 a[248:249], v11 offset:33824
v_add_f32 v181, 1.0, v181
v_mfma_f32_16x16x32_bf16 a[64:67], a[228:231], a[164:167], a[64:67]
v_exp_f32 v183, v183
v_mfma_f32_16x16x32_bf16 a[72:75], a[228:231], a[172:175], a[72:75]
ds_read_b64_tr_b16 a[250:251], v11 offset:35360
v_add_f32 v182, 1.0, v182
v_mfma_f32_16x16x32_bf16 a[72:75], a[224:227], a[168:171], a[72:75]
buffer_store_dwordx4 v[160:163], v1, s[24:27], s4 offen offset:2048 sc1
v_add_f32 v183, 1.0, v183
v_rcp_f32 v176, v176
v_mfma_f32_16x16x32_bf16 a[80:83], a[224:227], a[176:179], a[80:83]
ds_read_b64_tr_b16 a[252:253], v11 offset:37920
v_mul_f32 v96, s57, v96
v_mfma_f32_16x16x32_bf16 a[80:83], a[228:231], a[180:183], a[80:83]
v_rcp_f32 v177, v177
v_mfma_f32_16x16x32_bf16 a[88:91], a[228:231], a[188:191], a[88:91]
ds_read_b64_tr_b16 a[254:255], v11 offset:39456
v_mul_f32 v97, s57, v97
v_mfma_f32_16x16x32_bf16 a[88:91], a[224:227], a[184:187], a[88:91]
s_waitcnt lgkmcnt(8)
buffer_load_dwordx4 v13, s[36:39], s55 offen offset:1024 lds
v_mul_f32 v98, s57, v98
v_mfma_f32_16x16x32_bf16 a[92:95], a[232:235], a[184:187], a[92:95]
ds_read_b64_tr_b16 a[224:225], v11 offset:33856
v_mul_f32 v99, s57, v99
v_mfma_f32_16x16x32_bf16 a[92:95], a[236:239], a[188:191], a[92:95]
v_rcp_f32 v178, v178
v_mfma_f32_16x16x32_bf16 a[84:87], a[236:239], a[180:183], a[84:87]
ds_read_b64_tr_b16 a[226:227], v11 offset:35392
v_mul_f32 v100, s57, v100
v_mfma_f32_16x16x32_bf16 a[84:87], a[232:235], a[176:179], a[84:87]
v_rcp_f32 v179, v179
v_mfma_f32_16x16x32_bf16 a[76:79], a[232:235], a[168:171], a[76:79]
ds_read_b64_tr_b16 a[228:229], v11 offset:37952
v_mul_f32 v101, s57, v101
v_mfma_f32_16x16x32_bf16 a[76:79], a[236:239], a[172:175], a[76:79]
v_rcp_f32 v180, v180
v_mfma_f32_16x16x32_bf16 a[68:71], a[236:239], a[164:167], a[68:71]
buffer_load_dwordx4 v14, s[36:39], s55 offen offset:2048 lds
v_mfma_f32_16x16x32_bf16 a[68:71], a[232:235], a[160:163], a[68:71]
s_waitcnt lgkmcnt(7)
ds_read_b64_tr_b16 a[230:231], v11 offset:39488
v_rcp_f32 v181, v181
v_mfma_f32_16x16x32_bf16 a[0:3], a[240:243], a[160:163], a[0:3]
pg_5:
s_cbranch_execz pg_t9
ds_read_b64_tr_b16 a[232:233], v11 offset:41984
v_mul_f32 v102, s57, v102
v_mfma_f32_16x16x32_bf16 a[0:3], a[244:247], a[164:167], a[0:3]
v_rcp_f32 v182, v182
v_mfma_f32_16x16x32_bf16 a[16:19], a[244:247], a[172:175], a[16:19]
ds_read_b64_tr_b16 a[234:235], v11 offset:43520
v_mul_f32 v103, s57, v103
v_mfma_f32_16x16x32_bf16 a[16:19], a[240:243], a[168:171], a[16:19]
v_rcp_f32 v183, v183
v_mfma_f32_16x16x32_bf16 a[32:35], a[240:243], a[176:179], a[32:35]
ds_read_b64_tr_b16 a[236:237], v11 offset:46080
v_mul_f32 v176, v176, v184
v_mfma_f32_16x16x32_bf16 a[32:35], a[244:247], a[180:183], a[32:35]
v_exp_f32 v96, v96
v_mfma_f32_16x16x32_bf16 a[48:51], a[244:247], a[188:191], a[48:51]
ds_read_b64_tr_b16 a[238:239], v11 offset:47616
v_mul_f32 v177, v177, v185
v_mfma_f32_16x16x32_bf16 a[48:51], a[240:243], a[184:187], a[48:51]
s_waitcnt lgkmcnt(8)
buffer_load_dwordx4 v3, s[36:39], s55 offen offset:3072 lds
v_mul_f32 v178, v178, v186
v_mfma_f32_16x16x32_bf16 a[52:55], a[248:251], a[184:187], a[52:55]
s_add_u32 s54, s53, 98304
ds_read_b64_tr_b16 a[240:241], v11 offset:42016
v_mul_f32 v179, v179, v187
v_mfma_f32_16x16x32_bf16 a[52:55], a[252:255], a[188:191], a[52:55]
v_exp_f32 v97, v97
v_mfma_f32_16x16x32_bf16 a[36:39], a[252:255], a[180:183], a[36:39]
ds_read_b64_tr_b16 a[242:243], v11 offset:43552
v_mul_f32 v180, v180, v188
v_mfma_f32_16x16x32_bf16 a[36:39], a[248:251], a[176:179], a[36:39]
v_exp_f32 v98, v98
v_mfma_f32_16x16x32_bf16 a[20:23], a[248:251], a[168:171], a[20:23]
ds_read_b64_tr_b16 a[244:245], v11 offset:46112
v_mul_f32 v181, v181, v189
v_mfma_f32_16x16x32_bf16 a[20:23], a[252:255], a[172:175], a[20:23]
v_exp_f32 v99, v99
v_mfma_f32_16x16x32_bf16 a[4:7], a[252:255], a[164:167], a[4:7]
ds_read_b64_tr_b16 a[246:247], v11 offset:47648
v_mul_f32 v182, v182, v190
v_mfma_f32_16x16x32_bf16 a[4:7], a[248:251], a[160:163], a[4:7]
s_waitcnt lgkmcnt(8)
v_exp_f32 v100, v100
v_mul_f32 v183, v183, v191
v_mfma_f32_16x16x32_bf16 a[96:99], a[224:227], a[160:163], a[96:99]
buffer_load_dwordx4 a[192:195], v1, s[24:27], s54 offen offset:0 sc1
v_mfma_f32_16x16x32_bf16 a[96:99], a[228:231], a[164:167], a[96:99]
ds_read_b64_tr_b16 a[248:249], v11 offset:42048
v_cvt_pk_bf16_f32 v176, v176, v177
v_mfma_f32_16x16x32_bf16 a[104:107], a[228:231], a[172:175], a[104:107]
ds_read_b64_tr_b16 a[250:251], v11 offset:43584
v_add_f32 v96, 1.0, v96
v_mfma_f32_16x16x32_bf16 a[104:107], a[224:227], a[168:171], a[104:107]
v_exp_f32 v101, v101
v_mfma_f32_16x16x32_bf16 a[112:115], a[224:227], a[176:179], a[112:115]
buffer_load_dwordx4 a[196:199], v1, s[24:27], s54 offen offset:1024 sc1
v_mfma_f32_16x16x32_bf16 a[112:115], a[228:231], a[180:183], a[112:115]
ds_read_b64_tr_b16 a[252:253], v11 offset:46144
v_cvt_pk_bf16_f32 v177, v178, v179
v_mfma_f32_16x16x32_bf16 a[120:123], a[228:231], a[188:191], a[120:123]
ds_read_b64_tr_b16 a[254:255], v11 offset:47680
v_add_f32 v97, 1.0, v97
v_mfma_f32_16x16x32_bf16 a[120:123], a[224:227], a[184:187], a[120:123]
s_waitcnt vmcnt(23) lgkmcnt(8)
s_barrier
v_cvt_pk_bf16_f32 v178, v180, v181
v_mfma_f32_16x16x32_bf16 a[56:59], a[232:235], a[184:187], a[56:59]
buffer_load_dwordx4 a[200:203], v1, s[24:27], s54 offen offset:2048 sc1
v_mfma_f32_16x16x32_bf16 a[56:59], a[236:239], a[188:191], a[56:59]
ds_read_b64_tr_b16 a[224:225], v6 offset:49152
v_add_f32 v98, 1.0, v98
v_mfma_f32_16x16x32_bf16 a[40:43], a[236:239], a[180:183], a[40:43]
ds_read_b64_tr_b16 a[226:227], v6 offset:53248
v_cvt_pk_bf16_f32 v179, v182, v183
v_mfma_f32_16x16x32_bf16 a[40:43], a[232:235], a[176:179], a[40:43]
v_exp_f32 v102, v102
v_mfma_f32_16x16x32_bf16 a[24:27], a[232:235], a[168:171], a[24:27]
buffer_store_dwordx4 v[176:179], v1, s[24:27], s4 offen offset:3072 sc1
ds_read_b64_tr_b16 a[228:229], v6 offset:57344
v_exp_f32 v103, v103
v_mfma_f32_16x16x32_bf16 a[24:27], a[236:239], a[172:175], a[24:27]
v_add_f32 v99, 1.0, v99
v_add_f32 v100, 1.0, v100
v_mfma_f32_16x16x32_bf16 a[8:11], a[236:239], a[164:167], a[8:11]
ds_read_b64_tr_b16 a[230:231], v6 offset:61440
v_add_f32 v101, 1.0, v101
v_mfma_f32_16x16x32_bf16 a[8:11], a[232:235], a[160:163], a[8:11]
s_waitcnt lgkmcnt(8)
v_add_f32 v102, 1.0, v102
v_add_f32 v103, 1.0, v103
v_mul_f32 v112, s57, v112
v_mfma_f32_16x16x32_bf16 a[12:15], a[240:243], a[160:163], a[12:15]
buffer_load_dwordx4 a[204:207], v1, s[24:27], s54 offen offset:3072 sc1
v_mfma_f32_16x16x32_bf16 a[12:15], a[244:247], a[164:167], a[12:15]
ds_read_b64_tr_b16 a[232:233], v7 offset:49152
v_mul_f32 v113, s57, v113
v_mfma_f32_16x16x32_bf16 a[28:31], a[244:247], a[172:175], a[28:31]
ds_read_b64_tr_b16 a[234:235], v7 offset:53248
v_mul_f32 v114, s57, v114
v_mfma_f32_16x16x32_bf16 a[28:31], a[240:243], a[168:171], a[28:31]
buffer_load_dwordx4 a[208:211], v2, s[24:27], s54 offen offset:0 sc1
v_mfma_f32_16x16x32_bf16 a[44:47], a[240:243], a[176:179], a[44:47]
ds_read_b64_tr_b16 a[236:237], v7 offset:57344
v_mul_f32 v115, s57, v115
v_mfma_f32_16x16x32_bf16 a[44:47], a[244:247], a[180:183], a[44:47]
v_rcp_f32 v96, v96
v_mfma_f32_16x16x32_bf16 a[60:63], a[244:247], a[188:191], a[60:63]
ds_read_b64_tr_b16 a[238:239], v7 offset:61440
v_mul_f32 v116, s57, v116
v_mfma_f32_16x16x32_bf16 a[60:63], a[240:243], a[184:187], a[60:63]
s_waitcnt lgkmcnt(8)
buffer_load_dwordx4 a[212:215], v2, s[24:27], s54 offen offset:1024 sc1
v_mul_f32 v117, s57, v117
v_mfma_f32_16x16x32_bf16 a[124:127], a[248:251], a[184:187], a[124:127]
ds_read_b64_tr_b16 a[240:241], v11 offset:50176
v_mul_f32 v118, s57, v118
v_mfma_f32_16x16x32_bf16 a[124:127], a[252:255], a[188:191], a[124:127]
v_rcp_f32 v97, v97
v_mfma_f32_16x16x32_bf16 a[116:119], a[252:255], a[180:183], a[116:119]
ds_read_b64_tr_b16 a[242:243], v11 offset:51712
v_mul_f32 v119, s57, v119
v_mfma_f32_16x16x32_bf16 a[116:119], a[248:251], a[176:179], a[116:119]
v_rcp_f32 v98, v98
v_mfma_f32_16x16x32_bf16 a[108:111], a[248:251], a[168:171], a[108:111]
buffer_load_dwordx4 a[216:219], v2, s[24:27], s54 offen offset:2048 sc1
v_mfma_f32_16x16x32_bf16 a[108:111], a[252:255], a[172:175], a[108:111]
ds_read_b64_tr_b16 a[244:245], v11 offset:54272
v_mul_f32 v96, v96, v104
v_mfma_f32_16x16x32_bf16 a[100:103], a[252:255], a[164:167], a[100:103]
ds_read_b64_tr_b16 a[246:247], v11 offset:55808
v_mul_f32 v97, v97, v105
v_mfma_f32_16x16x32_bf16 a[100:103], a[248:251], a[160:163], a[100:103]
s_waitcnt lgkmcnt(8)
v_rcp_f32 v99, v99
v_mul_f32 v98, v98, v106
v_mfma_f32_16x16x32_bf16 a[64:67], a[224:227], a[128:131], a[64:67]
buffer_load_dwordx4 a[220:223], v2, s[24:27], s54 offen offset:3072 sc1
v_mfma_f32_16x16x32_bf16 a[64:67], a[228:231], a[132:135], a[64:67]
s_add_u32 s54, s53, 90112
ds_read_b64_tr_b16 a[248:249], v11 offset:50208
v_mul_f32 v99, v99, v107
v_mfma_f32_16x16x32_bf16 a[72:75], a[228:231], a[140:143], a[72:75]
ds_read_b64_tr_b16 a[250:251], v11 offset:51744
v_cvt_pk_bf16_f32 v96, v96, v97
v_mfma_f32_16x16x32_bf16 a[72:75], a[224:227], a[136:139], a[72:75]
v_rcp_f32 v100, v100
v_mfma_f32_16x16x32_bf16 a[80:83], a[224:227], a[144:147], a[80:83]
buffer_load_dwordx4 a[160:163], v1, s[24:27], s54 offen offset:0 sc1
v_mfma_f32_16x16x32_bf16 a[80:83], a[228:231], a[148:151], a[80:83]
ds_read_b64_tr_b16 a[252:253], v11 offset:54304
v_mul_f32 v100, v100, v108
v_mfma_f32_16x16x32_bf16 a[88:91], a[228:231], a[156:159], a[88:91]
ds_read_b64_tr_b16 a[254:255], v11 offset:55840
v_cvt_pk_bf16_f32 v97, v98, v99
v_mfma_f32_16x16x32_bf16 a[88:91], a[224:227], a[152:155], a[88:91]
s_waitcnt lgkmcnt(8)
v_rcp_f32 v101, v101
v_lshrrev_b32 v52, 2, v0
v_mfma_f32_16x16x32_bf16 a[92:95], a[232:235], a[152:155], a[92:95]
ds_read_b64_tr_b16 a[224:225], v11 offset:50240
v_mul_f32 v101, v101, v109
v_mfma_f32_16x16x32_bf16 a[92:95], a[236:239], a[156:159], a[92:95]
buffer_load_dwordx4 a[164:167], v1, s[24:27], s54 offen offset:1024 sc1
v_mfma_f32_16x16x32_bf16 a[84:87], a[236:239], a[148:151], a[84:87]
ds_read_b64_tr_b16 a[226:227], v11 offset:51776
v_cvt_pk_bf16_f32 v98, v100, v101
v_mfma_f32_16x16x32_bf16 a[84:87], a[232:235], a[144:147], a[84:87]
v_rcp_f32 v102, v102
v_mfma_f32_16x16x32_bf16 a[76:79], a[232:235], a[136:139], a[76:79]
ds_read_b64_tr_b16 a[228:229], v11 offset:54336
v_mul_f32 v102, v102, v110
v_mfma_f32_16x16x32_bf16 a[76:79], a[236:239], a[140:143], a[76:79]
buffer_load_dwordx4 a[168:171], v1, s[24:27], s54 offen offset:2048 sc1
v_mfma_f32_16x16x32_bf16 a[68:71], a[236:239], a[132:135], a[68:71]
ds_read_b64_tr_b16 a[230:231], v11 offset:55872
v_mul_f32 v128, s57, v128
v_mfma_f32_16x16x32_bf16 a[68:71], a[232:235], a[128:131], a[68:71]
s_waitcnt lgkmcnt(8)
v_rcp_f32 v103, v103
v_mul_f32 v129, s57, v129
v_mfma_f32_16x16x32_bf16 a[0:3], a[240:243], a[128:131], a[0:3]
ds_read_b64_tr_b16 a[232:233], v11 offset:58368
v_mul_f32 v103, v103, v111
v_mfma_f32_16x16x32_bf16 a[0:3], a[244:247], a[132:135], a[0:3]
buffer_load_dwordx4 a[172:175], v1, s[24:27], s54 offen offset:3072 sc1
v_mfma_f32_16x16x32_bf16 a[16:19], a[244:247], a[140:143], a[16:19]
ds_read_b64_tr_b16 a[234:235], v11 offset:59904
v_cvt_pk_bf16_f32 v99, v102, v103
v_mfma_f32_16x16x32_bf16 a[16:19], a[240:243], a[136:139], a[16:19]
v_exp_f32 v112, v112
v_mfma_f32_16x16x32_bf16 a[32:35], a[240:243], a[144:147], a[32:35]
ds_read_b64_tr_b16 a[236:237], v11 offset:62464
v_add_f32 v112, 1.0, v112
v_mfma_f32_16x16x32_bf16 a[32:35], a[244:247], a[148:151], a[32:35]
v_exp_f32 v113, v113
v_mfma_f32_16x16x32_bf16 a[48:51], a[244:247], a[156:159], a[48:51]
buffer_store_dwordx4 v[96:99], v1, s[24:27], s4 offen offset:0 sc1
ds_read_b64_tr_b16 a[238:239], v11 offset:64000
v_exp_f32 v114, v114
v_mfma_f32_16x16x32_bf16 a[48:51], a[240:243], a[152:155], a[48:51]
s_waitcnt lgkmcnt(8)
v_exp_f32 v115, v115
v_add_f32 v113, 1.0, v113
v_mfma_f32_16x16x32_bf16 a[52:55], a[248:251], a[152:155], a[52:55]
ds_read_b64_tr_b16 a[240:241], v11 offset:58400
v_add_f32 v114, 1.0, v114
v_mfma_f32_16x16x32_bf16 a[52:55], a[252:255], a[156:159], a[52:55]
buffer_load_dwordx4 a[176:179], v2, s[24:27], s54 offen offset:0 sc1
v_mfma_f32_16x16x32_bf16 a[36:39], a[252:255], a[148:151], a[36:39]
ds_read_b64_tr_b16 a[242:243], v11 offset:59936
v_add_f32 v115, 1.0, v115
v_mfma_f32_16x16x32_bf16 a[36:39], a[248:251], a[144:147], a[36:39]
v_exp_f32 v116, v116
v_mfma_f32_16x16x32_bf16 a[20:23], a[248:251], a[136:139], a[20:23]
buffer_load_dwordx4 a[180:183], v2, s[24:27], s54 offen offset:1024 sc1
v_mfma_f32_16x16x32_bf16 a[20:23], a[252:255], a[140:143], a[20:23]
ds_read_b64_tr_b16 a[244:245], v11 offset:62496
v_add_f32 v116, 1.0, v116
v_mfma_f32_16x16x32_bf16 a[4:7], a[252:255], a[132:135], a[4:7]
ds_read_b64_tr_b16 a[246:247], v11 offset:64032
v_mul_f32 v130, s57, v130
v_mfma_f32_16x16x32_bf16 a[4:7], a[248:251], a[128:131], a[4:7]
s_waitcnt lgkmcnt(8)
v_exp_f32 v117, v117
v_mul_f32 v131, s57, v131
v_mfma_f32_16x16x32_bf16 a[96:99], a[224:227], a[128:131], a[96:99]
buffer_load_dwordx4 a[184:187], v2, s[24:27], s54 offen offset:2048 sc1
v_mfma_f32_16x16x32_bf16 a[96:99], a[228:231], a[132:135], a[96:99]
ds_read_b64_tr_b16 a[248:249], v11 offset:58432
v_add_f32 v117, 1.0, v117
v_mfma_f32_16x16x32_bf16 a[104:107], a[228:231], a[140:143], a[104:107]
ds_read_b64_tr_b16 a[250:251], v11 offset:59968
v_mul_f32 v132, s57, v132
v_mfma_f32_16x16x32_bf16 a[104:107], a[224:227], a[136:139], a[104:107]
v_exp_f32 v118, v118
v_mfma_f32_16x16x32_bf16 a[112:115], a[224:227], a[144:147], a[112:115]
ds_read_b64_tr_b16 a[252:253], v11 offset:62528
v_add_f32 v118, 1.0, v118
v_mfma_f32_16x16x32_bf16 a[112:115], a[228:231], a[148:151], a[112:115]
buffer_load_dwordx4 a[188:191], v2, s[24:27], s54 offen offset:3072 sc1
v_mfma_f32_16x16x32_bf16 a[120:123], a[228:231], a[156:159], a[120:123]
s_bfe_u32 s55, 0x10000e00, s99
ds_read_b64_tr_b16 a[254:255], v11 offset:64064
v_mul_f32 v133, s57, v133
v_mfma_f32_16x16x32_bf16 a[120:123], a[224:227], a[152:155], a[120:123]
s_waitcnt vmcnt(35) lgkmcnt(8)
s_barrier
s_lshl4_add_u32 m0, s55, s100
v_mfma_f32_16x16x32_bf16 a[56:59], a[232:235], a[152:155], a[56:59]
s_mov_b32 s55, 3211264
ds_read_b64_tr_b16 a[224:225], v8 offset:0
s_mov_b32 s56, 2752512
v_mfma_f32_16x16x32_bf16 a[56:59], a[236:239], a[156:159], a[56:59]
buffer_load_dwordx4 v15, s[12:15], s56 offen offset:0 lds
v_mfma_f32_16x16x32_bf16 a[40:43], a[236:239], a[148:151], a[40:43]
ds_read_b64_tr_b16 a[226:227], v8 offset:4096
v_mul_f32 v134, s57, v134
v_mfma_f32_16x16x32_bf16 a[40:43], a[232:235], a[144:147], a[40:43]
v_exp_f32 v119, v119
v_mfma_f32_16x16x32_bf16 a[24:27], a[232:235], a[136:139], a[24:27]
ds_read_b64_tr_b16 a[228:229], v8 offset:8192
v_add_f32 v119, 1.0, v119
v_mfma_f32_16x16x32_bf16 a[24:27], a[236:239], a[140:143], a[24:27]
v_rcp_f32 v112, v112
v_mfma_f32_16x16x32_bf16 a[8:11], a[236:239], a[132:135], a[8:11]
ds_read_b64_tr_b16 a[230:231], v8 offset:12288
v_mul_f32 v135, s57, v135
v_mfma_f32_16x16x32_bf16 a[8:11], a[232:235], a[128:131], a[8:11]
s_waitcnt lgkmcnt(8)
v_rcp_f32 v113, v113
v_mul_f32 v112, v112, v120
v_mfma_f32_16x16x32_bf16 a[12:15], a[240:243], a[128:131], a[12:15]
ds_read_b64_tr_b16 a[232:233], v9 offset:0
v_mul_f32 v113, v113, v121
v_mfma_f32_16x16x32_bf16 a[12:15], a[244:247], a[132:135], a[12:15]
buffer_load_dwordx4 v13, s[36:39], s55 offen offset:1024 lds
v_mfma_f32_16x16x32_bf16 a[28:31], a[244:247], a[140:143], a[28:31]
ds_read_b64_tr_b16 a[234:235], v9 offset:4096
v_cvt_pk_bf16_f32 v112, v112, v113
v_mfma_f32_16x16x32_bf16 a[28:31], a[240:243], a[136:139], a[28:31]
v_rcp_f32 v114, v114
v_mfma_f32_16x16x32_bf16 a[44:47], a[240:243], a[144:147], a[44:47]
ds_read_b64_tr_b16 a[236:237], v9 offset:8192
v_mul_f32 v114, v114, v122
v_mfma_f32_16x16x32_bf16 a[44:47], a[244:247], a[148:151], a[44:47]
v_rcp_f32 v115, v115
v_mfma_f32_16x16x32_bf16 a[60:63], a[244:247], a[156:159], a[60:63]
ds_read_b64_tr_b16 a[238:239], v9 offset:12288
v_mul_f32 v115, v115, v123
v_mfma_f32_16x16x32_bf16 a[60:63], a[240:243], a[152:155], a[60:63]
s_waitcnt lgkmcnt(8)
v_rcp_f32 v116, v116
v_cvt_pk_bf16_f32 v113, v114, v115
v_mfma_f32_16x16x32_bf16 a[124:127], a[248:251], a[152:155], a[124:127]
ds_read_b64_tr_b16 a[240:241], v12 offset:1024
v_mul_f32 v116, v116, v124
v_mfma_f32_16x16x32_bf16 a[124:127], a[252:255], a[156:159], a[124:127]
v_rcp_f32 v117, v117
v_mfma_f32_16x16x32_bf16 a[116:119], a[252:255], a[148:151], a[116:119]
buffer_load_dwordx4 v14, s[36:39], s55 offen offset:2048 lds
v_mfma_f32_16x16x32_bf16 a[116:119], a[248:251], a[144:147], a[116:119]
ds_read_b64_tr_b16 a[242:243], v12 offset:2560
v_mul_f32 v117, v117, v125
v_mfma_f32_16x16x32_bf16 a[108:111], a[248:251], a[136:139], a[108:111]
ds_read_b64_tr_b16 a[244:245], v12 offset:5120
v_cvt_pk_bf16_f32 v114, v116, v117
v_mfma_f32_16x16x32_bf16 a[108:111], a[252:255], a[140:143], a[108:111]
v_rcp_f32 v118, v118
v_mfma_f32_16x16x32_bf16 a[100:103], a[252:255], a[132:135], a[100:103]
ds_read_b64_tr_b16 a[246:247], v12 offset:6656
v_mul_f32 v118, v118, v126
v_mfma_f32_16x16x32_bf16 a[100:103], a[248:251], a[128:131], a[100:103]
s_waitcnt vmcnt(12) lgkmcnt(8)
v_rcp_f32 v119, v119
v_lshlrev_b32 v52, 6, v52
v_mfma_f32_16x16x32_bf16 a[64:67], a[224:227], a[192:195], a[64:67]
s_load_dword s101, s[92:93], 28664
ds_read_b64_tr_b16 a[248:249], v12 offset:1056
v_mul_f32 v119, v119, v127
v_mfma_f32_16x16x32_bf16 a[64:67], a[228:231], a[196:199], a[64:67]
v_exp_f32 v128, v128
v_mfma_f32_16x16x32_bf16 a[72:75], a[228:231], a[204:207], a[72:75]
buffer_load_dwordx4 v3, s[36:39], s55 offen offset:3072 lds
v_mfma_f32_16x16x32_bf16 a[72:75], a[224:227], a[200:203], a[72:75]
s_add_u32 s54, s53, 81920
ds_read_b64_tr_b16 a[250:251], v12 offset:2592
v_add_f32 v128, 1.0, v128
v_mfma_f32_16x16x32_bf16 a[80:83], a[224:227], a[208:211], a[80:83]
ds_read_b64_tr_b16 a[252:253], v12 offset:5152
v_cvt_pk_bf16_f32 v115, v118, v119
v_mfma_f32_16x16x32_bf16 a[80:83], a[228:231], a[212:215], a[80:83]
v_exp_f32 v129, v129
v_mfma_f32_16x16x32_bf16 a[88:91], a[228:231], a[220:223], a[88:91]
ds_read_b64_tr_b16 a[254:255], v12 offset:6688
v_add_f32 v129, 1.0, v129
v_mfma_f32_16x16x32_bf16 a[88:91], a[224:227], a[216:219], a[88:91]
s_waitcnt lgkmcnt(8)
v_exp_f32 v130, v130
v_and_b32 v53, 3, v0
v_mfma_f32_16x16x32_bf16 a[92:95], a[232:235], a[216:219], a[92:95]
ds_read_b64_tr_b16 a[224:225], v12 offset:1088
v_add_f32 v130, 1.0, v130
v_mfma_f32_16x16x32_bf16 a[92:95], a[236:239], a[220:223], a[92:95]
v_exp_f32 v131, v131
v_mfma_f32_16x16x32_bf16 a[84:87], a[236:239], a[212:215], a[84:87]
ds_read_b64_tr_b16 a[226:227], v12 offset:2624
v_add_f32 v131, 1.0, v131
v_mfma_f32_16x16x32_bf16 a[84:87], a[232:235], a[208:211], a[84:87]
buffer_store_dwordx4 v[112:115], v1, s[24:27], s4 offen offset:1024 sc1
v_exp_f32 v132, v132
v_lshl_add_u32 v52, v53, 3, v52
v_mfma_f32_16x16x32_bf16 a[76:79], a[232:235], a[200:203], a[76:79]
ds_read_b64_tr_b16 a[228:229], v12 offset:5184
v_add_f32 v132, 1.0, v132
v_mfma_f32_16x16x32_bf16 a[76:79], a[236:239], a[204:207], a[76:79]
v_exp_f32 v133, v133
v_mfma_f32_16x16x32_bf16 a[68:71], a[236:239], a[196:199], a[68:71]
ds_read_b64_tr_b16 a[230:231], v12 offset:6720
v_add_f32 v133, 1.0, v133
v_mfma_f32_16x16x32_bf16 a[68:71], a[232:235], a[192:195], a[68:71]
s_waitcnt lgkmcnt(8)
buffer_load_dwordx4 a[128:131], v1, s[24:27], s54 offen offset:0 sc1
v_add_u32 v52, 155648, v52
v_mfma_f32_16x16x32_bf16 a[0:3], a[240:243], a[192:195], a[0:3]
ds_read_b64_tr_b16 v[40:41], v52 offset:0
ds_read_b64_tr_b16 a[232:233], v12 offset:9216
v_mfma_f32_16x16x32_bf16 a[0:3], a[244:247], a[196:199], a[0:3]
ds_read_b64_tr_b16 v[42:43], v52 offset:1024
v_cvt_pk_bf16_f32 v192, v192, v193
v_mfma_f32_16x16x32_bf16 a[16:19], a[244:247], a[204:207], a[16:19]
buffer_load_dwordx4 a[132:135], v1, s[24:27], s54 offen offset:1024 sc1
v_mfma_f32_16x16x32_bf16 a[16:19], a[240:243], a[200:203], a[16:19]
ds_read_b64_tr_b16 v[44:45], v52 offset:32
ds_read_b64_tr_b16 a[234:235], v12 offset:10752
v_mfma_f32_16x16x32_bf16 a[32:35], a[240:243], a[208:211], a[32:35]
ds_read_b64_tr_b16 v[46:47], v52 offset:1056
ds_read_b64_tr_b16 a[236:237], v12 offset:13312
v_mfma_f32_16x16x32_bf16 a[32:35], a[244:247], a[212:215], a[32:35]
v_exp_f32 v134, v134
v_mfma_f32_16x16x32_bf16 a[48:51], a[244:247], a[220:223], a[48:51]
buffer_load_dwordx4 a[136:139], v1, s[24:27], s54 offen offset:2048 sc1
v_mfma_f32_16x16x32_bf16 a[48:51], a[240:243], a[216:219], a[48:51]
s_waitcnt lgkmcnt(11)
ds_read_b64_tr_b16 a[238:239], v12 offset:14848
v_exp_f32 v135, v135
v_mfma_f32_16x16x32_bf16 a[52:55], a[248:251], a[216:219], a[52:55]
ds_read_b64_tr_b16 a[240:241], v12 offset:9248
v_add_f32 v134, 1.0, v134
v_mfma_f32_16x16x32_bf16 a[52:55], a[252:255], a[220:223], a[52:55]
v_add_f32 v135, 1.0, v135
v_mul_f32 v144, s57, v144
v_mfma_f32_16x16x32_bf16 a[36:39], a[252:255], a[212:215], a[36:39]
buffer_load_dwordx4 a[140:143], v1, s[24:27], s54 offen offset:3072 sc1
v_mfma_f32_16x16x32_bf16 a[36:39], a[248:251], a[208:211], a[36:39]
ds_read_b64_tr_b16 a[242:243], v12 offset:10784
v_mul_f32 v145, s57, v145
v_mfma_f32_16x16x32_bf16 a[20:23], a[248:251], a[200:203], a[20:23]
ds_read_b64_tr_b16 a[244:245], v12 offset:13344
v_mul_f32 v146, s57, v146
v_mfma_f32_16x16x32_bf16 a[20:23], a[252:255], a[204:207], a[20:23]
v_rcp_f32 v128, v128
v_mfma_f32_16x16x32_bf16 a[4:7], a[252:255], a[196:199], a[4:7]
ds_read_b64_tr_b16 a[246:247], v12 offset:14880
v_mul_f32 v147, s57, v147
v_mfma_f32_16x16x32_bf16 a[4:7], a[248:251], a[192:195], a[4:7]
s_waitcnt lgkmcnt(12)
buffer_load_dwordx4 a[144:147], v2, s[24:27], s54 offen offset:0 sc1
v_mul_f32 v148, s57, v148
v_mfma_f32_16x16x32_bf16 a[96:99], a[224:227], a[192:195], a[96:99]
ds_read_b64_tr_b16 a[248:249], v12 offset:9280
v_mul_f32 v149, s57, v149
v_mfma_f32_16x16x32_bf16 a[96:99], a[228:231], a[196:199], a[96:99]
v_rcp_f32 v129, v129
v_mfma_f32_16x16x32_bf16 a[104:107], a[228:231], a[204:207], a[104:107]
ds_read_b64_tr_b16 a[250:251], v12 offset:10816
v_mul_f32 v150, s57, v150
v_mfma_f32_16x16x32_bf16 a[104:107], a[224:227], a[200:203], a[104:107]
buffer_load_dwordx4 a[148:151], v2, s[24:27], s54 offen offset:1024 sc1
v_mfma_f32_16x16x32_bf16 a[112:115], a[224:227], a[208:211], a[112:115]
ds_read_b64_tr_b16 a[252:253], v12 offset:13376
v_mul_f32 v151, s57, v151
v_mfma_f32_16x16x32_bf16 a[112:115], a[228:231], a[212:215], a[112:115]
v_rcp_f32 v130, v130
v_mfma_f32_16x16x32_bf16 a[120:123], a[228:231], a[220:223], a[120:123]
ds_read_b64_tr_b16 a[254:255], v12 offset:14912
v_mul_f32 v128, v128, v136
v_mfma_f32_16x16x32_bf16 a[120:123], a[224:227], a[216:219], a[120:123]
s_waitcnt vmcnt(42) lgkmcnt(8)
s_barrier
v_mul_f32 v129, v129, v137
v_mfma_f32_16x16x32_bf16 a[56:59], a[232:235], a[216:219], a[56:59]
buffer_load_dwordx4 a[152:155], v2, s[24:27], s54 offen offset:2048 sc1
v_mfma_f32_16x16x32_bf16 a[56:59], a[236:239], a[220:223], a[56:59]
ds_read_b64_tr_b16 a[224:225], v8 offset:16384
v_mul_f32 v130, v130, v138
v_mfma_f32_16x16x32_bf16 a[40:43], a[236:239], a[212:215], a[40:43]
ds_read_b64_tr_b16 a[226:227], v8 offset:20480
v_cvt_pk_bf16_f32 v128, v128, v129
v_mfma_f32_16x16x32_bf16 a[40:43], a[232:235], a[208:211], a[40:43]
buffer_load_dwordx4 a[156:159], v2, s[24:27], s54 offen offset:3072 sc1
v_mfma_f32_16x16x32_bf16 a[24:27], a[232:235], a[200:203], a[24:27]
s_add_u32 s54, s53, 73728
ds_read_b64_tr_b16 a[228:229], v4 offset:0
v_cvt_pk_bf16_f32 v193, v194, v195
v_mfma_f32_16x16x32_bf16 a[24:27], a[236:239], a[204:207], a[24:27]
v_rcp_f32 v131, v131
v_mfma_f32_16x16x32_bf16 a[8:11], a[236:239], a[196:199], a[8:11]
ds_read_b64_tr_b16 a[230:231], v4 offset:4096
v_mul_f32 v131, v131, v139
v_mfma_f32_16x16x32_bf16 a[8:11], a[232:235], a[192:195], a[8:11]
s_waitcnt lgkmcnt(8)
v_rcp_f32 v132, v132
v_cvt_pk_bf16_f32 v129, v130, v131
v_mfma_f32_16x16x32_bf16 a[12:15], a[240:243], a[192:195], a[12:15]
buffer_load_dwordx4 v[96:99], v1, s[24:27], s54 offen offset:0 sc1
v_mfma_f32_16x16x32_bf16 a[12:15], a[244:247], a[196:199], a[12:15]
ds_read_b64_tr_b16 a[232:233], v9 offset:16384
v_mul_f32 v132, v132, v140
v_mfma_f32_16x16x32_bf16 a[28:31], a[244:247], a[204:207], a[28:31]
ds_read_b64_tr_b16 a[234:235], v9 offset:20480
v_cvt_pk_bf16_f32 v194, v196, v197
v_mfma_f32_16x16x32_bf16 a[28:31], a[240:243], a[200:203], a[28:31]
v_rcp_f32 v133, v133
v_mfma_f32_16x16x32_bf16 a[44:47], a[240:243], a[208:211], a[44:47]
buffer_load_dwordx4 v[100:103], v1, s[24:27], s54 offen offset:1024 sc1
v_mfma_f32_16x16x32_bf16 a[44:47], a[244:247], a[212:215], a[44:47]
ds_read_b64_tr_b16 a[236:237], v5 offset:0
v_mul_f32 v133, v133, v141
v_mfma_f32_16x16x32_bf16 a[60:63], a[244:247], a[220:223], a[60:63]
ds_read_b64_tr_b16 a[238:239], v5 offset:4096
v_cvt_pk_bf16_f32 v130, v132, v133
v_mfma_f32_16x16x32_bf16 a[60:63], a[240:243], a[216:219], a[60:63]
s_waitcnt lgkmcnt(8)
v_rcp_f32 v134, v134
v_mul_f32 v64, s57, v64
v_mfma_f32_16x16x32_bf16 a[124:127], a[248:251], a[216:219], a[124:127]
buffer_load_dwordx4 v[104:107], v1, s[24:27], s54 offen offset:2048 sc1
v_mfma_f32_16x16x32_bf16 a[124:127], a[252:255], a[220:223], a[124:127]
ds_read_b64_tr_b16 a[240:241], v12 offset:17408
v_mul_f32 v134, v134, v142
v_mfma_f32_16x16x32_bf16 a[116:119], a[252:255], a[212:215], a[116:119]
ds_read_b64_tr_b16 a[242:243], v12 offset:18944
v_mul_f32 v65, s57, v65
v_mfma_f32_16x16x32_bf16 a[116:119], a[248:251], a[208:211], a[116:119]
v_rcp_f32 v135, v135
v_mfma_f32_16x16x32_bf16 a[108:111], a[248:251], a[200:203], a[108:111]
ds_read_b64_tr_b16 a[244:245], v12 offset:21504
v_mul_f32 v135, v135, v143
v_mfma_f32_16x16x32_bf16 a[108:111], a[252:255], a[204:207], a[108:111]
buffer_load_dwordx4 v[108:111], v1, s[24:27], s54 offen offset:3072 sc1
v_mfma_f32_16x16x32_bf16 a[100:103], a[252:255], a[196:199], a[100:103]
ds_read_b64_tr_b16 a[246:247], v12 offset:23040
v_cvt_pk_bf16_f32 v131, v134, v135
v_mfma_f32_16x16x32_bf16 a[100:103], a[248:251], a[192:195], a[100:103]
s_waitcnt vmcnt(17) lgkmcnt(8)
v_exp_f32 v144, v144
v_mul_f32 v66, s57, v66
v_mfma_f32_16x16x32_bf16 a[64:67], a[224:227], a[160:163], a[64:67]
ds_read_b64_tr_b16 a[248:249], v12 offset:17440
v_add_f32 v144, 1.0, v144
v_mfma_f32_16x16x32_bf16 a[64:67], a[228:231], a[164:167], a[64:67]
buffer_store_dwordx4 v[128:131], v1, s[24:27], s59 offen offset:2048 sc1
v_exp_f32 v145, v145
v_mul_f32 v67, s57, v67
v_mfma_f32_16x16x32_bf16 a[72:75], a[228:231], a[172:175], a[72:75]
ds_read_b64_tr_b16 a[250:251], v12 offset:18976
v_add_f32 v145, 1.0, v145
v_mfma_f32_16x16x32_bf16 a[72:75], a[224:227], a[168:171], a[72:75]
v_exp_f32 v146, v146
v_mfma_f32_16x16x32_bf16 a[80:83], a[224:227], a[176:179], a[80:83]
ds_read_b64_tr_b16 a[252:253], v12 offset:21536
v_add_f32 v146, 1.0, v146
v_mfma_f32_16x16x32_bf16 a[80:83], a[228:231], a[180:183], a[80:83]
buffer_load_dwordx4 v[112:115], v2, s[24:27], s54 offen offset:0 sc1
v_mfma_f32_16x16x32_bf16 a[88:91], a[228:231], a[188:191], a[88:91]
ds_read_b64_tr_b16 a[254:255], v12 offset:23072
v_mul_f32 v68, s57, v68
v_mfma_f32_16x16x32_bf16 a[88:91], a[224:227], a[184:187], a[88:91]
s_waitcnt lgkmcnt(8)
v_exp_f32 v147, v147
v_mul_f32 v69, s57, v69
v_mfma_f32_16x16x32_bf16 a[92:95], a[232:235], a[184:187], a[92:95]
buffer_load_dwordx4 v[116:119], v2, s[24:27], s54 offen offset:1024 sc1
v_mfma_f32_16x16x32_bf16 a[92:95], a[236:239], a[188:191], a[92:95]
ds_read_b64_tr_b16 a[224:225], v12 offset:17472
v_add_f32 v147, 1.0, v147
v_mfma_f32_16x16x32_bf16 a[84:87], a[236:239], a[180:183], a[84:87]
ds_read_b64_tr_b16 a[226:227], v12 offset:19008
v_mul_f32 v70, s57, v70
v_mfma_f32_16x16x32_bf16 a[84:87], a[232:235], a[176:179], a[84:87]
v_exp_f32 v148, v148
v_mfma_f32_16x16x32_bf16 a[76:79], a[232:235], a[168:171], a[76:79]
buffer_load_dwordx4 v[120:123], v2, s[24:27], s54 offen offset:2048 sc1
v_mfma_f32_16x16x32_bf16 a[76:79], a[236:239], a[172:175], a[76:79]
ds_read_b64_tr_b16 a[228:229], v12 offset:21568
v_add_f32 v148, 1.0, v148
v_mfma_f32_16x16x32_bf16 a[68:71], a[236:239], a[164:167], a[68:71]
ds_read_b64_tr_b16 a[230:231], v12 offset:23104
v_mul_f32 v71, s57, v71
v_mfma_f32_16x16x32_bf16 a[68:71], a[232:235], a[160:163], a[68:71]
s_waitcnt lgkmcnt(8)
v_exp_f32 v149, v149
v_cvt_pk_bf16_f32 v195, v198, v199
v_mfma_f32_16x16x32_bf16 a[0:3], a[240:243], a[160:163], a[0:3]
buffer_load_dwordx4 v[124:127], v2, s[24:27], s54 offen offset:3072 sc1
v_mfma_f32_16x16x32_bf16 v[160:163], v[40:43], v[192:195], 0
s_add_u32 s54, s53, 65536
ds_read_b64_tr_b16 a[232:233], v10 offset:1024
v_add_f32 v149, 1.0, v149
v_mfma_f32_16x16x32_bf16 v[164:167], v[44:47], v[192:195], 0
v_exp_f32 v150, v150
v_mfma_f32_16x16x32_bf16 a[0:3], a[244:247], a[164:167], a[0:3]
v_exp_f32 v151, v151
v_mfma_f32_16x16x32_bf16 a[16:19], a[244:247], a[172:175], a[16:19]
ds_read_b64_tr_b16 a[234:235], v10 offset:2560
v_add_f32 v150, 1.0, v150
v_mfma_f32_16x16x32_bf16 a[16:19], a[240:243], a[168:171], a[16:19]
buffer_load_dwordx4 a[192:195], v1, s[24:27], s54 offen offset:0 sc1
v_mfma_f32_16x16x32_bf16 a[32:35], a[240:243], a[176:179], a[32:35]
ds_read_b64_tr_b16 a[236:237], v10 offset:5120
v_add_f32 v151, 1.0, v151
v_mfma_f32_16x16x32_bf16 a[32:35], a[244:247], a[180:183], a[32:35]
v_rcp_f32 v144, v144
v_mfma_f32_16x16x32_bf16 a[48:51], a[244:247], a[188:191], a[48:51]
ds_read_b64_tr_b16 a[238:239], v10 offset:6656
v_mul_f32 v144, v144, v152
v_mfma_f32_16x16x32_bf16 a[48:51], a[240:243], a[184:187], a[48:51]
s_waitcnt lgkmcnt(8)
buffer_load_dwordx4 a[196:199], v1, s[24:27], s54 offen offset:1024 sc1
v_cvt_pk_bf16_f32 v196, v200, v201
v_mfma_f32_16x16x32_bf16 a[52:55], a[248:251], a[184:187], a[52:55]
ds_read_b64_tr_b16 a[240:241], v10 offset:1056
v_cvt_pk_bf16_f32 v197, v202, v203
v_mfma_f32_16x16x32_bf16 a[52:55], a[252:255], a[188:191], a[52:55]
v_rcp_f32 v145, v145
v_mfma_f32_16x16x32_bf16 a[36:39], a[252:255], a[180:183], a[36:39]
ds_read_b64_tr_b16 a[242:243], v10 offset:2592
v_mul_f32 v145, v145, v153
v_mfma_f32_16x16x32_bf16 a[36:39], a[248:251], a[176:179], a[36:39]
v_rcp_f32 v146, v146
v_mfma_f32_16x16x32_bf16 a[20:23], a[248:251], a[168:171], a[20:23]
buffer_load_dwordx4 a[200:203], v1, s[24:27], s54 offen offset:2048 sc1
v_mfma_f32_16x16x32_bf16 a[20:23], a[252:255], a[172:175], a[20:23]
ds_read_b64_tr_b16 a[244:245], v10 offset:5152
v_mul_f32 v146, v146, v154
v_mfma_f32_16x16x32_bf16 a[4:7], a[252:255], a[164:167], a[4:7]
ds_read_b64_tr_b16 a[246:247], v10 offset:6688
v_cvt_pk_bf16_f32 v144, v144, v145
v_mfma_f32_16x16x32_bf16 a[4:7], a[248:251], a[160:163], a[4:7]
s_waitcnt lgkmcnt(8)
v_rcp_f32 v147, v147
v_cvt_pk_bf16_f32 v198, v204, v205
v_mfma_f32_16x16x32_bf16 a[96:99], a[224:227], a[160:163], a[96:99]
buffer_load_dwordx4 a[204:207], v1, s[24:27], s54 offen offset:3072 sc1
v_mfma_f32_16x16x32_bf16 a[96:99], a[228:231], a[164:167], a[96:99]
ds_read_b64_tr_b16 a[248:249], v10 offset:1088
v_mul_f32 v147, v147, v155
v_mfma_f32_16x16x32_bf16 a[104:107], a[228:231], a[172:175], a[104:107]
ds_read_b64_tr_b16 a[250:251], v10 offset:2624
v_cvt_pk_bf16_f32 v145, v146, v147
v_mfma_f32_16x16x32_bf16 a[104:107], a[224:227], a[168:171], a[104:107]
v_rcp_f32 v148, v148
v_mfma_f32_16x16x32_bf16 a[112:115], a[224:227], a[176:179], a[112:115]
buffer_load_dwordx4 a[208:211], v2, s[24:27], s54 offen offset:0 sc1
v_mfma_f32_16x16x32_bf16 a[112:115], a[228:231], a[180:183], a[112:115]
ds_read_b64_tr_b16 a[252:253], v10 offset:5184
v_mul_f32 v148, v148, v156
v_mfma_f32_16x16x32_bf16 a[120:123], a[228:231], a[188:191], a[120:123]
ds_read_b64_tr_b16 a[254:255], v10 offset:6720
v_cvt_pk_bf16_f32 v199, v206, v207
v_mfma_f32_16x16x32_bf16 a[120:123], a[224:227], a[184:187], a[120:123]
s_waitcnt vmcnt(54) lgkmcnt(8)
s_barrier
v_cvt_pk_bf16_f32 v224, v224, v225
v_mfma_f32_16x16x32_bf16 v[168:171], v[40:43], v[196:199], 0
buffer_load_dwordx4 a[212:215], v2, s[24:27], s54 offen offset:1024 sc1
pg_6:
s_cbranch_execz pg_t10
v_mfma_f32_16x16x32_bf16 v[172:175], v[44:47], v[196:199], 0
v_rcp_f32 v149, v149
v_mfma_f32_16x16x32_bf16 a[56:59], a[232:235], a[184:187], a[56:59]
ds_read_b64_tr_b16 a[224:225], v4 offset:8192
v_mul_f32 v149, v149, v157
v_mfma_f32_16x16x32_bf16 a[56:59], a[236:239], a[188:191], a[56:59]
v_rcp_f32 v150, v150
v_mfma_f32_16x16x32_bf16 a[40:43], a[236:239], a[180:183], a[40:43]
buffer_load_dwordx4 a[216:219], v2, s[24:27], s54 offen offset:2048 sc1
v_mfma_f32_16x16x32_bf16 a[40:43], a[232:235], a[176:179], a[40:43]
ds_read_b64_tr_b16 a[226:227], v4 offset:12288
v_mul_f32 v150, v150, v158
v_mfma_f32_16x16x32_bf16 a[24:27], a[232:235], a[168:171], a[24:27]
ds_read_b64_tr_b16 a[228:229], v4 offset:16384
v_cvt_pk_bf16_f32 v146, v148, v149
v_mfma_f32_16x16x32_bf16 a[24:27], a[236:239], a[172:175], a[24:27]
v_rcp_f32 v151, v151
v_mfma_f32_16x16x32_bf16 a[8:11], a[236:239], a[164:167], a[8:11]
ds_read_b64_tr_b16 a[230:231], v4 offset:20480
v_mul_f32 v151, v151, v159
v_mfma_f32_16x16x32_bf16 a[8:11], a[232:235], a[160:163], a[8:11]
s_waitcnt lgkmcnt(8)
buffer_load_dwordx4 a[220:223], v2, s[24:27], s54 offen offset:3072 sc1
v_cvt_pk_bf16_f32 v147, v150, v151
v_mfma_f32_16x16x32_bf16 a[12:15], a[240:243], a[160:163], a[12:15]
s_bfe_u32 s55, 0x14001200, s99
ds_read_b64_tr_b16 a[232:233], v5 offset:8192
v_cvt_pk_bf16_f32 v225, v226, v227
v_mfma_f32_16x16x32_bf16 a[12:15], a[244:247], a[164:167], a[12:15]
s_lshl4_add_u32 m0, s55, s100
v_exp_f32 v64, v64
v_mfma_f32_16x16x32_bf16 a[28:31], a[244:247], a[172:175], a[28:31]
s_mov_b32 s55, 2752512
ds_read_b64_tr_b16 a[234:235], v5 offset:12288
v_add_f32 v64, 1.0, v64
v_mfma_f32_16x16x32_bf16 a[28:31], a[240:243], a[168:171], a[28:31]
buffer_store_dwordx4 v[144:147], v1, s[24:27], s59 offen offset:3072 sc1
v_exp_f32 v65, v65
v_cvt_pk_bf16_f32 v226, v228, v229
v_mfma_f32_16x16x32_bf16 a[44:47], a[240:243], a[176:179], a[44:47]
s_mov_b32 s56, 2359296
ds_read_b64_tr_b16 a[236:237], v5 offset:16384
v_add_f32 v65, 1.0, v65
v_mfma_f32_16x16x32_bf16 a[44:47], a[244:247], a[180:183], a[44:47]
v_exp_f32 v66, v66
v_mfma_f32_16x16x32_bf16 a[60:63], a[244:247], a[188:191], a[60:63]
ds_read_b64_tr_b16 a[238:239], v5 offset:20480
v_add_f32 v66, 1.0, v66
v_mfma_f32_16x16x32_bf16 a[60:63], a[240:243], a[184:187], a[60:63]
s_waitcnt lgkmcnt(8)
buffer_load_dwordx4 v15, s[12:15], s56 offen offset:0 lds
v_cvt_pk_bf16_f32 v227, v230, v231
v_mfma_f32_16x16x32_bf16 a[124:127], a[248:251], a[184:187], a[124:127]
ds_read_b64_tr_b16 a[240:241], v10 offset:9216
v_cvt_pk_bf16_f32 v240, v240, v241
v_mfma_f32_16x16x32_bf16 a[124:127], a[252:255], a[188:191], a[124:127]
v_exp_f32 v67, v67
v_mfma_f32_16x16x32_bf16 a[116:119], a[252:255], a[180:183], a[116:119]
ds_read_b64_tr_b16 a[242:243], v10 offset:10752
v_add_f32 v67, 1.0, v67
v_mfma_f32_16x16x32_bf16 a[116:119], a[248:251], a[176:179], a[116:119]
v_exp_f32 v68, v68
v_mfma_f32_16x16x32_bf16 a[108:111], a[248:251], a[168:171], a[108:111]
ds_read_b64_tr_b16 a[244:245], v10 offset:13312
v_add_f32 v68, 1.0, v68
v_mfma_f32_16x16x32_bf16 a[108:111], a[252:255], a[172:175], a[108:111]
v_exp_f32 v69, v69
v_mfma_f32_16x16x32_bf16 a[100:103], a[252:255], a[164:167], a[100:103]
buffer_load_dwordx4 v13, s[36:39], s55 offen offset:1024 lds
v_mfma_f32_16x16x32_bf16 a[100:103], a[248:251], a[160:163], a[100:103]
s_waitcnt vmcnt(20) lgkmcnt(7)
ds_read_b64_tr_b16 a[246:247], v10 offset:14848
v_exp_f32 v70, v70
v_mfma_f32_16x16x32_bf16 a[64:67], a[224:227], a[128:131], a[64:67]
ds_read_b64_tr_b16 a[248:249], v10 offset:9248
v_add_f32 v69, 1.0, v69
v_mfma_f32_16x16x32_bf16 a[64:67], a[228:231], a[132:135], a[64:67]
v_exp_f32 v71, v71
v_mfma_f32_16x16x32_bf16 a[72:75], a[228:231], a[140:143], a[72:75]
ds_read_b64_tr_b16 a[250:251], v10 offset:10784
v_add_f32 v70, 1.0, v70
v_mfma_f32_16x16x32_bf16 a[72:75], a[224:227], a[136:139], a[72:75]
v_add_f32 v71, 1.0, v71
v_mul_f32 v80, s57, v80
v_mfma_f32_16x16x32_bf16 a[80:83], a[224:227], a[144:147], a[80:83]
ds_read_b64_tr_b16 a[252:253], v10 offset:13344
v_mul_f32 v81, s57, v81
v_mfma_f32_16x16x32_bf16 a[80:83], a[228:231], a[148:151], a[80:83]
v_rcp_f32 v64, v64
v_mfma_f32_16x16x32_bf16 a[88:91], a[228:231], a[156:159], a[88:91]
ds_read_b64_tr_b16 a[254:255], v10 offset:14880
v_mul_f32 v82, s57, v82
v_mfma_f32_16x16x32_bf16 a[88:91], a[224:227], a[152:155], a[88:91]
s_waitcnt lgkmcnt(8)
buffer_load_dwordx4 v14, s[36:39], s55 offen offset:2048 lds
v_mul_f32 v83, s57, v83
v_mfma_f32_16x16x32_bf16 a[92:95], a[232:235], a[152:155], a[92:95]
ds_read_b64_tr_b16 a[224:225], v10 offset:9280
v_mul_f32 v84, s57, v84
v_mfma_f32_16x16x32_bf16 a[92:95], a[236:239], a[156:159], a[92:95]
v_rcp_f32 v65, v65
v_mfma_f32_16x16x32_bf16 a[84:87], a[236:239], a[148:151], a[84:87]
ds_read_b64_tr_b16 a[226:227], v10 offset:10816
v_mul_f32 v85, s57, v85
v_mfma_f32_16x16x32_bf16 a[84:87], a[232:235], a[144:147], a[84:87]
v_rcp_f32 v66, v66
v_mfma_f32_16x16x32_bf16 a[76:79], a[232:235], a[136:139], a[76:79]
ds_read_b64_tr_b16 a[228:229], v10 offset:13376
v_mul_f32 v86, s57, v86
v_mfma_f32_16x16x32_bf16 a[76:79], a[236:239], a[140:143], a[76:79]
v_rcp_f32 v67, v67
v_mfma_f32_16x16x32_bf16 a[68:71], a[236:239], a[132:135], a[68:71]
ds_read_b64_tr_b16 a[230:231], v10 offset:14912
v_mul_f32 v87, s57, v87
v_mfma_f32_16x16x32_bf16 a[68:71], a[232:235], a[128:131], a[68:71]
s_waitcnt lgkmcnt(8)
v_rcp_f32 v68, v68
v_mul_f32 v64, v64, v72
v_mfma_f32_16x16x32_bf16 a[0:3], a[240:243], a[128:131], a[0:3]
buffer_load_dwordx4 v3, s[36:39], s55 offen offset:3072 lds
v_mfma_f32_16x16x32_bf16 a[0:3], a[244:247], a[132:135], a[0:3]
s_add_u32 s54, s53, 57344
ds_read_b64_tr_b16 a[232:233], v10 offset:17408
v_mul_f32 v65, v65, v73
v_mfma_f32_16x16x32_bf16 a[16:19], a[244:247], a[140:143], a[16:19]
ds_read_b64_tr_b16 a[234:235], v10 offset:18944
v_mul_f32 v66, v66, v74
v_mfma_f32_16x16x32_bf16 a[16:19], a[240:243], a[136:139], a[16:19]
v_rcp_f32 v69, v69
v_mfma_f32_16x16x32_bf16 a[32:35], a[240:243], a[144:147], a[32:35]
ds_read_b64_tr_b16 a[236:237], v10 offset:21504
v_mul_f32 v67, v67, v75
v_mfma_f32_16x16x32_bf16 a[32:35], a[244:247], a[148:151], a[32:35]
v_rcp_f32 v70, v70
v_mfma_f32_16x16x32_bf16 a[48:51], a[244:247], a[156:159], a[48:51]
ds_read_b64_tr_b16 a[238:239], v10 offset:23040
v_mul_f32 v68, v68, v76
v_mfma_f32_16x16x32_bf16 a[48:51], a[240:243], a[152:155], a[48:51]
s_waitcnt lgkmcnt(8)
v_rcp_f32 v71, v71
v_mul_f32 v69, v69, v77
v_mfma_f32_16x16x32_bf16 a[52:55], a[248:251], a[152:155], a[52:55]
buffer_load_dwordx4 a[160:163], v1, s[24:27], s54 offen offset:0 sc1
v_mfma_f32_16x16x32_bf16 a[52:55], a[252:255], a[156:159], a[52:55]
ds_read_b64_tr_b16 a[240:241], v10 offset:17440
v_mul_f32 v70, v70, v78
v_mfma_f32_16x16x32_bf16 a[36:39], a[252:255], a[148:151], a[36:39]
ds_read_b64_tr_b16 a[242:243], v10 offset:18976
v_mul_f32 v71, v71, v79
v_mfma_f32_16x16x32_bf16 a[36:39], a[248:251], a[144:147], a[36:39]
v_exp_f32 v80, v80
v_mfma_f32_16x16x32_bf16 a[20:23], a[248:251], a[136:139], a[20:23]
ds_read_b64_tr_b16 a[244:245], v10 offset:21536
v_cvt_pk_bf16_f32 v64, v64, v65
v_mfma_f32_16x16x32_bf16 a[20:23], a[252:255], a[140:143], a[20:23]
buffer_load_dwordx4 a[164:167], v1, s[24:27], s54 offen offset:1024 sc1
v_mfma_f32_16x16x32_bf16 a[4:7], a[252:255], a[132:135], a[4:7]
ds_read_b64_tr_b16 a[246:247], v10 offset:23072
v_add_f32 v80, 1.0, v80
v_mfma_f32_16x16x32_bf16 a[4:7], a[248:251], a[128:131], a[4:7]
s_waitcnt lgkmcnt(8)
v_exp_f32 v81, v81
v_cvt_pk_bf16_f32 v65, v66, v67
v_mfma_f32_16x16x32_bf16 a[96:99], a[224:227], a[128:131], a[96:99]
ds_read_b64_tr_b16 a[248:249], v10 offset:17472
v_add_f32 v81, 1.0, v81
v_mfma_f32_16x16x32_bf16 a[96:99], a[228:231], a[132:135], a[96:99]
buffer_load_dwordx4 a[168:171], v1, s[24:27], s54 offen offset:2048 sc1
v_mfma_f32_16x16x32_bf16 a[104:107], a[228:231], a[140:143], a[104:107]
ds_read_b64_tr_b16 a[250:251], v10 offset:19008
v_cvt_pk_bf16_f32 v66, v68, v69
v_mfma_f32_16x16x32_bf16 a[104:107], a[224:227], a[136:139], a[104:107]
v_exp_f32 v82, v82
v_mfma_f32_16x16x32_bf16 a[112:115], a[224:227], a[144:147], a[112:115]
ds_read_b64_tr_b16 a[252:253], v10 offset:21568
v_add_f32 v82, 1.0, v82
v_mfma_f32_16x16x32_bf16 a[112:115], a[228:231], a[148:151], a[112:115]
buffer_load_dwordx4 a[172:175], v1, s[24:27], s54 offen offset:3072 sc1
v_mfma_f32_16x16x32_bf16 a[120:123], a[228:231], a[156:159], a[120:123]
ds_read_b64_tr_b16 a[254:255], v10 offset:23104
v_cvt_pk_bf16_f32 v67, v70, v71
v_mfma_f32_16x16x32_bf16 a[120:123], a[224:227], a[152:155], a[120:123]
s_waitcnt vmcnt(62) lgkmcnt(8)
s_barrier
v_cvt_pk_bf16_f32 v241, v242, v243
v_mfma_f32_16x16x32_bf16 a[56:59], a[232:235], a[152:155], a[56:59]
ds_read_b64_tr_b16 a[224:225], v4 offset:24576
v_cvt_pk_bf16_f32 v242, v244, v245
v_mfma_f32_16x16x32_bf16 a[56:59], a[236:239], a[156:159], a[56:59]
buffer_store_dwordx4 v[64:67], v1, s[24:27], s59 offen offset:0 sc1
v_exp_f32 v83, v83
v_cvt_pk_bf16_f32 v243, v246, v247
v_mfma_f32_16x16x32_bf16 a[40:43], a[236:239], a[148:151], a[40:43]
ds_read_b64_tr_b16 a[226:227], v4 offset:28672
v_add_f32 v83, 1.0, v83
v_mfma_f32_16x16x32_bf16 a[40:43], a[232:235], a[144:147], a[40:43]
v_exp_f32 v84, v84
v_mfma_f32_16x16x32_bf16 a[24:27], a[232:235], a[136:139], a[24:27]
ds_read_b64_tr_b16 a[228:229], v4 offset:32768
v_add_f32 v84, 1.0, v84
v_mfma_f32_16x16x32_bf16 a[24:27], a[236:239], a[140:143], a[24:27]
buffer_load_dwordx4 a[176:179], v2, s[24:27], s54 offen offset:0 sc1
v_mfma_f32_16x16x32_bf16 a[8:11], a[236:239], a[132:135], a[8:11]
ds_read_b64_tr_b16 a[230:231], v4 offset:36864
v_max3_f32 v60, v160, v161, v162
v_mfma_f32_16x16x32_bf16 a[8:11], a[232:235], a[128:131], a[8:11]
s_waitcnt lgkmcnt(8)
v_exp_f32 v85, v85
v_max3_f32 v62, -v160, -v161, -v162
v_mfma_f32_16x16x32_bf16 a[12:15], a[240:243], a[128:131], a[12:15]
buffer_load_dwordx4 a[180:183], v2, s[24:27], s54 offen offset:1024 sc1
v_mfma_f32_16x16x32_bf16 a[12:15], a[244:247], a[132:135], a[12:15]
ds_read_b64_tr_b16 a[232:233], v5 offset:24576
v_add_f32 v85, 1.0, v85
v_mfma_f32_16x16x32_bf16 a[28:31], a[244:247], a[140:143], a[28:31]
ds_read_b64_tr_b16 a[234:235], v5 offset:28672
v_max3_f32 v60, v60, v163, v164
v_mfma_f32_16x16x32_bf16 a[28:31], a[240:243], a[136:139], a[28:31]
v_exp_f32 v86, v86
v_mfma_f32_16x16x32_bf16 a[44:47], a[240:243], a[144:147], a[44:47]
buffer_load_dwordx4 a[184:187], v2, s[24:27], s54 offen offset:2048 sc1
v_mfma_f32_16x16x32_bf16 a[44:47], a[244:247], a[148:151], a[44:47]
ds_read_b64_tr_b16 a[236:237], v5 offset:32768
v_add_f32 v86, 1.0, v86
v_mfma_f32_16x16x32_bf16 a[60:63], a[244:247], a[156:159], a[60:63]
ds_read_b64_tr_b16 a[238:239], v5 offset:36864
v_max3_f32 v62, v62, -v163, -v164
v_mfma_f32_16x16x32_bf16 a[60:63], a[240:243], a[152:155], a[60:63]
s_waitcnt lgkmcnt(8)
v_exp_f32 v87, v87
v_max3_f32 v60, v60, v165, v166
v_mfma_f32_16x16x32_bf16 a[124:127], a[248:251], a[152:155], a[124:127]
buffer_load_dwordx4 a[188:191], v2, s[24:27], s54 offen offset:3072 sc1
v_mfma_f32_16x16x32_bf16 a[124:127], a[252:255], a[156:159], a[124:127]
s_add_u32 s54, s53, 49152
ds_read_b64_tr_b16 a[240:241], v10 offset:25600
v_add_f32 v87, 1.0, v87
v_mfma_f32_16x16x32_bf16 a[116:119], a[252:255], a[148:151], a[116:119]
ds_read_b64_tr_b16 a[242:243], v10 offset:27136
v_max3_f32 v62, v62, -v165, -v166
v_mfma_f32_16x16x32_bf16 a[116:119], a[248:251], a[144:147], a[116:119]
v_rcp_f32 v80, v80
v_mfma_f32_16x16x32_bf16 a[108:111], a[248:251], a[136:139], a[108:111]
ds_read_b64_tr_b16 a[244:245], v10 offset:29696
v_mul_f32 v80, v80, v88
v_mfma_f32_16x16x32_bf16 a[108:111], a[252:255], a[140:143], a[108:111]
buffer_load_dwordx4 v[128:131], v1, s[24:27], s54 offen offset:0 sc1
v_mfma_f32_16x16x32_bf16 a[100:103], a[252:255], a[132:135], a[100:103]
ds_read_b64_tr_b16 a[246:247], v10 offset:31232
v_max_f32 v60, v60, v167
v_mfma_f32_16x16x32_bf16 a[100:103], a[248:251], a[128:131], a[100:103]
s_waitcnt vmcnt(23) lgkmcnt(8)
v_rcp_f32 v81, v81
v_max_f32_e64 v62, v62, -v167
v_mfma_f32_16x16x32_bf16 a[64:67], a[224:227], v[96:99], a[64:67]
ds_read_b64_tr_b16 a[248:249], v10 offset:25632
v_mul_f32 v81, v81, v89
v_mfma_f32_16x16x32_bf16 a[64:67], a[228:231], v[100:103], a[64:67]
buffer_load_dwordx4 v[132:135], v1, s[24:27], s54 offen offset:1024 sc1
v_mfma_f32_16x16x32_bf16 a[72:75], a[228:231], v[108:111], a[72:75]
ds_read_b64_tr_b16 a[250:251], v10 offset:27168
v_cvt_pk_bf16_f32 v80, v80, v81
v_mfma_f32_16x16x32_bf16 a[72:75], a[224:227], v[104:107], a[72:75]
v_rcp_f32 v82, v82
v_mfma_f32_16x16x32_bf16 a[80:83], a[224:227], v[112:115], a[80:83]
ds_read_b64_tr_b16 a[252:253], v10 offset:29728
v_mul_f32 v82, v82, v90
v_mfma_f32_16x16x32_bf16 a[80:83], a[228:231], v[116:119], a[80:83]
v_rcp_f32 v83, v83
v_mfma_f32_16x16x32_bf16 a[88:91], a[228:231], v[124:127], a[88:91]
buffer_load_dwordx4 v[136:139], v1, s[24:27], s54 offen offset:2048 sc1
v_mfma_f32_16x16x32_bf16 a[88:91], a[224:227], v[120:123], a[88:91]
s_waitcnt lgkmcnt(7)
ds_read_b64_tr_b16 a[254:255], v10 offset:31264
v_rcp_f32 v84, v84
v_mfma_f32_16x16x32_bf16 a[92:95], a[232:235], v[120:123], a[92:95]
ds_read_b64_tr_b16 a[224:225], v10 offset:25664
v_mul_f32 v83, v83, v91
v_mfma_f32_16x16x32_bf16 a[92:95], a[236:239], v[124:127], a[92:95]
v_rcp_f32 v85, v85
v_mfma_f32_16x16x32_bf16 a[84:87], a[236:239], v[116:119], a[84:87]
buffer_load_dwordx4 v[140:143], v1, s[24:27], s54 offen offset:3072 sc1
v_mfma_f32_16x16x32_bf16 a[84:87], a[232:235], v[112:115], a[84:87]
ds_read_b64_tr_b16 a[226:227], v10 offset:27200
v_mul_f32 v84, v84, v92
v_mfma_f32_16x16x32_bf16 a[76:79], a[232:235], v[104:107], a[76:79]
ds_read_b64_tr_b16 a[228:229], v10 offset:29760
v_mul_f32 v85, v85, v93
v_mfma_f32_16x16x32_bf16 a[76:79], a[236:239], v[108:111], a[76:79]
v_rcp_f32 v86, v86
v_mfma_f32_16x16x32_bf16 a[68:71], a[236:239], v[100:103], a[68:71]
buffer_load_dwordx4 v[144:147], v2, s[24:27], s54 offen offset:0 sc1
v_mfma_f32_16x16x32_bf16 a[68:71], a[232:235], v[96:99], a[68:71]
s_waitcnt lgkmcnt(7)
ds_read_b64_tr_b16 a[230:231], v10 offset:31296
v_rcp_f32 v87, v87
v_mfma_f32_16x16x32_bf16 a[0:3], a[240:243], v[96:99], a[0:3]
ds_read_b64_tr_b16 a[232:233], v10 offset:33792
v_mul_f32 v86, v86, v94
v_mfma_f32_16x16x32_bf16 a[0:3], a[244:247], v[100:103], a[0:3]
v_mul_f32 v87, v87, v95
v_cvt_pk_bf16_f32 v81, v82, v83
v_mfma_f32_16x16x32_bf16 a[16:19], a[244:247], v[108:111], a[16:19]
s_load_dword s101, s[92:93], 32760
ds_read_b64_tr_b16 a[234:235], v10 offset:35328
v_cvt_pk_bf16_f32 v82, v84, v85
v_mfma_f32_16x16x32_bf16 a[16:19], a[240:243], v[104:107], a[16:19]
buffer_load_dwordx4 v[148:151], v2, s[24:27], s54 offen offset:1024 sc1
v_mfma_f32_16x16x32_bf16 a[32:35], a[240:243], v[112:115], a[32:35]
ds_read_b64_tr_b16 a[236:237], v10 offset:37888
v_cvt_pk_bf16_f32 v83, v86, v87
v_mfma_f32_16x16x32_bf16 a[32:35], a[244:247], v[116:119], a[32:35]
v_max3_f32 v61, v168, v169, v170
v_max3_f32 v63, -v168, -v169, -v170
v_mfma_f32_16x16x32_bf16 a[48:51], a[244:247], v[124:127], a[48:51]
ds_read_b64_tr_b16 a[238:239], v10 offset:39424
v_max3_f32 v61, v61, v171, v172
v_mfma_f32_16x16x32_bf16 a[48:51], a[240:243], v[120:123], a[48:51]
s_waitcnt lgkmcnt(8)
buffer_load_dwordx4 v[152:155], v2, s[24:27], s54 offen offset:2048 sc1
v_max3_f32 v63, v63, -v171, -v172
v_mfma_f32_16x16x32_bf16 a[52:55], a[248:251], v[120:123], a[52:55]
ds_read_b64_tr_b16 a[240:241], v10 offset:33824
v_max3_f32 v61, v61, v173, v174
v_mfma_f32_16x16x32_bf16 a[52:55], a[252:255], v[124:127], a[52:55]
v_max3_f32 v63, v63, -v173, -v174
v_max_f32 v61, v61, v175
v_mfma_f32_16x16x32_bf16 a[36:39], a[252:255], v[116:119], a[36:39]
ds_read_b64_tr_b16 a[242:243], v10 offset:35360
v_max_f32_e64 v63, v63, -v175
v_mfma_f32_16x16x32_bf16 a[36:39], a[248:251], v[112:115], a[36:39]
buffer_store_dwordx4 v[80:83], v1, s[24:27], s59 offen offset:1024 sc1
v_permlane16_swap_b32 v60, v61
v_max_f32 v60, v60, v61
v_mfma_f32_16x16x32_bf16 a[20:23], a[248:251], v[104:107], a[20:23]
ds_read_b64_tr_b16 a[244:245], v10 offset:37920
ds_read_b64_tr_b16 a[246:247], v10 offset:39456
v_mfma_f32_16x16x32_bf16 a[20:23], a[252:255], v[108:111], a[20:23]
v_permlane16_swap_b32 v62, v63
v_mfma_f32_16x16x32_bf16 a[4:7], a[252:255], v[100:103], a[4:7]
v_max_f32 v62, v62, v63
v_mfma_f32_16x16x32_bf16 a[4:7], a[248:251], v[96:99], a[4:7]
s_waitcnt lgkmcnt(8)
buffer_load_dwordx4 v[156:159], v2, s[24:27], s54 offen offset:3072 sc1
v_mfma_f32_16x16x32_bf16 a[96:99], a[224:227], v[96:99], a[96:99]
s_bfe_u32 s55, 0x18001600, s99
ds_read_b64_tr_b16 a[248:249], v10 offset:33856
s_lshl4_add_u32 m0, s55, s100
v_mfma_f32_16x16x32_bf16 a[96:99], a[228:231], v[100:103], a[96:99]
s_mov_b32 s55, 2293760
v_permlane32_swap_b32 v60, v62
v_mfma_f32_16x16x32_bf16 a[104:107], a[228:231], v[108:111], a[104:107]
s_mov_b32 s56, 1966080
ds_read_b64_tr_b16 a[250:251], v10 offset:35392
v_max_f32 v60, v60, v62
v_mfma_f32_16x16x32_bf16 a[104:107], a[224:227], v[104:107], a[104:107]
buffer_load_dwordx4 v15, s[12:15], s56 offen offset:0 lds
v_mfma_f32_16x16x32_bf16 a[112:115], a[224:227], v[112:115], a[112:115]
ds_read_b64_tr_b16 a[252:253], v10 offset:37952
v_mul_f32 v60, s58, v60
v_mfma_f32_16x16x32_bf16 a[112:115], a[228:231], v[116:119], a[112:115]
v_mov_b32 v62, v60
v_mfma_f32_16x16x32_bf16 a[120:123], a[228:231], v[124:127], a[120:123]
ds_read_b64_tr_b16 a[254:255], v10 offset:39488
v_mfma_f32_16x16x32_bf16 a[120:123], a[224:227], v[120:123], a[120:123]
s_waitcnt vmcnt(63) lgkmcnt(8)
s_barrier
v_mfma_f32_16x16x32_bf16 a[56:59], a[232:235], v[120:123], a[56:59]
ds_read_b64_tr_b16 a[224:225], v4 offset:40960
ds_read_b64_tr_b16 a[226:227], v4 offset:45056
v_mfma_f32_16x16x32_bf16 a[56:59], a[236:239], v[124:127], a[56:59]
v_permlane32_swap_b32 v60, v62
v_mfma_f32_16x16x32_bf16 a[40:43], a[236:239], v[116:119], a[40:43]
buffer_load_dwordx4 v13, s[36:39], s55 offen offset:1024 lds
v_mfma_f32_16x16x32_bf16 a[40:43], a[232:235], v[112:115], a[40:43]
v_mov_b32 v61, v60
v_mov_b32 v63, v62
v_mfma_f32_16x16x32_bf16 a[24:27], a[232:235], v[104:107], a[24:27]
ds_read_b64_tr_b16 a[228:229], v4 offset:49152
ds_read_b64_tr_b16 a[230:231], v4 offset:53248
v_mfma_f32_16x16x32_bf16 a[24:27], a[236:239], v[108:111], a[24:27]
v_permlane16_swap_b32 v60, v61
v_mfma_f32_16x16x32_bf16 a[8:11], a[236:239], v[100:103], a[8:11]
v_permlane16_swap_b32 v62, v63
v_mfma_f32_16x16x32_bf16 a[8:11], a[232:235], v[96:99], a[8:11]
s_waitcnt lgkmcnt(8)
v_fma_f32 v176, -v160, s58, -v62
v_exp_f32 v176, v176
v_mfma_f32_16x16x32_bf16 a[12:15], a[240:243], v[96:99], a[12:15]
ds_read_b64_tr_b16 a[232:233], v5 offset:40960
v_fma_f32 v160, v160, s58, -v60
v_mfma_f32_16x16x32_bf16 a[12:15], a[244:247], v[100:103], a[12:15]
v_exp_f32 v160, v160
v_mfma_f32_16x16x32_bf16 a[28:31], a[244:247], v[108:111], a[28:31]
ds_read_b64_tr_b16 a[234:235], v5 offset:45056
v_fma_f32 v177, -v161, s58, -v62
v_mfma_f32_16x16x32_bf16 a[28:31], a[240:243], v[104:107], a[28:31]
buffer_load_dwordx4 v14, s[36:39], s55 offen offset:2048 lds
v_mfma_f32_16x16x32_bf16 a[44:47], a[240:243], v[112:115], a[44:47]
ds_read_b64_tr_b16 a[236:237], v5 offset:49152
v_fma_f32 v161, v161, s58, -v60
v_mfma_f32_16x16x32_bf16 a[44:47], a[244:247], v[116:119], a[44:47]
v_exp_f32 v177, v177
v_mfma_f32_16x16x32_bf16 a[60:63], a[244:247], v[124:127], a[60:63]
ds_read_b64_tr_b16 a[238:239], v5 offset:53248
v_fma_f32 v178, -v162, s58, -v62
v_mfma_f32_16x16x32_bf16 a[60:63], a[240:243], v[120:123], a[60:63]
s_waitcnt lgkmcnt(8)
v_fma_f32 v162, v162, s58, -v60
v_exp_f32 v161, v161
v_mfma_f32_16x16x32_bf16 a[124:127], a[248:251], v[120:123], a[124:127]
ds_read_b64_tr_b16 a[240:241], v10 offset:41984
v_fma_f32 v179, -v163, s58, -v62
v_mfma_f32_16x16x32_bf16 a[124:127], a[252:255], v[124:127], a[124:127]
v_exp_f32 v178, v178
v_mfma_f32_16x16x32_bf16 a[116:119], a[252:255], v[116:119], a[116:119]
ds_read_b64_tr_b16 a[242:243], v10 offset:43520
v_fma_f32 v163, v163, s58, -v60
v_mfma_f32_16x16x32_bf16 a[116:119], a[248:251], v[112:115], a[116:119]
v_exp_f32 v162, v162
v_mfma_f32_16x16x32_bf16 a[108:111], a[248:251], v[104:107], a[108:111]
buffer_load_dwordx4 v3, s[36:39], s55 offen offset:3072 lds
v_mfma_f32_16x16x32_bf16 a[108:111], a[252:255], v[108:111], a[108:111]
s_add_u32 s54, s53, 40960
ds_read_b64_tr_b16 a[244:245], v10 offset:46080
v_fma_f32 v180, -v164, s58, -v62
v_mfma_f32_16x16x32_bf16 a[100:103], a[252:255], v[100:103], a[100:103]
ds_read_b64_tr_b16 a[246:247], v10 offset:47616
v_fma_f32 v164, v164, s58, -v60
v_mfma_f32_16x16x32_bf16 a[100:103], a[248:251], v[96:99], a[100:103]
s_waitcnt vmcnt(27) lgkmcnt(8)
v_fma_f32 v181, -v165, s58, -v62
v_exp_f32 v179, v179
v_mfma_f32_16x16x32_bf16 a[64:67], a[224:227], a[192:195], a[64:67]
ds_read_b64_tr_b16 a[248:249], v10 offset:42016
v_fma_f32 v165, v165, s58, -v60
v_mfma_f32_16x16x32_bf16 a[64:67], a[228:231], a[196:199], a[64:67]
v_exp_f32 v163, v163
v_mfma_f32_16x16x32_bf16 a[72:75], a[228:231], a[204:207], a[72:75]
ds_read_b64_tr_b16 a[250:251], v10 offset:43552
v_fma_f32 v182, -v166, s58, -v62
v_mfma_f32_16x16x32_bf16 a[72:75], a[224:227], a[200:203], a[72:75]
v_exp_f32 v180, v180
v_mfma_f32_16x16x32_bf16 a[80:83], a[224:227], a[208:211], a[80:83]
buffer_load_dwordx4 a[128:131], v1, s[24:27], s54 offen offset:0 sc1
v_mfma_f32_16x16x32_bf16 a[80:83], a[228:231], a[212:215], a[80:83]
ds_read_b64_tr_b16 a[252:253], v10 offset:46112
v_fma_f32 v166, v166, s58, -v60
v_mfma_f32_16x16x32_bf16 a[88:91], a[228:231], a[220:223], a[88:91]
ds_read_b64_tr_b16 a[254:255], v10 offset:47648
v_fma_f32 v183, -v167, s58, -v62
v_mfma_f32_16x16x32_bf16 a[88:91], a[224:227], a[216:219], a[88:91]
s_waitcnt lgkmcnt(8)
v_fma_f32 v167, v167, s58, -v60
v_exp_f32 v164, v164
v_mfma_f32_16x16x32_bf16 a[92:95], a[232:235], a[216:219], a[92:95]
ds_read_b64_tr_b16 a[224:225], v10 offset:42048
v_fma_f32 v184, -v168, s58, -v63
v_mfma_f32_16x16x32_bf16 a[92:95], a[236:239], a[220:223], a[92:95]
buffer_load_dwordx4 a[132:135], v1, s[24:27], s54 offen offset:1024 sc1
v_mfma_f32_16x16x32_bf16 a[84:87], a[236:239], a[212:215], a[84:87]
ds_read_b64_tr_b16 a[226:227], v10 offset:43584
v_fma_f32 v168, v168, s58, -v61
v_mfma_f32_16x16x32_bf16 a[84:87], a[232:235], a[208:211], a[84:87]
v_exp_f32 v181, v181
v_mfma_f32_16x16x32_bf16 a[76:79], a[232:235], a[200:203], a[76:79]
ds_read_b64_tr_b16 a[228:229], v10 offset:46144
v_fma_f32 v185, -v169, s58, -v63
v_mfma_f32_16x16x32_bf16 a[76:79], a[236:239], a[204:207], a[76:79]
buffer_load_dwordx4 a[136:139], v1, s[24:27], s54 offen offset:2048 sc1
v_mfma_f32_16x16x32_bf16 a[68:71], a[236:239], a[196:199], a[68:71]
ds_read_b64_tr_b16 a[230:231], v10 offset:47680
v_fma_f32 v169, v169, s58, -v61
v_mfma_f32_16x16x32_bf16 a[68:71], a[232:235], a[192:195], a[68:71]
s_waitcnt lgkmcnt(8)
v_exp_f32 v165, v165
v_fma_f32 v186, -v170, s58, -v63
v_mfma_f32_16x16x32_bf16 a[0:3], a[240:243], a[192:195], a[0:3]
ds_read_b64_tr_b16 a[232:233], v10 offset:50176
v_fma_f32 v170, v170, s58, -v61
v_mfma_f32_16x16x32_bf16 a[0:3], a[244:247], a[196:199], a[0:3]
buffer_load_dwordx4 a[140:143], v1, s[24:27], s54 offen offset:3072 sc1
v_mfma_f32_16x16x32_bf16 a[16:19], a[244:247], a[204:207], a[16:19]
ds_read_b64_tr_b16 a[234:235], v10 offset:51712
v_fma_f32 v187, -v171, s58, -v63
v_mfma_f32_16x16x32_bf16 a[16:19], a[240:243], a[200:203], a[16:19]
v_exp_f32 v182, v182
v_mfma_f32_16x16x32_bf16 a[32:35], a[240:243], a[208:211], a[32:35]
ds_read_b64_tr_b16 a[236:237], v10 offset:54272
v_fma_f32 v171, v171, s58, -v61
v_mfma_f32_16x16x32_bf16 a[32:35], a[244:247], a[212:215], a[32:35]
v_exp_f32 v166, v166
v_mfma_f32_16x16x32_bf16 a[48:51], a[244:247], a[220:223], a[48:51]
buffer_load_dwordx4 a[144:147], v2, s[24:27], s54 offen offset:0 sc1
v_mfma_f32_16x16x32_bf16 a[48:51], a[240:243], a[216:219], a[48:51]
s_waitcnt lgkmcnt(7)
ds_read_b64_tr_b16 a[238:239], v10 offset:55808
v_exp_f32 v183, v183
v_mfma_f32_16x16x32_bf16 a[52:55], a[248:251], a[216:219], a[52:55]
ds_read_b64_tr_b16 a[240:241], v10 offset:50208
v_fma_f32 v188, -v172, s58, -v63
v_mfma_f32_16x16x32_bf16 a[52:55], a[252:255], a[220:223], a[52:55]
v_exp_f32 v167, v167
v_mfma_f32_16x16x32_bf16 a[36:39], a[252:255], a[212:215], a[36:39]
buffer_load_dwordx4 a[148:151], v2, s[24:27], s54 offen offset:1024 sc1
v_mfma_f32_16x16x32_bf16 a[36:39], a[248:251], a[208:211], a[36:39]
ds_read_b64_tr_b16 a[242:243], v10 offset:51744
v_fma_f32 v172, v172, s58, -v61
v_mfma_f32_16x16x32_bf16 a[20:23], a[248:251], a[200:203], a[20:23]
ds_read_b64_tr_b16 a[244:245], v10 offset:54304
v_fma_f32 v189, -v173, s58, -v63
v_mfma_f32_16x16x32_bf16 a[20:23], a[252:255], a[204:207], a[20:23]
v_exp_f32 v184, v184
v_mfma_f32_16x16x32_bf16 a[4:7], a[252:255], a[196:199], a[4:7]
ds_read_b64_tr_b16 a[246:247], v10 offset:55840
v_fma_f32 v173, v173, s58, -v61
v_mfma_f32_16x16x32_bf16 a[4:7], a[248:251], a[192:195], a[4:7]
s_waitcnt lgkmcnt(8)
buffer_load_dwordx4 a[152:155], v2, s[24:27], s54 offen offset:2048 sc1
v_fma_f32 v190, -v174, s58, -v63
v_mfma_f32_16x16x32_bf16 a[96:99], a[224:227], a[192:195], a[96:99]
ds_read_b64_tr_b16 a[248:249], v10 offset:50240
v_fma_f32 v174, v174, s58, -v61
v_mfma_f32_16x16x32_bf16 a[96:99], a[228:231], a[196:199], a[96:99]
v_exp_f32 v168, v168
v_mfma_f32_16x16x32_bf16 a[104:107], a[228:231], a[204:207], a[104:107]
ds_read_b64_tr_b16 a[250:251], v10 offset:51776
v_fma_f32 v191, -v175, s58, -v63
v_mfma_f32_16x16x32_bf16 a[104:107], a[224:227], a[200:203], a[104:107]
buffer_load_dwordx4 a[156:159], v2, s[24:27], s54 offen offset:3072 sc1
v_mfma_f32_16x16x32_bf16 a[112:115], a[224:227], a[208:211], a[112:115]
s_bfe_u32 s55, 0x1c001a00, s99
ds_read_b64_tr_b16 a[252:253], v10 offset:54336
v_fma_f32 v175, v175, s58, -v61
v_mfma_f32_16x16x32_bf16 a[112:115], a[228:231], a[212:215], a[112:115]
s_lshl4_add_u32 m0, s55, s100
v_exp_f32 v185, v185
v_mfma_f32_16x16x32_bf16 a[120:123], a[228:231], a[220:223], a[120:123]
s_mov_b32 s55, 1835008
ds_read_b64_tr_b16 a[254:255], v10 offset:55872
v_add_f32 v60, v160, v161
v_mfma_f32_16x16x32_bf16 a[120:123], a[224:227], a[216:219], a[120:123]
s_waitcnt vmcnt(61) lgkmcnt(8)
s_barrier
s_mov_b32 s56, 1572864
v_mfma_f32_16x16x32_bf16 a[56:59], a[232:235], a[216:219], a[56:59]
buffer_load_dwordx4 v15, s[12:15], s56 offen offset:0 lds
v_mfma_f32_16x16x32_bf16 a[56:59], a[236:239], a[220:223], a[56:59]
s_waitcnt vmcnt(14)
ds_read_b64_tr_b16 a[224:225], v4 offset:57344
v_add_f32 v62, v176, v177
v_mfma_f32_16x16x32_bf16 a[40:43], a[236:239], a[212:215], a[40:43]
buffer_store_dword v32, v30, s[24:27], s61 offen offset:0 sc1
ds_read_b64_tr_b16 a[226:227], v4 offset:61440
v_exp_f32 v169, v169
v_mfma_f32_16x16x32_bf16 a[40:43], a[232:235], a[208:211], a[40:43]
v_exp_f32 v186, v186
v_mfma_f32_16x16x32_bf16 a[24:27], a[232:235], a[200:203], a[24:27]
ds_read_b64_tr_b16 a[228:229], v6 offset:0
v_add_f32 v61, v168, v169
v_mfma_f32_16x16x32_bf16 a[24:27], a[236:239], a[204:207], a[24:27]
v_exp_f32 v170, v170
v_mfma_f32_16x16x32_bf16 a[8:11], a[236:239], a[196:199], a[8:11]
ds_read_b64_tr_b16 a[230:231], v6 offset:4096
v_add_f32 v63, v184, v185
v_mfma_f32_16x16x32_bf16 a[8:11], a[232:235], a[192:195], a[8:11]
s_waitcnt lgkmcnt(8)
buffer_load_dwordx4 v13, s[36:39], s55 offen offset:1024 lds
v_add_f32 v60, v60, v162
v_mfma_f32_16x16x32_bf16 a[12:15], a[240:243], a[192:195], a[12:15]
ds_read_b64_tr_b16 a[232:233], v5 offset:57344
v_add_f32 v62, v62, v178
v_mfma_f32_16x16x32_bf16 a[12:15], a[244:247], a[196:199], a[12:15]
v_exp_f32 v187, v187
v_mfma_f32_16x16x32_bf16 a[28:31], a[244:247], a[204:207], a[28:31]
ds_read_b64_tr_b16 a[234:235], v5 offset:61440
v_add_f32 v61, v61, v170
v_mfma_f32_16x16x32_bf16 a[28:31], a[240:243], a[200:203], a[28:31]
v_exp_f32 v171, v171
v_mfma_f32_16x16x32_bf16 a[44:47], a[240:243], a[208:211], a[44:47]
ds_read_b64_tr_b16 a[236:237], v7 offset:0
v_add_f32 v63, v63, v186
v_mfma_f32_16x16x32_bf16 a[44:47], a[244:247], a[212:215], a[44:47]
v_exp_f32 v188, v188
v_mfma_f32_16x16x32_bf16 a[60:63], a[244:247], a[220:223], a[60:63]
pg_7:
s_cbranch_execz pg_t11
ds_read_b64_tr_b16 a[238:239], v7 offset:4096
v_add_f32 v60, v60, v163
v_mfma_f32_16x16x32_bf16 a[60:63], a[240:243], a[216:219], a[60:63]
s_waitcnt lgkmcnt(8)
v_exp_f32 v172, v172
v_add_f32 v62, v62, v179
v_mfma_f32_16x16x32_bf16 a[124:127], a[248:251], a[216:219], a[124:127]
buffer_load_dwordx4 v14, s[36:39], s55 offen offset:2048 lds
v_mfma_f32_16x16x32_bf16 a[124:127], a[252:255], a[220:223], a[124:127]
ds_read_b64_tr_b16 a[240:241], v10 offset:58368
v_add_f32 v61, v61, v171
v_mfma_f32_16x16x32_bf16 a[116:119], a[252:255], a[212:215], a[116:119]
ds_read_b64_tr_b16 a[242:243], v10 offset:59904
v_add_f32 v63, v63, v187
v_mfma_f32_16x16x32_bf16 a[116:119], a[248:251], a[208:211], a[116:119]
v_exp_f32 v189, v189
v_mfma_f32_16x16x32_bf16 a[108:111], a[248:251], a[200:203], a[108:111]
ds_read_b64_tr_b16 a[244:245], v10 offset:62464
v_add_f32 v60, v60, v164
v_mfma_f32_16x16x32_bf16 a[108:111], a[252:255], a[204:207], a[108:111]
v_exp_f32 v173, v173
v_mfma_f32_16x16x32_bf16 a[100:103], a[252:255], a[196:199], a[100:103]
ds_read_b64_tr_b16 a[246:247], v10 offset:64000
v_add_f32 v62, v62, v180
v_mfma_f32_16x16x32_bf16 a[100:103], a[248:251], a[192:195], a[100:103]
s_waitcnt lgkmcnt(8)
v_exp_f32 v190, v190
v_add_f32 v61, v61, v172
v_mfma_f32_16x16x32_bf16 a[64:67], a[224:227], a[160:163], a[64:67]
buffer_load_dwordx4 v3, s[36:39], s55 offen offset:3072 lds
v_mfma_f32_16x16x32_bf16 a[64:67], a[228:231], a[164:167], a[64:67]
s_add_u32 s54, s53, 32768
ds_read_b64_tr_b16 a[248:249], v10 offset:58400
v_add_f32 v63, v63, v188
v_mfma_f32_16x16x32_bf16 a[72:75], a[228:231], a[172:175], a[72:75]
ds_read_b64_tr_b16 a[250:251], v10 offset:59936
v_add_f32 v60, v60, v165
v_mfma_f32_16x16x32_bf16 a[72:75], a[224:227], a[168:171], a[72:75]
v_exp_f32 v174, v174
v_mfma_f32_16x16x32_bf16 a[80:83], a[224:227], a[176:179], a[80:83]
ds_read_b64_tr_b16 a[252:253], v10 offset:62496
v_add_f32 v62, v62, v181
v_mfma_f32_16x16x32_bf16 a[80:83], a[228:231], a[180:183], a[80:83]
v_exp_f32 v191, v191
v_mfma_f32_16x16x32_bf16 a[88:91], a[228:231], a[188:191], a[88:91]
ds_read_b64_tr_b16 a[254:255], v10 offset:64032
v_add_f32 v61, v61, v173
v_mfma_f32_16x16x32_bf16 a[88:91], a[224:227], a[184:187], a[88:91]
s_waitcnt lgkmcnt(8)
v_exp_f32 v175, v175
v_add_f32 v63, v63, v189
v_mfma_f32_16x16x32_bf16 a[92:95], a[232:235], a[184:187], a[92:95]
ds_read_b64_tr_b16 a[224:225], v10 offset:58432
v_add_f32 v60, v60, v166
v_mfma_f32_16x16x32_bf16 a[92:95], a[236:239], a[188:191], a[92:95]
buffer_load_dwordx4 a[192:195], v1, s[24:27], s54 offen offset:0 sc1
v_mfma_f32_16x16x32_bf16 a[84:87], a[236:239], a[180:183], a[84:87]
ds_read_b64_tr_b16 a[226:227], v10 offset:59968
v_add_f32 v62, v62, v182
v_mfma_f32_16x16x32_bf16 a[84:87], a[232:235], a[176:179], a[84:87]
v_add_f32 v61, v61, v174
v_add_f32 v63, v63, v190
v_mfma_f32_16x16x32_bf16 a[76:79], a[232:235], a[168:171], a[76:79]
ds_read_b64_tr_b16 a[228:229], v10 offset:62528
v_add_f32 v60, v60, v167
v_mfma_f32_16x16x32_bf16 a[76:79], a[236:239], a[172:175], a[76:79]
v_add_f32 v62, v62, v183
v_add_f32 v61, v61, v175
v_mfma_f32_16x16x32_bf16 a[68:71], a[236:239], a[164:167], a[68:71]
buffer_load_dwordx4 a[196:199], v1, s[24:27], s54 offen offset:1024 sc1
v_mfma_f32_16x16x32_bf16 a[68:71], a[232:235], a[160:163], a[68:71]
s_waitcnt lgkmcnt(7)
ds_read_b64_tr_b16 a[230:231], v10 offset:64064
v_permlane16_swap_b32 v60, v61
v_mfma_f32_16x16x32_bf16 a[0:3], a[240:243], a[160:163], a[0:3]
ds_read_b64_tr_b16 a[232:233], v11 offset:1024
v_add_f32 v63, v63, v191
v_mfma_f32_16x16x32_bf16 a[0:3], a[244:247], a[164:167], a[0:3]
v_add_f32 v60, v60, v61
v_mfma_f32_16x16x32_bf16 a[16:19], a[244:247], a[172:175], a[16:19]
buffer_load_dwordx4 a[200:203], v1, s[24:27], s54 offen offset:2048 sc1
v_mfma_f32_16x16x32_bf16 a[16:19], a[240:243], a[168:171], a[16:19]
ds_read_b64_tr_b16 a[234:235], v11 offset:2560
ds_read_b64_tr_b16 a[236:237], v11 offset:5120
v_mfma_f32_16x16x32_bf16 a[32:35], a[240:243], a[176:179], a[32:35]
v_permlane16_swap_b32 v62, v63
v_mfma_f32_16x16x32_bf16 a[32:35], a[244:247], a[180:183], a[32:35]
v_add_f32 v62, v62, v63
v_mfma_f32_16x16x32_bf16 a[48:51], a[244:247], a[188:191], a[48:51]
buffer_load_dwordx4 a[204:207], v1, s[24:27], s54 offen offset:3072 sc1
v_mfma_f32_16x16x32_bf16 a[48:51], a[240:243], a[184:187], a[48:51]
s_waitcnt lgkmcnt(7)
ds_read_b64_tr_b16 a[238:239], v11 offset:6656
v_permlane32_swap_b32 v60, v62
v_mfma_f32_16x16x32_bf16 a[52:55], a[248:251], a[184:187], a[52:55]
ds_read_b64_tr_b16 a[240:241], v11 offset:1056
v_add_f32 v60, v60, v62
v_mfma_f32_16x16x32_bf16 a[52:55], a[252:255], a[188:191], a[52:55]
v_rcp_f32 v60, v60
v_mfma_f32_16x16x32_bf16 a[36:39], a[252:255], a[180:183], a[36:39]
ds_read_b64_tr_b16 a[242:243], v11 offset:2592
v_mov_b32 v62, v60
v_mfma_f32_16x16x32_bf16 a[36:39], a[248:251], a[176:179], a[36:39]
buffer_load_dwordx4 a[208:211], v2, s[24:27], s54 offen offset:0 sc1
v_mfma_f32_16x16x32_bf16 a[20:23], a[248:251], a[168:171], a[20:23]
ds_read_b64_tr_b16 a[244:245], v11 offset:5152
ds_read_b64_tr_b16 a[246:247], v11 offset:6688
v_mfma_f32_16x16x32_bf16 a[20:23], a[252:255], a[172:175], a[20:23]
v_permlane32_swap_b32 v60, v62
v_mfma_f32_16x16x32_bf16 a[4:7], a[252:255], a[164:167], a[4:7]
v_mov_b32 v61, v60
v_mov_b32 v63, v62
v_mfma_f32_16x16x32_bf16 a[4:7], a[248:251], a[160:163], a[4:7]
s_waitcnt lgkmcnt(8)
buffer_load_dwordx4 a[212:215], v2, s[24:27], s54 offen offset:1024 sc1
v_mfma_f32_16x16x32_bf16 a[96:99], a[224:227], a[160:163], a[96:99]
ds_read_b64_tr_b16 a[248:249], v11 offset:1088
ds_read_b64_tr_b16 a[250:251], v11 offset:2624
v_mfma_f32_16x16x32_bf16 a[96:99], a[228:231], a[164:167], a[96:99]
v_permlane16_swap_b32 v60, v61
v_mfma_f32_16x16x32_bf16 a[104:107], a[228:231], a[172:175], a[104:107]
v_permlane16_swap_b32 v62, v63
v_mfma_f32_16x16x32_bf16 a[104:107], a[224:227], a[168:171], a[104:107]
v_mul_f32 v160, v160, v60
v_mul_f32 v176, v176, v62
v_mfma_f32_16x16x32_bf16 a[112:115], a[224:227], a[176:179], a[112:115]
buffer_load_dwordx4 a[216:219], v2, s[24:27], s54 offen offset:2048 sc1
v_mfma_f32_16x16x32_bf16 a[112:115], a[228:231], a[180:183], a[112:115]
ds_read_b64_tr_b16 a[252:253], v11 offset:5184
v_mul_f32 v161, v161, v60
v_mfma_f32_16x16x32_bf16 a[120:123], a[228:231], a[188:191], a[120:123]
ds_read_b64_tr_b16 a[254:255], v11 offset:6720
v_mul_f32 v177, v177, v62
v_mfma_f32_16x16x32_bf16 a[120:123], a[224:227], a[184:187], a[120:123]
s_waitcnt vmcnt(42) lgkmcnt(8)
s_barrier
v_mul_f32 v162, v162, v60
v_mfma_f32_16x16x32_bf16 a[56:59], a[232:235], a[184:187], a[56:59]
buffer_load_dwordx4 a[220:223], v2, s[24:27], s54 offen offset:3072 sc1
v_mfma_f32_16x16x32_bf16 a[56:59], a[236:239], a[188:191], a[56:59]
s_bfe_u32 s55, 0x20001e00, s99
ds_read_b64_tr_b16 a[224:225], v6 offset:8192
s_lshl4_add_u32 m0, s55, s100
v_mfma_f32_16x16x32_bf16 a[40:43], a[236:239], a[180:183], a[40:43]
s_mov_b32 s55, 1376256
ds_read_b64_tr_b16 a[226:227], v6 offset:12288
v_mul_f32 v178, v178, v62
v_mfma_f32_16x16x32_bf16 a[40:43], a[232:235], a[176:179], a[40:43]
s_mov_b32 s56, 1179648
v_mul_f32 v163, v163, v60
v_mul_f32 v179, v179, v62
v_mfma_f32_16x16x32_bf16 a[24:27], a[232:235], a[168:171], a[24:27]
buffer_load_dwordx4 v15, s[12:15], s56 offen offset:0 lds
v_mfma_f32_16x16x32_bf16 a[24:27], a[236:239], a[172:175], a[24:27]
ds_read_b64_tr_b16 a[228:229], v6 offset:16384
v_mul_f32 v164, v164, v60
v_mfma_f32_16x16x32_bf16 a[8:11], a[236:239], a[164:167], a[8:11]
ds_read_b64_tr_b16 a[230:231], v6 offset:20480
v_mul_f32 v180, v180, v62
v_mfma_f32_16x16x32_bf16 a[8:11], a[232:235], a[160:163], a[8:11]
s_waitcnt lgkmcnt(8)
v_mul_f32 v165, v165, v60
v_mul_f32 v181, v181, v62
v_mul_f32 v166, v166, v60
v_mfma_f32_16x16x32_bf16 a[12:15], a[240:243], a[160:163], a[12:15]
ds_read_b64_tr_b16 a[232:233], v7 offset:8192
v_mul_f32 v182, v182, v62
v_mfma_f32_16x16x32_bf16 a[12:15], a[244:247], a[164:167], a[12:15]
v_mul_f32 v167, v167, v60
v_mul_f32 v183, v183, v62
v_mfma_f32_16x16x32_bf16 a[28:31], a[244:247], a[172:175], a[28:31]
ds_read_b64_tr_b16 a[234:235], v7 offset:12288
v_cvt_pk_bf16_f32 v192, v160, v161
v_mfma_f32_16x16x32_bf16 a[28:31], a[240:243], a[168:171], a[28:31]
v_cvt_pk_bf16_f32 v193, v162, v163
v_cvt_pk_bf16_f32 v194, v164, v165
v_mfma_f32_16x16x32_bf16 a[44:47], a[240:243], a[176:179], a[44:47]
buffer_load_dwordx4 v13, s[36:39], s55 offen offset:1024 lds
v_mfma_f32_16x16x32_bf16 a[44:47], a[244:247], a[180:183], a[44:47]
ds_read_b64_tr_b16 a[236:237], v7 offset:16384
v_cvt_pk_bf16_f32 v195, v166, v167
v_mfma_f32_16x16x32_bf16 a[60:63], a[244:247], a[188:191], a[60:63]
ds_read_b64_tr_b16 a[238:239], v7 offset:20480
v_cvt_pk_bf16_f32 v196, v176, v177
v_mfma_f32_16x16x32_bf16 a[60:63], a[240:243], a[184:187], a[60:63]
s_waitcnt lgkmcnt(8)
v_cvt_pk_bf16_f32 v197, v178, v179
v_cvt_pk_bf16_f32 v198, v180, v181
v_cvt_pk_bf16_f32 v199, v182, v183
v_mfma_f32_16x16x32_bf16 a[124:127], a[248:251], a[184:187], a[124:127]
ds_read_b64_tr_b16 a[240:241], v11 offset:9216
v_mul_f32 v168, v168, v61
v_mfma_f32_16x16x16_bf16 v[160:163], v[192:193], v[38:39], 0
v_mul_f32 v184, v184, v63
v_mul_f32 v169, v169, v61
v_mfma_f32_16x16x32_bf16 a[124:127], a[252:255], a[188:191], a[124:127]
v_mul_f32 v185, v185, v63
v_mul_f32 v170, v170, v61
v_mfma_f32_16x16x16_bf16 v[176:179], v[196:197], v[38:39], 0
v_mul_f32 v186, v186, v63
v_mul_f32 v171, v171, v61
v_mfma_f32_16x16x32_bf16 a[116:119], a[252:255], a[180:183], a[116:119]
ds_read_b64_tr_b16 a[242:243], v11 offset:10752
v_mul_f32 v187, v187, v63
v_mfma_f32_16x16x32_bf16 a[116:119], a[248:251], a[176:179], a[116:119]
buffer_load_dwordx4 v14, s[36:39], s55 offen offset:2048 lds
v_mfma_f32_16x16x32_bf16 a[108:111], a[248:251], a[168:171], a[108:111]
ds_read_b64_tr_b16 a[244:245], v11 offset:13312
v_mul_f32 v172, v172, v61
v_mfma_f32_16x16x32_bf16 a[108:111], a[252:255], a[172:175], a[108:111]
v_mul_f32 v188, v188, v63
v_mul_f32 v173, v173, v61
v_mfma_f32_16x16x32_bf16 a[100:103], a[252:255], a[164:167], a[100:103]
ds_read_b64_tr_b16 a[246:247], v11 offset:14848
v_mul_f32 v189, v189, v63
v_mfma_f32_16x16x32_bf16 a[100:103], a[248:251], a[160:163], a[100:103]
s_waitcnt vmcnt(28) lgkmcnt(8)
v_mul_f32 v174, v174, v61
v_mul_f32 v190, v190, v63
v_mul_f32 v175, v175, v61
v_mfma_f32_16x16x32_bf16 a[64:67], a[224:227], v[128:131], a[64:67]
ds_read_b64_tr_b16 a[248:249], v11 offset:9248
v_mul_f32 v191, v191, v63
v_mfma_f32_16x16x32_bf16 a[64:67], a[228:231], v[132:135], a[64:67]
v_cvt_pk_bf16_f32 v200, v168, v169
v_cvt_pk_bf16_f32 v201, v170, v171
v_mfma_f32_16x16x16_bf16 v[168:171], v[194:195], v[38:39], 0
v_cvt_pk_bf16_f32 v202, v172, v173
v_cvt_pk_bf16_f32 v203, v174, v175
v_mfma_f32_16x16x16_bf16 v[164:167], v[200:201], v[38:39], 0
v_cvt_pk_bf16_f32 v204, v184, v185
v_cvt_pk_bf16_f32 v205, v186, v187
v_mfma_f32_16x16x16_bf16 v[172:175], v[202:203], v[38:39], 0
buffer_load_dwordx4 v3, s[36:39], s55 offen offset:3072 lds
v_mfma_f32_16x16x16_bf16 v[180:183], v[204:205], v[38:39], 0
s_add_u32 s54, s53, 24576
v_cvt_pk_bf16_f32 v206, v188, v189
v_cvt_pk_bf16_f32 v207, v190, v191
v_mfma_f32_16x16x16_bf16 v[184:187], v[198:199], v[38:39], 0
v_cvt_pk_bf16_f32 v192, v160, v161
v_cvt_pk_bf16_f32 v193, v162, v163
v_mfma_f32_16x16x16_bf16 v[188:191], v[206:207], v[38:39], 0
v_cvt_pk_bf16_f32 v194, v164, v165
v_cvt_pk_bf16_f32 v195, v166, v167
v_mfma_f32_16x16x32_bf16 a[72:75], a[228:231], v[140:143], a[72:75]
ds_read_b64_tr_b16 a[250:251], v11 offset:10784
v_cvt_pk_bf16_f32 v196, v168, v169
v_mfma_f32_16x16x32_bf16 a[72:75], a[224:227], v[136:139], a[72:75]
v_cvt_pk_bf16_f32 v197, v170, v171
v_cvt_pk_bf16_f32 v198, v172, v173
v_mfma_f32_16x16x32_bf16 a[80:83], a[224:227], v[144:147], a[80:83]
ds_read_b64_tr_b16 a[252:253], v11 offset:13344
v_cvt_pk_bf16_f32 v199, v174, v175
v_mfma_f32_16x16x32_bf16 a[80:83], a[228:231], v[148:151], a[80:83]
v_cvt_pk_bf16_f32 v200, v176, v177
v_cvt_pk_bf16_f32 v201, v178, v179
v_mfma_f32_16x16x32_bf16 a[88:91], a[228:231], v[156:159], a[88:91]
ds_read_b64_tr_b16 a[254:255], v11 offset:14880
v_cvt_pk_bf16_f32 v202, v180, v181
v_mfma_f32_16x16x32_bf16 a[88:91], a[224:227], v[152:155], a[88:91]
s_waitcnt lgkmcnt(8)
buffer_load_dwordx4 a[160:163], v1, s[24:27], s54 offen offset:0 sc1
v_cvt_pk_bf16_f32 v203, v182, v183
v_mfma_f32_16x16x32_bf16 a[92:95], a[232:235], v[152:155], a[92:95]
ds_read_b64_tr_b16 a[224:225], v11 offset:9280
v_cvt_pk_bf16_f32 v204, v184, v185
v_mfma_f32_16x16x32_bf16 a[92:95], a[236:239], v[156:159], a[92:95]
v_cvt_pk_bf16_f32 v205, v186, v187
v_cvt_pk_bf16_f32 v206, v188, v189
v_mfma_f32_16x16x32_bf16 a[84:87], a[236:239], v[148:151], a[84:87]
ds_read_b64_tr_b16 a[226:227], v11 offset:10816
v_cvt_pk_bf16_f32 v207, v190, v191
v_mfma_f32_16x16x32_bf16 a[84:87], a[232:235], v[144:147], a[84:87]
buffer_load_dwordx4 a[164:167], v1, s[24:27], s54 offen offset:1024 sc1
v_mfma_f32_16x16x32_bf16 a[76:79], a[232:235], v[136:139], a[76:79]
ds_read_b64_tr_b16 a[228:229], v11 offset:13376
v_cvt_pk_bf16_f32 v208, v208, v209
v_mfma_f32_16x16x32_bf16 a[76:79], a[236:239], v[140:143], a[76:79]
v_cvt_pk_bf16_f32 v209, v210, v211
v_cvt_pk_bf16_f32 v210, v212, v213
v_mfma_f32_16x16x32_bf16 a[68:71], a[236:239], v[132:135], a[68:71]
ds_read_b64_tr_b16 a[230:231], v11 offset:14912
v_cvt_pk_bf16_f32 v211, v214, v215
v_mfma_f32_16x16x32_bf16 a[68:71], a[232:235], v[128:131], a[68:71]
s_waitcnt lgkmcnt(8)
buffer_load_dwordx4 a[168:171], v1, s[24:27], s54 offen offset:2048 sc1
v_cvt_pk_bf16_f32 v212, v216, v217
v_mfma_f32_16x16x32_bf16 v[160:163], v[40:43], v[208:211], 0
v_cvt_pk_bf16_f32 v213, v218, v219
v_cvt_pk_bf16_f32 v214, v220, v221
v_mfma_f32_16x16x32_bf16 v[164:167], v[44:47], v[208:211], 0
v_cvt_pk_bf16_f32 v215, v222, v223
v_cvt_pk_bf16_f32 v232, v232, v233
v_mfma_f32_16x16x32_bf16 a[0:3], a[240:243], v[128:131], a[0:3]
ds_read_b64_tr_b16 a[232:233], v11 offset:17408
v_cvt_pk_bf16_f32 v233, v234, v235
v_mfma_f32_16x16x32_bf16 v[168:171], v[40:43], v[212:215], 0
v_cvt_pk_bf16_f32 v234, v236, v237
v_cvt_pk_bf16_f32 v235, v238, v239
v_mfma_f32_16x16x32_bf16 v[172:175], v[44:47], v[212:215], 0
buffer_load_dwordx4 a[172:175], v1, s[24:27], s54 offen offset:3072 sc1
v_mfma_f32_16x16x32_bf16 a[0:3], a[244:247], v[132:135], a[0:3]
v_cvt_pk_bf16_f32 v248, v248, v249
v_cvt_pk_bf16_f32 v249, v250, v251
v_mfma_f32_16x16x32_bf16 a[16:19], a[244:247], v[140:143], a[16:19]
s_bitcmp1_b32 s2, 0
s_cselect_b32 s74, pg_8_b-pg_8, 0
s_add_u32 s92, s92, s74
s_addc_u32 s93, s93, 0
s_load_dword s101, s[92:93], 36856
ds_read_b64_tr_b16 a[234:235], v11 offset:18944
v_cvt_pk_bf16_f32 v250, v252, v253
v_mfma_f32_16x16x32_bf16 a[16:19], a[240:243], v[136:139], a[16:19]
v_cvt_pk_bf16_f32 v251, v254, v255
v_max3_f32 v60, v160, v161, v162
v_mfma_f32_16x16x32_bf16 a[32:35], a[240:243], v[144:147], a[32:35]
buffer_load_dwordx4 a[176:179], v2, s[24:27], s54 offen offset:0 sc1
v_mfma_f32_16x16x32_bf16 a[32:35], a[244:247], v[148:151], a[32:35]
ds_read_b64_tr_b16 a[236:237], v11 offset:21504
v_max3_f32 v62, -v160, -v161, -v162
v_mfma_f32_16x16x32_bf16 a[48:51], a[244:247], v[156:159], a[48:51]
ds_read_b64_tr_b16 a[238:239], v11 offset:23040
v_max3_f32 v60, v60, v163, v164
v_mfma_f32_16x16x32_bf16 a[48:51], a[240:243], v[152:155], a[48:51]
s_waitcnt lgkmcnt(8)
v_max3_f32 v62, v62, -v163, -v164
v_max3_f32 v60, v60, v165, v166
v_max3_f32 v62, v62, -v165, -v166
v_mfma_f32_16x16x32_bf16 a[52:55], a[248:251], v[152:155], a[52:55]
buffer_load_dwordx4 a[180:183], v2, s[24:27], s54 offen offset:1024 sc1
v_mfma_f32_16x16x32_bf16 a[52:55], a[252:255], v[156:159], a[52:55]
ds_read_b64_tr_b16 a[240:241], v11 offset:17440
v_max_f32 v60, v60, v167
v_mfma_f32_16x16x32_bf16 a[36:39], a[252:255], v[148:151], a[36:39]
ds_read_b64_tr_b16 a[242:243], v11 offset:18976
v_max_f32_e64 v62, v62, -v167
v_mfma_f32_16x16x32_bf16 a[36:39], a[248:251], v[144:147], a[36:39]
v_max3_f32 v61, v168, v169, v170
v_max3_f32 v63, -v168, -v169, -v170
v_mfma_f32_16x16x32_bf16 a[20:23], a[248:251], v[136:139], a[20:23]
ds_read_b64_tr_b16 a[244:245], v11 offset:21536
v_max3_f32 v61, v61, v171, v172
v_mfma_f32_16x16x32_bf16 a[20:23], a[252:255], v[140:143], a[20:23]
buffer_load_dwordx4 a[184:187], v2, s[24:27], s54 offen offset:2048 sc1
v_mfma_f32_16x16x32_bf16 a[4:7], a[252:255], v[132:135], a[4:7]
ds_read_b64_tr_b16 a[246:247], v11 offset:23072
v_max3_f32 v63, v63, -v171, -v172
v_mfma_f32_16x16x32_bf16 a[4:7], a[248:251], v[128:131], a[4:7]
s_waitcnt lgkmcnt(8)
v_max3_f32 v61, v61, v173, v174
v_max3_f32 v63, v63, -v173, -v174
v_max_f32 v61, v61, v175
v_mfma_f32_16x16x32_bf16 a[96:99], a[224:227], v[128:131], a[96:99]
ds_read_b64_tr_b16 a[248:249], v11 offset:17472
v_max_f32_e64 v63, v63, -v175
v_mfma_f32_16x16x32_bf16 a[96:99], a[228:231], v[132:135], a[96:99]
buffer_load_dwordx4 a[188:191], v2, s[24:27], s54 offen offset:3072 sc1
v_mfma_f32_16x16x32_bf16 a[104:107], a[228:231], v[140:143], a[104:107]
s_bfe_u32 s55, 0x24002200, s99
ds_read_b64_tr_b16 a[250:251], v11 offset:19008
ds_read_b64_tr_b16 a[252:253], v11 offset:21568
v_mfma_f32_16x16x32_bf16 a[104:107], a[224:227], v[136:139], a[104:107]
s_lshl4_add_u32 m0, s55, s100
v_permlane16_swap_b32 v60, v61
v_mfma_f32_16x16x32_bf16 a[112:115], a[224:227], v[144:147], a[112:115]
s_mov_b32 s55, 917504
v_permlane16_swap_b32 v62, v63
v_mfma_f32_16x16x32_bf16 a[112:115], a[228:231], v[148:151], a[112:115]
s_mov_b32 s56, 786432
v_max_f32 v60, v60, v61
v_max_f32 v62, v62, v63
v_mfma_f32_16x16x32_bf16 a[120:123], a[228:231], v[156:159], a[120:123]
buffer_load_dwordx4 v15, s[12:15], s56 offen offset:0 lds
v_mfma_f32_16x16x32_bf16 a[120:123], a[224:227], v[152:155], a[120:123]
s_waitcnt vmcnt(34) lgkmcnt(7)
s_barrier
v_mfma_f32_16x16x32_bf16 a[56:59], a[232:235], v[152:155], a[56:59]
ds_read_b64_tr_b16 a[254:255], v11 offset:23104
ds_read_b64_tr_b16 a[224:225], v6 offset:24576
v_mfma_f32_16x16x32_bf16 a[56:59], a[236:239], v[156:159], a[56:59]
v_permlane32_swap_b32 v60, v62
v_mfma_f32_16x16x32_bf16 a[40:43], a[236:239], v[148:151], a[40:43]
ds_read_b64_tr_b16 a[226:227], v6 offset:28672
v_max_f32 v60, v60, v62
v_mfma_f32_16x16x32_bf16 a[40:43], a[232:235], v[144:147], a[40:43]
v_mul_f32 v60, s58, v60
v_mov_b32 v62, v60
v_mfma_f32_16x16x32_bf16 a[24:27], a[232:235], v[136:139], a[24:27]
ds_read_b64_tr_b16 a[228:229], v6 offset:32768
ds_read_b64_tr_b16 a[230:231], v6 offset:36864
v_mfma_f32_16x16x32_bf16 a[24:27], a[236:239], v[140:143], a[24:27]
v_permlane32_swap_b32 v60, v62
v_mfma_f32_16x16x32_bf16 a[8:11], a[236:239], v[132:135], a[8:11]
buffer_load_dwordx4 v13, s[36:39], s55 offen offset:1024 lds
v_mfma_f32_16x16x32_bf16 a[8:11], a[232:235], v[128:131], a[8:11]
s_waitcnt lgkmcnt(8)
v_mov_b32 v61, v60
v_mov_b32 v63, v62
v_mfma_f32_16x16x32_bf16 a[12:15], a[240:243], v[128:131], a[12:15]
ds_read_b64_tr_b16 a[232:233], v7 offset:24576
ds_read_b64_tr_b16 a[234:235], v7 offset:28672
v_mfma_f32_16x16x32_bf16 a[12:15], a[244:247], v[132:135], a[12:15]
v_permlane16_swap_b32 v60, v61
v_mfma_f32_16x16x32_bf16 a[28:31], a[244:247], v[140:143], a[28:31]
v_permlane16_swap_b32 v62, v63
v_mfma_f32_16x16x32_bf16 a[28:31], a[240:243], v[136:139], a[28:31]
v_fma_f32 v176, -v160, s58, -v62
v_fma_f32 v160, v160, s58, -v60
v_mfma_f32_16x16x32_bf16 a[44:47], a[240:243], v[144:147], a[44:47]
ds_read_b64_tr_b16 a[236:237], v7 offset:32768
v_fma_f32 v177, -v161, s58, -v62
v_mfma_f32_16x16x32_bf16 a[44:47], a[244:247], v[148:151], a[44:47]
v_exp_f32 v176, v176
v_mfma_f32_16x16x32_bf16 a[60:63], a[244:247], v[156:159], a[60:63]
ds_read_b64_tr_b16 a[238:239], v7 offset:36864
v_fma_f32 v161, v161, s58, -v60
v_mfma_f32_16x16x32_bf16 a[60:63], a[240:243], v[152:155], a[60:63]
s_waitcnt lgkmcnt(8)
buffer_load_dwordx4 v14, s[36:39], s55 offen offset:2048 lds
v_fma_f32 v178, -v162, s58, -v62
v_mfma_f32_16x16x32_bf16 a[124:127], a[248:251], v[152:155], a[124:127]
ds_read_b64_tr_b16 a[240:241], v11 offset:25600
v_fma_f32 v162, v162, s58, -v60
v_mfma_f32_16x16x32_bf16 a[124:127], a[252:255], v[156:159], a[124:127]
v_exp_f32 v160, v160
v_mfma_f32_16x16x32_bf16 a[116:119], a[252:255], v[148:151], a[116:119]
ds_read_b64_tr_b16 a[242:243], v11 offset:27136
v_fma_f32 v179, -v163, s58, -v62
v_mfma_f32_16x16x32_bf16 a[116:119], a[248:251], v[144:147], a[116:119]
v_exp_f32 v177, v177
v_mfma_f32_16x16x32_bf16 a[108:111], a[248:251], v[136:139], a[108:111]
ds_read_b64_tr_b16 a[244:245], v11 offset:29696
v_fma_f32 v163, v163, s58, -v60
v_mfma_f32_16x16x32_bf16 a[108:111], a[252:255], v[140:143], a[108:111]
v_exp_f32 v161, v161
v_mfma_f32_16x16x32_bf16 a[100:103], a[252:255], v[132:135], a[100:103]
ds_read_b64_tr_b16 a[246:247], v11 offset:31232
v_fma_f32 v180, -v164, s58, -v62
v_mfma_f32_16x16x32_bf16 a[100:103], a[248:251], v[128:131], a[100:103]
s_waitcnt vmcnt(28) lgkmcnt(8)
v_fma_f32 v164, v164, s58, -v60
v_exp_f32 v178, v178
v_mfma_f32_16x16x32_bf16 a[64:67], a[224:227], a[128:131], a[64:67]
buffer_load_dwordx4 v3, s[36:39], s55 offen offset:3072 lds
v_mfma_f32_16x16x32_bf16 a[64:67], a[228:231], a[132:135], a[64:67]
s_add_u32 s54, s53, 16384
ds_read_b64_tr_b16 a[248:249], v11 offset:25632
v_fma_f32 v181, -v165, s58, -v62
v_mfma_f32_16x16x32_bf16 a[72:75], a[228:231], a[140:143], a[72:75]
ds_read_b64_tr_b16 a[250:251], v11 offset:27168
v_fma_f32 v165, v165, s58, -v60
v_mfma_f32_16x16x32_bf16 a[72:75], a[224:227], a[136:139], a[72:75]
v_exp_f32 v162, v162
v_mfma_f32_16x16x32_bf16 a[80:83], a[224:227], a[144:147], a[80:83]
ds_read_b64_tr_b16 a[252:253], v11 offset:29728
v_fma_f32 v182, -v166, s58, -v62
v_mfma_f32_16x16x32_bf16 a[80:83], a[228:231], a[148:151], a[80:83]
v_exp_f32 v179, v179
v_mfma_f32_16x16x32_bf16 a[88:91], a[228:231], a[156:159], a[88:91]
ds_read_b64_tr_b16 a[254:255], v11 offset:31264
v_fma_f32 v166, v166, s58, -v60
v_mfma_f32_16x16x32_bf16 a[88:91], a[224:227], a[152:155], a[88:91]
s_waitcnt lgkmcnt(8)
v_fma_f32 v183, -v167, s58, -v62
v_exp_f32 v163, v163
v_mfma_f32_16x16x32_bf16 a[92:95], a[232:235], a[152:155], a[92:95]
buffer_load_dwordx4 v[64:67], v1, s[24:27], s54 offen offset:0 sc1
v_mfma_f32_16x16x32_bf16 a[92:95], a[236:239], a[156:159], a[92:95]
ds_read_b64_tr_b16 a[224:225], v11 offset:25664
v_fma_f32 v167, v167, s58, -v60
v_mfma_f32_16x16x32_bf16 a[84:87], a[236:239], a[148:151], a[84:87]
ds_read_b64_tr_b16 a[226:227], v11 offset:27200
v_fma_f32 v184, -v168, s58, -v63
v_mfma_f32_16x16x32_bf16 a[84:87], a[232:235], a[144:147], a[84:87]
v_exp_f32 v180, v180
v_mfma_f32_16x16x32_bf16 a[76:79], a[232:235], a[136:139], a[76:79]
ds_read_b64_tr_b16 a[228:229], v11 offset:29760
v_fma_f32 v168, v168, s58, -v61
v_mfma_f32_16x16x32_bf16 a[76:79], a[236:239], a[140:143], a[76:79]
buffer_load_dwordx4 v[68:71], v1, s[24:27], s54 offen offset:1024 sc1
v_mfma_f32_16x16x32_bf16 a[68:71], a[236:239], a[132:135], a[68:71]
ds_read_b64_tr_b16 a[230:231], v11 offset:31296
v_fma_f32 v185, -v169, s58, -v63
v_mfma_f32_16x16x32_bf16 a[68:71], a[232:235], a[128:131], a[68:71]
s_waitcnt lgkmcnt(8)
v_exp_f32 v164, v164
v_fma_f32 v169, v169, s58, -v61
v_mfma_f32_16x16x32_bf16 a[0:3], a[240:243], a[128:131], a[0:3]
ds_read_b64_tr_b16 a[232:233], v11 offset:33792
v_fma_f32 v186, -v170, s58, -v63
v_mfma_f32_16x16x32_bf16 a[0:3], a[244:247], a[132:135], a[0:3]
buffer_load_dwordx4 v[72:75], v1, s[24:27], s54 offen offset:2048 sc1
v_mfma_f32_16x16x32_bf16 a[16:19], a[244:247], a[140:143], a[16:19]
ds_read_b64_tr_b16 a[234:235], v11 offset:35328
v_fma_f32 v170, v170, s58, -v61
v_mfma_f32_16x16x32_bf16 a[16:19], a[240:243], a[136:139], a[16:19]
v_exp_f32 v181, v181
v_mfma_f32_16x16x32_bf16 a[32:35], a[240:243], a[144:147], a[32:35]
ds_read_b64_tr_b16 a[236:237], v11 offset:37888
v_fma_f32 v187, -v171, s58, -v63
v_mfma_f32_16x16x32_bf16 a[32:35], a[244:247], a[148:151], a[32:35]
buffer_load_dwordx4 v[76:79], v1, s[24:27], s54 offen offset:3072 sc1
v_mfma_f32_16x16x32_bf16 a[48:51], a[244:247], a[156:159], a[48:51]
ds_read_b64_tr_b16 a[238:239], v11 offset:39424
v_fma_f32 v171, v171, s58, -v61
v_mfma_f32_16x16x32_bf16 a[48:51], a[240:243], a[152:155], a[48:51]
s_waitcnt lgkmcnt(8)
v_exp_f32 v165, v165
v_fma_f32 v188, -v172, s58, -v63
v_mfma_f32_16x16x32_bf16 a[52:55], a[248:251], a[152:155], a[52:55]
ds_read_b64_tr_b16 a[240:241], v11 offset:33824
v_fma_f32 v172, v172, s58, -v61
v_mfma_f32_16x16x32_bf16 a[52:55], a[252:255], a[156:159], a[52:55]
v_exp_f32 v182, v182
v_mfma_f32_16x16x32_bf16 a[36:39], a[252:255], a[148:151], a[36:39]
buffer_load_dwordx4 v[80:83], v2, s[24:27], s54 offen offset:0 sc1
v_mfma_f32_16x16x32_bf16 a[36:39], a[248:251], a[144:147], a[36:39]
ds_read_b64_tr_b16 a[242:243], v11 offset:35360
v_fma_f32 v189, -v173, s58, -v63
v_mfma_f32_16x16x32_bf16 a[20:23], a[248:251], a[136:139], a[20:23]
ds_read_b64_tr_b16 a[244:245], v11 offset:37920
v_fma_f32 v173, v173, s58, -v61
v_mfma_f32_16x16x32_bf16 a[20:23], a[252:255], a[140:143], a[20:23]
v_exp_f32 v166, v166
v_mfma_f32_16x16x32_bf16 a[4:7], a[252:255], a[132:135], a[4:7]
buffer_load_dwordx4 v[84:87], v2, s[24:27], s54 offen offset:1024 sc1
v_mfma_f32_16x16x32_bf16 a[4:7], a[248:251], a[128:131], a[4:7]
s_waitcnt lgkmcnt(7)
ds_read_b64_tr_b16 a[246:247], v11 offset:39456
v_exp_f32 v183, v183
v_mfma_f32_16x16x32_bf16 a[96:99], a[224:227], a[128:131], a[96:99]
ds_read_b64_tr_b16 a[248:249], v11 offset:33856
v_fma_f32 v190, -v174, s58, -v63
v_mfma_f32_16x16x32_bf16 a[96:99], a[228:231], a[132:135], a[96:99]
v_exp_f32 v167, v167
v_mfma_f32_16x16x32_bf16 a[104:107], a[228:231], a[140:143], a[104:107]
buffer_load_dwordx4 v[88:91], v2, s[24:27], s54 offen offset:2048 sc1
v_mfma_f32_16x16x32_bf16 a[104:107], a[224:227], a[136:139], a[104:107]
ds_read_b64_tr_b16 a[250:251], v11 offset:35392
v_fma_f32 v174, v174, s58, -v61
v_mfma_f32_16x16x32_bf16 a[112:115], a[224:227], a[144:147], a[112:115]
ds_read_b64_tr_b16 a[252:253], v11 offset:37952
v_fma_f32 v191, -v175, s58, -v63
v_mfma_f32_16x16x32_bf16 a[112:115], a[228:231], a[148:151], a[112:115]
v_exp_f32 v184, v184
v_mfma_f32_16x16x32_bf16 a[120:123], a[228:231], a[156:159], a[120:123]
ds_read_b64_tr_b16 a[254:255], v11 offset:39488
v_fma_f32 v175, v175, s58, -v61
v_mfma_f32_16x16x32_bf16 a[120:123], a[224:227], a[152:155], a[120:123]
s_waitcnt vmcnt(31) lgkmcnt(8)
s_barrier
v_add_f32 v60, v160, v161
v_mfma_f32_16x16x32_bf16 a[56:59], a[232:235], a[152:155], a[56:59]
buffer_load_dwordx4 v[92:95], v2, s[24:27], s54 offen offset:3072 sc1
v_mfma_f32_16x16x32_bf16 a[56:59], a[236:239], a[156:159], a[56:59]
s_add_u32 s54, s53, 8192
ds_read_b64_tr_b16 a[224:225], v6 offset:40960
v_add_f32 v62, v176, v177
v_mfma_f32_16x16x32_bf16 a[40:43], a[236:239], a[148:151], a[40:43]
ds_read_b64_tr_b16 a[226:227], v6 offset:45056
v_add_f32 v60, v60, v162
v_mfma_f32_16x16x32_bf16 a[40:43], a[232:235], a[144:147], a[40:43]
buffer_load_dwordx4 v[96:99], v1, s[24:27], s54 offen offset:0 sc1
v_mfma_f32_16x16x32_bf16 a[24:27], a[232:235], a[136:139], a[24:27]
ds_read_b64_tr_b16 a[228:229], v6 offset:49152
v_add_f32 v62, v62, v178
v_mfma_f32_16x16x32_bf16 a[24:27], a[236:239], a[140:143], a[24:27]
v_exp_f32 v168, v168
v_mfma_f32_16x16x32_bf16 a[8:11], a[236:239], a[132:135], a[8:11]
ds_read_b64_tr_b16 a[230:231], v6 offset:53248
v_add_f32 v60, v60, v163
v_mfma_f32_16x16x32_bf16 a[8:11], a[232:235], a[128:131], a[8:11]
s_waitcnt lgkmcnt(8)
buffer_load_dwordx4 v[100:103], v1, s[24:27], s54 offen offset:1024 sc1
v_add_f32 v62, v62, v179
v_mfma_f32_16x16x32_bf16 a[12:15], a[240:243], a[128:131], a[12:15]
ds_read_b64_tr_b16 a[232:233], v7 offset:40960
v_add_f32 v60, v60, v164
v_mfma_f32_16x16x32_bf16 a[12:15], a[244:247], a[132:135], a[12:15]
v_exp_f32 v185, v185
v_mfma_f32_16x16x32_bf16 a[28:31], a[244:247], a[140:143], a[28:31]
ds_read_b64_tr_b16 a[234:235], v7 offset:45056
v_add_f32 v63, v184, v185
v_mfma_f32_16x16x32_bf16 a[28:31], a[240:243], a[136:139], a[28:31]
s_bitcmp1_b32 s2, 0
s_cbranch_scc1 pg_8_b
pg_8:
s_cbranch_execz pg_12
v_exp_f32 v169, v169
v_mfma_f32_16x16x32_bf16 a[44:47], a[240:243], a[144:147], a[44:47]
buffer_load_dwordx4 v[104:107], v1, s[24:27], s54 offen offset:2048 sc1
v_mfma_f32_16x16x32_bf16 a[44:47], a[244:247], a[148:151], a[44:47]
ds_read_b64_tr_b16 a[236:237], v7 offset:49152
v_add_f32 v61, v168, v169
v_mfma_f32_16x16x32_bf16 a[60:63], a[244:247], a[156:159], a[60:63]
ds_read_b64_tr_b16 a[238:239], v7 offset:53248
v_add_f32 v62, v62, v180
v_mfma_f32_16x16x32_bf16 a[60:63], a[240:243], a[152:155], a[60:63]
s_waitcnt lgkmcnt(8)
v_exp_f32 v186, v186
v_add_f32 v60, v60, v165
v_mfma_f32_16x16x32_bf16 a[124:127], a[248:251], a[152:155], a[124:127]
buffer_load_dwordx4 v[108:111], v1, s[24:27], s54 offen offset:3072 sc1
v_mfma_f32_16x16x32_bf16 a[124:127], a[252:255], a[156:159], a[124:127]
ds_read_b64_tr_b16 a[240:241], v11 offset:41984
v_add_f32 v63, v63, v186
v_mfma_f32_16x16x32_bf16 a[116:119], a[252:255], a[148:151], a[116:119]
ds_read_b64_tr_b16 a[242:243], v11 offset:43520
v_add_f32 v62, v62, v181
v_mfma_f32_16x16x32_bf16 a[116:119], a[248:251], a[144:147], a[116:119]
v_exp_f32 v170, v170
v_mfma_f32_16x16x32_bf16 a[108:111], a[248:251], a[136:139], a[108:111]
buffer_load_dwordx4 v[112:115], v2, s[24:27], s54 offen offset:0 sc1
v_mfma_f32_16x16x32_bf16 a[108:111], a[252:255], a[140:143], a[108:111]
ds_read_b64_tr_b16 a[244:245], v11 offset:46080
v_add_f32 v61, v61, v170
v_mfma_f32_16x16x32_bf16 a[100:103], a[252:255], a[132:135], a[100:103]
ds_read_b64_tr_b16 a[246:247], v11 offset:47616
v_add_f32 v60, v60, v166
v_mfma_f32_16x16x32_bf16 a[100:103], a[248:251], a[128:131], a[100:103]
s_waitcnt vmcnt(29) lgkmcnt(8)
buffer_load_dword v33, v31, s[24:27], s62 offen offset:0 sc1
v_add_f32 v62, v62, v182
v_mfma_f32_16x16x32_bf16 a[64:67], a[224:227], a[192:195], a[64:67]
ds_read_b64_tr_b16 a[248:249], v11 offset:42016
v_add_f32 v60, v60, v167
v_mfma_f32_16x16x32_bf16 a[64:67], a[228:231], a[196:199], a[64:67]
buffer_load_dwordx4 v[116:119], v2, s[24:27], s54 offen offset:1024 sc1
v_mfma_f32_16x16x32_bf16 a[72:75], a[228:231], a[204:207], a[72:75]
ds_read_b64_tr_b16 a[250:251], v11 offset:43552
v_add_f32 v62, v62, v183
v_mfma_f32_16x16x32_bf16 a[72:75], a[224:227], a[200:203], a[72:75]
v_exp_f32 v187, v187
v_mfma_f32_16x16x32_bf16 a[80:83], a[224:227], a[208:211], a[80:83]
ds_read_b64_tr_b16 a[252:253], v11 offset:46112
v_add_f32 v63, v63, v187
v_mfma_f32_16x16x32_bf16 a[80:83], a[228:231], a[212:215], a[80:83]
v_exp_f32 v171, v171
v_mfma_f32_16x16x32_bf16 a[88:91], a[228:231], a[220:223], a[88:91]
buffer_load_dwordx4 v[120:123], v2, s[24:27], s54 offen offset:2048 sc1
v_mfma_f32_16x16x32_bf16 a[88:91], a[224:227], a[216:219], a[88:91]
s_waitcnt lgkmcnt(7)
ds_read_b64_tr_b16 a[254:255], v11 offset:47648
v_exp_f32 v188, v188
v_mfma_f32_16x16x32_bf16 a[92:95], a[232:235], a[216:219], a[92:95]
ds_read_b64_tr_b16 a[224:225], v11 offset:42048
v_add_f32 v61, v61, v171
v_mfma_f32_16x16x32_bf16 a[92:95], a[236:239], a[220:223], a[92:95]
v_exp_f32 v172, v172
v_mfma_f32_16x16x32_bf16 a[84:87], a[236:239], a[212:215], a[84:87]
buffer_load_dwordx4 v[124:127], v2, s[24:27], s54 offen offset:3072 sc1
v_mfma_f32_16x16x32_bf16 a[84:87], a[232:235], a[208:211], a[84:87]
s_bfe_u32 s55, 0x2000000, s99
ds_read_b64_tr_b16 a[226:227], v11 offset:43584
v_add_f32 v61, v61, v172
v_mfma_f32_16x16x32_bf16 a[76:79], a[232:235], a[200:203], a[76:79]
s_lshl4_add_u32 m0, s55, s100
ds_read_b64_tr_b16 a[228:229], v11 offset:46144
v_add_f32 v63, v63, v188
v_mfma_f32_16x16x32_bf16 a[76:79], a[236:239], a[204:207], a[76:79]
s_mov_b32 s55, 458752
v_exp_f32 v189, v189
v_mfma_f32_16x16x32_bf16 a[68:71], a[236:239], a[196:199], a[68:71]
s_mov_b32 s56, 393216
ds_read_b64_tr_b16 a[230:231], v11 offset:47680
v_add_f32 v63, v63, v189
v_mfma_f32_16x16x32_bf16 a[68:71], a[232:235], a[192:195], a[68:71]
s_waitcnt lgkmcnt(8)
buffer_load_dwordx4 v15, s[12:15], s56 offen offset:0 lds
v_mfma_f32_16x16x32_bf16 a[0:3], a[240:243], a[192:195], a[0:3]
ds_read_b64_tr_b16 a[232:233], v11 offset:50176
ds_read_b64_tr_b16 a[234:235], v11 offset:51712
v_mfma_f32_16x16x32_bf16 a[0:3], a[244:247], a[196:199], a[0:3]
v_exp_f32 v173, v173
v_mfma_f32_16x16x32_bf16 a[16:19], a[244:247], a[204:207], a[16:19]
v_exp_f32 v190, v190
v_mfma_f32_16x16x32_bf16 a[16:19], a[240:243], a[200:203], a[16:19]
v_exp_f32 v174, v174
v_mfma_f32_16x16x32_bf16 a[32:35], a[240:243], a[208:211], a[32:35]
ds_read_b64_tr_b16 a[236:237], v11 offset:54272
v_add_f32 v61, v61, v173
v_mfma_f32_16x16x32_bf16 a[32:35], a[244:247], a[212:215], a[32:35]
v_exp_f32 v191, v191
v_mfma_f32_16x16x32_bf16 a[48:51], a[244:247], a[220:223], a[48:51]
ds_read_b64_tr_b16 a[238:239], v11 offset:55808
v_add_f32 v61, v61, v174
v_mfma_f32_16x16x32_bf16 a[48:51], a[240:243], a[216:219], a[48:51]
s_waitcnt lgkmcnt(8)
v_exp_f32 v175, v175
v_add_f32 v63, v63, v190
v_mfma_f32_16x16x32_bf16 a[52:55], a[248:251], a[216:219], a[52:55]
buffer_load_dwordx4 v13, s[36:39], s55 offen offset:1024 lds
v_mfma_f32_16x16x32_bf16 a[52:55], a[252:255], a[220:223], a[52:55]
ds_read_b64_tr_b16 a[240:241], v11 offset:50208
v_add_f32 v61, v61, v175
v_mfma_f32_16x16x32_bf16 a[36:39], a[252:255], a[212:215], a[36:39]
ds_read_b64_tr_b16 a[242:243], v11 offset:51744
v_add_f32 v63, v63, v191
v_mfma_f32_16x16x32_bf16 a[36:39], a[248:251], a[208:211], a[36:39]
v_permlane16_swap_b32 v60, v61
v_mfma_f32_16x16x32_bf16 a[20:23], a[248:251], a[200:203], a[20:23]
ds_read_b64_tr_b16 a[244:245], v11 offset:54304
v_add_f32 v60, v60, v61
v_mfma_f32_16x16x32_bf16 a[20:23], a[252:255], a[204:207], a[20:23]
v_permlane16_swap_b32 v62, v63
v_mfma_f32_16x16x32_bf16 a[4:7], a[252:255], a[196:199], a[4:7]
ds_read_b64_tr_b16 a[246:247], v11 offset:55840
v_add_f32 v62, v62, v63
v_mfma_f32_16x16x32_bf16 a[4:7], a[248:251], a[192:195], a[4:7]
s_waitcnt lgkmcnt(8)
v_mfma_f32_16x16x32_bf16 a[96:99], a[224:227], a[192:195], a[96:99]
buffer_load_dwordx4 v14, s[36:39], s55 offen offset:2048 lds
v_mfma_f32_16x16x32_bf16 a[96:99], a[228:231], a[196:199], a[96:99]
ds_read_b64_tr_b16 a[248:249], v11 offset:50240
ds_read_b64_tr_b16 a[250:251], v11 offset:51776
v_mfma_f32_16x16x32_bf16 a[104:107], a[228:231], a[204:207], a[104:107]
v_permlane32_swap_b32 v60, v62
v_mfma_f32_16x16x32_bf16 a[104:107], a[224:227], a[200:203], a[104:107]
v_add_f32 v60, v60, v62
v_mfma_f32_16x16x32_bf16 a[112:115], a[224:227], a[208:211], a[112:115]
ds_read_b64_tr_b16 a[252:253], v11 offset:54336
ds_read_b64_tr_b16 a[254:255], v11 offset:55872
v_mfma_f32_16x16x32_bf16 a[112:115], a[228:231], a[212:215], a[112:115]
v_rcp_f32 v60, v60
v_mfma_f32_16x16x32_bf16 a[120:123], a[228:231], a[220:223], a[120:123]
v_mfma_f32_16x16x32_bf16 a[120:123], a[224:227], a[216:219], a[120:123]
s_waitcnt vmcnt(32) lgkmcnt(8)
s_barrier
v_mov_b32 v62, v60
v_mfma_f32_16x16x32_bf16 a[56:59], a[232:235], a[216:219], a[56:59]
buffer_load_dwordx4 v3, s[36:39], s55 offen offset:3072 lds
v_mfma_f32_16x16x32_bf16 a[56:59], a[236:239], a[220:223], a[56:59]
s_bfe_u32 s55, 0x6000400, s99
ds_read_b64_tr_b16 a[224:225], v6 offset:57344
ds_read_b64_tr_b16 a[226:227], v6 offset:61440
v_mfma_f32_16x16x32_bf16 a[40:43], a[236:239], a[212:215], a[40:43]
s_lshl4_add_u32 m0, s55, s100
v_permlane32_swap_b32 v60, v62
v_mfma_f32_16x16x32_bf16 a[40:43], a[232:235], a[208:211], a[40:43]
s_mov_b32 s55, 0
v_mov_b32 v61, v60
v_mov_b32 v63, v62
v_mfma_f32_16x16x32_bf16 a[24:27], a[232:235], a[200:203], a[24:27]
s_mov_b32 s56, 0
ds_read_b64_tr_b16 a[228:229], v8 offset:0
ds_read_b64_tr_b16 a[230:231], v8 offset:4096
v_mfma_f32_16x16x32_bf16 a[24:27], a[236:239], a[204:207], a[24:27]
v_permlane16_swap_b32 v60, v61
v_mfma_f32_16x16x32_bf16 a[8:11], a[236:239], a[196:199], a[8:11]
v_permlane16_swap_b32 v62, v63
v_mfma_f32_16x16x32_bf16 a[8:11], a[232:235], a[192:195], a[8:11]
s_waitcnt lgkmcnt(8)
v_mul_f32 v160, v160, v60
v_mul_f32 v176, v176, v62
v_mul_f32 v161, v161, v60
v_mfma_f32_16x16x32_bf16 a[12:15], a[240:243], a[192:195], a[12:15]
ds_read_b64_tr_b16 a[232:233], v7 offset:57344
v_mul_f32 v177, v177, v62
v_mfma_f32_16x16x32_bf16 a[12:15], a[244:247], a[196:199], a[12:15]
buffer_load_dwordx4 v15, s[12:15], s56 offen offset:0 lds
v_mfma_f32_16x16x32_bf16 a[28:31], a[244:247], a[204:207], a[28:31]
ds_read_b64_tr_b16 a[234:235], v7 offset:61440
v_mul_f32 v162, v162, v60
v_mfma_f32_16x16x32_bf16 a[28:31], a[240:243], a[200:203], a[28:31]
v_mul_f32 v178, v178, v62
v_mul_f32 v163, v163, v60
v_mfma_f32_16x16x32_bf16 a[44:47], a[240:243], a[208:211], a[44:47]
ds_read_b64_tr_b16 a[236:237], v9 offset:0
v_mul_f32 v179, v179, v62
v_mfma_f32_16x16x32_bf16 a[44:47], a[244:247], a[212:215], a[44:47]
v_mul_f32 v164, v164, v60
v_mul_f32 v180, v180, v62
v_mfma_f32_16x16x32_bf16 a[60:63], a[244:247], a[220:223], a[60:63]
ds_read_b64_tr_b16 a[238:239], v9 offset:4096
v_mul_f32 v165, v165, v60
v_mfma_f32_16x16x32_bf16 a[60:63], a[240:243], a[216:219], a[60:63]
s_waitcnt lgkmcnt(8)
v_mul_f32 v181, v181, v62
v_mul_f32 v166, v166, v60
v_mul_f32 v182, v182, v62
v_mfma_f32_16x16x32_bf16 a[124:127], a[248:251], a[216:219], a[124:127]
ds_read_b64_tr_b16 a[240:241], v11 offset:58368
v_mul_f32 v167, v167, v60
v_mfma_f32_16x16x32_bf16 a[124:127], a[252:255], a[220:223], a[124:127]
v_mul_f32 v183, v183, v62
v_cvt_pk_bf16_f32 v208, v160, v161
v_mfma_f32_16x16x32_bf16 a[116:119], a[252:255], a[212:215], a[116:119]
buffer_load_dwordx4 v13, s[36:39], s55 offen offset:1024 lds
v_mfma_f32_16x16x32_bf16 a[116:119], a[248:251], a[208:211], a[116:119]
ds_read_b64_tr_b16 a[242:243], v11 offset:59904
v_cvt_pk_bf16_f32 v209, v162, v163
v_mfma_f32_16x16x32_bf16 a[108:111], a[248:251], a[200:203], a[108:111]
ds_read_b64_tr_b16 a[244:245], v11 offset:62464
v_cvt_pk_bf16_f32 v210, v164, v165
v_mfma_f32_16x16x32_bf16 a[108:111], a[252:255], a[204:207], a[108:111]
s_waitcnt vmcnt(9)
v_cvt_pk_bf16_f32 v211, v166, v167
v_cmp_ne_u32 vcc, v33, v32
s_nop 0
s_cbranch_vccnz ckH_spin
ckH_ok:
v_mfma_f32_16x16x32_bf16 a[100:103], a[252:255], a[196:199], a[100:103]
ds_read_b64_tr_b16 a[246:247], v11 offset:64000
v_cvt_pk_bf16_f32 v212, v176, v177
v_mfma_f32_16x16x32_bf16 a[100:103], a[248:251], a[192:195], a[100:103]
s_waitcnt lgkmcnt(8)
v_cvt_pk_bf16_f32 v213, v178, v179
v_cvt_pk_bf16_f32 v214, v180, v181
v_cvt_pk_bf16_f32 v215, v182, v183
v_mfma_f32_16x16x32_bf16 a[64:67], a[224:227], a[160:163], a[64:67]
ds_read_b64_tr_b16 a[248:249], v11 offset:58400
v_mul_f32 v168, v168, v61
v_mfma_f32_16x16x16_bf16 v[160:163], v[208:209], v[38:39], 0
v_mul_f32 v184, v184, v63
v_mul_f32 v169, v169, v61
v_mfma_f32_16x16x32_bf16 a[64:67], a[228:231], a[164:167], a[64:67]
buffer_load_dwordx4 v14, s[36:39], s55 offen offset:2048 lds
v_mfma_f32_16x16x32_bf16 a[72:75], a[228:231], a[172:175], a[72:75]
ds_read_b64_tr_b16 a[250:251], v11 offset:59936
v_mul_f32 v185, v185, v63
v_mfma_f32_16x16x16_bf16 v[176:179], v[212:213], v[38:39], 0
v_mul_f32 v170, v170, v61
v_mul_f32 v186, v186, v63
v_mfma_f32_16x16x32_bf16 a[72:75], a[224:227], a[168:171], a[72:75]
v_mul_f32 v171, v171, v61
v_mul_f32 v187, v187, v63
v_mfma_f32_16x16x32_bf16 a[80:83], a[224:227], a[176:179], a[80:83]
ds_read_b64_tr_b16 a[252:253], v11 offset:62496
v_mul_f32 v172, v172, v61
v_mfma_f32_16x16x32_bf16 a[80:83], a[228:231], a[180:183], a[80:83]
v_mul_f32 v188, v188, v63
v_mul_f32 v173, v173, v61
v_mfma_f32_16x16x32_bf16 a[88:91], a[228:231], a[188:191], a[88:91]
ds_read_b64_tr_b16 a[254:255], v11 offset:64032
v_mul_f32 v189, v189, v63
v_mfma_f32_16x16x32_bf16 a[88:91], a[224:227], a[184:187], a[88:91]
s_waitcnt lgkmcnt(8)
v_mul_f32 v174, v174, v61
v_mul_f32 v190, v190, v63
v_mul_f32 v175, v175, v61
v_mfma_f32_16x16x32_bf16 a[92:95], a[232:235], a[184:187], a[92:95]
ds_read_b64_tr_b16 a[224:225], v11 offset:58432
v_mul_f32 v191, v191, v63
v_mfma_f32_16x16x32_bf16 a[92:95], a[236:239], a[188:191], a[92:95]
buffer_load_dwordx4 v3, s[36:39], s55 offen offset:3072 lds
v_mfma_f32_16x16x32_bf16 a[84:87], a[236:239], a[180:183], a[84:87]
s_add_u32 s54, s53, 0
ds_read_b64_tr_b16 a[226:227], v11 offset:59968
v_cvt_pk_bf16_f32 v216, v168, v169
v_mfma_f32_16x16x32_bf16 a[84:87], a[232:235], a[176:179], a[84:87]
v_cvt_pk_bf16_f32 v217, v170, v171
v_cvt_pk_bf16_f32 v218, v172, v173
v_mfma_f32_16x16x16_bf16 v[168:171], v[210:211], v[38:39], 0
v_cvt_pk_bf16_f32 v219, v174, v175
v_cvt_pk_bf16_f32 v220, v184, v185
v_mfma_f32_16x16x16_bf16 v[164:167], v[216:217], v[38:39], 0
v_cvt_pk_bf16_f32 v221, v186, v187
v_cvt_pk_bf16_f32 v222, v188, v189
v_mfma_f32_16x16x16_bf16 v[172:175], v[218:219], v[38:39], 0
v_cvt_pk_bf16_f32 v223, v190, v191
v_cvt_pk_bf16_f32 v208, v160, v161
v_mfma_f32_16x16x16_bf16 v[180:183], v[220:221], v[38:39], 0
v_cvt_pk_bf16_f32 v209, v162, v163
v_cvt_pk_bf16_f32 v212, v168, v169
v_mfma_f32_16x16x16_bf16 v[184:187], v[214:215], v[38:39], 0
v_cvt_pk_bf16_f32 v210, v164, v165
v_cvt_pk_bf16_f32 v211, v166, v167
v_mfma_f32_16x16x16_bf16 v[188:191], v[222:223], v[38:39], 0
v_cvt_pk_bf16_f32 v213, v170, v171
v_cvt_pk_bf16_f32 v214, v172, v173
v_mfma_f32_16x16x32_bf16 v[160:163], v[192:195], v[224:227], 0
buffer_load_dwordx4 a[128:131], v1, s[24:27], s54 offen offset:0 sc1
v_mfma_f32_16x16x32_bf16 v[160:163], v[208:211], v[232:235], v[160:163]
v_cvt_pk_bf16_f32 v215, v174, v175
v_cvt_pk_bf16_f32 v216, v176, v177
v_mfma_f32_16x16x32_bf16 v[164:167], v[192:195], v[240:243], 0
v_cvt_pk_bf16_f32 v217, v178, v179
v_cvt_pk_bf16_f32 v218, v180, v181
v_mfma_f32_16x16x32_bf16 v[164:167], v[208:211], v[248:251], v[164:167]
v_cvt_pk_bf16_f32 v219, v182, v183
v_cvt_pk_bf16_f32 v220, v184, v185
v_mfma_f32_16x16x32_bf16 v[228:231], v[192:195], v[48:51], 0
buffer_load_dwordx4 a[132:135], v1, s[24:27], s54 offen offset:1024 sc1
v_mfma_f32_16x16x32_bf16 v[228:231], v[208:211], v[48:51], v[228:231]
v_cvt_pk_bf16_f32 v221, v186, v187
v_cvt_pk_bf16_f32 v222, v188, v189
v_mfma_f32_16x16x32_bf16 v[168:171], v[196:199], v[224:227], 0
v_cvt_pk_bf16_f32 v223, v190, v191
v_mfma_f32_16x16x32_bf16 v[168:171], v[212:215], v[232:235], v[168:171]
v_mfma_f32_16x16x32_bf16 v[172:175], v[196:199], v[240:243], 0
v_mfma_f32_16x16x32_bf16 v[172:175], v[212:215], v[248:251], v[172:175]
buffer_load_dwordx4 a[136:139], v1, s[24:27], s54 offen offset:2048 sc1
v_mfma_f32_16x16x32_bf16 v[236:239], v[196:199], v[48:51], 0
v_mfma_f32_16x16x32_bf16 v[236:239], v[212:215], v[48:51], v[236:239]
v_mfma_f32_16x16x32_bf16 v[176:179], v[200:203], v[224:227], 0
v_mfma_f32_16x16x32_bf16 v[176:179], v[216:219], v[232:235], v[176:179]
buffer_load_dwordx4 a[140:143], v1, s[24:27], s54 offen offset:3072 sc1
v_mfma_f32_16x16x32_bf16 v[180:183], v[200:203], v[240:243], 0
v_mfma_f32_16x16x32_bf16 v[180:183], v[216:219], v[248:251], v[180:183]
s_load_dword s101, s[92:93], 40952
v_mfma_f32_16x16x32_bf16 v[244:247], v[200:203], v[48:51], 0
v_mfma_f32_16x16x32_bf16 v[244:247], v[216:219], v[48:51], v[244:247]
v_mfma_f32_16x16x32_bf16 v[184:187], v[204:207], v[224:227], 0
buffer_load_dwordx4 a[144:147], v2, s[24:27], s54 offen offset:0 sc1
v_mfma_f32_16x16x32_bf16 v[184:187], v[220:223], v[232:235], v[184:187]
v_mfma_f32_16x16x32_bf16 v[188:191], v[204:207], v[240:243], 0
v_mfma_f32_16x16x32_bf16 v[188:191], v[220:223], v[248:251], v[188:191]
v_mfma_f32_16x16x32_bf16 v[252:255], v[204:207], v[48:51], 0
buffer_load_dwordx4 a[148:151], v2, s[24:27], s54 offen offset:1024 sc1
v_mfma_f32_16x16x32_bf16 v[252:255], v[220:223], v[48:51], v[252:255]
s_lshl_b32 s5, s32, 6
v_add_u32 v52, s52, v1
v_and_b32 v54, 48, v0
v_mfma_f32_16x16x32_bf16 a[76:79], a[232:235], a[168:171], a[76:79]
s_add_u32 s5, s5, 157696
ds_read_b64_tr_b16 a[228:229], v11 offset:62528
v_add_u32 v55, s5, v54
v_mfma_f32_16x16x32_bf16 a[76:79], a[236:239], a[172:175], a[76:79]
v_and_b32 v53, 15, v0
v_lshl_add_u32 v55, v53, 18, v55
v_mfma_f32_16x16x32_bf16 a[68:71], a[236:239], a[164:167], a[68:71]
ds_read_b64_tr_b16 a[230:231], v11 offset:64064
v_add_u32 v53, 65536, v52
v_mfma_f32_16x16x32_bf16 a[68:71], a[232:235], a[160:163], a[68:71]
s_waitcnt lgkmcnt(8)
buffer_load_dwordx4 a[152:155], v2, s[24:27], s54 offen offset:2048 sc1
v_mfma_f32_16x16x32_bf16 a[0:3], a[240:243], a[160:163], a[0:3]
ds_read_b64_tr_b16 a[232:233], v12 offset:1024
ds_write_b128 v53, v[160:163] offset:0
v_mfma_f32_16x16x32_bf16 a[0:3], a[244:247], a[164:167], a[0:3]
v_mfma_f32_16x16x32_bf16 a[16:19], a[244:247], a[172:175], a[16:19]
buffer_load_dwordx4 a[156:159], v2, s[24:27], s54 offen offset:3072 sc1
v_mfma_f32_16x16x32_bf16 a[16:19], a[240:243], a[168:171], a[16:19]
s_bfe_u32 s55, 0x40200, s64
ds_read_b64_tr_b16 a[234:235], v12 offset:2560
ds_write_b128 v53, v[164:167] offset:1024
v_mfma_f32_16x16x32_bf16 a[32:35], a[240:243], a[176:179], a[32:35]
s_lshl_b32 s55, s55, 18
ds_read_b64_tr_b16 a[236:237], v12 offset:5120
v_add_u32 v53, 73728, v52
v_mfma_f32_16x16x32_bf16 a[32:35], a[244:247], a[180:183], a[32:35]
s_add_u32 m0, s52, 32768
v_mfma_f32_16x16x32_bf16 a[48:51], a[244:247], a[188:191], a[48:51]
buffer_load_dwordx4 v28, s[40:43], s55 offen offset:0 lds
v_mfma_f32_16x16x32_bf16 a[48:51], a[240:243], a[184:187], a[48:51]
s_waitcnt lgkmcnt(9)
ds_read_b64_tr_b16 a[238:239], v12 offset:6656
ds_write_b128 v55, v[228:231] offset:0
v_mfma_f32_16x16x32_bf16 a[52:55], a[248:251], a[184:187], a[52:55]
ds_read_b64_tr_b16 a[240:241], v12 offset:1056
v_mfma_f32_16x16x32_bf16 a[52:55], a[252:255], a[188:191], a[52:55]
buffer_load_dwordx4 v29, s[40:43], s55 offen offset:1024 lds
v_mfma_f32_16x16x32_bf16 a[36:39], a[252:255], a[180:183], a[36:39]
s_xor_b32 s55, s55, 128
ds_read_b64_tr_b16 a[242:243], v12 offset:2592
ds_write_b128 v53, v[168:171] offset:0
v_mfma_f32_16x16x32_bf16 a[36:39], a[248:251], a[176:179], a[36:39]
s_add_u32 m0, s52, 40960
v_mfma_f32_16x16x32_bf16 a[20:23], a[248:251], a[168:171], a[20:23]
ds_read_b64_tr_b16 a[244:245], v12 offset:5152
v_mfma_f32_16x16x32_bf16 a[20:23], a[252:255], a[172:175], a[20:23]
buffer_load_dwordx4 v28, s[40:43], s55 offen offset:0 lds
v_mfma_f32_16x16x32_bf16 a[4:7], a[252:255], a[164:167], a[4:7]
ds_read_b64_tr_b16 a[246:247], v12 offset:6688
ds_write_b128 v53, v[172:175] offset:1024
v_mfma_f32_16x16x32_bf16 a[4:7], a[248:251], a[160:163], a[4:7]
s_waitcnt lgkmcnt(13)
v_add_u32 v53, 81920, v52
v_mfma_f32_16x16x32_bf16 a[96:99], a[224:227], a[160:163], a[96:99]
buffer_load_dwordx4 v29, s[40:43], s55 offen offset:1024 lds
v_mfma_f32_16x16x32_bf16 a[96:99], a[228:231], a[164:167], a[96:99]
s_xor_b32 s55, s55, 131072
ds_read_b64_tr_b16 a[248:249], v12 offset:1088
ds_write_b128 v55, v[236:239] offset:256
v_mfma_f32_16x16x32_bf16 a[104:107], a[228:231], a[172:175], a[104:107]
s_add_u32 m0, s52, 49152
ds_read_b64_tr_b16 a[250:251], v12 offset:2624
v_mfma_f32_16x16x32_bf16 a[104:107], a[224:227], a[168:171], a[104:107]
v_mfma_f32_16x16x32_bf16 a[112:115], a[224:227], a[176:179], a[112:115]
buffer_load_dwordx4 v28, s[40:43], s55 offen offset:0 lds
v_mfma_f32_16x16x32_bf16 a[112:115], a[228:231], a[180:183], a[112:115]
ds_read_b64_tr_b16 a[252:253], v12 offset:5184
ds_write_b128 v53, v[176:179] offset:0
v_mfma_f32_16x16x32_bf16 a[120:123], a[228:231], a[188:191], a[120:123]
ds_read_b64_tr_b16 a[254:255], v12 offset:6720
v_mfma_f32_16x16x32_bf16 a[120:123], a[224:227], a[184:187], a[120:123]
s_waitcnt vmcnt(38) lgkmcnt(13)
s_barrier
v_mfma_f32_16x16x32_bf16 a[56:59], a[232:235], a[184:187], a[56:59]
buffer_load_dwordx4 v29, s[40:43], s55 offen offset:1024 lds
v_mfma_f32_16x16x32_bf16 a[56:59], a[236:239], a[188:191], a[56:59]
s_xor_b32 s55, s55, 128
ds_read_b64_tr_b16 a[224:225], v8 offset:8192
ds_write_b128 v53, v[180:183] offset:1024
v_mfma_f32_16x16x32_bf16 a[40:43], a[236:239], a[180:183], a[40:43]
s_add_u32 m0, s52, 57344
ds_read_b64_tr_b16 a[226:227], v8 offset:12288
v_add_u32 v53, 90112, v52
v_mfma_f32_16x16x32_bf16 a[40:43], a[232:235], a[176:179], a[40:43]
buffer_load_dwordx4 v28, s[40:43], s55 offen offset:0 lds
v_mfma_f32_16x16x32_bf16 a[24:27], a[232:235], a[168:171], a[24:27]
ds_read_b64_tr_b16 a[228:229], v8 offset:16384
ds_write_b128 v55, v[244:247] offset:512
v_mfma_f32_16x16x32_bf16 a[24:27], a[236:239], a[172:175], a[24:27]
buffer_load_dwordx4 v29, s[40:43], s55 offen offset:1024 lds
v_mfma_f32_16x16x32_bf16 a[8:11], a[236:239], a[164:167], a[8:11]
s_bfe_u32 s54, 0x40200, s64
ds_read_b64_tr_b16 a[230:231], v8 offset:20480
s_lshl_b32 s54, s54, 13
v_mfma_f32_16x16x32_bf16 a[8:11], a[232:235], a[160:163], a[8:11]
s_waitcnt lgkmcnt(13)
s_add_u32 s54, s54, s63
v_mfma_f32_16x16x32_bf16 a[12:15], a[240:243], a[160:163], a[12:15]
ds_read_b64_tr_b16 a[232:233], v9 offset:8192
ds_write_b128 v53, v[184:187] offset:0
v_mfma_f32_16x16x32_bf16 a[12:15], a[244:247], a[164:167], a[12:15]
buffer_load_dwordx4 v[128:131], v1, s[24:27], s54 offen offset:0 sc1
v_mfma_f32_16x16x32_bf16 a[28:31], a[244:247], a[172:175], a[28:31]
ds_read_b64_tr_b16 a[234:235], v9 offset:12288
v_mfma_f32_16x16x32_bf16 a[28:31], a[240:243], a[168:171], a[28:31]
v_mfma_f32_16x16x32_bf16 a[44:47], a[240:243], a[176:179], a[44:47]
ds_read_b64_tr_b16 a[236:237], v9 offset:16384
ds_write_b128 v53, v[188:191] offset:1024
v_mfma_f32_16x16x32_bf16 a[44:47], a[244:247], a[180:183], a[44:47]
buffer_load_dwordx4 v[132:135], v1, s[24:27], s54 offen offset:1024 sc1
v_mfma_f32_16x16x32_bf16 a[60:63], a[244:247], a[188:191], a[60:63]
ds_read_b64_tr_b16 a[238:239], v9 offset:20480
v_mfma_f32_16x16x32_bf16 a[60:63], a[240:243], a[184:187], a[60:63]
s_waitcnt lgkmcnt(12)
v_mfma_f32_16x16x32_bf16 a[124:127], a[248:251], a[184:187], a[124:127]
ds_read_b64_tr_b16 a[240:241], v12 offset:9216
ds_write_b128 v55, v[252:255] offset:768
v_mfma_f32_16x16x32_bf16 a[124:127], a[252:255], a[188:191], a[124:127]
buffer_load_dwordx4 v[136:139], v1, s[24:27], s54 offen offset:2048 sc1
v_mfma_f32_16x16x32_bf16 a[116:119], a[252:255], a[180:183], a[116:119]
s_lshl_b32 s5, s32, 3
ds_read_b64_tr_b16 a[242:243], v12 offset:10752
s_lshr_b32 s5, 0xb0a0908, s5
v_mfma_f32_16x16x32_bf16 a[116:119], a[248:251], a[176:179], a[116:119]
s_and_b32 s5, s5, 255
s_lshl_b32 s5, s5, 13
v_add_u32 v53, s5, v1
v_mfma_f32_16x16x32_bf16 a[108:111], a[248:251], a[168:171], a[108:111]
buffer_load_dwordx4 v[140:143], v1, s[24:27], s54 offen offset:3072 sc1
v_mfma_f32_16x16x32_bf16 a[108:111], a[252:255], a[172:175], a[108:111]
s_lshl_b32 s5, s32, 8
ds_read_b64_tr_b16 a[244:245], v12 offset:13312
s_add_u32 s5, s5, 157696
v_mfma_f32_16x16x32_bf16 a[100:103], a[252:255], a[164:167], a[100:103]
ds_read_b64_tr_b16 a[246:247], v12 offset:14848
v_add_u32 v55, s5, v54
v_mfma_f32_16x16x32_bf16 a[100:103], a[248:251], a[160:163], a[100:103]
s_waitcnt lgkmcnt(11)
v_mfma_f32_16x16x32_bf16 a[64:67], a[224:227], v[64:67], a[64:67]
ds_read_b64_tr_b16 a[248:249], v12 offset:9248
v_mfma_f32_16x16x32_bf16 a[64:67], a[228:231], v[68:71], a[64:67]
buffer_load_dwordx4 v[144:147], v2, s[24:27], s54 offen offset:0 sc1
v_mfma_f32_16x16x32_bf16 a[72:75], a[228:231], v[76:79], a[72:75]
ds_read_b64_tr_b16 a[250:251], v12 offset:10784
v_mfma_f32_16x16x32_bf16 a[72:75], a[224:227], v[72:75], a[72:75]
v_mfma_f32_16x16x32_bf16 a[80:83], a[224:227], v[80:83], a[80:83]
ds_read_b64_tr_b16 a[252:253], v12 offset:13344
v_mfma_f32_16x16x32_bf16 a[80:83], a[228:231], v[84:87], a[80:83]
buffer_load_dwordx4 v[148:151], v2, s[24:27], s54 offen offset:1024 sc1
v_mfma_f32_16x16x32_bf16 a[88:91], a[228:231], v[92:95], a[88:91]
ds_read_b64_tr_b16 a[254:255], v12 offset:14880
v_mfma_f32_16x16x32_bf16 a[88:91], a[224:227], v[88:91], a[88:91]
s_waitcnt lgkmcnt(9)
v_mfma_f32_16x16x32_bf16 a[92:95], a[232:235], v[88:91], a[92:95]
ds_read_b64_tr_b16 a[224:225], v12 offset:9280
v_mfma_f32_16x16x32_bf16 a[92:95], a[236:239], v[92:95], a[92:95]
v_mfma_f32_16x16x32_bf16 a[84:87], a[236:239], v[84:87], a[84:87]
buffer_load_dwordx4 v[152:155], v2, s[24:27], s54 offen offset:2048 sc1
v_mfma_f32_16x16x32_bf16 a[84:87], a[232:235], v[80:83], a[84:87]
ds_read_b64_tr_b16 a[226:227], v12 offset:10816
v_mfma_f32_16x16x32_bf16 a[76:79], a[232:235], v[72:75], a[76:79]
ds_read_b64_tr_b16 a[228:229], v12 offset:13376
v_mfma_f32_16x16x32_bf16 a[76:79], a[236:239], v[76:79], a[76:79]
v_mfma_f32_16x16x32_bf16 a[68:71], a[236:239], v[68:71], a[68:71]
buffer_load_dwordx4 v[156:159], v2, s[24:27], s54 offen offset:3072 sc1
v_mfma_f32_16x16x32_bf16 a[68:71], a[232:235], v[64:67], a[68:71]
s_waitcnt lgkmcnt(7)
ds_read_b64_tr_b16 a[230:231], v12 offset:14912
s_bfe_u32 s55, 0x6000002, s64
v_mfma_f32_16x16x32_bf16 a[0:3], a[240:243], v[64:67], a[0:3]
s_lshl_b32 s55, s55, 18
ds_read_b64_tr_b16 a[232:233], v12 offset:17408
s_add_u32 m0, s52, 98304
v_mfma_f32_16x16x32_bf16 a[0:3], a[244:247], v[68:71], a[0:3]
v_mfma_f32_16x16x32_bf16 a[16:19], a[244:247], v[76:79], a[16:19]
ds_read_b64_tr_b16 a[234:235], v12 offset:18944
v_mfma_f32_16x16x32_bf16 a[16:19], a[240:243], v[72:75], a[16:19]
buffer_load_dwordx4 v28, s[40:43], s55 offen offset:0 lds
v_mfma_f32_16x16x32_bf16 a[32:35], a[240:243], v[80:83], a[32:35]
ds_read_b64_tr_b16 a[236:237], v12 offset:21504
v_mfma_f32_16x16x32_bf16 a[32:35], a[244:247], v[84:87], a[32:35]
v_mfma_f32_16x16x32_bf16 a[48:51], a[244:247], v[92:95], a[48:51]
ds_read_b64_tr_b16 a[238:239], v12 offset:23040
v_mfma_f32_16x16x32_bf16 a[48:51], a[240:243], v[88:91], a[48:51]
s_waitcnt lgkmcnt(8)
buffer_load_dwordx4 v29, s[40:43], s55 offen offset:1024 lds
v_mfma_f32_16x16x32_bf16 a[52:55], a[248:251], v[88:91], a[52:55]
s_xor_b32 s55, s55, 128
ds_read_b64_tr_b16 a[240:241], v12 offset:17440
s_add_u32 m0, s52, 106496
v_mfma_f32_16x16x32_bf16 a[52:55], a[252:255], v[92:95], a[52:55]
v_mfma_f32_16x16x32_bf16 a[36:39], a[252:255], v[84:87], a[36:39]
ds_read_b64_tr_b16 a[242:243], v12 offset:18976
v_mfma_f32_16x16x32_bf16 a[36:39], a[248:251], v[80:83], a[36:39]
v_mfma_f32_16x16x32_bf16 a[20:23], a[248:251], v[72:75], a[20:23]
buffer_load_dwordx4 v28, s[40:43], s55 offen offset:0 lds
v_mfma_f32_16x16x32_bf16 a[20:23], a[252:255], v[76:79], a[20:23]
ds_read_b64_tr_b16 a[244:245], v12 offset:21536
v_mfma_f32_16x16x32_bf16 a[4:7], a[252:255], v[68:71], a[4:7]
ds_read_b64_tr_b16 a[246:247], v12 offset:23072
v_mfma_f32_16x16x32_bf16 a[4:7], a[248:251], v[64:67], a[4:7]
s_waitcnt lgkmcnt(8)
v_mfma_f32_16x16x32_bf16 a[96:99], a[224:227], v[64:67], a[96:99]
buffer_load_dwordx4 v29, s[40:43], s55 offen offset:1024 lds
v_mfma_f32_16x16x32_bf16 a[96:99], a[228:231], v[68:71], a[96:99]
s_xor_b32 s55, s55, 131072
ds_read_b64_tr_b16 a[248:249], v12 offset:17472
s_add_u32 m0, s52, 114688
v_mfma_f32_16x16x32_bf16 a[104:107], a[228:231], v[76:79], a[104:107]
ds_read_b64_tr_b16 a[250:251], v12 offset:19008
v_mfma_f32_16x16x32_bf16 a[104:107], a[224:227], v[72:75], a[104:107]
v_mfma_f32_16x16x32_bf16 a[112:115], a[224:227], v[80:83], a[112:115]
ds_read_b64_tr_b16 a[252:253], v12 offset:21568
v_mfma_f32_16x16x32_bf16 a[112:115], a[228:231], v[84:87], a[112:115]
buffer_load_dwordx4 v28, s[40:43], s55 offen offset:0 lds
v_mfma_f32_16x16x32_bf16 a[120:123], a[228:231], v[92:95], a[120:123]
ds_read_b64_tr_b16 a[254:255], v12 offset:23104
v_mfma_f32_16x16x32_bf16 a[120:123], a[224:227], v[88:91], a[120:123]
s_waitcnt vmcnt(29) lgkmcnt(0)
s_barrier
v_mfma_f32_16x16x32_bf16 a[56:59], a[232:235], v[88:91], a[56:59]
ds_read_b128 v[192:195], v53 offset:0
ds_read_b64_tr_b16 a[224:225], v10 offset:1088
v_mfma_f32_16x16x32_bf16 a[56:59], a[236:239], v[92:95], a[56:59]
buffer_load_dwordx4 v29, s[40:43], s55 offen offset:1024 lds
v_mfma_f32_16x16x32_bf16 a[40:43], a[236:239], v[84:87], a[40:43]
s_xor_b32 s55, s55, 128
ds_read_b128 v[196:199], v53 offset:1024
ds_read_b64_tr_b16 a[226:227], v10 offset:2624
v_mfma_f32_16x16x32_bf16 a[40:43], a[232:235], v[80:83], a[40:43]
s_add_u32 m0, s52, 122880
v_and_b32 v52, 15, v0
v_mov_b32 v57, 0x7f000000
v_mfma_f32_16x16x32_bf16 a[24:27], a[232:235], v[72:75], a[24:27]
ds_read_b128 v[200:203], v55 offset:0
ds_read_b64_tr_b16 a[228:229], v10 offset:5184
v_mfma_f32_16x16x32_bf16 a[24:27], a[236:239], v[76:79], a[24:27]
buffer_load_dwordx4 v28, s[40:43], s55 offen offset:0 lds
v_mfma_f32_16x16x32_bf16 a[8:11], a[236:239], v[68:71], a[8:11]
ds_read_b128 v[204:207], v53 offset:2048
ds_read_b64_tr_b16 a[230:231], v10 offset:6720
v_mfma_f32_16x16x32_bf16 a[8:11], a[232:235], v[64:67], a[8:11]
v_mfma_f32_16x16x32_bf16 a[12:15], a[240:243], v[64:67], a[12:15]
ds_read_b128 v[208:211], v53 offset:3072
ds_read_b64_tr_b16 a[232:233], v10 offset:9280
v_mfma_f32_16x16x32_bf16 a[12:15], a[244:247], v[68:71], a[12:15]
v_mfma_f32_16x16x32_bf16 a[28:31], a[244:247], v[76:79], a[28:31]
buffer_load_dwordx4 v29, s[40:43], s55 offen offset:1024 lds
v_mfma_f32_16x16x32_bf16 a[28:31], a[240:243], v[72:75], a[28:31]
s_bfe_u32 s54, 0x6000002, s64
ds_read_b128 v[212:215], v55 offset:64
ds_read_b64_tr_b16 a[234:235], v10 offset:10816
v_mfma_f32_16x16x32_bf16 a[44:47], a[240:243], v[80:83], a[44:47]
s_lshl_b32 s54, s54, 13
ds_read_b64_tr_b16 a[236:237], v10 offset:13376
s_add_u32 s54, s54, s63
pg_9:
s_cbranch_execz pg_13
v_mfma_f32_16x16x32_bf16 a[44:47], a[244:247], v[84:87], a[44:47]
ds_read_b128 v[216:219], v53 offset:4096
v_mfma_f32_16x16x32_bf16 a[60:63], a[244:247], v[92:95], a[60:63]
buffer_load_dwordx4 a[160:163], v1, s[24:27], s54 offen offset:0 sc1
v_mfma_f32_16x16x32_bf16 a[60:63], a[240:243], v[88:91], a[60:63]
ds_read_b128 v[220:223], v53 offset:5120
ds_read_b64_tr_b16 a[238:239], v10 offset:14912
v_mfma_f32_16x16x32_bf16 a[124:127], a[248:251], v[88:91], a[124:127]
ds_read_b64_tr_b16 a[240:241], v10 offset:17472
v_mfma_f32_16x16x32_bf16 a[124:127], a[252:255], v[92:95], a[124:127]
ds_read_b128 v[224:227], v55 offset:128
v_mfma_f32_16x16x32_bf16 a[116:119], a[252:255], v[84:87], a[116:119]
ds_read_b64_tr_b16 a[242:243], v10 offset:19008
v_mfma_f32_16x16x32_bf16 a[116:119], a[248:251], v[80:83], a[116:119]
buffer_load_dwordx4 a[164:167], v1, s[24:27], s54 offen offset:1024 sc1
v_mfma_f32_16x16x32_bf16 a[108:111], a[248:251], v[72:75], a[108:111]
ds_read_b128 v[228:231], v53 offset:6144
ds_read_b64_tr_b16 a[244:245], v10 offset:21568
v_mfma_f32_16x16x32_bf16 a[108:111], a[252:255], v[76:79], a[108:111]
v_mfma_f32_16x16x32_bf16 a[100:103], a[252:255], v[68:71], a[100:103]
ds_read_b128 v[232:235], v53 offset:7168
ds_read_b64_tr_b16 a[246:247], v10 offset:23104
v_mfma_f32_16x16x32_bf16 a[100:103], a[248:251], v[64:67], a[100:103]
s_waitcnt lgkmcnt(15)
buffer_load_dwordx4 a[168:171], v1, s[24:27], s54 offen offset:2048 sc1
v_mfma_f32_16x16x32_bf16 a[96:99], a[224:227], v[96:99], a[96:99]
ds_read_b128 v[236:239], v55 offset:192
ds_read_b64_tr_b16 a[248:249], v10 offset:25664
v_mfma_f32_16x16x32_bf16 a[96:99], a[228:231], v[100:103], a[96:99]
s_lshl_b32 s6, s68, 3
s_add_u32 s6, s6, s33
s_lshl_b32 s5, s6, 6
v_mfma_f32_16x16x32_bf16 a[104:107], a[228:231], v[108:111], a[104:107]
s_lshl_b32 s6, s6, 10
ds_read_b64_tr_b16 a[250:251], v10 offset:27200
s_add_u32 s6, s6, 12582912
v_mfma_f32_16x16x32_bf16 a[104:107], a[224:227], v[104:107], a[104:107]
s_add_u32 s5, s5, 15728640
v_cmp_eq_u32 vcc, 0, v52
s_nop 1
v_cndmask_b32 v57, v57, v54, vcc
v_mfma_f32_16x16x32_bf16 a[112:115], a[224:227], v[112:115], a[112:115]
buffer_load_dwordx4 a[172:175], v1, s[24:27], s54 offen offset:3072 sc1
v_mfma_f32_16x16x32_bf16 a[112:115], a[228:231], v[116:119], a[112:115]
ds_read_b64_tr_b16 a[252:253], v10 offset:29760
v_add_f32 v192, v192, v204
v_mfma_f32_16x16x32_bf16 a[120:123], a[228:231], v[124:127], a[120:123]
ds_read_b64_tr_b16 a[254:255], v10 offset:31296
v_add_f32 v193, v193, v205
v_mfma_f32_16x16x32_bf16 a[120:123], a[224:227], v[120:123], a[120:123]
s_waitcnt lgkmcnt(12)
v_add_f32 v194, v194, v206
v_add_f32 v195, v195, v207
v_add_f32 v196, v196, v208
v_mfma_f32_16x16x32_bf16 a[124:127], a[232:235], v[120:123], a[124:127]
buffer_load_dwordx4 a[176:179], v2, s[24:27], s54 offen offset:0 sc1
v_mfma_f32_16x16x32_bf16 a[124:127], a[236:239], v[124:127], a[124:127]
ds_read_b64_tr_b16 a[224:225], v4 offset:0
v_add_f32 v197, v197, v209
v_mfma_f32_16x16x32_bf16 a[116:119], a[236:239], v[116:119], a[116:119]
ds_read_b64_tr_b16 a[226:227], v4 offset:4096
v_add_f32 v198, v198, v210
v_mfma_f32_16x16x32_bf16 a[116:119], a[232:235], v[112:115], a[116:119]
v_add_f32 v199, v199, v211
v_add_f32 v200, v200, v212
v_mfma_f32_16x16x32_bf16 a[108:111], a[232:235], v[104:107], a[108:111]
buffer_load_dwordx4 a[180:183], v2, s[24:27], s54 offen offset:1024 sc1
v_mfma_f32_16x16x32_bf16 a[108:111], a[236:239], v[108:111], a[108:111]
ds_read_b64_tr_b16 a[228:229], v4 offset:8192
v_add_f32 v201, v201, v213
v_mfma_f32_16x16x32_bf16 a[100:103], a[236:239], v[100:103], a[100:103]
ds_read_b64_tr_b16 a[230:231], v4 offset:12288
v_add_f32 v202, v202, v214
v_mfma_f32_16x16x32_bf16 a[100:103], a[232:235], v[96:99], a[100:103]
s_waitcnt vmcnt(30) lgkmcnt(9)
v_add_f32 v203, v203, v215
v_add_f32 v216, v216, v228
v_add_f32 v217, v217, v229
v_mfma_f32_16x16x32_bf16 a[96:99], a[240:243], a[128:131], a[96:99]
buffer_load_dwordx4 a[184:187], v2, s[24:27], s54 offen offset:2048 sc1
v_mfma_f32_16x16x32_bf16 a[96:99], a[244:247], a[132:135], a[96:99]
ds_read_b64_tr_b16 a[232:233], v5 offset:0
v_add_f32 v218, v218, v230
v_mfma_f32_16x16x32_bf16 a[104:107], a[244:247], a[140:143], a[104:107]
ds_read_b64_tr_b16 a[234:235], v5 offset:4096
v_add_f32 v219, v219, v231
v_mfma_f32_16x16x32_bf16 a[104:107], a[240:243], a[136:139], a[104:107]
v_add_f32 v220, v220, v232
v_add_f32 v221, v221, v233
v_mfma_f32_16x16x32_bf16 a[112:115], a[240:243], a[144:147], a[112:115]
ds_read_b64_tr_b16 a[236:237], v5 offset:8192
v_add_f32 v222, v222, v234
v_mfma_f32_16x16x32_bf16 a[112:115], a[244:247], a[148:151], a[112:115]
buffer_load_dwordx4 a[188:191], v2, s[24:27], s54 offen offset:3072 sc1
v_mfma_f32_16x16x32_bf16 a[120:123], a[244:247], a[156:159], a[120:123]
s_bfe_u32 s55, 0x2020408, s64
ds_read_b64_tr_b16 a[238:239], v5 offset:12288
v_add_f32 v223, v223, v235
v_mfma_f32_16x16x32_bf16 a[120:123], a[240:243], a[152:155], a[120:123]
s_waitcnt lgkmcnt(8)
v_add_f32 v224, v224, v236
v_add_f32 v225, v225, v237
v_add_f32 v226, v226, v238
v_mfma_f32_16x16x32_bf16 a[124:127], a[248:251], a[152:155], a[124:127]
s_lshl_b32 s55, s55, 18
ds_read_b64_tr_b16 a[240:241], v4 offset:16384
v_add_f32 v227, v227, v239
v_mfma_f32_16x16x32_bf16 a[124:127], a[252:255], a[156:159], a[124:127]
s_add_u32 m0, s52, 131072
v_add_f32 v192, v192, v216
v_add_f32 v193, v193, v217
v_mfma_f32_16x16x32_bf16 a[116:119], a[252:255], a[148:151], a[116:119]
buffer_load_dwordx4 v28, s[40:43], s55 offen offset:0 lds
v_mfma_f32_16x16x32_bf16 a[116:119], a[248:251], a[144:147], a[116:119]
ds_read_b64_tr_b16 a[242:243], v4 offset:20480
v_add_f32 v194, v194, v218
v_mfma_f32_16x16x32_bf16 a[108:111], a[248:251], a[136:139], a[108:111]
ds_read_b64_tr_b16 a[244:245], v4 offset:24576
v_add_f32 v195, v195, v219
v_mfma_f32_16x16x32_bf16 a[108:111], a[252:255], a[140:143], a[108:111]
v_add_f32 v196, v196, v220
v_add_f32 v197, v197, v221
v_mfma_f32_16x16x32_bf16 a[100:103], a[252:255], a[132:135], a[100:103]
buffer_load_dwordx4 v29, s[40:43], s55 offen offset:1024 lds
v_mfma_f32_16x16x32_bf16 a[100:103], a[248:251], a[128:131], a[100:103]
s_waitcnt lgkmcnt(7)
ds_read_b64_tr_b16 a[246:247], v4 offset:28672
v_add_f32 v198, v198, v222
v_add_f32 v199, v199, v223
v_mfma_f32_16x16x32_bf16 a[64:67], a[224:227], v[96:99], a[64:67]
s_xor_b32 s55, s55, 128
ds_read_b64_tr_b16 a[248:249], v5 offset:16384
v_add_f32 v200, v200, v224
v_mfma_f32_16x16x32_bf16 a[64:67], a[228:231], v[100:103], a[64:67]
s_add_u32 m0, s52, 139264
v_add_f32 v201, v201, v225
v_add_f32 v202, v202, v226
v_mfma_f32_16x16x32_bf16 a[72:75], a[228:231], v[108:111], a[72:75]
buffer_load_dwordx4 v28, s[40:43], s55 offen offset:0 lds
v_mfma_f32_16x16x32_bf16 a[72:75], a[224:227], v[104:107], a[72:75]
ds_read_b64_tr_b16 a[250:251], v5 offset:20480
v_add_f32 v203, v203, v227
v_mfma_f32_16x16x32_bf16 a[80:83], a[224:227], v[112:115], a[80:83]
ds_read_b64_tr_b16 a[252:253], v5 offset:24576
v_cvt_pk_bf16_f32 v192, v192, v193
v_mfma_f32_16x16x32_bf16 a[80:83], a[228:231], v[116:119], a[80:83]
v_cvt_pk_bf16_f32 v193, v194, v195
v_cvt_pk_bf16_f32 v194, v196, v197
v_mfma_f32_16x16x32_bf16 a[88:91], a[228:231], v[124:127], a[88:91]
buffer_load_dwordx4 v29, s[40:43], s55 offen offset:1024 lds
v_mfma_f32_16x16x32_bf16 a[88:91], a[224:227], v[120:123], a[88:91]
s_waitcnt lgkmcnt(7)
s_barrier
v_cvt_pk_bf16_f32 v195, v198, v199
v_mfma_f32_16x16x32_bf16 a[92:95], a[232:235], v[120:123], a[92:95]
s_xor_b32 s55, s55, 131072
ds_read_b64_tr_b16 a[254:255], v5 offset:28672
ds_read_b64_tr_b16 a[224:225], v10 offset:1024
v_mfma_f32_16x16x32_bf16 a[92:95], a[236:239], v[124:127], a[92:95]
s_add_u32 m0, s52, 147456
v_accvgpr_read_b32 v160, a96
v_accvgpr_read_b32 v161, a97
v_mfma_f32_16x16x32_bf16 a[84:87], a[236:239], v[116:119], a[84:87]
buffer_store_dwordx4 v[192:195], v1, s[24:27], s6 offen offset:0 sc1
ds_read_b64_tr_b16 a[226:227], v10 offset:2560
v_accvgpr_read_b32 v162, a98
v_accvgpr_read_b32 v163, a99
v_mfma_f32_16x16x32_bf16 a[84:87], a[232:235], v[112:115], a[84:87]
v_accvgpr_read_b32 v164, a104
v_accvgpr_read_b32 v165, a105
v_mfma_f32_16x16x32_bf16 a[76:79], a[232:235], v[104:107], a[76:79]
ds_read_b64_tr_b16 a[228:229], v10 offset:5120
v_accvgpr_read_b32 v166, a106
v_mfma_f32_16x16x32_bf16 a[76:79], a[236:239], v[108:111], a[76:79]
v_accvgpr_read_b32 v167, a107
v_accvgpr_read_b32 v168, a100
v_mfma_f32_16x16x32_bf16 a[68:71], a[236:239], v[100:103], a[68:71]
buffer_store_dwordx4 v[200:203], v57, s[24:27], s5 offen sc1
buffer_load_dwordx4 v28, s[40:43], s55 offen offset:0 lds
v_accvgpr_read_b32 v169, a101
v_mfma_f32_16x16x32_bf16 a[68:71], a[232:235], v[96:99], a[68:71]
s_waitcnt lgkmcnt(7)
ds_read_b64_tr_b16 a[230:231], v10 offset:6656
v_accvgpr_read_b32 v170, a102
v_accvgpr_read_b32 v171, a103
v_mfma_f32_16x16x32_bf16 a[64:67], a[240:243], a[128:131], a[64:67]
ds_read_b64_tr_b16 a[232:233], v10 offset:1056
v_accvgpr_read_b32 v172, a108
v_mfma_f32_16x16x32_bf16 a[64:67], a[244:247], a[132:135], a[64:67]
v_accvgpr_read_b32 v173, a109
v_accvgpr_read_b32 v174, a110
v_mfma_f32_16x16x32_bf16 a[72:75], a[244:247], a[140:143], a[72:75]
buffer_load_dwordx4 v29, s[40:43], s55 offen offset:1024 lds
v_mfma_f32_16x16x32_bf16 a[72:75], a[240:243], a[136:139], a[72:75]
s_xor_b32 s55, s55, 128
ds_read_b64_tr_b16 a[234:235], v10 offset:2592
v_accvgpr_read_b32 v175, a111
v_mfma_f32_16x16x32_bf16 a[80:83], a[240:243], a[144:147], a[80:83]
s_add_u32 m0, s52, 65536
ds_read_b64_tr_b16 a[236:237], v10 offset:5152
v_mul_f32 v160, s57, v160
v_mfma_f32_16x16x32_bf16 a[80:83], a[244:247], a[148:151], a[80:83]
v_exp_f32 v160, v160
v_mfma_f32_16x16x32_bf16 a[88:91], a[244:247], a[156:159], a[88:91]
ds_read_b64_tr_b16 a[238:239], v10 offset:6688
v_mul_f32 v161, s57, v161
v_mfma_f32_16x16x32_bf16 a[88:91], a[240:243], a[152:155], a[88:91]
s_waitcnt lgkmcnt(8)
buffer_load_dwordx4 v28, s[40:43], s55 offen offset:0 lds
v_mul_f32 v162, s57, v162
v_mfma_f32_16x16x32_bf16 a[92:95], a[248:251], a[152:155], a[92:95]
ds_read_b64_tr_b16 a[240:241], v10 offset:9216
v_mul_f32 v163, s57, v163
v_mfma_f32_16x16x32_bf16 a[92:95], a[252:255], a[156:159], a[92:95]
v_exp_f32 v161, v161
v_mfma_f32_16x16x32_bf16 a[84:87], a[252:255], a[148:151], a[84:87]
ds_read_b64_tr_b16 a[242:243], v10 offset:10752
v_mul_f32 v164, s57, v164
v_mfma_f32_16x16x32_bf16 a[84:87], a[248:251], a[144:147], a[84:87]
buffer_load_dwordx4 v29, s[40:43], s55 offen offset:1024 lds
v_mfma_f32_16x16x32_bf16 a[76:79], a[248:251], a[136:139], a[76:79]
s_bfe_u32 s55, 0x4060a04, s64
ds_read_b64_tr_b16 a[244:245], v10 offset:13312
v_mul_f32 v165, s57, v165
v_mfma_f32_16x16x32_bf16 a[76:79], a[252:255], a[140:143], a[76:79]
s_lshl_b32 s55, s55, 18
v_exp_f32 v162, v162
v_mfma_f32_16x16x32_bf16 a[68:71], a[252:255], a[132:135], a[68:71]
s_add_u32 m0, s52, 73728
ds_read_b64_tr_b16 a[246:247], v10 offset:14848
v_mul_f32 v166, s57, v166
v_mfma_f32_16x16x32_bf16 a[68:71], a[248:251], a[128:131], a[68:71]
s_waitcnt lgkmcnt(8)
buffer_load_dwordx4 v28, s[40:43], s55 offen offset:0 lds
v_mul_f32 v167, s57, v167
v_mfma_f32_16x16x32_bf16 a[0:3], a[224:227], v[96:99], a[0:3]
ds_read_b64_tr_b16 a[248:249], v10 offset:9248
v_add_f32 v160, 1.0, v160
v_mfma_f32_16x16x32_bf16 a[0:3], a[228:231], v[100:103], a[0:3]
v_exp_f32 v163, v163
v_mfma_f32_16x16x32_bf16 a[16:19], a[228:231], v[108:111], a[16:19]
ds_read_b64_tr_b16 a[250:251], v10 offset:10784
v_accvgpr_read_b32 v176, a112
v_mfma_f32_16x16x32_bf16 a[16:19], a[224:227], v[104:107], a[16:19]
v_exp_f32 v164, v164
v_mfma_f32_16x16x32_bf16 a[32:35], a[224:227], v[112:115], a[32:35]
buffer_load_dwordx4 v29, s[40:43], s55 offen offset:1024 lds
v_mfma_f32_16x16x32_bf16 a[32:35], a[228:231], v[116:119], a[32:35]
s_xor_b32 s55, s55, 128
ds_read_b64_tr_b16 a[252:253], v10 offset:13344
v_add_f32 v161, 1.0, v161
v_mfma_f32_16x16x32_bf16 a[48:51], a[228:231], v[124:127], a[48:51]
s_add_u32 m0, s52, 81920
ds_read_b64_tr_b16 a[254:255], v10 offset:14880
v_accvgpr_read_b32 v177, a113
v_mfma_f32_16x16x32_bf16 a[48:51], a[224:227], v[120:123], a[48:51]
s_waitcnt lgkmcnt(8)
v_exp_f32 v165, v165
v_add_f32 v162, 1.0, v162
v_mfma_f32_16x16x32_bf16 a[52:55], a[232:235], v[120:123], a[52:55]
buffer_load_dwordx4 v28, s[40:43], s55 offen offset:0 lds
v_mfma_f32_16x16x32_bf16 a[52:55], a[236:239], v[124:127], a[52:55]
ds_read_b64_tr_b16 a[224:225], v10 offset:17408
v_accvgpr_read_b32 v178, a114
v_mfma_f32_16x16x32_bf16 a[36:39], a[236:239], v[116:119], a[36:39]
ds_read_b64_tr_b16 a[226:227], v10 offset:18944
v_add_f32 v163, 1.0, v163
v_mfma_f32_16x16x32_bf16 a[36:39], a[232:235], v[112:115], a[36:39]
v_exp_f32 v166, v166
v_mfma_f32_16x16x32_bf16 a[20:23], a[232:235], v[104:107], a[20:23]
buffer_load_dwordx4 v29, s[40:43], s55 offen offset:1024 lds
v_mfma_f32_16x16x32_bf16 a[20:23], a[236:239], v[108:111], a[20:23]
s_xor_b32 s55, s55, 131072
ds_read_b64_tr_b16 a[228:229], v10 offset:21504
v_accvgpr_read_b32 v179, a115
v_mfma_f32_16x16x32_bf16 a[4:7], a[236:239], v[100:103], a[4:7]
s_add_u32 m0, s52, 90112
ds_read_b64_tr_b16 a[230:231], v10 offset:23040
v_add_f32 v164, 1.0, v164
v_mfma_f32_16x16x32_bf16 a[4:7], a[232:235], v[96:99], a[4:7]
s_waitcnt lgkmcnt(8)
v_exp_f32 v167, v167
v_accvgpr_read_b32 v180, a120
v_mfma_f32_16x16x32_bf16 a[8:11], a[240:243], v[96:99], a[8:11]
ds_read_b64_tr_b16 a[232:233], v10 offset:17440
v_add_f32 v165, 1.0, v165
v_mfma_f32_16x16x32_bf16 a[8:11], a[244:247], v[100:103], a[8:11]
buffer_load_dwordx4 v28, s[40:43], s55 offen offset:0 lds
v_mfma_f32_16x16x32_bf16 a[24:27], a[244:247], v[108:111], a[24:27]
ds_read_b64_tr_b16 a[234:235], v10 offset:18976
v_accvgpr_read_b32 v181, a121
v_mfma_f32_16x16x32_bf16 a[24:27], a[240:243], v[104:107], a[24:27]
v_rcp_f32 v160, v160
v_mfma_f32_16x16x32_bf16 a[40:43], a[240:243], v[112:115], a[40:43]
ds_read_b64_tr_b16 a[236:237], v10 offset:21536
v_add_f32 v166, 1.0, v166
v_mfma_f32_16x16x32_bf16 a[40:43], a[244:247], v[116:119], a[40:43]
buffer_load_dwordx4 v29, s[40:43], s55 offen offset:1024 lds
v_mfma_f32_16x16x32_bf16 a[56:59], a[244:247], v[124:127], a[56:59]
s_load_dword s101, s[92:93], 45048
ds_read_b64_tr_b16 a[238:239], v10 offset:23072
v_accvgpr_read_b32 v182, a122
v_mfma_f32_16x16x32_bf16 a[56:59], a[240:243], v[120:123], a[56:59]
s_waitcnt lgkmcnt(8)
v_add_f32 v167, 1.0, v167
v_rcp_f32 v161, v161
v_mfma_f32_16x16x32_bf16 a[60:63], a[248:251], v[120:123], a[60:63]
ds_read_b64_tr_b16 a[240:241], v10 offset:25600
v_accvgpr_read_b32 v183, a123
v_mfma_f32_16x16x32_bf16 a[60:63], a[252:255], v[124:127], a[60:63]
v_rcp_f32 v162, v162
v_mfma_f32_16x16x32_bf16 a[44:47], a[252:255], v[116:119], a[44:47]
ds_read_b64_tr_b16 a[242:243], v10 offset:27136
v_accvgpr_read_b32 v184, a116
v_mfma_f32_16x16x32_bf16 a[44:47], a[248:251], v[112:115], a[44:47]
v_rcp_f32 v163, v163
v_mfma_f32_16x16x32_bf16 a[28:31], a[248:251], v[104:107], a[28:31]
ds_read_b64_tr_b16 a[244:245], v10 offset:29696
v_accvgpr_read_b32 v185, a117
v_mfma_f32_16x16x32_bf16 a[28:31], a[252:255], v[108:111], a[28:31]
v_rcp_f32 v164, v164
v_mfma_f32_16x16x32_bf16 a[12:15], a[252:255], v[100:103], a[12:15]
ds_read_b64_tr_b16 a[246:247], v10 offset:31232
v_accvgpr_read_b32 v186, a118
v_mfma_f32_16x16x32_bf16 a[12:15], a[248:251], v[96:99], a[12:15]
s_waitcnt lgkmcnt(8)
v_accvgpr_read_b32 v187, a119
v_rcp_f32 v165, v165
v_mfma_f32_16x16x32_bf16 a[0:3], a[224:227], a[128:131], a[0:3]
ds_read_b64_tr_b16 a[248:249], v10 offset:25632
v_accvgpr_read_b32 v188, a124
v_mfma_f32_16x16x32_bf16 a[0:3], a[228:231], a[132:135], a[0:3]
v_rcp_f32 v166, v166
v_mfma_f32_16x16x32_bf16 a[16:19], a[228:231], a[140:143], a[16:19]
ds_read_b64_tr_b16 a[250:251], v10 offset:27168
v_accvgpr_read_b32 v189, a125
v_mfma_f32_16x16x32_bf16 a[16:19], a[224:227], a[136:139], a[16:19]
v_rcp_f32 v167, v167
v_mfma_f32_16x16x32_bf16 a[32:35], a[224:227], a[144:147], a[32:35]
ds_read_b64_tr_b16 a[252:253], v10 offset:29728
v_accvgpr_read_b32 v190, a126
v_mfma_f32_16x16x32_bf16 a[32:35], a[228:231], a[148:151], a[32:35]
v_accvgpr_read_b32 v191, a127
v_mul_f32 v160, v160, v168
v_mfma_f32_16x16x32_bf16 a[48:51], a[228:231], a[156:159], a[48:51]
ds_read_b64_tr_b16 a[254:255], v10 offset:31264
v_mul_f32 v176, s57, v176
v_mfma_f32_16x16x32_bf16 a[48:51], a[224:227], a[152:155], a[48:51]
s_waitcnt vmcnt(40) lgkmcnt(8)
s_barrier
s_xor_b32 s55, s55, 128
v_mfma_f32_16x16x32_bf16 a[52:55], a[232:235], a[152:155], a[52:55]
s_add_u32 m0, s52, 0
ds_read_b64_tr_b16 a[224:225], v16 offset:32768
v_mul_f32 v161, v161, v169
v_mfma_f32_16x16x32_bf16 a[52:55], a[236:239], a[156:159], a[52:55]
buffer_load_dwordx4 v28, s[40:43], s55 offen offset:0 lds
v_mfma_f32_16x16x32_bf16 a[36:39], a[236:239], a[148:151], a[36:39]
s_lshl_b32 s6, s68, 7
ds_read_b64_tr_b16 a[226:227], v16 offset:34816
v_mul_f32 v177, s57, v177
v_mfma_f32_16x16x32_bf16 a[36:39], a[232:235], a[144:147], a[36:39]
s_add_u32 s6, s6, 50348032
v_exp_f32 v176, v176
v_mfma_f32_16x16x32_bf16 a[20:23], a[232:235], a[136:139], a[20:23]
buffer_load_dwordx4 v29, s[40:43], s55 offen offset:1024 lds
v_mfma_f32_16x16x32_bf16 a[20:23], a[236:239], a[140:143], a[20:23]
s_bfe_u32 s55, 0x80c0606, s64
ds_read_b64_tr_b16 a[228:229], v16 offset:36864
v_mul_f32 v162, v162, v170
v_mfma_f32_16x16x32_bf16 a[4:7], a[236:239], a[132:135], a[4:7]
s_lshl_b32 s55, s55, 18
ds_read_b64_tr_b16 a[230:231], v16 offset:38912
v_mul_f32 v178, s57, v178
v_mfma_f32_16x16x32_bf16 a[4:7], a[232:235], a[128:131], a[4:7]
s_waitcnt lgkmcnt(8)
v_mul_f32 v163, v163, v171
v_exp_f32 v177, v177
v_mfma_f32_16x16x32_bf16 a[8:11], a[240:243], a[128:131], a[8:11]
s_add_u32 m0, s52, 8192
ds_read_b64_tr_b16 a[232:233], v17 offset:32768
v_mul_f32 v179, s57, v179
v_mfma_f32_16x16x32_bf16 a[8:11], a[244:247], a[132:135], a[8:11]
buffer_load_dwordx4 v28, s[40:43], s55 offen offset:0 lds
v_mfma_f32_16x16x32_bf16 a[24:27], a[244:247], a[140:143], a[24:27]
s_lshl_b32 s7, s33, 2
ds_read_b64_tr_b16 a[234:235], v17 offset:34816
v_mul_f32 v164, v164, v172
v_mfma_f32_16x16x32_bf16 a[24:27], a[240:243], a[136:139], a[24:27]
s_add_u32 s7, s7, s6
v_exp_f32 v178, v178
v_mfma_f32_16x16x32_bf16 a[40:43], a[240:243], a[144:147], a[40:43]
s_waitcnt vmcnt(13)
ds_read_b64_tr_b16 a[236:237], v17 offset:36864
v_mul_f32 v180, s57, v180
v_mfma_f32_16x16x32_bf16 a[40:43], a[244:247], a[148:151], a[40:43]
buffer_store_dword v32, v30, s[24:27], s7 offen sc1
buffer_load_dwordx4 v29, s[40:43], s55 offen offset:1024 lds
v_and_b32 v55, 28, v31
v_mfma_f32_16x16x32_bf16 a[56:59], a[244:247], a[156:159], a[56:59]
s_xor_b32 s55, s55, 128
ds_read_b64_tr_b16 a[238:239], v17 offset:38912
v_mul_f32 v165, v165, v173
v_mfma_f32_16x16x32_bf16 a[56:59], a[240:243], a[152:155], a[56:59]
s_waitcnt lgkmcnt(8)
v_mul_f32 v181, s57, v181
v_exp_f32 v179, v179
v_mfma_f32_16x16x32_bf16 a[60:63], a[248:251], a[152:155], a[60:63]
s_add_u32 m0, s52, 16384
ds_read_b64_tr_b16 a[240:241], v18 offset:32768
v_mul_f32 v166, v166, v174
v_mfma_f32_16x16x32_bf16 a[60:63], a[252:255], a[156:159], a[60:63]
buffer_load_dwordx4 v28, s[40:43], s55 offen offset:0 lds
v_mfma_f32_16x16x32_bf16 a[44:47], a[252:255], a[148:151], a[44:47]
ds_read_b64_tr_b16 a[242:243], v18 offset:34816
v_mul_f32 v182, s57, v182
v_mfma_f32_16x16x32_bf16 a[44:47], a[248:251], a[144:147], a[44:47]
v_exp_f32 v180, v180
v_mfma_f32_16x16x32_bf16 a[28:31], a[248:251], a[136:139], a[28:31]
ds_read_b64_tr_b16 a[244:245], v18 offset:36864
v_mul_f32 v167, v167, v175
v_mfma_f32_16x16x32_bf16 a[28:31], a[252:255], a[140:143], a[28:31]
buffer_load_dwordx4 v29, s[40:43], s55 offen offset:1024 lds
v_mfma_f32_16x16x32_bf16 a[12:15], a[252:255], a[132:135], a[12:15]
ds_read_b64_tr_b16 a[246:247], v18 offset:38912
v_mul_f32 v183, s57, v183
v_mfma_f32_16x16x32_bf16 a[12:15], a[248:251], a[128:131], a[12:15]
s_waitcnt lgkmcnt(8)
v_cvt_pk_bf16_f32 v160, v160, v161
v_exp_f32 v181, v181
v_mfma_f32_16x16x32_bf16 v[64:67], a[224:227], v[128:131], 0
s_bfe_u32 s54, 0x2020408, s64
ds_read_b64_tr_b16 a[248:249], v19 offset:32768
s_lshl_b32 s54, s54, 13
v_cvt_pk_bf16_f32 v161, v162, v163
v_cvt_pk_bf16_f32 v162, v164, v165
v_cvt_pk_bf16_f32 v163, v166, v167
v_exp_f32 v182, v182
v_mfma_f32_16x16x32_bf16 v[64:67], a[228:231], v[136:139], v[64:67]
s_add_u32 s54, s54, s63
ds_read_b64_tr_b16 a[250:251], v19 offset:34816
v_permlane32_swap_b32 v160, v162
v_permlane32_swap_b32 v161, v163
v_exp_f32 v183, v183
v_mfma_f32_16x16x32_bf16 v[68:71], a[228:231], v[140:143], 0
ds_read_b64_tr_b16 a[252:253], v19 offset:36864
buffer_load_dwordx4 a[128:131], v1, s[24:27], s54 offen offset:0 sc1
v_and_b32 v164, 512, v1
v_add_u32 v164, v164, v1
v_accvgpr_read_b32 v224, a64
v_accvgpr_read_b32 v225, a65
v_mfma_f32_16x16x32_bf16 v[68:71], a[224:227], v[132:135], v[68:71]
s_waitcnt lgkmcnt(7)
ds_read_b64_tr_b16 a[254:255], v19 offset:38912
v_accvgpr_read_b32 v226, a66
v_accvgpr_read_b32 v227, a67
v_accvgpr_read_b32 v228, a68
v_accvgpr_read_b32 v229, a69
v_accvgpr_read_b32 v230, a70
v_accvgpr_read_b32 v231, a71
v_mfma_f32_16x16x32_bf16 v[76:79], a[232:235], v[132:135], 0
buffer_store_dwordx4 v[160:163], v164, s[24:27], s66 offen sc1
buffer_load_dwordx4 a[132:135], v1, s[24:27], s54 offen offset:1024 sc1
v_add_f32 v176, 1.0, v176
v_add_f32 v177, 1.0, v177
v_mfma_f32_16x16x32_bf16 v[76:79], a[236:239], v[140:143], v[76:79]
ds_read_b64_tr_b16 a[224:225], v16 offset:40960
v_add_f32 v178, 1.0, v178
v_add_f32 v179, 1.0, v179
v_add_f32 v180, 1.0, v180
v_add_f32 v181, 1.0, v181
v_rcp_f32 v176, v176
v_mfma_f32_16x16x32_bf16 v[72:75], a[236:239], v[136:139], 0
s_add_u32 s66, s66, 294912
ds_read_b64_tr_b16 a[226:227], v16 offset:43008
v_add_f32 v182, 1.0, v182
v_add_f32 v183, 1.0, v183
v_rcp_f32 v177, v177
v_rcp_f32 v178, v178
v_mfma_f32_16x16x32_bf16 v[72:75], a[232:235], v[128:131], v[72:75]
s_waitcnt lgkmcnt(6)
ds_read_b64_tr_b16 a[228:229], v16 offset:45056
buffer_load_dwordx4 a[136:139], v1, s[24:27], s54 offen offset:2048 sc1
v_rcp_f32 v179, v179
v_rcp_f32 v180, v180
v_mfma_f32_16x16x32_bf16 v[80:83], a[240:243], v[128:131], 0
ds_read_b64_tr_b16 a[230:231], v16 offset:47104
v_rcp_f32 v181, v181
v_rcp_f32 v182, v182
v_rcp_f32 v183, v183
v_mfma_f32_16x16x32_bf16 v[80:83], a[244:247], v[136:139], v[80:83]
ds_read_b64_tr_b16 a[232:233], v17 offset:40960
buffer_load_dwordx4 a[140:143], v1, s[24:27], s54 offen offset:3072 sc1
v_mul_f32 v176, v176, v184
v_mul_f32 v177, v177, v185
v_mul_f32 v178, v178, v186
v_mul_f32 v179, v179, v187
v_mfma_f32_16x16x32_bf16 v[84:87], a[244:247], v[140:143], 0
ds_read_b64_tr_b16 a[234:235], v17 offset:43008
v_mul_f32 v180, v180, v188
v_mul_f32 v181, v181, v189
v_mul_f32 v182, v182, v190
v_mul_f32 v183, v183, v191
v_cvt_pk_bf16_f32 v176, v176, v177
v_cvt_pk_bf16_f32 v177, v178, v179
v_mfma_f32_16x16x32_bf16 v[84:87], a[240:243], v[132:135], v[84:87]
s_waitcnt lgkmcnt(6)
ds_read_b64_tr_b16 a[236:237], v17 offset:45056
buffer_load_dwordx4 a[144:147], v2, s[24:27], s54 offen offset:0 sc1
v_cvt_pk_bf16_f32 v178, v180, v181
v_cvt_pk_bf16_f32 v179, v182, v183
v_and_b32 v180, 512, v1
v_add_u32 v180, v180, v1
v_mfma_f32_16x16x32_bf16 v[92:95], a[248:251], v[132:135], 0
ds_read_b64_tr_b16 a[238:239], v17 offset:47104
v_permlane32_swap_b32 v176, v178
v_permlane32_swap_b32 v177, v179
v_accvgpr_read_b32 v232, a72
v_accvgpr_read_b32 v233, a73
v_mfma_f32_16x16x32_bf16 v[92:95], a[252:255], v[140:143], v[92:95]
buffer_store_dwordx4 v[176:179], v180, s[24:27], s66 offen sc1
buffer_load_dwordx4 a[148:151], v2, s[24:27], s54 offen offset:1024 sc1
v_accvgpr_read_b32 v234, a74
v_accvgpr_read_b32 v235, a75
v_mfma_f32_16x16x32_bf16 v[88:91], a[252:255], v[136:139], 0
s_add_u32 s4, s65, 32768
ds_read_b64_tr_b16 a[240:241], v18 offset:40960
ds_read_b64_tr_b16 a[242:243], v18 offset:43008
v_accvgpr_read_b32 v236, a76
v_accvgpr_read_b32 v237, a77
v_accvgpr_read_b32 v238, a78
v_accvgpr_read_b32 v239, a79
v_accvgpr_read_b32 v240, a80
v_mfma_f32_16x16x32_bf16 v[88:91], a[248:251], v[128:131], v[88:91]
s_waitcnt lgkmcnt(6)
ds_read_b64_tr_b16 a[244:245], v18 offset:45056
v_accvgpr_read_b32 v241, a81
v_accvgpr_read_b32 v242, a82
v_accvgpr_read_b32 v243, a83
v_accvgpr_read_b32 v244, a84
v_accvgpr_read_b32 v245, a85
v_accvgpr_read_b32 v246, a86
v_mfma_f32_16x16x32_bf16 a[192:195], a[224:227], v[128:131], 0
ds_read_b64_tr_b16 a[246:247], v18 offset:47104
buffer_load_dwordx4 v[4:7], v34, s[8:11], s65 offen offset:0
v_accvgpr_read_b32 v247, a87
v_accvgpr_read_b32 v248, a88
v_accvgpr_read_b32 v249, a89
v_accvgpr_read_b32 v250, a90
v_mfma_f32_16x16x32_bf16 a[192:195], a[228:231], v[136:139], a[192:195]
ds_read_b64_tr_b16 a[248:249], v19 offset:40960
v_accvgpr_read_b32 v251, a91
v_accvgpr_read_b32 v252, a92
v_accvgpr_read_b32 v253, a93
v_accvgpr_read_b32 v254, a94
v_accvgpr_read_b32 v255, a95
v_cvt_pk_bf16_f32 v224, v224, v225
v_mfma_f32_16x16x32_bf16 a[196:199], a[228:231], v[140:143], 0
ds_read_b64_tr_b16 a[250:251], v19 offset:43008
v_cvt_pk_bf16_f32 v225, v226, v227
v_cvt_pk_bf16_f32 v226, v228, v229
v_cvt_pk_bf16_f32 v227, v230, v231
v_cvt_pk_bf16_f32 v228, v232, v233
v_cvt_pk_bf16_f32 v229, v234, v235
v_cvt_pk_bf16_f32 v230, v236, v237
v_mfma_f32_16x16x32_bf16 v[192:195], v[40:43], v[224:227], 0
ds_read_b64_tr_b16 a[252:253], v19 offset:45056
v_cvt_pk_bf16_f32 v231, v238, v239
v_mfma_f32_16x16x32_bf16 v[196:199], v[44:47], v[224:227], 0
buffer_load_dwordx4 v[12:15], v34, s[8:11], s65 offen offset:64
v_mfma_f32_16x16x32_bf16 v[200:203], v[40:43], v[228:231], 0
v_mfma_f32_16x16x32_bf16 v[204:207], v[44:47], v[228:231], 0
v_mfma_f32_16x16x32_bf16 a[196:199], a[224:227], v[132:135], a[196:199]
s_waitcnt lgkmcnt(7)
ds_read_b64_tr_b16 a[254:255], v19 offset:47104
v_max3_f32 v60, v192, v193, v194
v_mfma_f32_16x16x32_bf16 a[204:207], a[232:235], v[132:135], 0
ds_read_b64_tr_b16 a[224:225], v16 offset:49152
v_max3_f32 v62, -v192, -v193, -v194
v_max3_f32 v60, v60, v195, v196
v_max3_f32 v62, v62, -v195, -v196
v_max3_f32 v60, v60, v197, v198
v_max3_f32 v62, v62, -v197, -v198
v_max_f32 v60, v60, v199
v_mfma_f32_16x16x32_bf16 a[204:207], a[236:239], v[140:143], a[204:207]
ds_read_b64_tr_b16 a[226:227], v16 offset:51200
v_max_f32_e64 v62, v62, -v199
v_max3_f32 v61, v200, v201, v202
v_max3_f32 v63, -v200, -v201, -v202
v_max3_f32 v61, v61, v203, v204
v_max3_f32 v63, v63, -v203, -v204
v_max3_f32 v61, v61, v205, v206
v_mfma_f32_16x16x32_bf16 a[200:203], a[236:239], v[136:139], 0
pg_10:
s_cbranch_execz pg_14
ds_read_b64_tr_b16 a[228:229], v16 offset:53248
v_max3_f32 v63, v63, -v205, -v206
v_max_f32 v61, v61, v207
v_max_f32_e64 v63, v63, -v207
v_mfma_f32_16x16x32_bf16 a[200:203], a[232:235], v[128:131], a[200:203]
s_waitcnt lgkmcnt(7)
ds_read_b64_tr_b16 a[230:231], v16 offset:55296
buffer_load_dwordx4 v[8:11], v34, s[8:11], s4 offen offset:0
v_permlane16_swap_b32 v60, v61
v_permlane16_swap_b32 v62, v63
v_mfma_f32_16x16x32_bf16 a[208:211], a[240:243], v[128:131], 0
ds_read_b64_tr_b16 a[232:233], v17 offset:49152
v_max_f32 v60, v60, v61
v_max_f32 v62, v62, v63
v_mfma_f32_16x16x32_bf16 a[208:211], a[244:247], v[136:139], a[208:211]
ds_read_b64_tr_b16 a[234:235], v17 offset:51200
ds_read_b64_tr_b16 a[236:237], v17 offset:53248
v_mfma_f32_16x16x32_bf16 a[212:215], a[244:247], v[140:143], 0
v_permlane32_swap_b32 v60, v62
v_max_f32 v60, v60, v62
v_mul_f32 v60, s58, v60
v_mov_b32 v62, v60
v_mfma_f32_16x16x32_bf16 a[212:215], a[240:243], v[132:135], a[212:215]
s_waitcnt lgkmcnt(7)
ds_read_b64_tr_b16 a[238:239], v17 offset:55296
v_mfma_f32_16x16x32_bf16 a[220:223], a[248:251], v[132:135], 0
ds_read_b64_tr_b16 a[240:241], v18 offset:49152
v_permlane32_swap_b32 v60, v62
v_mov_b32 v61, v60
v_mov_b32 v63, v62
v_mfma_f32_16x16x32_bf16 a[220:223], a[252:255], v[140:143], a[220:223]
ds_read_b64_tr_b16 a[242:243], v18 offset:51200
buffer_load_dwordx4 v[56:59], v34, s[8:11], s4 offen offset:64
v_accvgpr_read_b32 v160, a0
v_accvgpr_read_b32 v161, a1
v_permlane16_swap_b32 v60, v61
v_mfma_f32_16x16x32_bf16 a[216:219], a[252:255], v[136:139], 0
ds_read_b64_tr_b16 a[244:245], v18 offset:53248
v_accvgpr_read_b32 v162, a2
v_accvgpr_read_b32 v163, a3
v_accvgpr_read_b32 v164, a4
v_accvgpr_read_b32 v165, a5
v_permlane16_swap_b32 v62, v63
v_mfma_f32_16x16x32_bf16 a[216:219], a[248:251], v[128:131], a[216:219]
s_waitcnt lgkmcnt(7)
ds_read_b64_tr_b16 a[246:247], v18 offset:55296
v_accvgpr_read_b32 v166, a6
v_accvgpr_read_b32 v167, a7
v_accvgpr_read_b32 v168, a8
v_accvgpr_read_b32 v169, a9
v_accvgpr_read_b32 v170, a10
v_accvgpr_read_b32 v171, a11
v_mfma_f32_16x16x32_bf16 a[192:195], a[224:227], v[144:147], a[192:195]
ds_read_b64_tr_b16 a[248:249], v19 offset:49152
v_accvgpr_read_b32 v172, a12
v_accvgpr_read_b32 v173, a13
v_accvgpr_read_b32 v174, a14
v_accvgpr_read_b32 v175, a15
v_mul_f32 v160, s57, v160
v_mul_f32 v161, s57, v161
v_mfma_f32_16x16x32_bf16 a[192:195], a[228:231], v[152:155], a[192:195]
ds_read_b64_tr_b16 a[250:251], v19 offset:51200
v_mul_f32 v162, s57, v162
v_mul_f32 v163, s57, v163
v_mul_f32 v164, s57, v164
v_mul_f32 v165, s57, v165
v_exp_f32 v160, v160
v_mfma_f32_16x16x32_bf16 a[196:199], a[228:231], v[156:159], a[196:199]
ds_read_b64_tr_b16 a[252:253], v19 offset:53248
v_mul_f32 v166, s57, v166
v_mul_f32 v167, s57, v167
v_exp_f32 v161, v161
v_exp_f32 v162, v162
v_mfma_f32_16x16x32_bf16 a[196:199], a[224:227], v[148:151], a[196:199]
s_waitcnt lgkmcnt(7)
ds_read_b64_tr_b16 a[254:255], v19 offset:55296
v_exp_f32 v163, v163
v_exp_f32 v164, v164
v_exp_f32 v165, v165
v_mfma_f32_16x16x32_bf16 a[204:207], a[232:235], v[148:151], a[204:207]
ds_read_b64_tr_b16 a[224:225], v16 offset:57344
v_exp_f32 v166, v166
v_exp_f32 v167, v167
v_add_f32 v160, 1.0, v160
v_accvgpr_read_b32 v176, a16
v_mfma_f32_16x16x32_bf16 a[204:207], a[236:239], v[156:159], a[204:207]
ds_read_b64_tr_b16 a[226:227], v16 offset:59392
v_add_f32 v161, 1.0, v161
v_accvgpr_read_b32 v177, a17
v_add_f32 v162, 1.0, v162
v_accvgpr_read_b32 v178, a18
v_rcp_f32 v160, v160
v_mfma_f32_16x16x32_bf16 a[200:203], a[236:239], v[152:155], a[200:203]
ds_read_b64_tr_b16 a[228:229], v16 offset:61440
v_add_f32 v163, 1.0, v163
v_accvgpr_read_b32 v179, a19
v_add_f32 v164, 1.0, v164
v_accvgpr_read_b32 v180, a20
v_rcp_f32 v161, v161
v_mfma_f32_16x16x32_bf16 a[200:203], a[232:235], v[144:147], a[200:203]
s_waitcnt lgkmcnt(7)
ds_read_b64_tr_b16 a[230:231], v16 offset:63488
v_add_f32 v165, 1.0, v165
v_accvgpr_read_b32 v181, a21
v_add_f32 v166, 1.0, v166
v_accvgpr_read_b32 v182, a22
v_rcp_f32 v162, v162
v_mfma_f32_16x16x32_bf16 a[208:211], a[240:243], v[144:147], a[208:211]
ds_read_b64_tr_b16 a[232:233], v17 offset:57344
v_add_f32 v167, 1.0, v167
v_accvgpr_read_b32 v183, a23
v_accvgpr_read_b32 v184, a24
v_accvgpr_read_b32 v185, a25
v_rcp_f32 v163, v163
v_mfma_f32_16x16x32_bf16 a[208:211], a[244:247], v[152:155], a[208:211]
ds_read_b64_tr_b16 a[234:235], v17 offset:59392
v_accvgpr_read_b32 v186, a26
v_accvgpr_read_b32 v187, a27
v_rcp_f32 v164, v164
v_rcp_f32 v165, v165
v_mfma_f32_16x16x32_bf16 a[212:215], a[244:247], v[156:159], a[212:215]
ds_read_b64_tr_b16 a[236:237], v17 offset:61440
v_accvgpr_read_b32 v188, a28
v_accvgpr_read_b32 v189, a29
v_rcp_f32 v166, v166
v_rcp_f32 v167, v167
v_mfma_f32_16x16x32_bf16 a[212:215], a[240:243], v[148:151], a[212:215]
s_waitcnt lgkmcnt(7)
ds_read_b64_tr_b16 a[238:239], v17 offset:63488
v_accvgpr_read_b32 v190, a30
v_accvgpr_read_b32 v191, a31
v_mul_f32 v160, v160, v168
v_mul_f32 v176, s57, v176
v_exp_f32 v176, v176
v_mfma_f32_16x16x32_bf16 a[220:223], a[248:251], v[148:151], a[220:223]
ds_read_b64_tr_b16 a[240:241], v18 offset:57344
v_mul_f32 v161, v161, v169
v_mul_f32 v177, s57, v177
v_mul_f32 v162, v162, v170
v_mul_f32 v178, s57, v178
v_exp_f32 v177, v177
v_mfma_f32_16x16x32_bf16 a[220:223], a[252:255], v[156:159], a[220:223]
ds_read_b64_tr_b16 a[242:243], v18 offset:59392
v_mul_f32 v163, v163, v171
v_mul_f32 v179, s57, v179
v_mul_f32 v164, v164, v172
v_mul_f32 v180, s57, v180
v_exp_f32 v178, v178
v_mfma_f32_16x16x32_bf16 a[216:219], a[252:255], v[152:155], a[216:219]
ds_read_b64_tr_b16 a[244:245], v18 offset:61440
v_mul_f32 v165, v165, v173
v_mul_f32 v181, s57, v181
v_mul_f32 v166, v166, v174
v_mul_f32 v182, s57, v182
v_exp_f32 v179, v179
v_mfma_f32_16x16x32_bf16 a[216:219], a[248:251], v[144:147], a[216:219]
s_waitcnt lgkmcnt(7)
ds_read_b64_tr_b16 a[246:247], v18 offset:63488
v_mul_f32 v167, v167, v175
v_mul_f32 v183, s57, v183
v_cvt_pk_bf16_f32 v160, v160, v161
v_cvt_pk_bf16_f32 v161, v162, v163
v_exp_f32 v180, v180
v_mfma_f32_16x16x32_bf16 v[64:67], a[224:227], v[144:147], v[64:67]
ds_read_b64_tr_b16 a[248:249], v19 offset:57344
v_cvt_pk_bf16_f32 v162, v164, v165
v_cvt_pk_bf16_f32 v163, v166, v167
v_exp_f32 v181, v181
v_exp_f32 v182, v182
v_mfma_f32_16x16x32_bf16 v[64:67], a[228:231], v[152:155], v[64:67]
ds_read_b64_tr_b16 a[250:251], v19 offset:59392
v_exp_f32 v183, v183
v_fma_f32 v208, -v192, s58, -v62
v_fma_f32 v192, v192, s58, -v60
v_exp_f32 v208, v208
v_mfma_f32_16x16x32_bf16 v[68:71], a[228:231], v[156:159], v[68:71]
ds_read_b64_tr_b16 a[252:253], v19 offset:61440
v_fma_f32 v209, -v193, s58, -v62
v_fma_f32 v193, v193, s58, -v60
v_fma_f32 v210, -v194, s58, -v62
v_fma_f32 v194, v194, s58, -v60
v_exp_f32 v192, v192
v_mfma_f32_16x16x32_bf16 v[68:71], a[224:227], v[148:151], v[68:71]
s_waitcnt vmcnt(43) lgkmcnt(7)
s_barrier
ds_read_b64_tr_b16 a[254:255], v19 offset:63488
v_fma_f32 v211, -v195, s58, -v62
v_fma_f32 v195, v195, s58, -v60
v_exp_f32 v209, v209
v_mfma_f32_16x16x32_bf16 v[76:79], a[232:235], v[148:151], v[76:79]
buffer_store_dwordx4 v[160:163], v1, s[24:27], s60 offen offset:0 sc1
buffer_load_dwordx4 a[152:155], v2, s[24:27], s54 offen offset:2048 sc1
v_add_f32 v176, 1.0, v176
v_accvgpr_read_b32 v160, a32
v_mfma_f32_16x16x32_bf16 v[76:79], a[236:239], v[156:159], v[76:79]
ds_read_b64_tr_b16 a[224:225], v20 offset:32768
v_add_f32 v177, 1.0, v177
v_accvgpr_read_b32 v161, a33
v_add_f32 v178, 1.0, v178
v_accvgpr_read_b32 v162, a34
v_rcp_f32 v176, v176
v_mfma_f32_16x16x32_bf16 v[72:75], a[236:239], v[152:155], v[72:75]
ds_read_b64_tr_b16 a[226:227], v20 offset:34816
v_add_f32 v179, 1.0, v179
v_accvgpr_read_b32 v163, a35
v_add_f32 v180, 1.0, v180
v_accvgpr_read_b32 v164, a36
v_rcp_f32 v177, v177
v_mfma_f32_16x16x32_bf16 v[72:75], a[232:235], v[144:147], v[72:75]
s_waitcnt lgkmcnt(6)
ds_read_b64_tr_b16 a[228:229], v20 offset:36864
buffer_load_dwordx4 a[156:159], v2, s[24:27], s54 offen offset:3072 sc1
v_add_f32 v181, 1.0, v181
v_accvgpr_read_b32 v165, a37
v_rcp_f32 v178, v178
v_mfma_f32_16x16x32_bf16 v[80:83], a[240:243], v[144:147], v[80:83]
s_bfe_u32 s54, 0x4060a04, s64
ds_read_b64_tr_b16 a[230:231], v20 offset:38912
s_lshl_b32 s54, s54, 13
v_add_f32 v182, 1.0, v182
v_accvgpr_read_b32 v166, a38
v_add_f32 v183, 1.0, v183
v_rcp_f32 v179, v179
v_mfma_f32_16x16x32_bf16 v[80:83], a[244:247], v[152:155], v[80:83]
s_add_u32 s54, s54, s63
ds_read_b64_tr_b16 a[232:233], v21 offset:32768
v_accvgpr_read_b32 v167, a39
v_accvgpr_read_b32 v168, a40
v_accvgpr_read_b32 v169, a41
v_accvgpr_read_b32 v170, a42
v_rcp_f32 v180, v180
v_mfma_f32_16x16x32_bf16 v[84:87], a[244:247], v[156:159], v[84:87]
ds_read_b64_tr_b16 a[234:235], v21 offset:34816
buffer_load_dwordx4 a[0:3], v1, s[24:27], s54 offen offset:0 sc1
v_accvgpr_read_b32 v171, a43
v_accvgpr_read_b32 v172, a44
v_rcp_f32 v181, v181
v_mfma_f32_16x16x32_bf16 v[84:87], a[240:243], v[148:151], v[84:87]
s_waitcnt lgkmcnt(6)
ds_read_b64_tr_b16 a[236:237], v21 offset:36864
v_accvgpr_read_b32 v173, a45
v_rcp_f32 v182, v182
v_accvgpr_read_b32 v174, a46
v_rcp_f32 v183, v183
v_mfma_f32_16x16x32_bf16 v[92:95], a[248:251], v[148:151], v[92:95]
ds_read_b64_tr_b16 a[238:239], v21 offset:38912
buffer_load_dwordx4 a[4:7], v1, s[24:27], s54 offen offset:1024 sc1
v_accvgpr_read_b32 v175, a47
v_mul_f32 v176, v176, v184
v_exp_f32 v193, v193
v_mfma_f32_16x16x32_bf16 v[92:95], a[252:255], v[156:159], v[92:95]
ds_read_b64_tr_b16 a[240:241], v22 offset:32768
v_mul_f32 v160, s57, v160
v_mul_f32 v177, v177, v185
v_mul_f32 v161, s57, v161
v_mul_f32 v178, v178, v186
v_exp_f32 v160, v160
v_mfma_f32_16x16x32_bf16 v[88:91], a[252:255], v[152:155], v[88:91]
ds_read_b64_tr_b16 a[242:243], v22 offset:34816
buffer_load_dwordx4 a[8:11], v1, s[24:27], s54 offen offset:2048 sc1
v_mul_f32 v162, s57, v162
v_mul_f32 v179, v179, v187
v_exp_f32 v161, v161
v_mfma_f32_16x16x32_bf16 v[88:91], a[248:251], v[144:147], v[88:91]
s_waitcnt lgkmcnt(6)
ds_read_b64_tr_b16 a[244:245], v22 offset:36864
buffer_load_dword v33, v55, s[24:27], s6 offen offset:0 sc1
v_mul_f32 v163, s57, v163
v_mul_f32 v180, v180, v188
v_exp_f32 v162, v162
v_mfma_f32_16x16x32_bf16 v[64:67], a[224:227], a[160:163], v[64:67]
ds_read_b64_tr_b16 a[246:247], v22 offset:38912
buffer_load_dwordx4 a[12:15], v1, s[24:27], s54 offen offset:3072 sc1
v_mul_f32 v164, s57, v164
v_mul_f32 v181, v181, v189
v_exp_f32 v163, v163
v_mfma_f32_16x16x32_bf16 v[64:67], a[228:231], a[168:171], v[64:67]
ds_read_b64_tr_b16 a[248:249], v23 offset:32768
v_mul_f32 v165, s57, v165
v_mul_f32 v182, v182, v190
v_mul_f32 v166, s57, v166
v_mul_f32 v183, v183, v191
v_exp_f32 v164, v164
v_mfma_f32_16x16x32_bf16 v[68:71], a[228:231], a[172:175], v[68:71]
ds_read_b64_tr_b16 a[250:251], v23 offset:34816
buffer_load_dwordx4 a[16:19], v2, s[24:27], s54 offen offset:0 sc1
v_mul_f32 v167, s57, v167
v_cvt_pk_bf16_f32 v176, v176, v177
v_exp_f32 v165, v165
v_mfma_f32_16x16x32_bf16 v[68:71], a[224:227], a[164:167], v[68:71]
s_waitcnt lgkmcnt(6)
ds_read_b64_tr_b16 a[252:253], v23 offset:36864
v_cvt_pk_bf16_f32 v177, v178, v179
v_cvt_pk_bf16_f32 v178, v180, v181
v_cvt_pk_bf16_f32 v179, v182, v183
v_exp_f32 v166, v166
v_add_f32 v160, 1.0, v160
v_mfma_f32_16x16x32_bf16 v[76:79], a[232:235], a[164:167], v[76:79]
buffer_store_dwordx4 v[176:179], v1, s[24:27], s60 offen offset:1024 sc1
ds_read_b64_tr_b16 a[254:255], v23 offset:38912
v_exp_f32 v167, v167
v_accvgpr_read_b32 v176, a48
v_mfma_f32_16x16x32_bf16 v[76:79], a[236:239], a[172:175], v[76:79]
ds_read_b64_tr_b16 a[224:225], v20 offset:40960
v_add_f32 v161, 1.0, v161
v_accvgpr_read_b32 v177, a49
v_add_f32 v162, 1.0, v162
v_accvgpr_read_b32 v178, a50
v_rcp_f32 v160, v160
v_mfma_f32_16x16x32_bf16 v[72:75], a[236:239], a[168:171], v[72:75]
ds_read_b64_tr_b16 a[226:227], v20 offset:43008
buffer_load_dwordx4 a[20:23], v2, s[24:27], s54 offen offset:1024 sc1
v_add_f32 v163, 1.0, v163
v_accvgpr_read_b32 v179, a51
v_rcp_f32 v161, v161
v_mfma_f32_16x16x32_bf16 v[72:75], a[232:235], a[160:163], v[72:75]
s_waitcnt lgkmcnt(6)
ds_read_b64_tr_b16 a[228:229], v20 offset:45056
v_add_f32 v164, 1.0, v164
v_accvgpr_read_b32 v180, a52
v_add_f32 v165, 1.0, v165
v_accvgpr_read_b32 v181, a53
v_rcp_f32 v162, v162
v_mfma_f32_16x16x32_bf16 v[80:83], a[240:243], a[160:163], v[80:83]
ds_read_b64_tr_b16 a[230:231], v20 offset:47104
buffer_load_dwordx4 a[24:27], v2, s[24:27], s54 offen offset:2048 sc1
v_add_f32 v166, 1.0, v166
v_accvgpr_read_b32 v182, a54
v_rcp_f32 v163, v163
v_mfma_f32_16x16x32_bf16 v[80:83], a[244:247], a[168:171], v[80:83]
s_load_dword s101, s[92:93], 49144
ds_read_b64_tr_b16 a[232:233], v21 offset:40960
v_add_f32 v167, 1.0, v167
v_accvgpr_read_b32 v183, a55
v_accvgpr_read_b32 v184, a56
v_accvgpr_read_b32 v185, a57
v_rcp_f32 v164, v164
v_mfma_f32_16x16x32_bf16 v[84:87], a[244:247], a[172:175], v[84:87]
ds_read_b64_tr_b16 a[234:235], v21 offset:43008
buffer_load_dwordx4 a[28:31], v2, s[24:27], s54 offen offset:3072 sc1
v_accvgpr_read_b32 v186, a58
v_accvgpr_read_b32 v187, a59
v_rcp_f32 v165, v165
v_mfma_f32_16x16x32_bf16 v[84:87], a[240:243], a[164:167], v[84:87]
s_waitcnt lgkmcnt(6)
ds_read_b64_tr_b16 a[236:237], v21 offset:45056
s_xor_b32 s55, s55, 131072
v_accvgpr_read_b32 v188, a60
v_accvgpr_read_b32 v189, a61
v_rcp_f32 v166, v166
v_accvgpr_read_b32 v190, a62
v_mfma_f32_16x16x32_bf16 v[92:95], a[248:251], a[164:167], v[92:95]
s_add_u32 m0, s52, 24576
ds_read_b64_tr_b16 a[238:239], v21 offset:47104
v_rcp_f32 v167, v167
v_accvgpr_read_b32 v191, a63
v_mul_f32 v160, v160, v168
v_exp_f32 v210, v210
v_mfma_f32_16x16x32_bf16 v[92:95], a[252:255], a[172:175], v[92:95]
s_add_u32 s60, s60, 294912
ds_read_b64_tr_b16 a[240:241], v22 offset:40960
buffer_load_dwordx4 v28, s[40:43], s55 offen offset:0 lds
v_mul_f32 v176, s57, v176
v_mul_f32 v161, v161, v169
v_exp_f32 v176, v176
v_mfma_f32_16x16x32_bf16 v[88:91], a[252:255], a[168:171], v[88:91]
ds_read_b64_tr_b16 a[242:243], v22 offset:43008
v_mul_f32 v177, s57, v177
v_mul_f32 v162, v162, v170
v_mul_f32 v178, s57, v178
v_mul_f32 v163, v163, v171
v_exp_f32 v177, v177
v_mfma_f32_16x16x32_bf16 v[88:91], a[248:251], a[160:163], v[88:91]
s_waitcnt lgkmcnt(6)
ds_read_b64_tr_b16 a[244:245], v22 offset:45056
buffer_load_dwordx4 v29, s[40:43], s55 offen offset:1024 lds
v_mul_f32 v179, s57, v179
v_mul_f32 v164, v164, v172
v_exp_f32 v178, v178
v_mfma_f32_16x16x32_bf16 a[192:195], a[224:227], a[160:163], a[192:195]
s_xor_b32 s55, s55, 128
ds_read_b64_tr_b16 a[246:247], v22 offset:47104
v_mul_f32 v180, s57, v180
v_mul_f32 v165, v165, v173
v_mul_f32 v181, s57, v181
v_mul_f32 v166, v166, v174
v_exp_f32 v179, v179
v_mfma_f32_16x16x32_bf16 a[192:195], a[228:231], a[168:171], a[192:195]
s_add_u32 m0, s52, 32768
ds_read_b64_tr_b16 a[248:249], v23 offset:40960
v_mul_f32 v182, s57, v182
v_mul_f32 v167, v167, v175
v_mul_f32 v183, s57, v183
v_cvt_pk_bf16_f32 v160, v160, v161
v_exp_f32 v180, v180
v_mfma_f32_16x16x32_bf16 a[196:199], a[228:231], a[172:175], a[196:199]
ds_read_b64_tr_b16 a[250:251], v23 offset:43008
buffer_load_dwordx4 v28, s[40:43], s55 offen offset:0 lds
v_cvt_pk_bf16_f32 v161, v162, v163
v_cvt_pk_bf16_f32 v162, v164, v165
v_exp_f32 v181, v181
v_mfma_f32_16x16x32_bf16 a[196:199], a[224:227], a[164:167], a[196:199]
s_waitcnt lgkmcnt(6)
ds_read_b64_tr_b16 a[252:253], v23 offset:45056
v_cvt_pk_bf16_f32 v163, v166, v167
v_exp_f32 v182, v182
v_exp_f32 v183, v183
v_fma_f32 v212, -v196, s58, -v62
v_mfma_f32_16x16x32_bf16 a[204:207], a[232:235], a[164:167], a[204:207]
buffer_store_dwordx4 v[160:163], v1, s[24:27], s60 offen offset:0 sc1
buffer_load_dwordx4 v29, s[40:43], s55 offen offset:1024 lds
v_add_f32 v176, 1.0, v176
v_add_f32 v177, 1.0, v177
v_mfma_f32_16x16x32_bf16 a[204:207], a[236:239], a[172:175], a[204:207]
s_bfe_u32 s54, 0x80c0606, s64
ds_read_b64_tr_b16 a[254:255], v23 offset:47104
ds_read_b64_tr_b16 a[224:225], v20 offset:49152
v_add_f32 v178, 1.0, v178
v_add_f32 v179, 1.0, v179
v_add_f32 v180, 1.0, v180
v_rcp_f32 v176, v176
v_mfma_f32_16x16x32_bf16 a[200:203], a[236:239], a[168:171], a[200:203]
s_lshl_b32 s54, s54, 13
ds_read_b64_tr_b16 a[226:227], v20 offset:51200
v_add_f32 v181, 1.0, v181
v_add_f32 v182, 1.0, v182
v_add_f32 v183, 1.0, v183
v_rcp_f32 v177, v177
v_mul_f32 v176, v176, v184
v_mfma_f32_16x16x32_bf16 a[200:203], a[232:235], a[160:163], a[200:203]
s_waitcnt lgkmcnt(6)
ds_read_b64_tr_b16 a[228:229], v20 offset:53248
s_add_u32 s54, s54, s63
v_rcp_f32 v178, v178
v_rcp_f32 v179, v179
v_mul_f32 v177, v177, v185
v_mfma_f32_16x16x32_bf16 a[208:211], a[240:243], a[160:163], a[208:211]
ds_read_b64_tr_b16 a[230:231], v20 offset:55296
buffer_load_dwordx4 a[32:35], v1, s[24:27], s54 offen offset:0 sc1
v_rcp_f32 v180, v180
v_rcp_f32 v181, v181
v_mfma_f32_16x16x32_bf16 a[208:211], a[244:247], a[168:171], a[208:211]
ds_read_b64_tr_b16 a[232:233], v21 offset:49152
v_rcp_f32 v182, v182
v_rcp_f32 v183, v183
v_exp_f32 v194, v194
v_mfma_f32_16x16x32_bf16 a[212:215], a[244:247], a[172:175], a[212:215]
ds_read_b64_tr_b16 a[234:235], v21 offset:51200
buffer_load_dwordx4 a[36:39], v1, s[24:27], s54 offen offset:1024 sc1
v_mul_f32 v178, v178, v186
v_mul_f32 v179, v179, v187
v_exp_f32 v211, v211
v_mfma_f32_16x16x32_bf16 a[212:215], a[240:243], a[164:167], a[212:215]
s_waitcnt lgkmcnt(6)
ds_read_b64_tr_b16 a[236:237], v21 offset:53248
v_mul_f32 v180, v180, v188
v_mul_f32 v181, v181, v189
v_mul_f32 v182, v182, v190
v_mul_f32 v183, v183, v191
v_exp_f32 v195, v195
v_mfma_f32_16x16x32_bf16 a[220:223], a[248:251], a[164:167], a[220:223]
ds_read_b64_tr_b16 a[238:239], v21 offset:55296
buffer_load_dwordx4 a[40:43], v1, s[24:27], s54 offen offset:2048 sc1
v_cvt_pk_bf16_f32 v176, v176, v177
v_cvt_pk_bf16_f32 v177, v178, v179
v_exp_f32 v212, v212
v_mfma_f32_16x16x32_bf16 a[220:223], a[252:255], a[172:175], a[220:223]
s_waitcnt vmcnt(14)
ds_read_b64_tr_b16 a[240:241], v22 offset:49152
v_cvt_pk_bf16_f32 v178, v180, v181
v_cvt_pk_bf16_f32 v179, v182, v183
v_cmp_ne_u32 vcc, v33, v32
s_nop 0
s_cbranch_vccnz ckK_spin
ckK_ok:
v_fma_f32 v196, v196, s58, -v60
v_mfma_f32_16x16x32_bf16 a[216:219], a[252:255], a[168:171], a[216:219]
buffer_store_dwordx4 v[176:179], v1, s[24:27], s60 offen offset:1024 sc1
buffer_load_dwordx4 a[44:47], v1, s[24:27], s54 offen offset:3072 sc1
v_fma_f32 v213, -v197, s58, -v62
v_fma_f32 v197, v197, s58, -v60
v_mfma_f32_16x16x32_bf16 a[216:219], a[248:251], a[160:163], a[216:219]
s_waitcnt lgkmcnt(5)
ds_read_b64_tr_b16 a[242:243], v22 offset:51200
ds_read_b64_tr_b16 a[244:245], v22 offset:53248
v_fma_f32 v214, -v198, s58, -v62
v_exp_f32 v196, v196
v_mfma_f32_16x16x32_bf16 a[192:195], a[224:227], a[176:179], a[192:195]
ds_read_b64_tr_b16 a[246:247], v22 offset:55296
v_fma_f32 v198, v198, s58, -v60
v_fma_f32 v215, -v199, s58, -v62
v_exp_f32 v213, v213
v_mfma_f32_16x16x32_bf16 a[192:195], a[228:231], a[184:187], a[192:195]
ds_read_b64_tr_b16 a[248:249], v23 offset:49152
buffer_load_dwordx4 a[48:51], v2, s[24:27], s54 offen offset:0 sc1
v_exp_f32 v197, v197
v_mfma_f32_16x16x32_bf16 a[196:199], a[228:231], a[188:191], a[196:199]
ds_read_b64_tr_b16 a[250:251], v23 offset:51200
v_fma_f32 v199, v199, s58, -v60
v_exp_f32 v214, v214
v_fma_f32 v216, -v200, s58, -v63
v_mfma_f32_16x16x32_bf16 a[196:199], a[224:227], a[180:183], a[196:199]
s_waitcnt lgkmcnt(6)
ds_read_b64_tr_b16 a[252:253], v23 offset:53248
v_exp_f32 v198, v198
v_exp_f32 v215, v215
v_mfma_f32_16x16x32_bf16 a[204:207], a[232:235], a[180:183], a[204:207]
ds_read_b64_tr_b16 a[254:255], v23 offset:55296
buffer_load_dwordx4 a[52:55], v2, s[24:27], s54 offen offset:1024 sc1
v_exp_f32 v199, v199
v_mfma_f32_16x16x32_bf16 a[204:207], a[236:239], a[188:191], a[204:207]
ds_read_b64_tr_b16 a[224:225], v20 offset:57344
v_fma_f32 v200, v200, s58, -v61
v_fma_f32 v217, -v201, s58, -v63
v_exp_f32 v216, v216
v_mfma_f32_16x16x32_bf16 a[200:203], a[236:239], a[184:187], a[200:203]
ds_read_b64_tr_b16 a[226:227], v20 offset:59392
buffer_load_dwordx4 a[56:59], v2, s[24:27], s54 offen offset:2048 sc1
v_exp_f32 v200, v200
v_mfma_f32_16x16x32_bf16 a[200:203], a[232:235], a[176:179], a[200:203]
s_waitcnt lgkmcnt(6)
ds_read_b64_tr_b16 a[228:229], v20 offset:61440
v_fma_f32 v201, v201, s58, -v61
v_fma_f32 v218, -v202, s58, -v63
v_exp_f32 v217, v217
v_mfma_f32_16x16x32_bf16 a[208:211], a[240:243], a[176:179], a[208:211]
ds_read_b64_tr_b16 a[230:231], v20 offset:63488
v_fma_f32 v202, v202, s58, -v61
v_fma_f32 v219, -v203, s58, -v63
v_exp_f32 v201, v201
v_mfma_f32_16x16x32_bf16 a[208:211], a[244:247], a[184:187], a[208:211]
ds_read_b64_tr_b16 a[232:233], v21 offset:57344
buffer_load_dwordx4 a[60:63], v2, s[24:27], s54 offen offset:3072 sc1
v_exp_f32 v218, v218
v_mfma_f32_16x16x32_bf16 a[212:215], a[244:247], a[188:191], a[212:215]
s_bfe_u32 s55, 0xe08080a, s64
ds_read_b64_tr_b16 a[234:235], v21 offset:59392
v_fma_f32 v203, v203, s58, -v61
v_fma_f32 v220, -v204, s58, -v63
v_exp_f32 v202, v202
v_mfma_f32_16x16x32_bf16 a[212:215], a[240:243], a[180:183], a[212:215]
s_waitcnt lgkmcnt(6)
ds_read_b64_tr_b16 a[236:237], v21 offset:61440
s_lshl_b32 s55, s55, 18
v_fma_f32 v204, v204, s58, -v61
v_exp_f32 v219, v219
v_mfma_f32_16x16x32_bf16 a[220:223], a[248:251], a[180:183], a[220:223]
s_add_u32 m0, s52, 40960
ds_read_b64_tr_b16 a[238:239], v21 offset:63488
v_fma_f32 v221, -v205, s58, -v63
v_fma_f32 v205, v205, s58, -v61
v_exp_f32 v203, v203
v_mfma_f32_16x16x32_bf16 a[220:223], a[252:255], a[188:191], a[220:223]
ds_read_b64_tr_b16 a[240:241], v22 offset:57344
buffer_load_dwordx4 v28, s[40:43], s55 offen offset:0 lds
v_exp_f32 v220, v220
v_mfma_f32_16x16x32_bf16 a[216:219], a[252:255], a[184:187], a[216:219]
ds_read_b64_tr_b16 a[242:243], v22 offset:59392
v_fma_f32 v222, -v206, s58, -v63
v_fma_f32 v206, v206, s58, -v61
v_exp_f32 v204, v204
v_mfma_f32_16x16x32_bf16 a[216:219], a[248:251], a[176:179], a[216:219]
s_waitcnt lgkmcnt(6)
ds_read_b64_tr_b16 a[244:245], v22 offset:61440
buffer_load_dwordx4 v29, s[40:43], s55 offen offset:1024 lds
v_exp_f32 v221, v221
v_mfma_f32_16x16x32_bf16 v[64:67], a[224:227], a[176:179], v[64:67]
s_xor_b32 s55, s55, 128
ds_read_b64_tr_b16 a[246:247], v22 offset:63488
v_fma_f32 v223, -v207, s58, -v63
v_fma_f32 v207, v207, s58, -v61
v_exp_f32 v205, v205
v_mfma_f32_16x16x32_bf16 v[64:67], a[228:231], a[184:187], v[64:67]
s_add_u32 m0, s52, 49152
ds_read_b64_tr_b16 a[248:249], v23 offset:57344
v_exp_f32 v222, v222
v_exp_f32 v206, v206
v_mfma_f32_16x16x32_bf16 v[68:71], a[228:231], a[188:191], v[68:71]
ds_read_b64_tr_b16 a[250:251], v23 offset:59392
buffer_load_dwordx4 v28, s[40:43], s55 offen offset:0 lds
v_exp_f32 v223, v223
v_mfma_f32_16x16x32_bf16 v[68:71], a[224:227], a[180:183], v[68:71]
s_waitcnt vmcnt(55) lgkmcnt(6)
s_barrier
ds_read_b64_tr_b16 a[252:253], v23 offset:61440
v_exp_f32 v207, v207
v_mfma_f32_16x16x32_bf16 v[76:79], a[232:235], a[180:183], v[76:79]
ds_read_b64_tr_b16 a[254:255], v23 offset:63488
buffer_load_dwordx4 v29, s[40:43], s55 offen offset:1024 lds
v_add_f32 v60, v192, v193
v_add_f32 v62, v208, v209
v_mfma_f32_16x16x32_bf16 v[76:79], a[236:239], a[188:191], v[76:79]
s_xor_b32 s55, s55, 131072
ds_read_b64_tr_b16 a[224:225], v24 offset:0
v_add_f32 v61, v200, v201
v_add_f32 v63, v216, v217
v_add_f32 v60, v60, v194
v_add_f32 v62, v62, v210
v_mfma_f32_16x16x32_bf16 v[72:75], a[236:239], a[184:187], v[72:75]
s_add_u32 m0, s52, 57344
ds_read_b64_tr_b16 a[226:227], v24 offset:2048
v_add_f32 v61, v61, v202
v_add_f32 v63, v63, v218
v_add_f32 v60, v60, v195
v_add_f32 v62, v62, v211
v_mfma_f32_16x16x32_bf16 v[72:75], a[232:235], a[176:179], v[72:75]
s_waitcnt lgkmcnt(6)
ds_read_b64_tr_b16 a[228:229], v24 offset:4096
buffer_load_dwordx4 v28, s[40:43], s55 offen offset:0 lds
v_add_f32 v61, v61, v203
v_add_f32 v63, v63, v219
v_mfma_f32_16x16x32_bf16 v[80:83], a[240:243], a[176:179], v[80:83]
ds_read_b64_tr_b16 a[230:231], v24 offset:6144
v_add_f32 v60, v60, v196
v_add_f32 v62, v62, v212
v_add_f32 v61, v61, v204
v_add_f32 v63, v63, v220
v_mfma_f32_16x16x32_bf16 v[80:83], a[244:247], a[184:187], v[80:83]
ds_read_b64_tr_b16 a[232:233], v25 offset:0
buffer_load_dwordx4 v29, s[40:43], s55 offen offset:1024 lds
v_add_f32 v60, v60, v197
v_add_f32 v62, v62, v213
v_mfma_f32_16x16x32_bf16 v[84:87], a[244:247], a[188:191], v[84:87]
s_xor_b32 s55, s55, 128
ds_read_b64_tr_b16 a[234:235], v25 offset:2048
v_add_f32 v61, v61, v205
v_add_f32 v63, v63, v221
v_add_f32 v60, v60, v198
v_add_f32 v62, v62, v214
v_mfma_f32_16x16x32_bf16 v[84:87], a[240:243], a[180:183], v[84:87]
s_waitcnt lgkmcnt(6)
ds_read_b64_tr_b16 a[236:237], v25 offset:4096
v_add_f32 v61, v61, v206
v_add_f32 v63, v63, v222
v_add_f32 v60, v60, v199
v_add_f32 v62, v62, v215
v_mfma_f32_16x16x32_bf16 v[92:95], a[248:251], a[180:183], v[92:95]
s_add_u32 m0, s52, 98304
ds_read_b64_tr_b16 a[238:239], v25 offset:6144
v_add_f32 v61, v61, v207
v_add_f32 v63, v63, v223
v_mfma_f32_16x16x32_bf16 v[92:95], a[252:255], a[188:191], v[92:95]
pg_11:
s_cbranch_execz pg_back0
ds_read_b64_tr_b16 a[240:241], v26 offset:0
buffer_load_dwordx4 v28, s[40:43], s55 offen offset:0 lds
v_permlane16_swap_b32 v60, v61
v_mfma_f32_16x16x32_bf16 v[88:91], a[252:255], a[184:187], v[88:91]
ds_read_b64_tr_b16 a[242:243], v26 offset:2048
v_permlane16_swap_b32 v62, v63
v_add_f32 v60, v60, v61
v_add_f32 v62, v62, v63
v_mfma_f32_16x16x32_bf16 v[88:91], a[248:251], a[176:179], v[88:91]
s_waitcnt lgkmcnt(6)
ds_read_b64_tr_b16 a[244:245], v26 offset:4096
buffer_load_dwordx4 v29, s[40:43], s55 offen offset:1024 lds
v_permlane32_swap_b32 v60, v62
v_mfma_f32_16x16x32_bf16 v[64:67], a[224:227], a[128:131], v[64:67]
s_bfe_u32 s54, 0xe08080a, s64
ds_read_b64_tr_b16 a[246:247], v26 offset:6144
v_lshl_add_u32 v55, v55, 4, v54
v_add_f32 v60, v60, v62
v_rcp_f32 v60, v60
v_mfma_f32_16x16x32_bf16 v[64:67], a[228:231], a[136:139], v[64:67]
s_lshl_b32 s54, s54, 13
ds_read_b64_tr_b16 a[248:249], v27 offset:0
ds_read_b64_tr_b16 a[250:251], v27 offset:2048
v_mfma_f32_16x16x32_bf16 v[68:71], a[228:231], a[140:143], v[68:71]
s_add_u32 s54, s54, s63
ds_read_b64_tr_b16 a[252:253], v27 offset:4096
v_mov_b32 v62, v60
v_mfma_f32_16x16x32_bf16 v[68:71], a[224:227], a[132:135], v[68:71]
s_waitcnt lgkmcnt(7)
buffer_load_dwordx4 a[160:163], v1, s[24:27], s54 offen offset:0 sc1
v_mfma_f32_16x16x32_bf16 v[76:79], a[232:235], a[132:135], v[76:79]
s_waitcnt vmcnt(14)
ds_read_b64_tr_b16 a[254:255], v27 offset:6144
v_permlane32_swap_b32 v60, v62
v_mov_b32 v61, v60
v_mov_b32 v63, v62
v_mfma_f32_16x16x32_bf16 v[76:79], a[236:239], a[140:143], v[76:79]
buffer_store_dword v32, v30, s[24:27], s61 offen offset:128 sc1
buffer_load_dwordx4 a[164:167], v1, s[24:27], s54 offen offset:1024 sc1
ds_read_b64_tr_b16 a[224:225], v24 offset:8192
v_mfma_f32_16x16x32_bf16 v[72:75], a[236:239], a[136:139], v[72:75]
s_lshl_b32 s6, s68, 13
ds_read_b64_tr_b16 a[226:227], v24 offset:10240
v_permlane16_swap_b32 v60, v61
v_permlane16_swap_b32 v62, v63
v_mfma_f32_16x16x32_bf16 v[72:75], a[232:235], a[128:131], v[72:75]
s_waitcnt lgkmcnt(6)
ds_read_b64_tr_b16 a[228:229], v24 offset:12288
v_mul_f32 v192, v192, v60
v_mul_f32 v208, v208, v62
v_mul_f32 v193, v193, v60
v_mul_f32 v209, v209, v62
v_mfma_f32_16x16x32_bf16 v[80:83], a[240:243], a[128:131], v[80:83]
s_add_u32 s6, s6, 12582912
ds_read_b64_tr_b16 a[230:231], v24 offset:14336
buffer_load_dwordx4 a[168:171], v1, s[24:27], s54 offen offset:2048 sc1
v_mul_f32 v194, v194, v60
v_mul_f32 v210, v210, v62
v_mfma_f32_16x16x32_bf16 v[80:83], a[244:247], a[136:139], v[80:83]
s_lshl_b32 s7, s68, 9
ds_read_b64_tr_b16 a[232:233], v25 offset:8192
v_mul_f32 v195, v195, v60
v_mul_f32 v211, v211, v62
v_mul_f32 v196, v196, v60
v_mul_f32 v212, v212, v62
v_mfma_f32_16x16x32_bf16 v[84:87], a[244:247], a[140:143], v[84:87]
s_add_u32 s7, s7, 15728640
ds_read_b64_tr_b16 a[234:235], v25 offset:10240
v_mul_f32 v197, v197, v60
v_mul_f32 v213, v213, v62
v_mul_f32 v198, v198, v60
v_mul_f32 v214, v214, v62
v_mfma_f32_16x16x32_bf16 v[84:87], a[240:243], a[132:135], v[84:87]
s_waitcnt lgkmcnt(6)
ds_read_b64_tr_b16 a[236:237], v25 offset:12288
buffer_load_dwordx4 v[48:51], v55, s[24:27], s7 offen sc1
v_mul_f32 v199, v199, v60
v_mul_f32 v215, v215, v62
v_mfma_f32_16x16x32_bf16 v[92:95], a[248:251], a[132:135], v[92:95]
ds_read_b64_tr_b16 a[238:239], v25 offset:14336
v_cvt_pk_bf16_f32 v224, v192, v193
v_cvt_pk_bf16_f32 v225, v194, v195
v_cvt_pk_bf16_f32 v226, v196, v197
v_cvt_pk_bf16_f32 v227, v198, v199
v_mfma_f32_16x16x32_bf16 v[92:95], a[252:255], a[140:143], v[92:95]
ds_read_b64_tr_b16 a[240:241], v26 offset:8192
buffer_load_dwordx4 v[96:99], v1, s[24:27], s6 offen offset:0 sc1
v_cvt_pk_bf16_f32 v228, v208, v209
v_cvt_pk_bf16_f32 v229, v210, v211
v_mfma_f32_16x16x32_bf16 v[88:91], a[252:255], a[136:139], v[88:91]
ds_read_b64_tr_b16 a[242:243], v26 offset:10240
v_cvt_pk_bf16_f32 v230, v212, v213
v_cvt_pk_bf16_f32 v231, v214, v215
v_mul_f32 v200, v200, v61
v_mul_f32 v216, v216, v63
v_mfma_f32_16x16x32_bf16 v[88:91], a[248:251], a[128:131], v[88:91]
s_waitcnt lgkmcnt(6)
ds_read_b64_tr_b16 a[244:245], v26 offset:12288
v_mul_f32 v201, v201, v61
v_mul_f32 v217, v217, v63
v_mul_f32 v202, v202, v61
v_mul_f32 v218, v218, v63
v_mfma_f32_16x16x32_bf16 a[192:195], a[224:227], a[128:131], a[192:195]
ds_read_b64_tr_b16 a[246:247], v26 offset:14336
buffer_load_dwordx4 v[100:103], v1, s[24:27], s6 offen offset:1024 sc1
v_mul_f32 v203, v203, v61
v_mul_f32 v219, v219, v63
v_mfma_f32_16x16x32_bf16 a[192:195], a[228:231], a[136:139], a[192:195]
ds_read_b64_tr_b16 a[248:249], v27 offset:8192
v_mul_f32 v204, v204, v61
v_mul_f32 v220, v220, v63
v_mul_f32 v205, v205, v61
v_mul_f32 v221, v221, v63
v_mfma_f32_16x16x32_bf16 a[196:199], a[228:231], a[140:143], a[196:199]
ds_read_b64_tr_b16 a[250:251], v27 offset:10240
v_mul_f32 v206, v206, v61
v_mul_f32 v222, v222, v63
v_mul_f32 v207, v207, v61
v_mul_f32 v223, v223, v63
v_mfma_f32_16x16x32_bf16 a[196:199], a[224:227], a[132:135], a[196:199]
s_waitcnt lgkmcnt(6)
ds_read_b64_tr_b16 a[252:253], v27 offset:12288
buffer_load_dwordx4 v[104:107], v1, s[24:27], s6 offen offset:2048 sc1
v_cvt_pk_bf16_f32 v232, v200, v201
v_cvt_pk_bf16_f32 v233, v202, v203
v_mfma_f32_16x16x32_bf16 a[204:207], a[232:235], a[132:135], a[204:207]
ds_read_b64_tr_b16 a[254:255], v27 offset:14336
v_cvt_pk_bf16_f32 v234, v204, v205
v_cvt_pk_bf16_f32 v235, v206, v207
v_cvt_pk_bf16_f32 v236, v216, v217
v_cvt_pk_bf16_f32 v237, v218, v219
v_mfma_f32_16x16x32_bf16 a[204:207], a[236:239], a[140:143], a[204:207]
ds_read_b64_tr_b16 a[224:225], v24 offset:16384
buffer_load_dwordx4 v[108:111], v1, s[24:27], s6 offen offset:3072 sc1
v_cvt_pk_bf16_f32 v238, v220, v221
v_cvt_pk_bf16_f32 v239, v222, v223
v_mfma_f32_16x16x32_bf16 a[200:203], a[236:239], a[136:139], a[200:203]
ds_read_b64_tr_b16 a[226:227], v24 offset:18432
v_cvt_pk_bf16_f32 v240, v240, v241
v_cvt_pk_bf16_f32 v241, v242, v243
v_cvt_pk_bf16_f32 v242, v244, v245
v_cvt_pk_bf16_f32 v243, v246, v247
v_mfma_f32_16x16x32_bf16 a[200:203], a[232:235], a[128:131], a[200:203]
s_waitcnt lgkmcnt(6)
ds_read_b64_tr_b16 a[228:229], v24 offset:20480
v_cvt_pk_bf16_f32 v244, v248, v249
v_cvt_pk_bf16_f32 v245, v250, v251
v_cvt_pk_bf16_f32 v246, v252, v253
v_cvt_pk_bf16_f32 v247, v254, v255
v_mfma_f32_16x16x32_bf16 v[192:195], v[40:43], v[240:243], 0
buffer_load_dwordx4 v[112:115], v2, s[24:27], s6 offen offset:0 sc1
v_mfma_f32_16x16x32_bf16 v[196:199], v[44:47], v[240:243], 0
ds_read_b64_tr_b16 a[230:231], v24 offset:22528
v_mfma_f32_16x16x32_bf16 v[200:203], v[40:43], v[244:247], 0
v_mfma_f32_16x16x32_bf16 v[204:207], v[44:47], v[244:247], 0
v_mfma_f32_16x16x32_bf16 a[208:211], a[240:243], a[128:131], a[208:211]
buffer_load_dwordx4 v[116:119], v2, s[24:27], s6 offen offset:1024 sc1
v_mfma_f32_16x16x32_bf16 a[208:211], a[244:247], a[136:139], a[208:211]
ds_read_b64_tr_b16 a[232:233], v25 offset:16384
v_max3_f32 v60, v192, v193, v194
v_max3_f32 v62, -v192, -v193, -v194
v_max3_f32 v60, v60, v195, v196
v_max3_f32 v62, v62, -v195, -v196
v_mfma_f32_16x16x32_bf16 a[212:215], a[244:247], a[140:143], a[212:215]
ds_read_b64_tr_b16 a[234:235], v25 offset:18432
v_max3_f32 v60, v60, v197, v198
v_max3_f32 v62, v62, -v197, -v198
v_max_f32 v60, v60, v199
v_max_f32_e64 v62, v62, -v199
v_mfma_f32_16x16x32_bf16 a[212:215], a[240:243], a[132:135], a[212:215]
s_waitcnt lgkmcnt(6)
ds_read_b64_tr_b16 a[236:237], v25 offset:20480
buffer_load_dwordx4 v[120:123], v2, s[24:27], s6 offen offset:2048 sc1
v_max3_f32 v61, v200, v201, v202
v_max3_f32 v63, -v200, -v201, -v202
v_mfma_f32_16x16x32_bf16 a[220:223], a[248:251], a[132:135], a[220:223]
ds_read_b64_tr_b16 a[238:239], v25 offset:22528
v_max3_f32 v61, v61, v203, v204
v_max3_f32 v63, v63, -v203, -v204
v_max3_f32 v61, v61, v205, v206
v_max3_f32 v63, v63, -v205, -v206
v_mfma_f32_16x16x32_bf16 a[220:223], a[252:255], a[140:143], a[220:223]
ds_read_b64_tr_b16 a[240:241], v26 offset:16384
v_max_f32 v61, v61, v207
v_max_f32_e64 v63, v63, -v207
v_mfma_f32_16x16x32_bf16 a[216:219], a[252:255], a[136:139], a[216:219]
ds_read_b64_tr_b16 a[242:243], v26 offset:18432
buffer_load_dwordx4 v[124:127], v2, s[24:27], s6 offen offset:3072 sc1
v_permlane16_swap_b32 v60, v61
v_mfma_f32_16x16x32_bf16 a[216:219], a[248:251], a[128:131], a[216:219]
s_waitcnt lgkmcnt(6)
ds_read_b64_tr_b16 a[244:245], v26 offset:20480
v_permlane16_swap_b32 v62, v63
v_max_f32 v60, v60, v61
v_max_f32 v62, v62, v63
v_mfma_f32_16x16x32_bf16 a[192:195], a[224:227], a[144:147], a[192:195]
buffer_load_dwordx4 a[172:175], v1, s[24:27], s54 offen offset:3072 sc1
v_mfma_f32_16x16x32_bf16 a[192:195], a[228:231], a[152:155], a[192:195]
ds_read_b64_tr_b16 a[246:247], v26 offset:22528
ds_read_b64_tr_b16 a[248:249], v27 offset:16384
v_permlane32_swap_b32 v60, v62
v_max_f32 v60, v60, v62
v_mfma_f32_16x16x32_bf16 a[196:199], a[228:231], a[156:159], a[196:199]
ds_read_b64_tr_b16 a[250:251], v27 offset:18432
v_mul_f32 v60, s58, v60
v_mov_b32 v62, v60
v_mfma_f32_16x16x32_bf16 a[196:199], a[224:227], a[148:151], a[196:199]
s_waitcnt lgkmcnt(6)
ds_read_b64_tr_b16 a[252:253], v27 offset:20480
ds_read_b64_tr_b16 a[254:255], v27 offset:22528
v_mfma_f32_16x16x32_bf16 a[204:207], a[232:235], a[148:151], a[204:207]
ds_read_b64_tr_b16 a[224:225], v20 offset:0
buffer_load_dwordx4 a[176:179], v2, s[24:27], s54 offen offset:0 sc1
v_permlane32_swap_b32 v60, v62
v_mfma_f32_16x16x32_bf16 a[204:207], a[236:239], a[156:159], a[204:207]
ds_read_b64_tr_b16 a[226:227], v20 offset:2048
v_mov_b32 v61, v60
v_mov_b32 v63, v62
v_mfma_f32_16x16x32_bf16 a[200:203], a[236:239], a[152:155], a[200:203]
ds_read_b64_tr_b16 a[228:229], v20 offset:4096
v_permlane16_swap_b32 v60, v61
v_permlane16_swap_b32 v62, v63
v_mfma_f32_16x16x32_bf16 a[200:203], a[232:235], a[144:147], a[200:203]
s_waitcnt lgkmcnt(7)
ds_read_b64_tr_b16 a[230:231], v20 offset:6144
buffer_load_dwordx4 a[180:183], v2, s[24:27], s54 offen offset:1024 sc1
v_fma_f32 v208, -v192, s58, -v62
v_fma_f32 v192, v192, s58, -v60
v_mfma_f32_16x16x32_bf16 a[208:211], a[240:243], a[144:147], a[208:211]
ds_read_b64_tr_b16 a[232:233], v21 offset:0
v_fma_f32 v209, -v193, s58, -v62
v_fma_f32 v193, v193, s58, -v60
v_exp_f32 v208, v208
v_mfma_f32_16x16x32_bf16 a[208:211], a[244:247], a[152:155], a[208:211]
ds_read_b64_tr_b16 a[234:235], v21 offset:2048
v_fma_f32 v210, -v194, s58, -v62
v_fma_f32 v194, v194, s58, -v60
v_exp_f32 v192, v192
v_mfma_f32_16x16x32_bf16 a[212:215], a[244:247], a[156:159], a[212:215]
ds_read_b64_tr_b16 a[236:237], v21 offset:4096
buffer_load_dwordx4 a[184:187], v2, s[24:27], s54 offen offset:2048 sc1
v_exp_f32 v209, v209
v_mfma_f32_16x16x32_bf16 a[212:215], a[240:243], a[148:151], a[212:215]
s_waitcnt lgkmcnt(7)
ds_read_b64_tr_b16 a[238:239], v21 offset:6144
v_fma_f32 v211, -v195, s58, -v62
v_fma_f32 v195, v195, s58, -v60
v_exp_f32 v193, v193
v_mfma_f32_16x16x32_bf16 a[220:223], a[248:251], a[148:151], a[220:223]
ds_read_b64_tr_b16 a[240:241], v22 offset:0
buffer_load_dwordx4 a[188:191], v2, s[24:27], s54 offen offset:3072 sc1
v_exp_f32 v210, v210
v_mfma_f32_16x16x32_bf16 a[220:223], a[252:255], a[156:159], a[220:223]
s_bfe_u32 s55, 0xa0a0c0f, s64
ds_read_b64_tr_b16 a[242:243], v22 offset:2048
v_fma_f32 v212, -v196, s58, -v62
v_fma_f32 v196, v196, s58, -v60
v_exp_f32 v194, v194
v_mfma_f32_16x16x32_bf16 a[216:219], a[252:255], a[152:155], a[216:219]
s_lshl_b32 s55, s55, 18
ds_read_b64_tr_b16 a[244:245], v22 offset:4096
v_fma_f32 v213, -v197, s58, -v62
v_fma_f32 v197, v197, s58, -v60
v_exp_f32 v211, v211
v_mfma_f32_16x16x32_bf16 a[216:219], a[248:251], a[144:147], a[216:219]
s_waitcnt lgkmcnt(7)
ds_read_b64_tr_b16 a[246:247], v22 offset:6144
s_add_u32 m0, s52, 106496
v_fma_f32 v214, -v198, s58, -v62
v_exp_f32 v195, v195
v_mfma_f32_16x16x32_bf16 v[64:67], a[224:227], a[144:147], v[64:67]
ds_read_b64_tr_b16 a[248:249], v23 offset:0
buffer_load_dwordx4 v28, s[40:43], s55 offen offset:0 lds
v_exp_f32 v212, v212
v_mfma_f32_16x16x32_bf16 v[64:67], a[228:231], a[152:155], v[64:67]
ds_read_b64_tr_b16 a[250:251], v23 offset:2048
v_fma_f32 v198, v198, s58, -v60
v_fma_f32 v215, -v199, s58, -v62
v_exp_f32 v196, v196
v_mfma_f32_16x16x32_bf16 v[68:71], a[228:231], a[156:159], v[68:71]
ds_read_b64_tr_b16 a[252:253], v23 offset:4096
buffer_load_dwordx4 v29, s[40:43], s55 offen offset:1024 lds
v_exp_f32 v213, v213
v_mfma_f32_16x16x32_bf16 v[68:71], a[224:227], a[148:151], v[68:71]
s_waitcnt vmcnt(63) lgkmcnt(7)
s_barrier
ds_read_b64_tr_b16 a[254:255], v23 offset:6144
v_exp_f32 v197, v197
v_mfma_f32_16x16x32_bf16 v[76:79], a[232:235], a[148:151], v[76:79]
s_xor_b32 s55, s55, 128
ds_read_b64_tr_b16 a[224:225], v20 offset:8192
s_add_u32 m0, s52, 114688
v_fma_f32 v199, v199, s58, -v60
v_exp_f32 v214, v214
v_mfma_f32_16x16x32_bf16 v[76:79], a[236:239], a[156:159], v[76:79]
ds_read_b64_tr_b16 a[226:227], v20 offset:10240
buffer_load_dwordx4 v28, s[40:43], s55 offen offset:0 lds
v_exp_f32 v198, v198
v_mfma_f32_16x16x32_bf16 v[72:75], a[236:239], a[152:155], v[72:75]
ds_read_b64_tr_b16 a[228:229], v20 offset:12288
v_exp_f32 v215, v215
v_exp_f32 v199, v199
v_mfma_f32_16x16x32_bf16 v[72:75], a[232:235], a[144:147], v[72:75]
s_waitcnt lgkmcnt(7)
ds_read_b64_tr_b16 a[230:231], v20 offset:14336
buffer_load_dwordx4 v29, s[40:43], s55 offen offset:1024 lds
v_fma_f32 v216, -v200, s58, -v63
v_fma_f32 v200, v200, s58, -v61
v_mfma_f32_16x16x32_bf16 v[80:83], a[240:243], a[144:147], v[80:83]
s_xor_b32 s55, s55, 131072
ds_read_b64_tr_b16 a[232:233], v21 offset:8192
v_fma_f32 v217, -v201, s58, -v63
v_fma_f32 v201, v201, s58, -v61
v_exp_f32 v216, v216
v_mfma_f32_16x16x32_bf16 v[80:83], a[244:247], a[152:155], v[80:83]
s_add_u32 m0, s52, 122880
ds_read_b64_tr_b16 a[234:235], v21 offset:10240
v_fma_f32 v218, -v202, s58, -v63
v_fma_f32 v202, v202, s58, -v61
v_exp_f32 v200, v200
v_mfma_f32_16x16x32_bf16 v[84:87], a[244:247], a[156:159], v[84:87]
s_load_dword s101, s[92:93], 53240
ds_read_b64_tr_b16 a[236:237], v21 offset:12288
buffer_load_dwordx4 v28, s[40:43], s55 offen offset:0 lds
v_exp_f32 v217, v217
v_mfma_f32_16x16x32_bf16 v[84:87], a[240:243], a[148:151], v[84:87]
s_waitcnt lgkmcnt(7)
ds_read_b64_tr_b16 a[238:239], v21 offset:14336
v_fma_f32 v219, -v203, s58, -v63
v_fma_f32 v203, v203, s58, -v61
v_exp_f32 v201, v201
v_mfma_f32_16x16x32_bf16 v[92:95], a[248:251], a[148:151], v[92:95]
ds_read_b64_tr_b16 a[240:241], v22 offset:8192
buffer_load_dwordx4 v29, s[40:43], s55 offen offset:1024 lds
v_exp_f32 v218, v218
v_mfma_f32_16x16x32_bf16 v[92:95], a[252:255], a[156:159], v[92:95]
s_xor_b32 s55, s55, 128
ds_read_b64_tr_b16 a[242:243], v22 offset:10240
v_fma_f32 v220, -v204, s58, -v63
v_fma_f32 v204, v204, s58, -v61
v_exp_f32 v202, v202
v_mfma_f32_16x16x32_bf16 v[88:91], a[252:255], a[152:155], v[88:91]
s_add_u32 m0, s52, 131072
ds_read_b64_tr_b16 a[244:245], v22 offset:12288
v_fma_f32 v221, -v205, s58, -v63
v_fma_f32 v205, v205, s58, -v61
v_exp_f32 v219, v219
v_mfma_f32_16x16x32_bf16 v[88:91], a[248:251], a[144:147], v[88:91]
s_waitcnt lgkmcnt(7)
ds_read_b64_tr_b16 a[246:247], v22 offset:14336
buffer_load_dwordx4 v28, s[40:43], s55 offen offset:0 lds
v_exp_f32 v203, v203
v_mfma_f32_16x16x32_bf16 v[64:67], a[224:227], a[0:3], v[64:67]
ds_read_b64_tr_b16 a[248:249], v23 offset:8192
v_fma_f32 v222, -v206, s58, -v63
v_fma_f32 v206, v206, s58, -v61
v_exp_f32 v220, v220
v_mfma_f32_16x16x32_bf16 v[64:67], a[228:231], a[8:11], v[64:67]
ds_read_b64_tr_b16 a[250:251], v23 offset:10240
buffer_load_dwordx4 v29, s[40:43], s55 offen offset:1024 lds
v_exp_f32 v204, v204
v_mfma_f32_16x16x32_bf16 v[68:71], a[228:231], a[12:15], v[68:71]
s_bfe_u32 s54, 0xa0a0c0f, s64
ds_read_b64_tr_b16 a[252:253], v23 offset:12288
v_fma_f32 v223, -v207, s58, -v63
v_fma_f32 v207, v207, s58, -v61
v_exp_f32 v221, v221
v_mfma_f32_16x16x32_bf16 v[68:71], a[224:227], a[4:7], v[68:71]
s_waitcnt lgkmcnt(7)
ds_read_b64_tr_b16 a[254:255], v23 offset:14336
s_lshl_b32 s54, s54, 13
v_exp_f32 v205, v205
v_add_f32 v60, v192, v193
v_mfma_f32_16x16x32_bf16 v[76:79], a[232:235], a[4:7], v[76:79]
s_add_u32 s54, s54, s63
ds_read_b64_tr_b16 a[224:225], v20 offset:16384
s_waitcnt vmcnt(21)
v_add_f32_dpp v48, v48, v48 row_ror:1 row_mask:0xf bank_mask:0xf
v_exp_f32 v222, v222
s_waitcnt vmcnt(20)
v_mfma_f32_16x16x16_bf16 v[128:131], v[38:39], v[96:97], 0
buffer_load_dwordx4 a[128:131], v1, s[24:27], s54 offen offset:0 sc1
v_mfma_f32_16x16x16_bf16 v[132:135], v[38:39], v[98:99], 0
s_waitcnt vmcnt(20)
v_exp_f32 v206, v206
v_mfma_f32_16x16x16_bf16 v[128:131], v[38:39], v[100:101], v[128:131]
v_exp_f32 v223, v223
v_mfma_f32_16x16x16_bf16 v[132:135], v[38:39], v[102:103], v[132:135]
s_waitcnt vmcnt(19)
buffer_load_dwordx4 a[132:135], v1, s[24:27], s54 offen offset:1024 sc1
v_mfma_f32_16x16x16_bf16 v[128:131], v[38:39], v[104:105], v[128:131]
v_exp_f32 v207, v207
v_mfma_f32_16x16x16_bf16 v[132:135], v[38:39], v[106:107], v[132:135]
s_waitcnt vmcnt(19)
v_add_f32_dpp v49, v49, v49 row_ror:1 row_mask:0xf bank_mask:0xf
v_add_f32_dpp v50, v50, v50 row_ror:1 row_mask:0xf bank_mask:0xf
v_mfma_f32_16x16x16_bf16 v[128:131], v[38:39], v[108:109], v[128:131]
v_add_f32_dpp v51, v51, v51 row_ror:1 row_mask:0xf bank_mask:0xf
v_add_f32_dpp v48, v48, v48 row_ror:2 row_mask:0xf bank_mask:0xf
v_mfma_f32_16x16x16_bf16 v[132:135], v[38:39], v[110:111], v[132:135]
s_waitcnt vmcnt(18)
buffer_load_dwordx4 a[136:139], v1, s[24:27], s54 offen offset:2048 sc1
v_mfma_f32_16x16x16_bf16 v[128:131], v[38:39], v[112:113], v[128:131]
s_lshr_b32 s6, s32, 1
v_add_f32_dpp v49, v49, v49 row_ror:2 row_mask:0xf bank_mask:0xf
v_add_f32_dpp v50, v50, v50 row_ror:2 row_mask:0xf bank_mask:0xf
v_mfma_f32_16x16x16_bf16 v[132:135], v[38:39], v[114:115], v[132:135]
s_lshl_b32 s6, s6, 10
v_add_f32_dpp v51, v51, v51 row_ror:2 row_mask:0xf bank_mask:0xf
v_add_f32_dpp v48, v48, v48 row_ror:4 row_mask:0xf bank_mask:0xf
s_waitcnt vmcnt(18)
v_mfma_f32_16x16x16_bf16 v[128:131], v[38:39], v[116:117], v[128:131]
s_and_b32 s7, s32, 1
v_add_f32_dpp v49, v49, v49 row_ror:4 row_mask:0xf bank_mask:0xf
v_add_f32_dpp v50, v50, v50 row_ror:4 row_mask:0xf bank_mask:0xf
v_mfma_f32_16x16x16_bf16 v[132:135], v[38:39], v[118:119], v[132:135]
s_lshl_b32 s7, s7, 3
v_add_f32_dpp v51, v51, v51 row_ror:4 row_mask:0xf bank_mask:0xf
v_cvt_pk_bf16_f32 v48, v48, v49
s_waitcnt vmcnt(17)
v_mfma_f32_16x16x16_bf16 v[128:131], v[38:39], v[120:121], v[128:131]
buffer_load_dwordx4 a[140:143], v1, s[24:27], s54 offen offset:3072 sc1
v_mfma_f32_16x16x16_bf16 v[132:135], v[38:39], v[122:123], v[132:135]
s_add_u32 s6, s6, s7
v_cvt_pk_bf16_f32 v49, v50, v51
v_add_f32 v62, v208, v209
s_waitcnt vmcnt(17)
v_mfma_f32_16x16x16_bf16 v[128:131], v[38:39], v[124:125], v[128:131]
s_add_u32 s6, s6, 157696
v_add_u32 v55, s6, v1
v_add_f32 v61, v200, v201
v_mfma_f32_16x16x16_bf16 v[132:135], v[38:39], v[126:127], v[132:135]
v_add_f32 v63, v216, v217
v_add_f32 v60, v60, v194
v_mfma_f32_16x16x32_bf16 v[76:79], a[236:239], a[12:15], v[76:79]
ds_read_b64_tr_b16 a[226:227], v20 offset:18432
buffer_load_dwordx4 a[144:147], v2, s[24:27], s54 offen offset:0 sc1
v_cvt_pk_bf16_f32 v96, v128, v129
v_cvt_pk_bf16_f32 v97, v130, v131
v_mfma_f32_16x16x32_bf16 v[72:75], a[236:239], a[8:11], v[72:75]
ds_read_b64_tr_b16 a[228:229], v20 offset:20480
ds_write_b64 v55, v[96:97]
v_mfma_f32_16x16x32_bf16 v[72:75], a[232:235], a[0:3], v[72:75]
s_waitcnt lgkmcnt(8)
ds_read_b64_tr_b16 a[230:231], v20 offset:22528
buffer_load_dwordx4 a[148:151], v2, s[24:27], s54 offen offset:1024 sc1
v_cvt_pk_bf16_f32 v98, v132, v133
v_cvt_pk_bf16_f32 v99, v134, v135
v_mfma_f32_16x16x32_bf16 v[80:83], a[240:243], a[0:3], v[80:83]
ds_read_b64_tr_b16 a[232:233], v21 offset:16384
v_add_f32 v62, v62, v210
v_add_f32 v61, v61, v202
v_add_f32 v63, v63, v218
v_add_f32 v60, v60, v195
v_mfma_f32_16x16x32_bf16 v[80:83], a[244:247], a[8:11], v[80:83]
ds_read_b64_tr_b16 a[234:235], v21 offset:18432
ds_write_b64 v55, v[98:99] offset:2048
v_mfma_f32_16x16x32_bf16 v[84:87], a[244:247], a[12:15], v[84:87]
ds_read_b64_tr_b16 a[236:237], v21 offset:20480
buffer_load_dwordx4 a[152:155], v2, s[24:27], s54 offen offset:2048 sc1
v_add_f32 v62, v62, v211
v_add_f32 v61, v61, v203
v_mfma_f32_16x16x32_bf16 v[84:87], a[240:243], a[4:7], v[84:87]
s_waitcnt lgkmcnt(9)
ds_read_b64_tr_b16 a[238:239], v21 offset:22528
v_add_f32 v63, v63, v219
v_add_f32 v60, v60, v196
v_add_f32 v62, v62, v212
v_add_f32 v61, v61, v204
v_mfma_f32_16x16x32_bf16 v[92:95], a[248:251], a[4:7], v[92:95]
ds_read_b64_tr_b16 a[240:241], v22 offset:16384
ds_write_b64 v55, v[48:49] offset:4096
v_mfma_f32_16x16x32_bf16 v[92:95], a[252:255], a[12:15], v[92:95]
ds_read_b64_tr_b16 a[242:243], v22 offset:18432
buffer_load_dwordx4 a[156:159], v2, s[24:27], s54 offen offset:3072 sc1
v_add_u32 v55, 157696, v1
v_add_f32 v63, v63, v220
v_mfma_f32_16x16x32_bf16 v[88:91], a[252:255], a[8:11], v[88:91]
s_bfe_u32 s55, 0xc0e0e0c, s64
ds_read_b64_tr_b16 a[244:245], v22 offset:20480
s_lshl_b32 s55, s55, 18
v_add_f32 v60, v60, v197
v_add_f32 v62, v62, v213
v_add_f32 v61, v61, v205
v_mfma_f32_16x16x32_bf16 v[88:91], a[248:251], a[0:3], v[88:91]
s_waitcnt lgkmcnt(9)
ds_read_b64_tr_b16 a[246:247], v22 offset:22528
s_add_u32 m0, s52, 139264
v_add_f32 v63, v63, v221
v_add_f32 v60, v60, v198
v_add_f32 v62, v62, v214
v_mfma_f32_16x16x32_bf16 a[192:195], a[224:227], a[0:3], a[192:195]
ds_read_b64_tr_b16 a[248:249], v23 offset:16384
buffer_load_dwordx4 v28, s[40:43], s55 offen offset:0 lds
v_add_f32 v61, v61, v206
v_add_f32 v63, v63, v222
v_mfma_f32_16x16x32_bf16 a[192:195], a[228:231], a[8:11], a[192:195]
ds_read_b64_tr_b16 a[250:251], v23 offset:18432
v_add_f32 v60, v60, v199
v_add_f32 v62, v62, v215
v_add_f32 v61, v61, v207
v_add_f32 v63, v63, v223
v_mfma_f32_16x16x32_bf16 a[196:199], a[228:231], a[12:15], a[196:199]
ds_read_b64_tr_b16 a[252:253], v23 offset:20480
buffer_load_dwordx4 v29, s[40:43], s55 offen offset:1024 lds
v_permlane16_swap_b32 v60, v61
v_mfma_f32_16x16x32_bf16 a[196:199], a[224:227], a[4:7], a[196:199]
s_waitcnt lgkmcnt(8)
ds_read_b64_tr_b16 a[254:255], v23 offset:22528
v_permlane16_swap_b32 v62, v63
v_add_f32 v60, v60, v61
v_add_f32 v62, v62, v63
v_mfma_f32_16x16x32_bf16 a[204:207], a[232:235], a[4:7], a[204:207]
s_xor_b32 s55, s55, 128
ds_read_b64_tr_b16 a[224:225], v20 offset:24576
ds_read_b64_tr_b16 a[226:227], v20 offset:26624
v_mfma_f32_16x16x32_bf16 a[204:207], a[236:239], a[12:15], a[204:207]
s_add_u32 m0, s52, 147456
v_permlane32_swap_b32 v60, v62
v_add_f32 v60, v60, v62
v_rcp_f32 v60, v60
v_mfma_f32_16x16x32_bf16 a[200:203], a[236:239], a[8:11], a[200:203]
buffer_load_dwordx4 v28, s[40:43], s55 offen offset:0 lds
v_mfma_f32_16x16x32_bf16 a[200:203], a[232:235], a[0:3], a[200:203]
s_waitcnt lgkmcnt(6)
ds_read_b64_tr_b16 a[228:229], v20 offset:28672
v_mov_b32 v62, v60
v_mfma_f32_16x16x32_bf16 a[208:211], a[240:243], a[0:3], a[208:211]
ds_read_b64_tr_b16 a[230:231], v20 offset:30720
ds_read_b64_tr_b16 a[232:233], v21 offset:24576
v_mfma_f32_16x16x32_bf16 a[208:211], a[244:247], a[8:11], a[208:211]
ds_read_b64_tr_b16 a[234:235], v21 offset:26624
buffer_load_dwordx4 v29, s[40:43], s55 offen offset:1024 lds
v_permlane32_swap_b32 v60, v62
v_mfma_f32_16x16x32_bf16 a[212:215], a[244:247], a[12:15], a[212:215]
s_bfe_u32 s54, 0xc0e0e0c, s64
ds_read_b64_tr_b16 a[236:237], v21 offset:28672
v_mov_b32 v61, v60
v_mov_b32 v63, v62
v_mfma_f32_16x16x32_bf16 a[212:215], a[240:243], a[4:7], a[212:215]
s_waitcnt lgkmcnt(7)
ds_read_b64_tr_b16 a[238:239], v21 offset:30720
s_lshl_b32 s54, s54, 13
v_permlane16_swap_b32 v60, v61
v_mul_f32 v192, v192, v60
v_mfma_f32_16x16x32_bf16 a[220:223], a[248:251], a[4:7], a[220:223]
s_add_u32 s54, s54, s63
ds_read_b64_tr_b16 a[240:241], v22 offset:24576
v_permlane16_swap_b32 v62, v63
v_mul_f32 v208, v208, v62
v_mul_f32 v193, v193, v60
v_mfma_f32_16x16x32_bf16 a[220:223], a[252:255], a[12:15], a[220:223]
ds_read_b64_tr_b16 a[242:243], v22 offset:26624
buffer_load_dwordx4 a[64:67], v1, s[24:27], s54 offen offset:0 sc1
v_mul_f32 v209, v209, v62
v_mul_f32 v194, v194, v60
v_mfma_f32_16x16x32_bf16 a[216:219], a[252:255], a[8:11], a[216:219]
ds_read_b64_tr_b16 a[244:245], v22 offset:28672
v_mul_f32 v210, v210, v62
v_mul_f32 v195, v195, v60
v_mul_f32 v211, v211, v62
v_mul_f32 v196, v196, v60
v_mfma_f32_16x16x32_bf16 a[216:219], a[248:251], a[0:3], a[216:219]
s_waitcnt lgkmcnt(7)
ds_read_b64_tr_b16 a[246:247], v22 offset:30720
buffer_load_dwordx4 a[68:71], v1, s[24:27], s54 offen offset:1024 sc1
v_mul_f32 v212, v212, v62
v_mul_f32 v197, v197, v60
v_mfma_f32_16x16x32_bf16 a[192:195], a[224:227], a[16:19], a[192:195]
ds_read_b64_tr_b16 a[248:249], v23 offset:24576
v_mul_f32 v213, v213, v62
v_mul_f32 v198, v198, v60
v_mul_f32 v214, v214, v62
v_mul_f32 v199, v199, v60
v_mfma_f32_16x16x32_bf16 a[192:195], a[228:231], a[24:27], a[192:195]
ds_read_b64_tr_b16 a[250:251], v23 offset:26624
v_mul_f32 v215, v215, v62
v_cvt_pk_bf16_f32 v240, v192, v193
v_cvt_pk_bf16_f32 v241, v194, v195
v_cvt_pk_bf16_f32 v242, v196, v197
v_mfma_f32_16x16x32_bf16 a[196:199], a[228:231], a[28:31], a[196:199]
ds_read_b64_tr_b16 a[252:253], v23 offset:28672
buffer_load_dwordx4 a[72:75], v1, s[24:27], s54 offen offset:2048 sc1
v_cvt_pk_bf16_f32 v243, v198, v199
v_cvt_pk_bf16_f32 v244, v208, v209
v_mfma_f32_16x16x32_bf16 a[196:199], a[224:227], a[20:23], a[196:199]
s_waitcnt lgkmcnt(7)
ds_read_b64_tr_b16 a[254:255], v23 offset:30720
v_cvt_pk_bf16_f32 v245, v210, v211
v_cvt_pk_bf16_f32 v246, v212, v213
v_cvt_pk_bf16_f32 v247, v214, v215
v_mul_f32 v200, v200, v61
v_mfma_f32_16x16x32_bf16 a[204:207], a[232:235], a[20:23], a[204:207]
ds_read_b64_tr_b16 a[224:225], v16 offset:0
buffer_load_dwordx4 a[76:79], v1, s[24:27], s54 offen offset:3072 sc1
v_mul_f32 v216, v216, v63
v_mul_f32 v201, v201, v61
v_mfma_f32_16x16x32_bf16 a[204:207], a[236:239], a[28:31], a[204:207]
ds_read_b64_tr_b16 a[226:227], v16 offset:2048
v_mul_f32 v217, v217, v63
v_mul_f32 v202, v202, v61
v_mul_f32 v218, v218, v63
v_mul_f32 v203, v203, v61
v_mfma_f32_16x16x32_bf16 a[200:203], a[236:239], a[24:27], a[200:203]
ds_read_b64_tr_b16 a[228:229], v16 offset:4096
v_mul_f32 v219, v219, v63
v_mul_f32 v204, v204, v61
v_mul_f32 v220, v220, v63
v_mul_f32 v205, v205, v61
v_mfma_f32_16x16x32_bf16 a[200:203], a[232:235], a[16:19], a[200:203]
s_waitcnt lgkmcnt(7)
ds_read_b64_tr_b16 a[230:231], v16 offset:6144
buffer_load_dwordx4 a[80:83], v2, s[24:27], s54 offen offset:0 sc1
v_mul_f32 v221, v221, v63
v_mul_f32 v206, v206, v61
v_mfma_f32_16x16x32_bf16 a[208:211], a[240:243], a[16:19], a[208:211]
ds_read_b64_tr_b16 a[232:233], v17 offset:0
v_mul_f32 v222, v222, v63
v_mul_f32 v207, v207, v61
v_mul_f32 v223, v223, v63
v_cvt_pk_bf16_f32 v248, v200, v201
v_mfma_f32_16x16x32_bf16 a[208:211], a[244:247], a[24:27], a[208:211]
pg_12:
s_cbranch_execz pg_back0
ds_read_b64_tr_b16 a[234:235], v17 offset:2048
buffer_load_dwordx4 a[84:87], v2, s[24:27], s54 offen offset:1024 sc1
v_cvt_pk_bf16_f32 v249, v202, v203
v_cvt_pk_bf16_f32 v250, v204, v205
v_mfma_f32_16x16x32_bf16 a[212:215], a[244:247], a[28:31], a[212:215]
ds_read_b64_tr_b16 a[236:237], v17 offset:4096
v_cvt_pk_bf16_f32 v251, v206, v207
v_cvt_pk_bf16_f32 v252, v216, v217
v_cvt_pk_bf16_f32 v253, v218, v219
v_cvt_pk_bf16_f32 v254, v220, v221
v_mfma_f32_16x16x32_bf16 a[212:215], a[240:243], a[20:23], a[212:215]
s_waitcnt lgkmcnt(7)
ds_read_b64_tr_b16 a[238:239], v17 offset:6144
v_cvt_pk_bf16_f32 v255, v222, v223
v_mfma_f32_16x16x32_bf16 a[220:223], a[248:251], a[20:23], a[220:223]
buffer_load_dwordx4 a[88:91], v2, s[24:27], s54 offen offset:2048 sc1
v_mfma_f32_16x16x32_bf16 a[220:223], a[252:255], a[28:31], a[220:223]
ds_read_b64_tr_b16 a[240:241], v18 offset:0
ds_read_b64_tr_b16 a[242:243], v18 offset:2048
v_mfma_f32_16x16x32_bf16 a[216:219], a[252:255], a[24:27], a[216:219]
ds_read_b64_tr_b16 a[244:245], v18 offset:4096
v_mfma_f32_16x16x32_bf16 a[216:219], a[248:251], a[16:19], a[216:219]
s_waitcnt lgkmcnt(7)
ds_read_b64_tr_b16 a[246:247], v18 offset:6144
v_mfma_f32_16x16x32_bf16 v[64:67], a[224:227], a[16:19], v[64:67]
ds_read_b64_tr_b16 a[248:249], v19 offset:0
v_mfma_f32_16x16x32_bf16 v[64:67], a[228:231], a[24:27], v[64:67]
buffer_load_dwordx4 a[92:95], v2, s[24:27], s54 offen offset:3072 sc1
v_mfma_f32_16x16x32_bf16 v[68:71], a[228:231], a[28:31], v[68:71]
s_bfe_u32 s54, 0xf0f0f0e, s64
ds_read_b64_tr_b16 a[250:251], v19 offset:2048
ds_read_b64_tr_b16 a[252:253], v19 offset:4096
v_mfma_f32_16x16x32_bf16 v[68:71], a[224:227], a[20:23], v[68:71]
s_waitcnt vmcnt(63) lgkmcnt(0)
s_barrier
v_mfma_f32_16x16x32_bf16 v[76:79], a[232:235], a[20:23], v[76:79]
s_lshl_b32 s54, s54, 13
ds_read_b128 v[144:147], v55 offset:4096
ds_read_b64_tr_b16 a[254:255], v19 offset:6144
v_mfma_f32_16x16x32_bf16 v[76:79], a[236:239], a[28:31], v[76:79]
s_add_u32 s54, s54, s63
ds_read_b64_tr_b16 a[224:225], v16 offset:8192
ds_read_b64_tr_b16 a[226:227], v16 offset:10240
v_mfma_f32_16x16x32_bf16 v[72:75], a[236:239], a[24:27], v[72:75]
buffer_load_dwordx4 a[96:99], v1, s[24:27], s54 offen offset:0 sc1
v_mfma_f32_16x16x32_bf16 v[72:75], a[232:235], a[16:19], v[72:75]
s_xor_b32 s55, s55, 131072
ds_read_b128 v[148:151], v55 offset:5120
ds_read_b64_tr_b16 a[228:229], v16 offset:12288
v_mfma_f32_16x16x32_bf16 v[80:83], a[240:243], a[16:19], v[80:83]
s_add_u32 m0, s52, 65536
ds_read_b64_tr_b16 a[230:231], v16 offset:14336
ds_read_b64_tr_b16 a[232:233], v17 offset:8192
v_mfma_f32_16x16x32_bf16 v[80:83], a[244:247], a[24:27], v[80:83]
buffer_load_dwordx4 v28, s[40:43], s55 offen offset:0 lds
v_mfma_f32_16x16x32_bf16 v[84:87], a[244:247], a[28:31], v[84:87]
ds_read_b128 v[128:131], v55 offset:0
ds_read_b64_tr_b16 a[234:235], v17 offset:10240
v_mfma_f32_16x16x32_bf16 v[84:87], a[240:243], a[20:23], v[84:87]
s_waitcnt lgkmcnt(8)
ds_read_b64_tr_b16 a[236:237], v17 offset:12288
ds_read_b64_tr_b16 a[238:239], v17 offset:14336
v_mfma_f32_16x16x32_bf16 v[92:95], a[248:251], a[20:23], v[92:95]
ds_read_b128 v[132:135], v55 offset:1024
ds_read_b64_tr_b16 a[240:241], v18 offset:8192
v_mfma_f32_16x16x32_bf16 v[92:95], a[252:255], a[28:31], v[92:95]
buffer_load_dwordx4 v29, s[40:43], s55 offen offset:1024 lds
v_mfma_f32_16x16x32_bf16 v[88:91], a[252:255], a[24:27], v[88:91]
s_xor_b32 s55, s55, 128
ds_read_b128 v[136:139], v55 offset:2048
ds_read_b64_tr_b16 a[242:243], v18 offset:10240
v_mfma_f32_16x16x32_bf16 v[88:91], a[248:251], a[16:19], v[88:91]
s_waitcnt lgkmcnt(9)
ds_read_b64_tr_b16 a[244:245], v18 offset:12288
ds_read_b64_tr_b16 a[246:247], v18 offset:14336
v_mfma_f32_16x16x32_bf16 v[64:67], a[224:227], a[32:35], v[64:67]
s_add_u32 m0, s52, 73728
ds_read_b128 v[140:143], v55 offset:3072
ds_read_b64_tr_b16 a[248:249], v19 offset:8192
v_mfma_f32_16x16x32_bf16 v[64:67], a[228:231], a[40:43], v[64:67]
ds_read_b64_tr_b16 a[250:251], v19 offset:10240
v_mfma_f32_16x16x32_bf16 v[68:71], a[228:231], a[44:47], v[68:71]
buffer_load_dwordx4 v28, s[40:43], s55 offen offset:0 lds
v_mfma_f32_16x16x32_bf16 v[68:71], a[224:227], a[36:39], v[68:71]
s_waitcnt lgkmcnt(9)
ds_read_b64_tr_b16 a[252:253], v19 offset:12288
ds_read_b64_tr_b16 a[254:255], v19 offset:14336
v_mfma_f32_16x16x32_bf16 v[76:79], a[232:235], a[36:39], v[76:79]
ds_read_b64_tr_b16 a[224:225], v16 offset:16384
v_mfma_f32_16x16x32_bf16 v[76:79], a[236:239], a[44:47], v[76:79]
s_add_u32 s5, s34, 112
ds_read_b64_tr_b16 a[226:227], v16 offset:18432
s_lshl_b32 s5, s5, 11
v_mfma_f32_16x16x32_bf16 v[200:203], v[144:147], v[224:227], 0
buffer_load_dwordx4 v29, s[40:43], s55 offen offset:1024 lds
v_mfma_f32_16x16x32_bf16 v[200:203], v[148:151], v[228:231], v[200:203]
s_bfe_u32 s55, 0xf0f0f0e, s64
s_lshl_b32 s55, s55, 18
s_add_u32 m0, s52, 81920
v_mfma_f32_16x16x32_bf16 v[192:195], v[128:131], v[224:227], 0
s_add_u32 s5, s5, s69
s_waitcnt lgkmcnt(12)
v_mfma_f32_16x16x32_bf16 v[192:195], v[132:135], v[228:231], v[192:195]
s_waitcnt lgkmcnt(10)
v_mfma_f32_16x16x32_bf16 v[196:199], v[136:139], v[224:227], 0
s_waitcnt lgkmcnt(6)
v_mfma_f32_16x16x32_bf16 v[196:199], v[140:143], v[228:231], v[196:199]
buffer_load_dwordx4 v28, s[40:43], s55 offen offset:0 lds
v_mfma_f32_16x16x32_bf16 v[212:215], v[144:147], v[232:235], 0
v_add_f32 v200, 0x358637bd, v200
v_mfma_f32_16x16x32_bf16 v[212:215], v[148:151], v[236:239], v[212:215]
v_rcp_f32 v200, v200
v_mfma_f32_16x16x32_bf16 v[204:207], v[128:131], v[232:235], 0
v_mfma_f32_16x16x32_bf16 v[204:207], v[132:135], v[236:239], v[204:207]
buffer_load_dwordx4 v29, s[40:43], s55 offen offset:1024 lds
v_mfma_f32_16x16x32_bf16 v[208:211], v[136:139], v[232:235], 0
s_xor_b32 s55, s55, 128
v_mul_f32 v192, v192, v200
v_mul_f32 v193, v193, v200
v_mfma_f32_16x16x32_bf16 v[208:211], v[140:143], v[236:239], v[208:211]
s_add_u32 m0, s52, 90112
v_add_f32 v212, 0x358637bd, v212
v_mul_f32 v194, v194, v200
v_mfma_f32_16x16x32_bf16 v[104:107], v[144:147], v[240:243], 0
v_rcp_f32 v212, v212
v_mfma_f32_16x16x32_bf16 v[104:107], v[148:151], v[244:247], v[104:107]
v_mul_f32 v195, v195, v200
v_mul_f32 v196, v196, v200
v_mfma_f32_16x16x32_bf16 v[96:99], v[128:131], v[240:243], 0
buffer_load_dwordx4 v28, s[40:43], s55 offen offset:0 lds
v_mfma_f32_16x16x32_bf16 v[96:99], v[132:135], v[244:247], v[96:99]
v_mul_f32 v197, v197, v200
v_mul_f32 v198, v198, v200
v_mfma_f32_16x16x32_bf16 v[100:103], v[136:139], v[240:243], 0
v_add_f32 v104, 0x358637bd, v104
v_mul_f32 v199, v199, v200
v_mfma_f32_16x16x32_bf16 v[100:103], v[140:143], v[244:247], v[100:103]
v_rcp_f32 v104, v104
v_mfma_f32_16x16x32_bf16 v[116:119], v[144:147], v[248:251], 0
buffer_load_dwordx4 v29, s[40:43], s55 offen offset:1024 lds
v_mfma_f32_16x16x32_bf16 v[116:119], v[148:151], v[252:255], v[116:119]
v_cvt_pk_bf16_f32 v192, v192, v193
v_cvt_pk_bf16_f32 v193, v194, v195
v_mfma_f32_16x16x32_bf16 v[108:111], v[128:131], v[248:251], 0
v_cvt_pk_bf16_f32 v194, v196, v197
v_cvt_pk_bf16_f32 v195, v198, v199
v_mfma_f32_16x16x32_bf16 v[108:111], v[132:135], v[252:255], v[108:111]
v_mul_f32 v204, v204, v212
v_mul_f32 v205, v205, v212
v_mfma_f32_16x16x32_bf16 v[112:115], v[136:139], v[248:251], 0
v_add_f32 v116, 0x358637bd, v116
v_mul_f32 v206, v206, v212
v_mfma_f32_16x16x32_bf16 v[112:115], v[140:143], v[252:255], v[112:115]
buffer_store_dwordx4 v[192:195], v1, s[24:27], s5 offen offset:0 sc1
v_rcp_f32 v116, v116
v_mul_f32 v207, v207, v212
v_mfma_f32_16x16x32_bf16 v[72:75], a[236:239], a[40:43], v[72:75]
ds_read_b64_tr_b16 a[228:229], v16 offset:20480
v_mul_f32 v208, v208, v212
v_mul_f32 v209, v209, v212
v_mul_f32 v210, v210, v212
v_mul_f32 v211, v211, v212
v_mfma_f32_16x16x32_bf16 v[72:75], a[232:235], a[32:35], v[72:75]
ds_read_b64_tr_b16 a[230:231], v16 offset:22528
v_cvt_pk_bf16_f32 v204, v204, v205
v_cvt_pk_bf16_f32 v205, v206, v207
v_cvt_pk_bf16_f32 v206, v208, v209
v_cvt_pk_bf16_f32 v207, v210, v211
v_mfma_f32_16x16x32_bf16 v[80:83], a[240:243], a[32:35], v[80:83]
buffer_store_dwordx4 v[204:207], v1, s[24:27], s5 offen offset:1024 sc1
buffer_load_dwordx4 a[100:103], v1, s[24:27], s54 offen offset:1024 sc1
v_mul_f32 v96, v96, v104
v_mfma_f32_16x16x32_bf16 v[80:83], a[244:247], a[40:43], v[80:83]
s_add_u32 s5, s5, 294912
ds_read_b64_tr_b16 a[232:233], v17 offset:16384
v_mul_f32 v97, v97, v104
v_mul_f32 v98, v98, v104
v_mul_f32 v99, v99, v104
v_mul_f32 v100, v100, v104
v_mfma_f32_16x16x32_bf16 v[84:87], a[244:247], a[44:47], v[84:87]
ds_read_b64_tr_b16 a[234:235], v17 offset:18432
v_mul_f32 v101, v101, v104
v_mul_f32 v102, v102, v104
v_mul_f32 v103, v103, v104
v_cvt_pk_bf16_f32 v96, v96, v97
v_mfma_f32_16x16x32_bf16 v[84:87], a[240:243], a[36:39], v[84:87]
s_waitcnt lgkmcnt(6)
ds_read_b64_tr_b16 a[236:237], v17 offset:20480
buffer_load_dwordx4 a[104:107], v1, s[24:27], s54 offen offset:2048 sc1
v_cvt_pk_bf16_f32 v97, v98, v99
v_cvt_pk_bf16_f32 v98, v100, v101
v_mfma_f32_16x16x32_bf16 v[92:95], a[248:251], a[36:39], v[92:95]
ds_read_b64_tr_b16 a[238:239], v17 offset:22528
v_cvt_pk_bf16_f32 v99, v102, v103
v_mul_f32 v108, v108, v116
v_mul_f32 v109, v109, v116
v_mul_f32 v110, v110, v116
v_mfma_f32_16x16x32_bf16 v[92:95], a[252:255], a[44:47], v[92:95]
ds_read_b64_tr_b16 a[240:241], v18 offset:16384
v_mul_f32 v111, v111, v116
v_mul_f32 v112, v112, v116
v_mul_f32 v113, v113, v116
v_mul_f32 v114, v114, v116
v_mfma_f32_16x16x32_bf16 v[88:91], a[252:255], a[40:43], v[88:91]
buffer_store_dwordx4 v[96:99], v1, s[24:27], s5 offen offset:0 sc1
ds_read_b64_tr_b16 a[242:243], v18 offset:18432
v_mul_f32 v115, v115, v116
v_cvt_pk_bf16_f32 v108, v108, v109
v_mfma_f32_16x16x32_bf16 v[88:91], a[248:251], a[32:35], v[88:91]
s_waitcnt lgkmcnt(6)
ds_read_b64_tr_b16 a[244:245], v18 offset:20480
v_cvt_pk_bf16_f32 v109, v110, v111
v_cvt_pk_bf16_f32 v110, v112, v113
v_cvt_pk_bf16_f32 v111, v114, v115
v_mfma_f32_16x16x32_bf16 a[192:195], a[224:227], a[32:35], a[192:195]
ds_read_b64_tr_b16 a[246:247], v18 offset:22528
ds_read_b64_tr_b16 a[248:249], v19 offset:16384
v_mfma_f32_16x16x32_bf16 a[192:195], a[228:231], a[40:43], a[192:195]
buffer_store_dwordx4 v[108:111], v1, s[24:27], s5 offen offset:1024 sc1
buffer_load_dwordx4 a[108:111], v1, s[24:27], s54 offen offset:3072 sc1
s_add_u32 s5, s65, 32768
v_mfma_f32_16x16x32_bf16 a[196:199], a[228:231], a[44:47], a[196:199]
ds_read_b64_tr_b16 a[250:251], v19 offset:18432
ds_read_b64_tr_b16 a[252:253], v19 offset:20480
v_mfma_f32_16x16x32_bf16 a[196:199], a[224:227], a[36:39], a[196:199]
s_waitcnt lgkmcnt(7)
ds_read_b64_tr_b16 a[254:255], v19 offset:22528
v_mfma_f32_16x16x32_bf16 a[204:207], a[232:235], a[36:39], a[204:207]
ds_read_b64_tr_b16 a[224:225], v16 offset:24576
v_mfma_f32_16x16x32_bf16 a[204:207], a[236:239], a[44:47], a[204:207]
buffer_load_dwordx4 a[112:115], v2, s[24:27], s54 offen offset:0 sc1
v_mfma_f32_16x16x32_bf16 a[200:203], a[236:239], a[40:43], a[200:203]
ds_read_b64_tr_b16 a[226:227], v16 offset:26624
ds_read_b64_tr_b16 a[228:229], v16 offset:28672
v_mfma_f32_16x16x32_bf16 a[200:203], a[232:235], a[32:35], a[200:203]
s_waitcnt lgkmcnt(7)
ds_read_b64_tr_b16 a[230:231], v16 offset:30720
v_mfma_f32_16x16x32_bf16 a[208:211], a[240:243], a[32:35], a[208:211]
ds_read_b64_tr_b16 a[232:233], v17 offset:24576
v_mfma_f32_16x16x32_bf16 a[208:211], a[244:247], a[40:43], a[208:211]
ds_read_b64_tr_b16 a[234:235], v17 offset:26624
v_mfma_f32_16x16x32_bf16 a[212:215], a[244:247], a[44:47], a[212:215]
buffer_load_dwordx4 a[116:119], v2, s[24:27], s54 offen offset:1024 sc1
v_mfma_f32_16x16x32_bf16 a[212:215], a[240:243], a[36:39], a[212:215]
s_waitcnt lgkmcnt(6)
ds_read_b64_tr_b16 a[236:237], v17 offset:28672
ds_read_b64_tr_b16 a[238:239], v17 offset:30720
v_mfma_f32_16x16x32_bf16 a[220:223], a[248:251], a[36:39], a[220:223]
ds_read_b64_tr_b16 a[240:241], v18 offset:24576
v_mfma_f32_16x16x32_bf16 a[220:223], a[252:255], a[44:47], a[220:223]
ds_read_b64_tr_b16 a[242:243], v18 offset:26624
v_mfma_f32_16x16x32_bf16 a[216:219], a[252:255], a[40:43], a[216:219]
buffer_load_dwordx4 a[120:123], v2, s[24:27], s54 offen offset:2048 sc1
v_mfma_f32_16x16x32_bf16 a[216:219], a[248:251], a[32:35], a[216:219]
s_waitcnt lgkmcnt(6)
ds_read_b64_tr_b16 a[244:245], v18 offset:28672
ds_read_b64_tr_b16 a[246:247], v18 offset:30720
v_mfma_f32_16x16x32_bf16 a[192:195], a[224:227], a[48:51], a[192:195]
ds_read_b64_tr_b16 a[248:249], v19 offset:24576
v_mfma_f32_16x16x32_bf16 a[192:195], a[228:231], a[56:59], a[192:195]
ds_read_b64_tr_b16 a[250:251], v19 offset:26624
v_mfma_f32_16x16x32_bf16 a[196:199], a[228:231], a[60:63], a[196:199]
ds_read_b64_tr_b16 a[252:253], v19 offset:28672
v_mfma_f32_16x16x32_bf16 a[196:199], a[224:227], a[52:55], a[196:199]
s_waitcnt lgkmcnt(7)
buffer_load_dwordx4 a[124:127], v2, s[24:27], s54 offen offset:3072 sc1
v_mfma_f32_16x16x32_bf16 a[204:207], a[232:235], a[52:55], a[204:207]
ds_read_b64_tr_b16 a[254:255], v19 offset:30720
ds_read_b64_tr_b16 a[224:225], v16 offset:32768
v_mfma_f32_16x16x32_bf16 a[204:207], a[236:239], a[60:63], a[204:207]
ds_read_b64_tr_b16 a[226:227], v16 offset:34816
v_mfma_f32_16x16x32_bf16 a[200:203], a[236:239], a[56:59], a[200:203]
ds_read_b64_tr_b16 a[228:229], v16 offset:36864
v_mfma_f32_16x16x32_bf16 a[200:203], a[232:235], a[48:51], a[200:203]
s_waitcnt lgkmcnt(7)
ds_read_b64_tr_b16 a[230:231], v16 offset:38912
v_mfma_f32_16x16x32_bf16 a[208:211], a[240:243], a[48:51], a[208:211]
ds_read_b64_tr_b16 a[232:233], v17 offset:32768
v_mfma_f32_16x16x32_bf16 a[208:211], a[244:247], a[56:59], a[208:211]
ds_read_b64_tr_b16 a[234:235], v17 offset:34816
v_mfma_f32_16x16x32_bf16 a[212:215], a[244:247], a[60:63], a[212:215]
ds_read_b64_tr_b16 a[236:237], v17 offset:36864
v_mfma_f32_16x16x32_bf16 a[212:215], a[240:243], a[52:55], a[212:215]
s_waitcnt lgkmcnt(7)
ds_read_b64_tr_b16 a[238:239], v17 offset:38912
v_mfma_f32_16x16x32_bf16 a[220:223], a[248:251], a[52:55], a[220:223]
ds_read_b64_tr_b16 a[240:241], v18 offset:32768
v_mfma_f32_16x16x32_bf16 a[220:223], a[252:255], a[60:63], a[220:223]
ds_read_b64_tr_b16 a[242:243], v18 offset:34816
v_mfma_f32_16x16x32_bf16 a[216:219], a[252:255], a[56:59], a[216:219]
ds_read_b64_tr_b16 a[244:245], v18 offset:36864
v_mfma_f32_16x16x32_bf16 a[216:219], a[248:251], a[48:51], a[216:219]
s_waitcnt lgkmcnt(7)
ds_read_b64_tr_b16 a[246:247], v18 offset:38912
v_mfma_f32_16x16x32_bf16 v[64:67], a[224:227], a[48:51], v[64:67]
s_load_dword s101, s[92:93], 57336
ds_read_b64_tr_b16 a[248:249], v19 offset:32768
v_mfma_f32_16x16x32_bf16 v[64:67], a[228:231], a[56:59], v[64:67]
ds_read_b64_tr_b16 a[250:251], v19 offset:34816
v_mfma_f32_16x16x32_bf16 v[68:71], a[228:231], a[60:63], v[68:71]
ds_read_b64_tr_b16 a[252:253], v19 offset:36864
v_mfma_f32_16x16x32_bf16 v[68:71], a[224:227], a[52:55], v[68:71]
s_waitcnt vmcnt(63) lgkmcnt(7)
s_barrier
v_mfma_f32_16x16x32_bf16 v[76:79], a[232:235], a[52:55], v[76:79]
s_xor_b32 s55, s55, 131072
ds_read_b64_tr_b16 a[254:255], v19 offset:38912
ds_read_b64_tr_b16 a[224:225], v16 offset:40960
v_mfma_f32_16x16x32_bf16 v[76:79], a[236:239], a[60:63], v[76:79]
s_add_u32 m0, s52, 0
ds_read_b64_tr_b16 a[226:227], v16 offset:43008
v_mfma_f32_16x16x32_bf16 v[72:75], a[236:239], a[56:59], v[72:75]
buffer_load_dwordx4 v28, s[40:43], s55 offen offset:0 lds
v_mfma_f32_16x16x32_bf16 v[72:75], a[232:235], a[48:51], v[72:75]
s_waitcnt lgkmcnt(6)
ds_read_b64_tr_b16 a[228:229], v16 offset:45056
ds_read_b64_tr_b16 a[230:231], v16 offset:47104
v_mfma_f32_16x16x32_bf16 v[80:83], a[240:243], a[48:51], v[80:83]
ds_read_b64_tr_b16 a[232:233], v17 offset:40960
v_mfma_f32_16x16x32_bf16 v[80:83], a[244:247], a[56:59], v[80:83]
buffer_load_dwordx4 v29, s[40:43], s55 offen offset:1024 lds
v_mfma_f32_16x16x32_bf16 v[84:87], a[244:247], a[60:63], v[84:87]
s_xor_b32 s55, s55, 128
ds_read_b64_tr_b16 a[234:235], v17 offset:43008
ds_read_b64_tr_b16 a[236:237], v17 offset:45056
v_mfma_f32_16x16x32_bf16 v[84:87], a[240:243], a[52:55], v[84:87]
s_waitcnt lgkmcnt(7)
ds_read_b64_tr_b16 a[238:239], v17 offset:47104
s_add_u32 m0, s52, 8192
v_mfma_f32_16x16x32_bf16 v[92:95], a[248:251], a[52:55], v[92:95]
ds_read_b64_tr_b16 a[240:241], v18 offset:40960
v_mfma_f32_16x16x32_bf16 v[92:95], a[252:255], a[60:63], v[92:95]
buffer_load_dwordx4 v28, s[40:43], s55 offen offset:0 lds
v_mfma_f32_16x16x32_bf16 v[88:91], a[252:255], a[56:59], v[88:91]
ds_read_b64_tr_b16 a[242:243], v18 offset:43008
ds_read_b64_tr_b16 a[244:245], v18 offset:45056
v_mfma_f32_16x16x32_bf16 v[88:91], a[248:251], a[48:51], v[88:91]
s_waitcnt vmcnt(51) lgkmcnt(7)
ds_read_b64_tr_b16 a[246:247], v18 offset:47104
v_mfma_f32_16x16x32_bf16 v[64:67], a[224:227], a[160:163], v[64:67]
ds_read_b64_tr_b16 a[248:249], v19 offset:40960
v_mfma_f32_16x16x32_bf16 v[64:67], a[228:231], a[168:171], v[64:67]
ds_read_b64_tr_b16 a[250:251], v19 offset:43008
v_mfma_f32_16x16x32_bf16 v[68:71], a[228:231], a[172:175], v[68:71]
buffer_load_dwordx4 v29, s[40:43], s55 offen offset:1024 lds
v_mfma_f32_16x16x32_bf16 v[68:71], a[224:227], a[164:167], v[68:71]
s_waitcnt lgkmcnt(6)
ds_read_b64_tr_b16 a[252:253], v19 offset:45056
ds_read_b64_tr_b16 a[254:255], v19 offset:47104
v_mfma_f32_16x16x32_bf16 v[76:79], a[232:235], a[164:167], v[76:79]
s_bfe_u32 s55, 0x10141210, s64
ds_read_b64_tr_b16 a[224:225], v16 offset:49152
s_lshl_b32 s55, s55, 18
v_mfma_f32_16x16x32_bf16 v[76:79], a[236:239], a[172:175], v[76:79]
s_xor_b32 s55, s55, 128
ds_read_b64_tr_b16 a[226:227], v16 offset:51200
s_add_u32 m0, s52, 16384
v_mfma_f32_16x16x32_bf16 v[72:75], a[236:239], a[168:171], v[72:75]
buffer_load_dwordx4 v28, s[40:43], s55 offen offset:0 lds
v_mfma_f32_16x16x32_bf16 v[72:75], a[232:235], a[160:163], v[72:75]
s_waitcnt lgkmcnt(6)
ds_read_b64_tr_b16 a[228:229], v16 offset:53248
ds_read_b64_tr_b16 a[230:231], v16 offset:55296
v_mfma_f32_16x16x32_bf16 v[80:83], a[240:243], a[160:163], v[80:83]
ds_read_b64_tr_b16 a[232:233], v17 offset:49152
v_mfma_f32_16x16x32_bf16 v[80:83], a[244:247], a[168:171], v[80:83]
ds_read_b64_tr_b16 a[234:235], v17 offset:51200
v_mfma_f32_16x16x32_bf16 v[84:87], a[244:247], a[172:175], v[84:87]
ds_read_b64_tr_b16 a[236:237], v17 offset:53248
v_mfma_f32_16x16x32_bf16 v[84:87], a[240:243], a[164:167], v[84:87]
s_waitcnt lgkmcnt(7)
buffer_load_dwordx4 v29, s[40:43], s55 offen offset:1024 lds
v_mfma_f32_16x16x32_bf16 v[92:95], a[248:251], a[164:167], v[92:95]
s_xor_b32 s55, s55, 131072
ds_read_b64_tr_b16 a[238:239], v17 offset:55296
ds_read_b64_tr_b16 a[240:241], v18 offset:49152
v_mfma_f32_16x16x32_bf16 v[92:95], a[252:255], a[172:175], v[92:95]
s_add_u32 m0, s52, 24576
ds_read_b64_tr_b16 a[242:243], v18 offset:51200
s_waitcnt vmcnt(11)
v_mfma_f32_16x16x32_bf16 v[88:91], a[252:255], a[168:171], v[88:91]
buffer_store_dword v32, v30, s[24:27], s61 offen offset:256 sc1
ds_read_b64_tr_b16 a[244:245], v18 offset:53248
v_mfma_f32_16x16x32_bf16 v[88:91], a[248:251], a[160:163], v[88:91]
s_waitcnt lgkmcnt(7)
ds_read_b64_tr_b16 a[246:247], v18 offset:55296
v_mfma_f32_16x16x32_bf16 a[192:195], a[224:227], a[160:163], a[192:195]
ds_read_b64_tr_b16 a[248:249], v19 offset:49152
v_mfma_f32_16x16x32_bf16 a[192:195], a[228:231], a[168:171], a[192:195]
ds_read_b64_tr_b16 a[250:251], v19 offset:51200
v_mfma_f32_16x16x32_bf16 a[196:199], a[228:231], a[172:175], a[196:199]
buffer_load_dwordx4 v28, s[40:43], s55 offen offset:0 lds
v_mfma_f32_16x16x32_bf16 a[196:199], a[224:227], a[164:167], a[196:199]
s_waitcnt lgkmcnt(6)
ds_read_b64_tr_b16 a[252:253], v19 offset:53248
ds_read_b64_tr_b16 a[254:255], v19 offset:55296
v_mfma_f32_16x16x32_bf16 a[204:207], a[232:235], a[164:167], a[204:207]
ds_read_b64_tr_b16 a[224:225], v16 offset:57344
v_mfma_f32_16x16x32_bf16 a[204:207], a[236:239], a[172:175], a[204:207]
buffer_load_dwordx4 v29, s[40:43], s55 offen offset:1024 lds
v_mfma_f32_16x16x32_bf16 a[200:203], a[236:239], a[168:171], a[200:203]
ds_read_b64_tr_b16 a[226:227], v16 offset:59392
ds_read_b64_tr_b16 a[228:229], v16 offset:61440
v_mfma_f32_16x16x32_bf16 a[200:203], a[232:235], a[160:163], a[200:203]
s_waitcnt lgkmcnt(7)
ds_read_b64_tr_b16 a[230:231], v16 offset:63488
v_mfma_f32_16x16x32_bf16 a[208:211], a[240:243], a[160:163], a[208:211]
ds_read_b64_tr_b16 a[232:233], v17 offset:57344
v_mfma_f32_16x16x32_bf16 a[208:211], a[244:247], a[168:171], a[208:211]
ds_read_b64_tr_b16 a[234:235], v17 offset:59392
v_mfma_f32_16x16x32_bf16 a[212:215], a[244:247], a[172:175], a[212:215]
ds_read_b64_tr_b16 a[236:237], v17 offset:61440
v_mfma_f32_16x16x32_bf16 a[212:215], a[240:243], a[164:167], a[212:215]
s_waitcnt lgkmcnt(7)
ds_read_b64_tr_b16 a[238:239], v17 offset:63488
v_mfma_f32_16x16x32_bf16 a[220:223], a[248:251], a[164:167], a[220:223]
ds_read_b64_tr_b16 a[240:241], v18 offset:57344
v_mfma_f32_16x16x32_bf16 a[220:223], a[252:255], a[172:175], a[220:223]
ds_read_b64_tr_b16 a[242:243], v18 offset:59392
v_mfma_f32_16x16x32_bf16 a[216:219], a[252:255], a[168:171], a[216:219]
ds_read_b64_tr_b16 a[244:245], v18 offset:61440
v_mfma_f32_16x16x32_bf16 a[216:219], a[248:251], a[160:163], a[216:219]
s_waitcnt lgkmcnt(7)
buffer_load_dword v33, v31, s[24:27], s62 offen offset:128 sc1
v_mfma_f32_16x16x32_bf16 a[192:195], a[224:227], a[176:179], a[192:195]
ds_read_b64_tr_b16 a[246:247], v18 offset:63488
ds_read_b64_tr_b16 a[248:249], v19 offset:57344
v_mfma_f32_16x16x32_bf16 a[192:195], a[228:231], a[184:187], a[192:195]
ds_read_b64_tr_b16 a[250:251], v19 offset:59392
v_mfma_f32_16x16x32_bf16 a[196:199], a[228:231], a[188:191], a[196:199]
ds_read_b64_tr_b16 a[252:253], v19 offset:61440
v_mfma_f32_16x16x32_bf16 a[196:199], a[224:227], a[180:183], a[196:199]
s_waitcnt lgkmcnt(7)
ds_read_b64_tr_b16 a[254:255], v19 offset:63488
v_mfma_f32_16x16x32_bf16 a[204:207], a[232:235], a[180:183], a[204:207]
ds_read_b64_tr_b16 a[224:225], v20 offset:32768
v_mfma_f32_16x16x32_bf16 a[204:207], a[236:239], a[188:191], a[204:207]
ds_read_b64_tr_b16 a[226:227], v20 offset:34816
v_mfma_f32_16x16x32_bf16 a[200:203], a[236:239], a[184:187], a[200:203]
ds_read_b64_tr_b16 a[228:229], v20 offset:36864
v_mfma_f32_16x16x32_bf16 a[200:203], a[232:235], a[176:179], a[200:203]
s_waitcnt lgkmcnt(7)
ds_read_b64_tr_b16 a[230:231], v20 offset:38912
v_mfma_f32_16x16x32_bf16 a[208:211], a[240:243], a[176:179], a[208:211]
ds_read_b64_tr_b16 a[232:233], v21 offset:32768
v_mfma_f32_16x16x32_bf16 a[208:211], a[244:247], a[184:187], a[208:211]
ds_read_b64_tr_b16 a[234:235], v21 offset:34816
v_mfma_f32_16x16x32_bf16 a[212:215], a[244:247], a[188:191], a[212:215]
ds_read_b64_tr_b16 a[236:237], v21 offset:36864
v_mfma_f32_16x16x32_bf16 a[212:215], a[240:243], a[180:183], a[212:215]
s_waitcnt lgkmcnt(7)
ds_read_b64_tr_b16 a[238:239], v21 offset:38912
v_mfma_f32_16x16x32_bf16 a[220:223], a[248:251], a[180:183], a[220:223]
ds_read_b64_tr_b16 a[240:241], v22 offset:32768
v_mfma_f32_16x16x32_bf16 a[220:223], a[252:255], a[188:191], a[220:223]
ds_read_b64_tr_b16 a[242:243], v22 offset:34816
v_mfma_f32_16x16x32_bf16 a[216:219], a[252:255], a[184:187], a[216:219]
ds_read_b64_tr_b16 a[244:245], v22 offset:36864
v_mfma_f32_16x16x32_bf16 a[216:219], a[248:251], a[176:179], a[216:219]
s_waitcnt lgkmcnt(7)
ds_read_b64_tr_b16 a[246:247], v22 offset:38912
v_mfma_f32_16x16x32_bf16 v[64:67], a[224:227], a[176:179], v[64:67]
ds_read_b64_tr_b16 a[248:249], v23 offset:32768
v_mfma_f32_16x16x32_bf16 v[64:67], a[228:231], a[184:187], v[64:67]
ds_read_b64_tr_b16 a[250:251], v23 offset:34816
v_mfma_f32_16x16x32_bf16 v[68:71], a[228:231], a[188:191], v[68:71]
ds_read_b64_tr_b16 a[252:253], v23 offset:36864
v_mfma_f32_16x16x32_bf16 v[68:71], a[224:227], a[180:183], v[68:71]
s_waitcnt vmcnt(50) lgkmcnt(7)
s_barrier
v_mfma_f32_16x16x32_bf16 v[76:79], a[232:235], a[180:183], v[76:79]
s_bfe_u32 s55, 0x16101012, s64
ds_read_b64_tr_b16 a[254:255], v23 offset:38912
ds_read_b64_tr_b16 a[224:225], v20 offset:40960
v_mfma_f32_16x16x32_bf16 v[76:79], a[236:239], a[188:191], v[76:79]
s_lshl_b32 s55, s55, 18
ds_read_b64_tr_b16 a[226:227], v20 offset:43008
s_xor_b32 s55, s55, 128
v_mfma_f32_16x16x32_bf16 v[72:75], a[236:239], a[184:187], v[72:75]
s_add_u32 m0, s52, 32768
ds_read_b64_tr_b16 a[228:229], v20 offset:45056
v_mfma_f32_16x16x32_bf16 v[72:75], a[232:235], a[176:179], v[72:75]
s_waitcnt lgkmcnt(7)
buffer_load_dwordx4 v28, s[40:43], s55 offen offset:0 lds
v_mfma_f32_16x16x32_bf16 v[80:83], a[240:243], a[176:179], v[80:83]
ds_read_b64_tr_b16 a[230:231], v20 offset:47104
ds_read_b64_tr_b16 a[232:233], v21 offset:40960
v_mfma_f32_16x16x32_bf16 v[80:83], a[244:247], a[184:187], v[80:83]
ds_read_b64_tr_b16 a[234:235], v21 offset:43008
v_mfma_f32_16x16x32_bf16 v[84:87], a[244:247], a[188:191], v[84:87]
buffer_load_dwordx4 v29, s[40:43], s55 offen offset:1024 lds
v_mfma_f32_16x16x32_bf16 v[84:87], a[240:243], a[180:183], v[84:87]
s_waitcnt lgkmcnt(6)
ds_read_b64_tr_b16 a[236:237], v21 offset:45056
ds_read_b64_tr_b16 a[238:239], v21 offset:47104
v_mfma_f32_16x16x32_bf16 v[92:95], a[248:251], a[180:183], v[92:95]
s_xor_b32 s55, s55, 131072
ds_read_b64_tr_b16 a[240:241], v22 offset:40960
s_add_u32 m0, s52, 40960
v_mfma_f32_16x16x32_bf16 v[92:95], a[252:255], a[188:191], v[92:95]
ds_read_b64_tr_b16 a[242:243], v22 offset:43008
v_mfma_f32_16x16x32_bf16 v[88:91], a[252:255], a[184:187], v[88:91]
buffer_load_dwordx4 v28, s[40:43], s55 offen offset:0 lds
v_mfma_f32_16x16x32_bf16 v[88:91], a[248:251], a[176:179], v[88:91]
s_waitcnt lgkmcnt(6)
ds_read_b64_tr_b16 a[244:245], v22 offset:45056
ds_read_b64_tr_b16 a[246:247], v22 offset:47104
v_mfma_f32_16x16x32_bf16 v[64:67], a[224:227], a[128:131], v[64:67]
ds_read_b64_tr_b16 a[248:249], v23 offset:40960
v_mfma_f32_16x16x32_bf16 v[64:67], a[228:231], a[136:139], v[64:67]
ds_read_b64_tr_b16 a[250:251], v23 offset:43008
v_mfma_f32_16x16x32_bf16 v[68:71], a[228:231], a[140:143], v[68:71]
ds_read_b64_tr_b16 a[252:253], v23 offset:45056
v_mfma_f32_16x16x32_bf16 v[68:71], a[224:227], a[132:135], v[68:71]
s_waitcnt lgkmcnt(7)
buffer_load_dwordx4 v29, s[40:43], s55 offen offset:1024 lds
v_mfma_f32_16x16x32_bf16 v[76:79], a[232:235], a[132:135], v[76:79]
s_bfe_u32 s55, 0x12121418, s64
ds_read_b64_tr_b16 a[254:255], v23 offset:47104
ds_read_b64_tr_b16 a[224:225], v20 offset:49152
v_mfma_f32_16x16x32_bf16 v[76:79], a[236:239], a[140:143], v[76:79]
s_lshl_b32 s55, s55, 18
ds_read_b64_tr_b16 a[226:227], v20 offset:51200
s_xor_b32 s55, s55, 128
v_mfma_f32_16x16x32_bf16 v[72:75], a[236:239], a[136:139], v[72:75]
s_add_u32 m0, s52, 49152
ds_read_b64_tr_b16 a[228:229], v20 offset:53248
v_mfma_f32_16x16x32_bf16 v[72:75], a[232:235], a[128:131], v[72:75]
s_waitcnt lgkmcnt(7)
buffer_load_dwordx4 v28, s[40:43], s55 offen offset:0 lds
v_mfma_f32_16x16x32_bf16 v[80:83], a[240:243], a[128:131], v[80:83]
ds_read_b64_tr_b16 a[230:231], v20 offset:55296
ds_read_b64_tr_b16 a[232:233], v21 offset:49152
v_mfma_f32_16x16x32_bf16 v[80:83], a[244:247], a[136:139], v[80:83]
ds_read_b64_tr_b16 a[234:235], v21 offset:51200
v_mfma_f32_16x16x32_bf16 v[84:87], a[244:247], a[140:143], v[84:87]
ds_read_b64_tr_b16 a[236:237], v21 offset:53248
v_mfma_f32_16x16x32_bf16 v[84:87], a[240:243], a[132:135], v[84:87]
s_waitcnt lgkmcnt(7)
ds_read_b64_tr_b16 a[238:239], v21 offset:55296
v_mfma_f32_16x16x32_bf16 v[92:95], a[248:251], a[132:135], v[92:95]
buffer_load_dwordx4 v29, s[40:43], s55 offen offset:1024 lds
v_mfma_f32_16x16x32_bf16 v[92:95], a[252:255], a[140:143], v[92:95]
s_xor_b32 s55, s55, 131072
ds_read_b64_tr_b16 a[240:241], v22 offset:49152
v_permlane16_swap_b32 v4, v6
v_permlane16_swap_b32 v5, v7
v_mfma_f32_16x16x32_bf16 v[88:91], a[252:255], a[136:139], v[88:91]
s_add_u32 m0, s52, 57344
ds_read_b64_tr_b16 a[242:243], v22 offset:51200
v_permlane16_swap_b32 v8, v10
v_permlane16_swap_b32 v9, v11
v_mfma_f32_16x16x32_bf16 v[88:91], a[248:251], a[128:131], v[88:91]
s_waitcnt lgkmcnt(6)
ds_read_b64_tr_b16 a[244:245], v22 offset:53248
buffer_load_dwordx4 v28, s[40:43], s55 offen offset:0 lds
v_permlane16_swap_b32 v12, v14
v_mfma_f32_16x16x32_bf16 a[192:195], a[224:227], a[128:131], a[192:195]
ds_read_b64_tr_b16 a[246:247], v22 offset:55296
v_permlane16_swap_b32 v13, v15
v_permlane16_swap_b32 v56, v58
v_mfma_f32_16x16x32_bf16 a[192:195], a[228:231], a[136:139], a[192:195]
pg_13:
s_cbranch_execz pg_back0
ds_read_b64_tr_b16 a[248:249], v23 offset:49152
v_permlane16_swap_b32 v57, v59
v_lshlrev_b32 v192, 16, v4
v_and_b32 v193, 0xffff0000, v4
v_mfma_f32_16x16x32_bf16 a[196:199], a[228:231], a[140:143], a[196:199]
ds_read_b64_tr_b16 a[250:251], v23 offset:51200
buffer_load_dwordx4 v29, s[40:43], s55 offen offset:1024 lds
v_lshlrev_b32 v194, 16, v5
v_and_b32 v195, 0xffff0000, v5
v_mfma_f32_16x16x32_bf16 a[196:199], a[224:227], a[132:135], a[196:199]
s_waitcnt lgkmcnt(6)
ds_read_b64_tr_b16 a[252:253], v23 offset:53248
v_lshlrev_b32 v196, 16, v8
v_and_b32 v197, 0xffff0000, v8
v_lshlrev_b32 v198, 16, v9
v_and_b32 v199, 0xffff0000, v9
v_mfma_f32_16x16x32_bf16 a[204:207], a[232:235], a[132:135], a[204:207]
ds_read_b64_tr_b16 a[254:255], v23 offset:55296
v_lshlrev_b32 v200, 16, v6
v_and_b32 v201, 0xffff0000, v6
v_lshlrev_b32 v202, 16, v7
v_and_b32 v203, 0xffff0000, v7
v_mfma_f32_16x16x32_bf16 a[204:207], a[236:239], a[140:143], a[204:207]
ds_read_b64_tr_b16 a[224:225], v20 offset:57344
v_lshlrev_b32 v204, 16, v10
v_and_b32 v205, 0xffff0000, v10
v_lshlrev_b32 v206, 16, v11
v_and_b32 v207, 0xffff0000, v11
v_mfma_f32_16x16x32_bf16 a[200:203], a[236:239], a[136:139], a[200:203]
ds_read_b64_tr_b16 a[226:227], v20 offset:59392
v_lshlrev_b32 v208, 16, v12
v_and_b32 v209, 0xffff0000, v12
v_lshlrev_b32 v210, 16, v13
v_and_b32 v211, 0xffff0000, v13
v_mfma_f32_16x16x32_bf16 a[200:203], a[232:235], a[128:131], a[200:203]
s_waitcnt vmcnt(8) lgkmcnt(6)
ds_read_b64_tr_b16 a[228:229], v20 offset:61440
v_cmp_ne_u32 vcc, v33, v32
s_nop 0
s_cbranch_vccnz ckS_spin
ckS_ok:
v_lshlrev_b32 v212, 16, v56
v_mfma_f32_16x16x32_bf16 a[208:211], a[240:243], a[128:131], a[208:211]
s_bfe_u32 s54, 0x10141210, s64
ds_read_b64_tr_b16 a[230:231], v20 offset:63488
s_lshl_b32 s54, s54, 13
v_and_b32 v213, 0xffff0000, v56
v_lshlrev_b32 v214, 16, v57
v_and_b32 v215, 0xffff0000, v57
v_mfma_f32_16x16x32_bf16 a[208:211], a[244:247], a[136:139], a[208:211]
s_add_u32 s54, s54, s63
ds_read_b64_tr_b16 a[232:233], v21 offset:57344
v_lshlrev_b32 v216, 16, v14
v_and_b32 v217, 0xffff0000, v14
v_lshlrev_b32 v218, 16, v15
v_and_b32 v219, 0xffff0000, v15
v_mfma_f32_16x16x32_bf16 a[212:215], a[244:247], a[140:143], a[212:215]
ds_read_b64_tr_b16 a[234:235], v21 offset:59392
buffer_load_dwordx4 a[160:163], v1, s[24:27], s54 offen offset:0 sc1
v_lshlrev_b32 v220, 16, v58
v_and_b32 v221, 0xffff0000, v58
v_mfma_f32_16x16x32_bf16 a[212:215], a[240:243], a[132:135], a[212:215]
s_waitcnt lgkmcnt(6)
ds_read_b64_tr_b16 a[236:237], v21 offset:61440
v_lshlrev_b32 v222, 16, v59
v_and_b32 v223, 0xffff0000, v59
v_mfma_f32_16x16x32_bf16 a[220:223], a[248:251], a[132:135], a[220:223]
buffer_load_dwordx4 a[164:167], v1, s[24:27], s54 offen offset:1024 sc1
v_mfma_f32_16x16x32_bf16 a[220:223], a[252:255], a[140:143], a[220:223]
ds_read_b64_tr_b16 a[238:239], v21 offset:63488
ds_read_b64_tr_b16 a[240:241], v22 offset:57344
v_mfma_f32_16x16x32_bf16 a[216:219], a[252:255], a[136:139], a[216:219]
ds_read_b64_tr_b16 a[242:243], v22 offset:59392
ds_read_b64_tr_b16 a[244:245], v22 offset:61440
v_mfma_f32_16x16x32_bf16 a[216:219], a[248:251], a[128:131], a[216:219]
s_waitcnt lgkmcnt(7)
ds_read_b64_tr_b16 a[246:247], v22 offset:63488
v_mfma_f32_16x16x32_bf16 a[192:195], a[224:227], a[144:147], a[192:195]
ds_read_b64_tr_b16 a[248:249], v23 offset:57344
v_mfma_f32_16x16x32_bf16 a[192:195], a[228:231], a[152:155], a[192:195]
buffer_load_dwordx4 a[168:171], v1, s[24:27], s54 offen offset:2048 sc1
v_mfma_f32_16x16x32_bf16 a[196:199], a[228:231], a[156:159], a[196:199]
ds_read_b64_tr_b16 a[250:251], v23 offset:59392
ds_read_b64_tr_b16 a[252:253], v23 offset:61440
v_mfma_f32_16x16x32_bf16 a[196:199], a[224:227], a[148:151], a[196:199]
s_waitcnt lgkmcnt(7)
ds_read_b64_tr_b16 a[254:255], v23 offset:63488
v_mfma_f32_16x16x32_bf16 a[204:207], a[232:235], a[148:151], a[204:207]
ds_read_b64_tr_b16 a[224:225], v24 offset:0
v_mfma_f32_16x16x32_bf16 a[204:207], a[236:239], a[156:159], a[204:207]
buffer_load_dwordx4 a[172:175], v1, s[24:27], s54 offen offset:3072 sc1
v_mfma_f32_16x16x32_bf16 a[200:203], a[236:239], a[152:155], a[200:203]
ds_read_b64_tr_b16 a[226:227], v24 offset:2048
ds_read_b64_tr_b16 a[228:229], v24 offset:4096
v_mfma_f32_16x16x32_bf16 a[200:203], a[232:235], a[144:147], a[200:203]
s_waitcnt lgkmcnt(7)
ds_read_b64_tr_b16 a[230:231], v24 offset:6144
v_mfma_f32_16x16x32_bf16 a[208:211], a[240:243], a[144:147], a[208:211]
ds_read_b64_tr_b16 a[232:233], v25 offset:0
v_mfma_f32_16x16x32_bf16 a[208:211], a[244:247], a[152:155], a[208:211]
ds_read_b64_tr_b16 a[234:235], v25 offset:2048
v_mfma_f32_16x16x32_bf16 a[212:215], a[244:247], a[156:159], a[212:215]
buffer_load_dwordx4 a[176:179], v2, s[24:27], s54 offen offset:0 sc1
v_mfma_f32_16x16x32_bf16 a[212:215], a[240:243], a[148:151], a[212:215]
s_waitcnt lgkmcnt(6)
ds_read_b64_tr_b16 a[236:237], v25 offset:4096
ds_read_b64_tr_b16 a[238:239], v25 offset:6144
v_mfma_f32_16x16x32_bf16 a[220:223], a[248:251], a[148:151], a[220:223]
ds_read_b64_tr_b16 a[240:241], v26 offset:0
v_mfma_f32_16x16x32_bf16 a[220:223], a[252:255], a[156:159], a[220:223]
ds_read_b64_tr_b16 a[242:243], v26 offset:2048
v_mfma_f32_16x16x32_bf16 a[216:219], a[252:255], a[152:155], a[216:219]
buffer_load_dwordx4 a[180:183], v2, s[24:27], s54 offen offset:1024 sc1
v_mfma_f32_16x16x32_bf16 a[216:219], a[248:251], a[144:147], a[216:219]
s_waitcnt lgkmcnt(6)
ds_read_b64_tr_b16 a[244:245], v26 offset:4096
ds_read_b64_tr_b16 a[246:247], v26 offset:6144
v_mfma_f32_16x16x32_bf16 v[64:67], a[224:227], a[144:147], v[64:67]
ds_read_b64_tr_b16 a[248:249], v27 offset:0
v_mfma_f32_16x16x32_bf16 v[64:67], a[228:231], a[152:155], v[64:67]
ds_read_b64_tr_b16 a[250:251], v27 offset:2048
v_mfma_f32_16x16x32_bf16 v[68:71], a[228:231], a[156:159], v[68:71]
ds_read_b64_tr_b16 a[252:253], v27 offset:4096
v_mfma_f32_16x16x32_bf16 v[68:71], a[224:227], a[148:151], v[68:71]
s_waitcnt vmcnt(39) lgkmcnt(7)
s_barrier
v_mfma_f32_16x16x32_bf16 v[76:79], a[232:235], a[148:151], v[76:79]
buffer_load_dwordx4 a[184:187], v2, s[24:27], s54 offen offset:2048 sc1
v_mfma_f32_16x16x32_bf16 v[76:79], a[236:239], a[156:159], v[76:79]
ds_read_b64_tr_b16 a[254:255], v27 offset:6144
ds_read_b64_tr_b16 a[224:225], v24 offset:8192
v_mfma_f32_16x16x32_bf16 v[72:75], a[236:239], a[152:155], v[72:75]
ds_read_b64_tr_b16 a[226:227], v24 offset:10240
ds_read_b64_tr_b16 a[228:229], v24 offset:12288
v_mfma_f32_16x16x32_bf16 v[72:75], a[232:235], a[144:147], v[72:75]
s_waitcnt lgkmcnt(7)
buffer_load_dwordx4 a[188:191], v2, s[24:27], s54 offen offset:3072 sc1
v_mfma_f32_16x16x32_bf16 v[80:83], a[240:243], a[144:147], v[80:83]
s_bfe_u32 s54, 0x16101012, s64
ds_read_b64_tr_b16 a[230:231], v24 offset:14336
ds_read_b64_tr_b16 a[232:233], v25 offset:8192
v_mfma_f32_16x16x32_bf16 v[80:83], a[244:247], a[152:155], v[80:83]
s_lshl_b32 s54, s54, 13
ds_read_b64_tr_b16 a[234:235], v25 offset:10240
s_add_u32 s54, s54, s63
v_mfma_f32_16x16x32_bf16 v[84:87], a[244:247], a[156:159], v[84:87]
ds_read_b64_tr_b16 a[236:237], v25 offset:12288
v_mfma_f32_16x16x32_bf16 v[84:87], a[240:243], a[148:151], v[84:87]
s_waitcnt lgkmcnt(7)
buffer_load_dwordx4 a[0:3], v1, s[24:27], s54 offen offset:0 sc1
v_mfma_f32_16x16x32_bf16 v[92:95], a[248:251], a[148:151], v[92:95]
ds_read_b64_tr_b16 a[238:239], v25 offset:14336
ds_read_b64_tr_b16 a[240:241], v26 offset:8192
v_mfma_f32_16x16x32_bf16 v[92:95], a[252:255], a[156:159], v[92:95]
ds_read_b64_tr_b16 a[242:243], v26 offset:10240
v_mfma_f32_16x16x32_bf16 v[88:91], a[252:255], a[152:155], v[88:91]
ds_read_b64_tr_b16 a[244:245], v26 offset:12288
v_mfma_f32_16x16x32_bf16 v[88:91], a[248:251], a[144:147], v[88:91]
s_waitcnt lgkmcnt(7)
ds_read_b64_tr_b16 a[246:247], v26 offset:14336
v_mfma_f32_16x16x32_bf16 v[64:67], a[224:227], a[64:67], v[64:67]
buffer_load_dwordx4 a[4:7], v1, s[24:27], s54 offen offset:1024 sc1
v_mfma_f32_16x16x32_bf16 v[64:67], a[228:231], a[72:75], v[64:67]
ds_read_b64_tr_b16 a[248:249], v27 offset:8192
ds_read_b64_tr_b16 a[250:251], v27 offset:10240
v_mfma_f32_16x16x32_bf16 v[68:71], a[228:231], a[76:79], v[68:71]
ds_read_b64_tr_b16 a[252:253], v27 offset:12288
v_mfma_f32_16x16x32_bf16 v[68:71], a[224:227], a[68:71], v[68:71]
s_waitcnt lgkmcnt(7)
ds_read_b64_tr_b16 a[254:255], v27 offset:14336
v_mfma_f32_16x16x32_bf16 v[76:79], a[232:235], a[68:71], v[76:79]
buffer_load_dwordx4 a[8:11], v1, s[24:27], s54 offen offset:2048 sc1
v_mfma_f32_16x16x32_bf16 v[76:79], a[236:239], a[76:79], v[76:79]
ds_read_b64_tr_b16 a[224:225], v24 offset:16384
ds_read_b64_tr_b16 a[226:227], v24 offset:18432
v_mfma_f32_16x16x32_bf16 v[72:75], a[236:239], a[72:75], v[72:75]
ds_read_b64_tr_b16 a[228:229], v24 offset:20480
v_mfma_f32_16x16x32_bf16 v[72:75], a[232:235], a[64:67], v[72:75]
s_waitcnt lgkmcnt(7)
ds_read_b64_tr_b16 a[230:231], v24 offset:22528
v_mfma_f32_16x16x32_bf16 v[80:83], a[240:243], a[64:67], v[80:83]
ds_read_b64_tr_b16 a[232:233], v25 offset:16384
v_mfma_f32_16x16x32_bf16 v[80:83], a[244:247], a[72:75], v[80:83]
buffer_load_dwordx4 a[12:15], v1, s[24:27], s54 offen offset:3072 sc1
v_mfma_f32_16x16x32_bf16 v[84:87], a[244:247], a[76:79], v[84:87]
ds_read_b64_tr_b16 a[234:235], v25 offset:18432
ds_read_b64_tr_b16 a[236:237], v25 offset:20480
v_mfma_f32_16x16x32_bf16 v[84:87], a[240:243], a[68:71], v[84:87]
s_waitcnt lgkmcnt(7)
ds_read_b64_tr_b16 a[238:239], v25 offset:22528
v_mfma_f32_16x16x32_bf16 v[92:95], a[248:251], a[68:71], v[92:95]
ds_read_b64_tr_b16 a[240:241], v26 offset:16384
v_mfma_f32_16x16x32_bf16 v[92:95], a[252:255], a[76:79], v[92:95]
buffer_load_dwordx4 a[16:19], v2, s[24:27], s54 offen offset:0 sc1
v_mfma_f32_16x16x32_bf16 v[88:91], a[252:255], a[72:75], v[88:91]
ds_read_b64_tr_b16 a[242:243], v26 offset:18432
ds_read_b64_tr_b16 a[244:245], v26 offset:20480
v_mfma_f32_16x16x32_bf16 v[88:91], a[248:251], a[64:67], v[88:91]
s_waitcnt lgkmcnt(7)
ds_read_b64_tr_b16 a[246:247], v26 offset:22528
v_mfma_f32_16x16x32_bf16 a[192:195], a[224:227], a[64:67], a[192:195]
ds_read_b64_tr_b16 a[248:249], v27 offset:16384
v_mfma_f32_16x16x32_bf16 a[192:195], a[228:231], a[72:75], a[192:195]
ds_read_b64_tr_b16 a[250:251], v27 offset:18432
v_mfma_f32_16x16x32_bf16 a[196:199], a[228:231], a[76:79], a[196:199]
buffer_load_dwordx4 a[20:23], v2, s[24:27], s54 offen offset:1024 sc1
v_mfma_f32_16x16x32_bf16 a[196:199], a[224:227], a[68:71], a[196:199]
s_waitcnt lgkmcnt(6)
ds_read_b64_tr_b16 a[252:253], v27 offset:20480
ds_read_b64_tr_b16 a[254:255], v27 offset:22528
v_mfma_f32_16x16x32_bf16 a[204:207], a[232:235], a[68:71], a[204:207]
ds_read_b64_tr_b16 a[224:225], v20 offset:0
v_mfma_f32_16x16x32_bf16 a[204:207], a[236:239], a[76:79], a[204:207]
ds_read_b64_tr_b16 a[226:227], v20 offset:2048
v_mfma_f32_16x16x32_bf16 a[200:203], a[236:239], a[72:75], a[200:203]
buffer_load_dwordx4 a[24:27], v2, s[24:27], s54 offen offset:2048 sc1
v_mfma_f32_16x16x32_bf16 a[200:203], a[232:235], a[64:67], a[200:203]
s_waitcnt lgkmcnt(6)
ds_read_b64_tr_b16 a[228:229], v20 offset:4096
ds_read_b64_tr_b16 a[230:231], v20 offset:6144
v_mfma_f32_16x16x32_bf16 a[208:211], a[240:243], a[64:67], a[208:211]
ds_read_b64_tr_b16 a[232:233], v21 offset:0
v_mfma_f32_16x16x32_bf16 a[208:211], a[244:247], a[72:75], a[208:211]
ds_read_b64_tr_b16 a[234:235], v21 offset:2048
v_mfma_f32_16x16x32_bf16 a[212:215], a[244:247], a[76:79], a[212:215]
ds_read_b64_tr_b16 a[236:237], v21 offset:4096
v_mfma_f32_16x16x32_bf16 a[212:215], a[240:243], a[68:71], a[212:215]
s_waitcnt lgkmcnt(7)
buffer_load_dwordx4 a[28:31], v2, s[24:27], s54 offen offset:3072 sc1
v_mfma_f32_16x16x32_bf16 a[220:223], a[248:251], a[68:71], a[220:223]
s_bfe_u32 s55, 0x14161a14, s64
ds_read_b64_tr_b16 a[238:239], v21 offset:6144
ds_read_b64_tr_b16 a[240:241], v22 offset:0
v_mfma_f32_16x16x32_bf16 a[220:223], a[252:255], a[76:79], a[220:223]
s_lshl_b32 s55, s55, 18
ds_read_b64_tr_b16 a[242:243], v22 offset:2048
s_xor_b32 s55, s55, 128
v_mfma_f32_16x16x32_bf16 a[216:219], a[252:255], a[72:75], a[216:219]
s_add_u32 m0, s52, 98304
ds_read_b64_tr_b16 a[244:245], v22 offset:4096
v_mfma_f32_16x16x32_bf16 a[216:219], a[248:251], a[64:67], a[216:219]
s_waitcnt lgkmcnt(7)
buffer_load_dwordx4 v28, s[40:43], s55 offen offset:0 lds
v_mfma_f32_16x16x32_bf16 a[192:195], a[224:227], a[80:83], a[192:195]
ds_read_b64_tr_b16 a[246:247], v22 offset:6144
ds_read_b64_tr_b16 a[248:249], v23 offset:0
v_mfma_f32_16x16x32_bf16 a[192:195], a[228:231], a[88:91], a[192:195]
ds_read_b64_tr_b16 a[250:251], v23 offset:2048
v_mfma_f32_16x16x32_bf16 a[196:199], a[228:231], a[92:95], a[196:199]
ds_read_b64_tr_b16 a[252:253], v23 offset:4096
v_mfma_f32_16x16x32_bf16 a[196:199], a[224:227], a[84:87], a[196:199]
s_waitcnt lgkmcnt(7)
ds_read_b64_tr_b16 a[254:255], v23 offset:6144
v_mfma_f32_16x16x32_bf16 a[204:207], a[232:235], a[84:87], a[204:207]
buffer_load_dwordx4 v29, s[40:43], s55 offen offset:1024 lds
v_mfma_f32_16x16x32_bf16 a[204:207], a[236:239], a[92:95], a[204:207]
s_xor_b32 s55, s55, 131072
ds_read_b64_tr_b16 a[224:225], v20 offset:8192
ds_read_b64_tr_b16 a[226:227], v20 offset:10240
v_mfma_f32_16x16x32_bf16 a[200:203], a[236:239], a[88:91], a[200:203]
s_add_u32 m0, s52, 106496
ds_read_b64_tr_b16 a[228:229], v20 offset:12288
v_mfma_f32_16x16x32_bf16 a[200:203], a[232:235], a[80:83], a[200:203]
s_waitcnt lgkmcnt(7)
ds_read_b64_tr_b16 a[230:231], v20 offset:14336
v_mfma_f32_16x16x32_bf16 a[208:211], a[240:243], a[80:83], a[208:211]
buffer_load_dwordx4 v28, s[40:43], s55 offen offset:0 lds
v_mfma_f32_16x16x32_bf16 a[208:211], a[244:247], a[88:91], a[208:211]
ds_read_b64_tr_b16 a[232:233], v21 offset:8192
ds_read_b64_tr_b16 a[234:235], v21 offset:10240
v_mfma_f32_16x16x32_bf16 a[212:215], a[244:247], a[92:95], a[212:215]
ds_read_b64_tr_b16 a[236:237], v21 offset:12288
v_mfma_f32_16x16x32_bf16 a[212:215], a[240:243], a[84:87], a[212:215]
s_waitcnt lgkmcnt(7)
ds_read_b64_tr_b16 a[238:239], v21 offset:14336
v_mfma_f32_16x16x32_bf16 a[220:223], a[248:251], a[84:87], a[220:223]
ds_read_b64_tr_b16 a[240:241], v22 offset:8192
v_mfma_f32_16x16x32_bf16 a[220:223], a[252:255], a[92:95], a[220:223]
buffer_load_dwordx4 v29, s[40:43], s55 offen offset:1024 lds
v_mfma_f32_16x16x32_bf16 a[216:219], a[252:255], a[88:91], a[216:219]
s_bfe_u32 s54, 0x12121418, s64
ds_read_b64_tr_b16 a[242:243], v22 offset:10240
ds_read_b64_tr_b16 a[244:245], v22 offset:12288
v_mfma_f32_16x16x32_bf16 a[216:219], a[248:251], a[80:83], a[216:219]
s_waitcnt lgkmcnt(7)
ds_read_b64_tr_b16 a[246:247], v22 offset:14336
s_lshl_b32 s54, s54, 13
v_mfma_f32_16x16x32_bf16 v[64:67], a[224:227], a[80:83], v[64:67]
s_add_u32 s54, s54, s63
ds_read_b64_tr_b16 a[248:249], v23 offset:8192
v_mfma_f32_16x16x32_bf16 v[64:67], a[228:231], a[88:91], v[64:67]
buffer_load_dwordx4 a[128:131], v1, s[24:27], s54 offen offset:0 sc1
v_mfma_f32_16x16x32_bf16 v[68:71], a[228:231], a[92:95], v[68:71]
s_load_dword s101, s[92:93], 61432
ds_read_b64_tr_b16 a[250:251], v23 offset:10240
ds_read_b64_tr_b16 a[252:253], v23 offset:12288
v_mfma_f32_16x16x32_bf16 v[68:71], a[224:227], a[84:87], v[68:71]
s_waitcnt vmcnt(35) lgkmcnt(7)
s_barrier
v_mfma_f32_16x16x32_bf16 v[76:79], a[232:235], a[84:87], v[76:79]
ds_read_b64_tr_b16 a[254:255], v23 offset:14336
ds_read_b64_tr_b16 a[224:225], v20 offset:16384
v_mfma_f32_16x16x32_bf16 v[76:79], a[236:239], a[92:95], v[76:79]
buffer_load_dwordx4 a[132:135], v1, s[24:27], s54 offen offset:1024 sc1
v_mfma_f32_16x16x32_bf16 v[72:75], a[236:239], a[88:91], v[72:75]
ds_read_b64_tr_b16 a[226:227], v20 offset:18432
ds_read_b64_tr_b16 a[228:229], v20 offset:20480
v_mfma_f32_16x16x32_bf16 v[72:75], a[232:235], a[80:83], v[72:75]
s_waitcnt lgkmcnt(7)
ds_read_b64_tr_b16 a[230:231], v20 offset:22528
v_mfma_f32_16x16x32_bf16 v[80:83], a[240:243], a[80:83], v[80:83]
ds_read_b64_tr_b16 a[232:233], v21 offset:16384
v_mfma_f32_16x16x32_bf16 v[80:83], a[244:247], a[88:91], v[80:83]
ds_read_b64_tr_b16 a[234:235], v21 offset:18432
v_mfma_f32_16x16x32_bf16 v[84:87], a[244:247], a[92:95], v[84:87]
buffer_load_dwordx4 a[136:139], v1, s[24:27], s54 offen offset:2048 sc1
v_mfma_f32_16x16x32_bf16 v[84:87], a[240:243], a[84:87], v[84:87]
s_waitcnt lgkmcnt(6)
ds_read_b64_tr_b16 a[236:237], v21 offset:20480
ds_read_b64_tr_b16 a[238:239], v21 offset:22528
v_mfma_f32_16x16x32_bf16 v[92:95], a[248:251], a[84:87], v[92:95]
ds_read_b64_tr_b16 a[240:241], v22 offset:16384
v_mfma_f32_16x16x32_bf16 v[92:95], a[252:255], a[92:95], v[92:95]
ds_read_b64_tr_b16 a[242:243], v22 offset:18432
v_mfma_f32_16x16x32_bf16 v[88:91], a[252:255], a[88:91], v[88:91]
buffer_load_dwordx4 a[140:143], v1, s[24:27], s54 offen offset:3072 sc1
v_mfma_f32_16x16x32_bf16 v[88:91], a[248:251], a[80:83], v[88:91]
s_waitcnt lgkmcnt(6)
ds_read_b64_tr_b16 a[244:245], v22 offset:20480
ds_read_b64_tr_b16 a[246:247], v22 offset:22528
v_mfma_f32_16x16x32_bf16 v[64:67], a[224:227], a[96:99], v[64:67]
ds_read_b64_tr_b16 a[248:249], v23 offset:16384
v_mfma_f32_16x16x32_bf16 v[64:67], a[228:231], a[104:107], v[64:67]
ds_read_b64_tr_b16 a[250:251], v23 offset:18432
v_mfma_f32_16x16x32_bf16 v[68:71], a[228:231], a[108:111], v[68:71]
ds_read_b64_tr_b16 a[252:253], v23 offset:20480
v_mfma_f32_16x16x32_bf16 v[68:71], a[224:227], a[100:103], v[68:71]
s_waitcnt lgkmcnt(7)
buffer_load_dwordx4 a[144:147], v2, s[24:27], s54 offen offset:0 sc1
v_mfma_f32_16x16x32_bf16 v[76:79], a[232:235], a[100:103], v[76:79]
ds_read_b64_tr_b16 a[254:255], v23 offset:22528
ds_read_b64_tr_b16 a[224:225], v20 offset:24576
v_mfma_f32_16x16x32_bf16 v[76:79], a[236:239], a[108:111], v[76:79]
ds_read_b64_tr_b16 a[226:227], v20 offset:26624
v_mfma_f32_16x16x32_bf16 v[72:75], a[236:239], a[104:107], v[72:75]
ds_read_b64_tr_b16 a[228:229], v20 offset:28672
v_mfma_f32_16x16x32_bf16 v[72:75], a[232:235], a[96:99], v[72:75]
s_waitcnt lgkmcnt(7)
buffer_load_dwordx4 a[148:151], v2, s[24:27], s54 offen offset:1024 sc1
v_mfma_f32_16x16x32_bf16 v[80:83], a[240:243], a[96:99], v[80:83]
ds_read_b64_tr_b16 a[230:231], v20 offset:30720
ds_read_b64_tr_b16 a[232:233], v21 offset:24576
v_mfma_f32_16x16x32_bf16 v[80:83], a[244:247], a[104:107], v[80:83]
ds_read_b64_tr_b16 a[234:235], v21 offset:26624
v_mfma_f32_16x16x32_bf16 v[84:87], a[244:247], a[108:111], v[84:87]
ds_read_b64_tr_b16 a[236:237], v21 offset:28672
v_mfma_f32_16x16x32_bf16 v[84:87], a[240:243], a[100:103], v[84:87]
s_waitcnt lgkmcnt(7)
ds_read_b64_tr_b16 a[238:239], v21 offset:30720
v_mfma_f32_16x16x32_bf16 v[92:95], a[248:251], a[100:103], v[92:95]
buffer_load_dwordx4 a[152:155], v2, s[24:27], s54 offen offset:2048 sc1
v_mfma_f32_16x16x32_bf16 v[92:95], a[252:255], a[108:111], v[92:95]
ds_read_b64_tr_b16 a[240:241], v22 offset:24576
ds_read_b64_tr_b16 a[242:243], v22 offset:26624
v_mfma_f32_16x16x32_bf16 v[88:91], a[252:255], a[104:107], v[88:91]
ds_read_b64_tr_b16 a[244:245], v22 offset:28672
v_mfma_f32_16x16x32_bf16 v[88:91], a[248:251], a[96:99], v[88:91]
s_waitcnt lgkmcnt(7)
ds_read_b64_tr_b16 a[246:247], v22 offset:30720
v_mfma_f32_16x16x32_bf16 a[192:195], a[224:227], a[96:99], a[192:195]
buffer_load_dwordx4 a[156:159], v2, s[24:27], s54 offen offset:3072 sc1
v_mfma_f32_16x16x32_bf16 a[192:195], a[228:231], a[104:107], a[192:195]
s_bfe_u32 s54, 0x14161a14, s64
ds_read_b64_tr_b16 a[248:249], v23 offset:24576
ds_read_b64_tr_b16 a[250:251], v23 offset:26624
v_mfma_f32_16x16x32_bf16 a[196:199], a[228:231], a[108:111], a[196:199]
s_lshl_b32 s54, s54, 13
ds_read_b64_tr_b16 a[252:253], v23 offset:28672
s_add_u32 s54, s54, s63
v_mfma_f32_16x16x32_bf16 a[196:199], a[224:227], a[100:103], a[196:199]
s_waitcnt lgkmcnt(7)
ds_read_b64_tr_b16 a[254:255], v23 offset:30720
v_mfma_f32_16x16x32_bf16 a[204:207], a[232:235], a[100:103], a[204:207]
ds_read_b64_tr_b16 a[224:225], v16 offset:0
v_mfma_f32_16x16x32_bf16 a[204:207], a[236:239], a[108:111], a[204:207]
buffer_load_dwordx4 a[32:35], v1, s[24:27], s54 offen offset:0 sc1
v_mfma_f32_16x16x32_bf16 a[200:203], a[236:239], a[104:107], a[200:203]
ds_read_b64_tr_b16 a[226:227], v16 offset:2048
ds_read_b64_tr_b16 a[228:229], v16 offset:4096
v_mfma_f32_16x16x32_bf16 a[200:203], a[232:235], a[96:99], a[200:203]
s_waitcnt lgkmcnt(7)
ds_read_b64_tr_b16 a[230:231], v16 offset:6144
v_mfma_f32_16x16x32_bf16 a[208:211], a[240:243], a[96:99], a[208:211]
ds_read_b64_tr_b16 a[232:233], v17 offset:0
v_mfma_f32_16x16x32_bf16 a[208:211], a[244:247], a[104:107], a[208:211]
buffer_load_dwordx4 a[36:39], v1, s[24:27], s54 offen offset:1024 sc1
v_mfma_f32_16x16x32_bf16 a[212:215], a[244:247], a[108:111], a[212:215]
ds_read_b64_tr_b16 a[234:235], v17 offset:2048
ds_read_b64_tr_b16 a[236:237], v17 offset:4096
v_mfma_f32_16x16x32_bf16 a[212:215], a[240:243], a[100:103], a[212:215]
s_waitcnt lgkmcnt(7)
ds_read_b64_tr_b16 a[238:239], v17 offset:6144
v_mfma_f32_16x16x32_bf16 a[220:223], a[248:251], a[100:103], a[220:223]
ds_read_b64_tr_b16 a[240:241], v18 offset:0
v_mfma_f32_16x16x32_bf16 a[220:223], a[252:255], a[108:111], a[220:223]
ds_read_b64_tr_b16 a[242:243], v18 offset:2048
v_mfma_f32_16x16x32_bf16 a[216:219], a[252:255], a[104:107], a[216:219]
buffer_load_dwordx4 a[40:43], v1, s[24:27], s54 offen offset:2048 sc1
v_mfma_f32_16x16x32_bf16 a[216:219], a[248:251], a[96:99], a[216:219]
s_waitcnt lgkmcnt(6)
ds_read_b64_tr_b16 a[244:245], v18 offset:4096
ds_read_b64_tr_b16 a[246:247], v18 offset:6144
v_mfma_f32_16x16x32_bf16 a[192:195], a[224:227], a[112:115], a[192:195]
ds_read_b64_tr_b16 a[248:249], v19 offset:0
v_mfma_f32_16x16x32_bf16 a[192:195], a[228:231], a[120:123], a[192:195]
ds_read_b64_tr_b16 a[250:251], v19 offset:2048
v_mfma_f32_16x16x32_bf16 a[196:199], a[228:231], a[124:127], a[196:199]
buffer_load_dwordx4 a[44:47], v1, s[24:27], s54 offen offset:3072 sc1
v_mfma_f32_16x16x32_bf16 a[196:199], a[224:227], a[116:119], a[196:199]
s_waitcnt lgkmcnt(6)
ds_read_b64_tr_b16 a[252:253], v19 offset:4096
ds_read_b64_tr_b16 a[254:255], v19 offset:6144
v_mfma_f32_16x16x32_bf16 a[204:207], a[232:235], a[116:119], a[204:207]
ds_read_b64_tr_b16 a[224:225], v16 offset:8192
v_mfma_f32_16x16x32_bf16 a[204:207], a[236:239], a[124:127], a[204:207]
ds_read_b64_tr_b16 a[226:227], v16 offset:10240
v_mfma_f32_16x16x32_bf16 a[200:203], a[236:239], a[120:123], a[200:203]
ds_read_b64_tr_b16 a[228:229], v16 offset:12288
v_mfma_f32_16x16x32_bf16 a[200:203], a[232:235], a[112:115], a[200:203]
s_waitcnt lgkmcnt(7)
buffer_load_dwordx4 a[48:51], v2, s[24:27], s54 offen offset:0 sc1
v_mfma_f32_16x16x32_bf16 a[208:211], a[240:243], a[112:115], a[208:211]
ds_read_b64_tr_b16 a[230:231], v16 offset:14336
ds_read_b64_tr_b16 a[232:233], v17 offset:8192
v_mfma_f32_16x16x32_bf16 a[208:211], a[244:247], a[120:123], a[208:211]
ds_read_b64_tr_b16 a[234:235], v17 offset:10240
v_mfma_f32_16x16x32_bf16 a[212:215], a[244:247], a[124:127], a[212:215]
ds_read_b64_tr_b16 a[236:237], v17 offset:12288
v_mfma_f32_16x16x32_bf16 a[212:215], a[240:243], a[116:119], a[212:215]
s_waitcnt lgkmcnt(7)
buffer_load_dwordx4 a[52:55], v2, s[24:27], s54 offen offset:1024 sc1
v_mfma_f32_16x16x32_bf16 a[220:223], a[248:251], a[116:119], a[220:223]
ds_read_b64_tr_b16 a[238:239], v17 offset:14336
ds_read_b64_tr_b16 a[240:241], v18 offset:8192
v_mfma_f32_16x16x32_bf16 a[220:223], a[252:255], a[124:127], a[220:223]
ds_read_b64_tr_b16 a[242:243], v18 offset:10240
v_mfma_f32_16x16x32_bf16 a[216:219], a[252:255], a[120:123], a[216:219]
ds_read_b64_tr_b16 a[244:245], v18 offset:12288
v_mfma_f32_16x16x32_bf16 a[216:219], a[248:251], a[112:115], a[216:219]
s_waitcnt lgkmcnt(7)
ds_read_b64_tr_b16 a[246:247], v18 offset:14336
v_mfma_f32_16x16x32_bf16 v[64:67], a[224:227], a[112:115], v[64:67]
buffer_load_dwordx4 a[56:59], v2, s[24:27], s54 offen offset:2048 sc1
v_mfma_f32_16x16x32_bf16 v[64:67], a[228:231], a[120:123], v[64:67]
ds_read_b64_tr_b16 a[248:249], v19 offset:8192
ds_read_b64_tr_b16 a[250:251], v19 offset:10240
v_mfma_f32_16x16x32_bf16 v[68:71], a[228:231], a[124:127], v[68:71]
ds_read_b64_tr_b16 a[252:253], v19 offset:12288
v_mfma_f32_16x16x32_bf16 v[68:71], a[224:227], a[116:119], v[68:71]
s_waitcnt vmcnt(39) lgkmcnt(7)
s_barrier
v_mfma_f32_16x16x32_bf16 v[76:79], a[232:235], a[116:119], v[76:79]
buffer_load_dwordx4 a[60:63], v2, s[24:27], s54 offen offset:3072 sc1
v_mfma_f32_16x16x32_bf16 v[76:79], a[236:239], a[124:127], v[76:79]
s_bfe_u32 s55, 0x18181616, s64
ds_read_b64_tr_b16 a[254:255], v19 offset:14336
ds_read_b64_tr_b16 a[224:225], v16 offset:16384
v_mfma_f32_16x16x32_bf16 v[72:75], a[236:239], a[120:123], v[72:75]
s_lshl_b32 s55, s55, 18
ds_read_b64_tr_b16 a[226:227], v16 offset:18432
ds_read_b64_tr_b16 a[228:229], v16 offset:20480
v_mfma_f32_16x16x32_bf16 v[72:75], a[232:235], a[112:115], v[72:75]
s_waitcnt lgkmcnt(7)
ds_read_b64_tr_b16 a[230:231], v16 offset:22528
s_xor_b32 s55, s55, 128
v_mfma_f32_16x16x32_bf16 v[80:83], a[240:243], a[112:115], v[80:83]
s_add_u32 m0, s52, 114688
ds_read_b64_tr_b16 a[232:233], v17 offset:16384
v_mfma_f32_16x16x32_bf16 v[80:83], a[244:247], a[120:123], v[80:83]
buffer_load_dwordx4 v28, s[40:43], s55 offen offset:0 lds
v_mfma_f32_16x16x32_bf16 v[84:87], a[244:247], a[124:127], v[84:87]
ds_read_b64_tr_b16 a[234:235], v17 offset:18432
ds_read_b64_tr_b16 a[236:237], v17 offset:20480
v_mfma_f32_16x16x32_bf16 v[84:87], a[240:243], a[116:119], v[84:87]
s_waitcnt lgkmcnt(7)
ds_read_b64_tr_b16 a[238:239], v17 offset:22528
v_mfma_f32_16x16x32_bf16 v[92:95], a[248:251], a[116:119], v[92:95]
buffer_load_dwordx4 v29, s[40:43], s55 offen offset:1024 lds
v_mfma_f32_16x16x32_bf16 v[92:95], a[252:255], a[124:127], v[92:95]
s_xor_b32 s55, s55, 131072
ds_read_b64_tr_b16 a[240:241], v18 offset:16384
ds_read_b64_tr_b16 a[242:243], v18 offset:18432
v_mfma_f32_16x16x32_bf16 v[88:91], a[252:255], a[120:123], v[88:91]
s_add_u32 m0, s52, 122880
ds_read_b64_tr_b16 a[244:245], v18 offset:20480
v_mfma_f32_16x16x32_bf16 v[88:91], a[248:251], a[112:115], v[88:91]
s_waitcnt vmcnt(30) lgkmcnt(7)
ds_read_b64_tr_b16 a[246:247], v18 offset:22528
v_mfma_f32_16x16x32_bf16 a[192:195], a[224:227], a[160:163], a[192:195]
ds_read_b64_tr_b16 a[248:249], v19 offset:16384
v_mfma_f32_16x16x32_bf16 a[192:195], a[228:231], a[168:171], a[192:195]
buffer_load_dwordx4 v28, s[40:43], s55 offen offset:0 lds
v_mfma_f32_16x16x32_bf16 a[196:199], a[228:231], a[172:175], a[196:199]
ds_read_b64_tr_b16 a[250:251], v19 offset:18432
ds_read_b64_tr_b16 a[252:253], v19 offset:20480
v_mfma_f32_16x16x32_bf16 a[196:199], a[224:227], a[164:167], a[196:199]
s_waitcnt lgkmcnt(7)
ds_read_b64_tr_b16 a[254:255], v19 offset:22528
v_mfma_f32_16x16x32_bf16 a[204:207], a[232:235], a[164:167], a[204:207]
ds_read_b64_tr_b16 a[224:225], v16 offset:24576
v_mfma_f32_16x16x32_bf16 a[204:207], a[236:239], a[172:175], a[204:207]
buffer_load_dwordx4 v29, s[40:43], s55 offen offset:1024 lds
v_mfma_f32_16x16x32_bf16 a[200:203], a[236:239], a[168:171], a[200:203]
s_bfe_u32 s55, 0x1a1a181a, s64
ds_read_b64_tr_b16 a[226:227], v16 offset:26624
ds_read_b64_tr_b16 a[228:229], v16 offset:28672
v_mfma_f32_16x16x32_bf16 a[200:203], a[232:235], a[160:163], a[200:203]
s_waitcnt lgkmcnt(7)
ds_read_b64_tr_b16 a[230:231], v16 offset:30720
s_lshl_b32 s55, s55, 18
v_mfma_f32_16x16x32_bf16 a[208:211], a[240:243], a[160:163], a[208:211]
s_xor_b32 s55, s55, 128
ds_read_b64_tr_b16 a[232:233], v17 offset:24576
s_add_u32 m0, s52, 131072
v_mfma_f32_16x16x32_bf16 a[208:211], a[244:247], a[168:171], a[208:211]
ds_read_b64_tr_b16 a[234:235], v17 offset:26624
v_mfma_f32_16x16x32_bf16 a[212:215], a[244:247], a[172:175], a[212:215]
buffer_load_dwordx4 v28, s[40:43], s55 offen offset:0 lds
v_mfma_f32_16x16x32_bf16 a[212:215], a[240:243], a[164:167], a[212:215]
s_waitcnt lgkmcnt(6)
ds_read_b64_tr_b16 a[236:237], v17 offset:28672
ds_read_b64_tr_b16 a[238:239], v17 offset:30720
v_mfma_f32_16x16x32_bf16 a[220:223], a[248:251], a[164:167], a[220:223]
ds_read_b64_tr_b16 a[240:241], v18 offset:24576
v_mfma_f32_16x16x32_bf16 a[220:223], a[252:255], a[172:175], a[220:223]
ds_read_b64_tr_b16 a[242:243], v18 offset:26624
v_mfma_f32_16x16x32_bf16 a[216:219], a[252:255], a[168:171], a[216:219]
buffer_load_dwordx4 v29, s[40:43], s55 offen offset:1024 lds
v_mfma_f32_16x16x32_bf16 a[216:219], a[248:251], a[160:163], a[216:219]
s_waitcnt lgkmcnt(6)
ds_read_b64_tr_b16 a[244:245], v18 offset:28672
ds_read_b64_tr_b16 a[246:247], v18 offset:30720
v_mfma_f32_16x16x32_bf16 a[192:195], a[224:227], a[176:179], a[192:195]
s_xor_b32 s55, s55, 131072
ds_read_b64_tr_b16 a[248:249], v19 offset:24576
s_add_u32 m0, s52, 139264
v_mfma_f32_16x16x32_bf16 a[192:195], a[228:231], a[184:187], a[192:195]
ds_read_b64_tr_b16 a[250:251], v19 offset:26624
v_mfma_f32_16x16x32_bf16 a[196:199], a[228:231], a[188:191], a[196:199]
ds_read_b64_tr_b16 a[252:253], v19 offset:28672
v_mfma_f32_16x16x32_bf16 a[196:199], a[224:227], a[180:183], a[196:199]
s_waitcnt lgkmcnt(7)
buffer_load_dwordx4 v28, s[40:43], s55 offen offset:0 lds
v_mfma_f32_16x16x32_bf16 a[204:207], a[232:235], a[180:183], a[204:207]
pg_14:
s_cbranch_execz pg_back0
ds_read_b64_tr_b16 a[254:255], v19 offset:30720
ds_read_b64_tr_b16 a[224:225], v16 offset:32768
v_mfma_f32_16x16x32_bf16 a[204:207], a[236:239], a[188:191], a[204:207]
ds_read_b64_tr_b16 a[226:227], v16 offset:34816
v_mfma_f32_16x16x32_bf16 a[200:203], a[236:239], a[184:187], a[200:203]
ds_read_b64_tr_b16 a[228:229], v16 offset:36864
v_mfma_f32_16x16x32_bf16 a[200:203], a[232:235], a[176:179], a[200:203]
s_waitcnt lgkmcnt(7)
buffer_load_dwordx4 v29, s[40:43], s55 offen offset:1024 lds
v_mfma_f32_16x16x32_bf16 a[208:211], a[240:243], a[176:179], a[208:211]
s_bfe_u32 s54, 0x18181616, s64
ds_read_b64_tr_b16 a[230:231], v16 offset:38912
ds_read_b64_tr_b16 a[232:233], v17 offset:32768
v_mfma_f32_16x16x32_bf16 a[208:211], a[244:247], a[184:187], a[208:211]
s_lshl_b32 s54, s54, 13
ds_read_b64_tr_b16 a[234:235], v17 offset:34816
s_add_u32 s54, s54, s63
v_mfma_f32_16x16x32_bf16 a[212:215], a[244:247], a[188:191], a[212:215]
ds_read_b64_tr_b16 a[236:237], v17 offset:36864
v_mfma_f32_16x16x32_bf16 a[212:215], a[240:243], a[180:183], a[212:215]
s_waitcnt lgkmcnt(7)
ds_read_b64_tr_b16 a[238:239], v17 offset:38912
v_mfma_f32_16x16x32_bf16 a[220:223], a[248:251], a[180:183], a[220:223]
buffer_load_dwordx4 a[64:67], v1, s[24:27], s54 offen offset:0 sc1
v_mfma_f32_16x16x32_bf16 a[220:223], a[252:255], a[188:191], a[220:223]
ds_read_b64_tr_b16 a[240:241], v18 offset:32768
ds_read_b64_tr_b16 a[242:243], v18 offset:34816
v_mfma_f32_16x16x32_bf16 a[216:219], a[252:255], a[184:187], a[216:219]
ds_read_b64_tr_b16 a[244:245], v18 offset:36864
v_mfma_f32_16x16x32_bf16 a[216:219], a[248:251], a[176:179], a[216:219]
s_waitcnt vmcnt(29) lgkmcnt(7)
ds_read_b64_tr_b16 a[246:247], v18 offset:38912
v_mfma_f32_16x16x32_bf16 a[192:195], a[224:227], a[0:3], a[192:195]
buffer_load_dwordx4 a[68:71], v1, s[24:27], s54 offen offset:1024 sc1
v_mfma_f32_16x16x32_bf16 a[192:195], a[228:231], a[8:11], a[192:195]
ds_read_b64_tr_b16 a[248:249], v19 offset:32768
ds_read_b64_tr_b16 a[250:251], v19 offset:34816
v_mfma_f32_16x16x32_bf16 a[196:199], a[228:231], a[12:15], a[196:199]
ds_read_b64_tr_b16 a[252:253], v19 offset:36864
v_mfma_f32_16x16x32_bf16 a[196:199], a[224:227], a[4:7], a[196:199]
s_waitcnt lgkmcnt(7)
ds_read_b64_tr_b16 a[254:255], v19 offset:38912
v_mfma_f32_16x16x32_bf16 a[204:207], a[232:235], a[4:7], a[204:207]
ds_read_b64_tr_b16 a[224:225], v16 offset:40960
v_mfma_f32_16x16x32_bf16 a[204:207], a[236:239], a[12:15], a[204:207]
buffer_load_dwordx4 a[72:75], v1, s[24:27], s54 offen offset:2048 sc1
v_mfma_f32_16x16x32_bf16 a[200:203], a[236:239], a[8:11], a[200:203]
ds_read_b64_tr_b16 a[226:227], v16 offset:43008
ds_read_b64_tr_b16 a[228:229], v16 offset:45056
v_mfma_f32_16x16x32_bf16 a[200:203], a[232:235], a[0:3], a[200:203]
s_waitcnt lgkmcnt(7)
ds_read_b64_tr_b16 a[230:231], v16 offset:47104
v_mfma_f32_16x16x32_bf16 a[208:211], a[240:243], a[0:3], a[208:211]
ds_read_b64_tr_b16 a[232:233], v17 offset:40960
v_mfma_f32_16x16x32_bf16 a[208:211], a[244:247], a[8:11], a[208:211]
buffer_load_dwordx4 a[76:79], v1, s[24:27], s54 offen offset:3072 sc1
v_mfma_f32_16x16x32_bf16 a[212:215], a[244:247], a[12:15], a[212:215]
ds_read_b64_tr_b16 a[234:235], v17 offset:43008
ds_read_b64_tr_b16 a[236:237], v17 offset:45056
v_mfma_f32_16x16x32_bf16 a[212:215], a[240:243], a[4:7], a[212:215]
s_waitcnt lgkmcnt(7)
ds_read_b64_tr_b16 a[238:239], v17 offset:47104
v_mfma_f32_16x16x32_bf16 a[220:223], a[248:251], a[4:7], a[220:223]
ds_read_b64_tr_b16 a[240:241], v18 offset:40960
v_mfma_f32_16x16x32_bf16 a[220:223], a[252:255], a[12:15], a[220:223]
ds_read_b64_tr_b16 a[242:243], v18 offset:43008
v_mfma_f32_16x16x32_bf16 a[216:219], a[252:255], a[8:11], a[216:219]
buffer_load_dwordx4 a[80:83], v2, s[24:27], s54 offen offset:0 sc1
v_mfma_f32_16x16x32_bf16 a[216:219], a[248:251], a[0:3], a[216:219]
s_waitcnt lgkmcnt(6)
ds_read_b64_tr_b16 a[244:245], v18 offset:45056
ds_read_b64_tr_b16 a[246:247], v18 offset:47104
v_mfma_f32_16x16x32_bf16 a[192:195], a[224:227], a[16:19], a[192:195]
ds_read_b64_tr_b16 a[248:249], v19 offset:40960
v_mfma_f32_16x16x32_bf16 a[192:195], a[228:231], a[24:27], a[192:195]
ds_read_b64_tr_b16 a[250:251], v19 offset:43008
v_mfma_f32_16x16x32_bf16 a[196:199], a[228:231], a[28:31], a[196:199]
buffer_load_dwordx4 a[84:87], v2, s[24:27], s54 offen offset:1024 sc1
v_mfma_f32_16x16x32_bf16 a[196:199], a[224:227], a[20:23], a[196:199]
s_waitcnt vmcnt(30) lgkmcnt(6)
s_barrier
v_mfma_f32_16x16x32_bf16 a[204:207], a[232:235], a[20:23], a[204:207]
ds_read_b64_tr_b16 a[252:253], v19 offset:45056
ds_read_b64_tr_b16 a[254:255], v19 offset:47104
v_mfma_f32_16x16x32_bf16 a[204:207], a[236:239], a[28:31], a[204:207]
ds_read_b64_tr_b16 a[224:225], v16 offset:49152
ds_read_b64_tr_b16 a[226:227], v16 offset:51200
v_mfma_f32_16x16x32_bf16 a[200:203], a[236:239], a[24:27], a[200:203]
buffer_load_dwordx4 a[88:91], v2, s[24:27], s54 offen offset:2048 sc1
v_mfma_f32_16x16x32_bf16 a[200:203], a[232:235], a[16:19], a[200:203]
s_waitcnt lgkmcnt(6)
ds_read_b64_tr_b16 a[228:229], v16 offset:53248
ds_read_b64_tr_b16 a[230:231], v16 offset:55296
v_mfma_f32_16x16x32_bf16 a[208:211], a[240:243], a[16:19], a[208:211]
ds_read_b64_tr_b16 a[232:233], v17 offset:49152
v_mfma_f32_16x16x32_bf16 a[208:211], a[244:247], a[24:27], a[208:211]
ds_read_b64_tr_b16 a[234:235], v17 offset:51200
v_mfma_f32_16x16x32_bf16 a[212:215], a[244:247], a[28:31], a[212:215]
buffer_load_dwordx4 a[92:95], v2, s[24:27], s54 offen offset:3072 sc1
v_mfma_f32_16x16x32_bf16 a[212:215], a[240:243], a[20:23], a[212:215]
s_waitcnt lgkmcnt(6)
ds_read_b64_tr_b16 a[236:237], v17 offset:53248
ds_read_b64_tr_b16 a[238:239], v17 offset:55296
v_mfma_f32_16x16x32_bf16 a[220:223], a[248:251], a[20:23], a[220:223]
s_bfe_u32 s54, 0x1a1a181a, s64
ds_read_b64_tr_b16 a[240:241], v18 offset:49152
s_lshl_b32 s54, s54, 13
v_mfma_f32_16x16x32_bf16 a[220:223], a[252:255], a[28:31], a[220:223]
s_add_u32 s54, s54, s63
ds_read_b64_tr_b16 a[242:243], v18 offset:51200
v_mfma_f32_16x16x32_bf16 a[216:219], a[252:255], a[24:27], a[216:219]
ds_read_b64_tr_b16 a[244:245], v18 offset:53248
v_mfma_f32_16x16x32_bf16 a[216:219], a[248:251], a[16:19], a[216:219]
s_waitcnt vmcnt(24) lgkmcnt(7)
buffer_load_dwordx4 a[96:99], v1, s[24:27], s54 offen offset:0 sc1
v_mfma_f32_16x16x32_bf16 a[192:195], a[224:227], a[128:131], a[192:195]
ds_read_b64_tr_b16 a[246:247], v18 offset:55296
ds_read_b64_tr_b16 a[248:249], v19 offset:49152
v_mfma_f32_16x16x32_bf16 a[192:195], a[228:231], a[136:139], a[192:195]
ds_read_b64_tr_b16 a[250:251], v19 offset:51200
v_mfma_f32_16x16x32_bf16 a[196:199], a[228:231], a[140:143], a[196:199]
ds_read_b64_tr_b16 a[252:253], v19 offset:53248
v_mfma_f32_16x16x32_bf16 a[196:199], a[224:227], a[132:135], a[196:199]
s_waitcnt lgkmcnt(7)
buffer_load_dwordx4 a[100:103], v1, s[24:27], s54 offen offset:1024 sc1
v_mfma_f32_16x16x32_bf16 a[204:207], a[232:235], a[132:135], a[204:207]
ds_read_b64_tr_b16 a[254:255], v19 offset:55296
ds_read_b64_tr_b16 a[224:225], v16 offset:57344
v_mfma_f32_16x16x32_bf16 a[204:207], a[236:239], a[140:143], a[204:207]
ds_read_b64_tr_b16 a[226:227], v16 offset:59392
v_mfma_f32_16x16x32_bf16 a[200:203], a[236:239], a[136:139], a[200:203]
ds_read_b64_tr_b16 a[228:229], v16 offset:61440
v_mfma_f32_16x16x32_bf16 a[200:203], a[232:235], a[128:131], a[200:203]
s_waitcnt lgkmcnt(7)
ds_read_b64_tr_b16 a[230:231], v16 offset:63488
v_mfma_f32_16x16x32_bf16 a[208:211], a[240:243], a[128:131], a[208:211]
buffer_load_dwordx4 a[104:107], v1, s[24:27], s54 offen offset:2048 sc1
v_mfma_f32_16x16x32_bf16 a[208:211], a[244:247], a[136:139], a[208:211]
ds_read_b64_tr_b16 a[232:233], v17 offset:57344
ds_read_b64_tr_b16 a[234:235], v17 offset:59392
v_mfma_f32_16x16x32_bf16 a[212:215], a[244:247], a[140:143], a[212:215]
ds_read_b64_tr_b16 a[236:237], v17 offset:61440
v_mfma_f32_16x16x32_bf16 a[212:215], a[240:243], a[132:135], a[212:215]
s_waitcnt lgkmcnt(7)
ds_read_b64_tr_b16 a[238:239], v17 offset:63488
v_mfma_f32_16x16x32_bf16 a[220:223], a[248:251], a[132:135], a[220:223]
buffer_load_dwordx4 a[108:111], v1, s[24:27], s54 offen offset:3072 sc1
v_mfma_f32_16x16x32_bf16 a[220:223], a[252:255], a[140:143], a[220:223]
ds_read_b64_tr_b16 a[240:241], v18 offset:57344
ds_read_b64_tr_b16 a[242:243], v18 offset:59392
v_mfma_f32_16x16x32_bf16 a[216:219], a[252:255], a[136:139], a[216:219]
ds_read_b64_tr_b16 a[244:245], v18 offset:61440
v_mfma_f32_16x16x32_bf16 a[216:219], a[248:251], a[128:131], a[216:219]
s_waitcnt lgkmcnt(7)
ds_read_b64_tr_b16 a[246:247], v18 offset:63488
v_mfma_f32_16x16x32_bf16 a[192:195], a[224:227], a[144:147], a[192:195]
ds_read_b64_tr_b16 a[248:249], v19 offset:57344
v_mfma_f32_16x16x32_bf16 a[192:195], a[228:231], a[152:155], a[192:195]
buffer_load_dwordx4 a[112:115], v2, s[24:27], s54 offen offset:0 sc1
v_mfma_f32_16x16x32_bf16 a[196:199], a[228:231], a[156:159], a[196:199]
ds_read_b64_tr_b16 a[250:251], v19 offset:59392
ds_read_b64_tr_b16 a[252:253], v19 offset:61440
v_mfma_f32_16x16x32_bf16 a[196:199], a[224:227], a[148:151], a[196:199]
s_waitcnt lgkmcnt(7)
ds_read_b64_tr_b16 a[254:255], v19 offset:63488
v_mfma_f32_16x16x32_bf16 a[204:207], a[232:235], a[148:151], a[204:207]
ds_read_b64_tr_b16 a[224:225], v20 offset:32768
v_mfma_f32_16x16x32_bf16 a[204:207], a[236:239], a[156:159], a[204:207]
buffer_load_dwordx4 a[116:119], v2, s[24:27], s54 offen offset:1024 sc1
v_mfma_f32_16x16x32_bf16 a[200:203], a[236:239], a[152:155], a[200:203]
ds_read_b64_tr_b16 a[226:227], v20 offset:34816
ds_read_b64_tr_b16 a[228:229], v20 offset:36864
v_mfma_f32_16x16x32_bf16 a[200:203], a[232:235], a[144:147], a[200:203]
s_waitcnt lgkmcnt(7)
ds_read_b64_tr_b16 a[230:231], v20 offset:38912
v_mfma_f32_16x16x32_bf16 a[208:211], a[240:243], a[144:147], a[208:211]
ds_read_b64_tr_b16 a[232:233], v21 offset:32768
v_mfma_f32_16x16x32_bf16 a[208:211], a[244:247], a[152:155], a[208:211]
ds_read_b64_tr_b16 a[234:235], v21 offset:34816
v_mfma_f32_16x16x32_bf16 a[212:215], a[244:247], a[156:159], a[212:215]
buffer_load_dwordx4 a[120:123], v2, s[24:27], s54 offen offset:2048 sc1
v_mfma_f32_16x16x32_bf16 a[212:215], a[240:243], a[148:151], a[212:215]
s_waitcnt lgkmcnt(6)
ds_read_b64_tr_b16 a[236:237], v21 offset:36864
ds_read_b64_tr_b16 a[238:239], v21 offset:38912
v_mfma_f32_16x16x32_bf16 a[220:223], a[248:251], a[148:151], a[220:223]
ds_read_b64_tr_b16 a[240:241], v22 offset:32768
v_mfma_f32_16x16x32_bf16 a[220:223], a[252:255], a[156:159], a[220:223]
ds_read_b64_tr_b16 a[242:243], v22 offset:34816
v_mfma_f32_16x16x32_bf16 a[216:219], a[252:255], a[152:155], a[216:219]
buffer_load_dwordx4 a[124:127], v2, s[24:27], s54 offen offset:3072 sc1
v_mfma_f32_16x16x32_bf16 a[216:219], a[248:251], a[144:147], a[216:219]
s_waitcnt vmcnt(24) lgkmcnt(6)
buffer_load_dword v33, v31, s[24:27], s62 offen offset:256 sc1
v_mfma_f32_16x16x32_bf16 a[192:195], a[224:227], a[32:35], a[192:195]
s_bfe_u32 s55, 0x10141210, s64
ds_read_b64_tr_b16 a[244:245], v22 offset:36864
ds_read_b64_tr_b16 a[246:247], v22 offset:38912
v_mfma_f32_16x16x32_bf16 a[192:195], a[228:231], a[40:43], a[192:195]
s_lshl_b32 s55, s55, 18
ds_read_b64_tr_b16 a[248:249], v23 offset:32768
ds_read_b64_tr_b16 a[250:251], v23 offset:34816
v_mfma_f32_16x16x32_bf16 a[196:199], a[228:231], a[44:47], a[196:199]
s_add_u32 m0, s52, 147456
ds_read_b64_tr_b16 a[252:253], v23 offset:36864
v_mfma_f32_16x16x32_bf16 a[196:199], a[224:227], a[36:39], a[196:199]
s_waitcnt lgkmcnt(7)
buffer_load_dwordx4 v28, s[40:43], s55 offen offset:0 lds
v_mfma_f32_16x16x32_bf16 a[204:207], a[232:235], a[36:39], a[204:207]
ds_read_b64_tr_b16 a[254:255], v23 offset:38912
ds_read_b64_tr_b16 a[224:225], v20 offset:40960
v_mfma_f32_16x16x32_bf16 a[204:207], a[236:239], a[44:47], a[204:207]
ds_read_b64_tr_b16 a[226:227], v20 offset:43008
v_mfma_f32_16x16x32_bf16 a[200:203], a[236:239], a[40:43], a[200:203]
ds_read_b64_tr_b16 a[228:229], v20 offset:45056
v_mfma_f32_16x16x32_bf16 a[200:203], a[232:235], a[32:35], a[200:203]
s_waitcnt lgkmcnt(7)
ds_read_b64_tr_b16 a[230:231], v20 offset:47104
v_mfma_f32_16x16x32_bf16 a[208:211], a[240:243], a[32:35], a[208:211]
buffer_load_dwordx4 v29, s[40:43], s55 offen offset:1024 lds
v_mfma_f32_16x16x32_bf16 a[208:211], a[244:247], a[40:43], a[208:211]
s_xor_b32 s55, s55, 131072
ds_read_b64_tr_b16 a[232:233], v21 offset:40960
ds_read_b64_tr_b16 a[234:235], v21 offset:43008
v_mfma_f32_16x16x32_bf16 a[212:215], a[244:247], a[44:47], a[212:215]
s_add_u32 m0, s52, 65536
ds_read_b64_tr_b16 a[236:237], v21 offset:45056
v_mfma_f32_16x16x32_bf16 a[212:215], a[240:243], a[36:39], a[212:215]
s_waitcnt lgkmcnt(7)
ds_read_b64_tr_b16 a[238:239], v21 offset:47104
v_mfma_f32_16x16x32_bf16 a[220:223], a[248:251], a[36:39], a[220:223]
buffer_load_dwordx4 v28, s[40:43], s55 offen offset:0 lds
v_mfma_f32_16x16x32_bf16 a[220:223], a[252:255], a[44:47], a[220:223]
ds_read_b64_tr_b16 a[240:241], v22 offset:40960
ds_read_b64_tr_b16 a[242:243], v22 offset:43008
v_mfma_f32_16x16x32_bf16 a[216:219], a[252:255], a[40:43], a[216:219]
ds_read_b64_tr_b16 a[244:245], v22 offset:45056
v_mfma_f32_16x16x32_bf16 a[216:219], a[248:251], a[32:35], a[216:219]
s_waitcnt lgkmcnt(7)
ds_read_b64_tr_b16 a[246:247], v22 offset:47104
v_mfma_f32_16x16x32_bf16 a[192:195], a[224:227], a[48:51], a[192:195]
ds_read_b64_tr_b16 a[248:249], v23 offset:40960
v_mfma_f32_16x16x32_bf16 a[192:195], a[228:231], a[56:59], a[192:195]
buffer_load_dwordx4 v29, s[40:43], s55 offen offset:1024 lds
v_mfma_f32_16x16x32_bf16 a[196:199], a[228:231], a[60:63], a[196:199]
s_bfe_u32 s55, 0x16101012, s64
ds_read_b64_tr_b16 a[250:251], v23 offset:43008
ds_read_b64_tr_b16 a[252:253], v23 offset:45056
v_mfma_f32_16x16x32_bf16 a[196:199], a[224:227], a[52:55], a[196:199]
s_waitcnt vmcnt(21) lgkmcnt(7)
s_barrier
v_mfma_f32_16x16x32_bf16 a[204:207], a[232:235], a[52:55], a[204:207]
s_lshl_b32 s55, s55, 18
ds_read_b64_tr_b16 a[254:255], v23 offset:47104
ds_read_b64_tr_b16 a[224:225], v20 offset:49152
v_mfma_f32_16x16x32_bf16 a[204:207], a[236:239], a[60:63], a[204:207]
s_add_u32 m0, s52, 73728
ds_read_b64_tr_b16 a[226:227], v20 offset:51200
v_mfma_f32_16x16x32_bf16 a[200:203], a[236:239], a[56:59], a[200:203]
buffer_load_dwordx4 v28, s[40:43], s55 offen offset:0 lds
v_mfma_f32_16x16x32_bf16 a[200:203], a[232:235], a[48:51], a[200:203]
s_waitcnt lgkmcnt(6)
ds_read_b64_tr_b16 a[228:229], v20 offset:53248
ds_read_b64_tr_b16 a[230:231], v20 offset:55296
v_mfma_f32_16x16x32_bf16 a[208:211], a[240:243], a[48:51], a[208:211]
ds_read_b64_tr_b16 a[232:233], v21 offset:49152
v_mfma_f32_16x16x32_bf16 a[208:211], a[244:247], a[56:59], a[208:211]
buffer_load_dwordx4 v29, s[40:43], s55 offen offset:1024 lds
v_mfma_f32_16x16x32_bf16 a[212:215], a[244:247], a[60:63], a[212:215]
s_xor_b32 s55, s55, 131072
ds_read_b64_tr_b16 a[234:235], v21 offset:51200
ds_read_b64_tr_b16 a[236:237], v21 offset:53248
v_mfma_f32_16x16x32_bf16 a[212:215], a[240:243], a[52:55], a[212:215]
s_waitcnt lgkmcnt(7)
ds_read_b64_tr_b16 a[238:239], v21 offset:55296
s_add_u32 m0, s52, 81920
v_mfma_f32_16x16x32_bf16 a[220:223], a[248:251], a[52:55], a[220:223]
s_mov_b64 exec, 0
s_cmp_eq_u32 s32, 0
s_cbranch_scc1 pg_15
s_cmp_eq_u32 s32, 1
s_cbranch_scc1 pg_16
s_cmp_eq_u32 s32, 2
s_cbranch_scc1 pg_17
s_branch pg_back1
pg_back1:
s_mov_b64 exec, -1
ds_read_b64_tr_b16 a[240:241], v22 offset:49152
v_mfma_f32_16x16x32_bf16 a[220:223], a[252:255], a[60:63], a[220:223]
s_load_dword s101, s[92:93], 65528
ds_read_b64_tr_b16 a[242:243], v22 offset:51200
v_mfma_f32_16x16x32_bf16 a[216:219], a[252:255], a[56:59], a[216:219]
buffer_load_dwordx4 v28, s[40:43], s55 offen offset:0 lds
v_mfma_f32_16x16x32_bf16 a[216:219], a[248:251], a[48:51], a[216:219]
s_waitcnt vmcnt(16) lgkmcnt(6)
ds_read_b64_tr_b16 a[244:245], v22 offset:53248
ds_read_b64_tr_b16 a[246:247], v22 offset:55296
v_mfma_f32_16x16x32_bf16 a[192:195], a[224:227], a[64:67], a[192:195]
ds_read_b64_tr_b16 a[248:249], v23 offset:49152
v_mfma_f32_16x16x32_bf16 a[192:195], a[228:231], a[72:75], a[192:195]
ds_read_b64_tr_b16 a[250:251], v23 offset:51200
v_mfma_f32_16x16x32_bf16 a[196:199], a[228:231], a[76:79], a[196:199]
buffer_load_dwordx4 v29, s[40:43], s55 offen offset:1024 lds
v_mfma_f32_16x16x32_bf16 a[196:199], a[224:227], a[68:71], a[196:199]
s_waitcnt lgkmcnt(6)
ds_read_b64_tr_b16 a[252:253], v23 offset:53248
ds_read_b64_tr_b16 a[254:255], v23 offset:55296
v_mfma_f32_16x16x32_bf16 a[204:207], a[232:235], a[68:71], a[204:207]
s_bfe_u32 s55, 0x12121418, s64
ds_read_b64_tr_b16 a[224:225], v20 offset:57344
s_lshl_b32 s55, s55, 18
v_mfma_f32_16x16x32_bf16 a[204:207], a[236:239], a[76:79], a[204:207]
s_add_u32 m0, s52, 90112
ds_read_b64_tr_b16 a[226:227], v20 offset:59392
v_mfma_f32_16x16x32_bf16 a[200:203], a[236:239], a[72:75], a[200:203]
ds_read_b64_tr_b16 a[228:229], v20 offset:61440
v_mfma_f32_16x16x32_bf16 a[200:203], a[232:235], a[64:67], a[200:203]
s_waitcnt lgkmcnt(7)
buffer_load_dwordx4 v28, s[40:43], s55 offen offset:0 lds
v_mfma_f32_16x16x32_bf16 a[208:211], a[240:243], a[64:67], a[208:211]
ds_read_b64_tr_b16 a[230:231], v20 offset:63488
ds_read_b64_tr_b16 a[232:233], v21 offset:57344
v_mfma_f32_16x16x32_bf16 a[208:211], a[244:247], a[72:75], a[208:211]
ds_read_b64_tr_b16 a[234:235], v21 offset:59392
v_mfma_f32_16x16x32_bf16 a[212:215], a[244:247], a[76:79], a[212:215]
ds_read_b64_tr_b16 a[236:237], v21 offset:61440
v_mfma_f32_16x16x32_bf16 a[212:215], a[240:243], a[68:71], a[212:215]
s_waitcnt lgkmcnt(7)
buffer_load_dwordx4 v29, s[40:43], s55 offen offset:1024 lds
v_mfma_f32_16x16x32_bf16 a[220:223], a[248:251], a[68:71], a[220:223]
s_xor_b32 s55, s55, 131072
ds_read_b64_tr_b16 a[238:239], v21 offset:63488
ds_read_b64_tr_b16 a[240:241], v22 offset:57344
v_mfma_f32_16x16x32_bf16 a[220:223], a[252:255], a[76:79], a[220:223]
s_add_u32 m0, s52, 0
ds_read_b64_tr_b16 a[242:243], v22 offset:59392
v_mfma_f32_16x16x32_bf16 a[216:219], a[252:255], a[72:75], a[216:219]
ds_read_b64_tr_b16 a[244:245], v22 offset:61440
v_mfma_f32_16x16x32_bf16 a[216:219], a[248:251], a[64:67], a[216:219]
s_waitcnt lgkmcnt(7)
ds_read_b64_tr_b16 a[246:247], v22 offset:63488
v_mfma_f32_16x16x32_bf16 a[192:195], a[224:227], a[80:83], a[192:195]
buffer_load_dwordx4 v28, s[40:43], s55 offen offset:0 lds
v_mfma_f32_16x16x32_bf16 a[192:195], a[228:231], a[88:91], a[192:195]
ds_read_b64_tr_b16 a[248:249], v23 offset:57344
ds_read_b64_tr_b16 a[250:251], v23 offset:59392
v_mfma_f32_16x16x32_bf16 a[196:199], a[228:231], a[92:95], a[196:199]
ds_read_b64_tr_b16 a[252:253], v23 offset:61440
v_mfma_f32_16x16x32_bf16 a[196:199], a[224:227], a[84:87], a[196:199]
s_waitcnt lgkmcnt(7)
ds_read_b64_tr_b16 a[254:255], v23 offset:63488
v_mfma_f32_16x16x32_bf16 a[204:207], a[232:235], a[84:87], a[204:207]
buffer_load_dwordx4 v29, s[40:43], s55 offen offset:1024 lds
v_mfma_f32_16x16x32_bf16 a[204:207], a[236:239], a[92:95], a[204:207]
s_bfe_u32 s55, 0x14161a14, s64
ds_read_b64_tr_b16 a[224:225], v24 offset:0
ds_read_b64_tr_b16 a[226:227], v24 offset:2048
v_mfma_f32_16x16x32_bf16 a[200:203], a[236:239], a[88:91], a[200:203]
s_lshl_b32 s55, s55, 18
ds_read_b64_tr_b16 a[228:229], v24 offset:4096
s_add_u32 m0, s52, 8192
v_mfma_f32_16x16x32_bf16 a[200:203], a[232:235], a[80:83], a[200:203]
s_waitcnt lgkmcnt(7)
ds_read_b64_tr_b16 a[230:231], v24 offset:6144
v_mfma_f32_16x16x32_bf16 a[208:211], a[240:243], a[80:83], a[208:211]
ds_read_b64_tr_b16 a[232:233], v25 offset:0
v_mfma_f32_16x16x32_bf16 a[208:211], a[244:247], a[88:91], a[208:211]
buffer_load_dwordx4 v28, s[40:43], s55 offen offset:0 lds
v_mfma_f32_16x16x32_bf16 a[212:215], a[244:247], a[92:95], a[212:215]
ds_read_b64_tr_b16 a[234:235], v25 offset:2048
ds_read_b64_tr_b16 a[236:237], v25 offset:4096
v_mfma_f32_16x16x32_bf16 a[212:215], a[240:243], a[84:87], a[212:215]
s_waitcnt lgkmcnt(7)
ds_read_b64_tr_b16 a[238:239], v25 offset:6144
v_mfma_f32_16x16x32_bf16 a[220:223], a[248:251], a[84:87], a[220:223]
ds_read_b64_tr_b16 a[240:241], v26 offset:0
v_mfma_f32_16x16x32_bf16 a[220:223], a[252:255], a[92:95], a[220:223]
buffer_load_dwordx4 v29, s[40:43], s55 offen offset:1024 lds
v_mfma_f32_16x16x32_bf16 a[216:219], a[252:255], a[88:91], a[216:219]
s_xor_b32 s55, s55, 131072
ds_read_b64_tr_b16 a[242:243], v26 offset:2048
ds_read_b64_tr_b16 a[244:245], v26 offset:4096
v_mfma_f32_16x16x32_bf16 a[216:219], a[248:251], a[80:83], a[216:219]
s_waitcnt vmcnt(14) lgkmcnt(7)
ds_read_b64_tr_b16 a[246:247], v26 offset:6144
v_cmp_ne_u32 vcc, v33, v32
s_nop 0
s_cbranch_vccnz ckO_spin
ckO_ok:
v_mfma_f32_16x16x32_bf16 a[192:195], a[224:227], a[96:99], a[192:195]
s_add_u32 m0, s52, 16384
ds_read_b64_tr_b16 a[248:249], v27 offset:0
s_mov_b32 s4, 0x7f000000
s_cmp_eq_u32 s2, 0
s_cselect_b32 s4, 50397184, s4
v_mfma_f32_16x16x32_bf16 a[192:195], a[228:231], a[104:107], a[192:195]
buffer_store_dword v32, v30, s[24:27], s4 offen sc1
buffer_load_dwordx4 v28, s[40:43], s55 offen offset:0 lds
s_lshl_b32 s6, s2, 2
v_mfma_f32_16x16x32_bf16 a[196:199], a[228:231], a[108:111], a[196:199]
s_add_u32 s6, s6, s32
ds_read_b64_tr_b16 a[250:251], v27 offset:2048
ds_read_b64_tr_b16 a[252:253], v27 offset:4096
v_mfma_f32_16x16x32_bf16 a[196:199], a[224:227], a[100:103], a[196:199]
s_waitcnt lgkmcnt(7)
ds_read_b64_tr_b16 a[254:255], v27 offset:6144
s_lshl_b32 s7, s6, 7
v_mfma_f32_16x16x32_bf16 a[204:207], a[232:235], a[100:103], a[204:207]
s_add_u32 s7, s7, 50462720
ds_read_b64_tr_b16 a[224:225], v24 offset:8192
s_lshl_b32 s6, s6, 13
v_mfma_f32_16x16x32_bf16 a[204:207], a[236:239], a[108:111], a[204:207]
buffer_load_dwordx4 v29, s[40:43], s55 offen offset:1024 lds
v_mfma_f32_16x16x32_bf16 a[200:203], a[236:239], a[104:107], a[200:203]
s_bfe_u32 s55, 0x18181616, s64
ds_read_b64_tr_b16 a[226:227], v24 offset:10240
ds_read_b64_tr_b16 a[228:229], v24 offset:12288
v_mfma_f32_16x16x32_bf16 a[200:203], a[232:235], a[96:99], a[200:203]
s_waitcnt lgkmcnt(7)
ds_read_b64_tr_b16 a[230:231], v24 offset:14336
s_lshl_b32 s55, s55, 18
v_mfma_f32_16x16x32_bf16 a[208:211], a[240:243], a[96:99], a[208:211]
s_add_u32 m0, s52, 24576
ds_read_b64_tr_b16 a[232:233], v25 offset:8192
s_add_u32 s6, s6, 41943040
v_mfma_f32_16x16x32_bf16 a[208:211], a[244:247], a[104:107], a[208:211]
buffer_load_dwordx4 v28, s[40:43], s55 offen offset:0 lds
v_mfma_f32_16x16x32_bf16 a[212:215], a[244:247], a[108:111], a[212:215]
ds_read_b64_tr_b16 a[234:235], v25 offset:10240
ds_read_b64_tr_b16 a[236:237], v25 offset:12288
v_mfma_f32_16x16x32_bf16 a[212:215], a[240:243], a[100:103], a[212:215]
s_waitcnt lgkmcnt(7)
ds_read_b64_tr_b16 a[238:239], v25 offset:14336
v_mfma_f32_16x16x32_bf16 a[220:223], a[248:251], a[100:103], a[220:223]
ds_read_b64_tr_b16 a[240:241], v26 offset:8192
v_mfma_f32_16x16x32_bf16 a[220:223], a[252:255], a[108:111], a[220:223]
ds_read_b64_tr_b16 a[242:243], v26 offset:10240
v_mfma_f32_16x16x32_bf16 a[216:219], a[252:255], a[104:107], a[216:219]
buffer_load_dwordx4 v29, s[40:43], s55 offen offset:1024 lds
v_mfma_f32_16x16x32_bf16 a[216:219], a[248:251], a[96:99], a[216:219]
s_waitcnt lgkmcnt(6)
ds_read_b64_tr_b16 a[244:245], v26 offset:12288
ds_read_b64_tr_b16 a[246:247], v26 offset:14336
v_mfma_f32_16x16x32_bf16 a[192:195], a[224:227], a[112:115], a[192:195]
s_xor_b32 s55, s55, 131072
ds_read_b64_tr_b16 a[248:249], v27 offset:8192
s_add_u32 m0, s52, 32768
v_mfma_f32_16x16x32_bf16 a[192:195], a[228:231], a[120:123], a[192:195]
ds_read_b64_tr_b16 a[250:251], v27 offset:10240
v_mfma_f32_16x16x32_bf16 a[196:199], a[228:231], a[124:127], a[196:199]
buffer_load_dwordx4 v28, s[40:43], s55 offen offset:0 lds
v_mfma_f32_16x16x32_bf16 a[196:199], a[224:227], a[116:119], a[196:199]
s_waitcnt vmcnt(12) lgkmcnt(6)
s_barrier
v_mfma_f32_16x16x32_bf16 a[204:207], a[232:235], a[116:119], a[204:207]
ds_read_b64_tr_b16 a[252:253], v27 offset:12288
ds_read_b64_tr_b16 a[254:255], v27 offset:14336
v_mfma_f32_16x16x32_bf16 a[204:207], a[236:239], a[124:127], a[204:207]
ds_read_b64_tr_b16 a[224:225], v24 offset:16384
v_accvgpr_read_b32 v160, a192
v_accvgpr_read_b32 v161, a193
v_accvgpr_read_b32 v162, a194
v_accvgpr_read_b32 v163, a195
v_mfma_f32_16x16x32_bf16 a[200:203], a[236:239], a[120:123], a[200:203]
ds_read_b64_tr_b16 a[226:227], v24 offset:18432
buffer_load_dwordx4 v29, s[40:43], s55 offen offset:1024 lds
v_accvgpr_read_b32 v164, a196
v_accvgpr_read_b32 v165, a197
v_mfma_f32_16x16x32_bf16 a[200:203], a[232:235], a[112:115], a[200:203]
s_waitcnt lgkmcnt(6)
ds_read_b64_tr_b16 a[228:229], v24 offset:20480
s_bfe_u32 s55, 0x1a1a181a, s64
v_accvgpr_read_b32 v166, a198
v_accvgpr_read_b32 v167, a199
v_cvt_pk_bf16_f32 v160, v160, v161
v_mfma_f32_16x16x32_bf16 a[208:211], a[240:243], a[112:115], a[208:211]
s_lshl_b32 s55, s55, 18
ds_read_b64_tr_b16 a[230:231], v24 offset:22528
s_add_u32 m0, s52, 40960
v_cvt_pk_bf16_f32 v161, v162, v163
v_cvt_pk_bf16_f32 v162, v164, v165
v_cvt_pk_bf16_f32 v163, v166, v167
v_mfma_f32_16x16x32_bf16 a[208:211], a[244:247], a[120:123], a[208:211]
ds_read_b64_tr_b16 a[232:233], v25 offset:16384
buffer_load_dwordx4 v28, s[40:43], s55 offen offset:0 lds
v_accvgpr_read_b32 v168, a200
v_accvgpr_read_b32 v169, a201
v_mfma_f32_16x16x32_bf16 a[212:215], a[244:247], a[124:127], a[212:215]
ds_read_b64_tr_b16 a[234:235], v25 offset:18432
v_accvgpr_read_b32 v170, a202
v_accvgpr_read_b32 v171, a203
v_accvgpr_read_b32 v172, a204
v_accvgpr_read_b32 v173, a205
v_mfma_f32_16x16x32_bf16 a[212:215], a[240:243], a[116:119], a[212:215]
s_waitcnt lgkmcnt(6)
ds_read_b64_tr_b16 a[236:237], v25 offset:20480
buffer_load_dwordx4 v29, s[40:43], s55 offen offset:1024 lds
v_accvgpr_read_b32 v174, a206
v_accvgpr_read_b32 v175, a207
v_mfma_f32_16x16x32_bf16 a[220:223], a[248:251], a[116:119], a[220:223]
s_xor_b32 s55, s55, 131072
ds_read_b64_tr_b16 a[238:239], v25 offset:22528
v_cvt_pk_bf16_f32 v168, v168, v169
v_cvt_pk_bf16_f32 v169, v170, v171
v_cvt_pk_bf16_f32 v170, v172, v173
v_cvt_pk_bf16_f32 v171, v174, v175
v_mfma_f32_16x16x32_bf16 a[220:223], a[252:255], a[124:127], a[220:223]
s_add_u32 m0, s52, 49152
ds_read_b64_tr_b16 a[240:241], v26 offset:16384
v_accvgpr_read_b32 v176, a208
v_accvgpr_read_b32 v177, a209
v_accvgpr_read_b32 v178, a210
v_accvgpr_read_b32 v179, a211
v_mfma_f32_16x16x32_bf16 a[216:219], a[252:255], a[120:123], a[216:219]
ds_read_b64_tr_b16 a[242:243], v26 offset:18432
buffer_load_dwordx4 v28, s[40:43], s55 offen offset:0 lds
v_accvgpr_read_b32 v180, a212
v_accvgpr_read_b32 v181, a213
v_mfma_f32_16x16x32_bf16 a[216:219], a[248:251], a[112:115], a[216:219]
s_waitcnt lgkmcnt(6)
ds_read_b64_tr_b16 a[244:245], v26 offset:20480
v_accvgpr_read_b32 v182, a214
v_accvgpr_read_b32 v183, a215
v_cvt_pk_bf16_f32 v176, v176, v177
v_cvt_pk_bf16_f32 v177, v178, v179
v_mfma_f32_16x16x32_bf16 v[64:67], a[224:227], a[160:163], v[64:67]
ds_read_b64_tr_b16 a[246:247], v26 offset:22528
buffer_load_dwordx4 v29, s[40:43], s55 offen offset:1024 lds
v_cvt_pk_bf16_f32 v178, v180, v181
v_cvt_pk_bf16_f32 v179, v182, v183
v_mfma_f32_16x16x32_bf16 v[64:67], a[228:231], a[168:171], v[64:67]
s_bfe_u32 s55, 0x100, s64
ds_read_b64_tr_b16 a[248:249], v27 offset:16384
v_accvgpr_read_b32 v184, a216
v_accvgpr_read_b32 v185, a217
v_accvgpr_read_b32 v186, a218
v_accvgpr_read_b32 v187, a219
v_mfma_f32_16x16x32_bf16 v[68:71], a[228:231], a[172:175], v[68:71]
s_lshl_b32 s55, s55, 18
ds_read_b64_tr_b16 a[250:251], v27 offset:18432
v_accvgpr_read_b32 v188, a220
v_accvgpr_read_b32 v189, a221
v_accvgpr_read_b32 v190, a222
v_accvgpr_read_b32 v191, a223
v_mfma_f32_16x16x32_bf16 v[68:71], a[224:227], a[164:167], v[68:71]
s_waitcnt lgkmcnt(6)
ds_read_b64_tr_b16 a[252:253], v27 offset:20480
s_add_u32 m0, s52, 57344
v_cvt_pk_bf16_f32 v184, v184, v185
v_cvt_pk_bf16_f32 v185, v186, v187
v_cvt_pk_bf16_f32 v186, v188, v189
v_mfma_f32_16x16x32_bf16 v[76:79], a[232:235], a[164:167], v[76:79]
pg_15:
s_cbranch_execz pg_back1
ds_read_b64_tr_b16 a[254:255], v27 offset:22528
buffer_load_dwordx4 v28, s[44:47], s55 offen offset:0 lds
v_cvt_pk_bf16_f32 v187, v190, v191
v_mfma_f32_16x16x32_bf16 v[76:79], a[236:239], a[172:175], v[76:79]
ds_read_b64_tr_b16 a[224:225], v20 offset:0
ds_read_b64_tr_b16 a[226:227], v20 offset:2048
v_mfma_f32_16x16x32_bf16 v[72:75], a[236:239], a[168:171], v[72:75]
ds_read_b64_tr_b16 a[228:229], v20 offset:4096
v_mfma_f32_16x16x32_bf16 v[72:75], a[232:235], a[160:163], v[72:75]
s_waitcnt lgkmcnt(7)
buffer_load_dwordx4 v29, s[44:47], s55 offen offset:1024 lds
v_mfma_f32_16x16x32_bf16 v[80:83], a[240:243], a[160:163], v[80:83]
s_xor_b32 s55, s55, 131072
ds_read_b64_tr_b16 a[230:231], v20 offset:6144
ds_read_b64_tr_b16 a[232:233], v21 offset:0
v_mfma_f32_16x16x32_bf16 v[80:83], a[244:247], a[168:171], v[80:83]
s_add_u32 m0, s52, 98304
ds_read_b64_tr_b16 a[234:235], v21 offset:2048
v_mfma_f32_16x16x32_bf16 v[84:87], a[244:247], a[172:175], v[84:87]
ds_read_b64_tr_b16 a[236:237], v21 offset:4096
v_mfma_f32_16x16x32_bf16 v[84:87], a[240:243], a[164:167], v[84:87]
s_waitcnt lgkmcnt(7)
buffer_load_dwordx4 v28, s[44:47], s55 offen offset:0 lds
v_mfma_f32_16x16x32_bf16 v[92:95], a[248:251], a[164:167], v[92:95]
ds_read_b64_tr_b16 a[238:239], v21 offset:6144
ds_read_b64_tr_b16 a[240:241], v22 offset:0
v_mfma_f32_16x16x32_bf16 v[92:95], a[252:255], a[172:175], v[92:95]
ds_read_b64_tr_b16 a[242:243], v22 offset:2048
v_mfma_f32_16x16x32_bf16 v[88:91], a[252:255], a[168:171], v[88:91]
ds_read_b64_tr_b16 a[244:245], v22 offset:4096
v_mfma_f32_16x16x32_bf16 v[88:91], a[248:251], a[160:163], v[88:91]
s_waitcnt lgkmcnt(7)
ds_read_b64_tr_b16 a[246:247], v22 offset:6144
v_mfma_f32_16x16x32_bf16 v[64:67], a[224:227], a[176:179], v[64:67]
buffer_store_dwordx4 v[160:163], v1, s[24:27], s6 offen offset:0 sc1
ds_read_b64_tr_b16 a[248:249], v23 offset:0
v_mfma_f32_16x16x32_bf16 v[64:67], a[228:231], a[184:187], v[64:67]
ds_read_b64_tr_b16 a[250:251], v23 offset:2048
v_mfma_f32_16x16x32_bf16 v[68:71], a[228:231], a[188:191], v[68:71]
ds_read_b64_tr_b16 a[252:253], v23 offset:4096
v_mfma_f32_16x16x32_bf16 v[68:71], a[224:227], a[180:183], v[68:71]
s_waitcnt lgkmcnt(7)
ds_read_b64_tr_b16 a[254:255], v23 offset:6144
v_mfma_f32_16x16x32_bf16 v[76:79], a[232:235], a[180:183], v[76:79]
ds_read_b64_tr_b16 a[224:225], v20 offset:8192
v_mfma_f32_16x16x32_bf16 v[76:79], a[236:239], a[188:191], v[76:79]
ds_read_b64_tr_b16 a[226:227], v20 offset:10240
v_mfma_f32_16x16x32_bf16 v[72:75], a[236:239], a[184:187], v[72:75]
buffer_store_dwordx4 v[168:171], v1, s[24:27], s6 offen offset:1024 sc1
ds_read_b64_tr_b16 a[228:229], v20 offset:12288
v_mfma_f32_16x16x32_bf16 v[72:75], a[232:235], a[176:179], v[72:75]
s_waitcnt lgkmcnt(7)
ds_read_b64_tr_b16 a[230:231], v20 offset:14336
v_mfma_f32_16x16x32_bf16 v[80:83], a[240:243], a[176:179], v[80:83]
ds_read_b64_tr_b16 a[232:233], v21 offset:8192
v_mfma_f32_16x16x32_bf16 v[80:83], a[244:247], a[184:187], v[80:83]
ds_read_b64_tr_b16 a[234:235], v21 offset:10240
v_mfma_f32_16x16x32_bf16 v[84:87], a[244:247], a[188:191], v[84:87]
ds_read_b64_tr_b16 a[236:237], v21 offset:12288
v_mfma_f32_16x16x32_bf16 v[84:87], a[240:243], a[180:183], v[84:87]
s_waitcnt lgkmcnt(7)
buffer_load_dwordx4 v29, s[44:47], s55 offen offset:1024 lds
v_mfma_f32_16x16x32_bf16 v[92:95], a[248:251], a[180:183], v[92:95]
s_bfe_u32 s54, 0x100, s64
ds_read_b64_tr_b16 a[238:239], v21 offset:14336
ds_read_b64_tr_b16 a[240:241], v22 offset:8192
v_mfma_f32_16x16x32_bf16 v[92:95], a[252:255], a[188:191], v[92:95]
s_lshl_b32 s54, s54, 13
ds_read_b64_tr_b16 a[242:243], v22 offset:10240
s_add_u32 s54, s54, s71
v_mfma_f32_16x16x32_bf16 v[88:91], a[252:255], a[184:187], v[88:91]
ds_read_b64_tr_b16 a[244:245], v22 offset:12288
v_mfma_f32_16x16x32_bf16 v[88:91], a[248:251], a[176:179], v[88:91]
s_waitcnt lgkmcnt(7)
ds_read_b64_tr_b16 a[246:247], v22 offset:14336
v_mfma_f32_16x16x32_bf16 v[64:67], a[224:227], a[0:3], v[64:67]
buffer_store_dwordx4 v[176:179], v1, s[24:27], s6 offen offset:2048 sc1
ds_read_b64_tr_b16 a[248:249], v23 offset:8192
v_mfma_f32_16x16x32_bf16 v[64:67], a[228:231], a[8:11], v[64:67]
ds_read_b64_tr_b16 a[250:251], v23 offset:10240
v_mfma_f32_16x16x32_bf16 v[68:71], a[228:231], a[12:15], v[68:71]
ds_read_b64_tr_b16 a[252:253], v23 offset:12288
v_mfma_f32_16x16x32_bf16 v[68:71], a[224:227], a[4:7], v[68:71]
s_waitcnt lgkmcnt(7)
ds_read_b64_tr_b16 a[254:255], v23 offset:14336
v_mfma_f32_16x16x32_bf16 v[76:79], a[232:235], a[4:7], v[76:79]
ds_read_b64_tr_b16 a[224:225], v20 offset:16384
v_mfma_f32_16x16x32_bf16 v[76:79], a[236:239], a[12:15], v[76:79]
ds_read_b64_tr_b16 a[226:227], v20 offset:18432
v_mfma_f32_16x16x32_bf16 v[72:75], a[236:239], a[8:11], v[72:75]
buffer_store_dwordx4 v[184:187], v1, s[24:27], s6 offen offset:3072 sc1
ds_read_b64_tr_b16 a[228:229], v20 offset:20480
v_mfma_f32_16x16x32_bf16 v[72:75], a[232:235], a[0:3], v[72:75]
s_waitcnt lgkmcnt(7)
ds_read_b64_tr_b16 a[230:231], v20 offset:22528
v_mfma_f32_16x16x32_bf16 v[80:83], a[240:243], a[0:3], v[80:83]
ds_read_b64_tr_b16 a[232:233], v21 offset:16384
v_mfma_f32_16x16x32_bf16 v[80:83], a[244:247], a[8:11], v[80:83]
ds_read_b64_tr_b16 a[234:235], v21 offset:18432
v_mfma_f32_16x16x32_bf16 v[84:87], a[244:247], a[12:15], v[84:87]
ds_read_b64_tr_b16 a[236:237], v21 offset:20480
v_mfma_f32_16x16x32_bf16 v[84:87], a[240:243], a[4:7], v[84:87]
s_waitcnt lgkmcnt(7)
buffer_load_dwordx4 a[192:195], v1, s[24:27], s54 offen offset:0 sc1
v_mfma_f32_16x16x32_bf16 v[92:95], a[248:251], a[4:7], v[92:95]
ds_read_b64_tr_b16 a[238:239], v21 offset:22528
ds_read_b64_tr_b16 a[240:241], v22 offset:16384
v_mfma_f32_16x16x32_bf16 v[92:95], a[252:255], a[12:15], v[92:95]
ds_read_b64_tr_b16 a[242:243], v22 offset:18432
v_mfma_f32_16x16x32_bf16 v[88:91], a[252:255], a[8:11], v[88:91]
ds_read_b64_tr_b16 a[244:245], v22 offset:20480
v_mfma_f32_16x16x32_bf16 v[88:91], a[248:251], a[0:3], v[88:91]
s_waitcnt lgkmcnt(7)
ds_read_b64_tr_b16 a[246:247], v22 offset:22528
v_mfma_f32_16x16x32_bf16 v[64:67], a[224:227], a[16:19], v[64:67]
buffer_load_dwordx4 a[196:199], v1, s[24:27], s54 offen offset:1024 sc1
v_mfma_f32_16x16x32_bf16 v[64:67], a[228:231], a[24:27], v[64:67]
ds_read_b64_tr_b16 a[248:249], v23 offset:16384
ds_read_b64_tr_b16 a[250:251], v23 offset:18432
v_mfma_f32_16x16x32_bf16 v[68:71], a[228:231], a[28:31], v[68:71]
ds_read_b64_tr_b16 a[252:253], v23 offset:20480
v_mfma_f32_16x16x32_bf16 v[68:71], a[224:227], a[20:23], v[68:71]
s_waitcnt vmcnt(18) lgkmcnt(7)
s_barrier
v_mfma_f32_16x16x32_bf16 v[76:79], a[232:235], a[20:23], v[76:79]
buffer_load_dwordx4 a[200:203], v1, s[24:27], s54 offen offset:2048 sc1
v_mfma_f32_16x16x32_bf16 v[76:79], a[236:239], a[28:31], v[76:79]
ds_read_b64_tr_b16 a[254:255], v23 offset:22528
ds_read_b64_tr_b16 a[224:225], v20 offset:24576
v_mfma_f32_16x16x32_bf16 v[72:75], a[236:239], a[24:27], v[72:75]
ds_read_b64_tr_b16 a[226:227], v20 offset:26624
ds_read_b64_tr_b16 a[228:229], v20 offset:28672
v_mfma_f32_16x16x32_bf16 v[72:75], a[232:235], a[16:19], v[72:75]
s_waitcnt lgkmcnt(7)
ds_read_b64_tr_b16 a[230:231], v20 offset:30720
v_mfma_f32_16x16x32_bf16 v[80:83], a[240:243], a[16:19], v[80:83]
buffer_load_dwordx4 a[204:207], v1, s[24:27], s54 offen offset:3072 sc1
v_mfma_f32_16x16x32_bf16 v[80:83], a[244:247], a[24:27], v[80:83]
ds_read_b64_tr_b16 a[232:233], v21 offset:24576
ds_read_b64_tr_b16 a[234:235], v21 offset:26624
v_mfma_f32_16x16x32_bf16 v[84:87], a[244:247], a[28:31], v[84:87]
ds_read_b64_tr_b16 a[236:237], v21 offset:28672
v_mfma_f32_16x16x32_bf16 v[84:87], a[240:243], a[20:23], v[84:87]
s_waitcnt lgkmcnt(7)
ds_read_b64_tr_b16 a[238:239], v21 offset:30720
v_mfma_f32_16x16x32_bf16 v[92:95], a[248:251], a[20:23], v[92:95]
ds_read_b64_tr_b16 a[240:241], v22 offset:24576
v_mfma_f32_16x16x32_bf16 v[92:95], a[252:255], a[28:31], v[92:95]
buffer_load_dwordx4 a[208:211], v2, s[24:27], s54 offen offset:0 sc1
v_mfma_f32_16x16x32_bf16 v[88:91], a[252:255], a[24:27], v[88:91]
ds_read_b64_tr_b16 a[242:243], v22 offset:26624
ds_read_b64_tr_b16 a[244:245], v22 offset:28672
v_mfma_f32_16x16x32_bf16 v[88:91], a[248:251], a[16:19], v[88:91]
s_waitcnt lgkmcnt(7)
ds_read_b64_tr_b16 a[246:247], v22 offset:30720
v_mfma_f32_16x16x32_bf16 v[64:67], a[224:227], a[128:131], v[64:67]
ds_read_b64_tr_b16 a[248:249], v23 offset:24576
v_mfma_f32_16x16x32_bf16 v[64:67], a[228:231], a[136:139], v[64:67]
buffer_load_dwordx4 a[212:215], v2, s[24:27], s54 offen offset:1024 sc1
v_mfma_f32_16x16x32_bf16 v[68:71], a[228:231], a[140:143], v[68:71]
ds_read_b64_tr_b16 a[250:251], v23 offset:26624
ds_read_b64_tr_b16 a[252:253], v23 offset:28672
v_mfma_f32_16x16x32_bf16 v[68:71], a[224:227], a[132:135], v[68:71]
s_waitcnt lgkmcnt(7)
ds_read_b64_tr_b16 a[254:255], v23 offset:30720
v_mfma_f32_16x16x32_bf16 v[76:79], a[232:235], a[132:135], v[76:79]
ds_read_b64_tr_b16 a[224:225], v16 offset:0
v_mfma_f32_16x16x32_bf16 v[76:79], a[236:239], a[140:143], v[76:79]
ds_read_b64_tr_b16 a[226:227], v16 offset:2048
v_mfma_f32_16x16x32_bf16 v[72:75], a[236:239], a[136:139], v[72:75]
buffer_load_dwordx4 a[216:219], v2, s[24:27], s54 offen offset:2048 sc1
v_mfma_f32_16x16x32_bf16 v[72:75], a[232:235], a[128:131], v[72:75]
s_waitcnt lgkmcnt(6)
ds_read_b64_tr_b16 a[228:229], v16 offset:4096
ds_read_b64_tr_b16 a[230:231], v16 offset:6144
v_mfma_f32_16x16x32_bf16 v[80:83], a[240:243], a[128:131], v[80:83]
ds_read_b64_tr_b16 a[232:233], v17 offset:0
v_mfma_f32_16x16x32_bf16 v[80:83], a[244:247], a[136:139], v[80:83]
ds_read_b64_tr_b16 a[234:235], v17 offset:2048
v_mfma_f32_16x16x32_bf16 v[84:87], a[244:247], a[140:143], v[84:87]
buffer_load_dwordx4 a[220:223], v2, s[24:27], s54 offen offset:3072 sc1
v_mfma_f32_16x16x32_bf16 v[84:87], a[240:243], a[132:135], v[84:87]
s_waitcnt lgkmcnt(6)
ds_read_b64_tr_b16 a[236:237], v17 offset:4096
ds_read_b64_tr_b16 a[238:239], v17 offset:6144
v_mfma_f32_16x16x32_bf16 v[92:95], a[248:251], a[132:135], v[92:95]
s_bfe_u32 s55, 0x1020001, s64
ds_read_b64_tr_b16 a[240:241], v18 offset:0
s_lshl_b32 s55, s55, 18
v_mfma_f32_16x16x32_bf16 v[92:95], a[252:255], a[140:143], v[92:95]
s_add_u32 m0, s52, 106496
ds_read_b64_tr_b16 a[242:243], v18 offset:2048
v_mfma_f32_16x16x32_bf16 v[88:91], a[252:255], a[136:139], v[88:91]
ds_read_b64_tr_b16 a[244:245], v18 offset:4096
v_mfma_f32_16x16x32_bf16 v[88:91], a[248:251], a[128:131], v[88:91]
s_waitcnt lgkmcnt(7)
buffer_load_dwordx4 v28, s[44:47], s55 offen offset:0 lds
v_mfma_f32_16x16x32_bf16 v[64:67], a[224:227], a[144:147], v[64:67]
ds_read_b64_tr_b16 a[246:247], v18 offset:6144
ds_read_b64_tr_b16 a[248:249], v19 offset:0
v_mfma_f32_16x16x32_bf16 v[64:67], a[228:231], a[152:155], v[64:67]
ds_read_b64_tr_b16 a[250:251], v19 offset:2048
v_mfma_f32_16x16x32_bf16 v[68:71], a[228:231], a[156:159], v[68:71]
ds_read_b64_tr_b16 a[252:253], v19 offset:4096
v_mfma_f32_16x16x32_bf16 v[68:71], a[224:227], a[148:151], v[68:71]
s_waitcnt lgkmcnt(7)
buffer_load_dwordx4 v29, s[44:47], s55 offen offset:1024 lds
v_mfma_f32_16x16x32_bf16 v[76:79], a[232:235], a[148:151], v[76:79]
s_xor_b32 s55, s55, 131072
ds_read_b64_tr_b16 a[254:255], v19 offset:6144
ds_read_b64_tr_b16 a[224:225], v16 offset:8192
v_mfma_f32_16x16x32_bf16 v[76:79], a[236:239], a[156:159], v[76:79]
s_add_u32 m0, s52, 114688
ds_read_b64_tr_b16 a[226:227], v16 offset:10240
v_mfma_f32_16x16x32_bf16 v[72:75], a[236:239], a[152:155], v[72:75]
ds_read_b64_tr_b16 a[228:229], v16 offset:12288
v_mfma_f32_16x16x32_bf16 v[72:75], a[232:235], a[144:147], v[72:75]
s_waitcnt lgkmcnt(7)
ds_read_b64_tr_b16 a[230:231], v16 offset:14336
v_mfma_f32_16x16x32_bf16 v[80:83], a[240:243], a[144:147], v[80:83]
buffer_load_dwordx4 v28, s[44:47], s55 offen offset:0 lds
v_mfma_f32_16x16x32_bf16 v[80:83], a[244:247], a[152:155], v[80:83]
ds_read_b64_tr_b16 a[232:233], v17 offset:8192
ds_read_b64_tr_b16 a[234:235], v17 offset:10240
v_mfma_f32_16x16x32_bf16 v[84:87], a[244:247], a[156:159], v[84:87]
ds_read_b64_tr_b16 a[236:237], v17 offset:12288
v_mfma_f32_16x16x32_bf16 v[84:87], a[240:243], a[148:151], v[84:87]
s_waitcnt lgkmcnt(7)
ds_read_b64_tr_b16 a[238:239], v17 offset:14336
v_mfma_f32_16x16x32_bf16 v[92:95], a[248:251], a[148:151], v[92:95]
buffer_load_dwordx4 v29, s[44:47], s55 offen offset:1024 lds
v_mfma_f32_16x16x32_bf16 v[92:95], a[252:255], a[156:159], v[92:95]
s_bfe_u32 s54, 0x1020001, s64
ds_read_b64_tr_b16 a[240:241], v18 offset:8192
ds_read_b64_tr_b16 a[242:243], v18 offset:10240
v_mfma_f32_16x16x32_bf16 v[88:91], a[252:255], a[152:155], v[88:91]
s_lshl_b32 s54, s54, 13
ds_read_b64_tr_b16 a[244:245], v18 offset:12288
s_add_u32 s54, s54, s71
v_mfma_f32_16x16x32_bf16 v[88:91], a[248:251], a[144:147], v[88:91]
s_waitcnt lgkmcnt(7)
ds_read_b64_tr_b16 a[246:247], v18 offset:14336
v_mfma_f32_16x16x32_bf16 v[64:67], a[224:227], a[32:35], v[64:67]
ds_read_b64_tr_b16 a[248:249], v19 offset:8192
v_mfma_f32_16x16x32_bf16 v[64:67], a[228:231], a[40:43], v[64:67]
buffer_load_dwordx4 a[160:163], v1, s[24:27], s54 offen offset:0 sc1
v_mfma_f32_16x16x32_bf16 v[68:71], a[228:231], a[44:47], v[68:71]
ds_read_b64_tr_b16 a[250:251], v19 offset:10240
ds_read_b64_tr_b16 a[252:253], v19 offset:12288
v_mfma_f32_16x16x32_bf16 v[68:71], a[224:227], a[36:39], v[68:71]
s_waitcnt lgkmcnt(7)
ds_read_b64_tr_b16 a[254:255], v19 offset:14336
v_mfma_f32_16x16x32_bf16 v[76:79], a[232:235], a[36:39], v[76:79]
ds_read_b64_tr_b16 a[224:225], v16 offset:16384
v_mfma_f32_16x16x32_bf16 v[76:79], a[236:239], a[44:47], v[76:79]
buffer_load_dwordx4 a[164:167], v1, s[24:27], s54 offen offset:1024 sc1
v_mfma_f32_16x16x32_bf16 v[72:75], a[236:239], a[40:43], v[72:75]
ds_read_b64_tr_b16 a[226:227], v16 offset:18432
ds_read_b64_tr_b16 a[228:229], v16 offset:20480
v_mfma_f32_16x16x32_bf16 v[72:75], a[232:235], a[32:35], v[72:75]
s_waitcnt lgkmcnt(7)
ds_read_b64_tr_b16 a[230:231], v16 offset:22528
v_mfma_f32_16x16x32_bf16 v[80:83], a[240:243], a[32:35], v[80:83]
ds_read_b64_tr_b16 a[232:233], v17 offset:16384
v_mfma_f32_16x16x32_bf16 v[80:83], a[244:247], a[40:43], v[80:83]
ds_read_b64_tr_b16 a[234:235], v17 offset:18432
v_mfma_f32_16x16x32_bf16 v[84:87], a[244:247], a[44:47], v[84:87]
buffer_load_dwordx4 a[168:171], v1, s[24:27], s54 offen offset:2048 sc1
v_mfma_f32_16x16x32_bf16 v[84:87], a[240:243], a[36:39], v[84:87]
s_waitcnt lgkmcnt(6)
ds_read_b64_tr_b16 a[236:237], v17 offset:20480
ds_read_b64_tr_b16 a[238:239], v17 offset:22528
v_mfma_f32_16x16x32_bf16 v[92:95], a[248:251], a[36:39], v[92:95]
s_waitcnt vmcnt(15)
ds_read_b64_tr_b16 a[240:241], v18 offset:16384
v_mfma_f32_16x16x32_bf16 v[92:95], a[252:255], a[44:47], v[92:95]
buffer_store_dword v32, v30, s[24:27], s7 offen offset:0 sc1
ds_read_b64_tr_b16 a[242:243], v18 offset:18432
s_xor_b32 s7, s7, 512
s_xor_b32 s6, s6, 32768
v_mfma_f32_16x16x32_bf16 v[88:91], a[252:255], a[40:43], v[88:91]
s_load_dword s101, s[92:93], 67200
ds_read_b64_tr_b16 a[244:245], v18 offset:20480
v_mfma_f32_16x16x32_bf16 v[88:91], a[248:251], a[32:35], v[88:91]
s_waitcnt lgkmcnt(7)
ds_read_b64_tr_b16 a[246:247], v18 offset:22528
v_mfma_f32_16x16x32_bf16 v[64:67], a[224:227], a[48:51], v[64:67]
ds_read_b64_tr_b16 a[248:249], v19 offset:16384
v_mfma_f32_16x16x32_bf16 v[64:67], a[228:231], a[56:59], v[64:67]
buffer_load_dwordx4 a[172:175], v1, s[24:27], s54 offen offset:3072 sc1
v_mfma_f32_16x16x32_bf16 v[68:71], a[228:231], a[60:63], v[68:71]
ds_read_b64_tr_b16 a[250:251], v19 offset:18432
ds_read_b64_tr_b16 a[252:253], v19 offset:20480
v_mfma_f32_16x16x32_bf16 v[68:71], a[224:227], a[52:55], v[68:71]
s_waitcnt vmcnt(25) lgkmcnt(7)
s_barrier
v_mfma_f32_16x16x32_bf16 v[76:79], a[232:235], a[52:55], v[76:79]
buffer_load_dwordx4 a[176:179], v2, s[24:27], s54 offen offset:0 sc1
v_mfma_f32_16x16x32_bf16 v[76:79], a[236:239], a[60:63], v[76:79]
ds_read_b64_tr_b16 a[254:255], v19 offset:22528
ds_read_b64_tr_b16 a[224:225], v16 offset:24576
v_mfma_f32_16x16x32_bf16 v[72:75], a[236:239], a[56:59], v[72:75]
ds_read_b64_tr_b16 a[226:227], v16 offset:26624
ds_read_b64_tr_b16 a[228:229], v16 offset:28672
v_mfma_f32_16x16x32_bf16 v[72:75], a[232:235], a[48:51], v[72:75]
s_waitcnt lgkmcnt(7)
ds_read_b64_tr_b16 a[230:231], v16 offset:30720
v_mfma_f32_16x16x32_bf16 v[80:83], a[240:243], a[48:51], v[80:83]
buffer_load_dwordx4 a[180:183], v2, s[24:27], s54 offen offset:1024 sc1
v_mfma_f32_16x16x32_bf16 v[80:83], a[244:247], a[56:59], v[80:83]
ds_read_b64_tr_b16 a[232:233], v17 offset:24576
ds_read_b64_tr_b16 a[234:235], v17 offset:26624
v_mfma_f32_16x16x32_bf16 v[84:87], a[244:247], a[60:63], v[84:87]
ds_read_b64_tr_b16 a[236:237], v17 offset:28672
v_mfma_f32_16x16x32_bf16 v[84:87], a[240:243], a[52:55], v[84:87]
s_waitcnt lgkmcnt(7)
ds_read_b64_tr_b16 a[238:239], v17 offset:30720
v_mfma_f32_16x16x32_bf16 v[92:95], a[248:251], a[52:55], v[92:95]
buffer_load_dwordx4 a[184:187], v2, s[24:27], s54 offen offset:2048 sc1
v_mfma_f32_16x16x32_bf16 v[92:95], a[252:255], a[60:63], v[92:95]
ds_read_b64_tr_b16 a[240:241], v18 offset:24576
ds_read_b64_tr_b16 a[242:243], v18 offset:26624
v_mfma_f32_16x16x32_bf16 v[88:91], a[252:255], a[56:59], v[88:91]
ds_read_b64_tr_b16 a[244:245], v18 offset:28672
v_mfma_f32_16x16x32_bf16 v[88:91], a[248:251], a[48:51], v[88:91]
s_waitcnt lgkmcnt(7)
ds_read_b64_tr_b16 a[246:247], v18 offset:30720
v_mfma_f32_16x16x32_bf16 v[64:67], a[224:227], a[64:67], v[64:67]
ds_read_b64_tr_b16 a[248:249], v19 offset:24576
v_mfma_f32_16x16x32_bf16 v[64:67], a[228:231], a[72:75], v[64:67]
buffer_load_dwordx4 a[188:191], v2, s[24:27], s54 offen offset:3072 sc1
v_mfma_f32_16x16x32_bf16 v[68:71], a[228:231], a[76:79], v[68:71]
s_bfe_u32 s55, 0x3010202, s64
ds_read_b64_tr_b16 a[250:251], v19 offset:26624
ds_read_b64_tr_b16 a[252:253], v19 offset:28672
v_mfma_f32_16x16x32_bf16 v[68:71], a[224:227], a[68:71], v[68:71]
s_waitcnt lgkmcnt(7)
ds_read_b64_tr_b16 a[254:255], v19 offset:30720
s_lshl_b32 s55, s55, 18
v_mfma_f32_16x16x32_bf16 v[76:79], a[232:235], a[68:71], v[76:79]
s_add_u32 m0, s52, 122880
ds_read_b64_tr_b16 a[224:225], v16 offset:32768
v_mfma_f32_16x16x32_bf16 v[76:79], a[236:239], a[76:79], v[76:79]
buffer_load_dwordx4 v28, s[44:47], s55 offen offset:0 lds
v_mfma_f32_16x16x32_bf16 v[72:75], a[236:239], a[72:75], v[72:75]
ds_read_b64_tr_b16 a[226:227], v16 offset:34816
ds_read_b64_tr_b16 a[228:229], v16 offset:36864
v_mfma_f32_16x16x32_bf16 v[72:75], a[232:235], a[64:67], v[72:75]
s_waitcnt lgkmcnt(7)
ds_read_b64_tr_b16 a[230:231], v16 offset:38912
v_mfma_f32_16x16x32_bf16 v[80:83], a[240:243], a[64:67], v[80:83]
ds_read_b64_tr_b16 a[232:233], v17 offset:32768
v_mfma_f32_16x16x32_bf16 v[80:83], a[244:247], a[72:75], v[80:83]
ds_read_b64_tr_b16 a[234:235], v17 offset:34816
v_mfma_f32_16x16x32_bf16 v[84:87], a[244:247], a[76:79], v[84:87]
buffer_load_dwordx4 v29, s[44:47], s55 offen offset:1024 lds
v_mfma_f32_16x16x32_bf16 v[84:87], a[240:243], a[68:71], v[84:87]
s_waitcnt lgkmcnt(6)
ds_read_b64_tr_b16 a[236:237], v17 offset:36864
ds_read_b64_tr_b16 a[238:239], v17 offset:38912
v_mfma_f32_16x16x32_bf16 v[92:95], a[248:251], a[68:71], v[92:95]
s_xor_b32 s55, s55, 131072
ds_read_b64_tr_b16 a[240:241], v18 offset:32768
s_add_u32 m0, s52, 131072
v_mfma_f32_16x16x32_bf16 v[92:95], a[252:255], a[76:79], v[92:95]
ds_read_b64_tr_b16 a[242:243], v18 offset:34816
v_mfma_f32_16x16x32_bf16 v[88:91], a[252:255], a[72:75], v[88:91]
buffer_load_dwordx4 v28, s[44:47], s55 offen offset:0 lds
v_mfma_f32_16x16x32_bf16 v[88:91], a[248:251], a[64:67], v[88:91]
s_waitcnt lgkmcnt(6)
ds_read_b64_tr_b16 a[244:245], v18 offset:36864
ds_read_b64_tr_b16 a[246:247], v18 offset:38912
v_mfma_f32_16x16x32_bf16 v[64:67], a[224:227], a[80:83], v[64:67]
ds_read_b64_tr_b16 a[248:249], v19 offset:32768
v_mfma_f32_16x16x32_bf16 v[64:67], a[228:231], a[88:91], v[64:67]
ds_read_b64_tr_b16 a[250:251], v19 offset:34816
v_mfma_f32_16x16x32_bf16 v[68:71], a[228:231], a[92:95], v[68:71]
ds_read_b64_tr_b16 a[252:253], v19 offset:36864
v_mfma_f32_16x16x32_bf16 v[68:71], a[224:227], a[84:87], v[68:71]
s_waitcnt lgkmcnt(7)
buffer_load_dwordx4 v29, s[44:47], s55 offen offset:1024 lds
v_mfma_f32_16x16x32_bf16 v[76:79], a[232:235], a[84:87], v[76:79]
buffer_load_dword v33, off, s[24:27], s7 offset:0 sc1
v_mfma_f32_16x16x32_bf16 v[76:79], a[236:239], a[92:95], v[76:79]
s_bfe_u32 s54, 0x3010202, s64
ds_read_b64_tr_b16 a[254:255], v19 offset:38912
ds_read_b64_tr_b16 a[224:225], v16 offset:40960
v_mfma_f32_16x16x32_bf16 v[72:75], a[236:239], a[88:91], v[72:75]
s_lshl_b32 s54, s54, 13
ds_read_b64_tr_b16 a[226:227], v16 offset:43008
ds_read_b64_tr_b16 a[228:229], v16 offset:45056
v_mfma_f32_16x16x32_bf16 v[72:75], a[232:235], a[80:83], v[72:75]
s_waitcnt lgkmcnt(7)
ds_read_b64_tr_b16 a[230:231], v16 offset:47104
s_add_u32 s54, s54, s71
v_mfma_f32_16x16x32_bf16 v[80:83], a[240:243], a[80:83], v[80:83]
buffer_load_dwordx4 a[128:131], v1, s[24:27], s54 offen offset:0 sc1
v_mfma_f32_16x16x32_bf16 v[80:83], a[244:247], a[88:91], v[80:83]
ds_read_b64_tr_b16 a[232:233], v17 offset:40960
ds_read_b64_tr_b16 a[234:235], v17 offset:43008
v_mfma_f32_16x16x32_bf16 v[84:87], a[244:247], a[92:95], v[84:87]
ds_read_b64_tr_b16 a[236:237], v17 offset:45056
v_mfma_f32_16x16x32_bf16 v[84:87], a[240:243], a[84:87], v[84:87]
s_waitcnt lgkmcnt(7)
ds_read_b64_tr_b16 a[238:239], v17 offset:47104
v_mfma_f32_16x16x32_bf16 v[92:95], a[248:251], a[84:87], v[92:95]
buffer_load_dwordx4 a[132:135], v1, s[24:27], s54 offen offset:1024 sc1
v_mfma_f32_16x16x32_bf16 v[92:95], a[252:255], a[92:95], v[92:95]
ds_read_b64_tr_b16 a[240:241], v18 offset:40960
ds_read_b64_tr_b16 a[242:243], v18 offset:43008
v_mfma_f32_16x16x32_bf16 v[88:91], a[252:255], a[88:91], v[88:91]
ds_read_b64_tr_b16 a[244:245], v18 offset:45056
v_mfma_f32_16x16x32_bf16 v[88:91], a[248:251], a[80:83], v[88:91]
s_waitcnt lgkmcnt(7)
ds_read_b64_tr_b16 a[246:247], v18 offset:47104
v_mfma_f32_16x16x32_bf16 v[64:67], a[224:227], a[96:99], v[64:67]
ds_read_b64_tr_b16 a[248:249], v19 offset:40960
v_mfma_f32_16x16x32_bf16 v[64:67], a[228:231], a[104:107], v[64:67]
buffer_load_dwordx4 a[136:139], v1, s[24:27], s54 offen offset:2048 sc1
v_mfma_f32_16x16x32_bf16 v[68:71], a[228:231], a[108:111], v[68:71]
ds_read_b64_tr_b16 a[250:251], v19 offset:43008
ds_read_b64_tr_b16 a[252:253], v19 offset:45056
v_mfma_f32_16x16x32_bf16 v[68:71], a[224:227], a[100:103], v[68:71]
s_waitcnt lgkmcnt(7)
ds_read_b64_tr_b16 a[254:255], v19 offset:47104
v_mfma_f32_16x16x32_bf16 v[76:79], a[232:235], a[100:103], v[76:79]
ds_read_b64_tr_b16 a[224:225], v16 offset:49152
v_mfma_f32_16x16x32_bf16 v[76:79], a[236:239], a[108:111], v[76:79]
buffer_load_dwordx4 a[140:143], v1, s[24:27], s54 offen offset:3072 sc1
v_mfma_f32_16x16x32_bf16 v[72:75], a[236:239], a[104:107], v[72:75]
ds_read_b64_tr_b16 a[226:227], v16 offset:51200
ds_read_b64_tr_b16 a[228:229], v16 offset:53248
v_mfma_f32_16x16x32_bf16 v[72:75], a[232:235], a[96:99], v[72:75]
s_waitcnt lgkmcnt(7)
ds_read_b64_tr_b16 a[230:231], v16 offset:55296
v_mfma_f32_16x16x32_bf16 v[80:83], a[240:243], a[96:99], v[80:83]
ds_read_b64_tr_b16 a[232:233], v17 offset:49152
v_mfma_f32_16x16x32_bf16 v[80:83], a[244:247], a[104:107], v[80:83]
ds_read_b64_tr_b16 a[234:235], v17 offset:51200
v_mfma_f32_16x16x32_bf16 v[84:87], a[244:247], a[108:111], v[84:87]
buffer_load_dwordx4 a[144:147], v2, s[24:27], s54 offen offset:0 sc1
v_mfma_f32_16x16x32_bf16 v[84:87], a[240:243], a[100:103], v[84:87]
s_waitcnt lgkmcnt(6)
ds_read_b64_tr_b16 a[236:237], v17 offset:53248
ds_read_b64_tr_b16 a[238:239], v17 offset:55296
v_mfma_f32_16x16x32_bf16 v[92:95], a[248:251], a[100:103], v[92:95]
ds_read_b64_tr_b16 a[240:241], v18 offset:49152
v_mfma_f32_16x16x32_bf16 v[92:95], a[252:255], a[108:111], v[92:95]
ds_read_b64_tr_b16 a[242:243], v18 offset:51200
v_mfma_f32_16x16x32_bf16 v[88:91], a[252:255], a[104:107], v[88:91]
buffer_load_dwordx4 a[148:151], v2, s[24:27], s54 offen offset:1024 sc1
v_mfma_f32_16x16x32_bf16 v[88:91], a[248:251], a[96:99], v[88:91]
s_waitcnt lgkmcnt(6)
ds_read_b64_tr_b16 a[244:245], v18 offset:53248
ds_read_b64_tr_b16 a[246:247], v18 offset:55296
v_mfma_f32_16x16x32_bf16 v[64:67], a[224:227], a[112:115], v[64:67]
ds_read_b64_tr_b16 a[248:249], v19 offset:49152
v_mfma_f32_16x16x32_bf16 v[64:67], a[228:231], a[120:123], v[64:67]
ds_read_b64_tr_b16 a[250:251], v19 offset:51200
v_mfma_f32_16x16x32_bf16 v[68:71], a[228:231], a[124:127], v[68:71]
ds_read_b64_tr_b16 a[252:253], v19 offset:53248
v_mfma_f32_16x16x32_bf16 v[68:71], a[224:227], a[116:119], v[68:71]
s_waitcnt vmcnt(34) lgkmcnt(7)
s_barrier
v_mfma_f32_16x16x32_bf16 v[76:79], a[232:235], a[116:119], v[76:79]
buffer_load_dwordx4 a[152:155], v2, s[24:27], s54 offen offset:2048 sc1
v_mfma_f32_16x16x32_bf16 v[76:79], a[236:239], a[124:127], v[76:79]
ds_read_b64_tr_b16 a[254:255], v19 offset:55296
ds_read_b64_tr_b16 a[224:225], v16 offset:57344
v_mfma_f32_16x16x32_bf16 v[72:75], a[236:239], a[120:123], v[72:75]
ds_read_b64_tr_b16 a[226:227], v16 offset:59392
ds_read_b64_tr_b16 a[228:229], v16 offset:61440
v_mfma_f32_16x16x32_bf16 v[72:75], a[232:235], a[112:115], v[72:75]
s_waitcnt lgkmcnt(7)
buffer_load_dwordx4 a[156:159], v2, s[24:27], s54 offen offset:3072 sc1
v_mfma_f32_16x16x32_bf16 v[80:83], a[240:243], a[112:115], v[80:83]
s_bfe_u32 s55, 0x2030304, s64
ds_read_b64_tr_b16 a[230:231], v16 offset:63488
ds_read_b64_tr_b16 a[232:233], v17 offset:57344
v_mfma_f32_16x16x32_bf16 v[80:83], a[244:247], a[120:123], v[80:83]
s_lshl_b32 s55, s55, 18
ds_read_b64_tr_b16 a[234:235], v17 offset:59392
s_add_u32 m0, s52, 139264
v_mfma_f32_16x16x32_bf16 v[84:87], a[244:247], a[124:127], v[84:87]
ds_read_b64_tr_b16 a[236:237], v17 offset:61440
v_mfma_f32_16x16x32_bf16 v[84:87], a[240:243], a[116:119], v[84:87]
s_waitcnt lgkmcnt(7)
buffer_load_dwordx4 v28, s[44:47], s55 offen offset:0 lds
v_mfma_f32_16x16x32_bf16 v[92:95], a[248:251], a[116:119], v[92:95]
ds_read_b64_tr_b16 a[238:239], v17 offset:63488
ds_read_b64_tr_b16 a[240:241], v18 offset:57344
v_mfma_f32_16x16x32_bf16 v[92:95], a[252:255], a[124:127], v[92:95]
ds_read_b64_tr_b16 a[242:243], v18 offset:59392
v_mfma_f32_16x16x32_bf16 v[88:91], a[252:255], a[120:123], v[88:91]
ds_read_b64_tr_b16 a[244:245], v18 offset:61440
v_mfma_f32_16x16x32_bf16 v[88:91], a[248:251], a[112:115], v[88:91]
s_waitcnt vmcnt(27) lgkmcnt(7)
ds_read_b64_tr_b16 a[246:247], v18 offset:63488
v_mfma_f32_16x16x32_bf16 v[96:99], a[224:227], a[192:195], 0
buffer_load_dwordx4 v29, s[44:47], s55 offen offset:1024 lds
v_mfma_f32_16x16x32_bf16 v[96:99], a[228:231], a[200:203], v[96:99]
s_xor_b32 s55, s55, 131072
ds_read_b64_tr_b16 a[248:249], v19 offset:57344
ds_read_b64_tr_b16 a[250:251], v19 offset:59392
v_mfma_f32_16x16x32_bf16 v[100:103], a[228:231], a[204:207], 0
s_add_u32 m0, s52, 147456
ds_read_b64_tr_b16 a[252:253], v19 offset:61440
v_mfma_f32_16x16x32_bf16 v[100:103], a[224:227], a[196:199], v[100:103]
s_waitcnt lgkmcnt(7)
ds_read_b64_tr_b16 a[254:255], v19 offset:63488
v_mfma_f32_16x16x32_bf16 v[108:111], a[232:235], a[196:199], 0
buffer_load_dwordx4 v28, s[44:47], s55 offen offset:0 lds
v_mfma_f32_16x16x32_bf16 v[108:111], a[236:239], a[204:207], v[108:111]
ds_read_b64_tr_b16 a[224:225], v20 offset:32768
ds_read_b64_tr_b16 a[226:227], v20 offset:34816
v_mfma_f32_16x16x32_bf16 v[104:107], a[236:239], a[200:203], 0
ds_read_b64_tr_b16 a[228:229], v20 offset:36864
v_mfma_f32_16x16x32_bf16 v[104:107], a[232:235], a[192:195], v[104:107]
s_waitcnt lgkmcnt(7)
ds_read_b64_tr_b16 a[230:231], v20 offset:38912
v_mfma_f32_16x16x32_bf16 v[112:115], a[240:243], a[192:195], 0
buffer_load_dwordx4 v29, s[44:47], s55 offen offset:1024 lds
v_mfma_f32_16x16x32_bf16 v[112:115], a[244:247], a[200:203], v[112:115]
s_bfe_u32 s54, 0x2030304, s64
ds_read_b64_tr_b16 a[232:233], v21 offset:32768
ds_read_b64_tr_b16 a[234:235], v21 offset:34816
v_mfma_f32_16x16x32_bf16 v[116:119], a[244:247], a[204:207], 0
s_lshl_b32 s54, s54, 13
ds_read_b64_tr_b16 a[236:237], v21 offset:36864
s_add_u32 s54, s54, s71
v_mfma_f32_16x16x32_bf16 v[116:119], a[240:243], a[196:199], v[116:119]
s_waitcnt lgkmcnt(7)
ds_read_b64_tr_b16 a[238:239], v21 offset:38912
v_mfma_f32_16x16x32_bf16 v[124:127], a[248:251], a[196:199], 0
buffer_load_dwordx4 a[0:3], v1, s[24:27], s54 offen offset:0 sc1
v_mfma_f32_16x16x32_bf16 v[124:127], a[252:255], a[204:207], v[124:127]
ds_read_b64_tr_b16 a[240:241], v22 offset:32768
ds_read_b64_tr_b16 a[242:243], v22 offset:34816
v_mfma_f32_16x16x32_bf16 v[120:123], a[252:255], a[200:203], 0
ds_read_b64_tr_b16 a[244:245], v22 offset:36864
v_mfma_f32_16x16x32_bf16 v[120:123], a[248:251], a[192:195], v[120:123]
s_waitcnt lgkmcnt(7)
ds_read_b64_tr_b16 a[246:247], v22 offset:38912
v_mfma_f32_16x16x32_bf16 v[96:99], a[224:227], a[208:211], v[96:99]
buffer_load_dwordx4 a[4:7], v1, s[24:27], s54 offen offset:1024 sc1
v_mfma_f32_16x16x32_bf16 v[96:99], a[228:231], a[216:219], v[96:99]
pg_16:
s_cbranch_execz pg_back1
ds_read_b64_tr_b16 a[248:249], v23 offset:32768
ds_read_b64_tr_b16 a[250:251], v23 offset:34816
v_mfma_f32_16x16x32_bf16 v[100:103], a[228:231], a[220:223], v[100:103]
ds_read_b64_tr_b16 a[252:253], v23 offset:36864
v_mfma_f32_16x16x32_bf16 v[100:103], a[224:227], a[212:215], v[100:103]
s_waitcnt vmcnt(28) lgkmcnt(7)
s_barrier
v_mfma_f32_16x16x32_bf16 v[108:111], a[232:235], a[212:215], v[108:111]
buffer_load_dwordx4 a[8:11], v1, s[24:27], s54 offen offset:2048 sc1
v_mfma_f32_16x16x32_bf16 v[108:111], a[236:239], a[220:223], v[108:111]
ds_read_b64_tr_b16 a[254:255], v23 offset:38912
ds_read_b64_tr_b16 a[224:225], v20 offset:40960
v_mfma_f32_16x16x32_bf16 v[104:107], a[236:239], a[216:219], v[104:107]
ds_read_b64_tr_b16 a[226:227], v20 offset:43008
ds_read_b64_tr_b16 a[228:229], v20 offset:45056
v_mfma_f32_16x16x32_bf16 v[104:107], a[232:235], a[208:211], v[104:107]
s_waitcnt lgkmcnt(7)
buffer_load_dwordx4 a[12:15], v1, s[24:27], s54 offen offset:3072 sc1
v_mfma_f32_16x16x32_bf16 v[112:115], a[240:243], a[208:211], v[112:115]
ds_read_b64_tr_b16 a[230:231], v20 offset:47104
ds_read_b64_tr_b16 a[232:233], v21 offset:40960
v_mfma_f32_16x16x32_bf16 v[112:115], a[244:247], a[216:219], v[112:115]
s_waitcnt vmcnt(16)
ds_read_b64_tr_b16 a[234:235], v21 offset:43008
v_cmp_ne_u32 vcc, v33, v32
s_nop 0
s_cbranch_vccnz ckE_spin
ckE_ok:
v_mfma_f32_16x16x32_bf16 v[116:119], a[244:247], a[220:223], v[116:119]
ds_read_b64_tr_b16 a[236:237], v21 offset:45056
v_mfma_f32_16x16x32_bf16 v[116:119], a[240:243], a[212:215], v[116:119]
s_waitcnt lgkmcnt(7)
buffer_load_dwordx4 v[224:227], v1, s[24:27], s6 offen offset:0 sc1
v_mfma_f32_16x16x32_bf16 v[124:127], a[248:251], a[212:215], v[124:127]
ds_read_b64_tr_b16 a[238:239], v21 offset:47104
ds_read_b64_tr_b16 a[240:241], v22 offset:40960
v_mfma_f32_16x16x32_bf16 v[124:127], a[252:255], a[220:223], v[124:127]
ds_read_b64_tr_b16 a[242:243], v22 offset:43008
v_mfma_f32_16x16x32_bf16 v[120:123], a[252:255], a[216:219], v[120:123]
ds_read_b64_tr_b16 a[244:245], v22 offset:45056
v_mfma_f32_16x16x32_bf16 v[120:123], a[248:251], a[208:211], v[120:123]
s_waitcnt lgkmcnt(7)
buffer_load_dwordx4 v[228:231], v1, s[24:27], s6 offen offset:1024 sc1
v_mfma_f32_16x16x32_bf16 v[96:99], a[224:227], a[160:163], v[96:99]
ds_read_b64_tr_b16 a[246:247], v22 offset:47104
ds_read_b64_tr_b16 a[248:249], v23 offset:40960
v_mfma_f32_16x16x32_bf16 v[96:99], a[228:231], a[168:171], v[96:99]
ds_read_b64_tr_b16 a[250:251], v23 offset:43008
v_mfma_f32_16x16x32_bf16 v[100:103], a[228:231], a[172:175], v[100:103]
ds_read_b64_tr_b16 a[252:253], v23 offset:45056
v_mfma_f32_16x16x32_bf16 v[100:103], a[224:227], a[164:167], v[100:103]
s_waitcnt lgkmcnt(7)
buffer_load_dwordx4 v[232:235], v1, s[24:27], s6 offen offset:2048 sc1
v_mfma_f32_16x16x32_bf16 v[108:111], a[232:235], a[164:167], v[108:111]
ds_read_b64_tr_b16 a[254:255], v23 offset:47104
ds_read_b64_tr_b16 a[224:225], v20 offset:49152
v_mfma_f32_16x16x32_bf16 v[108:111], a[236:239], a[172:175], v[108:111]
ds_read_b64_tr_b16 a[226:227], v20 offset:51200
v_mfma_f32_16x16x32_bf16 v[104:107], a[236:239], a[168:171], v[104:107]
ds_read_b64_tr_b16 a[228:229], v20 offset:53248
v_mfma_f32_16x16x32_bf16 v[104:107], a[232:235], a[160:163], v[104:107]
s_waitcnt lgkmcnt(7)
buffer_load_dwordx4 v[236:239], v1, s[24:27], s6 offen offset:3072 sc1
v_mfma_f32_16x16x32_bf16 v[112:115], a[240:243], a[160:163], v[112:115]
ds_read_b64_tr_b16 a[230:231], v20 offset:55296
ds_read_b64_tr_b16 a[232:233], v21 offset:49152
v_mfma_f32_16x16x32_bf16 v[112:115], a[244:247], a[168:171], v[112:115]
ds_read_b64_tr_b16 a[234:235], v21 offset:51200
v_mfma_f32_16x16x32_bf16 v[116:119], a[244:247], a[172:175], v[116:119]
ds_read_b64_tr_b16 a[236:237], v21 offset:53248
v_mfma_f32_16x16x32_bf16 v[116:119], a[240:243], a[164:167], v[116:119]
s_waitcnt lgkmcnt(7)
buffer_load_dwordx4 a[16:19], v2, s[24:27], s54 offen offset:0 sc1
v_mfma_f32_16x16x32_bf16 v[124:127], a[248:251], a[164:167], v[124:127]
ds_read_b64_tr_b16 a[238:239], v21 offset:55296
ds_read_b64_tr_b16 a[240:241], v22 offset:49152
v_mfma_f32_16x16x32_bf16 v[124:127], a[252:255], a[172:175], v[124:127]
ds_read_b64_tr_b16 a[242:243], v22 offset:51200
v_mfma_f32_16x16x32_bf16 v[120:123], a[252:255], a[168:171], v[120:123]
ds_read_b64_tr_b16 a[244:245], v22 offset:53248
v_mfma_f32_16x16x32_bf16 v[120:123], a[248:251], a[160:163], v[120:123]
s_waitcnt lgkmcnt(7)
buffer_load_dwordx4 a[20:23], v2, s[24:27], s54 offen offset:1024 sc1
v_mfma_f32_16x16x32_bf16 v[96:99], a[224:227], a[176:179], v[96:99]
ds_read_b64_tr_b16 a[246:247], v22 offset:55296
ds_read_b64_tr_b16 a[248:249], v23 offset:49152
v_mfma_f32_16x16x32_bf16 v[96:99], a[228:231], a[184:187], v[96:99]
ds_read_b64_tr_b16 a[250:251], v23 offset:51200
v_mfma_f32_16x16x32_bf16 v[100:103], a[228:231], a[188:191], v[100:103]
ds_read_b64_tr_b16 a[252:253], v23 offset:53248
v_mfma_f32_16x16x32_bf16 v[100:103], a[224:227], a[180:183], v[100:103]
s_waitcnt vmcnt(23) lgkmcnt(7)
s_barrier
v_mfma_f32_16x16x32_bf16 v[108:111], a[232:235], a[180:183], v[108:111]
buffer_load_dwordx4 a[24:27], v2, s[24:27], s54 offen offset:2048 sc1
v_mfma_f32_16x16x32_bf16 v[108:111], a[236:239], a[188:191], v[108:111]
ds_read_b64_tr_b16 a[254:255], v23 offset:55296
ds_read_b64_tr_b16 a[224:225], v20 offset:57344
v_mfma_f32_16x16x32_bf16 v[104:107], a[236:239], a[184:187], v[104:107]
buffer_load_dwordx4 a[28:31], v2, s[24:27], s54 offen offset:3072 sc1
v_mfma_f32_16x16x32_bf16 v[104:107], a[232:235], a[176:179], v[104:107]
s_waitcnt lgkmcnt(5)
ds_read_b64_tr_b16 a[226:227], v20 offset:59392
ds_read_b64_tr_b16 a[228:229], v20 offset:61440
v_mfma_f32_16x16x32_bf16 v[112:115], a[240:243], a[176:179], v[112:115]
s_bfe_u32 s55, 0x4040503, s64
ds_read_b64_tr_b16 a[230:231], v20 offset:63488
ds_read_b64_tr_b16 a[232:233], v21 offset:57344
v_mfma_f32_16x16x32_bf16 v[112:115], a[244:247], a[184:187], v[112:115]
s_lshl_b32 s55, s55, 18
ds_read_b64_tr_b16 a[234:235], v21 offset:59392
s_add_u32 m0, s52, 65536
v_mfma_f32_16x16x32_bf16 v[116:119], a[244:247], a[188:191], v[116:119]
buffer_load_dwordx4 v28, s[44:47], s55 offen offset:0 lds
v_mfma_f32_16x16x32_bf16 v[116:119], a[240:243], a[180:183], v[116:119]
s_waitcnt lgkmcnt(6)
ds_read_b64_tr_b16 a[236:237], v21 offset:61440
ds_read_b64_tr_b16 a[238:239], v21 offset:63488
v_mfma_f32_16x16x32_bf16 v[124:127], a[248:251], a[180:183], v[124:127]
ds_read_b64_tr_b16 a[240:241], v22 offset:57344
v_mfma_f32_16x16x32_bf16 v[124:127], a[252:255], a[188:191], v[124:127]
ds_read_b64_tr_b16 a[242:243], v22 offset:59392
v_mfma_f32_16x16x32_bf16 v[120:123], a[252:255], a[184:187], v[120:123]
buffer_load_dwordx4 v29, s[44:47], s55 offen offset:1024 lds
v_mfma_f32_16x16x32_bf16 v[120:123], a[248:251], a[176:179], v[120:123]
s_waitcnt vmcnt(18) lgkmcnt(6)
ds_read_b64_tr_b16 a[244:245], v22 offset:61440
ds_read_b64_tr_b16 a[246:247], v22 offset:63488
v_mfma_f32_16x16x32_bf16 v[96:99], a[224:227], a[128:131], v[96:99]
s_xor_b32 s55, s55, 131072
ds_read_b64_tr_b16 a[248:249], v23 offset:57344
s_add_u32 m0, s52, 73728
v_mfma_f32_16x16x32_bf16 v[96:99], a[228:231], a[136:139], v[96:99]
ds_read_b64_tr_b16 a[250:251], v23 offset:59392
v_mfma_f32_16x16x32_bf16 v[100:103], a[228:231], a[140:143], v[100:103]
buffer_load_dwordx4 v28, s[44:47], s55 offen offset:0 lds
v_mfma_f32_16x16x32_bf16 v[100:103], a[224:227], a[132:135], v[100:103]
s_waitcnt lgkmcnt(6)
ds_read_b64_tr_b16 a[252:253], v23 offset:61440
ds_read_b64_tr_b16 a[254:255], v23 offset:63488
v_mfma_f32_16x16x32_bf16 v[108:111], a[232:235], a[132:135], v[108:111]
ds_read_b64_tr_b16 a[224:225], v24 offset:0
v_mfma_f32_16x16x32_bf16 v[108:111], a[236:239], a[140:143], v[108:111]
ds_read_b64_tr_b16 a[226:227], v24 offset:2048
v_mfma_f32_16x16x32_bf16 v[104:107], a[236:239], a[136:139], v[104:107]
buffer_load_dwordx4 v29, s[44:47], s55 offen offset:1024 lds
v_mfma_f32_16x16x32_bf16 v[104:107], a[232:235], a[128:131], v[104:107]
s_waitcnt lgkmcnt(6)
ds_read_b64_tr_b16 a[228:229], v24 offset:4096
ds_read_b64_tr_b16 a[230:231], v24 offset:6144
v_mfma_f32_16x16x32_bf16 v[112:115], a[240:243], a[128:131], v[112:115]
s_bfe_u32 s54, 0x4040503, s64
ds_read_b64_tr_b16 a[232:233], v25 offset:0
s_lshl_b32 s54, s54, 13
v_mfma_f32_16x16x32_bf16 v[112:115], a[244:247], a[136:139], v[112:115]
s_add_u32 s54, s54, s71
ds_read_b64_tr_b16 a[234:235], v25 offset:2048
v_mfma_f32_16x16x32_bf16 v[116:119], a[244:247], a[140:143], v[116:119]
buffer_load_dwordx4 a[160:163], v1, s[24:27], s54 offen offset:0 sc1
v_mfma_f32_16x16x32_bf16 v[116:119], a[240:243], a[132:135], v[116:119]
s_waitcnt lgkmcnt(6)
ds_read_b64_tr_b16 a[236:237], v25 offset:4096
ds_read_b64_tr_b16 a[238:239], v25 offset:6144
v_mfma_f32_16x16x32_bf16 v[124:127], a[248:251], a[132:135], v[124:127]
ds_read_b64_tr_b16 a[240:241], v26 offset:0
v_mfma_f32_16x16x32_bf16 v[124:127], a[252:255], a[140:143], v[124:127]
ds_read_b64_tr_b16 a[242:243], v26 offset:2048
v_mfma_f32_16x16x32_bf16 v[120:123], a[252:255], a[136:139], v[120:123]
buffer_load_dwordx4 a[164:167], v1, s[24:27], s54 offen offset:1024 sc1
v_mfma_f32_16x16x32_bf16 v[120:123], a[248:251], a[128:131], v[120:123]
s_waitcnt lgkmcnt(6)
ds_read_b64_tr_b16 a[244:245], v26 offset:4096
ds_read_b64_tr_b16 a[246:247], v26 offset:6144
v_mfma_f32_16x16x32_bf16 v[96:99], a[224:227], a[144:147], v[96:99]
ds_read_b64_tr_b16 a[248:249], v27 offset:0
v_mfma_f32_16x16x32_bf16 v[96:99], a[228:231], a[152:155], v[96:99]
ds_read_b64_tr_b16 a[250:251], v27 offset:2048
v_mfma_f32_16x16x32_bf16 v[100:103], a[228:231], a[156:159], v[100:103]
buffer_load_dwordx4 a[168:171], v1, s[24:27], s54 offen offset:2048 sc1
v_mfma_f32_16x16x32_bf16 v[100:103], a[224:227], a[148:151], v[100:103]
s_waitcnt vmcnt(19) lgkmcnt(6)
s_barrier
v_mfma_f32_16x16x32_bf16 v[108:111], a[232:235], a[148:151], v[108:111]
ds_read_b64_tr_b16 a[252:253], v27 offset:4096
ds_read_b64_tr_b16 a[254:255], v27 offset:6144
v_mfma_f32_16x16x32_bf16 v[108:111], a[236:239], a[156:159], v[108:111]
ds_read_b64_tr_b16 a[224:225], v24 offset:8192
ds_read_b64_tr_b16 a[226:227], v24 offset:10240
v_mfma_f32_16x16x32_bf16 v[104:107], a[236:239], a[152:155], v[104:107]
buffer_load_dwordx4 a[172:175], v1, s[24:27], s54 offen offset:3072 sc1
v_mfma_f32_16x16x32_bf16 v[104:107], a[232:235], a[144:147], v[104:107]
s_waitcnt lgkmcnt(6)
ds_read_b64_tr_b16 a[228:229], v24 offset:12288
ds_read_b64_tr_b16 a[230:231], v24 offset:14336
v_mfma_f32_16x16x32_bf16 v[112:115], a[240:243], a[144:147], v[112:115]
s_waitcnt vmcnt(15)
ds_read_b64_tr_b16 a[232:233], v25 offset:8192
v_mfma_f32_16x16x16_bf16 v[64:67], v[38:39], v[224:225], v[64:67]
v_mfma_f32_16x16x16_bf16 v[68:71], v[38:39], v[226:227], v[68:71]
s_waitcnt vmcnt(14)
buffer_load_dwordx4 a[176:179], v2, s[24:27], s54 offen offset:0 sc1
v_mfma_f32_16x16x16_bf16 v[72:75], v[38:39], v[228:229], v[72:75]
v_mfma_f32_16x16x16_bf16 v[76:79], v[38:39], v[230:231], v[76:79]
s_waitcnt vmcnt(14)
v_mfma_f32_16x16x16_bf16 v[80:83], v[38:39], v[232:233], v[80:83]
v_mfma_f32_16x16x16_bf16 v[84:87], v[38:39], v[234:235], v[84:87]
s_waitcnt vmcnt(13)
buffer_load_dwordx4 a[180:183], v2, s[24:27], s54 offen offset:1024 sc1
v_mfma_f32_16x16x16_bf16 v[88:91], v[38:39], v[236:237], v[88:91]
v_mul_f32 v160, s57, v64
v_mul_f32 v161, s57, v65
v_mfma_f32_16x16x16_bf16 v[92:95], v[38:39], v[238:239], v[92:95]
v_exp_f32 v160, v160
v_mfma_f32_16x16x32_bf16 v[112:115], a[244:247], a[152:155], v[112:115]
ds_read_b64_tr_b16 a[234:235], v25 offset:10240
v_exp_f32 v161, v161
v_mfma_f32_16x16x32_bf16 v[116:119], a[244:247], a[156:159], v[116:119]
ds_read_b64_tr_b16 a[236:237], v25 offset:12288
buffer_load_dwordx4 a[184:187], v2, s[24:27], s54 offen offset:2048 sc1
v_mfma_f32_16x16x32_bf16 v[116:119], a[240:243], a[148:151], v[116:119]
s_waitcnt lgkmcnt(7)
ds_read_b64_tr_b16 a[238:239], v25 offset:14336
v_mul_f32 v162, s57, v66
v_mul_f32 v163, s57, v67
v_mfma_f32_16x16x32_bf16 v[124:127], a[248:251], a[148:151], v[124:127]
ds_read_b64_tr_b16 a[240:241], v26 offset:8192
v_exp_f32 v162, v162
v_mfma_f32_16x16x32_bf16 v[124:127], a[252:255], a[156:159], v[124:127]
ds_read_b64_tr_b16 a[242:243], v26 offset:10240
buffer_load_dwordx4 a[188:191], v2, s[24:27], s54 offen offset:3072 sc1
v_mfma_f32_16x16x32_bf16 v[120:123], a[252:255], a[152:155], v[120:123]
s_bfe_u32 s55, 0x5060405, s64
ds_read_b64_tr_b16 a[244:245], v26 offset:12288
v_exp_f32 v163, v163
v_mfma_f32_16x16x32_bf16 v[120:123], a[248:251], a[144:147], v[120:123]
s_waitcnt vmcnt(12) lgkmcnt(7)
ds_read_b64_tr_b16 a[246:247], v26 offset:14336
s_lshl_b32 s55, s55, 18
v_mul_f32 v164, s57, v68
v_mfma_f32_16x16x32_bf16 v[96:99], a[224:227], a[0:3], v[96:99]
s_add_u32 m0, s52, 81920
ds_read_b64_tr_b16 a[248:249], v27 offset:8192
v_exp_f32 v164, v164
v_mfma_f32_16x16x32_bf16 v[96:99], a[228:231], a[8:11], v[96:99]
ds_read_b64_tr_b16 a[250:251], v27 offset:10240
buffer_load_dwordx4 v28, s[44:47], s55 offen offset:0 lds
v_mfma_f32_16x16x32_bf16 v[100:103], a[228:231], a[12:15], v[100:103]
ds_read_b64_tr_b16 a[252:253], v27 offset:12288
v_mul_f32 v165, s57, v69
v_mul_f32 v166, s57, v70
v_mfma_f32_16x16x32_bf16 v[100:103], a[224:227], a[4:7], v[100:103]
s_waitcnt lgkmcnt(7)
ds_read_b64_tr_b16 a[254:255], v27 offset:14336
buffer_load_dwordx4 v29, s[44:47], s55 offen offset:1024 lds
v_mfma_f32_16x16x32_bf16 v[108:111], a[232:235], a[4:7], v[108:111]
s_xor_b32 s55, s55, 131072
ds_read_b64_tr_b16 a[224:225], v24 offset:16384
v_exp_f32 v165, v165
v_mfma_f32_16x16x32_bf16 v[108:111], a[236:239], a[12:15], v[108:111]
s_add_u32 m0, s52, 90112
ds_read_b64_tr_b16 a[226:227], v24 offset:18432
v_exp_f32 v166, v166
v_mfma_f32_16x16x32_bf16 v[104:107], a[236:239], a[8:11], v[104:107]
ds_read_b64_tr_b16 a[228:229], v24 offset:20480
buffer_load_dwordx4 v28, s[44:47], s55 offen offset:0 lds
v_mfma_f32_16x16x32_bf16 v[104:107], a[232:235], a[0:3], v[104:107]
s_waitcnt lgkmcnt(7)
ds_read_b64_tr_b16 a[230:231], v24 offset:22528
v_mul_f32 v167, s57, v71
v_add_f32 v160, 1.0, v160
v_mfma_f32_16x16x32_bf16 v[112:115], a[240:243], a[0:3], v[112:115]
ds_read_b64_tr_b16 a[232:233], v25 offset:16384
v_exp_f32 v167, v167
v_mfma_f32_16x16x32_bf16 v[112:115], a[244:247], a[8:11], v[112:115]
ds_read_b64_tr_b16 a[234:235], v25 offset:18432
v_rcp_f32 v160, v160
v_mfma_f32_16x16x32_bf16 v[116:119], a[244:247], a[12:15], v[116:119]
ds_read_b64_tr_b16 a[236:237], v25 offset:20480
buffer_load_dwordx4 v29, s[44:47], s55 offen offset:1024 lds
v_mfma_f32_16x16x32_bf16 v[116:119], a[240:243], a[4:7], v[116:119]
s_waitcnt lgkmcnt(7)
ds_read_b64_tr_b16 a[238:239], v25 offset:22528
s_bfe_u32 s54, 0x5060405, s64
v_add_f32 v161, 1.0, v161
v_mfma_f32_16x16x32_bf16 v[124:127], a[248:251], a[4:7], v[124:127]
s_lshl_b32 s54, s54, 13
ds_read_b64_tr_b16 a[240:241], v26 offset:16384
v_rcp_f32 v161, v161
v_mfma_f32_16x16x32_bf16 v[124:127], a[252:255], a[12:15], v[124:127]
s_add_u32 s54, s54, s71
ds_read_b64_tr_b16 a[242:243], v26 offset:18432
v_add_f32 v162, 1.0, v162
v_add_f32 v163, 1.0, v163
v_mfma_f32_16x16x32_bf16 v[120:123], a[252:255], a[8:11], v[120:123]
s_load_dword s101, s[92:93], 67200
ds_read_b64_tr_b16 a[244:245], v26 offset:20480
buffer_load_dwordx4 a[128:131], v1, s[24:27], s54 offen offset:0 sc1
v_mfma_f32_16x16x32_bf16 v[120:123], a[248:251], a[0:3], v[120:123]
s_waitcnt lgkmcnt(7)
ds_read_b64_tr_b16 a[246:247], v26 offset:22528
v_rcp_f32 v162, v162
v_mfma_f32_16x16x32_bf16 v[96:99], a[224:227], a[16:19], v[96:99]
ds_read_b64_tr_b16 a[248:249], v27 offset:16384
buffer_load_dwordx4 a[132:135], v1, s[24:27], s54 offen offset:1024 sc1
v_mfma_f32_16x16x32_bf16 v[96:99], a[228:231], a[24:27], v[96:99]
ds_read_b64_tr_b16 a[250:251], v27 offset:18432
v_rcp_f32 v163, v163
v_mfma_f32_16x16x32_bf16 v[100:103], a[228:231], a[28:31], v[100:103]
ds_read_b64_tr_b16 a[252:253], v27 offset:20480
v_add_f32 v164, 1.0, v164
v_add_f32 v165, 1.0, v165
v_mfma_f32_16x16x32_bf16 v[100:103], a[224:227], a[20:23], v[100:103]
s_waitcnt vmcnt(14) lgkmcnt(7)
s_barrier
v_add_f32 v166, 1.0, v166
v_mfma_f32_16x16x32_bf16 v[108:111], a[232:235], a[20:23], v[108:111]
ds_read_b64_tr_b16 a[254:255], v27 offset:22528
buffer_load_dwordx4 a[136:139], v1, s[24:27], s54 offen offset:2048 sc1
v_mfma_f32_16x16x32_bf16 v[108:111], a[236:239], a[28:31], v[108:111]
ds_read_b64_tr_b16 a[224:225], v20 offset:0
v_rcp_f32 v164, v164
v_mfma_f32_16x16x32_bf16 v[104:107], a[236:239], a[24:27], v[104:107]
ds_read_b64_tr_b16 a[226:227], v20 offset:2048
buffer_load_dwordx4 a[140:143], v1, s[24:27], s54 offen offset:3072 sc1
v_mfma_f32_16x16x32_bf16 v[104:107], a[232:235], a[16:19], v[104:107]
s_waitcnt lgkmcnt(6)
ds_read_b64_tr_b16 a[228:229], v20 offset:4096
v_rcp_f32 v165, v165
v_mfma_f32_16x16x32_bf16 v[112:115], a[240:243], a[16:19], v[112:115]
ds_read_b64_tr_b16 a[230:231], v20 offset:6144
v_rcp_f32 v166, v166
v_mfma_f32_16x16x32_bf16 v[112:115], a[244:247], a[24:27], v[112:115]
ds_read_b64_tr_b16 a[232:233], v21 offset:0
buffer_load_dwordx4 a[144:147], v2, s[24:27], s54 offen offset:0 sc1
v_mfma_f32_16x16x32_bf16 v[116:119], a[244:247], a[28:31], v[116:119]
ds_read_b64_tr_b16 a[234:235], v21 offset:2048
v_add_f32 v167, 1.0, v167
v_mul_f32 v64, v64, v160
v_mfma_f32_16x16x32_bf16 v[116:119], a[240:243], a[20:23], v[116:119]
s_waitcnt lgkmcnt(6)
ds_read_b64_tr_b16 a[236:237], v21 offset:4096
v_rcp_f32 v167, v167
v_mfma_f32_16x16x32_bf16 v[124:127], a[248:251], a[20:23], v[124:127]
ds_read_b64_tr_b16 a[238:239], v21 offset:6144
v_mul_f32 v65, v65, v161
v_mul_f32 v66, v66, v162
v_mfma_f32_16x16x32_bf16 v[124:127], a[252:255], a[28:31], v[124:127]
ds_read_b64_tr_b16 a[240:241], v22 offset:0
buffer_load_dwordx4 a[148:151], v2, s[24:27], s54 offen offset:1024 sc1
v_mfma_f32_16x16x32_bf16 v[120:123], a[252:255], a[24:27], v[120:123]
ds_read_b64_tr_b16 a[242:243], v22 offset:2048
v_mul_f32 v67, v67, v163
v_mul_f32 v68, v68, v164
v_mfma_f32_16x16x32_bf16 v[120:123], a[248:251], a[16:19], v[120:123]
s_waitcnt vmcnt(10) lgkmcnt(6)
ds_read_b64_tr_b16 a[244:245], v22 offset:4096
v_mul_f32 v69, v69, v165
v_mul_f32 v70, v70, v166
v_mfma_f32_16x16x32_bf16 v[96:99], a[224:227], a[160:163], v[96:99]
ds_read_b64_tr_b16 a[246:247], v22 offset:6144
buffer_load_dwordx4 a[152:155], v2, s[24:27], s54 offen offset:2048 sc1
v_mfma_f32_16x16x32_bf16 v[96:99], a[228:231], a[168:171], v[96:99]
ds_read_b64_tr_b16 a[248:249], v23 offset:0
v_mul_f32 v71, v71, v167
v_mul_f32 v168, s57, v72
v_mfma_f32_16x16x32_bf16 v[100:103], a[228:231], a[172:175], v[100:103]
ds_read_b64_tr_b16 a[250:251], v23 offset:2048
v_exp_f32 v168, v168
v_mfma_f32_16x16x32_bf16 v[100:103], a[224:227], a[164:167], v[100:103]
s_waitcnt lgkmcnt(6)
ds_read_b64_tr_b16 a[252:253], v23 offset:4096
buffer_load_dwordx4 a[156:159], v2, s[24:27], s54 offen offset:3072 sc1
v_mfma_f32_16x16x32_bf16 v[108:111], a[232:235], a[164:167], v[108:111]
s_bfe_u32 s55, 0x7050606, s64
ds_read_b64_tr_b16 a[254:255], v23 offset:6144
v_mul_f32 v169, s57, v73
v_mul_f32 v170, s57, v74
v_mfma_f32_16x16x32_bf16 v[108:111], a[236:239], a[172:175], v[108:111]
s_lshl_b32 s55, s55, 18
ds_read_b64_tr_b16 a[224:225], v20 offset:8192
v_exp_f32 v169, v169
v_mfma_f32_16x16x32_bf16 v[104:107], a[236:239], a[168:171], v[104:107]
s_add_u32 m0, s52, 0
ds_read_b64_tr_b16 a[226:227], v20 offset:10240
v_exp_f32 v170, v170
v_mfma_f32_16x16x32_bf16 v[104:107], a[232:235], a[160:163], v[104:107]
s_waitcnt lgkmcnt(6)
ds_read_b64_tr_b16 a[228:229], v20 offset:12288
buffer_load_dwordx4 v28, s[44:47], s55 offen offset:0 lds
v_mfma_f32_16x16x32_bf16 v[112:115], a[240:243], a[160:163], v[112:115]
ds_read_b64_tr_b16 a[230:231], v20 offset:14336
v_mul_f32 v171, s57, v75
v_mul_f32 v172, s57, v76
v_mfma_f32_16x16x32_bf16 v[112:115], a[244:247], a[168:171], v[112:115]
ds_read_b64_tr_b16 a[232:233], v21 offset:8192
buffer_load_dwordx4 v29, s[44:47], s55 offen offset:1024 lds
v_mfma_f32_16x16x32_bf16 v[116:119], a[244:247], a[172:175], v[116:119]
s_xor_b32 s55, s55, 131072
ds_read_b64_tr_b16 a[234:235], v21 offset:10240
v_exp_f32 v171, v171
v_mfma_f32_16x16x32_bf16 v[116:119], a[240:243], a[164:167], v[116:119]
s_waitcnt lgkmcnt(6)
ds_read_b64_tr_b16 a[236:237], v21 offset:12288
v_exp_f32 v172, v172
v_mfma_f32_16x16x32_bf16 v[124:127], a[248:251], a[164:167], v[124:127]
s_add_u32 m0, s52, 8192
ds_read_b64_tr_b16 a[238:239], v21 offset:14336
v_mul_f32 v173, s57, v77
v_mul_f32 v174, s57, v78
v_mfma_f32_16x16x32_bf16 v[124:127], a[252:255], a[172:175], v[124:127]
ds_read_b64_tr_b16 a[240:241], v22 offset:8192
buffer_load_dwordx4 v28, s[44:47], s55 offen offset:0 lds
v_mfma_f32_16x16x32_bf16 v[120:123], a[252:255], a[168:171], v[120:123]
ds_read_b64_tr_b16 a[242:243], v22 offset:10240
v_exp_f32 v173, v173
v_mfma_f32_16x16x32_bf16 v[120:123], a[248:251], a[160:163], v[120:123]
s_waitcnt lgkmcnt(6)
ds_read_b64_tr_b16 a[244:245], v22 offset:12288
v_exp_f32 v174, v174
v_mfma_f32_16x16x32_bf16 v[96:99], a[224:227], a[176:179], v[96:99]
ds_read_b64_tr_b16 a[246:247], v22 offset:14336
buffer_load_dwordx4 v29, s[44:47], s55 offen offset:1024 lds
v_mfma_f32_16x16x32_bf16 v[96:99], a[228:231], a[184:187], v[96:99]
s_bfe_u32 s54, 0x7050606, s64
ds_read_b64_tr_b16 a[248:249], v23 offset:8192
v_mul_f32 v175, s57, v79
v_add_f32 v168, 1.0, v168
v_mfma_f32_16x16x32_bf16 v[100:103], a[228:231], a[188:191], v[100:103]
s_lshl_b32 s54, s54, 13
ds_read_b64_tr_b16 a[250:251], v23 offset:10240
v_exp_f32 v175, v175
v_mfma_f32_16x16x32_bf16 v[100:103], a[224:227], a[180:183], v[100:103]
s_waitcnt vmcnt(12) lgkmcnt(6)
s_barrier
s_add_u32 s54, s54, s71
v_mfma_f32_16x16x32_bf16 v[108:111], a[232:235], a[180:183], v[108:111]
ds_read_b64_tr_b16 a[252:253], v23 offset:12288
ds_read_b64_tr_b16 a[254:255], v23 offset:14336
v_add_f32 v169, 1.0, v169
v_mfma_f32_16x16x32_bf16 v[108:111], a[236:239], a[188:191], v[108:111]
ds_read_b64_tr_b16 a[224:225], v20 offset:16384
buffer_load_dwordx4 a[192:195], v1, s[24:27], s54 offen offset:0 sc1
v_mfma_f32_16x16x32_bf16 v[104:107], a[236:239], a[184:187], v[104:107]
ds_read_b64_tr_b16 a[226:227], v20 offset:18432
v_rcp_f32 v168, v168
v_mfma_f32_16x16x32_bf16 v[104:107], a[232:235], a[176:179], v[104:107]
s_waitcnt lgkmcnt(6)
ds_read_b64_tr_b16 a[228:229], v20 offset:20480
buffer_load_dwordx4 a[196:199], v1, s[24:27], s54 offen offset:1024 sc1
v_mfma_f32_16x16x32_bf16 v[112:115], a[240:243], a[176:179], v[112:115]
ds_read_b64_tr_b16 a[230:231], v20 offset:22528
v_rcp_f32 v169, v169
v_mfma_f32_16x16x32_bf16 v[112:115], a[244:247], a[184:187], v[112:115]
ds_read_b64_tr_b16 a[232:233], v21 offset:16384
v_add_f32 v170, 1.0, v170
v_add_f32 v171, 1.0, v171
v_mfma_f32_16x16x32_bf16 v[116:119], a[244:247], a[188:191], v[116:119]
ds_read_b64_tr_b16 a[234:235], v21 offset:18432
buffer_load_dwordx4 a[200:203], v1, s[24:27], s54 offen offset:2048 sc1
v_mfma_f32_16x16x32_bf16 v[116:119], a[240:243], a[180:183], v[116:119]
s_waitcnt lgkmcnt(6)
ds_read_b64_tr_b16 a[236:237], v21 offset:20480
v_rcp_f32 v170, v170
v_mfma_f32_16x16x32_bf16 v[124:127], a[248:251], a[180:183], v[124:127]
ds_read_b64_tr_b16 a[238:239], v21 offset:22528
v_rcp_f32 v171, v171
v_mfma_f32_16x16x32_bf16 v[124:127], a[252:255], a[188:191], v[124:127]
ds_read_b64_tr_b16 a[240:241], v22 offset:16384
v_add_f32 v172, 1.0, v172
v_add_f32 v173, 1.0, v173
v_mfma_f32_16x16x32_bf16 v[120:123], a[252:255], a[184:187], v[120:123]
ds_read_b64_tr_b16 a[242:243], v22 offset:18432
buffer_load_dwordx4 a[204:207], v1, s[24:27], s54 offen offset:3072 sc1
v_mfma_f32_16x16x32_bf16 v[120:123], a[248:251], a[176:179], v[120:123]
s_waitcnt vmcnt(8) lgkmcnt(6)
ds_read_b64_tr_b16 a[244:245], v22 offset:20480
v_rcp_f32 v172, v172
v_mfma_f32_16x16x32_bf16 v[96:99], a[224:227], a[128:131], v[96:99]
ds_read_b64_tr_b16 a[246:247], v22 offset:22528
v_rcp_f32 v173, v173
v_mfma_f32_16x16x32_bf16 v[96:99], a[228:231], a[136:139], v[96:99]
ds_read_b64_tr_b16 a[248:249], v23 offset:16384
buffer_load_dwordx4 a[208:211], v2, s[24:27], s54 offen offset:0 sc1
v_mfma_f32_16x16x32_bf16 v[100:103], a[228:231], a[140:143], v[100:103]
ds_read_b64_tr_b16 a[250:251], v23 offset:18432
v_add_f32 v174, 1.0, v174
v_add_f32 v175, 1.0, v175
v_mfma_f32_16x16x32_bf16 v[100:103], a[224:227], a[132:135], v[100:103]
s_waitcnt lgkmcnt(6)
ds_read_b64_tr_b16 a[252:253], v23 offset:20480
v_rcp_f32 v174, v174
v_mfma_f32_16x16x32_bf16 v[108:111], a[232:235], a[132:135], v[108:111]
ds_read_b64_tr_b16 a[254:255], v23 offset:22528
buffer_load_dwordx4 a[212:215], v2, s[24:27], s54 offen offset:1024 sc1
v_mfma_f32_16x16x32_bf16 v[108:111], a[236:239], a[140:143], v[108:111]
ds_read_b64_tr_b16 a[224:225], v20 offset:24576
v_rcp_f32 v175, v175
v_mfma_f32_16x16x32_bf16 v[104:107], a[236:239], a[136:139], v[104:107]
ds_read_b64_tr_b16 a[226:227], v20 offset:26624
v_mul_f32 v72, v72, v168
v_mul_f32 v73, v73, v169
v_mfma_f32_16x16x32_bf16 v[104:107], a[232:235], a[128:131], v[104:107]
s_waitcnt lgkmcnt(6)
ds_read_b64_tr_b16 a[228:229], v20 offset:28672
buffer_load_dwordx4 a[216:219], v2, s[24:27], s54 offen offset:2048 sc1
v_mfma_f32_16x16x32_bf16 v[112:115], a[240:243], a[128:131], v[112:115]
ds_read_b64_tr_b16 a[230:231], v20 offset:30720
v_mul_f32 v74, v74, v170
v_mul_f32 v75, v75, v171
v_mfma_f32_16x16x32_bf16 v[112:115], a[244:247], a[136:139], v[112:115]
ds_read_b64_tr_b16 a[232:233], v21 offset:24576
v_mul_f32 v76, v76, v172
v_mul_f32 v77, v77, v173
v_mfma_f32_16x16x32_bf16 v[116:119], a[244:247], a[140:143], v[116:119]
ds_read_b64_tr_b16 a[234:235], v21 offset:26624
buffer_load_dwordx4 a[220:223], v2, s[24:27], s54 offen offset:3072 sc1
v_mfma_f32_16x16x32_bf16 v[116:119], a[240:243], a[132:135], v[116:119]
s_waitcnt lgkmcnt(6)
ds_read_b64_tr_b16 a[236:237], v21 offset:28672
v_mul_f32 v78, v78, v174
v_mul_f32 v79, v79, v175
v_mfma_f32_16x16x32_bf16 v[124:127], a[248:251], a[132:135], v[124:127]
s_bfe_u32 s55, 0x6070707, s64
ds_read_b64_tr_b16 a[238:239], v21 offset:30720
v_mul_f32 v176, s57, v80
v_mul_f32 v177, s57, v81
v_mfma_f32_16x16x32_bf16 v[124:127], a[252:255], a[140:143], v[124:127]
s_lshl_b32 s55, s55, 18
ds_read_b64_tr_b16 a[240:241], v22 offset:24576
v_exp_f32 v176, v176
v_mfma_f32_16x16x32_bf16 v[120:123], a[252:255], a[136:139], v[120:123]
s_add_u32 m0, s52, 16384
ds_read_b64_tr_b16 a[242:243], v22 offset:26624
v_exp_f32 v177, v177
v_mfma_f32_16x16x32_bf16 v[120:123], a[248:251], a[128:131], v[120:123]
s_waitcnt lgkmcnt(6)
ds_read_b64_tr_b16 a[244:245], v22 offset:28672
buffer_load_dwordx4 v28, s[44:47], s55 offen offset:0 lds
v_mfma_f32_16x16x32_bf16 v[96:99], a[224:227], a[144:147], v[96:99]
ds_read_b64_tr_b16 a[246:247], v22 offset:30720
v_mul_f32 v178, s57, v82
v_mul_f32 v179, s57, v83
v_mfma_f32_16x16x32_bf16 v[96:99], a[228:231], a[152:155], v[96:99]
ds_read_b64_tr_b16 a[248:249], v23 offset:24576
buffer_load_dwordx4 v29, s[44:47], s55 offen offset:1024 lds
v_mfma_f32_16x16x32_bf16 v[100:103], a[228:231], a[156:159], v[100:103]
s_xor_b32 s55, s55, 131072
ds_read_b64_tr_b16 a[250:251], v23 offset:26624
v_exp_f32 v178, v178
v_mfma_f32_16x16x32_bf16 v[100:103], a[224:227], a[148:151], v[100:103]
s_waitcnt vmcnt(10) lgkmcnt(6)
s_barrier
v_mul_f32 v180, s57, v84
v_mfma_f32_16x16x32_bf16 v[108:111], a[232:235], a[148:151], v[108:111]
s_add_u32 m0, s52, 24576
ds_read_b64_tr_b16 a[252:253], v23 offset:28672
ds_read_b64_tr_b16 a[254:255], v23 offset:30720
v_mul_f32 v181, s57, v85
v_mfma_f32_16x16x32_bf16 v[108:111], a[236:239], a[156:159], v[108:111]
ds_read_b64_tr_b16 a[224:225], v16 offset:0
buffer_load_dwordx4 v28, s[44:47], s55 offen offset:0 lds
v_mfma_f32_16x16x32_bf16 v[104:107], a[236:239], a[152:155], v[104:107]
ds_read_b64_tr_b16 a[226:227], v16 offset:2048
v_exp_f32 v179, v179
v_mfma_f32_16x16x32_bf16 v[104:107], a[232:235], a[144:147], v[104:107]
s_waitcnt lgkmcnt(6)
ds_read_b64_tr_b16 a[228:229], v16 offset:4096
buffer_load_dwordx4 v29, s[44:47], s55 offen offset:1024 lds
v_mfma_f32_16x16x32_bf16 v[112:115], a[240:243], a[144:147], v[112:115]
s_bfe_u32 s54, 0x6070707, s64
ds_read_b64_tr_b16 a[230:231], v16 offset:6144
v_exp_f32 v180, v180
v_mfma_f32_16x16x32_bf16 v[112:115], a[244:247], a[152:155], v[112:115]
s_lshl_b32 s54, s54, 13
ds_read_b64_tr_b16 a[232:233], v17 offset:0
v_exp_f32 v181, v181
v_mfma_f32_16x16x32_bf16 v[116:119], a[244:247], a[156:159], v[116:119]
s_add_u32 s54, s54, s71
ds_read_b64_tr_b16 a[234:235], v17 offset:2048
v_mul_f32 v182, s57, v86
v_mul_f32 v183, s57, v87
v_mfma_f32_16x16x32_bf16 v[116:119], a[240:243], a[148:151], v[116:119]
s_waitcnt lgkmcnt(6)
ds_read_b64_tr_b16 a[236:237], v17 offset:4096
buffer_load_dwordx4 a[160:163], v1, s[24:27], s54 offen offset:0 sc1
v_mfma_f32_16x16x32_bf16 v[124:127], a[248:251], a[148:151], v[124:127]
ds_read_b64_tr_b16 a[238:239], v17 offset:6144
v_exp_f32 v182, v182
v_mfma_f32_16x16x32_bf16 v[124:127], a[252:255], a[156:159], v[124:127]
ds_read_b64_tr_b16 a[240:241], v18 offset:0
v_exp_f32 v183, v183
v_mfma_f32_16x16x32_bf16 v[120:123], a[252:255], a[152:155], v[120:123]
pg_17:
s_cbranch_execz pg_back1
ds_read_b64_tr_b16 a[242:243], v18 offset:2048
buffer_load_dwordx4 a[164:167], v1, s[24:27], s54 offen offset:1024 sc1
v_mfma_f32_16x16x32_bf16 v[120:123], a[248:251], a[144:147], v[120:123]
s_waitcnt vmcnt(6) lgkmcnt(6)
ds_read_b64_tr_b16 a[244:245], v18 offset:4096
v_add_f32 v176, 1.0, v176
v_add_f32 v177, 1.0, v177
v_mfma_f32_16x16x32_bf16 v[96:99], a[224:227], a[192:195], v[96:99]
ds_read_b64_tr_b16 a[246:247], v18 offset:6144
v_rcp_f32 v176, v176
v_mfma_f32_16x16x32_bf16 v[96:99], a[228:231], a[200:203], v[96:99]
ds_read_b64_tr_b16 a[248:249], v19 offset:0
buffer_load_dwordx4 a[168:171], v1, s[24:27], s54 offen offset:2048 sc1
v_mfma_f32_16x16x32_bf16 v[100:103], a[228:231], a[204:207], v[100:103]
ds_read_b64_tr_b16 a[250:251], v19 offset:2048
v_rcp_f32 v177, v177
v_mfma_f32_16x16x32_bf16 v[100:103], a[224:227], a[196:199], v[100:103]
s_waitcnt lgkmcnt(6)
ds_read_b64_tr_b16 a[252:253], v19 offset:4096
v_add_f32 v178, 1.0, v178
v_add_f32 v179, 1.0, v179
v_mfma_f32_16x16x32_bf16 v[108:111], a[232:235], a[196:199], v[108:111]
ds_read_b64_tr_b16 a[254:255], v19 offset:6144
buffer_load_dwordx4 a[172:175], v1, s[24:27], s54 offen offset:3072 sc1
v_mfma_f32_16x16x32_bf16 v[108:111], a[236:239], a[204:207], v[108:111]
ds_read_b64_tr_b16 a[224:225], v16 offset:8192
v_rcp_f32 v178, v178
v_mfma_f32_16x16x32_bf16 v[104:107], a[236:239], a[200:203], v[104:107]
ds_read_b64_tr_b16 a[226:227], v16 offset:10240
v_rcp_f32 v179, v179
v_mfma_f32_16x16x32_bf16 v[104:107], a[232:235], a[192:195], v[104:107]
s_waitcnt lgkmcnt(6)
ds_read_b64_tr_b16 a[228:229], v16 offset:12288
buffer_load_dwordx4 a[176:179], v2, s[24:27], s54 offen offset:0 sc1
v_mfma_f32_16x16x32_bf16 v[112:115], a[240:243], a[192:195], v[112:115]
ds_read_b64_tr_b16 a[230:231], v16 offset:14336
v_add_f32 v180, 1.0, v180
v_add_f32 v181, 1.0, v181
v_mfma_f32_16x16x32_bf16 v[112:115], a[244:247], a[200:203], v[112:115]
ds_read_b64_tr_b16 a[232:233], v17 offset:8192
v_rcp_f32 v180, v180
v_mfma_f32_16x16x32_bf16 v[116:119], a[244:247], a[204:207], v[116:119]
ds_read_b64_tr_b16 a[234:235], v17 offset:10240
buffer_load_dwordx4 a[180:183], v2, s[24:27], s54 offen offset:1024 sc1
v_mfma_f32_16x16x32_bf16 v[116:119], a[240:243], a[196:199], v[116:119]
s_waitcnt lgkmcnt(6)
ds_read_b64_tr_b16 a[236:237], v17 offset:12288
v_rcp_f32 v181, v181
v_mfma_f32_16x16x32_bf16 v[124:127], a[248:251], a[196:199], v[124:127]
ds_read_b64_tr_b16 a[238:239], v17 offset:14336
v_add_f32 v182, 1.0, v182
v_add_f32 v183, 1.0, v183
v_mfma_f32_16x16x32_bf16 v[124:127], a[252:255], a[204:207], v[124:127]
ds_read_b64_tr_b16 a[240:241], v18 offset:8192
v_rcp_f32 v182, v182
v_mfma_f32_16x16x32_bf16 v[120:123], a[252:255], a[200:203], v[120:123]
ds_read_b64_tr_b16 a[242:243], v18 offset:10240
buffer_load_dwordx4 a[184:187], v2, s[24:27], s54 offen offset:2048 sc1
v_mfma_f32_16x16x32_bf16 v[120:123], a[248:251], a[192:195], v[120:123]
s_waitcnt lgkmcnt(6)
ds_read_b64_tr_b16 a[244:245], v18 offset:12288
v_rcp_f32 v183, v183
v_mfma_f32_16x16x32_bf16 v[96:99], a[224:227], a[208:211], v[96:99]
ds_read_b64_tr_b16 a[246:247], v18 offset:14336
v_mul_f32 v80, v80, v176
v_mul_f32 v81, v81, v177
v_mfma_f32_16x16x32_bf16 v[96:99], a[228:231], a[216:219], v[96:99]
ds_read_b64_tr_b16 a[248:249], v19 offset:8192
buffer_load_dwordx4 a[188:191], v2, s[24:27], s54 offen offset:3072 sc1
v_mfma_f32_16x16x32_bf16 v[100:103], a[228:231], a[220:223], v[100:103]
ds_read_b64_tr_b16 a[250:251], v19 offset:10240
v_mul_f32 v82, v82, v178
v_mul_f32 v83, v83, v179
v_mfma_f32_16x16x32_bf16 v[100:103], a[224:227], a[212:215], v[100:103]
s_waitcnt vmcnt(8) lgkmcnt(6)
s_barrier
v_mul_f32 v84, v84, v180
v_mfma_f32_16x16x32_bf16 v[108:111], a[232:235], a[212:215], v[108:111]
ds_read_b64_tr_b16 a[252:253], v19 offset:12288
ds_read_b64_tr_b16 a[254:255], v19 offset:14336
v_mul_f32 v85, v85, v181
v_mfma_f32_16x16x32_bf16 v[108:111], a[236:239], a[220:223], v[108:111]
ds_read_b64_tr_b16 a[224:225], v16 offset:16384
v_mul_f32 v86, v86, v182
v_mul_f32 v87, v87, v183
v_mfma_f32_16x16x32_bf16 v[104:107], a[236:239], a[216:219], v[104:107]
ds_read_b64_tr_b16 a[226:227], v16 offset:18432
v_mul_f32 v184, s57, v88
v_mul_f32 v185, s57, v89
v_mfma_f32_16x16x32_bf16 v[104:107], a[232:235], a[208:211], v[104:107]
s_waitcnt lgkmcnt(6)
ds_read_b64_tr_b16 a[228:229], v16 offset:20480
v_exp_f32 v184, v184
v_mfma_f32_16x16x32_bf16 v[112:115], a[240:243], a[208:211], v[112:115]
ds_read_b64_tr_b16 a[230:231], v16 offset:22528
v_exp_f32 v185, v185
v_mfma_f32_16x16x32_bf16 v[112:115], a[244:247], a[216:219], v[112:115]
ds_read_b64_tr_b16 a[232:233], v17 offset:16384
v_mul_f32 v186, s57, v90
v_mul_f32 v187, s57, v91
v_mfma_f32_16x16x32_bf16 v[116:119], a[244:247], a[220:223], v[116:119]
ds_read_b64_tr_b16 a[234:235], v17 offset:18432
v_exp_f32 v186, v186
v_mfma_f32_16x16x32_bf16 v[116:119], a[240:243], a[212:215], v[116:119]
s_waitcnt lgkmcnt(6)
ds_read_b64_tr_b16 a[236:237], v17 offset:20480
v_exp_f32 v187, v187
v_mfma_f32_16x16x32_bf16 v[124:127], a[248:251], a[212:215], v[124:127]
ds_read_b64_tr_b16 a[238:239], v17 offset:22528
v_mul_f32 v188, s57, v92
v_mul_f32 v189, s57, v93
v_mfma_f32_16x16x32_bf16 v[124:127], a[252:255], a[220:223], v[124:127]
ds_read_b64_tr_b16 a[240:241], v16 offset:24576
v_exp_f32 v188, v188
v_mfma_f32_16x16x32_bf16 v[120:123], a[252:255], a[216:219], v[120:123]
ds_read_b64_tr_b16 a[242:243], v16 offset:26624
v_exp_f32 v189, v189
v_mfma_f32_16x16x32_bf16 v[120:123], a[248:251], a[208:211], v[120:123]
s_waitcnt vmcnt(0) lgkmcnt(6)
ds_read_b64_tr_b16 a[244:245], v16 offset:28672
v_mul_f32 v190, s57, v94
v_mul_f32 v191, s57, v95
v_mfma_f32_16x16x32_bf16 v[96:99], a[224:227], a[160:163], v[96:99]
ds_read_b64_tr_b16 a[246:247], v16 offset:30720
v_exp_f32 v190, v190
v_mfma_f32_16x16x32_bf16 v[96:99], a[228:231], a[168:171], v[96:99]
ds_read_b64_tr_b16 a[248:249], v17 offset:24576
v_exp_f32 v191, v191
v_mfma_f32_16x16x32_bf16 v[100:103], a[228:231], a[172:175], v[100:103]
ds_read_b64_tr_b16 a[250:251], v17 offset:26624
v_add_f32 v184, 1.0, v184
v_add_f32 v185, 1.0, v185
v_mfma_f32_16x16x32_bf16 v[100:103], a[224:227], a[164:167], v[100:103]
s_waitcnt lgkmcnt(6)
ds_read_b64_tr_b16 a[252:253], v17 offset:28672
v_rcp_f32 v184, v184
v_mfma_f32_16x16x32_bf16 v[108:111], a[232:235], a[164:167], v[108:111]
ds_read_b64_tr_b16 a[254:255], v17 offset:30720
v_rcp_f32 v185, v185
v_mfma_f32_16x16x32_bf16 v[108:111], a[236:239], a[172:175], v[108:111]
ds_read_b64_tr_b16 a[224:225], v18 offset:16384
v_add_f32 v186, 1.0, v186
v_add_f32 v187, 1.0, v187
v_mfma_f32_16x16x32_bf16 v[104:107], a[236:239], a[168:171], v[104:107]
ds_read_b64_tr_b16 a[226:227], v18 offset:18432
v_rcp_f32 v186, v186
v_mfma_f32_16x16x32_bf16 v[104:107], a[232:235], a[160:163], v[104:107]
s_waitcnt lgkmcnt(6)
ds_read_b64_tr_b16 a[228:229], v18 offset:20480
v_rcp_f32 v187, v187
v_mfma_f32_16x16x32_bf16 v[96:99], a[240:243], a[176:179], v[96:99]
ds_read_b64_tr_b16 a[230:231], v18 offset:22528
v_add_f32 v188, 1.0, v188
v_add_f32 v189, 1.0, v189
v_mfma_f32_16x16x32_bf16 v[96:99], a[244:247], a[184:187], v[96:99]
ds_read_b64_tr_b16 a[232:233], v19 offset:16384
v_rcp_f32 v188, v188
v_mfma_f32_16x16x32_bf16 v[100:103], a[244:247], a[188:191], v[100:103]
ds_read_b64_tr_b16 a[234:235], v19 offset:18432
v_rcp_f32 v189, v189
v_mfma_f32_16x16x32_bf16 v[100:103], a[240:243], a[180:183], v[100:103]
s_waitcnt lgkmcnt(6)
ds_read_b64_tr_b16 a[236:237], v19 offset:20480
v_add_f32 v190, 1.0, v190
v_add_f32 v191, 1.0, v191
v_mfma_f32_16x16x32_bf16 v[108:111], a[248:251], a[180:183], v[108:111]
ds_read_b64_tr_b16 a[238:239], v19 offset:22528
v_rcp_f32 v190, v190
v_mfma_f32_16x16x32_bf16 v[108:111], a[252:255], a[188:191], v[108:111]
ds_read_b64_tr_b16 a[240:241], v18 offset:24576
v_rcp_f32 v191, v191
v_mfma_f32_16x16x32_bf16 v[104:107], a[252:255], a[184:187], v[104:107]
ds_read_b64_tr_b16 a[242:243], v18 offset:26624
v_mul_f32 v88, v88, v184
v_mul_f32 v89, v89, v185
v_mfma_f32_16x16x32_bf16 v[104:107], a[248:251], a[176:179], v[104:107]
s_waitcnt lgkmcnt(6)
ds_read_b64_tr_b16 a[244:245], v18 offset:28672
v_mul_f32 v90, v90, v186
v_mul_f32 v91, v91, v187
v_mfma_f32_16x16x32_bf16 v[112:115], a[224:227], a[160:163], v[112:115]
ds_read_b64_tr_b16 a[246:247], v18 offset:30720
v_mul_f32 v92, v92, v188
v_mul_f32 v93, v93, v189
v_mfma_f32_16x16x32_bf16 v[112:115], a[228:231], a[168:171], v[112:115]
ds_read_b64_tr_b16 a[248:249], v19 offset:24576
v_mul_f32 v94, v94, v190
v_mul_f32 v95, v95, v191
v_mfma_f32_16x16x32_bf16 v[116:119], a[228:231], a[172:175], v[116:119]
ds_read_b64_tr_b16 a[250:251], v19 offset:26624
v_fma_f32 v192, v96, v64, v192
v_fma_f32 v193, v97, v65, v193
v_mfma_f32_16x16x32_bf16 v[116:119], a[224:227], a[164:167], v[116:119]
s_waitcnt lgkmcnt(6)
ds_read_b64_tr_b16 a[252:253], v19 offset:28672
v_fma_f32 v194, v98, v66, v194
v_fma_f32 v195, v99, v67, v195
v_mfma_f32_16x16x32_bf16 v[124:127], a[232:235], a[164:167], v[124:127]
ds_read_b64_tr_b16 a[254:255], v19 offset:30720
v_fma_f32 v196, v100, v68, v196
v_fma_f32 v197, v101, v69, v197
v_mfma_f32_16x16x32_bf16 v[124:127], a[236:239], a[172:175], v[124:127]
v_fma_f32 v198, v102, v70, v198
v_fma_f32 v199, v103, v71, v199
v_cvt_pk_bf16_f32 v4, v192, v193
v_mfma_f32_16x16x32_bf16 v[120:123], a[236:239], a[168:171], v[120:123]
v_cvt_pk_bf16_f32 v5, v194, v195
v_cvt_pk_bf16_f32 v8, v196, v197
v_cvt_pk_bf16_f32 v9, v198, v199
v_mfma_f32_16x16x32_bf16 v[120:123], a[232:235], a[160:163], v[120:123]
s_waitcnt lgkmcnt(4)
v_fma_f32 v200, v104, v72, v200
v_fma_f32 v201, v105, v73, v201
v_fma_f32 v202, v106, v74, v202
v_mfma_f32_16x16x32_bf16 v[112:115], a[240:243], a[176:179], v[112:115]
v_fma_f32 v203, v107, v75, v203
v_fma_f32 v204, v108, v76, v204
v_fma_f32 v205, v109, v77, v205
v_mfma_f32_16x16x32_bf16 v[112:115], a[244:247], a[184:187], v[112:115]
v_fma_f32 v206, v110, v78, v206
v_fma_f32 v207, v111, v79, v207
v_cvt_pk_bf16_f32 v6, v200, v201
v_mfma_f32_16x16x32_bf16 v[116:119], a[244:247], a[188:191], v[116:119]
v_cvt_pk_bf16_f32 v7, v202, v203
v_permlane16_swap_b32 v4, v6
v_mfma_f32_16x16x32_bf16 v[116:119], a[240:243], a[180:183], v[116:119]
s_waitcnt lgkmcnt(0)
v_cvt_pk_bf16_f32 v10, v204, v205
v_permlane16_swap_b32 v5, v7
v_mfma_f32_16x16x32_bf16 v[124:127], a[248:251], a[180:183], v[124:127]
buffer_store_dwordx4 v[4:7], v34, s[48:51], s65 offen offset:0 sc0 sc1
v_cvt_pk_bf16_f32 v11, v206, v207
v_permlane16_swap_b32 v8, v10
v_mfma_f32_16x16x32_bf16 v[124:127], a[252:255], a[188:191], v[124:127]
v_permlane16_swap_b32 v9, v11
v_mfma_f32_16x16x32_bf16 v[120:123], a[252:255], a[184:187], v[120:123]
v_mfma_f32_16x16x32_bf16 v[120:123], a[248:251], a[176:179], v[120:123]
buffer_store_dwordx4 v[8:11], v34, s[48:51], s5 offen offset:0 sc0 sc1
v_pk_fma_f32 v[208:209], v[112:113], v[80:81], v[208:209]
v_pk_fma_f32 v[210:211], v[114:115], v[82:83], v[210:211]
v_pk_fma_f32 v[212:213], v[116:117], v[84:85], v[212:213]
v_pk_fma_f32 v[214:215], v[118:119], v[86:87], v[214:215]
v_cvt_pk_bf16_f32 v12, v208, v209
v_cvt_pk_bf16_f32 v13, v210, v211
v_cvt_pk_bf16_f32 v56, v212, v213
v_cvt_pk_bf16_f32 v57, v214, v215
v_pk_fma_f32 v[216:217], v[120:121], v[88:89], v[216:217]
v_pk_fma_f32 v[218:219], v[122:123], v[90:91], v[218:219]
v_pk_fma_f32 v[220:221], v[124:125], v[92:93], v[220:221]
v_pk_fma_f32 v[222:223], v[126:127], v[94:95], v[222:223]
v_cvt_pk_bf16_f32 v14, v216, v217
v_cvt_pk_bf16_f32 v15, v218, v219
v_cvt_pk_bf16_f32 v58, v220, v221
v_cvt_pk_bf16_f32 v59, v222, v223
v_permlane16_swap_b32 v12, v14
v_permlane16_swap_b32 v13, v15
v_permlane16_swap_b32 v56, v58
v_permlane16_swap_b32 v57, v59
buffer_store_dwordx4 v[12:15], v34, s[48:51], s65 offen offset:64 sc0 sc1
buffer_store_dwordx4 v[56:59], v34, s[48:51], s5 offen offset:64 sc0 sc1
k_done:
s_endpgm
ckH_spin:
s_mov_b32 s98, 131072
ckH_again:
s_sleep 1
buffer_load_dword v33, v31, s[24:27], s62 offen offset:0 sc1
s_waitcnt vmcnt(0)
v_cmp_ne_u32 vcc, v33, v32
s_sub_u32 s98, s98, 1
s_cbranch_scc1 ckH_ok
s_cbranch_vccnz ckH_again
s_branch ckH_ok
ckS_spin:
s_mov_b32 s98, 131072
ckS_again:
s_sleep 1
buffer_load_dword v33, v31, s[24:27], s62 offen offset:128 sc1
s_waitcnt vmcnt(0)
v_cmp_ne_u32 vcc, v33, v32
s_sub_u32 s98, s98, 1
s_cbranch_scc1 ckS_ok
s_cbranch_vccnz ckS_again
s_branch ckS_ok
ckK_spin:
s_mov_b32 s98, 131072
ckK_again:
s_sleep 1
buffer_load_dword v33, v55, s[24:27], s6 offen offset:0 sc1
s_waitcnt vmcnt(0)
v_cmp_ne_u32 vcc, v33, v32
s_sub_u32 s98, s98, 1
s_cbranch_scc1 ckK_ok
s_cbranch_vccnz ckK_again
s_branch ckK_ok
ckO_spin:
s_mov_b32 s98, 131072
ckO_again:
s_sleep 1
buffer_load_dword v33, v31, s[24:27], s62 offen offset:256 sc1
s_waitcnt vmcnt(0)
v_cmp_ne_u32 vcc, v33, v32
s_sub_u32 s98, s98, 1
s_cbranch_scc1 ckO_ok
s_cbranch_vccnz ckO_again
s_branch ckO_ok
ckE_spin:
s_mov_b32 s98, 131072
ckE_again:
s_sleep 1
buffer_load_dword v33, off, s[24:27], s7 offset:0 sc1
s_waitcnt vmcnt(0)
v_cmp_ne_u32 vcc, v33, v32
s_sub_u32 s98, s98, 1
s_cbranch_scc1 ckE_ok
s_cbranch_vccnz ckE_again
s_branch ckE_ok

.p2align 12
s_nop 0
s_nop 0
s_nop 0
pg_8_b:
s_cbranch_execz pg_12_b
v_exp_f32 v169, v169
v_mfma_f32_16x16x32_bf16 a[44:47], a[240:243], a[144:147], a[44:47]
buffer_load_dwordx4 v[104:107], v1, s[24:27], s54 offen offset:2048 sc1
v_mfma_f32_16x16x32_bf16 a[44:47], a[244:247], a[148:151], a[44:47]
ds_read_b64_tr_b16 a[236:237], v7 offset:49152
v_add_f32 v61, v168, v169
v_mfma_f32_16x16x32_bf16 a[60:63], a[244:247], a[156:159], a[60:63]
ds_read_b64_tr_b16 a[238:239], v7 offset:53248
v_add_f32 v62, v62, v180
v_mfma_f32_16x16x32_bf16 a[60:63], a[240:243], a[152:155], a[60:63]
s_waitcnt lgkmcnt(8)
v_exp_f32 v186, v186
v_add_f32 v60, v60, v165
v_mfma_f32_16x16x32_bf16 a[124:127], a[248:251], a[152:155], a[124:127]
buffer_load_dwordx4 v[108:111], v1, s[24:27], s54 offen offset:3072 sc1
v_mfma_f32_16x16x32_bf16 a[124:127], a[252:255], a[156:159], a[124:127]
ds_read_b64_tr_b16 a[240:241], v11 offset:41984
v_add_f32 v63, v63, v186
v_mfma_f32_16x16x32_bf16 a[116:119], a[252:255], a[148:151], a[116:119]
ds_read_b64_tr_b16 a[242:243], v11 offset:43520
v_add_f32 v62, v62, v181
v_mfma_f32_16x16x32_bf16 a[116:119], a[248:251], a[144:147], a[116:119]
v_exp_f32 v170, v170
v_mfma_f32_16x16x32_bf16 a[108:111], a[248:251], a[136:139], a[108:111]
buffer_load_dwordx4 v[112:115], v2, s[24:27], s54 offen offset:0 sc1
v_mfma_f32_16x16x32_bf16 a[108:111], a[252:255], a[140:143], a[108:111]
ds_read_b64_tr_b16 a[244:245], v11 offset:46080
v_add_f32 v61, v61, v170
v_mfma_f32_16x16x32_bf16 a[100:103], a[252:255], a[132:135], a[100:103]
ds_read_b64_tr_b16 a[246:247], v11 offset:47616
v_add_f32 v60, v60, v166
v_mfma_f32_16x16x32_bf16 a[100:103], a[248:251], a[128:131], a[100:103]
s_waitcnt vmcnt(29) lgkmcnt(8)
buffer_load_dword v33, v31, s[24:27], s62 offen offset:0 sc1
v_add_f32 v62, v62, v182
v_mfma_f32_16x16x32_bf16 a[64:67], a[224:227], a[192:195], a[64:67]
ds_read_b64_tr_b16 a[248:249], v11 offset:42016
v_add_f32 v60, v60, v167
v_mfma_f32_16x16x32_bf16 a[64:67], a[228:231], a[196:199], a[64:67]
buffer_load_dwordx4 v[116:119], v2, s[24:27], s54 offen offset:1024 sc1
v_mfma_f32_16x16x32_bf16 a[72:75], a[228:231], a[204:207], a[72:75]
ds_read_b64_tr_b16 a[250:251], v11 offset:43552
v_add_f32 v62, v62, v183
v_mfma_f32_16x16x32_bf16 a[72:75], a[224:227], a[200:203], a[72:75]
v_exp_f32 v187, v187
v_mfma_f32_16x16x32_bf16 a[80:83], a[224:227], a[208:211], a[80:83]
ds_read_b64_tr_b16 a[252:253], v11 offset:46112
v_add_f32 v63, v63, v187
v_mfma_f32_16x16x32_bf16 a[80:83], a[228:231], a[212:215], a[80:83]
v_exp_f32 v171, v171
v_mfma_f32_16x16x32_bf16 a[88:91], a[228:231], a[220:223], a[88:91]
buffer_load_dwordx4 v[120:123], v2, s[24:27], s54 offen offset:2048 sc1
v_mfma_f32_16x16x32_bf16 a[88:91], a[224:227], a[216:219], a[88:91]
s_waitcnt lgkmcnt(7)
ds_read_b64_tr_b16 a[254:255], v11 offset:47648
v_exp_f32 v188, v188
v_mfma_f32_16x16x32_bf16 a[92:95], a[232:235], a[216:219], a[92:95]
ds_read_b64_tr_b16 a[224:225], v11 offset:42048
v_add_f32 v61, v61, v171
v_mfma_f32_16x16x32_bf16 a[92:95], a[236:239], a[220:223], a[92:95]
v_exp_f32 v172, v172
v_mfma_f32_16x16x32_bf16 a[84:87], a[236:239], a[212:215], a[84:87]
buffer_load_dwordx4 v[124:127], v2, s[24:27], s54 offen offset:3072 sc1
v_mfma_f32_16x16x32_bf16 a[84:87], a[232:235], a[208:211], a[84:87]
s_bfe_u32 s55, 0x2000000, s99
ds_read_b64_tr_b16 a[226:227], v11 offset:43584
v_add_f32 v61, v61, v172
v_mfma_f32_16x16x32_bf16 a[76:79], a[232:235], a[200:203], a[76:79]
s_lshl4_add_u32 m0, s55, s100
ds_read_b64_tr_b16 a[228:229], v11 offset:46144
v_add_f32 v63, v63, v188
v_mfma_f32_16x16x32_bf16 a[76:79], a[236:239], a[204:207], a[76:79]
s_mov_b32 s55, 458752
v_exp_f32 v189, v189
v_mfma_f32_16x16x32_bf16 a[68:71], a[236:239], a[196:199], a[68:71]
s_mov_b32 s56, 393216
ds_read_b64_tr_b16 a[230:231], v11 offset:47680
v_add_f32 v63, v63, v189
v_mfma_f32_16x16x32_bf16 a[68:71], a[232:235], a[192:195], a[68:71]
s_waitcnt lgkmcnt(8)
buffer_load_dwordx4 v15, s[12:15], s56 offen offset:0 lds
v_mfma_f32_16x16x32_bf16 a[0:3], a[240:243], a[192:195], a[0:3]
ds_read_b64_tr_b16 a[232:233], v11 offset:50176
ds_read_b64_tr_b16 a[234:235], v11 offset:51712
v_mfma_f32_16x16x32_bf16 a[0:3], a[244:247], a[196:199], a[0:3]
v_exp_f32 v173, v173
v_mfma_f32_16x16x32_bf16 a[16:19], a[244:247], a[204:207], a[16:19]
v_exp_f32 v190, v190
v_mfma_f32_16x16x32_bf16 a[16:19], a[240:243], a[200:203], a[16:19]
v_exp_f32 v174, v174
v_mfma_f32_16x16x32_bf16 a[32:35], a[240:243], a[208:211], a[32:35]
ds_read_b64_tr_b16 a[236:237], v11 offset:54272
v_add_f32 v61, v61, v173
v_mfma_f32_16x16x32_bf16 a[32:35], a[244:247], a[212:215], a[32:35]
v_exp_f32 v191, v191
v_mfma_f32_16x16x32_bf16 a[48:51], a[244:247], a[220:223], a[48:51]
ds_read_b64_tr_b16 a[238:239], v11 offset:55808
v_add_f32 v61, v61, v174
v_mfma_f32_16x16x32_bf16 a[48:51], a[240:243], a[216:219], a[48:51]
s_waitcnt lgkmcnt(8)
v_exp_f32 v175, v175
v_add_f32 v63, v63, v190
v_mfma_f32_16x16x32_bf16 a[52:55], a[248:251], a[216:219], a[52:55]
buffer_load_dwordx4 v13, s[36:39], s55 offen offset:1024 lds
v_mfma_f32_16x16x32_bf16 a[52:55], a[252:255], a[220:223], a[52:55]
ds_read_b64_tr_b16 a[240:241], v11 offset:50208
v_add_f32 v61, v61, v175
v_mfma_f32_16x16x32_bf16 a[36:39], a[252:255], a[212:215], a[36:39]
ds_read_b64_tr_b16 a[242:243], v11 offset:51744
v_add_f32 v63, v63, v191
v_mfma_f32_16x16x32_bf16 a[36:39], a[248:251], a[208:211], a[36:39]
v_permlane16_swap_b32 v60, v61
v_mfma_f32_16x16x32_bf16 a[20:23], a[248:251], a[200:203], a[20:23]
ds_read_b64_tr_b16 a[244:245], v11 offset:54304
v_add_f32 v60, v60, v61
v_mfma_f32_16x16x32_bf16 a[20:23], a[252:255], a[204:207], a[20:23]
v_permlane16_swap_b32 v62, v63
v_mfma_f32_16x16x32_bf16 a[4:7], a[252:255], a[196:199], a[4:7]
ds_read_b64_tr_b16 a[246:247], v11 offset:55840
v_add_f32 v62, v62, v63
v_mfma_f32_16x16x32_bf16 a[4:7], a[248:251], a[192:195], a[4:7]
s_waitcnt lgkmcnt(8)
v_mfma_f32_16x16x32_bf16 a[96:99], a[224:227], a[192:195], a[96:99]
buffer_load_dwordx4 v14, s[36:39], s55 offen offset:2048 lds
v_mfma_f32_16x16x32_bf16 a[96:99], a[228:231], a[196:199], a[96:99]
ds_read_b64_tr_b16 a[248:249], v11 offset:50240
ds_read_b64_tr_b16 a[250:251], v11 offset:51776
v_mfma_f32_16x16x32_bf16 a[104:107], a[228:231], a[204:207], a[104:107]
v_permlane32_swap_b32 v60, v62
v_mfma_f32_16x16x32_bf16 a[104:107], a[224:227], a[200:203], a[104:107]
v_add_f32 v60, v60, v62
v_mfma_f32_16x16x32_bf16 a[112:115], a[224:227], a[208:211], a[112:115]
ds_read_b64_tr_b16 a[252:253], v11 offset:54336
ds_read_b64_tr_b16 a[254:255], v11 offset:55872
v_mfma_f32_16x16x32_bf16 a[112:115], a[228:231], a[212:215], a[112:115]
v_rcp_f32 v60, v60
v_mfma_f32_16x16x32_bf16 a[120:123], a[228:231], a[220:223], a[120:123]
v_mfma_f32_16x16x32_bf16 a[120:123], a[224:227], a[216:219], a[120:123]
s_waitcnt vmcnt(32) lgkmcnt(8)
s_barrier
v_mov_b32 v62, v60
v_mfma_f32_16x16x32_bf16 a[56:59], a[232:235], a[216:219], a[56:59]
buffer_load_dwordx4 v3, s[36:39], s55 offen offset:3072 lds
v_mfma_f32_16x16x32_bf16 a[56:59], a[236:239], a[220:223], a[56:59]
s_bfe_u32 s55, 0x6000400, s99
ds_read_b64_tr_b16 a[224:225], v6 offset:57344
ds_read_b64_tr_b16 a[226:227], v6 offset:61440
v_mfma_f32_16x16x32_bf16 a[40:43], a[236:239], a[212:215], a[40:43]
s_lshl4_add_u32 m0, s55, s100
v_permlane32_swap_b32 v60, v62
v_mfma_f32_16x16x32_bf16 a[40:43], a[232:235], a[208:211], a[40:43]
s_mov_b32 s55, 0
v_mov_b32 v61, v60
v_mov_b32 v63, v62
v_mfma_f32_16x16x32_bf16 a[24:27], a[232:235], a[200:203], a[24:27]
s_mov_b32 s56, 0
ds_read_b64_tr_b16 a[228:229], v8 offset:0
ds_read_b64_tr_b16 a[230:231], v8 offset:4096
v_mfma_f32_16x16x32_bf16 a[24:27], a[236:239], a[204:207], a[24:27]
v_permlane16_swap_b32 v60, v61
v_mfma_f32_16x16x32_bf16 a[8:11], a[236:239], a[196:199], a[8:11]
v_permlane16_swap_b32 v62, v63
v_mfma_f32_16x16x32_bf16 a[8:11], a[232:235], a[192:195], a[8:11]
s_waitcnt lgkmcnt(8)
v_mul_f32 v160, v160, v60
v_mul_f32 v176, v176, v62
v_mul_f32 v161, v161, v60
v_mfma_f32_16x16x32_bf16 a[12:15], a[240:243], a[192:195], a[12:15]
ds_read_b64_tr_b16 a[232:233], v7 offset:57344
v_mul_f32 v177, v177, v62
v_mfma_f32_16x16x32_bf16 a[12:15], a[244:247], a[196:199], a[12:15]
buffer_load_dwordx4 v15, s[12:15], s56 offen offset:0 lds
v_mfma_f32_16x16x32_bf16 a[28:31], a[244:247], a[204:207], a[28:31]
ds_read_b64_tr_b16 a[234:235], v7 offset:61440
v_mul_f32 v162, v162, v60
v_mfma_f32_16x16x32_bf16 a[28:31], a[240:243], a[200:203], a[28:31]
v_mul_f32 v178, v178, v62
v_mul_f32 v163, v163, v60
v_mfma_f32_16x16x32_bf16 a[44:47], a[240:243], a[208:211], a[44:47]
ds_read_b64_tr_b16 a[236:237], v9 offset:0
v_mul_f32 v179, v179, v62
v_mfma_f32_16x16x32_bf16 a[44:47], a[244:247], a[212:215], a[44:47]
v_mul_f32 v164, v164, v60
v_mul_f32 v180, v180, v62
v_mfma_f32_16x16x32_bf16 a[60:63], a[244:247], a[220:223], a[60:63]
ds_read_b64_tr_b16 a[238:239], v9 offset:4096
v_mul_f32 v165, v165, v60
v_mfma_f32_16x16x32_bf16 a[60:63], a[240:243], a[216:219], a[60:63]
s_waitcnt lgkmcnt(8)
v_mul_f32 v181, v181, v62
v_mul_f32 v166, v166, v60
v_mul_f32 v182, v182, v62
v_mfma_f32_16x16x32_bf16 a[124:127], a[248:251], a[216:219], a[124:127]
ds_read_b64_tr_b16 a[240:241], v11 offset:58368
v_mul_f32 v167, v167, v60
v_mfma_f32_16x16x32_bf16 a[124:127], a[252:255], a[220:223], a[124:127]
v_mul_f32 v183, v183, v62
v_cvt_pk_bf16_f32 v208, v160, v161
v_mfma_f32_16x16x32_bf16 a[116:119], a[252:255], a[212:215], a[116:119]
buffer_load_dwordx4 v13, s[36:39], s55 offen offset:1024 lds
v_mfma_f32_16x16x32_bf16 a[116:119], a[248:251], a[208:211], a[116:119]
ds_read_b64_tr_b16 a[242:243], v11 offset:59904
v_cvt_pk_bf16_f32 v209, v162, v163
v_mfma_f32_16x16x32_bf16 a[108:111], a[248:251], a[200:203], a[108:111]
ds_read_b64_tr_b16 a[244:245], v11 offset:62464
v_cvt_pk_bf16_f32 v210, v164, v165
v_mfma_f32_16x16x32_bf16 a[108:111], a[252:255], a[204:207], a[108:111]
s_waitcnt vmcnt(9)
v_cvt_pk_bf16_f32 v211, v166, v167
v_cmp_ne_u32 vcc, v33, v32
s_nop 0
s_cbranch_vccnz ckH_spin_b
ckH_ok_b:
v_mfma_f32_16x16x32_bf16 a[100:103], a[252:255], a[196:199], a[100:103]
ds_read_b64_tr_b16 a[246:247], v11 offset:64000
v_cvt_pk_bf16_f32 v212, v176, v177
v_mfma_f32_16x16x32_bf16 a[100:103], a[248:251], a[192:195], a[100:103]
s_waitcnt lgkmcnt(8)
v_cvt_pk_bf16_f32 v213, v178, v179
v_cvt_pk_bf16_f32 v214, v180, v181
v_cvt_pk_bf16_f32 v215, v182, v183
v_mfma_f32_16x16x32_bf16 a[64:67], a[224:227], a[160:163], a[64:67]
ds_read_b64_tr_b16 a[248:249], v11 offset:58400
v_mul_f32 v168, v168, v61
v_mfma_f32_16x16x16_bf16 v[160:163], v[208:209], v[38:39], 0
v_mul_f32 v184, v184, v63
v_mul_f32 v169, v169, v61
v_mfma_f32_16x16x32_bf16 a[64:67], a[228:231], a[164:167], a[64:67]
buffer_load_dwordx4 v14, s[36:39], s55 offen offset:2048 lds
v_mfma_f32_16x16x32_bf16 a[72:75], a[228:231], a[172:175], a[72:75]
ds_read_b64_tr_b16 a[250:251], v11 offset:59936
v_mul_f32 v185, v185, v63
v_mfma_f32_16x16x16_bf16 v[176:179], v[212:213], v[38:39], 0
v_mul_f32 v170, v170, v61
v_mul_f32 v186, v186, v63
v_mfma_f32_16x16x32_bf16 a[72:75], a[224:227], a[168:171], a[72:75]
v_mul_f32 v171, v171, v61
v_mul_f32 v187, v187, v63
v_mfma_f32_16x16x32_bf16 a[80:83], a[224:227], a[176:179], a[80:83]
ds_read_b64_tr_b16 a[252:253], v11 offset:62496
v_mul_f32 v172, v172, v61
v_mfma_f32_16x16x32_bf16 a[80:83], a[228:231], a[180:183], a[80:83]
v_mul_f32 v188, v188, v63
v_mul_f32 v173, v173, v61
v_mfma_f32_16x16x32_bf16 a[88:91], a[228:231], a[188:191], a[88:91]
ds_read_b64_tr_b16 a[254:255], v11 offset:64032
v_mul_f32 v189, v189, v63
v_mfma_f32_16x16x32_bf16 a[88:91], a[224:227], a[184:187], a[88:91]
s_waitcnt lgkmcnt(8)
v_mul_f32 v174, v174, v61
v_mul_f32 v190, v190, v63
v_mul_f32 v175, v175, v61
v_mfma_f32_16x16x32_bf16 a[92:95], a[232:235], a[184:187], a[92:95]
ds_read_b64_tr_b16 a[224:225], v11 offset:58432
v_mul_f32 v191, v191, v63
v_mfma_f32_16x16x32_bf16 a[92:95], a[236:239], a[188:191], a[92:95]
buffer_load_dwordx4 v3, s[36:39], s55 offen offset:3072 lds
v_mfma_f32_16x16x32_bf16 a[84:87], a[236:239], a[180:183], a[84:87]
s_add_u32 s54, s53, 0
ds_read_b64_tr_b16 a[226:227], v11 offset:59968
v_cvt_pk_bf16_f32 v216, v168, v169
v_mfma_f32_16x16x32_bf16 a[84:87], a[232:235], a[176:179], a[84:87]
v_cvt_pk_bf16_f32 v217, v170, v171
v_cvt_pk_bf16_f32 v218, v172, v173
v_mfma_f32_16x16x16_bf16 v[168:171], v[210:211], v[38:39], 0
v_cvt_pk_bf16_f32 v219, v174, v175
v_cvt_pk_bf16_f32 v220, v184, v185
v_mfma_f32_16x16x16_bf16 v[164:167], v[216:217], v[38:39], 0
v_cvt_pk_bf16_f32 v221, v186, v187
v_cvt_pk_bf16_f32 v222, v188, v189
v_mfma_f32_16x16x16_bf16 v[172:175], v[218:219], v[38:39], 0
v_cvt_pk_bf16_f32 v223, v190, v191
v_cvt_pk_bf16_f32 v208, v160, v161
v_mfma_f32_16x16x16_bf16 v[180:183], v[220:221], v[38:39], 0
v_cvt_pk_bf16_f32 v209, v162, v163
v_cvt_pk_bf16_f32 v212, v168, v169
v_mfma_f32_16x16x16_bf16 v[184:187], v[214:215], v[38:39], 0
v_cvt_pk_bf16_f32 v210, v164, v165
v_cvt_pk_bf16_f32 v211, v166, v167
v_mfma_f32_16x16x16_bf16 v[188:191], v[222:223], v[38:39], 0
v_cvt_pk_bf16_f32 v213, v170, v171
v_cvt_pk_bf16_f32 v214, v172, v173
v_mfma_f32_16x16x32_bf16 v[160:163], v[192:195], v[224:227], 0
buffer_load_dwordx4 a[128:131], v1, s[24:27], s54 offen offset:0 sc1
v_mfma_f32_16x16x32_bf16 v[160:163], v[208:211], v[232:235], v[160:163]
v_cvt_pk_bf16_f32 v215, v174, v175
v_cvt_pk_bf16_f32 v216, v176, v177
v_mfma_f32_16x16x32_bf16 v[164:167], v[192:195], v[240:243], 0
v_cvt_pk_bf16_f32 v217, v178, v179
v_cvt_pk_bf16_f32 v218, v180, v181
v_mfma_f32_16x16x32_bf16 v[164:167], v[208:211], v[248:251], v[164:167]
v_cvt_pk_bf16_f32 v219, v182, v183
v_cvt_pk_bf16_f32 v220, v184, v185
v_mfma_f32_16x16x32_bf16 v[228:231], v[192:195], v[48:51], 0
buffer_load_dwordx4 a[132:135], v1, s[24:27], s54 offen offset:1024 sc1
v_mfma_f32_16x16x32_bf16 v[228:231], v[208:211], v[48:51], v[228:231]
v_cvt_pk_bf16_f32 v221, v186, v187
v_cvt_pk_bf16_f32 v222, v188, v189
v_mfma_f32_16x16x32_bf16 v[168:171], v[196:199], v[224:227], 0
v_cvt_pk_bf16_f32 v223, v190, v191
v_mfma_f32_16x16x32_bf16 v[168:171], v[212:215], v[232:235], v[168:171]
v_mfma_f32_16x16x32_bf16 v[172:175], v[196:199], v[240:243], 0
v_mfma_f32_16x16x32_bf16 v[172:175], v[212:215], v[248:251], v[172:175]
buffer_load_dwordx4 a[136:139], v1, s[24:27], s54 offen offset:2048 sc1
v_mfma_f32_16x16x32_bf16 v[236:239], v[196:199], v[48:51], 0
v_mfma_f32_16x16x32_bf16 v[236:239], v[212:215], v[48:51], v[236:239]
v_mfma_f32_16x16x32_bf16 v[176:179], v[200:203], v[224:227], 0
v_mfma_f32_16x16x32_bf16 v[176:179], v[216:219], v[232:235], v[176:179]
buffer_load_dwordx4 a[140:143], v1, s[24:27], s54 offen offset:3072 sc1
v_mfma_f32_16x16x32_bf16 v[180:183], v[200:203], v[240:243], 0
v_mfma_f32_16x16x32_bf16 v[180:183], v[216:219], v[248:251], v[180:183]
s_load_dword s101, s[92:93], 40952
v_mfma_f32_16x16x32_bf16 v[244:247], v[200:203], v[48:51], 0
v_mfma_f32_16x16x32_bf16 v[244:247], v[216:219], v[48:51], v[244:247]
v_mfma_f32_16x16x32_bf16 v[184:187], v[204:207], v[224:227], 0
buffer_load_dwordx4 a[144:147], v2, s[24:27], s54 offen offset:0 sc1
v_mfma_f32_16x16x32_bf16 v[184:187], v[220:223], v[232:235], v[184:187]
v_mfma_f32_16x16x32_bf16 v[188:191], v[204:207], v[240:243], 0
v_mfma_f32_16x16x32_bf16 v[188:191], v[220:223], v[248:251], v[188:191]
v_mfma_f32_16x16x32_bf16 v[252:255], v[204:207], v[48:51], 0
buffer_load_dwordx4 a[148:151], v2, s[24:27], s54 offen offset:1024 sc1
v_mfma_f32_16x16x32_bf16 v[252:255], v[220:223], v[48:51], v[252:255]
s_lshl_b32 s5, s32, 6
v_add_u32 v52, s52, v1
v_and_b32 v54, 48, v0
v_mfma_f32_16x16x32_bf16 a[76:79], a[232:235], a[168:171], a[76:79]
s_add_u32 s5, s5, 157696
ds_read_b64_tr_b16 a[228:229], v11 offset:62528
v_add_u32 v55, s5, v54
v_mfma_f32_16x16x32_bf16 a[76:79], a[236:239], a[172:175], a[76:79]
v_and_b32 v53, 15, v0
v_lshl_add_u32 v55, v53, 18, v55
v_mfma_f32_16x16x32_bf16 a[68:71], a[236:239], a[164:167], a[68:71]
ds_read_b64_tr_b16 a[230:231], v11 offset:64064
v_add_u32 v53, 65536, v52
v_mfma_f32_16x16x32_bf16 a[68:71], a[232:235], a[160:163], a[68:71]
s_waitcnt lgkmcnt(8)
buffer_load_dwordx4 a[152:155], v2, s[24:27], s54 offen offset:2048 sc1
v_mfma_f32_16x16x32_bf16 a[0:3], a[240:243], a[160:163], a[0:3]
ds_read_b64_tr_b16 a[232:233], v12 offset:1024
ds_write_b128 v53, v[160:163] offset:0
v_mfma_f32_16x16x32_bf16 a[0:3], a[244:247], a[164:167], a[0:3]
v_mfma_f32_16x16x32_bf16 a[16:19], a[244:247], a[172:175], a[16:19]
buffer_load_dwordx4 a[156:159], v2, s[24:27], s54 offen offset:3072 sc1
v_mfma_f32_16x16x32_bf16 a[16:19], a[240:243], a[168:171], a[16:19]
s_bfe_u32 s55, 0x1050301, s64
ds_read_b64_tr_b16 a[234:235], v12 offset:2560
ds_write_b128 v53, v[164:167] offset:1024
v_mfma_f32_16x16x32_bf16 a[32:35], a[240:243], a[176:179], a[32:35]
s_lshl_b32 s55, s55, 18
ds_read_b64_tr_b16 a[236:237], v12 offset:5120
s_or_b32 s55, s55, 128
v_mfma_f32_16x16x32_bf16 a[32:35], a[244:247], a[180:183], a[32:35]
s_add_u32 m0, s52, 32768
v_add_u32 v53, 73728, v52
v_mfma_f32_16x16x32_bf16 a[48:51], a[244:247], a[188:191], a[48:51]
buffer_load_dwordx4 v28, s[40:43], s55 offen offset:0 lds
v_mfma_f32_16x16x32_bf16 a[48:51], a[240:243], a[184:187], a[48:51]
s_waitcnt lgkmcnt(9)
ds_read_b64_tr_b16 a[238:239], v12 offset:6656
ds_write_b128 v55, v[228:231] offset:0
v_mfma_f32_16x16x32_bf16 a[52:55], a[248:251], a[184:187], a[52:55]
ds_read_b64_tr_b16 a[240:241], v12 offset:1056
v_mfma_f32_16x16x32_bf16 a[52:55], a[252:255], a[188:191], a[52:55]
buffer_load_dwordx4 v29, s[40:43], s55 offen offset:1024 lds
v_mfma_f32_16x16x32_bf16 a[36:39], a[252:255], a[180:183], a[36:39]
s_xor_b32 s55, s55, 128
ds_read_b64_tr_b16 a[242:243], v12 offset:2592
ds_write_b128 v53, v[168:171] offset:0
v_mfma_f32_16x16x32_bf16 a[36:39], a[248:251], a[176:179], a[36:39]
s_add_u32 m0, s52, 40960
v_mfma_f32_16x16x32_bf16 a[20:23], a[248:251], a[168:171], a[20:23]
ds_read_b64_tr_b16 a[244:245], v12 offset:5152
v_mfma_f32_16x16x32_bf16 a[20:23], a[252:255], a[172:175], a[20:23]
buffer_load_dwordx4 v28, s[40:43], s55 offen offset:0 lds
v_mfma_f32_16x16x32_bf16 a[4:7], a[252:255], a[164:167], a[4:7]
ds_read_b64_tr_b16 a[246:247], v12 offset:6688
ds_write_b128 v53, v[172:175] offset:1024
v_mfma_f32_16x16x32_bf16 a[4:7], a[248:251], a[160:163], a[4:7]
s_waitcnt lgkmcnt(13)
v_add_u32 v53, 81920, v52
v_mfma_f32_16x16x32_bf16 a[96:99], a[224:227], a[160:163], a[96:99]
buffer_load_dwordx4 v29, s[40:43], s55 offen offset:1024 lds
v_mfma_f32_16x16x32_bf16 a[96:99], a[228:231], a[164:167], a[96:99]
s_xor_b32 s55, s55, 131072
ds_read_b64_tr_b16 a[248:249], v12 offset:1088
ds_write_b128 v55, v[236:239] offset:256
v_mfma_f32_16x16x32_bf16 a[104:107], a[228:231], a[172:175], a[104:107]
s_add_u32 m0, s52, 49152
ds_read_b64_tr_b16 a[250:251], v12 offset:2624
v_mfma_f32_16x16x32_bf16 a[104:107], a[224:227], a[168:171], a[104:107]
v_mfma_f32_16x16x32_bf16 a[112:115], a[224:227], a[176:179], a[112:115]
buffer_load_dwordx4 v28, s[40:43], s55 offen offset:0 lds
v_mfma_f32_16x16x32_bf16 a[112:115], a[228:231], a[180:183], a[112:115]
ds_read_b64_tr_b16 a[252:253], v12 offset:5184
ds_write_b128 v53, v[176:179] offset:0
v_mfma_f32_16x16x32_bf16 a[120:123], a[228:231], a[188:191], a[120:123]
ds_read_b64_tr_b16 a[254:255], v12 offset:6720
v_mfma_f32_16x16x32_bf16 a[120:123], a[224:227], a[184:187], a[120:123]
s_waitcnt vmcnt(38) lgkmcnt(13)
s_barrier
v_mfma_f32_16x16x32_bf16 a[56:59], a[232:235], a[184:187], a[56:59]
buffer_load_dwordx4 v29, s[40:43], s55 offen offset:1024 lds
v_mfma_f32_16x16x32_bf16 a[56:59], a[236:239], a[188:191], a[56:59]
s_xor_b32 s55, s55, 128
ds_read_b64_tr_b16 a[224:225], v8 offset:8192
ds_write_b128 v53, v[180:183] offset:1024
v_mfma_f32_16x16x32_bf16 a[40:43], a[236:239], a[180:183], a[40:43]
s_add_u32 m0, s52, 57344
ds_read_b64_tr_b16 a[226:227], v8 offset:12288
v_add_u32 v53, 90112, v52
v_mfma_f32_16x16x32_bf16 a[40:43], a[232:235], a[176:179], a[40:43]
buffer_load_dwordx4 v28, s[40:43], s55 offen offset:0 lds
v_mfma_f32_16x16x32_bf16 a[24:27], a[232:235], a[168:171], a[24:27]
ds_read_b64_tr_b16 a[228:229], v8 offset:16384
ds_write_b128 v55, v[244:247] offset:512
v_mfma_f32_16x16x32_bf16 a[24:27], a[236:239], a[172:175], a[24:27]
buffer_load_dwordx4 v29, s[40:43], s55 offen offset:1024 lds
v_mfma_f32_16x16x32_bf16 a[8:11], a[236:239], a[164:167], a[8:11]
s_bfe_u32 s54, 0x1050301, s64
ds_read_b64_tr_b16 a[230:231], v8 offset:20480
s_lshl_b32 s54, s54, 13
v_mfma_f32_16x16x32_bf16 a[8:11], a[232:235], a[160:163], a[8:11]
s_waitcnt lgkmcnt(13)
s_add_u32 s54, s54, s63
v_mfma_f32_16x16x32_bf16 a[12:15], a[240:243], a[160:163], a[12:15]
ds_read_b64_tr_b16 a[232:233], v9 offset:8192
ds_write_b128 v53, v[184:187] offset:0
v_mfma_f32_16x16x32_bf16 a[12:15], a[244:247], a[164:167], a[12:15]
buffer_load_dwordx4 v[128:131], v1, s[24:27], s54 offen offset:0 sc1
v_mfma_f32_16x16x32_bf16 a[28:31], a[244:247], a[172:175], a[28:31]
ds_read_b64_tr_b16 a[234:235], v9 offset:12288
v_mfma_f32_16x16x32_bf16 a[28:31], a[240:243], a[168:171], a[28:31]
v_mfma_f32_16x16x32_bf16 a[44:47], a[240:243], a[176:179], a[44:47]
ds_read_b64_tr_b16 a[236:237], v9 offset:16384
ds_write_b128 v53, v[188:191] offset:1024
v_mfma_f32_16x16x32_bf16 a[44:47], a[244:247], a[180:183], a[44:47]
buffer_load_dwordx4 v[132:135], v1, s[24:27], s54 offen offset:1024 sc1
v_mfma_f32_16x16x32_bf16 a[60:63], a[244:247], a[188:191], a[60:63]
ds_read_b64_tr_b16 a[238:239], v9 offset:20480
v_mfma_f32_16x16x32_bf16 a[60:63], a[240:243], a[184:187], a[60:63]
s_waitcnt lgkmcnt(12)
v_mfma_f32_16x16x32_bf16 a[124:127], a[248:251], a[184:187], a[124:127]
ds_read_b64_tr_b16 a[240:241], v12 offset:9216
ds_write_b128 v55, v[252:255] offset:768
v_mfma_f32_16x16x32_bf16 a[124:127], a[252:255], a[188:191], a[124:127]
buffer_load_dwordx4 v[136:139], v1, s[24:27], s54 offen offset:2048 sc1
v_mfma_f32_16x16x32_bf16 a[116:119], a[252:255], a[180:183], a[116:119]
s_lshl_b32 s5, s32, 3
ds_read_b64_tr_b16 a[242:243], v12 offset:10752
s_lshr_b32 s5, 0xb0a0908, s5
v_mfma_f32_16x16x32_bf16 a[116:119], a[248:251], a[176:179], a[116:119]
s_and_b32 s5, s5, 255
s_lshl_b32 s5, s5, 13
v_add_u32 v53, s5, v1
v_mfma_f32_16x16x32_bf16 a[108:111], a[248:251], a[168:171], a[108:111]
buffer_load_dwordx4 v[140:143], v1, s[24:27], s54 offen offset:3072 sc1
v_mfma_f32_16x16x32_bf16 a[108:111], a[252:255], a[172:175], a[108:111]
s_lshl_b32 s5, s32, 8
ds_read_b64_tr_b16 a[244:245], v12 offset:13312
s_add_u32 s5, s5, 157696
v_mfma_f32_16x16x32_bf16 a[100:103], a[252:255], a[164:167], a[100:103]
ds_read_b64_tr_b16 a[246:247], v12 offset:14848
v_add_u32 v55, s5, v54
v_mfma_f32_16x16x32_bf16 a[100:103], a[248:251], a[160:163], a[100:103]
s_waitcnt lgkmcnt(11)
v_mfma_f32_16x16x32_bf16 a[64:67], a[224:227], v[64:67], a[64:67]
ds_read_b64_tr_b16 a[248:249], v12 offset:9248
v_mfma_f32_16x16x32_bf16 a[64:67], a[228:231], v[68:71], a[64:67]
buffer_load_dwordx4 v[144:147], v2, s[24:27], s54 offen offset:0 sc1
v_mfma_f32_16x16x32_bf16 a[72:75], a[228:231], v[76:79], a[72:75]
ds_read_b64_tr_b16 a[250:251], v12 offset:10784
v_mfma_f32_16x16x32_bf16 a[72:75], a[224:227], v[72:75], a[72:75]
v_mfma_f32_16x16x32_bf16 a[80:83], a[224:227], v[80:83], a[80:83]
ds_read_b64_tr_b16 a[252:253], v12 offset:13344
v_mfma_f32_16x16x32_bf16 a[80:83], a[228:231], v[84:87], a[80:83]
buffer_load_dwordx4 v[148:151], v2, s[24:27], s54 offen offset:1024 sc1
v_mfma_f32_16x16x32_bf16 a[88:91], a[228:231], v[92:95], a[88:91]
ds_read_b64_tr_b16 a[254:255], v12 offset:14880
v_mfma_f32_16x16x32_bf16 a[88:91], a[224:227], v[88:91], a[88:91]
s_waitcnt lgkmcnt(9)
v_mfma_f32_16x16x32_bf16 a[92:95], a[232:235], v[88:91], a[92:95]
ds_read_b64_tr_b16 a[224:225], v12 offset:9280
v_mfma_f32_16x16x32_bf16 a[92:95], a[236:239], v[92:95], a[92:95]
v_mfma_f32_16x16x32_bf16 a[84:87], a[236:239], v[84:87], a[84:87]
buffer_load_dwordx4 v[152:155], v2, s[24:27], s54 offen offset:2048 sc1
v_mfma_f32_16x16x32_bf16 a[84:87], a[232:235], v[80:83], a[84:87]
ds_read_b64_tr_b16 a[226:227], v12 offset:10816
v_mfma_f32_16x16x32_bf16 a[76:79], a[232:235], v[72:75], a[76:79]
ds_read_b64_tr_b16 a[228:229], v12 offset:13376
v_mfma_f32_16x16x32_bf16 a[76:79], a[236:239], v[76:79], a[76:79]
v_mfma_f32_16x16x32_bf16 a[68:71], a[236:239], v[68:71], a[68:71]
buffer_load_dwordx4 v[156:159], v2, s[24:27], s54 offen offset:3072 sc1
v_mfma_f32_16x16x32_bf16 a[68:71], a[232:235], v[64:67], a[68:71]
s_waitcnt lgkmcnt(7)
ds_read_b64_tr_b16 a[230:231], v12 offset:14912
s_bfe_u32 s55, 0x7010103, s64
v_mfma_f32_16x16x32_bf16 a[0:3], a[240:243], v[64:67], a[0:3]
s_lshl_b32 s55, s55, 18
ds_read_b64_tr_b16 a[232:233], v12 offset:17408
s_or_b32 s55, s55, 128
v_mfma_f32_16x16x32_bf16 a[0:3], a[244:247], v[68:71], a[0:3]
s_add_u32 m0, s52, 98304
v_mfma_f32_16x16x32_bf16 a[16:19], a[244:247], v[76:79], a[16:19]
ds_read_b64_tr_b16 a[234:235], v12 offset:18944
v_mfma_f32_16x16x32_bf16 a[16:19], a[240:243], v[72:75], a[16:19]
buffer_load_dwordx4 v28, s[40:43], s55 offen offset:0 lds
v_mfma_f32_16x16x32_bf16 a[32:35], a[240:243], v[80:83], a[32:35]
ds_read_b64_tr_b16 a[236:237], v12 offset:21504
v_mfma_f32_16x16x32_bf16 a[32:35], a[244:247], v[84:87], a[32:35]
v_mfma_f32_16x16x32_bf16 a[48:51], a[244:247], v[92:95], a[48:51]
ds_read_b64_tr_b16 a[238:239], v12 offset:23040
v_mfma_f32_16x16x32_bf16 a[48:51], a[240:243], v[88:91], a[48:51]
s_waitcnt lgkmcnt(8)
buffer_load_dwordx4 v29, s[40:43], s55 offen offset:1024 lds
v_mfma_f32_16x16x32_bf16 a[52:55], a[248:251], v[88:91], a[52:55]
s_xor_b32 s55, s55, 128
ds_read_b64_tr_b16 a[240:241], v12 offset:17440
s_add_u32 m0, s52, 106496
v_mfma_f32_16x16x32_bf16 a[52:55], a[252:255], v[92:95], a[52:55]
v_mfma_f32_16x16x32_bf16 a[36:39], a[252:255], v[84:87], a[36:39]
ds_read_b64_tr_b16 a[242:243], v12 offset:18976
v_mfma_f32_16x16x32_bf16 a[36:39], a[248:251], v[80:83], a[36:39]
v_mfma_f32_16x16x32_bf16 a[20:23], a[248:251], v[72:75], a[20:23]
buffer_load_dwordx4 v28, s[40:43], s55 offen offset:0 lds
v_mfma_f32_16x16x32_bf16 a[20:23], a[252:255], v[76:79], a[20:23]
ds_read_b64_tr_b16 a[244:245], v12 offset:21536
v_mfma_f32_16x16x32_bf16 a[4:7], a[252:255], v[68:71], a[4:7]
ds_read_b64_tr_b16 a[246:247], v12 offset:23072
v_mfma_f32_16x16x32_bf16 a[4:7], a[248:251], v[64:67], a[4:7]
s_waitcnt lgkmcnt(8)
v_mfma_f32_16x16x32_bf16 a[96:99], a[224:227], v[64:67], a[96:99]
buffer_load_dwordx4 v29, s[40:43], s55 offen offset:1024 lds
v_mfma_f32_16x16x32_bf16 a[96:99], a[228:231], v[68:71], a[96:99]
s_xor_b32 s55, s55, 131072
ds_read_b64_tr_b16 a[248:249], v12 offset:17472
s_add_u32 m0, s52, 114688
v_mfma_f32_16x16x32_bf16 a[104:107], a[228:231], v[76:79], a[104:107]
ds_read_b64_tr_b16 a[250:251], v12 offset:19008
v_mfma_f32_16x16x32_bf16 a[104:107], a[224:227], v[72:75], a[104:107]
v_mfma_f32_16x16x32_bf16 a[112:115], a[224:227], v[80:83], a[112:115]
ds_read_b64_tr_b16 a[252:253], v12 offset:21568
v_mfma_f32_16x16x32_bf16 a[112:115], a[228:231], v[84:87], a[112:115]
buffer_load_dwordx4 v28, s[40:43], s55 offen offset:0 lds
v_mfma_f32_16x16x32_bf16 a[120:123], a[228:231], v[92:95], a[120:123]
ds_read_b64_tr_b16 a[254:255], v12 offset:23104
v_mfma_f32_16x16x32_bf16 a[120:123], a[224:227], v[88:91], a[120:123]
s_waitcnt vmcnt(29) lgkmcnt(0)
s_barrier
v_mfma_f32_16x16x32_bf16 a[56:59], a[232:235], v[88:91], a[56:59]
ds_read_b128 v[192:195], v53 offset:0
ds_read_b64_tr_b16 a[224:225], v10 offset:1088
v_mfma_f32_16x16x32_bf16 a[56:59], a[236:239], v[92:95], a[56:59]
buffer_load_dwordx4 v29, s[40:43], s55 offen offset:1024 lds
v_mfma_f32_16x16x32_bf16 a[40:43], a[236:239], v[84:87], a[40:43]
s_xor_b32 s55, s55, 128
ds_read_b128 v[196:199], v53 offset:1024
ds_read_b64_tr_b16 a[226:227], v10 offset:2624
v_mfma_f32_16x16x32_bf16 a[40:43], a[232:235], v[80:83], a[40:43]
s_add_u32 m0, s52, 122880
v_and_b32 v52, 15, v0
v_mov_b32 v57, 0x7f000000
v_mfma_f32_16x16x32_bf16 a[24:27], a[232:235], v[72:75], a[24:27]
ds_read_b128 v[200:203], v55 offset:0
ds_read_b64_tr_b16 a[228:229], v10 offset:5184
v_mfma_f32_16x16x32_bf16 a[24:27], a[236:239], v[76:79], a[24:27]
buffer_load_dwordx4 v28, s[40:43], s55 offen offset:0 lds
v_mfma_f32_16x16x32_bf16 a[8:11], a[236:239], v[68:71], a[8:11]
ds_read_b128 v[204:207], v53 offset:2048
ds_read_b64_tr_b16 a[230:231], v10 offset:6720
v_mfma_f32_16x16x32_bf16 a[8:11], a[232:235], v[64:67], a[8:11]
v_mfma_f32_16x16x32_bf16 a[12:15], a[240:243], v[64:67], a[12:15]
ds_read_b128 v[208:211], v53 offset:3072
ds_read_b64_tr_b16 a[232:233], v10 offset:9280
v_mfma_f32_16x16x32_bf16 a[12:15], a[244:247], v[68:71], a[12:15]
pg_9_b:
s_cbranch_execz pg_13_b
v_mfma_f32_16x16x32_bf16 a[28:31], a[244:247], v[76:79], a[28:31]
buffer_load_dwordx4 v29, s[40:43], s55 offen offset:1024 lds
v_mfma_f32_16x16x32_bf16 a[28:31], a[240:243], v[72:75], a[28:31]
s_bfe_u32 s54, 0x7010103, s64
ds_read_b128 v[212:215], v55 offset:64
ds_read_b64_tr_b16 a[234:235], v10 offset:10816
v_mfma_f32_16x16x32_bf16 a[44:47], a[240:243], v[80:83], a[44:47]
s_lshl_b32 s54, s54, 13
ds_read_b64_tr_b16 a[236:237], v10 offset:13376
s_add_u32 s54, s54, s63
v_mfma_f32_16x16x32_bf16 a[44:47], a[244:247], v[84:87], a[44:47]
ds_read_b128 v[216:219], v53 offset:4096
v_mfma_f32_16x16x32_bf16 a[60:63], a[244:247], v[92:95], a[60:63]
buffer_load_dwordx4 a[160:163], v1, s[24:27], s54 offen offset:0 sc1
v_mfma_f32_16x16x32_bf16 a[60:63], a[240:243], v[88:91], a[60:63]
ds_read_b128 v[220:223], v53 offset:5120
ds_read_b64_tr_b16 a[238:239], v10 offset:14912
v_mfma_f32_16x16x32_bf16 a[124:127], a[248:251], v[88:91], a[124:127]
ds_read_b64_tr_b16 a[240:241], v10 offset:17472
v_mfma_f32_16x16x32_bf16 a[124:127], a[252:255], v[92:95], a[124:127]
ds_read_b128 v[224:227], v55 offset:128
v_mfma_f32_16x16x32_bf16 a[116:119], a[252:255], v[84:87], a[116:119]
ds_read_b64_tr_b16 a[242:243], v10 offset:19008
v_mfma_f32_16x16x32_bf16 a[116:119], a[248:251], v[80:83], a[116:119]
buffer_load_dwordx4 a[164:167], v1, s[24:27], s54 offen offset:1024 sc1
v_mfma_f32_16x16x32_bf16 a[108:111], a[248:251], v[72:75], a[108:111]
ds_read_b128 v[228:231], v53 offset:6144
ds_read_b64_tr_b16 a[244:245], v10 offset:21568
v_mfma_f32_16x16x32_bf16 a[108:111], a[252:255], v[76:79], a[108:111]
v_mfma_f32_16x16x32_bf16 a[100:103], a[252:255], v[68:71], a[100:103]
ds_read_b128 v[232:235], v53 offset:7168
ds_read_b64_tr_b16 a[246:247], v10 offset:23104
v_mfma_f32_16x16x32_bf16 a[100:103], a[248:251], v[64:67], a[100:103]
s_waitcnt lgkmcnt(15)
buffer_load_dwordx4 a[168:171], v1, s[24:27], s54 offen offset:2048 sc1
v_mfma_f32_16x16x32_bf16 a[96:99], a[224:227], v[96:99], a[96:99]
ds_read_b128 v[236:239], v55 offset:192
ds_read_b64_tr_b16 a[248:249], v10 offset:25664
v_mfma_f32_16x16x32_bf16 a[96:99], a[228:231], v[100:103], a[96:99]
s_lshl_b32 s6, s68, 3
s_add_u32 s6, s6, s33
s_lshl_b32 s5, s6, 6
v_mfma_f32_16x16x32_bf16 a[104:107], a[228:231], v[108:111], a[104:107]
s_lshl_b32 s6, s6, 10
ds_read_b64_tr_b16 a[250:251], v10 offset:27200
s_add_u32 s6, s6, 12582912
v_mfma_f32_16x16x32_bf16 a[104:107], a[224:227], v[104:107], a[104:107]
s_add_u32 s5, s5, 15728640
v_cmp_eq_u32 vcc, 0, v52
s_nop 1
v_cndmask_b32 v57, v57, v54, vcc
v_mfma_f32_16x16x32_bf16 a[112:115], a[224:227], v[112:115], a[112:115]
buffer_load_dwordx4 a[172:175], v1, s[24:27], s54 offen offset:3072 sc1
v_mfma_f32_16x16x32_bf16 a[112:115], a[228:231], v[116:119], a[112:115]
ds_read_b64_tr_b16 a[252:253], v10 offset:29760
v_add_f32 v192, v192, v204
v_mfma_f32_16x16x32_bf16 a[120:123], a[228:231], v[124:127], a[120:123]
ds_read_b64_tr_b16 a[254:255], v10 offset:31296
v_add_f32 v193, v193, v205
v_mfma_f32_16x16x32_bf16 a[120:123], a[224:227], v[120:123], a[120:123]
s_waitcnt lgkmcnt(12)
v_add_f32 v194, v194, v206
v_add_f32 v195, v195, v207
v_add_f32 v196, v196, v208
v_mfma_f32_16x16x32_bf16 a[124:127], a[232:235], v[120:123], a[124:127]
buffer_load_dwordx4 a[176:179], v2, s[24:27], s54 offen offset:0 sc1
v_mfma_f32_16x16x32_bf16 a[124:127], a[236:239], v[124:127], a[124:127]
ds_read_b64_tr_b16 a[224:225], v4 offset:0
v_add_f32 v197, v197, v209
v_mfma_f32_16x16x32_bf16 a[116:119], a[236:239], v[116:119], a[116:119]
ds_read_b64_tr_b16 a[226:227], v4 offset:4096
v_add_f32 v198, v198, v210
v_mfma_f32_16x16x32_bf16 a[116:119], a[232:235], v[112:115], a[116:119]
v_add_f32 v199, v199, v211
v_add_f32 v200, v200, v212
v_mfma_f32_16x16x32_bf16 a[108:111], a[232:235], v[104:107], a[108:111]
buffer_load_dwordx4 a[180:183], v2, s[24:27], s54 offen offset:1024 sc1
v_mfma_f32_16x16x32_bf16 a[108:111], a[236:239], v[108:111], a[108:111]
ds_read_b64_tr_b16 a[228:229], v4 offset:8192
v_add_f32 v201, v201, v213
v_mfma_f32_16x16x32_bf16 a[100:103], a[236:239], v[100:103], a[100:103]
ds_read_b64_tr_b16 a[230:231], v4 offset:12288
v_add_f32 v202, v202, v214
v_mfma_f32_16x16x32_bf16 a[100:103], a[232:235], v[96:99], a[100:103]
s_waitcnt vmcnt(30) lgkmcnt(9)
v_add_f32 v203, v203, v215
v_add_f32 v216, v216, v228
v_add_f32 v217, v217, v229
v_mfma_f32_16x16x32_bf16 a[96:99], a[240:243], a[128:131], a[96:99]
buffer_load_dwordx4 a[184:187], v2, s[24:27], s54 offen offset:2048 sc1
v_mfma_f32_16x16x32_bf16 a[96:99], a[244:247], a[132:135], a[96:99]
ds_read_b64_tr_b16 a[232:233], v5 offset:0
v_add_f32 v218, v218, v230
v_mfma_f32_16x16x32_bf16 a[104:107], a[244:247], a[140:143], a[104:107]
ds_read_b64_tr_b16 a[234:235], v5 offset:4096
v_add_f32 v219, v219, v231
v_mfma_f32_16x16x32_bf16 a[104:107], a[240:243], a[136:139], a[104:107]
v_add_f32 v220, v220, v232
v_add_f32 v221, v221, v233
v_mfma_f32_16x16x32_bf16 a[112:115], a[240:243], a[144:147], a[112:115]
ds_read_b64_tr_b16 a[236:237], v5 offset:8192
v_add_f32 v222, v222, v234
v_mfma_f32_16x16x32_bf16 a[112:115], a[244:247], a[148:151], a[112:115]
buffer_load_dwordx4 a[188:191], v2, s[24:27], s54 offen offset:3072 sc1
v_mfma_f32_16x16x32_bf16 a[120:123], a[244:247], a[156:159], a[120:123]
s_bfe_u32 s55, 0x3030509, s64
ds_read_b64_tr_b16 a[238:239], v5 offset:12288
v_add_f32 v223, v223, v235
v_mfma_f32_16x16x32_bf16 a[120:123], a[240:243], a[152:155], a[120:123]
s_waitcnt lgkmcnt(8)
s_lshl_b32 s55, s55, 18
v_add_f32 v224, v224, v236
v_add_f32 v225, v225, v237
v_mfma_f32_16x16x32_bf16 a[124:127], a[248:251], a[152:155], a[124:127]
s_or_b32 s55, s55, 128
ds_read_b64_tr_b16 a[240:241], v4 offset:16384
v_add_f32 v226, v226, v238
v_mfma_f32_16x16x32_bf16 a[124:127], a[252:255], a[156:159], a[124:127]
s_add_u32 m0, s52, 131072
v_add_f32 v227, v227, v239
v_add_f32 v192, v192, v216
v_mfma_f32_16x16x32_bf16 a[116:119], a[252:255], a[148:151], a[116:119]
buffer_load_dwordx4 v28, s[40:43], s55 offen offset:0 lds
v_mfma_f32_16x16x32_bf16 a[116:119], a[248:251], a[144:147], a[116:119]
ds_read_b64_tr_b16 a[242:243], v4 offset:20480
v_add_f32 v193, v193, v217
v_mfma_f32_16x16x32_bf16 a[108:111], a[248:251], a[136:139], a[108:111]
ds_read_b64_tr_b16 a[244:245], v4 offset:24576
v_add_f32 v194, v194, v218
v_mfma_f32_16x16x32_bf16 a[108:111], a[252:255], a[140:143], a[108:111]
v_add_f32 v195, v195, v219
v_add_f32 v196, v196, v220
v_mfma_f32_16x16x32_bf16 a[100:103], a[252:255], a[132:135], a[100:103]
buffer_load_dwordx4 v29, s[40:43], s55 offen offset:1024 lds
v_mfma_f32_16x16x32_bf16 a[100:103], a[248:251], a[128:131], a[100:103]
s_waitcnt lgkmcnt(7)
ds_read_b64_tr_b16 a[246:247], v4 offset:28672
v_add_f32 v197, v197, v221
v_add_f32 v198, v198, v222
v_mfma_f32_16x16x32_bf16 a[64:67], a[224:227], v[96:99], a[64:67]
s_xor_b32 s55, s55, 128
ds_read_b64_tr_b16 a[248:249], v5 offset:16384
v_add_f32 v199, v199, v223
v_mfma_f32_16x16x32_bf16 a[64:67], a[228:231], v[100:103], a[64:67]
s_add_u32 m0, s52, 139264
v_add_f32 v200, v200, v224
v_add_f32 v201, v201, v225
v_mfma_f32_16x16x32_bf16 a[72:75], a[228:231], v[108:111], a[72:75]
buffer_load_dwordx4 v28, s[40:43], s55 offen offset:0 lds
v_mfma_f32_16x16x32_bf16 a[72:75], a[224:227], v[104:107], a[72:75]
ds_read_b64_tr_b16 a[250:251], v5 offset:20480
v_add_f32 v202, v202, v226
v_mfma_f32_16x16x32_bf16 a[80:83], a[224:227], v[112:115], a[80:83]
ds_read_b64_tr_b16 a[252:253], v5 offset:24576
v_add_f32 v203, v203, v227
v_mfma_f32_16x16x32_bf16 a[80:83], a[228:231], v[116:119], a[80:83]
v_cvt_pk_bf16_f32 v192, v192, v193
v_cvt_pk_bf16_f32 v193, v194, v195
v_mfma_f32_16x16x32_bf16 a[88:91], a[228:231], v[124:127], a[88:91]
buffer_load_dwordx4 v29, s[40:43], s55 offen offset:1024 lds
v_mfma_f32_16x16x32_bf16 a[88:91], a[224:227], v[120:123], a[88:91]
s_waitcnt lgkmcnt(7)
s_barrier
v_cvt_pk_bf16_f32 v194, v196, v197
v_mfma_f32_16x16x32_bf16 a[92:95], a[232:235], v[120:123], a[92:95]
s_xor_b32 s55, s55, 131072
ds_read_b64_tr_b16 a[254:255], v5 offset:28672
ds_read_b64_tr_b16 a[224:225], v10 offset:1024
v_mfma_f32_16x16x32_bf16 a[92:95], a[236:239], v[124:127], a[92:95]
s_add_u32 m0, s52, 147456
v_cvt_pk_bf16_f32 v195, v198, v199
v_accvgpr_read_b32 v160, a96
v_mfma_f32_16x16x32_bf16 a[84:87], a[236:239], v[116:119], a[84:87]
buffer_store_dwordx4 v[192:195], v1, s[24:27], s6 offen offset:0 sc1
ds_read_b64_tr_b16 a[226:227], v10 offset:2560
v_accvgpr_read_b32 v161, a97
v_accvgpr_read_b32 v162, a98
v_mfma_f32_16x16x32_bf16 a[84:87], a[232:235], v[112:115], a[84:87]
v_accvgpr_read_b32 v163, a99
v_accvgpr_read_b32 v164, a104
v_mfma_f32_16x16x32_bf16 a[76:79], a[232:235], v[104:107], a[76:79]
ds_read_b64_tr_b16 a[228:229], v10 offset:5120
v_accvgpr_read_b32 v165, a105
v_mfma_f32_16x16x32_bf16 a[76:79], a[236:239], v[108:111], a[76:79]
v_accvgpr_read_b32 v166, a106
v_accvgpr_read_b32 v167, a107
v_mfma_f32_16x16x32_bf16 a[68:71], a[236:239], v[100:103], a[68:71]
buffer_store_dwordx4 v[200:203], v57, s[24:27], s5 offen sc1
buffer_load_dwordx4 v28, s[40:43], s55 offen offset:0 lds
v_accvgpr_read_b32 v168, a100
v_mfma_f32_16x16x32_bf16 a[68:71], a[232:235], v[96:99], a[68:71]
s_waitcnt lgkmcnt(7)
ds_read_b64_tr_b16 a[230:231], v10 offset:6656
v_accvgpr_read_b32 v169, a101
v_accvgpr_read_b32 v170, a102
v_mfma_f32_16x16x32_bf16 a[64:67], a[240:243], a[128:131], a[64:67]
ds_read_b64_tr_b16 a[232:233], v10 offset:1056
v_accvgpr_read_b32 v171, a103
v_mfma_f32_16x16x32_bf16 a[64:67], a[244:247], a[132:135], a[64:67]
v_accvgpr_read_b32 v172, a108
v_accvgpr_read_b32 v173, a109
v_mfma_f32_16x16x32_bf16 a[72:75], a[244:247], a[140:143], a[72:75]
buffer_load_dwordx4 v29, s[40:43], s55 offen offset:1024 lds
v_mfma_f32_16x16x32_bf16 a[72:75], a[240:243], a[136:139], a[72:75]
s_xor_b32 s55, s55, 128
ds_read_b64_tr_b16 a[234:235], v10 offset:2592
v_accvgpr_read_b32 v174, a110
v_mfma_f32_16x16x32_bf16 a[80:83], a[240:243], a[144:147], a[80:83]
s_add_u32 m0, s52, 65536
ds_read_b64_tr_b16 a[236:237], v10 offset:5152
v_accvgpr_read_b32 v175, a111
v_mfma_f32_16x16x32_bf16 a[80:83], a[244:247], a[148:151], a[80:83]
v_mul_f32 v160, s57, v160
v_mul_f32 v161, s57, v161
v_mfma_f32_16x16x32_bf16 a[88:91], a[244:247], a[156:159], a[88:91]
ds_read_b64_tr_b16 a[238:239], v10 offset:6688
v_mul_f32 v162, s57, v162
v_mfma_f32_16x16x32_bf16 a[88:91], a[240:243], a[152:155], a[88:91]
s_waitcnt lgkmcnt(8)
buffer_load_dwordx4 v28, s[40:43], s55 offen offset:0 lds
v_mul_f32 v163, s57, v163
v_mfma_f32_16x16x32_bf16 a[92:95], a[248:251], a[152:155], a[92:95]
ds_read_b64_tr_b16 a[240:241], v10 offset:9216
v_mul_f32 v164, s57, v164
v_mfma_f32_16x16x32_bf16 a[92:95], a[252:255], a[156:159], a[92:95]
v_exp_f32 v160, v160
v_mfma_f32_16x16x32_bf16 a[84:87], a[252:255], a[148:151], a[84:87]
ds_read_b64_tr_b16 a[242:243], v10 offset:10752
v_mul_f32 v165, s57, v165
v_mfma_f32_16x16x32_bf16 a[84:87], a[248:251], a[144:147], a[84:87]
buffer_load_dwordx4 v29, s[40:43], s55 offen offset:1024 lds
v_mfma_f32_16x16x32_bf16 a[76:79], a[248:251], a[136:139], a[76:79]
s_bfe_u32 s55, 0x5070b05, s64
ds_read_b64_tr_b16 a[244:245], v10 offset:13312
v_mul_f32 v166, s57, v166
v_mfma_f32_16x16x32_bf16 a[76:79], a[252:255], a[140:143], a[76:79]
s_lshl_b32 s55, s55, 18
v_exp_f32 v161, v161
v_mfma_f32_16x16x32_bf16 a[68:71], a[252:255], a[132:135], a[68:71]
s_or_b32 s55, s55, 128
ds_read_b64_tr_b16 a[246:247], v10 offset:14848
v_mul_f32 v167, s57, v167
v_mfma_f32_16x16x32_bf16 a[68:71], a[248:251], a[128:131], a[68:71]
s_waitcnt lgkmcnt(8)
s_add_u32 m0, s52, 73728
v_exp_f32 v162, v162
v_mfma_f32_16x16x32_bf16 a[0:3], a[224:227], v[96:99], a[0:3]
buffer_load_dwordx4 v28, s[40:43], s55 offen offset:0 lds
v_mfma_f32_16x16x32_bf16 a[0:3], a[228:231], v[100:103], a[0:3]
ds_read_b64_tr_b16 a[248:249], v10 offset:9248
v_add_f32 v160, 1.0, v160
v_mfma_f32_16x16x32_bf16 a[16:19], a[228:231], v[108:111], a[16:19]
ds_read_b64_tr_b16 a[250:251], v10 offset:10784
v_accvgpr_read_b32 v176, a112
v_mfma_f32_16x16x32_bf16 a[16:19], a[224:227], v[104:107], a[16:19]
v_exp_f32 v163, v163
v_mfma_f32_16x16x32_bf16 a[32:35], a[224:227], v[112:115], a[32:35]
buffer_load_dwordx4 v29, s[40:43], s55 offen offset:1024 lds
v_mfma_f32_16x16x32_bf16 a[32:35], a[228:231], v[116:119], a[32:35]
s_xor_b32 s55, s55, 128
ds_read_b64_tr_b16 a[252:253], v10 offset:13344
v_add_f32 v161, 1.0, v161
v_mfma_f32_16x16x32_bf16 a[48:51], a[228:231], v[124:127], a[48:51]
s_add_u32 m0, s52, 81920
ds_read_b64_tr_b16 a[254:255], v10 offset:14880
v_accvgpr_read_b32 v177, a113
v_mfma_f32_16x16x32_bf16 a[48:51], a[224:227], v[120:123], a[48:51]
s_waitcnt lgkmcnt(8)
v_exp_f32 v164, v164
v_add_f32 v162, 1.0, v162
v_mfma_f32_16x16x32_bf16 a[52:55], a[232:235], v[120:123], a[52:55]
buffer_load_dwordx4 v28, s[40:43], s55 offen offset:0 lds
v_mfma_f32_16x16x32_bf16 a[52:55], a[236:239], v[124:127], a[52:55]
ds_read_b64_tr_b16 a[224:225], v10 offset:17408
v_accvgpr_read_b32 v178, a114
v_mfma_f32_16x16x32_bf16 a[36:39], a[236:239], v[116:119], a[36:39]
ds_read_b64_tr_b16 a[226:227], v10 offset:18944
v_add_f32 v163, 1.0, v163
v_mfma_f32_16x16x32_bf16 a[36:39], a[232:235], v[112:115], a[36:39]
v_exp_f32 v165, v165
v_mfma_f32_16x16x32_bf16 a[20:23], a[232:235], v[104:107], a[20:23]
buffer_load_dwordx4 v29, s[40:43], s55 offen offset:1024 lds
v_mfma_f32_16x16x32_bf16 a[20:23], a[236:239], v[108:111], a[20:23]
s_xor_b32 s55, s55, 131072
ds_read_b64_tr_b16 a[228:229], v10 offset:21504
v_accvgpr_read_b32 v179, a115
v_mfma_f32_16x16x32_bf16 a[4:7], a[236:239], v[100:103], a[4:7]
s_add_u32 m0, s52, 90112
ds_read_b64_tr_b16 a[230:231], v10 offset:23040
v_add_f32 v164, 1.0, v164
v_mfma_f32_16x16x32_bf16 a[4:7], a[232:235], v[96:99], a[4:7]
s_waitcnt lgkmcnt(8)
v_exp_f32 v166, v166
v_accvgpr_read_b32 v180, a120
v_mfma_f32_16x16x32_bf16 a[8:11], a[240:243], v[96:99], a[8:11]
ds_read_b64_tr_b16 a[232:233], v10 offset:17440
v_add_f32 v165, 1.0, v165
v_mfma_f32_16x16x32_bf16 a[8:11], a[244:247], v[100:103], a[8:11]
buffer_load_dwordx4 v28, s[40:43], s55 offen offset:0 lds
v_mfma_f32_16x16x32_bf16 a[24:27], a[244:247], v[108:111], a[24:27]
ds_read_b64_tr_b16 a[234:235], v10 offset:18976
v_accvgpr_read_b32 v181, a121
v_mfma_f32_16x16x32_bf16 a[24:27], a[240:243], v[104:107], a[24:27]
s_load_dword s101, s[92:93], 45048
v_exp_f32 v167, v167
v_mfma_f32_16x16x32_bf16 a[40:43], a[240:243], v[112:115], a[40:43]
ds_read_b64_tr_b16 a[236:237], v10 offset:21536
v_add_f32 v166, 1.0, v166
v_mfma_f32_16x16x32_bf16 a[40:43], a[244:247], v[116:119], a[40:43]
buffer_load_dwordx4 v29, s[40:43], s55 offen offset:1024 lds
v_mfma_f32_16x16x32_bf16 a[56:59], a[244:247], v[124:127], a[56:59]
ds_read_b64_tr_b16 a[238:239], v10 offset:23072
v_accvgpr_read_b32 v182, a122
v_mfma_f32_16x16x32_bf16 a[56:59], a[240:243], v[120:123], a[56:59]
s_waitcnt lgkmcnt(8)
v_add_f32 v167, 1.0, v167
v_rcp_f32 v160, v160
v_mfma_f32_16x16x32_bf16 a[60:63], a[248:251], v[120:123], a[60:63]
ds_read_b64_tr_b16 a[240:241], v10 offset:25600
v_accvgpr_read_b32 v183, a123
v_mfma_f32_16x16x32_bf16 a[60:63], a[252:255], v[124:127], a[60:63]
v_rcp_f32 v161, v161
v_mfma_f32_16x16x32_bf16 a[44:47], a[252:255], v[116:119], a[44:47]
ds_read_b64_tr_b16 a[242:243], v10 offset:27136
v_accvgpr_read_b32 v184, a116
v_mfma_f32_16x16x32_bf16 a[44:47], a[248:251], v[112:115], a[44:47]
v_rcp_f32 v162, v162
v_mfma_f32_16x16x32_bf16 a[28:31], a[248:251], v[104:107], a[28:31]
ds_read_b64_tr_b16 a[244:245], v10 offset:29696
v_accvgpr_read_b32 v185, a117
v_mfma_f32_16x16x32_bf16 a[28:31], a[252:255], v[108:111], a[28:31]
v_rcp_f32 v163, v163
v_mfma_f32_16x16x32_bf16 a[12:15], a[252:255], v[100:103], a[12:15]
ds_read_b64_tr_b16 a[246:247], v10 offset:31232
v_accvgpr_read_b32 v186, a118
v_mfma_f32_16x16x32_bf16 a[12:15], a[248:251], v[96:99], a[12:15]
s_waitcnt lgkmcnt(8)
v_accvgpr_read_b32 v187, a119
v_rcp_f32 v164, v164
v_mfma_f32_16x16x32_bf16 a[0:3], a[224:227], a[128:131], a[0:3]
ds_read_b64_tr_b16 a[248:249], v10 offset:25632
v_accvgpr_read_b32 v188, a124
v_mfma_f32_16x16x32_bf16 a[0:3], a[228:231], a[132:135], a[0:3]
v_rcp_f32 v165, v165
v_mfma_f32_16x16x32_bf16 a[16:19], a[228:231], a[140:143], a[16:19]
ds_read_b64_tr_b16 a[250:251], v10 offset:27168
v_accvgpr_read_b32 v189, a125
v_mfma_f32_16x16x32_bf16 a[16:19], a[224:227], a[136:139], a[16:19]
v_rcp_f32 v166, v166
v_mfma_f32_16x16x32_bf16 a[32:35], a[224:227], a[144:147], a[32:35]
ds_read_b64_tr_b16 a[252:253], v10 offset:29728
v_accvgpr_read_b32 v190, a126
v_mfma_f32_16x16x32_bf16 a[32:35], a[228:231], a[148:151], a[32:35]
v_rcp_f32 v167, v167
v_mfma_f32_16x16x32_bf16 a[48:51], a[228:231], a[156:159], a[48:51]
ds_read_b64_tr_b16 a[254:255], v10 offset:31264
v_accvgpr_read_b32 v191, a127
v_mfma_f32_16x16x32_bf16 a[48:51], a[224:227], a[152:155], a[48:51]
s_waitcnt vmcnt(40) lgkmcnt(8)
s_barrier
s_xor_b32 s55, s55, 128
v_mfma_f32_16x16x32_bf16 a[52:55], a[232:235], a[152:155], a[52:55]
s_add_u32 m0, s52, 0
ds_read_b64_tr_b16 a[224:225], v16 offset:32768
v_mul_f32 v160, v160, v168
v_mfma_f32_16x16x32_bf16 a[52:55], a[236:239], a[156:159], a[52:55]
buffer_load_dwordx4 v28, s[40:43], s55 offen offset:0 lds
v_mfma_f32_16x16x32_bf16 a[36:39], a[236:239], a[148:151], a[36:39]
s_lshl_b32 s6, s68, 7
ds_read_b64_tr_b16 a[226:227], v16 offset:34816
v_mul_f32 v176, s57, v176
v_mfma_f32_16x16x32_bf16 a[36:39], a[232:235], a[144:147], a[36:39]
s_add_u32 s6, s6, 50348032
v_exp_f32 v176, v176
v_mfma_f32_16x16x32_bf16 a[20:23], a[232:235], a[136:139], a[20:23]
buffer_load_dwordx4 v29, s[40:43], s55 offen offset:1024 lds
v_mfma_f32_16x16x32_bf16 a[20:23], a[236:239], a[140:143], a[20:23]
s_bfe_u32 s55, 0x90d0707, s64
ds_read_b64_tr_b16 a[228:229], v16 offset:36864
v_mul_f32 v161, v161, v169
v_mfma_f32_16x16x32_bf16 a[4:7], a[236:239], a[132:135], a[4:7]
s_lshl_b32 s55, s55, 18
ds_read_b64_tr_b16 a[230:231], v16 offset:38912
v_mul_f32 v177, s57, v177
v_mfma_f32_16x16x32_bf16 a[4:7], a[232:235], a[128:131], a[4:7]
s_waitcnt lgkmcnt(8)
v_mul_f32 v162, v162, v170
v_exp_f32 v177, v177
v_mfma_f32_16x16x32_bf16 a[8:11], a[240:243], a[128:131], a[8:11]
s_or_b32 s55, s55, 128
ds_read_b64_tr_b16 a[232:233], v17 offset:32768
s_add_u32 m0, s52, 8192
v_mfma_f32_16x16x32_bf16 a[8:11], a[244:247], a[132:135], a[8:11]
buffer_load_dwordx4 v28, s[40:43], s55 offen offset:0 lds
v_mfma_f32_16x16x32_bf16 a[24:27], a[244:247], a[140:143], a[24:27]
s_lshl_b32 s7, s33, 2
ds_read_b64_tr_b16 a[234:235], v17 offset:34816
v_mul_f32 v178, s57, v178
v_mfma_f32_16x16x32_bf16 a[24:27], a[240:243], a[136:139], a[24:27]
s_add_u32 s7, s7, s6
v_exp_f32 v178, v178
v_mfma_f32_16x16x32_bf16 a[40:43], a[240:243], a[144:147], a[40:43]
s_waitcnt vmcnt(13)
ds_read_b64_tr_b16 a[236:237], v17 offset:36864
v_mul_f32 v163, v163, v171
v_mfma_f32_16x16x32_bf16 a[40:43], a[244:247], a[148:151], a[40:43]
buffer_store_dword v32, v30, s[24:27], s7 offen sc1
buffer_load_dwordx4 v29, s[40:43], s55 offen offset:1024 lds
v_and_b32 v55, 28, v31
v_mfma_f32_16x16x32_bf16 a[56:59], a[244:247], a[156:159], a[56:59]
s_xor_b32 s55, s55, 128
ds_read_b64_tr_b16 a[238:239], v17 offset:38912
v_mul_f32 v179, s57, v179
v_mfma_f32_16x16x32_bf16 a[56:59], a[240:243], a[152:155], a[56:59]
s_waitcnt lgkmcnt(8)
v_mul_f32 v164, v164, v172
v_exp_f32 v179, v179
v_mfma_f32_16x16x32_bf16 a[60:63], a[248:251], a[152:155], a[60:63]
s_add_u32 m0, s52, 16384
ds_read_b64_tr_b16 a[240:241], v18 offset:32768
v_mul_f32 v180, s57, v180
v_mfma_f32_16x16x32_bf16 a[60:63], a[252:255], a[156:159], a[60:63]
buffer_load_dwordx4 v28, s[40:43], s55 offen offset:0 lds
v_mfma_f32_16x16x32_bf16 a[44:47], a[252:255], a[148:151], a[44:47]
ds_read_b64_tr_b16 a[242:243], v18 offset:34816
v_mul_f32 v165, v165, v173
v_mfma_f32_16x16x32_bf16 a[44:47], a[248:251], a[144:147], a[44:47]
v_exp_f32 v180, v180
v_mfma_f32_16x16x32_bf16 a[28:31], a[248:251], a[136:139], a[28:31]
ds_read_b64_tr_b16 a[244:245], v18 offset:36864
v_mul_f32 v181, s57, v181
v_mfma_f32_16x16x32_bf16 a[28:31], a[252:255], a[140:143], a[28:31]
buffer_load_dwordx4 v29, s[40:43], s55 offen offset:1024 lds
v_mfma_f32_16x16x32_bf16 a[12:15], a[252:255], a[132:135], a[12:15]
ds_read_b64_tr_b16 a[246:247], v18 offset:38912
v_mul_f32 v166, v166, v174
v_mfma_f32_16x16x32_bf16 a[12:15], a[248:251], a[128:131], a[12:15]
s_waitcnt lgkmcnt(8)
v_mul_f32 v182, s57, v182
v_exp_f32 v181, v181
v_mfma_f32_16x16x32_bf16 v[64:67], a[224:227], v[128:131], 0
s_bfe_u32 s54, 0x3030509, s64
ds_read_b64_tr_b16 a[248:249], v19 offset:32768
s_lshl_b32 s54, s54, 13
v_mul_f32 v167, v167, v175
v_mul_f32 v183, s57, v183
v_cvt_pk_bf16_f32 v160, v160, v161
v_exp_f32 v182, v182
v_mfma_f32_16x16x32_bf16 v[64:67], a[228:231], v[136:139], v[64:67]
s_add_u32 s54, s54, s63
ds_read_b64_tr_b16 a[250:251], v19 offset:34816
v_cvt_pk_bf16_f32 v161, v162, v163
v_cvt_pk_bf16_f32 v162, v164, v165
v_cvt_pk_bf16_f32 v163, v166, v167
v_and_b32 v164, 512, v1
v_permlane32_swap_b32 v160, v162
v_mfma_f32_16x16x32_bf16 v[68:71], a[228:231], v[140:143], 0
ds_read_b64_tr_b16 a[252:253], v19 offset:36864
buffer_load_dwordx4 a[128:131], v1, s[24:27], s54 offen offset:0 sc1
v_permlane32_swap_b32 v161, v163
v_exp_f32 v183, v183
v_mfma_f32_16x16x32_bf16 v[68:71], a[224:227], v[132:135], v[68:71]
s_waitcnt lgkmcnt(7)
ds_read_b64_tr_b16 a[254:255], v19 offset:38912
v_add_u32 v164, v164, v1
v_accvgpr_read_b32 v224, a64
v_accvgpr_read_b32 v225, a65
v_accvgpr_read_b32 v226, a66
v_accvgpr_read_b32 v227, a67
v_accvgpr_read_b32 v228, a68
v_mfma_f32_16x16x32_bf16 v[76:79], a[232:235], v[132:135], 0
buffer_store_dwordx4 v[160:163], v164, s[24:27], s66 offen sc1
buffer_load_dwordx4 a[132:135], v1, s[24:27], s54 offen offset:1024 sc1
v_add_f32 v176, 1.0, v176
v_add_f32 v177, 1.0, v177
v_mfma_f32_16x16x32_bf16 v[76:79], a[236:239], v[140:143], v[76:79]
ds_read_b64_tr_b16 a[224:225], v16 offset:40960
v_add_f32 v178, 1.0, v178
v_add_f32 v179, 1.0, v179
v_add_f32 v180, 1.0, v180
v_add_f32 v181, 1.0, v181
v_rcp_f32 v176, v176
v_mfma_f32_16x16x32_bf16 v[72:75], a[236:239], v[136:139], 0
s_add_u32 s66, s66, 294912
ds_read_b64_tr_b16 a[226:227], v16 offset:43008
v_add_f32 v182, 1.0, v182
v_add_f32 v183, 1.0, v183
v_rcp_f32 v177, v177
v_rcp_f32 v178, v178
v_mfma_f32_16x16x32_bf16 v[72:75], a[232:235], v[128:131], v[72:75]
s_waitcnt lgkmcnt(6)
ds_read_b64_tr_b16 a[228:229], v16 offset:45056
buffer_load_dwordx4 a[136:139], v1, s[24:27], s54 offen offset:2048 sc1
v_rcp_f32 v179, v179
v_rcp_f32 v180, v180
v_mfma_f32_16x16x32_bf16 v[80:83], a[240:243], v[128:131], 0
ds_read_b64_tr_b16 a[230:231], v16 offset:47104
v_rcp_f32 v181, v181
v_rcp_f32 v182, v182
v_rcp_f32 v183, v183
v_mfma_f32_16x16x32_bf16 v[80:83], a[244:247], v[136:139], v[80:83]
ds_read_b64_tr_b16 a[232:233], v17 offset:40960
buffer_load_dwordx4 a[140:143], v1, s[24:27], s54 offen offset:3072 sc1
v_mul_f32 v176, v176, v184
v_mul_f32 v177, v177, v185
v_mul_f32 v178, v178, v186
v_mul_f32 v179, v179, v187
v_mfma_f32_16x16x32_bf16 v[84:87], a[244:247], v[140:143], 0
ds_read_b64_tr_b16 a[234:235], v17 offset:43008
v_mul_f32 v180, v180, v188
v_mul_f32 v181, v181, v189
v_mul_f32 v182, v182, v190
v_mul_f32 v183, v183, v191
v_cvt_pk_bf16_f32 v176, v176, v177
v_cvt_pk_bf16_f32 v177, v178, v179
v_mfma_f32_16x16x32_bf16 v[84:87], a[240:243], v[132:135], v[84:87]
s_waitcnt lgkmcnt(6)
ds_read_b64_tr_b16 a[236:237], v17 offset:45056
buffer_load_dwordx4 a[144:147], v2, s[24:27], s54 offen offset:0 sc1
v_cvt_pk_bf16_f32 v178, v180, v181
v_cvt_pk_bf16_f32 v179, v182, v183
v_and_b32 v180, 512, v1
v_add_u32 v180, v180, v1
v_mfma_f32_16x16x32_bf16 v[92:95], a[248:251], v[132:135], 0
ds_read_b64_tr_b16 a[238:239], v17 offset:47104
v_permlane32_swap_b32 v176, v178
v_permlane32_swap_b32 v177, v179
v_accvgpr_read_b32 v229, a69
v_accvgpr_read_b32 v230, a70
v_mfma_f32_16x16x32_bf16 v[92:95], a[252:255], v[140:143], v[92:95]
buffer_store_dwordx4 v[176:179], v180, s[24:27], s66 offen sc1
buffer_load_dwordx4 a[148:151], v2, s[24:27], s54 offen offset:1024 sc1
v_accvgpr_read_b32 v231, a71
v_accvgpr_read_b32 v232, a72
v_mfma_f32_16x16x32_bf16 v[88:91], a[252:255], v[136:139], 0
s_add_u32 s4, s65, 32768
ds_read_b64_tr_b16 a[240:241], v18 offset:40960
ds_read_b64_tr_b16 a[242:243], v18 offset:43008
v_accvgpr_read_b32 v233, a73
v_accvgpr_read_b32 v234, a74
v_accvgpr_read_b32 v235, a75
v_accvgpr_read_b32 v236, a76
v_accvgpr_read_b32 v237, a77
v_mfma_f32_16x16x32_bf16 v[88:91], a[248:251], v[128:131], v[88:91]
s_waitcnt lgkmcnt(6)
ds_read_b64_tr_b16 a[244:245], v18 offset:45056
v_accvgpr_read_b32 v238, a78
v_accvgpr_read_b32 v239, a79
v_accvgpr_read_b32 v240, a80
v_accvgpr_read_b32 v241, a81
v_accvgpr_read_b32 v242, a82
v_accvgpr_read_b32 v243, a83
v_mfma_f32_16x16x32_bf16 a[192:195], a[224:227], v[128:131], 0
ds_read_b64_tr_b16 a[246:247], v18 offset:47104
buffer_load_dwordx4 v[4:7], v34, s[8:11], s65 offen offset:0
v_accvgpr_read_b32 v244, a84
v_accvgpr_read_b32 v245, a85
v_accvgpr_read_b32 v246, a86
v_accvgpr_read_b32 v247, a87
v_mfma_f32_16x16x32_bf16 a[192:195], a[228:231], v[136:139], a[192:195]
ds_read_b64_tr_b16 a[248:249], v19 offset:40960
v_accvgpr_read_b32 v248, a88
v_accvgpr_read_b32 v249, a89
v_accvgpr_read_b32 v250, a90
v_accvgpr_read_b32 v251, a91
v_accvgpr_read_b32 v252, a92
v_accvgpr_read_b32 v253, a93
v_mfma_f32_16x16x32_bf16 a[196:199], a[228:231], v[140:143], 0
ds_read_b64_tr_b16 a[250:251], v19 offset:43008
v_accvgpr_read_b32 v254, a94
v_accvgpr_read_b32 v255, a95
v_cvt_pk_bf16_f32 v224, v224, v225
v_cvt_pk_bf16_f32 v225, v226, v227
v_cvt_pk_bf16_f32 v226, v228, v229
v_cvt_pk_bf16_f32 v227, v230, v231
v_mfma_f32_16x16x32_bf16 a[196:199], a[224:227], v[132:135], a[196:199]
s_waitcnt lgkmcnt(6)
ds_read_b64_tr_b16 a[252:253], v19 offset:45056
v_cvt_pk_bf16_f32 v228, v232, v233
v_cvt_pk_bf16_f32 v229, v234, v235
v_cvt_pk_bf16_f32 v230, v236, v237
v_cvt_pk_bf16_f32 v231, v238, v239
v_mfma_f32_16x16x32_bf16 v[192:195], v[40:43], v[224:227], 0
buffer_load_dwordx4 v[12:15], v34, s[8:11], s65 offen offset:64
v_mfma_f32_16x16x32_bf16 v[196:199], v[44:47], v[224:227], 0
ds_read_b64_tr_b16 a[254:255], v19 offset:47104
v_mfma_f32_16x16x32_bf16 v[200:203], v[40:43], v[228:231], 0
v_mfma_f32_16x16x32_bf16 v[204:207], v[44:47], v[228:231], 0
v_mfma_f32_16x16x32_bf16 a[204:207], a[232:235], v[132:135], 0
ds_read_b64_tr_b16 a[224:225], v16 offset:49152
v_mfma_f32_16x16x32_bf16 a[204:207], a[236:239], v[140:143], a[204:207]
ds_read_b64_tr_b16 a[226:227], v16 offset:51200
v_max3_f32 v60, v192, v193, v194
v_max3_f32 v62, -v192, -v193, -v194
v_max3_f32 v60, v60, v195, v196
v_max3_f32 v62, v62, -v195, -v196
v_max3_f32 v60, v60, v197, v198
v_max3_f32 v62, v62, -v197, -v198
v_mfma_f32_16x16x32_bf16 a[200:203], a[236:239], v[136:139], 0
pg_10_b:
s_cbranch_execz pg_14_b
ds_read_b64_tr_b16 a[228:229], v16 offset:53248
v_max_f32 v60, v60, v199
v_max_f32_e64 v62, v62, -v199
v_max3_f32 v61, v200, v201, v202
v_max3_f32 v63, -v200, -v201, -v202
v_max3_f32 v61, v61, v203, v204
v_max3_f32 v63, v63, -v203, -v204
v_mfma_f32_16x16x32_bf16 a[200:203], a[232:235], v[128:131], a[200:203]
s_waitcnt lgkmcnt(7)
ds_read_b64_tr_b16 a[230:231], v16 offset:55296
buffer_load_dwordx4 v[8:11], v34, s[8:11], s4 offen offset:0
v_max3_f32 v61, v61, v205, v206
v_max3_f32 v63, v63, -v205, -v206
v_max_f32 v61, v61, v207
v_max_f32_e64 v63, v63, -v207
v_mfma_f32_16x16x32_bf16 a[208:211], a[240:243], v[128:131], 0
ds_read_b64_tr_b16 a[232:233], v17 offset:49152
v_permlane16_swap_b32 v60, v61
v_permlane16_swap_b32 v62, v63
v_max_f32 v60, v60, v61
v_max_f32 v62, v62, v63
v_mfma_f32_16x16x32_bf16 a[208:211], a[244:247], v[136:139], a[208:211]
ds_read_b64_tr_b16 a[234:235], v17 offset:51200
ds_read_b64_tr_b16 a[236:237], v17 offset:53248
v_mfma_f32_16x16x32_bf16 a[212:215], a[244:247], v[140:143], 0
v_permlane32_swap_b32 v60, v62
v_max_f32 v60, v60, v62
v_mul_f32 v60, s58, v60
v_mov_b32 v62, v60
v_mfma_f32_16x16x32_bf16 a[212:215], a[240:243], v[132:135], a[212:215]
s_waitcnt lgkmcnt(7)
ds_read_b64_tr_b16 a[238:239], v17 offset:55296
v_mfma_f32_16x16x32_bf16 a[220:223], a[248:251], v[132:135], 0
ds_read_b64_tr_b16 a[240:241], v18 offset:49152
buffer_load_dwordx4 v[56:59], v34, s[8:11], s4 offen offset:64
v_accvgpr_read_b32 v160, a0
v_accvgpr_read_b32 v161, a1
v_permlane32_swap_b32 v60, v62
v_mfma_f32_16x16x32_bf16 a[220:223], a[252:255], v[140:143], a[220:223]
ds_read_b64_tr_b16 a[242:243], v18 offset:51200
v_accvgpr_read_b32 v162, a2
v_accvgpr_read_b32 v163, a3
v_accvgpr_read_b32 v164, a4
v_accvgpr_read_b32 v165, a5
v_accvgpr_read_b32 v166, a6
v_accvgpr_read_b32 v167, a7
v_mfma_f32_16x16x32_bf16 a[216:219], a[252:255], v[136:139], 0
ds_read_b64_tr_b16 a[244:245], v18 offset:53248
v_accvgpr_read_b32 v168, a8
v_accvgpr_read_b32 v169, a9
v_accvgpr_read_b32 v170, a10
v_accvgpr_read_b32 v171, a11
v_accvgpr_read_b32 v172, a12
v_accvgpr_read_b32 v173, a13
v_mfma_f32_16x16x32_bf16 a[216:219], a[248:251], v[128:131], a[216:219]
s_waitcnt lgkmcnt(7)
ds_read_b64_tr_b16 a[246:247], v18 offset:55296
v_accvgpr_read_b32 v174, a14
v_accvgpr_read_b32 v175, a15
v_mul_f32 v160, s57, v160
v_mul_f32 v161, s57, v161
v_exp_f32 v160, v160
v_mfma_f32_16x16x32_bf16 a[192:195], a[224:227], v[144:147], a[192:195]
ds_read_b64_tr_b16 a[248:249], v19 offset:49152
v_mul_f32 v162, s57, v162
v_mul_f32 v163, s57, v163
v_mul_f32 v164, s57, v164
v_mul_f32 v165, s57, v165
v_exp_f32 v161, v161
v_mfma_f32_16x16x32_bf16 a[192:195], a[228:231], v[152:155], a[192:195]
ds_read_b64_tr_b16 a[250:251], v19 offset:51200
v_mul_f32 v166, s57, v166
v_mul_f32 v167, s57, v167
v_exp_f32 v162, v162
v_exp_f32 v163, v163
v_mfma_f32_16x16x32_bf16 a[196:199], a[228:231], v[156:159], a[196:199]
ds_read_b64_tr_b16 a[252:253], v19 offset:53248
v_exp_f32 v164, v164
v_exp_f32 v165, v165
v_exp_f32 v166, v166
v_mfma_f32_16x16x32_bf16 a[196:199], a[224:227], v[148:151], a[196:199]
s_waitcnt lgkmcnt(7)
ds_read_b64_tr_b16 a[254:255], v19 offset:55296
v_exp_f32 v167, v167
v_add_f32 v160, 1.0, v160
v_accvgpr_read_b32 v176, a16
v_rcp_f32 v160, v160
v_mfma_f32_16x16x32_bf16 a[204:207], a[232:235], v[148:151], a[204:207]
ds_read_b64_tr_b16 a[224:225], v16 offset:57344
v_add_f32 v161, 1.0, v161
v_accvgpr_read_b32 v177, a17
v_add_f32 v162, 1.0, v162
v_accvgpr_read_b32 v178, a18
v_rcp_f32 v161, v161
v_mfma_f32_16x16x32_bf16 a[204:207], a[236:239], v[156:159], a[204:207]
ds_read_b64_tr_b16 a[226:227], v16 offset:59392
v_add_f32 v163, 1.0, v163
v_accvgpr_read_b32 v179, a19
v_add_f32 v164, 1.0, v164
v_accvgpr_read_b32 v180, a20
v_rcp_f32 v162, v162
v_mfma_f32_16x16x32_bf16 a[200:203], a[236:239], v[152:155], a[200:203]
ds_read_b64_tr_b16 a[228:229], v16 offset:61440
v_add_f32 v165, 1.0, v165
v_accvgpr_read_b32 v181, a21
v_add_f32 v166, 1.0, v166
v_accvgpr_read_b32 v182, a22
v_rcp_f32 v163, v163
v_mfma_f32_16x16x32_bf16 a[200:203], a[232:235], v[144:147], a[200:203]
s_waitcnt lgkmcnt(7)
ds_read_b64_tr_b16 a[230:231], v16 offset:63488
v_add_f32 v167, 1.0, v167
v_accvgpr_read_b32 v183, a23
v_accvgpr_read_b32 v184, a24
v_accvgpr_read_b32 v185, a25
v_rcp_f32 v164, v164
v_mfma_f32_16x16x32_bf16 a[208:211], a[240:243], v[144:147], a[208:211]
ds_read_b64_tr_b16 a[232:233], v17 offset:57344
v_accvgpr_read_b32 v186, a26
v_accvgpr_read_b32 v187, a27
v_accvgpr_read_b32 v188, a28
v_rcp_f32 v165, v165
v_accvgpr_read_b32 v189, a29
v_mfma_f32_16x16x32_bf16 a[208:211], a[244:247], v[152:155], a[208:211]
ds_read_b64_tr_b16 a[234:235], v17 offset:59392
v_rcp_f32 v166, v166
v_accvgpr_read_b32 v190, a30
v_rcp_f32 v167, v167
v_accvgpr_read_b32 v191, a31
v_mfma_f32_16x16x32_bf16 a[212:215], a[244:247], v[156:159], a[212:215]
ds_read_b64_tr_b16 a[236:237], v17 offset:61440
v_mul_f32 v160, v160, v168
v_mul_f32 v176, s57, v176
v_mul_f32 v161, v161, v169
v_mul_f32 v177, s57, v177
v_exp_f32 v176, v176
v_mfma_f32_16x16x32_bf16 a[212:215], a[240:243], v[148:151], a[212:215]
s_waitcnt lgkmcnt(7)
ds_read_b64_tr_b16 a[238:239], v17 offset:63488
v_mul_f32 v162, v162, v170
v_mul_f32 v178, s57, v178
v_mul_f32 v163, v163, v171
v_mul_f32 v179, s57, v179
v_exp_f32 v177, v177
v_mfma_f32_16x16x32_bf16 a[220:223], a[248:251], v[148:151], a[220:223]
ds_read_b64_tr_b16 a[240:241], v18 offset:57344
v_mul_f32 v164, v164, v172
v_mul_f32 v180, s57, v180
v_mul_f32 v165, v165, v173
v_mul_f32 v181, s57, v181
v_exp_f32 v178, v178
v_mfma_f32_16x16x32_bf16 a[220:223], a[252:255], v[156:159], a[220:223]
ds_read_b64_tr_b16 a[242:243], v18 offset:59392
v_mul_f32 v166, v166, v174
v_mul_f32 v182, s57, v182
v_mul_f32 v167, v167, v175
v_mul_f32 v183, s57, v183
v_exp_f32 v179, v179
v_mfma_f32_16x16x32_bf16 a[216:219], a[252:255], v[152:155], a[216:219]
ds_read_b64_tr_b16 a[244:245], v18 offset:61440
v_cvt_pk_bf16_f32 v160, v160, v161
v_cvt_pk_bf16_f32 v161, v162, v163
v_cvt_pk_bf16_f32 v162, v164, v165
v_cvt_pk_bf16_f32 v163, v166, v167
v_exp_f32 v180, v180
v_mfma_f32_16x16x32_bf16 a[216:219], a[248:251], v[144:147], a[216:219]
s_waitcnt lgkmcnt(7)
ds_read_b64_tr_b16 a[246:247], v18 offset:63488
v_exp_f32 v181, v181
v_exp_f32 v182, v182
v_exp_f32 v183, v183
v_mfma_f32_16x16x32_bf16 v[64:67], a[224:227], v[144:147], v[64:67]
ds_read_b64_tr_b16 a[248:249], v19 offset:57344
v_mov_b32 v61, v60
v_mov_b32 v63, v62
v_mfma_f32_16x16x32_bf16 v[64:67], a[228:231], v[152:155], v[64:67]
ds_read_b64_tr_b16 a[250:251], v19 offset:59392
v_permlane16_swap_b32 v60, v61
v_permlane16_swap_b32 v62, v63
v_fma_f32 v208, -v192, s58, -v62
v_fma_f32 v192, v192, s58, -v60
v_mfma_f32_16x16x32_bf16 v[68:71], a[228:231], v[156:159], v[68:71]
ds_read_b64_tr_b16 a[252:253], v19 offset:61440
v_fma_f32 v209, -v193, s58, -v62
v_fma_f32 v193, v193, s58, -v60
v_fma_f32 v210, -v194, s58, -v62
v_fma_f32 v194, v194, s58, -v60
v_exp_f32 v208, v208
v_mfma_f32_16x16x32_bf16 v[68:71], a[224:227], v[148:151], v[68:71]
s_waitcnt vmcnt(43) lgkmcnt(7)
s_barrier
ds_read_b64_tr_b16 a[254:255], v19 offset:63488
buffer_load_dwordx4 a[152:155], v2, s[24:27], s54 offen offset:2048 sc1
v_exp_f32 v192, v192
v_mfma_f32_16x16x32_bf16 v[76:79], a[232:235], v[148:151], v[76:79]
ds_read_b64_tr_b16 a[224:225], v20 offset:32768
v_fma_f32 v211, -v195, s58, -v62
v_fma_f32 v195, v195, s58, -v60
v_fma_f32 v212, -v196, s58, -v62
v_fma_f32 v196, v196, s58, -v60
v_exp_f32 v209, v209
v_mfma_f32_16x16x32_bf16 v[76:79], a[236:239], v[156:159], v[76:79]
buffer_store_dwordx4 v[160:163], v1, s[24:27], s60 offen offset:0 sc1
ds_read_b64_tr_b16 a[226:227], v20 offset:34816
v_add_f32 v176, 1.0, v176
v_accvgpr_read_b32 v160, a32
v_add_f32 v177, 1.0, v177
v_mfma_f32_16x16x32_bf16 v[72:75], a[236:239], v[152:155], v[72:75]
ds_read_b64_tr_b16 a[228:229], v20 offset:36864
v_accvgpr_read_b32 v161, a33
v_add_f32 v178, 1.0, v178
v_accvgpr_read_b32 v162, a34
v_add_f32 v179, 1.0, v179
v_rcp_f32 v176, v176
v_mfma_f32_16x16x32_bf16 v[72:75], a[232:235], v[144:147], v[72:75]
s_waitcnt lgkmcnt(7)
ds_read_b64_tr_b16 a[230:231], v20 offset:38912
buffer_load_dwordx4 a[156:159], v2, s[24:27], s54 offen offset:3072 sc1
v_accvgpr_read_b32 v163, a35
v_add_f32 v180, 1.0, v180
v_rcp_f32 v177, v177
v_mfma_f32_16x16x32_bf16 v[80:83], a[240:243], v[144:147], v[80:83]
s_bfe_u32 s54, 0x5070b05, s64
ds_read_b64_tr_b16 a[232:233], v21 offset:32768
s_lshl_b32 s54, s54, 13
v_accvgpr_read_b32 v164, a36
v_add_f32 v181, 1.0, v181
v_accvgpr_read_b32 v165, a37
v_rcp_f32 v178, v178
v_mfma_f32_16x16x32_bf16 v[80:83], a[244:247], v[152:155], v[80:83]
s_add_u32 s54, s54, s63
ds_read_b64_tr_b16 a[234:235], v21 offset:34816
v_add_f32 v182, 1.0, v182
v_accvgpr_read_b32 v166, a38
v_add_f32 v183, 1.0, v183
v_accvgpr_read_b32 v167, a39
v_rcp_f32 v179, v179
v_mfma_f32_16x16x32_bf16 v[84:87], a[244:247], v[156:159], v[84:87]
ds_read_b64_tr_b16 a[236:237], v21 offset:36864
buffer_load_dwordx4 a[0:3], v1, s[24:27], s54 offen offset:0 sc1
v_accvgpr_read_b32 v168, a40
v_accvgpr_read_b32 v169, a41
v_rcp_f32 v180, v180
v_mfma_f32_16x16x32_bf16 v[84:87], a[240:243], v[148:151], v[84:87]
s_waitcnt lgkmcnt(7)
ds_read_b64_tr_b16 a[238:239], v21 offset:38912
v_accvgpr_read_b32 v170, a42
v_accvgpr_read_b32 v171, a43
v_accvgpr_read_b32 v172, a44
v_rcp_f32 v181, v181
v_accvgpr_read_b32 v173, a45
v_mfma_f32_16x16x32_bf16 v[92:95], a[248:251], v[148:151], v[92:95]
ds_read_b64_tr_b16 a[240:241], v22 offset:32768
buffer_load_dwordx4 a[4:7], v1, s[24:27], s54 offen offset:1024 sc1
v_rcp_f32 v182, v182
v_rcp_f32 v183, v183
v_mfma_f32_16x16x32_bf16 v[92:95], a[252:255], v[156:159], v[92:95]
ds_read_b64_tr_b16 a[242:243], v22 offset:34816
v_accvgpr_read_b32 v174, a46
v_accvgpr_read_b32 v175, a47
v_mul_f32 v176, v176, v184
v_mul_f32 v160, s57, v160
v_exp_f32 v160, v160
v_mfma_f32_16x16x32_bf16 v[88:91], a[252:255], v[152:155], v[88:91]
ds_read_b64_tr_b16 a[244:245], v22 offset:36864
buffer_load_dwordx4 a[8:11], v1, s[24:27], s54 offen offset:2048 sc1
v_mul_f32 v177, v177, v185
v_mul_f32 v161, s57, v161
v_exp_f32 v161, v161
v_mfma_f32_16x16x32_bf16 v[88:91], a[248:251], v[144:147], v[88:91]
s_waitcnt lgkmcnt(7)
ds_read_b64_tr_b16 a[246:247], v22 offset:38912
buffer_load_dword v33, v55, s[24:27], s6 offen offset:0 sc1
v_mul_f32 v178, v178, v186
v_mul_f32 v162, s57, v162
v_exp_f32 v162, v162
v_mfma_f32_16x16x32_bf16 v[64:67], a[224:227], a[160:163], v[64:67]
ds_read_b64_tr_b16 a[248:249], v23 offset:32768
buffer_load_dwordx4 a[12:15], v1, s[24:27], s54 offen offset:3072 sc1
v_mul_f32 v179, v179, v187
v_mul_f32 v163, s57, v163
v_exp_f32 v163, v163
v_mfma_f32_16x16x32_bf16 v[64:67], a[228:231], a[168:171], v[64:67]
ds_read_b64_tr_b16 a[250:251], v23 offset:34816
v_mul_f32 v180, v180, v188
v_mul_f32 v164, s57, v164
v_mul_f32 v181, v181, v189
v_mul_f32 v165, s57, v165
v_exp_f32 v164, v164
v_mfma_f32_16x16x32_bf16 v[68:71], a[228:231], a[172:175], v[68:71]
ds_read_b64_tr_b16 a[252:253], v23 offset:36864
buffer_load_dwordx4 a[16:19], v2, s[24:27], s54 offen offset:0 sc1
v_mul_f32 v182, v182, v190
v_mul_f32 v166, s57, v166
v_exp_f32 v165, v165
v_mfma_f32_16x16x32_bf16 v[68:71], a[224:227], a[164:167], v[68:71]
s_waitcnt lgkmcnt(7)
ds_read_b64_tr_b16 a[254:255], v23 offset:38912
v_mul_f32 v183, v183, v191
v_mul_f32 v167, s57, v167
v_cvt_pk_bf16_f32 v176, v176, v177
v_cvt_pk_bf16_f32 v177, v178, v179
v_exp_f32 v166, v166
v_mfma_f32_16x16x32_bf16 v[76:79], a[232:235], a[164:167], v[76:79]
ds_read_b64_tr_b16 a[224:225], v20 offset:40960
buffer_load_dwordx4 a[20:23], v2, s[24:27], s54 offen offset:1024 sc1
v_cvt_pk_bf16_f32 v178, v180, v181
v_cvt_pk_bf16_f32 v179, v182, v183
v_exp_f32 v167, v167
v_mfma_f32_16x16x32_bf16 v[76:79], a[236:239], a[172:175], v[76:79]
ds_read_b64_tr_b16 a[226:227], v20 offset:43008
v_add_f32 v160, 1.0, v160
v_add_f32 v161, 1.0, v161
v_add_f32 v162, 1.0, v162
v_add_f32 v163, 1.0, v163
v_rcp_f32 v160, v160
v_mfma_f32_16x16x32_bf16 v[72:75], a[236:239], a[168:171], v[72:75]
buffer_store_dwordx4 v[176:179], v1, s[24:27], s60 offen offset:1024 sc1
ds_read_b64_tr_b16 a[228:229], v20 offset:45056
v_add_f32 v164, 1.0, v164
v_accvgpr_read_b32 v176, a48
v_accvgpr_read_b32 v177, a49
v_mfma_f32_16x16x32_bf16 v[72:75], a[232:235], a[160:163], v[72:75]
s_waitcnt lgkmcnt(7)
ds_read_b64_tr_b16 a[230:231], v20 offset:47104
v_accvgpr_read_b32 v178, a50
v_accvgpr_read_b32 v179, a51
v_accvgpr_read_b32 v180, a52
v_add_f32 v165, 1.0, v165
v_rcp_f32 v161, v161
v_mfma_f32_16x16x32_bf16 v[80:83], a[240:243], a[160:163], v[80:83]
s_load_dword s101, s[92:93], 49144
ds_read_b64_tr_b16 a[232:233], v21 offset:40960
buffer_load_dwordx4 a[24:27], v2, s[24:27], s54 offen offset:2048 sc1
v_accvgpr_read_b32 v181, a53
v_add_f32 v166, 1.0, v166
v_rcp_f32 v162, v162
v_mfma_f32_16x16x32_bf16 v[80:83], a[244:247], a[168:171], v[80:83]
ds_read_b64_tr_b16 a[234:235], v21 offset:43008
v_accvgpr_read_b32 v182, a54
v_add_f32 v167, 1.0, v167
v_accvgpr_read_b32 v183, a55
v_accvgpr_read_b32 v184, a56
v_rcp_f32 v163, v163
v_mfma_f32_16x16x32_bf16 v[84:87], a[244:247], a[172:175], v[84:87]
ds_read_b64_tr_b16 a[236:237], v21 offset:45056
buffer_load_dwordx4 a[28:31], v2, s[24:27], s54 offen offset:3072 sc1
v_accvgpr_read_b32 v185, a57
v_accvgpr_read_b32 v186, a58
v_rcp_f32 v164, v164
v_mfma_f32_16x16x32_bf16 v[84:87], a[240:243], a[164:167], v[84:87]
s_waitcnt lgkmcnt(7)
ds_read_b64_tr_b16 a[238:239], v21 offset:47104
s_xor_b32 s55, s55, 131072
v_accvgpr_read_b32 v187, a59
v_accvgpr_read_b32 v188, a60
v_rcp_f32 v165, v165
v_accvgpr_read_b32 v189, a61
v_mfma_f32_16x16x32_bf16 v[92:95], a[248:251], a[164:167], v[92:95]
s_add_u32 m0, s52, 24576
ds_read_b64_tr_b16 a[240:241], v22 offset:40960
v_rcp_f32 v166, v166
v_accvgpr_read_b32 v190, a62
v_rcp_f32 v167, v167
v_accvgpr_read_b32 v191, a63
v_mfma_f32_16x16x32_bf16 v[92:95], a[252:255], a[172:175], v[92:95]
ds_read_b64_tr_b16 a[242:243], v22 offset:43008
buffer_load_dwordx4 v28, s[40:43], s55 offen offset:0 lds
v_mul_f32 v160, v160, v168
v_mul_f32 v176, s57, v176
v_exp_f32 v176, v176
v_mfma_f32_16x16x32_bf16 v[88:91], a[252:255], a[168:171], v[88:91]
s_add_u32 s60, s60, 294912
ds_read_b64_tr_b16 a[244:245], v22 offset:45056
v_mul_f32 v161, v161, v169
v_mul_f32 v177, s57, v177
v_mul_f32 v162, v162, v170
v_mul_f32 v178, s57, v178
v_exp_f32 v177, v177
v_mfma_f32_16x16x32_bf16 v[88:91], a[248:251], a[160:163], v[88:91]
s_waitcnt lgkmcnt(7)
ds_read_b64_tr_b16 a[246:247], v22 offset:47104
buffer_load_dwordx4 v29, s[40:43], s55 offen offset:1024 lds
v_mul_f32 v163, v163, v171
v_mul_f32 v179, s57, v179
v_exp_f32 v178, v178
v_mfma_f32_16x16x32_bf16 a[192:195], a[224:227], a[160:163], a[192:195]
s_xor_b32 s55, s55, 128
ds_read_b64_tr_b16 a[248:249], v23 offset:40960
v_mul_f32 v164, v164, v172
v_mul_f32 v180, s57, v180
v_mul_f32 v165, v165, v173
v_mul_f32 v181, s57, v181
v_exp_f32 v179, v179
v_mfma_f32_16x16x32_bf16 a[192:195], a[228:231], a[168:171], a[192:195]
s_add_u32 m0, s52, 32768
ds_read_b64_tr_b16 a[250:251], v23 offset:43008
v_mul_f32 v166, v166, v174
v_mul_f32 v182, s57, v182
v_mul_f32 v167, v167, v175
v_mul_f32 v183, s57, v183
v_exp_f32 v180, v180
v_mfma_f32_16x16x32_bf16 a[196:199], a[228:231], a[172:175], a[196:199]
ds_read_b64_tr_b16 a[252:253], v23 offset:45056
buffer_load_dwordx4 v28, s[40:43], s55 offen offset:0 lds
v_cvt_pk_bf16_f32 v160, v160, v161
v_cvt_pk_bf16_f32 v161, v162, v163
v_exp_f32 v181, v181
v_mfma_f32_16x16x32_bf16 a[196:199], a[224:227], a[164:167], a[196:199]
s_waitcnt lgkmcnt(7)
ds_read_b64_tr_b16 a[254:255], v23 offset:47104
v_cvt_pk_bf16_f32 v162, v164, v165
v_cvt_pk_bf16_f32 v163, v166, v167
v_exp_f32 v182, v182
v_exp_f32 v183, v183
v_mfma_f32_16x16x32_bf16 a[204:207], a[232:235], a[164:167], a[204:207]
buffer_store_dwordx4 v[160:163], v1, s[24:27], s60 offen offset:0 sc1
buffer_load_dwordx4 v29, s[40:43], s55 offen offset:1024 lds
v_add_f32 v176, 1.0, v176
v_add_f32 v177, 1.0, v177
v_mfma_f32_16x16x32_bf16 a[204:207], a[236:239], a[172:175], a[204:207]
s_bfe_u32 s54, 0x90d0707, s64
ds_read_b64_tr_b16 a[224:225], v20 offset:49152
v_add_f32 v178, 1.0, v178
v_add_f32 v179, 1.0, v179
v_add_f32 v180, 1.0, v180
v_add_f32 v181, 1.0, v181
v_rcp_f32 v176, v176
v_mfma_f32_16x16x32_bf16 a[200:203], a[236:239], a[168:171], a[200:203]
s_lshl_b32 s54, s54, 13
ds_read_b64_tr_b16 a[226:227], v20 offset:51200
v_add_f32 v182, 1.0, v182
v_add_f32 v183, 1.0, v183
v_rcp_f32 v177, v177
v_rcp_f32 v178, v178
v_mfma_f32_16x16x32_bf16 a[200:203], a[232:235], a[160:163], a[200:203]
s_waitcnt lgkmcnt(6)
ds_read_b64_tr_b16 a[228:229], v20 offset:53248
s_add_u32 s54, s54, s63
v_rcp_f32 v179, v179
v_rcp_f32 v180, v180
v_mul_f32 v176, v176, v184
v_mfma_f32_16x16x32_bf16 a[208:211], a[240:243], a[160:163], a[208:211]
ds_read_b64_tr_b16 a[230:231], v20 offset:55296
buffer_load_dwordx4 a[32:35], v1, s[24:27], s54 offen offset:0 sc1
v_rcp_f32 v181, v181
v_rcp_f32 v182, v182
v_mfma_f32_16x16x32_bf16 a[208:211], a[244:247], a[168:171], a[208:211]
ds_read_b64_tr_b16 a[232:233], v21 offset:49152
v_rcp_f32 v183, v183
v_mul_f32 v177, v177, v185
v_mul_f32 v178, v178, v186
v_exp_f32 v193, v193
v_mfma_f32_16x16x32_bf16 a[212:215], a[244:247], a[172:175], a[212:215]
ds_read_b64_tr_b16 a[234:235], v21 offset:51200
buffer_load_dwordx4 a[36:39], v1, s[24:27], s54 offen offset:1024 sc1
v_mul_f32 v179, v179, v187
v_mul_f32 v180, v180, v188
v_exp_f32 v210, v210
v_mfma_f32_16x16x32_bf16 a[212:215], a[240:243], a[164:167], a[212:215]
s_waitcnt lgkmcnt(6)
ds_read_b64_tr_b16 a[236:237], v21 offset:53248
v_mul_f32 v181, v181, v189
v_mul_f32 v182, v182, v190
v_mul_f32 v183, v183, v191
v_cvt_pk_bf16_f32 v176, v176, v177
v_exp_f32 v194, v194
v_mfma_f32_16x16x32_bf16 a[220:223], a[248:251], a[164:167], a[220:223]
ds_read_b64_tr_b16 a[238:239], v21 offset:55296
buffer_load_dwordx4 a[40:43], v1, s[24:27], s54 offen offset:2048 sc1
v_cvt_pk_bf16_f32 v177, v178, v179
v_cvt_pk_bf16_f32 v178, v180, v181
v_exp_f32 v211, v211
v_mfma_f32_16x16x32_bf16 a[220:223], a[252:255], a[172:175], a[220:223]
s_waitcnt vmcnt(14)
ds_read_b64_tr_b16 a[240:241], v22 offset:49152
v_cvt_pk_bf16_f32 v179, v182, v183
v_cmp_ne_u32 vcc, v33, v32
s_nop 0
s_cbranch_vccnz ckK_spin_b
ckK_ok_b:
v_exp_f32 v195, v195
v_mfma_f32_16x16x32_bf16 a[216:219], a[252:255], a[168:171], a[216:219]
buffer_store_dwordx4 v[176:179], v1, s[24:27], s60 offen offset:1024 sc1
buffer_load_dwordx4 a[44:47], v1, s[24:27], s54 offen offset:3072 sc1
v_fma_f32 v213, -v197, s58, -v62
v_fma_f32 v197, v197, s58, -v60
v_mfma_f32_16x16x32_bf16 a[216:219], a[248:251], a[160:163], a[216:219]
s_waitcnt lgkmcnt(5)
ds_read_b64_tr_b16 a[242:243], v22 offset:51200
ds_read_b64_tr_b16 a[244:245], v22 offset:53248
v_fma_f32 v214, -v198, s58, -v62
v_exp_f32 v212, v212
v_mfma_f32_16x16x32_bf16 a[192:195], a[224:227], a[176:179], a[192:195]
ds_read_b64_tr_b16 a[246:247], v22 offset:55296
v_fma_f32 v198, v198, s58, -v60
v_fma_f32 v215, -v199, s58, -v62
v_exp_f32 v196, v196
v_mfma_f32_16x16x32_bf16 a[192:195], a[228:231], a[184:187], a[192:195]
ds_read_b64_tr_b16 a[248:249], v23 offset:49152
buffer_load_dwordx4 a[48:51], v2, s[24:27], s54 offen offset:0 sc1
v_exp_f32 v213, v213
v_mfma_f32_16x16x32_bf16 a[196:199], a[228:231], a[188:191], a[196:199]
ds_read_b64_tr_b16 a[250:251], v23 offset:51200
v_fma_f32 v199, v199, s58, -v60
v_exp_f32 v197, v197
v_fma_f32 v216, -v200, s58, -v63
v_mfma_f32_16x16x32_bf16 a[196:199], a[224:227], a[180:183], a[196:199]
s_waitcnt lgkmcnt(6)
ds_read_b64_tr_b16 a[252:253], v23 offset:53248
v_exp_f32 v214, v214
v_exp_f32 v198, v198
v_mfma_f32_16x16x32_bf16 a[204:207], a[232:235], a[180:183], a[204:207]
ds_read_b64_tr_b16 a[254:255], v23 offset:55296
buffer_load_dwordx4 a[52:55], v2, s[24:27], s54 offen offset:1024 sc1
v_exp_f32 v215, v215
v_mfma_f32_16x16x32_bf16 a[204:207], a[236:239], a[188:191], a[204:207]
ds_read_b64_tr_b16 a[224:225], v20 offset:57344
v_exp_f32 v199, v199
v_exp_f32 v216, v216
v_mfma_f32_16x16x32_bf16 a[200:203], a[236:239], a[184:187], a[200:203]
ds_read_b64_tr_b16 a[226:227], v20 offset:59392
buffer_load_dwordx4 a[56:59], v2, s[24:27], s54 offen offset:2048 sc1
v_fma_f32 v200, v200, s58, -v61
v_fma_f32 v217, -v201, s58, -v63
v_mfma_f32_16x16x32_bf16 a[200:203], a[232:235], a[176:179], a[200:203]
s_waitcnt lgkmcnt(6)
ds_read_b64_tr_b16 a[228:229], v20 offset:61440
v_fma_f32 v201, v201, s58, -v61
v_fma_f32 v218, -v202, s58, -v63
v_exp_f32 v200, v200
v_mfma_f32_16x16x32_bf16 a[208:211], a[240:243], a[176:179], a[208:211]
ds_read_b64_tr_b16 a[230:231], v20 offset:63488
v_fma_f32 v202, v202, s58, -v61
v_fma_f32 v219, -v203, s58, -v63
v_exp_f32 v217, v217
v_mfma_f32_16x16x32_bf16 a[208:211], a[244:247], a[184:187], a[208:211]
ds_read_b64_tr_b16 a[232:233], v21 offset:57344
buffer_load_dwordx4 a[60:63], v2, s[24:27], s54 offen offset:3072 sc1
s_bfe_u32 s55, 0xb09090b, s64
v_fma_f32 v203, v203, s58, -v61
v_mfma_f32_16x16x32_bf16 a[212:215], a[244:247], a[188:191], a[212:215]
s_lshl_b32 s55, s55, 18
ds_read_b64_tr_b16 a[234:235], v21 offset:59392
v_fma_f32 v220, -v204, s58, -v63
v_fma_f32 v204, v204, s58, -v61
v_exp_f32 v201, v201
v_mfma_f32_16x16x32_bf16 a[212:215], a[240:243], a[180:183], a[212:215]
s_waitcnt lgkmcnt(6)
ds_read_b64_tr_b16 a[236:237], v21 offset:61440
s_or_b32 s55, s55, 128
v_fma_f32 v221, -v205, s58, -v63
v_exp_f32 v218, v218
v_mfma_f32_16x16x32_bf16 a[220:223], a[248:251], a[180:183], a[220:223]
s_add_u32 m0, s52, 40960
ds_read_b64_tr_b16 a[238:239], v21 offset:63488
v_fma_f32 v205, v205, s58, -v61
v_fma_f32 v222, -v206, s58, -v63
v_exp_f32 v202, v202
v_mfma_f32_16x16x32_bf16 a[220:223], a[252:255], a[188:191], a[220:223]
ds_read_b64_tr_b16 a[240:241], v22 offset:57344
buffer_load_dwordx4 v28, s[40:43], s55 offen offset:0 lds
v_exp_f32 v219, v219
v_mfma_f32_16x16x32_bf16 a[216:219], a[252:255], a[184:187], a[216:219]
ds_read_b64_tr_b16 a[242:243], v22 offset:59392
v_fma_f32 v206, v206, s58, -v61
v_fma_f32 v223, -v207, s58, -v63
v_exp_f32 v203, v203
v_mfma_f32_16x16x32_bf16 a[216:219], a[248:251], a[176:179], a[216:219]
s_waitcnt lgkmcnt(6)
ds_read_b64_tr_b16 a[244:245], v22 offset:61440
buffer_load_dwordx4 v29, s[40:43], s55 offen offset:1024 lds
v_exp_f32 v220, v220
v_mfma_f32_16x16x32_bf16 v[64:67], a[224:227], a[176:179], v[64:67]
s_xor_b32 s55, s55, 128
ds_read_b64_tr_b16 a[246:247], v22 offset:63488
v_fma_f32 v207, v207, s58, -v61
v_exp_f32 v204, v204
v_add_f32 v60, v192, v193
v_mfma_f32_16x16x32_bf16 v[64:67], a[228:231], a[184:187], v[64:67]
s_add_u32 m0, s52, 49152
ds_read_b64_tr_b16 a[248:249], v23 offset:57344
v_exp_f32 v221, v221
v_exp_f32 v205, v205
v_mfma_f32_16x16x32_bf16 v[68:71], a[228:231], a[188:191], v[68:71]
ds_read_b64_tr_b16 a[250:251], v23 offset:59392
buffer_load_dwordx4 v28, s[40:43], s55 offen offset:0 lds
v_exp_f32 v222, v222
v_mfma_f32_16x16x32_bf16 v[68:71], a[224:227], a[180:183], v[68:71]
s_waitcnt vmcnt(55) lgkmcnt(6)
s_barrier
ds_read_b64_tr_b16 a[252:253], v23 offset:61440
v_exp_f32 v206, v206
v_mfma_f32_16x16x32_bf16 v[76:79], a[232:235], a[180:183], v[76:79]
ds_read_b64_tr_b16 a[254:255], v23 offset:63488
buffer_load_dwordx4 v29, s[40:43], s55 offen offset:1024 lds
v_exp_f32 v223, v223
v_mfma_f32_16x16x32_bf16 v[76:79], a[236:239], a[188:191], v[76:79]
s_xor_b32 s55, s55, 131072
ds_read_b64_tr_b16 a[224:225], v24 offset:0
v_exp_f32 v207, v207
v_add_f32 v62, v208, v209
v_add_f32 v61, v200, v201
v_mfma_f32_16x16x32_bf16 v[72:75], a[236:239], a[184:187], v[72:75]
s_add_u32 m0, s52, 57344
ds_read_b64_tr_b16 a[226:227], v24 offset:2048
v_add_f32 v63, v216, v217
v_add_f32 v60, v60, v194
v_add_f32 v62, v62, v210
v_add_f32 v61, v61, v202
v_mfma_f32_16x16x32_bf16 v[72:75], a[232:235], a[176:179], v[72:75]
s_waitcnt lgkmcnt(6)
ds_read_b64_tr_b16 a[228:229], v24 offset:4096
buffer_load_dwordx4 v28, s[40:43], s55 offen offset:0 lds
v_add_f32 v63, v63, v218
v_add_f32 v60, v60, v195
v_mfma_f32_16x16x32_bf16 v[80:83], a[240:243], a[176:179], v[80:83]
ds_read_b64_tr_b16 a[230:231], v24 offset:6144
v_add_f32 v62, v62, v211
v_add_f32 v61, v61, v203
v_add_f32 v63, v63, v219
v_add_f32 v60, v60, v196
v_mfma_f32_16x16x32_bf16 v[80:83], a[244:247], a[184:187], v[80:83]
ds_read_b64_tr_b16 a[232:233], v25 offset:0
buffer_load_dwordx4 v29, s[40:43], s55 offen offset:1024 lds
v_add_f32 v62, v62, v212
v_add_f32 v61, v61, v204
v_mfma_f32_16x16x32_bf16 v[84:87], a[244:247], a[188:191], v[84:87]
s_xor_b32 s55, s55, 128
ds_read_b64_tr_b16 a[234:235], v25 offset:2048
v_add_f32 v63, v63, v220
v_add_f32 v60, v60, v197
v_add_f32 v62, v62, v213
v_add_f32 v61, v61, v205
v_mfma_f32_16x16x32_bf16 v[84:87], a[240:243], a[180:183], v[84:87]
s_waitcnt lgkmcnt(6)
ds_read_b64_tr_b16 a[236:237], v25 offset:4096
v_add_f32 v63, v63, v221
v_add_f32 v60, v60, v198
v_add_f32 v62, v62, v214
v_add_f32 v61, v61, v206
v_mfma_f32_16x16x32_bf16 v[92:95], a[248:251], a[180:183], v[92:95]
s_add_u32 m0, s52, 98304
ds_read_b64_tr_b16 a[238:239], v25 offset:6144
v_add_f32 v63, v63, v222
v_add_f32 v60, v60, v199
v_add_f32 v62, v62, v215
v_add_f32 v61, v61, v207
v_mfma_f32_16x16x32_bf16 v[92:95], a[252:255], a[188:191], v[92:95]
pg_11_b:
s_cbranch_execz pg_back0
ds_read_b64_tr_b16 a[240:241], v26 offset:0
buffer_load_dwordx4 v28, s[40:43], s55 offen offset:0 lds
v_permlane16_swap_b32 v60, v61
v_mfma_f32_16x16x32_bf16 v[88:91], a[252:255], a[184:187], v[88:91]
ds_read_b64_tr_b16 a[242:243], v26 offset:2048
v_add_f32 v63, v63, v223
v_add_f32 v60, v60, v61
v_mfma_f32_16x16x32_bf16 v[88:91], a[248:251], a[176:179], v[88:91]
s_waitcnt lgkmcnt(6)
ds_read_b64_tr_b16 a[244:245], v26 offset:4096
buffer_load_dwordx4 v29, s[40:43], s55 offen offset:1024 lds
v_permlane16_swap_b32 v62, v63
v_mfma_f32_16x16x32_bf16 v[64:67], a[224:227], a[128:131], v[64:67]
s_bfe_u32 s54, 0xb09090b, s64
ds_read_b64_tr_b16 a[246:247], v26 offset:6144
v_lshl_add_u32 v55, v55, 4, v54
v_add_f32 v62, v62, v63
v_mfma_f32_16x16x32_bf16 v[64:67], a[228:231], a[136:139], v[64:67]
s_lshl_b32 s54, s54, 13
ds_read_b64_tr_b16 a[248:249], v27 offset:0
ds_read_b64_tr_b16 a[250:251], v27 offset:2048
v_mfma_f32_16x16x32_bf16 v[68:71], a[228:231], a[140:143], v[68:71]
s_add_u32 s54, s54, s63
ds_read_b64_tr_b16 a[252:253], v27 offset:4096
v_permlane32_swap_b32 v60, v62
v_add_f32 v60, v60, v62
v_mfma_f32_16x16x32_bf16 v[68:71], a[224:227], a[132:135], v[68:71]
s_waitcnt lgkmcnt(7)
ds_read_b64_tr_b16 a[254:255], v27 offset:6144
buffer_load_dwordx4 a[160:163], v1, s[24:27], s54 offen offset:0 sc1
v_rcp_f32 v60, v60
v_mfma_f32_16x16x32_bf16 v[76:79], a[232:235], a[132:135], v[76:79]
s_waitcnt vmcnt(14)
ds_read_b64_tr_b16 a[224:225], v24 offset:8192
v_mov_b32 v62, v60
v_mfma_f32_16x16x32_bf16 v[76:79], a[236:239], a[140:143], v[76:79]
buffer_store_dword v32, v30, s[24:27], s61 offen offset:128 sc1
ds_read_b64_tr_b16 a[226:227], v24 offset:10240
v_permlane32_swap_b32 v60, v62
v_mfma_f32_16x16x32_bf16 v[72:75], a[236:239], a[136:139], v[72:75]
s_lshl_b32 s6, s68, 13
ds_read_b64_tr_b16 a[228:229], v24 offset:12288
v_mov_b32 v61, v60
v_mov_b32 v63, v62
v_mfma_f32_16x16x32_bf16 v[72:75], a[232:235], a[128:131], v[72:75]
s_waitcnt lgkmcnt(7)
ds_read_b64_tr_b16 a[230:231], v24 offset:14336
v_permlane16_swap_b32 v60, v61
v_permlane16_swap_b32 v62, v63
v_mfma_f32_16x16x32_bf16 v[80:83], a[240:243], a[128:131], v[80:83]
s_add_u32 s6, s6, 12582912
ds_read_b64_tr_b16 a[232:233], v25 offset:8192
buffer_load_dwordx4 a[164:167], v1, s[24:27], s54 offen offset:1024 sc1
v_mul_f32 v192, v192, v60
v_mul_f32 v208, v208, v62
v_mfma_f32_16x16x32_bf16 v[80:83], a[244:247], a[136:139], v[80:83]
s_lshl_b32 s7, s68, 9
ds_read_b64_tr_b16 a[234:235], v25 offset:10240
v_mul_f32 v193, v193, v60
v_mul_f32 v209, v209, v62
v_mul_f32 v194, v194, v60
v_mul_f32 v210, v210, v62
v_mfma_f32_16x16x32_bf16 v[84:87], a[244:247], a[140:143], v[84:87]
s_add_u32 s7, s7, 15728640
ds_read_b64_tr_b16 a[236:237], v25 offset:12288
buffer_load_dwordx4 v[48:51], v55, s[24:27], s7 offen sc1
v_mul_f32 v195, v195, v60
v_mul_f32 v211, v211, v62
v_mfma_f32_16x16x32_bf16 v[84:87], a[240:243], a[132:135], v[84:87]
s_waitcnt lgkmcnt(7)
ds_read_b64_tr_b16 a[238:239], v25 offset:14336
v_mul_f32 v196, v196, v60
v_mul_f32 v212, v212, v62
v_mul_f32 v197, v197, v60
v_mul_f32 v213, v213, v62
v_mfma_f32_16x16x32_bf16 v[92:95], a[248:251], a[132:135], v[92:95]
ds_read_b64_tr_b16 a[240:241], v26 offset:8192
v_mul_f32 v198, v198, v60
v_mul_f32 v214, v214, v62
v_mul_f32 v199, v199, v60
v_mul_f32 v215, v215, v62
v_mfma_f32_16x16x32_bf16 v[92:95], a[252:255], a[140:143], v[92:95]
ds_read_b64_tr_b16 a[242:243], v26 offset:10240
buffer_load_dwordx4 v[96:99], v1, s[24:27], s6 offen offset:0 sc1
v_cvt_pk_bf16_f32 v224, v192, v193
v_cvt_pk_bf16_f32 v225, v194, v195
v_mfma_f32_16x16x32_bf16 v[88:91], a[252:255], a[136:139], v[88:91]
ds_read_b64_tr_b16 a[244:245], v26 offset:12288
v_cvt_pk_bf16_f32 v226, v196, v197
v_cvt_pk_bf16_f32 v227, v198, v199
v_cvt_pk_bf16_f32 v228, v208, v209
v_cvt_pk_bf16_f32 v229, v210, v211
v_mfma_f32_16x16x32_bf16 v[88:91], a[248:251], a[128:131], v[88:91]
s_waitcnt lgkmcnt(7)
ds_read_b64_tr_b16 a[246:247], v26 offset:14336
buffer_load_dwordx4 v[100:103], v1, s[24:27], s6 offen offset:1024 sc1
v_cvt_pk_bf16_f32 v230, v212, v213
v_cvt_pk_bf16_f32 v231, v214, v215
v_mfma_f32_16x16x32_bf16 a[192:195], a[224:227], a[128:131], a[192:195]
ds_read_b64_tr_b16 a[248:249], v27 offset:8192
v_mul_f32 v200, v200, v61
v_mul_f32 v216, v216, v63
v_mul_f32 v201, v201, v61
v_mul_f32 v217, v217, v63
v_mfma_f32_16x16x32_bf16 a[192:195], a[228:231], a[136:139], a[192:195]
ds_read_b64_tr_b16 a[250:251], v27 offset:10240
v_mul_f32 v202, v202, v61
v_mul_f32 v218, v218, v63
v_mul_f32 v203, v203, v61
v_mul_f32 v219, v219, v63
v_mfma_f32_16x16x32_bf16 a[196:199], a[228:231], a[140:143], a[196:199]
ds_read_b64_tr_b16 a[252:253], v27 offset:12288
buffer_load_dwordx4 v[104:107], v1, s[24:27], s6 offen offset:2048 sc1
v_mul_f32 v204, v204, v61
v_mul_f32 v220, v220, v63
v_mfma_f32_16x16x32_bf16 a[196:199], a[224:227], a[132:135], a[196:199]
s_waitcnt lgkmcnt(7)
ds_read_b64_tr_b16 a[254:255], v27 offset:14336
v_mul_f32 v205, v205, v61
v_mul_f32 v221, v221, v63
v_mul_f32 v206, v206, v61
v_mul_f32 v222, v222, v63
v_mfma_f32_16x16x32_bf16 a[204:207], a[232:235], a[132:135], a[204:207]
ds_read_b64_tr_b16 a[224:225], v24 offset:16384
buffer_load_dwordx4 v[108:111], v1, s[24:27], s6 offen offset:3072 sc1
v_mul_f32 v207, v207, v61
v_mul_f32 v223, v223, v63
v_mfma_f32_16x16x32_bf16 a[204:207], a[236:239], a[140:143], a[204:207]
ds_read_b64_tr_b16 a[226:227], v24 offset:18432
v_cvt_pk_bf16_f32 v232, v200, v201
v_cvt_pk_bf16_f32 v233, v202, v203
v_cvt_pk_bf16_f32 v234, v204, v205
v_cvt_pk_bf16_f32 v235, v206, v207
v_mfma_f32_16x16x32_bf16 a[200:203], a[236:239], a[136:139], a[200:203]
ds_read_b64_tr_b16 a[228:229], v24 offset:20480
v_cvt_pk_bf16_f32 v236, v216, v217
v_cvt_pk_bf16_f32 v237, v218, v219
v_cvt_pk_bf16_f32 v238, v220, v221
v_cvt_pk_bf16_f32 v239, v222, v223
v_mfma_f32_16x16x32_bf16 a[200:203], a[232:235], a[128:131], a[200:203]
s_waitcnt lgkmcnt(7)
ds_read_b64_tr_b16 a[230:231], v24 offset:22528
buffer_load_dwordx4 v[112:115], v2, s[24:27], s6 offen offset:0 sc1
v_cvt_pk_bf16_f32 v240, v240, v241
v_cvt_pk_bf16_f32 v241, v242, v243
v_mfma_f32_16x16x32_bf16 a[208:211], a[240:243], a[128:131], a[208:211]
ds_read_b64_tr_b16 a[232:233], v25 offset:16384
v_cvt_pk_bf16_f32 v242, v244, v245
v_cvt_pk_bf16_f32 v243, v246, v247
v_cvt_pk_bf16_f32 v244, v248, v249
v_cvt_pk_bf16_f32 v245, v250, v251
v_mfma_f32_16x16x32_bf16 v[192:195], v[40:43], v[240:243], 0
buffer_load_dwordx4 v[116:119], v2, s[24:27], s6 offen offset:1024 sc1
v_mfma_f32_16x16x32_bf16 v[196:199], v[44:47], v[240:243], 0
v_cvt_pk_bf16_f32 v246, v252, v253
v_cvt_pk_bf16_f32 v247, v254, v255
v_mfma_f32_16x16x32_bf16 a[208:211], a[244:247], a[136:139], a[208:211]
ds_read_b64_tr_b16 a[234:235], v25 offset:18432
v_mfma_f32_16x16x32_bf16 v[200:203], v[40:43], v[244:247], 0
v_mfma_f32_16x16x32_bf16 v[204:207], v[44:47], v[244:247], 0
v_max3_f32 v60, v192, v193, v194
v_max3_f32 v62, -v192, -v193, -v194
v_mfma_f32_16x16x32_bf16 a[212:215], a[244:247], a[140:143], a[212:215]
ds_read_b64_tr_b16 a[236:237], v25 offset:20480
buffer_load_dwordx4 v[120:123], v2, s[24:27], s6 offen offset:2048 sc1
v_max3_f32 v60, v60, v195, v196
v_max3_f32 v62, v62, -v195, -v196
v_mfma_f32_16x16x32_bf16 a[212:215], a[240:243], a[132:135], a[212:215]
s_waitcnt lgkmcnt(7)
ds_read_b64_tr_b16 a[238:239], v25 offset:22528
v_max3_f32 v60, v60, v197, v198
v_max3_f32 v62, v62, -v197, -v198
v_max_f32 v60, v60, v199
v_max_f32_e64 v62, v62, -v199
v_mfma_f32_16x16x32_bf16 a[220:223], a[248:251], a[132:135], a[220:223]
ds_read_b64_tr_b16 a[240:241], v26 offset:16384
v_max3_f32 v61, v200, v201, v202
v_max3_f32 v63, -v200, -v201, -v202
v_max3_f32 v61, v61, v203, v204
v_max3_f32 v63, v63, -v203, -v204
v_mfma_f32_16x16x32_bf16 a[220:223], a[252:255], a[140:143], a[220:223]
ds_read_b64_tr_b16 a[242:243], v26 offset:18432
buffer_load_dwordx4 v[124:127], v2, s[24:27], s6 offen offset:3072 sc1
v_max3_f32 v61, v61, v205, v206
v_max3_f32 v63, v63, -v205, -v206
v_mfma_f32_16x16x32_bf16 a[216:219], a[252:255], a[136:139], a[216:219]
ds_read_b64_tr_b16 a[244:245], v26 offset:20480
v_max_f32 v61, v61, v207
v_max_f32_e64 v63, v63, -v207
v_mfma_f32_16x16x32_bf16 a[216:219], a[248:251], a[128:131], a[216:219]
s_waitcnt lgkmcnt(7)
ds_read_b64_tr_b16 a[246:247], v26 offset:22528
v_permlane16_swap_b32 v60, v61
v_permlane16_swap_b32 v62, v63
v_mfma_f32_16x16x32_bf16 a[192:195], a[224:227], a[144:147], a[192:195]
ds_read_b64_tr_b16 a[248:249], v27 offset:16384
buffer_load_dwordx4 a[168:171], v1, s[24:27], s54 offen offset:2048 sc1
v_max_f32 v60, v60, v61
v_max_f32 v62, v62, v63
v_mfma_f32_16x16x32_bf16 a[192:195], a[228:231], a[152:155], a[192:195]
ds_read_b64_tr_b16 a[250:251], v27 offset:18432
ds_read_b64_tr_b16 a[252:253], v27 offset:20480
v_mfma_f32_16x16x32_bf16 a[196:199], a[228:231], a[156:159], a[196:199]
v_permlane32_swap_b32 v60, v62
v_max_f32 v60, v60, v62
v_mul_f32 v60, s58, v60
v_mov_b32 v62, v60
v_mfma_f32_16x16x32_bf16 a[196:199], a[224:227], a[148:151], a[196:199]
s_waitcnt lgkmcnt(7)
buffer_load_dwordx4 a[172:175], v1, s[24:27], s54 offen offset:3072 sc1
v_mfma_f32_16x16x32_bf16 a[204:207], a[232:235], a[148:151], a[204:207]
ds_read_b64_tr_b16 a[254:255], v27 offset:22528
v_permlane32_swap_b32 v60, v62
v_mov_b32 v61, v60
v_mov_b32 v63, v62
v_mfma_f32_16x16x32_bf16 a[204:207], a[236:239], a[156:159], a[204:207]
ds_read_b64_tr_b16 a[224:225], v20 offset:0
v_permlane16_swap_b32 v60, v61
v_permlane16_swap_b32 v62, v63
v_mfma_f32_16x16x32_bf16 a[200:203], a[236:239], a[152:155], a[200:203]
ds_read_b64_tr_b16 a[226:227], v20 offset:2048
buffer_load_dwordx4 a[176:179], v2, s[24:27], s54 offen offset:0 sc1
v_fma_f32 v208, -v192, s58, -v62
v_fma_f32 v192, v192, s58, -v60
v_mfma_f32_16x16x32_bf16 a[200:203], a[232:235], a[144:147], a[200:203]
s_waitcnt lgkmcnt(6)
ds_read_b64_tr_b16 a[228:229], v20 offset:4096
v_fma_f32 v209, -v193, s58, -v62
v_fma_f32 v193, v193, s58, -v60
v_exp_f32 v208, v208
v_mfma_f32_16x16x32_bf16 a[208:211], a[240:243], a[144:147], a[208:211]
ds_read_b64_tr_b16 a[230:231], v20 offset:6144
buffer_load_dwordx4 a[180:183], v2, s[24:27], s54 offen offset:1024 sc1
v_exp_f32 v192, v192
v_mfma_f32_16x16x32_bf16 a[208:211], a[244:247], a[152:155], a[208:211]
ds_read_b64_tr_b16 a[232:233], v21 offset:0
v_fma_f32 v210, -v194, s58, -v62
v_fma_f32 v194, v194, s58, -v60
v_exp_f32 v209, v209
v_mfma_f32_16x16x32_bf16 a[212:215], a[244:247], a[156:159], a[212:215]
ds_read_b64_tr_b16 a[234:235], v21 offset:2048
v_fma_f32 v211, -v195, s58, -v62
v_fma_f32 v195, v195, s58, -v60
v_exp_f32 v193, v193
v_mfma_f32_16x16x32_bf16 a[212:215], a[240:243], a[148:151], a[212:215]
s_waitcnt lgkmcnt(6)
ds_read_b64_tr_b16 a[236:237], v21 offset:4096
buffer_load_dwordx4 a[184:187], v2, s[24:27], s54 offen offset:2048 sc1
v_exp_f32 v210, v210
v_mfma_f32_16x16x32_bf16 a[220:223], a[248:251], a[148:151], a[220:223]
ds_read_b64_tr_b16 a[238:239], v21 offset:6144
v_fma_f32 v212, -v196, s58, -v62
v_fma_f32 v196, v196, s58, -v60
v_exp_f32 v194, v194
v_mfma_f32_16x16x32_bf16 a[220:223], a[252:255], a[156:159], a[220:223]
ds_read_b64_tr_b16 a[240:241], v22 offset:0
buffer_load_dwordx4 a[188:191], v2, s[24:27], s54 offen offset:3072 sc1
v_exp_f32 v211, v211
v_mfma_f32_16x16x32_bf16 a[216:219], a[252:255], a[152:155], a[216:219]
s_bfe_u32 s55, 0xd0b0d0d, s64
ds_read_b64_tr_b16 a[242:243], v22 offset:2048
v_fma_f32 v213, -v197, s58, -v62
v_fma_f32 v197, v197, s58, -v60
v_exp_f32 v195, v195
v_mfma_f32_16x16x32_bf16 a[216:219], a[248:251], a[144:147], a[216:219]
s_waitcnt lgkmcnt(6)
ds_read_b64_tr_b16 a[244:245], v22 offset:4096
s_lshl_b32 s55, s55, 18
v_fma_f32 v214, -v198, s58, -v62
v_exp_f32 v212, v212
v_mfma_f32_16x16x32_bf16 v[64:67], a[224:227], a[144:147], v[64:67]
s_or_b32 s55, s55, 128
ds_read_b64_tr_b16 a[246:247], v22 offset:6144
s_add_u32 m0, s52, 106496
v_fma_f32 v198, v198, s58, -v60
v_exp_f32 v196, v196
v_mfma_f32_16x16x32_bf16 v[64:67], a[228:231], a[152:155], v[64:67]
ds_read_b64_tr_b16 a[248:249], v23 offset:0
buffer_load_dwordx4 v28, s[40:43], s55 offen offset:0 lds
v_exp_f32 v213, v213
v_mfma_f32_16x16x32_bf16 v[68:71], a[228:231], a[156:159], v[68:71]
ds_read_b64_tr_b16 a[250:251], v23 offset:2048
v_fma_f32 v215, -v199, s58, -v62
v_fma_f32 v199, v199, s58, -v60
v_exp_f32 v197, v197
v_mfma_f32_16x16x32_bf16 v[68:71], a[224:227], a[148:151], v[68:71]
s_waitcnt vmcnt(63) lgkmcnt(6)
s_barrier
ds_read_b64_tr_b16 a[252:253], v23 offset:4096
buffer_load_dwordx4 v29, s[40:43], s55 offen offset:1024 lds
v_mfma_f32_16x16x32_bf16 v[76:79], a[232:235], a[148:151], v[76:79]
s_xor_b32 s55, s55, 128
ds_read_b64_tr_b16 a[254:255], v23 offset:6144
v_exp_f32 v214, v214
v_exp_f32 v198, v198
v_mfma_f32_16x16x32_bf16 v[76:79], a[236:239], a[156:159], v[76:79]
s_add_u32 m0, s52, 114688
ds_read_b64_tr_b16 a[224:225], v20 offset:8192
v_exp_f32 v215, v215
v_exp_f32 v199, v199
v_mfma_f32_16x16x32_bf16 v[72:75], a[236:239], a[152:155], v[72:75]
ds_read_b64_tr_b16 a[226:227], v20 offset:10240
buffer_load_dwordx4 v28, s[40:43], s55 offen offset:0 lds
v_fma_f32 v216, -v200, s58, -v63
v_fma_f32 v200, v200, s58, -v61
v_mfma_f32_16x16x32_bf16 v[72:75], a[232:235], a[144:147], v[72:75]
s_waitcnt lgkmcnt(6)
ds_read_b64_tr_b16 a[228:229], v20 offset:12288
v_fma_f32 v217, -v201, s58, -v63
v_fma_f32 v201, v201, s58, -v61
v_exp_f32 v216, v216
v_mfma_f32_16x16x32_bf16 v[80:83], a[240:243], a[144:147], v[80:83]
s_load_dword s101, s[92:93], 53240
ds_read_b64_tr_b16 a[230:231], v20 offset:14336
buffer_load_dwordx4 v29, s[40:43], s55 offen offset:1024 lds
v_exp_f32 v200, v200
v_mfma_f32_16x16x32_bf16 v[80:83], a[244:247], a[152:155], v[80:83]
s_xor_b32 s55, s55, 131072
ds_read_b64_tr_b16 a[232:233], v21 offset:8192
v_fma_f32 v218, -v202, s58, -v63
v_fma_f32 v202, v202, s58, -v61
v_exp_f32 v217, v217
v_mfma_f32_16x16x32_bf16 v[84:87], a[244:247], a[156:159], v[84:87]
s_add_u32 m0, s52, 122880
ds_read_b64_tr_b16 a[234:235], v21 offset:10240
v_fma_f32 v219, -v203, s58, -v63
v_fma_f32 v203, v203, s58, -v61
v_exp_f32 v201, v201
v_mfma_f32_16x16x32_bf16 v[84:87], a[240:243], a[148:151], v[84:87]
s_waitcnt lgkmcnt(6)
ds_read_b64_tr_b16 a[236:237], v21 offset:12288
buffer_load_dwordx4 v28, s[40:43], s55 offen offset:0 lds
v_exp_f32 v218, v218
v_mfma_f32_16x16x32_bf16 v[92:95], a[248:251], a[148:151], v[92:95]
ds_read_b64_tr_b16 a[238:239], v21 offset:14336
v_fma_f32 v220, -v204, s58, -v63
v_fma_f32 v204, v204, s58, -v61
v_exp_f32 v202, v202
v_mfma_f32_16x16x32_bf16 v[92:95], a[252:255], a[156:159], v[92:95]
ds_read_b64_tr_b16 a[240:241], v22 offset:8192
buffer_load_dwordx4 v29, s[40:43], s55 offen offset:1024 lds
v_exp_f32 v219, v219
v_mfma_f32_16x16x32_bf16 v[88:91], a[252:255], a[152:155], v[88:91]
s_xor_b32 s55, s55, 128
ds_read_b64_tr_b16 a[242:243], v22 offset:10240
v_fma_f32 v221, -v205, s58, -v63
v_fma_f32 v205, v205, s58, -v61
v_exp_f32 v203, v203
v_mfma_f32_16x16x32_bf16 v[88:91], a[248:251], a[144:147], v[88:91]
s_waitcnt lgkmcnt(6)
ds_read_b64_tr_b16 a[244:245], v22 offset:12288
v_fma_f32 v222, -v206, s58, -v63
v_fma_f32 v206, v206, s58, -v61
v_exp_f32 v220, v220
v_mfma_f32_16x16x32_bf16 v[64:67], a[224:227], a[0:3], v[64:67]
s_add_u32 m0, s52, 131072
ds_read_b64_tr_b16 a[246:247], v22 offset:14336
v_fma_f32 v223, -v207, s58, -v63
v_fma_f32 v207, v207, s58, -v61
v_exp_f32 v204, v204
v_mfma_f32_16x16x32_bf16 v[64:67], a[228:231], a[8:11], v[64:67]
ds_read_b64_tr_b16 a[248:249], v23 offset:8192
buffer_load_dwordx4 v28, s[40:43], s55 offen offset:0 lds
v_exp_f32 v221, v221
v_mfma_f32_16x16x32_bf16 v[68:71], a[228:231], a[12:15], v[68:71]
s_waitcnt vmcnt(20)
ds_read_b64_tr_b16 a[250:251], v23 offset:10240
v_exp_f32 v205, v205
v_exp_f32 v222, v222
v_mfma_f32_16x16x16_bf16 v[128:131], v[38:39], v[96:97], 0
buffer_load_dwordx4 v29, s[40:43], s55 offen offset:1024 lds
v_mfma_f32_16x16x16_bf16 v[132:135], v[38:39], v[98:99], 0
s_bfe_u32 s54, 0xd0b0d0d, s64
ds_read_b64_tr_b16 a[252:253], v23 offset:12288
v_add_f32_dpp v48, v48, v48 row_ror:1 row_mask:0xf bank_mask:0xf
s_waitcnt vmcnt(20)
v_mfma_f32_16x16x16_bf16 v[128:131], v[38:39], v[100:101], v[128:131]
s_lshl_b32 s54, s54, 13
v_exp_f32 v206, v206
v_mfma_f32_16x16x16_bf16 v[132:135], v[38:39], v[102:103], v[132:135]
s_add_u32 s54, s54, s63
v_exp_f32 v223, v223
s_waitcnt vmcnt(19)
v_mfma_f32_16x16x16_bf16 v[128:131], v[38:39], v[104:105], v[128:131]
buffer_load_dwordx4 a[128:131], v1, s[24:27], s54 offen offset:0 sc1
v_mfma_f32_16x16x16_bf16 v[132:135], v[38:39], v[106:107], v[132:135]
s_waitcnt vmcnt(19)
v_exp_f32 v207, v207
v_mfma_f32_16x16x16_bf16 v[128:131], v[38:39], v[108:109], v[128:131]
v_add_f32_dpp v49, v49, v49 row_ror:1 row_mask:0xf bank_mask:0xf
v_add_f32_dpp v50, v50, v50 row_ror:1 row_mask:0xf bank_mask:0xf
v_mfma_f32_16x16x16_bf16 v[132:135], v[38:39], v[110:111], v[132:135]
s_lshr_b32 s6, s32, 1
v_add_f32_dpp v51, v51, v51 row_ror:1 row_mask:0xf bank_mask:0xf
v_add_f32_dpp v48, v48, v48 row_ror:2 row_mask:0xf bank_mask:0xf
s_waitcnt vmcnt(18)
v_mfma_f32_16x16x16_bf16 v[128:131], v[38:39], v[112:113], v[128:131]
buffer_load_dwordx4 a[132:135], v1, s[24:27], s54 offen offset:1024 sc1
v_mfma_f32_16x16x16_bf16 v[132:135], v[38:39], v[114:115], v[132:135]
s_lshl_b32 s6, s6, 10
v_add_f32_dpp v49, v49, v49 row_ror:2 row_mask:0xf bank_mask:0xf
v_add_f32_dpp v50, v50, v50 row_ror:2 row_mask:0xf bank_mask:0xf
s_waitcnt vmcnt(18)
v_mfma_f32_16x16x16_bf16 v[128:131], v[38:39], v[116:117], v[128:131]
s_and_b32 s7, s32, 1
v_add_f32_dpp v51, v51, v51 row_ror:2 row_mask:0xf bank_mask:0xf
v_add_f32_dpp v48, v48, v48 row_ror:4 row_mask:0xf bank_mask:0xf
v_mfma_f32_16x16x16_bf16 v[132:135], v[38:39], v[118:119], v[132:135]
s_lshl_b32 s7, s7, 3
v_add_f32_dpp v49, v49, v49 row_ror:4 row_mask:0xf bank_mask:0xf
v_add_f32_dpp v50, v50, v50 row_ror:4 row_mask:0xf bank_mask:0xf
s_waitcnt vmcnt(17)
v_mfma_f32_16x16x16_bf16 v[128:131], v[38:39], v[120:121], v[128:131]
buffer_load_dwordx4 a[136:139], v1, s[24:27], s54 offen offset:2048 sc1
v_mfma_f32_16x16x16_bf16 v[132:135], v[38:39], v[122:123], v[132:135]
s_add_u32 s6, s6, s7
v_add_f32_dpp v51, v51, v51 row_ror:4 row_mask:0xf bank_mask:0xf
v_cvt_pk_bf16_f32 v48, v48, v49
s_waitcnt vmcnt(17)
v_mfma_f32_16x16x16_bf16 v[128:131], v[38:39], v[124:125], v[128:131]
s_add_u32 s6, s6, 157696
v_cvt_pk_bf16_f32 v49, v50, v51
v_add_u32 v55, s6, v1
v_mfma_f32_16x16x16_bf16 v[132:135], v[38:39], v[126:127], v[132:135]
v_add_f32 v60, v192, v193
v_add_f32 v62, v208, v209
v_mfma_f32_16x16x32_bf16 v[68:71], a[224:227], a[4:7], v[68:71]
s_waitcnt lgkmcnt(7)
ds_read_b64_tr_b16 a[254:255], v23 offset:14336
buffer_load_dwordx4 a[140:143], v1, s[24:27], s54 offen offset:3072 sc1
v_cvt_pk_bf16_f32 v96, v128, v129
v_cvt_pk_bf16_f32 v97, v130, v131
v_mfma_f32_16x16x32_bf16 v[76:79], a[232:235], a[4:7], v[76:79]
ds_read_b64_tr_b16 a[224:225], v20 offset:16384
ds_write_b64 v55, v[96:97]
v_mfma_f32_16x16x32_bf16 v[76:79], a[236:239], a[12:15], v[76:79]
ds_read_b64_tr_b16 a[226:227], v20 offset:18432
v_cvt_pk_bf16_f32 v98, v132, v133
v_cvt_pk_bf16_f32 v99, v134, v135
v_add_f32 v61, v200, v201
v_add_f32 v63, v216, v217
v_mfma_f32_16x16x32_bf16 v[72:75], a[236:239], a[8:11], v[72:75]
ds_read_b64_tr_b16 a[228:229], v20 offset:20480
buffer_load_dwordx4 a[144:147], v2, s[24:27], s54 offen offset:0 sc1
v_add_f32 v60, v60, v194
v_add_f32 v62, v62, v210
v_mfma_f32_16x16x32_bf16 v[72:75], a[232:235], a[0:3], v[72:75]
s_waitcnt lgkmcnt(8)
ds_read_b64_tr_b16 a[230:231], v20 offset:22528
ds_write_b64 v55, v[98:99] offset:2048
v_mfma_f32_16x16x32_bf16 v[80:83], a[240:243], a[0:3], v[80:83]
ds_read_b64_tr_b16 a[232:233], v21 offset:16384
buffer_load_dwordx4 a[148:151], v2, s[24:27], s54 offen offset:1024 sc1
v_add_f32 v61, v61, v202
v_add_f32 v63, v63, v218
v_mfma_f32_16x16x32_bf16 v[80:83], a[244:247], a[8:11], v[80:83]
ds_read_b64_tr_b16 a[234:235], v21 offset:18432
v_add_f32 v60, v60, v195
v_add_f32 v62, v62, v211
v_add_f32 v61, v61, v203
v_add_f32 v63, v63, v219
v_mfma_f32_16x16x32_bf16 v[84:87], a[244:247], a[12:15], v[84:87]
ds_read_b64_tr_b16 a[236:237], v21 offset:20480
ds_write_b64 v55, v[48:49] offset:4096
v_mfma_f32_16x16x32_bf16 v[84:87], a[240:243], a[4:7], v[84:87]
s_waitcnt lgkmcnt(10)
ds_read_b64_tr_b16 a[238:239], v21 offset:22528
buffer_load_dwordx4 a[152:155], v2, s[24:27], s54 offen offset:2048 sc1
v_add_u32 v55, 157696, v1
v_add_f32 v60, v60, v196
v_mfma_f32_16x16x32_bf16 v[92:95], a[248:251], a[4:7], v[92:95]
ds_read_b64_tr_b16 a[240:241], v22 offset:16384
v_add_f32 v62, v62, v212
v_add_f32 v61, v61, v204
v_add_f32 v63, v63, v220
v_add_f32 v60, v60, v197
v_mfma_f32_16x16x32_bf16 v[92:95], a[252:255], a[12:15], v[92:95]
ds_read_b64_tr_b16 a[242:243], v22 offset:18432
buffer_load_dwordx4 a[156:159], v2, s[24:27], s54 offen offset:3072 sc1
s_bfe_u32 s55, 0x11151311, s64
v_add_f32 v62, v62, v213
v_mfma_f32_16x16x32_bf16 v[88:91], a[252:255], a[8:11], v[88:91]
s_lshl_b32 s55, s55, 18
ds_read_b64_tr_b16 a[244:245], v22 offset:20480
v_add_f32 v61, v61, v205
v_add_f32 v63, v63, v221
v_add_f32 v60, v60, v198
v_add_f32 v62, v62, v214
v_mfma_f32_16x16x32_bf16 v[88:91], a[248:251], a[0:3], v[88:91]
s_waitcnt lgkmcnt(9)
ds_read_b64_tr_b16 a[246:247], v22 offset:22528
s_or_b32 s55, s55, 128
v_add_f32 v61, v61, v206
v_add_f32 v63, v63, v222
v_add_f32 v60, v60, v199
v_mfma_f32_16x16x32_bf16 a[192:195], a[224:227], a[0:3], a[192:195]
s_xor_b32 s55, s55, 128
ds_read_b64_tr_b16 a[248:249], v23 offset:16384
s_add_u32 m0, s52, 139264
v_add_f32 v62, v62, v215
v_add_f32 v61, v61, v207
v_add_f32 v63, v63, v223
v_mfma_f32_16x16x32_bf16 a[192:195], a[228:231], a[8:11], a[192:195]
ds_read_b64_tr_b16 a[250:251], v23 offset:18432
buffer_load_dwordx4 v28, s[40:43], s55 offen offset:0 lds
v_permlane16_swap_b32 v60, v61
v_mfma_f32_16x16x32_bf16 a[196:199], a[228:231], a[12:15], a[196:199]
ds_read_b64_tr_b16 a[252:253], v23 offset:20480
v_permlane16_swap_b32 v62, v63
v_add_f32 v60, v60, v61
v_add_f32 v62, v62, v63
v_mfma_f32_16x16x32_bf16 a[196:199], a[224:227], a[4:7], a[196:199]
s_waitcnt lgkmcnt(7)
buffer_load_dwordx4 v29, s[40:43], s55 offen offset:1024 lds
v_mfma_f32_16x16x32_bf16 a[204:207], a[232:235], a[4:7], a[204:207]
s_xor_b32 s55, s55, 131072
ds_read_b64_tr_b16 a[254:255], v23 offset:22528
v_permlane32_swap_b32 v60, v62
v_add_f32 v60, v60, v62
v_mfma_f32_16x16x32_bf16 a[204:207], a[236:239], a[12:15], a[204:207]
s_add_u32 m0, s52, 147456
ds_read_b64_tr_b16 a[224:225], v20 offset:24576
v_rcp_f32 v60, v60
v_mfma_f32_16x16x32_bf16 a[200:203], a[236:239], a[8:11], a[200:203]
buffer_load_dwordx4 v28, s[40:43], s55 offen offset:0 lds
v_mfma_f32_16x16x32_bf16 a[200:203], a[232:235], a[0:3], a[200:203]
s_waitcnt lgkmcnt(5)
ds_read_b64_tr_b16 a[226:227], v20 offset:26624
ds_read_b64_tr_b16 a[228:229], v20 offset:28672
v_mov_b32 v62, v60
v_mfma_f32_16x16x32_bf16 a[208:211], a[240:243], a[0:3], a[208:211]
ds_read_b64_tr_b16 a[230:231], v20 offset:30720
ds_read_b64_tr_b16 a[232:233], v21 offset:24576
v_mfma_f32_16x16x32_bf16 a[208:211], a[244:247], a[8:11], a[208:211]
ds_read_b64_tr_b16 a[234:235], v21 offset:26624
v_permlane32_swap_b32 v60, v62
v_mov_b32 v61, v60
v_mov_b32 v63, v62
v_mfma_f32_16x16x32_bf16 a[212:215], a[244:247], a[12:15], a[212:215]
ds_read_b64_tr_b16 a[236:237], v21 offset:28672
buffer_load_dwordx4 v29, s[40:43], s55 offen offset:1024 lds
v_permlane16_swap_b32 v60, v61
v_mfma_f32_16x16x32_bf16 a[212:215], a[240:243], a[4:7], a[212:215]
s_waitcnt lgkmcnt(7)
ds_read_b64_tr_b16 a[238:239], v21 offset:30720
v_permlane16_swap_b32 v62, v63
v_mul_f32 v192, v192, v60
v_mul_f32 v208, v208, v62
v_mfma_f32_16x16x32_bf16 a[220:223], a[248:251], a[4:7], a[220:223]
ds_read_b64_tr_b16 a[240:241], v22 offset:24576
v_mul_f32 v193, v193, v60
v_mul_f32 v209, v209, v62
v_mul_f32 v194, v194, v60
v_mul_f32 v210, v210, v62
v_mfma_f32_16x16x32_bf16 a[220:223], a[252:255], a[12:15], a[220:223]
ds_read_b64_tr_b16 a[242:243], v22 offset:26624
v_mul_f32 v195, v195, v60
v_mul_f32 v211, v211, v62
v_mul_f32 v196, v196, v60
v_mul_f32 v212, v212, v62
v_mfma_f32_16x16x32_bf16 a[216:219], a[252:255], a[8:11], a[216:219]
ds_read_b64_tr_b16 a[244:245], v22 offset:28672
v_mul_f32 v197, v197, v60
v_mul_f32 v213, v213, v62
v_mul_f32 v198, v198, v60
v_mul_f32 v214, v214, v62
v_mfma_f32_16x16x32_bf16 a[216:219], a[248:251], a[0:3], a[216:219]
s_waitcnt lgkmcnt(7)
ds_read_b64_tr_b16 a[246:247], v22 offset:30720
v_mul_f32 v199, v199, v60
v_mul_f32 v215, v215, v62
v_cvt_pk_bf16_f32 v240, v192, v193
v_cvt_pk_bf16_f32 v241, v194, v195
v_mfma_f32_16x16x32_bf16 a[192:195], a[224:227], a[16:19], a[192:195]
ds_read_b64_tr_b16 a[248:249], v23 offset:24576
v_cvt_pk_bf16_f32 v242, v196, v197
v_cvt_pk_bf16_f32 v243, v198, v199
v_cvt_pk_bf16_f32 v244, v208, v209
v_cvt_pk_bf16_f32 v245, v210, v211
v_mfma_f32_16x16x32_bf16 a[192:195], a[228:231], a[24:27], a[192:195]
ds_read_b64_tr_b16 a[250:251], v23 offset:26624
v_cvt_pk_bf16_f32 v246, v212, v213
v_cvt_pk_bf16_f32 v247, v214, v215
v_mul_f32 v200, v200, v61
v_mul_f32 v216, v216, v63
v_mfma_f32_16x16x32_bf16 a[196:199], a[228:231], a[28:31], a[196:199]
ds_read_b64_tr_b16 a[252:253], v23 offset:28672
v_mul_f32 v201, v201, v61
v_mul_f32 v217, v217, v63
v_mul_f32 v202, v202, v61
v_mul_f32 v218, v218, v63
v_mfma_f32_16x16x32_bf16 a[196:199], a[224:227], a[20:23], a[196:199]
s_waitcnt lgkmcnt(7)
ds_read_b64_tr_b16 a[254:255], v23 offset:30720
v_mul_f32 v203, v203, v61
v_mul_f32 v219, v219, v63
v_mul_f32 v204, v204, v61
v_mul_f32 v220, v220, v63
v_mfma_f32_16x16x32_bf16 a[204:207], a[232:235], a[20:23], a[204:207]
ds_read_b64_tr_b16 a[224:225], v16 offset:0
v_mul_f32 v205, v205, v61
v_mul_f32 v221, v221, v63
v_mul_f32 v206, v206, v61
v_mul_f32 v222, v222, v63
v_mfma_f32_16x16x32_bf16 a[204:207], a[236:239], a[28:31], a[204:207]
ds_read_b64_tr_b16 a[226:227], v16 offset:2048
v_mul_f32 v207, v207, v61
v_mul_f32 v223, v223, v63
v_cvt_pk_bf16_f32 v248, v200, v201
v_cvt_pk_bf16_f32 v249, v202, v203
v_mfma_f32_16x16x32_bf16 a[200:203], a[236:239], a[24:27], a[200:203]
ds_read_b64_tr_b16 a[228:229], v16 offset:4096
v_cvt_pk_bf16_f32 v250, v204, v205
v_cvt_pk_bf16_f32 v251, v206, v207
v_cvt_pk_bf16_f32 v252, v216, v217
v_cvt_pk_bf16_f32 v253, v218, v219
v_mfma_f32_16x16x32_bf16 a[200:203], a[232:235], a[16:19], a[200:203]
s_waitcnt lgkmcnt(7)
ds_read_b64_tr_b16 a[230:231], v16 offset:6144
v_cvt_pk_bf16_f32 v254, v220, v221
v_cvt_pk_bf16_f32 v255, v222, v223
pg_12_b:
s_cbranch_execz pg_back0
v_mfma_f32_16x16x32_bf16 a[208:211], a[240:243], a[16:19], a[208:211]
ds_read_b64_tr_b16 a[232:233], v17 offset:0
v_mfma_f32_16x16x32_bf16 a[208:211], a[244:247], a[24:27], a[208:211]
ds_read_b64_tr_b16 a[234:235], v17 offset:2048
v_mfma_f32_16x16x32_bf16 a[212:215], a[244:247], a[28:31], a[212:215]
ds_read_b64_tr_b16 a[236:237], v17 offset:4096
v_mfma_f32_16x16x32_bf16 a[212:215], a[240:243], a[20:23], a[212:215]
s_waitcnt lgkmcnt(7)
ds_read_b64_tr_b16 a[238:239], v17 offset:6144
v_mfma_f32_16x16x32_bf16 a[220:223], a[248:251], a[20:23], a[220:223]
ds_read_b64_tr_b16 a[240:241], v18 offset:0
v_mfma_f32_16x16x32_bf16 a[220:223], a[252:255], a[28:31], a[220:223]
ds_read_b64_tr_b16 a[242:243], v18 offset:2048
v_mfma_f32_16x16x32_bf16 a[216:219], a[252:255], a[24:27], a[216:219]
ds_read_b64_tr_b16 a[244:245], v18 offset:4096
v_mfma_f32_16x16x32_bf16 a[216:219], a[248:251], a[16:19], a[216:219]
s_waitcnt lgkmcnt(7)
ds_read_b64_tr_b16 a[246:247], v18 offset:6144
v_mfma_f32_16x16x32_bf16 v[64:67], a[224:227], a[16:19], v[64:67]
ds_read_b64_tr_b16 a[248:249], v19 offset:0
v_mfma_f32_16x16x32_bf16 v[64:67], a[228:231], a[24:27], v[64:67]
ds_read_b64_tr_b16 a[250:251], v19 offset:2048
v_mfma_f32_16x16x32_bf16 v[68:71], a[228:231], a[28:31], v[68:71]
ds_read_b64_tr_b16 a[252:253], v19 offset:4096
v_mfma_f32_16x16x32_bf16 v[68:71], a[224:227], a[20:23], v[68:71]
s_waitcnt vmcnt(55) lgkmcnt(0)
s_barrier
v_mfma_f32_16x16x32_bf16 v[76:79], a[232:235], a[20:23], v[76:79]
s_bfe_u32 s55, 0x17111113, s64
ds_read_b128 v[144:147], v55 offset:4096
ds_read_b64_tr_b16 a[254:255], v19 offset:6144
v_mfma_f32_16x16x32_bf16 v[76:79], a[236:239], a[28:31], v[76:79]
s_lshl_b32 s55, s55, 18
ds_read_b64_tr_b16 a[224:225], v16 offset:8192
ds_read_b64_tr_b16 a[226:227], v16 offset:10240
v_mfma_f32_16x16x32_bf16 v[72:75], a[236:239], a[24:27], v[72:75]
s_or_b32 s55, s55, 128
ds_read_b128 v[148:151], v55 offset:5120
ds_read_b64_tr_b16 a[228:229], v16 offset:12288
v_mfma_f32_16x16x32_bf16 v[72:75], a[232:235], a[16:19], v[72:75]
s_xor_b32 s55, s55, 128
ds_read_b64_tr_b16 a[230:231], v16 offset:14336
s_add_u32 m0, s52, 65536
v_mfma_f32_16x16x32_bf16 v[80:83], a[240:243], a[16:19], v[80:83]
buffer_load_dwordx4 v28, s[40:43], s55 offen offset:0 lds
v_mfma_f32_16x16x32_bf16 v[80:83], a[244:247], a[24:27], v[80:83]
ds_read_b128 v[128:131], v55 offset:0
ds_read_b64_tr_b16 a[232:233], v17 offset:8192
v_mfma_f32_16x16x32_bf16 v[84:87], a[244:247], a[28:31], v[84:87]
ds_read_b64_tr_b16 a[234:235], v17 offset:10240
ds_read_b64_tr_b16 a[236:237], v17 offset:12288
v_mfma_f32_16x16x32_bf16 v[84:87], a[240:243], a[20:23], v[84:87]
s_waitcnt lgkmcnt(9)
buffer_load_dwordx4 v29, s[40:43], s55 offen offset:1024 lds
v_mfma_f32_16x16x32_bf16 v[92:95], a[248:251], a[20:23], v[92:95]
s_xor_b32 s55, s55, 131072
ds_read_b128 v[132:135], v55 offset:1024
ds_read_b64_tr_b16 a[238:239], v17 offset:14336
v_mfma_f32_16x16x32_bf16 v[92:95], a[252:255], a[28:31], v[92:95]
s_add_u32 m0, s52, 73728
ds_read_b64_tr_b16 a[240:241], v18 offset:8192
ds_read_b64_tr_b16 a[242:243], v18 offset:10240
v_mfma_f32_16x16x32_bf16 v[88:91], a[252:255], a[24:27], v[88:91]
ds_read_b128 v[136:139], v55 offset:2048
ds_read_b64_tr_b16 a[244:245], v18 offset:12288
v_mfma_f32_16x16x32_bf16 v[88:91], a[248:251], a[16:19], v[88:91]
s_waitcnt lgkmcnt(10)
buffer_load_dword v33, v31, s[24:27], s62 offen offset:128 sc1
v_mfma_f32_16x16x32_bf16 v[64:67], a[224:227], a[32:35], v[64:67]
buffer_load_dwordx4 v28, s[40:43], s55 offen offset:0 lds
v_mfma_f32_16x16x32_bf16 v[64:67], a[228:231], a[40:43], v[64:67]
ds_read_b128 v[140:143], v55 offset:3072
ds_read_b64_tr_b16 a[246:247], v18 offset:14336
v_mfma_f32_16x16x32_bf16 v[68:71], a[228:231], a[44:47], v[68:71]
ds_read_b64_tr_b16 a[248:249], v19 offset:8192
ds_read_b64_tr_b16 a[250:251], v19 offset:10240
v_mfma_f32_16x16x32_bf16 v[68:71], a[224:227], a[36:39], v[68:71]
s_waitcnt lgkmcnt(8)
ds_read_b64_tr_b16 a[252:253], v19 offset:12288
ds_read_b64_tr_b16 a[254:255], v19 offset:14336
v_mfma_f32_16x16x32_bf16 v[76:79], a[232:235], a[36:39], v[76:79]
ds_read_b64_tr_b16 a[224:225], v16 offset:16384
v_mfma_f32_16x16x32_bf16 v[76:79], a[236:239], a[44:47], v[76:79]
buffer_load_dwordx4 v29, s[40:43], s55 offen offset:1024 lds
v_mfma_f32_16x16x32_bf16 v[200:203], v[144:147], v[224:227], 0
s_bfe_u32 s55, 0x13131519, s64
ds_read_b64_tr_b16 a[226:227], v16 offset:18432
s_lshl_b32 s55, s55, 18
v_mfma_f32_16x16x32_bf16 v[200:203], v[148:151], v[228:231], v[200:203]
s_or_b32 s55, s55, 128
s_xor_b32 s55, s55, 128
s_add_u32 m0, s52, 81920
v_mfma_f32_16x16x32_bf16 v[192:195], v[128:131], v[224:227], 0
s_add_u32 s5, s34, 112
s_lshl_b32 s5, s5, 11
s_add_u32 s5, s5, s69
v_mfma_f32_16x16x32_bf16 v[192:195], v[132:135], v[228:231], v[192:195]
s_waitcnt lgkmcnt(9)
buffer_load_dwordx4 v28, s[40:43], s55 offen offset:0 lds
v_mfma_f32_16x16x32_bf16 v[196:199], v[136:139], v[224:227], 0
s_waitcnt lgkmcnt(7)
v_add_f32 v200, 0x358637bd, v200
v_mfma_f32_16x16x32_bf16 v[196:199], v[140:143], v[228:231], v[196:199]
v_rcp_f32 v200, v200
v_mfma_f32_16x16x32_bf16 v[212:215], v[144:147], v[232:235], 0
v_mfma_f32_16x16x32_bf16 v[212:215], v[148:151], v[236:239], v[212:215]
v_mfma_f32_16x16x32_bf16 v[204:207], v[128:131], v[232:235], 0
buffer_load_dwordx4 v29, s[40:43], s55 offen offset:1024 lds
v_mfma_f32_16x16x32_bf16 v[204:207], v[132:135], v[236:239], v[204:207]
s_xor_b32 s55, s55, 131072
v_mul_f32 v192, v192, v200
v_mul_f32 v193, v193, v200
v_mfma_f32_16x16x32_bf16 v[208:211], v[136:139], v[232:235], 0
s_add_u32 m0, s52, 90112
v_add_f32 v212, 0x358637bd, v212
v_mul_f32 v194, v194, v200
v_mfma_f32_16x16x32_bf16 v[208:211], v[140:143], v[236:239], v[208:211]
v_rcp_f32 v212, v212
v_mfma_f32_16x16x32_bf16 v[104:107], v[144:147], v[240:243], 0
buffer_load_dwordx4 v28, s[40:43], s55 offen offset:0 lds
v_mfma_f32_16x16x32_bf16 v[104:107], v[148:151], v[244:247], v[104:107]
v_mul_f32 v195, v195, v200
v_mul_f32 v196, v196, v200
v_mfma_f32_16x16x32_bf16 v[96:99], v[128:131], v[240:243], 0
v_mul_f32 v197, v197, v200
v_mul_f32 v198, v198, v200
v_mfma_f32_16x16x32_bf16 v[96:99], v[132:135], v[244:247], v[96:99]
v_mul_f32 v199, v199, v200
v_cvt_pk_bf16_f32 v192, v192, v193
v_mfma_f32_16x16x32_bf16 v[100:103], v[136:139], v[240:243], 0
v_add_f32 v104, 0x358637bd, v104
v_cvt_pk_bf16_f32 v193, v194, v195
v_mfma_f32_16x16x32_bf16 v[100:103], v[140:143], v[244:247], v[100:103]
buffer_load_dwordx4 v29, s[40:43], s55 offen offset:1024 lds
v_mfma_f32_16x16x32_bf16 v[116:119], v[144:147], v[248:251], 0
v_rcp_f32 v104, v104
v_mfma_f32_16x16x32_bf16 v[116:119], v[148:151], v[252:255], v[116:119]
v_cvt_pk_bf16_f32 v194, v196, v197
v_cvt_pk_bf16_f32 v195, v198, v199
v_mfma_f32_16x16x32_bf16 v[108:111], v[128:131], v[248:251], 0
v_mul_f32 v204, v204, v212
v_mul_f32 v205, v205, v212
v_mfma_f32_16x16x32_bf16 v[108:111], v[132:135], v[252:255], v[108:111]
buffer_store_dwordx4 v[192:195], v1, s[24:27], s5 offen offset:0 sc1
v_mul_f32 v206, v206, v212
v_add_f32 v116, 0x358637bd, v116
v_mul_f32 v207, v207, v212
v_mfma_f32_16x16x32_bf16 v[112:115], v[136:139], v[248:251], 0
v_rcp_f32 v116, v116
v_mfma_f32_16x16x32_bf16 v[112:115], v[140:143], v[252:255], v[112:115]
v_mul_f32 v208, v208, v212
v_mul_f32 v209, v209, v212
v_mfma_f32_16x16x32_bf16 v[72:75], a[236:239], a[40:43], v[72:75]
ds_read_b64_tr_b16 a[228:229], v16 offset:20480
v_mul_f32 v210, v210, v212
v_mul_f32 v211, v211, v212
v_cvt_pk_bf16_f32 v204, v204, v205
v_cvt_pk_bf16_f32 v205, v206, v207
v_mfma_f32_16x16x32_bf16 v[72:75], a[232:235], a[32:35], v[72:75]
s_waitcnt lgkmcnt(7)
ds_read_b64_tr_b16 a[230:231], v16 offset:22528
v_cvt_pk_bf16_f32 v206, v208, v209
v_cvt_pk_bf16_f32 v207, v210, v211
v_mul_f32 v96, v96, v104
v_mul_f32 v97, v97, v104
v_mfma_f32_16x16x32_bf16 v[80:83], a[240:243], a[32:35], v[80:83]
buffer_store_dwordx4 v[204:207], v1, s[24:27], s5 offen offset:1024 sc1
ds_read_b64_tr_b16 a[232:233], v17 offset:16384
v_mul_f32 v98, v98, v104
v_mul_f32 v99, v99, v104
v_mfma_f32_16x16x32_bf16 v[80:83], a[244:247], a[40:43], v[80:83]
s_add_u32 s5, s5, 294912
ds_read_b64_tr_b16 a[234:235], v17 offset:18432
v_mul_f32 v100, v100, v104
v_mul_f32 v101, v101, v104
v_mul_f32 v102, v102, v104
v_mul_f32 v103, v103, v104
v_mfma_f32_16x16x32_bf16 v[84:87], a[244:247], a[44:47], v[84:87]
ds_read_b64_tr_b16 a[236:237], v17 offset:20480
v_cvt_pk_bf16_f32 v96, v96, v97
v_cvt_pk_bf16_f32 v97, v98, v99
v_cvt_pk_bf16_f32 v98, v100, v101
v_cvt_pk_bf16_f32 v99, v102, v103
v_mfma_f32_16x16x32_bf16 v[84:87], a[240:243], a[36:39], v[84:87]
s_waitcnt lgkmcnt(7)
ds_read_b64_tr_b16 a[238:239], v17 offset:22528
v_mul_f32 v108, v108, v116
v_mul_f32 v109, v109, v116
v_mul_f32 v110, v110, v116
v_mul_f32 v111, v111, v116
v_mfma_f32_16x16x32_bf16 v[92:95], a[248:251], a[36:39], v[92:95]
buffer_store_dwordx4 v[96:99], v1, s[24:27], s5 offen offset:0 sc1
ds_read_b64_tr_b16 a[240:241], v18 offset:16384
v_mul_f32 v112, v112, v116
v_mul_f32 v113, v113, v116
v_mfma_f32_16x16x32_bf16 v[92:95], a[252:255], a[44:47], v[92:95]
ds_read_b64_tr_b16 a[242:243], v18 offset:18432
v_mul_f32 v114, v114, v116
v_mul_f32 v115, v115, v116
v_cvt_pk_bf16_f32 v108, v108, v109
v_cvt_pk_bf16_f32 v109, v110, v111
v_mfma_f32_16x16x32_bf16 v[88:91], a[252:255], a[40:43], v[88:91]
ds_read_b64_tr_b16 a[244:245], v18 offset:20480
v_cvt_pk_bf16_f32 v110, v112, v113
v_cvt_pk_bf16_f32 v111, v114, v115
v_mfma_f32_16x16x32_bf16 v[88:91], a[248:251], a[32:35], v[88:91]
s_waitcnt lgkmcnt(7)
ds_read_b64_tr_b16 a[246:247], v18 offset:22528
v_mfma_f32_16x16x32_bf16 a[192:195], a[224:227], a[32:35], a[192:195]
buffer_store_dwordx4 v[108:111], v1, s[24:27], s5 offen offset:1024 sc1
ds_read_b64_tr_b16 a[248:249], v19 offset:16384
s_add_u32 s5, s65, 32768
v_mfma_f32_16x16x32_bf16 a[192:195], a[228:231], a[40:43], a[192:195]
ds_read_b64_tr_b16 a[250:251], v19 offset:18432
v_mfma_f32_16x16x32_bf16 a[196:199], a[228:231], a[44:47], a[196:199]
ds_read_b64_tr_b16 a[252:253], v19 offset:20480
v_mfma_f32_16x16x32_bf16 a[196:199], a[224:227], a[36:39], a[196:199]
s_waitcnt lgkmcnt(7)
ds_read_b64_tr_b16 a[254:255], v19 offset:22528
v_mfma_f32_16x16x32_bf16 a[204:207], a[232:235], a[36:39], a[204:207]
ds_read_b64_tr_b16 a[224:225], v16 offset:24576
v_mfma_f32_16x16x32_bf16 a[204:207], a[236:239], a[44:47], a[204:207]
ds_read_b64_tr_b16 a[226:227], v16 offset:26624
v_mfma_f32_16x16x32_bf16 a[200:203], a[236:239], a[40:43], a[200:203]
ds_read_b64_tr_b16 a[228:229], v16 offset:28672
v_mfma_f32_16x16x32_bf16 a[200:203], a[232:235], a[32:35], a[200:203]
s_waitcnt lgkmcnt(7)
ds_read_b64_tr_b16 a[230:231], v16 offset:30720
v_mfma_f32_16x16x32_bf16 a[208:211], a[240:243], a[32:35], a[208:211]
ds_read_b64_tr_b16 a[232:233], v17 offset:24576
v_mfma_f32_16x16x32_bf16 a[208:211], a[244:247], a[40:43], a[208:211]
ds_read_b64_tr_b16 a[234:235], v17 offset:26624
v_mfma_f32_16x16x32_bf16 a[212:215], a[244:247], a[44:47], a[212:215]
ds_read_b64_tr_b16 a[236:237], v17 offset:28672
v_mfma_f32_16x16x32_bf16 a[212:215], a[240:243], a[36:39], a[212:215]
s_waitcnt lgkmcnt(7)
ds_read_b64_tr_b16 a[238:239], v17 offset:30720
v_mfma_f32_16x16x32_bf16 a[220:223], a[248:251], a[36:39], a[220:223]
ds_read_b64_tr_b16 a[240:241], v18 offset:24576
v_mfma_f32_16x16x32_bf16 a[220:223], a[252:255], a[44:47], a[220:223]
ds_read_b64_tr_b16 a[242:243], v18 offset:26624
v_mfma_f32_16x16x32_bf16 a[216:219], a[252:255], a[40:43], a[216:219]
ds_read_b64_tr_b16 a[244:245], v18 offset:28672
v_mfma_f32_16x16x32_bf16 a[216:219], a[248:251], a[32:35], a[216:219]
s_waitcnt vmcnt(10) lgkmcnt(7)
ds_read_b64_tr_b16 a[246:247], v18 offset:30720
v_cmp_ne_u32 vcc, v33, v32
s_nop 0
s_cbranch_vccnz ckS_spin_b
ckS_ok_b:
v_mfma_f32_16x16x32_bf16 a[192:195], a[224:227], a[48:51], a[192:195]
s_bfe_u32 s54, 0x11151311, s64
ds_read_b64_tr_b16 a[248:249], v19 offset:24576
s_lshl_b32 s54, s54, 13
v_mfma_f32_16x16x32_bf16 a[192:195], a[228:231], a[56:59], a[192:195]
s_add_u32 s54, s54, s63
ds_read_b64_tr_b16 a[250:251], v19 offset:26624
v_mfma_f32_16x16x32_bf16 a[196:199], a[228:231], a[60:63], a[196:199]
buffer_load_dwordx4 a[0:3], v1, s[24:27], s54 offen offset:0 sc1
v_mfma_f32_16x16x32_bf16 a[196:199], a[224:227], a[52:55], a[196:199]
s_waitcnt lgkmcnt(6)
ds_read_b64_tr_b16 a[252:253], v19 offset:28672
ds_read_b64_tr_b16 a[254:255], v19 offset:30720
v_mfma_f32_16x16x32_bf16 a[204:207], a[232:235], a[52:55], a[204:207]
ds_read_b64_tr_b16 a[224:225], v16 offset:32768
v_mfma_f32_16x16x32_bf16 a[204:207], a[236:239], a[60:63], a[204:207]
buffer_load_dwordx4 a[4:7], v1, s[24:27], s54 offen offset:1024 sc1
v_mfma_f32_16x16x32_bf16 a[200:203], a[236:239], a[56:59], a[200:203]
ds_read_b64_tr_b16 a[226:227], v16 offset:34816
ds_read_b64_tr_b16 a[228:229], v16 offset:36864
v_mfma_f32_16x16x32_bf16 a[200:203], a[232:235], a[48:51], a[200:203]
s_waitcnt lgkmcnt(7)
ds_read_b64_tr_b16 a[230:231], v16 offset:38912
v_mfma_f32_16x16x32_bf16 a[208:211], a[240:243], a[48:51], a[208:211]
ds_read_b64_tr_b16 a[232:233], v17 offset:32768
v_mfma_f32_16x16x32_bf16 a[208:211], a[244:247], a[56:59], a[208:211]
buffer_load_dwordx4 a[8:11], v1, s[24:27], s54 offen offset:2048 sc1
v_mfma_f32_16x16x32_bf16 a[212:215], a[244:247], a[60:63], a[212:215]
ds_read_b64_tr_b16 a[234:235], v17 offset:34816
ds_read_b64_tr_b16 a[236:237], v17 offset:36864
v_mfma_f32_16x16x32_bf16 a[212:215], a[240:243], a[52:55], a[212:215]
s_waitcnt lgkmcnt(7)
ds_read_b64_tr_b16 a[238:239], v17 offset:38912
v_mfma_f32_16x16x32_bf16 a[220:223], a[248:251], a[52:55], a[220:223]
ds_read_b64_tr_b16 a[240:241], v18 offset:32768
v_mfma_f32_16x16x32_bf16 a[220:223], a[252:255], a[60:63], a[220:223]
ds_read_b64_tr_b16 a[242:243], v18 offset:34816
v_mfma_f32_16x16x32_bf16 a[216:219], a[252:255], a[56:59], a[216:219]
buffer_load_dwordx4 a[12:15], v1, s[24:27], s54 offen offset:3072 sc1
v_mfma_f32_16x16x32_bf16 a[216:219], a[248:251], a[48:51], a[216:219]
s_waitcnt lgkmcnt(6)
ds_read_b64_tr_b16 a[244:245], v18 offset:36864
ds_read_b64_tr_b16 a[246:247], v18 offset:38912
v_mfma_f32_16x16x32_bf16 v[64:67], a[224:227], a[48:51], v[64:67]
s_load_dword s101, s[92:93], 57336
ds_read_b64_tr_b16 a[248:249], v19 offset:32768
v_mfma_f32_16x16x32_bf16 v[64:67], a[228:231], a[56:59], v[64:67]
ds_read_b64_tr_b16 a[250:251], v19 offset:34816
v_mfma_f32_16x16x32_bf16 v[68:71], a[228:231], a[60:63], v[68:71]
buffer_load_dwordx4 a[16:19], v2, s[24:27], s54 offen offset:0 sc1
v_mfma_f32_16x16x32_bf16 v[68:71], a[224:227], a[52:55], v[68:71]
s_waitcnt vmcnt(56) lgkmcnt(6)
s_barrier
v_mfma_f32_16x16x32_bf16 v[76:79], a[232:235], a[52:55], v[76:79]
ds_read_b64_tr_b16 a[252:253], v19 offset:36864
ds_read_b64_tr_b16 a[254:255], v19 offset:38912
v_mfma_f32_16x16x32_bf16 v[76:79], a[236:239], a[60:63], v[76:79]
ds_read_b64_tr_b16 a[224:225], v16 offset:40960
ds_read_b64_tr_b16 a[226:227], v16 offset:43008
v_mfma_f32_16x16x32_bf16 v[72:75], a[236:239], a[56:59], v[72:75]
buffer_load_dwordx4 a[20:23], v2, s[24:27], s54 offen offset:1024 sc1
v_mfma_f32_16x16x32_bf16 v[72:75], a[232:235], a[48:51], v[72:75]
s_waitcnt lgkmcnt(6)
ds_read_b64_tr_b16 a[228:229], v16 offset:45056
ds_read_b64_tr_b16 a[230:231], v16 offset:47104
v_mfma_f32_16x16x32_bf16 v[80:83], a[240:243], a[48:51], v[80:83]
ds_read_b64_tr_b16 a[232:233], v17 offset:40960
v_mfma_f32_16x16x32_bf16 v[80:83], a[244:247], a[56:59], v[80:83]
ds_read_b64_tr_b16 a[234:235], v17 offset:43008
v_mfma_f32_16x16x32_bf16 v[84:87], a[244:247], a[60:63], v[84:87]
ds_read_b64_tr_b16 a[236:237], v17 offset:45056
v_mfma_f32_16x16x32_bf16 v[84:87], a[240:243], a[52:55], v[84:87]
s_waitcnt lgkmcnt(7)
buffer_load_dwordx4 a[24:27], v2, s[24:27], s54 offen offset:2048 sc1
v_mfma_f32_16x16x32_bf16 v[92:95], a[248:251], a[52:55], v[92:95]
ds_read_b64_tr_b16 a[238:239], v17 offset:47104
ds_read_b64_tr_b16 a[240:241], v18 offset:40960
v_mfma_f32_16x16x32_bf16 v[92:95], a[252:255], a[60:63], v[92:95]
ds_read_b64_tr_b16 a[242:243], v18 offset:43008
v_mfma_f32_16x16x32_bf16 v[88:91], a[252:255], a[56:59], v[88:91]
ds_read_b64_tr_b16 a[244:245], v18 offset:45056
v_mfma_f32_16x16x32_bf16 v[88:91], a[248:251], a[48:51], v[88:91]
s_waitcnt lgkmcnt(7)
buffer_load_dwordx4 a[28:31], v2, s[24:27], s54 offen offset:3072 sc1
v_mfma_f32_16x16x32_bf16 v[64:67], a[224:227], a[160:163], v[64:67]
s_bfe_u32 s54, 0x17111113, s64
ds_read_b64_tr_b16 a[246:247], v18 offset:47104
ds_read_b64_tr_b16 a[248:249], v19 offset:40960
v_mfma_f32_16x16x32_bf16 v[64:67], a[228:231], a[168:171], v[64:67]
s_lshl_b32 s54, s54, 13
ds_read_b64_tr_b16 a[250:251], v19 offset:43008
s_add_u32 s54, s54, s63
v_mfma_f32_16x16x32_bf16 v[68:71], a[228:231], a[172:175], v[68:71]
ds_read_b64_tr_b16 a[252:253], v19 offset:45056
v_mfma_f32_16x16x32_bf16 v[68:71], a[224:227], a[164:167], v[68:71]
s_waitcnt lgkmcnt(7)
ds_read_b64_tr_b16 a[254:255], v19 offset:47104
v_mfma_f32_16x16x32_bf16 v[76:79], a[232:235], a[164:167], v[76:79]
buffer_load_dwordx4 a[32:35], v1, s[24:27], s54 offen offset:0 sc1
v_mfma_f32_16x16x32_bf16 v[76:79], a[236:239], a[172:175], v[76:79]
ds_read_b64_tr_b16 a[224:225], v16 offset:49152
ds_read_b64_tr_b16 a[226:227], v16 offset:51200
v_mfma_f32_16x16x32_bf16 v[72:75], a[236:239], a[168:171], v[72:75]
ds_read_b64_tr_b16 a[228:229], v16 offset:53248
v_mfma_f32_16x16x32_bf16 v[72:75], a[232:235], a[160:163], v[72:75]
s_waitcnt lgkmcnt(7)
ds_read_b64_tr_b16 a[230:231], v16 offset:55296
v_mfma_f32_16x16x32_bf16 v[80:83], a[240:243], a[160:163], v[80:83]
buffer_load_dwordx4 a[36:39], v1, s[24:27], s54 offen offset:1024 sc1
v_mfma_f32_16x16x32_bf16 v[80:83], a[244:247], a[168:171], v[80:83]
ds_read_b64_tr_b16 a[232:233], v17 offset:49152
ds_read_b64_tr_b16 a[234:235], v17 offset:51200
v_mfma_f32_16x16x32_bf16 v[84:87], a[244:247], a[172:175], v[84:87]
ds_read_b64_tr_b16 a[236:237], v17 offset:53248
v_mfma_f32_16x16x32_bf16 v[84:87], a[240:243], a[164:167], v[84:87]
s_waitcnt lgkmcnt(7)
ds_read_b64_tr_b16 a[238:239], v17 offset:55296
s_waitcnt vmcnt(10)
v_mfma_f32_16x16x32_bf16 v[92:95], a[248:251], a[164:167], v[92:95]
buffer_store_dword v32, v30, s[24:27], s61 offen offset:256 sc1
buffer_load_dwordx4 a[40:43], v1, s[24:27], s54 offen offset:2048 sc1
v_mfma_f32_16x16x32_bf16 v[92:95], a[252:255], a[172:175], v[92:95]
ds_read_b64_tr_b16 a[240:241], v18 offset:49152
ds_read_b64_tr_b16 a[242:243], v18 offset:51200
v_mfma_f32_16x16x32_bf16 v[88:91], a[252:255], a[168:171], v[88:91]
ds_read_b64_tr_b16 a[244:245], v18 offset:53248
v_mfma_f32_16x16x32_bf16 v[88:91], a[248:251], a[160:163], v[88:91]
s_waitcnt lgkmcnt(7)
ds_read_b64_tr_b16 a[246:247], v18 offset:55296
v_mfma_f32_16x16x32_bf16 a[192:195], a[224:227], a[160:163], a[192:195]
ds_read_b64_tr_b16 a[248:249], v19 offset:49152
v_mfma_f32_16x16x32_bf16 a[192:195], a[228:231], a[168:171], a[192:195]
buffer_load_dwordx4 a[44:47], v1, s[24:27], s54 offen offset:3072 sc1
v_mfma_f32_16x16x32_bf16 a[196:199], a[228:231], a[172:175], a[196:199]
ds_read_b64_tr_b16 a[250:251], v19 offset:51200
ds_read_b64_tr_b16 a[252:253], v19 offset:53248
v_mfma_f32_16x16x32_bf16 a[196:199], a[224:227], a[164:167], a[196:199]
s_waitcnt lgkmcnt(7)
ds_read_b64_tr_b16 a[254:255], v19 offset:55296
v_mfma_f32_16x16x32_bf16 a[204:207], a[232:235], a[164:167], a[204:207]
ds_read_b64_tr_b16 a[224:225], v16 offset:57344
v_mfma_f32_16x16x32_bf16 a[204:207], a[236:239], a[172:175], a[204:207]
buffer_load_dwordx4 a[48:51], v2, s[24:27], s54 offen offset:0 sc1
v_mfma_f32_16x16x32_bf16 a[200:203], a[236:239], a[168:171], a[200:203]
ds_read_b64_tr_b16 a[226:227], v16 offset:59392
ds_read_b64_tr_b16 a[228:229], v16 offset:61440
v_mfma_f32_16x16x32_bf16 a[200:203], a[232:235], a[160:163], a[200:203]
s_waitcnt lgkmcnt(7)
ds_read_b64_tr_b16 a[230:231], v16 offset:63488
v_mfma_f32_16x16x32_bf16 a[208:211], a[240:243], a[160:163], a[208:211]
ds_read_b64_tr_b16 a[232:233], v17 offset:57344
v_mfma_f32_16x16x32_bf16 a[208:211], a[244:247], a[168:171], a[208:211]
ds_read_b64_tr_b16 a[234:235], v17 offset:59392
v_mfma_f32_16x16x32_bf16 a[212:215], a[244:247], a[172:175], a[212:215]
buffer_load_dwordx4 a[52:55], v2, s[24:27], s54 offen offset:1024 sc1
v_mfma_f32_16x16x32_bf16 a[212:215], a[240:243], a[164:167], a[212:215]
s_waitcnt lgkmcnt(6)
ds_read_b64_tr_b16 a[236:237], v17 offset:61440
ds_read_b64_tr_b16 a[238:239], v17 offset:63488
v_mfma_f32_16x16x32_bf16 a[220:223], a[248:251], a[164:167], a[220:223]
ds_read_b64_tr_b16 a[240:241], v18 offset:57344
v_mfma_f32_16x16x32_bf16 a[220:223], a[252:255], a[172:175], a[220:223]
ds_read_b64_tr_b16 a[242:243], v18 offset:59392
v_mfma_f32_16x16x32_bf16 a[216:219], a[252:255], a[168:171], a[216:219]
buffer_load_dwordx4 a[56:59], v2, s[24:27], s54 offen offset:2048 sc1
v_mfma_f32_16x16x32_bf16 a[216:219], a[248:251], a[160:163], a[216:219]
s_waitcnt lgkmcnt(6)
ds_read_b64_tr_b16 a[244:245], v18 offset:61440
ds_read_b64_tr_b16 a[246:247], v18 offset:63488
v_mfma_f32_16x16x32_bf16 a[192:195], a[224:227], a[176:179], a[192:195]
ds_read_b64_tr_b16 a[248:249], v19 offset:57344
v_mfma_f32_16x16x32_bf16 a[192:195], a[228:231], a[184:187], a[192:195]
ds_read_b64_tr_b16 a[250:251], v19 offset:59392
v_mfma_f32_16x16x32_bf16 a[196:199], a[228:231], a[188:191], a[196:199]
ds_read_b64_tr_b16 a[252:253], v19 offset:61440
v_mfma_f32_16x16x32_bf16 a[196:199], a[224:227], a[180:183], a[196:199]
s_waitcnt lgkmcnt(7)
buffer_load_dwordx4 a[60:63], v2, s[24:27], s54 offen offset:3072 sc1
v_mfma_f32_16x16x32_bf16 a[204:207], a[232:235], a[180:183], a[204:207]
s_bfe_u32 s55, 0x15171b15, s64
ds_read_b64_tr_b16 a[254:255], v19 offset:63488
ds_read_b64_tr_b16 a[224:225], v20 offset:32768
v_mfma_f32_16x16x32_bf16 a[204:207], a[236:239], a[188:191], a[204:207]
s_lshl_b32 s55, s55, 18
ds_read_b64_tr_b16 a[226:227], v20 offset:34816
s_or_b32 s55, s55, 128
v_mfma_f32_16x16x32_bf16 a[200:203], a[236:239], a[184:187], a[200:203]
s_xor_b32 s55, s55, 128
ds_read_b64_tr_b16 a[228:229], v20 offset:36864
s_add_u32 m0, s52, 0
v_mfma_f32_16x16x32_bf16 a[200:203], a[232:235], a[176:179], a[200:203]
s_waitcnt lgkmcnt(7)
buffer_load_dwordx4 v28, s[40:43], s55 offen offset:0 lds
v_mfma_f32_16x16x32_bf16 a[208:211], a[240:243], a[176:179], a[208:211]
ds_read_b64_tr_b16 a[230:231], v20 offset:38912
ds_read_b64_tr_b16 a[232:233], v21 offset:32768
v_mfma_f32_16x16x32_bf16 a[208:211], a[244:247], a[184:187], a[208:211]
ds_read_b64_tr_b16 a[234:235], v21 offset:34816
v_mfma_f32_16x16x32_bf16 a[212:215], a[244:247], a[188:191], a[212:215]
ds_read_b64_tr_b16 a[236:237], v21 offset:36864
v_mfma_f32_16x16x32_bf16 a[212:215], a[240:243], a[180:183], a[212:215]
s_waitcnt lgkmcnt(7)
ds_read_b64_tr_b16 a[238:239], v21 offset:38912
v_mfma_f32_16x16x32_bf16 a[220:223], a[248:251], a[180:183], a[220:223]
buffer_load_dwordx4 v29, s[40:43], s55 offen offset:1024 lds
v_mfma_f32_16x16x32_bf16 a[220:223], a[252:255], a[188:191], a[220:223]
s_xor_b32 s55, s55, 131072
ds_read_b64_tr_b16 a[240:241], v22 offset:32768
ds_read_b64_tr_b16 a[242:243], v22 offset:34816
v_mfma_f32_16x16x32_bf16 a[216:219], a[252:255], a[184:187], a[216:219]
s_add_u32 m0, s52, 8192
ds_read_b64_tr_b16 a[244:245], v22 offset:36864
v_mfma_f32_16x16x32_bf16 a[216:219], a[248:251], a[176:179], a[216:219]
s_waitcnt lgkmcnt(7)
ds_read_b64_tr_b16 a[246:247], v22 offset:38912
v_mfma_f32_16x16x32_bf16 v[64:67], a[224:227], a[176:179], v[64:67]
buffer_load_dwordx4 v28, s[40:43], s55 offen offset:0 lds
v_mfma_f32_16x16x32_bf16 v[64:67], a[228:231], a[184:187], v[64:67]
ds_read_b64_tr_b16 a[248:249], v23 offset:32768
ds_read_b64_tr_b16 a[250:251], v23 offset:34816
v_mfma_f32_16x16x32_bf16 v[68:71], a[228:231], a[188:191], v[68:71]
ds_read_b64_tr_b16 a[252:253], v23 offset:36864
v_mfma_f32_16x16x32_bf16 v[68:71], a[224:227], a[180:183], v[68:71]
s_waitcnt vmcnt(45) lgkmcnt(7)
s_barrier
v_mfma_f32_16x16x32_bf16 v[76:79], a[232:235], a[180:183], v[76:79]
buffer_load_dwordx4 v29, s[40:43], s55 offen offset:1024 lds
v_mfma_f32_16x16x32_bf16 v[76:79], a[236:239], a[188:191], v[76:79]
s_bfe_u32 s54, 0x13131519, s64
ds_read_b64_tr_b16 a[254:255], v23 offset:38912
ds_read_b64_tr_b16 a[224:225], v20 offset:40960
v_mfma_f32_16x16x32_bf16 v[72:75], a[236:239], a[184:187], v[72:75]
s_lshl_b32 s54, s54, 13
ds_read_b64_tr_b16 a[226:227], v20 offset:43008
ds_read_b64_tr_b16 a[228:229], v20 offset:45056
v_mfma_f32_16x16x32_bf16 v[72:75], a[232:235], a[176:179], v[72:75]
s_waitcnt lgkmcnt(7)
ds_read_b64_tr_b16 a[230:231], v20 offset:47104
s_add_u32 s54, s54, s63
v_mfma_f32_16x16x32_bf16 v[80:83], a[240:243], a[176:179], v[80:83]
buffer_load_dwordx4 a[64:67], v1, s[24:27], s54 offen offset:0 sc1
v_mfma_f32_16x16x32_bf16 v[80:83], a[244:247], a[184:187], v[80:83]
ds_read_b64_tr_b16 a[232:233], v21 offset:40960
ds_read_b64_tr_b16 a[234:235], v21 offset:43008
v_mfma_f32_16x16x32_bf16 v[84:87], a[244:247], a[188:191], v[84:87]
ds_read_b64_tr_b16 a[236:237], v21 offset:45056
v_mfma_f32_16x16x32_bf16 v[84:87], a[240:243], a[180:183], v[84:87]
s_waitcnt lgkmcnt(7)
ds_read_b64_tr_b16 a[238:239], v21 offset:47104
v_mfma_f32_16x16x32_bf16 v[92:95], a[248:251], a[180:183], v[92:95]
ds_read_b64_tr_b16 a[240:241], v22 offset:40960
v_mfma_f32_16x16x32_bf16 v[92:95], a[252:255], a[188:191], v[92:95]
buffer_load_dwordx4 a[68:71], v1, s[24:27], s54 offen offset:1024 sc1
v_mfma_f32_16x16x32_bf16 v[88:91], a[252:255], a[184:187], v[88:91]
ds_read_b64_tr_b16 a[242:243], v22 offset:43008
ds_read_b64_tr_b16 a[244:245], v22 offset:45056
v_mfma_f32_16x16x32_bf16 v[88:91], a[248:251], a[176:179], v[88:91]
s_waitcnt lgkmcnt(7)
ds_read_b64_tr_b16 a[246:247], v22 offset:47104
v_mfma_f32_16x16x32_bf16 v[64:67], a[224:227], a[128:131], v[64:67]
ds_read_b64_tr_b16 a[248:249], v23 offset:40960
v_mfma_f32_16x16x32_bf16 v[64:67], a[228:231], a[136:139], v[64:67]
buffer_load_dwordx4 a[72:75], v1, s[24:27], s54 offen offset:2048 sc1
v_mfma_f32_16x16x32_bf16 v[68:71], a[228:231], a[140:143], v[68:71]
ds_read_b64_tr_b16 a[250:251], v23 offset:43008
ds_read_b64_tr_b16 a[252:253], v23 offset:45056
v_mfma_f32_16x16x32_bf16 v[68:71], a[224:227], a[132:135], v[68:71]
s_waitcnt lgkmcnt(7)
ds_read_b64_tr_b16 a[254:255], v23 offset:47104
v_mfma_f32_16x16x32_bf16 v[76:79], a[232:235], a[132:135], v[76:79]
ds_read_b64_tr_b16 a[224:225], v20 offset:49152
v_mfma_f32_16x16x32_bf16 v[76:79], a[236:239], a[140:143], v[76:79]
ds_read_b64_tr_b16 a[226:227], v20 offset:51200
v_mfma_f32_16x16x32_bf16 v[72:75], a[236:239], a[136:139], v[72:75]
buffer_load_dwordx4 a[76:79], v1, s[24:27], s54 offen offset:3072 sc1
v_mfma_f32_16x16x32_bf16 v[72:75], a[232:235], a[128:131], v[72:75]
s_waitcnt lgkmcnt(6)
ds_read_b64_tr_b16 a[228:229], v20 offset:53248
ds_read_b64_tr_b16 a[230:231], v20 offset:55296
v_mfma_f32_16x16x32_bf16 v[80:83], a[240:243], a[128:131], v[80:83]
ds_read_b64_tr_b16 a[232:233], v21 offset:49152
v_mfma_f32_16x16x32_bf16 v[80:83], a[244:247], a[136:139], v[80:83]
ds_read_b64_tr_b16 a[234:235], v21 offset:51200
v_mfma_f32_16x16x32_bf16 v[84:87], a[244:247], a[140:143], v[84:87]
buffer_load_dwordx4 a[80:83], v2, s[24:27], s54 offen offset:0 sc1
v_mfma_f32_16x16x32_bf16 v[84:87], a[240:243], a[132:135], v[84:87]
s_waitcnt lgkmcnt(6)
ds_read_b64_tr_b16 a[236:237], v21 offset:53248
v_permlane16_swap_b32 v4, v6
v_permlane16_swap_b32 v5, v7
v_mfma_f32_16x16x32_bf16 v[92:95], a[248:251], a[132:135], v[92:95]
ds_read_b64_tr_b16 a[238:239], v21 offset:55296
v_permlane16_swap_b32 v8, v10
v_permlane16_swap_b32 v9, v11
v_mfma_f32_16x16x32_bf16 v[92:95], a[252:255], a[140:143], v[92:95]
ds_read_b64_tr_b16 a[240:241], v22 offset:49152
buffer_load_dwordx4 a[84:87], v2, s[24:27], s54 offen offset:1024 sc1
v_permlane16_swap_b32 v12, v14
v_mfma_f32_16x16x32_bf16 v[88:91], a[252:255], a[136:139], v[88:91]
ds_read_b64_tr_b16 a[242:243], v22 offset:51200
v_permlane16_swap_b32 v13, v15
v_permlane16_swap_b32 v56, v58
v_mfma_f32_16x16x32_bf16 v[88:91], a[248:251], a[128:131], v[88:91]
s_waitcnt lgkmcnt(6)
ds_read_b64_tr_b16 a[244:245], v22 offset:53248
v_permlane16_swap_b32 v57, v59
v_lshlrev_b32 v192, 16, v4
v_and_b32 v193, 0xffff0000, v4
v_mfma_f32_16x16x32_bf16 a[192:195], a[224:227], a[128:131], a[192:195]
ds_read_b64_tr_b16 a[246:247], v22 offset:55296
buffer_load_dwordx4 a[88:91], v2, s[24:27], s54 offen offset:2048 sc1
v_lshlrev_b32 v194, 16, v5
v_and_b32 v195, 0xffff0000, v5
v_mfma_f32_16x16x32_bf16 a[192:195], a[228:231], a[136:139], a[192:195]
pg_13_b:
s_cbranch_execz pg_back0
ds_read_b64_tr_b16 a[248:249], v23 offset:49152
v_lshlrev_b32 v196, 16, v8
v_and_b32 v197, 0xffff0000, v8
v_lshlrev_b32 v198, 16, v9
v_and_b32 v199, 0xffff0000, v9
v_mfma_f32_16x16x32_bf16 a[196:199], a[228:231], a[140:143], a[196:199]
ds_read_b64_tr_b16 a[250:251], v23 offset:51200
v_lshlrev_b32 v200, 16, v6
v_and_b32 v201, 0xffff0000, v6
v_lshlrev_b32 v202, 16, v7
v_and_b32 v203, 0xffff0000, v7
v_mfma_f32_16x16x32_bf16 a[196:199], a[224:227], a[132:135], a[196:199]
s_waitcnt lgkmcnt(6)
ds_read_b64_tr_b16 a[252:253], v23 offset:53248
buffer_load_dwordx4 a[92:95], v2, s[24:27], s54 offen offset:3072 sc1
v_lshlrev_b32 v204, 16, v10
v_and_b32 v205, 0xffff0000, v10
v_mfma_f32_16x16x32_bf16 a[204:207], a[232:235], a[132:135], a[204:207]
s_bfe_u32 s54, 0x15171b15, s64
ds_read_b64_tr_b16 a[254:255], v23 offset:55296
s_lshl_b32 s54, s54, 13
v_lshlrev_b32 v206, 16, v11
v_and_b32 v207, 0xffff0000, v11
v_lshlrev_b32 v208, 16, v12
v_mfma_f32_16x16x32_bf16 a[204:207], a[236:239], a[140:143], a[204:207]
s_add_u32 s54, s54, s63
ds_read_b64_tr_b16 a[224:225], v20 offset:57344
v_and_b32 v209, 0xffff0000, v12
v_lshlrev_b32 v210, 16, v13
v_and_b32 v211, 0xffff0000, v13
v_lshlrev_b32 v212, 16, v56
v_mfma_f32_16x16x32_bf16 a[200:203], a[236:239], a[136:139], a[200:203]
ds_read_b64_tr_b16 a[226:227], v20 offset:59392
buffer_load_dwordx4 a[160:163], v1, s[24:27], s54 offen offset:0 sc1
v_and_b32 v213, 0xffff0000, v56
v_lshlrev_b32 v214, 16, v57
v_mfma_f32_16x16x32_bf16 a[200:203], a[232:235], a[128:131], a[200:203]
s_waitcnt lgkmcnt(6)
ds_read_b64_tr_b16 a[228:229], v20 offset:61440
v_and_b32 v215, 0xffff0000, v57
v_lshlrev_b32 v216, 16, v14
v_and_b32 v217, 0xffff0000, v14
v_lshlrev_b32 v218, 16, v15
v_mfma_f32_16x16x32_bf16 a[208:211], a[240:243], a[128:131], a[208:211]
ds_read_b64_tr_b16 a[230:231], v20 offset:63488
buffer_load_dwordx4 a[164:167], v1, s[24:27], s54 offen offset:1024 sc1
v_and_b32 v219, 0xffff0000, v15
v_lshlrev_b32 v220, 16, v58
v_mfma_f32_16x16x32_bf16 a[208:211], a[244:247], a[136:139], a[208:211]
ds_read_b64_tr_b16 a[232:233], v21 offset:57344
v_and_b32 v221, 0xffff0000, v58
v_lshlrev_b32 v222, 16, v59
v_and_b32 v223, 0xffff0000, v59
v_mfma_f32_16x16x32_bf16 a[212:215], a[244:247], a[140:143], a[212:215]
ds_read_b64_tr_b16 a[234:235], v21 offset:59392
ds_read_b64_tr_b16 a[236:237], v21 offset:61440
v_mfma_f32_16x16x32_bf16 a[212:215], a[240:243], a[132:135], a[212:215]
s_waitcnt lgkmcnt(7)
buffer_load_dwordx4 a[168:171], v1, s[24:27], s54 offen offset:2048 sc1
v_mfma_f32_16x16x32_bf16 a[220:223], a[248:251], a[132:135], a[220:223]
ds_read_b64_tr_b16 a[238:239], v21 offset:63488
ds_read_b64_tr_b16 a[240:241], v22 offset:57344
v_mfma_f32_16x16x32_bf16 a[220:223], a[252:255], a[140:143], a[220:223]
ds_read_b64_tr_b16 a[242:243], v22 offset:59392
v_mfma_f32_16x16x32_bf16 a[216:219], a[252:255], a[136:139], a[216:219]
ds_read_b64_tr_b16 a[244:245], v22 offset:61440
v_mfma_f32_16x16x32_bf16 a[216:219], a[248:251], a[128:131], a[216:219]
s_waitcnt lgkmcnt(7)
buffer_load_dwordx4 a[172:175], v1, s[24:27], s54 offen offset:3072 sc1
v_mfma_f32_16x16x32_bf16 a[192:195], a[224:227], a[144:147], a[192:195]
ds_read_b64_tr_b16 a[246:247], v22 offset:63488
ds_read_b64_tr_b16 a[248:249], v23 offset:57344
v_mfma_f32_16x16x32_bf16 a[192:195], a[228:231], a[152:155], a[192:195]
ds_read_b64_tr_b16 a[250:251], v23 offset:59392
v_mfma_f32_16x16x32_bf16 a[196:199], a[228:231], a[156:159], a[196:199]
ds_read_b64_tr_b16 a[252:253], v23 offset:61440
v_mfma_f32_16x16x32_bf16 a[196:199], a[224:227], a[148:151], a[196:199]
s_waitcnt lgkmcnt(7)
ds_read_b64_tr_b16 a[254:255], v23 offset:63488
v_mfma_f32_16x16x32_bf16 a[204:207], a[232:235], a[148:151], a[204:207]
buffer_load_dwordx4 a[176:179], v2, s[24:27], s54 offen offset:0 sc1
v_mfma_f32_16x16x32_bf16 a[204:207], a[236:239], a[156:159], a[204:207]
ds_read_b64_tr_b16 a[224:225], v24 offset:0
ds_read_b64_tr_b16 a[226:227], v24 offset:2048
v_mfma_f32_16x16x32_bf16 a[200:203], a[236:239], a[152:155], a[200:203]
ds_read_b64_tr_b16 a[228:229], v24 offset:4096
v_mfma_f32_16x16x32_bf16 a[200:203], a[232:235], a[144:147], a[200:203]
s_waitcnt lgkmcnt(7)
ds_read_b64_tr_b16 a[230:231], v24 offset:6144
v_mfma_f32_16x16x32_bf16 a[208:211], a[240:243], a[144:147], a[208:211]
buffer_load_dwordx4 a[180:183], v2, s[24:27], s54 offen offset:1024 sc1
v_mfma_f32_16x16x32_bf16 a[208:211], a[244:247], a[152:155], a[208:211]
ds_read_b64_tr_b16 a[232:233], v25 offset:0
ds_read_b64_tr_b16 a[234:235], v25 offset:2048
v_mfma_f32_16x16x32_bf16 a[212:215], a[244:247], a[156:159], a[212:215]
ds_read_b64_tr_b16 a[236:237], v25 offset:4096
v_mfma_f32_16x16x32_bf16 a[212:215], a[240:243], a[148:151], a[212:215]
s_waitcnt lgkmcnt(7)
ds_read_b64_tr_b16 a[238:239], v25 offset:6144
v_mfma_f32_16x16x32_bf16 a[220:223], a[248:251], a[148:151], a[220:223]
ds_read_b64_tr_b16 a[240:241], v26 offset:0
v_mfma_f32_16x16x32_bf16 a[220:223], a[252:255], a[156:159], a[220:223]
buffer_load_dwordx4 a[184:187], v2, s[24:27], s54 offen offset:2048 sc1
v_mfma_f32_16x16x32_bf16 a[216:219], a[252:255], a[152:155], a[216:219]
ds_read_b64_tr_b16 a[242:243], v26 offset:2048
ds_read_b64_tr_b16 a[244:245], v26 offset:4096
v_mfma_f32_16x16x32_bf16 a[216:219], a[248:251], a[144:147], a[216:219]
s_waitcnt lgkmcnt(7)
ds_read_b64_tr_b16 a[246:247], v26 offset:6144
v_mfma_f32_16x16x32_bf16 v[64:67], a[224:227], a[144:147], v[64:67]
ds_read_b64_tr_b16 a[248:249], v27 offset:0
v_mfma_f32_16x16x32_bf16 v[64:67], a[228:231], a[152:155], v[64:67]
buffer_load_dwordx4 a[188:191], v2, s[24:27], s54 offen offset:3072 sc1
v_mfma_f32_16x16x32_bf16 v[68:71], a[228:231], a[156:159], v[68:71]
s_bfe_u32 s55, 0x19191717, s64
ds_read_b64_tr_b16 a[250:251], v27 offset:2048
ds_read_b64_tr_b16 a[252:253], v27 offset:4096
v_mfma_f32_16x16x32_bf16 v[68:71], a[224:227], a[148:151], v[68:71]
s_waitcnt vmcnt(45) lgkmcnt(7)
s_barrier
v_mfma_f32_16x16x32_bf16 v[76:79], a[232:235], a[148:151], v[76:79]
s_lshl_b32 s55, s55, 18
ds_read_b64_tr_b16 a[254:255], v27 offset:6144
ds_read_b64_tr_b16 a[224:225], v24 offset:8192
v_mfma_f32_16x16x32_bf16 v[76:79], a[236:239], a[156:159], v[76:79]
s_or_b32 s55, s55, 128
ds_read_b64_tr_b16 a[226:227], v24 offset:10240
s_xor_b32 s55, s55, 128
v_mfma_f32_16x16x32_bf16 v[72:75], a[236:239], a[152:155], v[72:75]
s_add_u32 m0, s52, 16384
ds_read_b64_tr_b16 a[228:229], v24 offset:12288
v_mfma_f32_16x16x32_bf16 v[72:75], a[232:235], a[144:147], v[72:75]
s_waitcnt lgkmcnt(7)
buffer_load_dwordx4 v28, s[40:43], s55 offen offset:0 lds
v_mfma_f32_16x16x32_bf16 v[80:83], a[240:243], a[144:147], v[80:83]
ds_read_b64_tr_b16 a[230:231], v24 offset:14336
ds_read_b64_tr_b16 a[232:233], v25 offset:8192
v_mfma_f32_16x16x32_bf16 v[80:83], a[244:247], a[152:155], v[80:83]
ds_read_b64_tr_b16 a[234:235], v25 offset:10240
v_mfma_f32_16x16x32_bf16 v[84:87], a[244:247], a[156:159], v[84:87]
buffer_load_dwordx4 v29, s[40:43], s55 offen offset:1024 lds
v_mfma_f32_16x16x32_bf16 v[84:87], a[240:243], a[148:151], v[84:87]
s_waitcnt lgkmcnt(6)
ds_read_b64_tr_b16 a[236:237], v25 offset:12288
ds_read_b64_tr_b16 a[238:239], v25 offset:14336
v_mfma_f32_16x16x32_bf16 v[92:95], a[248:251], a[148:151], v[92:95]
s_xor_b32 s55, s55, 131072
ds_read_b64_tr_b16 a[240:241], v26 offset:8192
s_add_u32 m0, s52, 24576
v_mfma_f32_16x16x32_bf16 v[92:95], a[252:255], a[156:159], v[92:95]
ds_read_b64_tr_b16 a[242:243], v26 offset:10240
v_mfma_f32_16x16x32_bf16 v[88:91], a[252:255], a[152:155], v[88:91]
buffer_load_dwordx4 v28, s[40:43], s55 offen offset:0 lds
v_mfma_f32_16x16x32_bf16 v[88:91], a[248:251], a[144:147], v[88:91]
s_waitcnt vmcnt(32) lgkmcnt(6)
ds_read_b64_tr_b16 a[244:245], v26 offset:12288
ds_read_b64_tr_b16 a[246:247], v26 offset:14336
v_mfma_f32_16x16x32_bf16 a[192:195], a[224:227], a[0:3], a[192:195]
ds_read_b64_tr_b16 a[248:249], v27 offset:8192
v_mfma_f32_16x16x32_bf16 a[192:195], a[228:231], a[8:11], a[192:195]
ds_read_b64_tr_b16 a[250:251], v27 offset:10240
v_mfma_f32_16x16x32_bf16 a[196:199], a[228:231], a[12:15], a[196:199]
ds_read_b64_tr_b16 a[252:253], v27 offset:12288
v_mfma_f32_16x16x32_bf16 a[196:199], a[224:227], a[4:7], a[196:199]
s_waitcnt lgkmcnt(7)
buffer_load_dwordx4 v29, s[40:43], s55 offen offset:1024 lds
v_mfma_f32_16x16x32_bf16 a[204:207], a[232:235], a[4:7], a[204:207]
s_bfe_u32 s55, 0x1b1b191b, s64
ds_read_b64_tr_b16 a[254:255], v27 offset:14336
ds_read_b64_tr_b16 a[224:225], v24 offset:16384
v_mfma_f32_16x16x32_bf16 a[204:207], a[236:239], a[12:15], a[204:207]
s_lshl_b32 s55, s55, 18
ds_read_b64_tr_b16 a[226:227], v24 offset:18432
s_or_b32 s55, s55, 128
v_mfma_f32_16x16x32_bf16 a[200:203], a[236:239], a[8:11], a[200:203]
s_xor_b32 s55, s55, 128
ds_read_b64_tr_b16 a[228:229], v24 offset:20480
s_add_u32 m0, s52, 32768
v_mfma_f32_16x16x32_bf16 a[200:203], a[232:235], a[0:3], a[200:203]
s_waitcnt lgkmcnt(7)
buffer_load_dwordx4 v28, s[40:43], s55 offen offset:0 lds
v_mfma_f32_16x16x32_bf16 a[208:211], a[240:243], a[0:3], a[208:211]
ds_read_b64_tr_b16 a[230:231], v24 offset:22528
ds_read_b64_tr_b16 a[232:233], v25 offset:16384
v_mfma_f32_16x16x32_bf16 a[208:211], a[244:247], a[8:11], a[208:211]
ds_read_b64_tr_b16 a[234:235], v25 offset:18432
v_mfma_f32_16x16x32_bf16 a[212:215], a[244:247], a[12:15], a[212:215]
ds_read_b64_tr_b16 a[236:237], v25 offset:20480
v_mfma_f32_16x16x32_bf16 a[212:215], a[240:243], a[4:7], a[212:215]
s_waitcnt lgkmcnt(7)
ds_read_b64_tr_b16 a[238:239], v25 offset:22528
v_mfma_f32_16x16x32_bf16 a[220:223], a[248:251], a[4:7], a[220:223]
buffer_load_dwordx4 v29, s[40:43], s55 offen offset:1024 lds
v_mfma_f32_16x16x32_bf16 a[220:223], a[252:255], a[12:15], a[220:223]
s_xor_b32 s55, s55, 131072
ds_read_b64_tr_b16 a[240:241], v26 offset:16384
ds_read_b64_tr_b16 a[242:243], v26 offset:18432
v_mfma_f32_16x16x32_bf16 a[216:219], a[252:255], a[8:11], a[216:219]
s_add_u32 m0, s52, 40960
ds_read_b64_tr_b16 a[244:245], v26 offset:20480
v_mfma_f32_16x16x32_bf16 a[216:219], a[248:251], a[0:3], a[216:219]
s_waitcnt lgkmcnt(7)
ds_read_b64_tr_b16 a[246:247], v26 offset:22528
v_mfma_f32_16x16x32_bf16 a[192:195], a[224:227], a[16:19], a[192:195]
buffer_load_dwordx4 v28, s[40:43], s55 offen offset:0 lds
v_mfma_f32_16x16x32_bf16 a[192:195], a[228:231], a[24:27], a[192:195]
ds_read_b64_tr_b16 a[248:249], v27 offset:16384
ds_read_b64_tr_b16 a[250:251], v27 offset:18432
v_mfma_f32_16x16x32_bf16 a[196:199], a[228:231], a[28:31], a[196:199]
ds_read_b64_tr_b16 a[252:253], v27 offset:20480
v_mfma_f32_16x16x32_bf16 a[196:199], a[224:227], a[20:23], a[196:199]
s_waitcnt lgkmcnt(7)
ds_read_b64_tr_b16 a[254:255], v27 offset:22528
v_mfma_f32_16x16x32_bf16 a[204:207], a[232:235], a[20:23], a[204:207]
ds_read_b64_tr_b16 a[224:225], v20 offset:0
v_mfma_f32_16x16x32_bf16 a[204:207], a[236:239], a[28:31], a[204:207]
buffer_load_dwordx4 v29, s[40:43], s55 offen offset:1024 lds
v_mfma_f32_16x16x32_bf16 a[200:203], a[236:239], a[24:27], a[200:203]
s_bfe_u32 s54, 0x19191717, s64
ds_read_b64_tr_b16 a[226:227], v20 offset:2048
ds_read_b64_tr_b16 a[228:229], v20 offset:4096
v_mfma_f32_16x16x32_bf16 a[200:203], a[232:235], a[16:19], a[200:203]
s_waitcnt lgkmcnt(7)
ds_read_b64_tr_b16 a[230:231], v20 offset:6144
s_lshl_b32 s54, s54, 13
v_mfma_f32_16x16x32_bf16 a[208:211], a[240:243], a[16:19], a[208:211]
s_add_u32 s54, s54, s63
ds_read_b64_tr_b16 a[232:233], v21 offset:0
v_mfma_f32_16x16x32_bf16 a[208:211], a[244:247], a[24:27], a[208:211]
buffer_load_dwordx4 a[128:131], v1, s[24:27], s54 offen offset:0 sc1
v_mfma_f32_16x16x32_bf16 a[212:215], a[244:247], a[28:31], a[212:215]
ds_read_b64_tr_b16 a[234:235], v21 offset:2048
ds_read_b64_tr_b16 a[236:237], v21 offset:4096
v_mfma_f32_16x16x32_bf16 a[212:215], a[240:243], a[20:23], a[212:215]
s_waitcnt lgkmcnt(7)
ds_read_b64_tr_b16 a[238:239], v21 offset:6144
v_mfma_f32_16x16x32_bf16 a[220:223], a[248:251], a[20:23], a[220:223]
ds_read_b64_tr_b16 a[240:241], v22 offset:0
v_mfma_f32_16x16x32_bf16 a[220:223], a[252:255], a[28:31], a[220:223]
ds_read_b64_tr_b16 a[242:243], v22 offset:2048
v_mfma_f32_16x16x32_bf16 a[216:219], a[252:255], a[24:27], a[216:219]
buffer_load_dwordx4 a[132:135], v1, s[24:27], s54 offen offset:1024 sc1
v_mfma_f32_16x16x32_bf16 a[216:219], a[248:251], a[16:19], a[216:219]
s_waitcnt vmcnt(30) lgkmcnt(6)
ds_read_b64_tr_b16 a[244:245], v22 offset:4096
ds_read_b64_tr_b16 a[246:247], v22 offset:6144
v_mfma_f32_16x16x32_bf16 a[192:195], a[224:227], a[32:35], a[192:195]
ds_read_b64_tr_b16 a[248:249], v23 offset:0
v_mfma_f32_16x16x32_bf16 a[192:195], a[228:231], a[40:43], a[192:195]
ds_read_b64_tr_b16 a[250:251], v23 offset:2048
v_mfma_f32_16x16x32_bf16 a[196:199], a[228:231], a[44:47], a[196:199]
buffer_load_dwordx4 a[136:139], v1, s[24:27], s54 offen offset:2048 sc1
v_mfma_f32_16x16x32_bf16 a[196:199], a[224:227], a[36:39], a[196:199]
s_waitcnt lgkmcnt(6)
ds_read_b64_tr_b16 a[252:253], v23 offset:4096
ds_read_b64_tr_b16 a[254:255], v23 offset:6144
v_mfma_f32_16x16x32_bf16 a[204:207], a[232:235], a[36:39], a[204:207]
ds_read_b64_tr_b16 a[224:225], v20 offset:8192
v_mfma_f32_16x16x32_bf16 a[204:207], a[236:239], a[44:47], a[204:207]
ds_read_b64_tr_b16 a[226:227], v20 offset:10240
v_mfma_f32_16x16x32_bf16 a[200:203], a[236:239], a[40:43], a[200:203]
ds_read_b64_tr_b16 a[228:229], v20 offset:12288
v_mfma_f32_16x16x32_bf16 a[200:203], a[232:235], a[32:35], a[200:203]
s_waitcnt lgkmcnt(7)
buffer_load_dwordx4 a[140:143], v1, s[24:27], s54 offen offset:3072 sc1
v_mfma_f32_16x16x32_bf16 a[208:211], a[240:243], a[32:35], a[208:211]
ds_read_b64_tr_b16 a[230:231], v20 offset:14336
ds_read_b64_tr_b16 a[232:233], v21 offset:8192
v_mfma_f32_16x16x32_bf16 a[208:211], a[244:247], a[40:43], a[208:211]
ds_read_b64_tr_b16 a[234:235], v21 offset:10240
v_mfma_f32_16x16x32_bf16 a[212:215], a[244:247], a[44:47], a[212:215]
ds_read_b64_tr_b16 a[236:237], v21 offset:12288
v_mfma_f32_16x16x32_bf16 a[212:215], a[240:243], a[36:39], a[212:215]
s_waitcnt lgkmcnt(7)
buffer_load_dwordx4 a[144:147], v2, s[24:27], s54 offen offset:0 sc1
v_mfma_f32_16x16x32_bf16 a[220:223], a[248:251], a[36:39], a[220:223]
ds_read_b64_tr_b16 a[238:239], v21 offset:14336
ds_read_b64_tr_b16 a[240:241], v22 offset:8192
v_mfma_f32_16x16x32_bf16 a[220:223], a[252:255], a[44:47], a[220:223]
ds_read_b64_tr_b16 a[242:243], v22 offset:10240
v_mfma_f32_16x16x32_bf16 a[216:219], a[252:255], a[40:43], a[216:219]
s_load_dword s101, s[92:93], 61432
ds_read_b64_tr_b16 a[244:245], v22 offset:12288
v_mfma_f32_16x16x32_bf16 a[216:219], a[248:251], a[32:35], a[216:219]
s_waitcnt lgkmcnt(7)
ds_read_b64_tr_b16 a[246:247], v22 offset:14336
v_mfma_f32_16x16x32_bf16 a[192:195], a[224:227], a[48:51], a[192:195]
buffer_load_dwordx4 a[148:151], v2, s[24:27], s54 offen offset:1024 sc1
v_mfma_f32_16x16x32_bf16 a[192:195], a[228:231], a[56:59], a[192:195]
ds_read_b64_tr_b16 a[248:249], v23 offset:8192
ds_read_b64_tr_b16 a[250:251], v23 offset:10240
v_mfma_f32_16x16x32_bf16 a[196:199], a[228:231], a[60:63], a[196:199]
ds_read_b64_tr_b16 a[252:253], v23 offset:12288
v_mfma_f32_16x16x32_bf16 a[196:199], a[224:227], a[52:55], a[196:199]
s_waitcnt vmcnt(30) lgkmcnt(7)
s_barrier
v_mfma_f32_16x16x32_bf16 a[204:207], a[232:235], a[52:55], a[204:207]
buffer_load_dwordx4 a[152:155], v2, s[24:27], s54 offen offset:2048 sc1
v_mfma_f32_16x16x32_bf16 a[204:207], a[236:239], a[60:63], a[204:207]
ds_read_b64_tr_b16 a[254:255], v23 offset:14336
ds_read_b64_tr_b16 a[224:225], v20 offset:16384
v_mfma_f32_16x16x32_bf16 a[200:203], a[236:239], a[56:59], a[200:203]
ds_read_b64_tr_b16 a[226:227], v20 offset:18432
ds_read_b64_tr_b16 a[228:229], v20 offset:20480
v_mfma_f32_16x16x32_bf16 a[200:203], a[232:235], a[48:51], a[200:203]
s_waitcnt lgkmcnt(7)
ds_read_b64_tr_b16 a[230:231], v20 offset:22528
v_mfma_f32_16x16x32_bf16 a[208:211], a[240:243], a[48:51], a[208:211]
buffer_load_dwordx4 a[156:159], v2, s[24:27], s54 offen offset:3072 sc1
v_mfma_f32_16x16x32_bf16 a[208:211], a[244:247], a[56:59], a[208:211]
s_bfe_u32 s54, 0x1b1b191b, s64
ds_read_b64_tr_b16 a[232:233], v21 offset:16384
ds_read_b64_tr_b16 a[234:235], v21 offset:18432
v_mfma_f32_16x16x32_bf16 a[212:215], a[244:247], a[60:63], a[212:215]
s_lshl_b32 s54, s54, 13
ds_read_b64_tr_b16 a[236:237], v21 offset:20480
s_add_u32 s54, s54, s63
v_mfma_f32_16x16x32_bf16 a[212:215], a[240:243], a[52:55], a[212:215]
s_waitcnt lgkmcnt(7)
ds_read_b64_tr_b16 a[238:239], v21 offset:22528
v_mfma_f32_16x16x32_bf16 a[220:223], a[248:251], a[52:55], a[220:223]
ds_read_b64_tr_b16 a[240:241], v22 offset:16384
v_mfma_f32_16x16x32_bf16 a[220:223], a[252:255], a[60:63], a[220:223]
buffer_load_dwordx4 a[96:99], v1, s[24:27], s54 offen offset:0 sc1
v_mfma_f32_16x16x32_bf16 a[216:219], a[252:255], a[56:59], a[216:219]
ds_read_b64_tr_b16 a[242:243], v22 offset:18432
ds_read_b64_tr_b16 a[244:245], v22 offset:20480
v_mfma_f32_16x16x32_bf16 a[216:219], a[248:251], a[48:51], a[216:219]
s_waitcnt vmcnt(25) lgkmcnt(7)
ds_read_b64_tr_b16 a[246:247], v22 offset:22528
v_mfma_f32_16x16x32_bf16 a[192:195], a[224:227], a[64:67], a[192:195]
ds_read_b64_tr_b16 a[248:249], v23 offset:16384
v_mfma_f32_16x16x32_bf16 a[192:195], a[228:231], a[72:75], a[192:195]
buffer_load_dwordx4 a[100:103], v1, s[24:27], s54 offen offset:1024 sc1
v_mfma_f32_16x16x32_bf16 a[196:199], a[228:231], a[76:79], a[196:199]
ds_read_b64_tr_b16 a[250:251], v23 offset:18432
ds_read_b64_tr_b16 a[252:253], v23 offset:20480
v_mfma_f32_16x16x32_bf16 a[196:199], a[224:227], a[68:71], a[196:199]
s_waitcnt lgkmcnt(7)
ds_read_b64_tr_b16 a[254:255], v23 offset:22528
v_mfma_f32_16x16x32_bf16 a[204:207], a[232:235], a[68:71], a[204:207]
ds_read_b64_tr_b16 a[224:225], v20 offset:24576
v_mfma_f32_16x16x32_bf16 a[204:207], a[236:239], a[76:79], a[204:207]
ds_read_b64_tr_b16 a[226:227], v20 offset:26624
v_mfma_f32_16x16x32_bf16 a[200:203], a[236:239], a[72:75], a[200:203]
buffer_load_dwordx4 a[104:107], v1, s[24:27], s54 offen offset:2048 sc1
v_mfma_f32_16x16x32_bf16 a[200:203], a[232:235], a[64:67], a[200:203]
s_waitcnt lgkmcnt(6)
ds_read_b64_tr_b16 a[228:229], v20 offset:28672
ds_read_b64_tr_b16 a[230:231], v20 offset:30720
v_mfma_f32_16x16x32_bf16 a[208:211], a[240:243], a[64:67], a[208:211]
ds_read_b64_tr_b16 a[232:233], v21 offset:24576
v_mfma_f32_16x16x32_bf16 a[208:211], a[244:247], a[72:75], a[208:211]
ds_read_b64_tr_b16 a[234:235], v21 offset:26624
v_mfma_f32_16x16x32_bf16 a[212:215], a[244:247], a[76:79], a[212:215]
buffer_load_dwordx4 a[108:111], v1, s[24:27], s54 offen offset:3072 sc1
v_mfma_f32_16x16x32_bf16 a[212:215], a[240:243], a[68:71], a[212:215]
s_waitcnt lgkmcnt(6)
ds_read_b64_tr_b16 a[236:237], v21 offset:28672
ds_read_b64_tr_b16 a[238:239], v21 offset:30720
v_mfma_f32_16x16x32_bf16 a[220:223], a[248:251], a[68:71], a[220:223]
ds_read_b64_tr_b16 a[240:241], v22 offset:24576
v_mfma_f32_16x16x32_bf16 a[220:223], a[252:255], a[76:79], a[220:223]
ds_read_b64_tr_b16 a[242:243], v22 offset:26624
v_mfma_f32_16x16x32_bf16 a[216:219], a[252:255], a[72:75], a[216:219]
ds_read_b64_tr_b16 a[244:245], v22 offset:28672
v_mfma_f32_16x16x32_bf16 a[216:219], a[248:251], a[64:67], a[216:219]
s_waitcnt lgkmcnt(7)
buffer_load_dwordx4 a[112:115], v2, s[24:27], s54 offen offset:0 sc1
v_mfma_f32_16x16x32_bf16 a[192:195], a[224:227], a[80:83], a[192:195]
ds_read_b64_tr_b16 a[246:247], v22 offset:30720
ds_read_b64_tr_b16 a[248:249], v23 offset:24576
v_mfma_f32_16x16x32_bf16 a[192:195], a[228:231], a[88:91], a[192:195]
ds_read_b64_tr_b16 a[250:251], v23 offset:26624
v_mfma_f32_16x16x32_bf16 a[196:199], a[228:231], a[92:95], a[196:199]
ds_read_b64_tr_b16 a[252:253], v23 offset:28672
v_mfma_f32_16x16x32_bf16 a[196:199], a[224:227], a[84:87], a[196:199]
s_waitcnt lgkmcnt(7)
buffer_load_dwordx4 a[116:119], v2, s[24:27], s54 offen offset:1024 sc1
v_mfma_f32_16x16x32_bf16 a[204:207], a[232:235], a[84:87], a[204:207]
ds_read_b64_tr_b16 a[254:255], v23 offset:30720
ds_read_b64_tr_b16 a[224:225], v16 offset:0
v_mfma_f32_16x16x32_bf16 a[204:207], a[236:239], a[92:95], a[204:207]
ds_read_b64_tr_b16 a[226:227], v16 offset:2048
v_mfma_f32_16x16x32_bf16 a[200:203], a[236:239], a[88:91], a[200:203]
ds_read_b64_tr_b16 a[228:229], v16 offset:4096
v_mfma_f32_16x16x32_bf16 a[200:203], a[232:235], a[80:83], a[200:203]
s_waitcnt lgkmcnt(7)
ds_read_b64_tr_b16 a[230:231], v16 offset:6144
v_mfma_f32_16x16x32_bf16 a[208:211], a[240:243], a[80:83], a[208:211]
buffer_load_dwordx4 a[120:123], v2, s[24:27], s54 offen offset:2048 sc1
v_mfma_f32_16x16x32_bf16 a[208:211], a[244:247], a[88:91], a[208:211]
ds_read_b64_tr_b16 a[232:233], v17 offset:0
ds_read_b64_tr_b16 a[234:235], v17 offset:2048
v_mfma_f32_16x16x32_bf16 a[212:215], a[244:247], a[92:95], a[212:215]
ds_read_b64_tr_b16 a[236:237], v17 offset:4096
v_mfma_f32_16x16x32_bf16 a[212:215], a[240:243], a[84:87], a[212:215]
s_waitcnt lgkmcnt(7)
ds_read_b64_tr_b16 a[238:239], v17 offset:6144
v_mfma_f32_16x16x32_bf16 a[220:223], a[248:251], a[84:87], a[220:223]
buffer_load_dwordx4 a[124:127], v2, s[24:27], s54 offen offset:3072 sc1
v_mfma_f32_16x16x32_bf16 a[220:223], a[252:255], a[92:95], a[220:223]
s_bfe_u32 s55, 0x11151311, s64
ds_read_b64_tr_b16 a[240:241], v18 offset:0
ds_read_b64_tr_b16 a[242:243], v18 offset:2048
v_mfma_f32_16x16x32_bf16 a[216:219], a[252:255], a[88:91], a[216:219]
s_lshl_b32 s55, s55, 18
ds_read_b64_tr_b16 a[244:245], v18 offset:4096
s_or_b32 s55, s55, 128
v_mfma_f32_16x16x32_bf16 a[216:219], a[248:251], a[80:83], a[216:219]
s_waitcnt vmcnt(24) lgkmcnt(7)
buffer_load_dword v33, v31, s[24:27], s62 offen offset:256 sc1
v_mfma_f32_16x16x32_bf16 a[192:195], a[224:227], a[160:163], a[192:195]
s_add_u32 m0, s52, 49152
ds_read_b64_tr_b16 a[246:247], v18 offset:6144
ds_read_b64_tr_b16 a[248:249], v19 offset:0
v_mfma_f32_16x16x32_bf16 a[192:195], a[228:231], a[168:171], a[192:195]
buffer_load_dwordx4 v28, s[40:43], s55 offen offset:0 lds
v_mfma_f32_16x16x32_bf16 a[196:199], a[228:231], a[172:175], a[196:199]
ds_read_b64_tr_b16 a[250:251], v19 offset:2048
ds_read_b64_tr_b16 a[252:253], v19 offset:4096
v_mfma_f32_16x16x32_bf16 a[196:199], a[224:227], a[164:167], a[196:199]
s_waitcnt lgkmcnt(7)
ds_read_b64_tr_b16 a[254:255], v19 offset:6144
v_mfma_f32_16x16x32_bf16 a[204:207], a[232:235], a[164:167], a[204:207]
ds_read_b64_tr_b16 a[224:225], v16 offset:8192
v_mfma_f32_16x16x32_bf16 a[204:207], a[236:239], a[172:175], a[204:207]
ds_read_b64_tr_b16 a[226:227], v16 offset:10240
v_mfma_f32_16x16x32_bf16 a[200:203], a[236:239], a[168:171], a[200:203]
buffer_load_dwordx4 v29, s[40:43], s55 offen offset:1024 lds
v_mfma_f32_16x16x32_bf16 a[200:203], a[232:235], a[160:163], a[200:203]
s_waitcnt lgkmcnt(6)
ds_read_b64_tr_b16 a[228:229], v16 offset:12288
ds_read_b64_tr_b16 a[230:231], v16 offset:14336
v_mfma_f32_16x16x32_bf16 a[208:211], a[240:243], a[160:163], a[208:211]
s_xor_b32 s55, s55, 131072
ds_read_b64_tr_b16 a[232:233], v17 offset:8192
s_add_u32 m0, s52, 57344
v_mfma_f32_16x16x32_bf16 a[208:211], a[244:247], a[168:171], a[208:211]
ds_read_b64_tr_b16 a[234:235], v17 offset:10240
v_mfma_f32_16x16x32_bf16 a[212:215], a[244:247], a[172:175], a[212:215]
buffer_load_dwordx4 v28, s[40:43], s55 offen offset:0 lds
v_mfma_f32_16x16x32_bf16 a[212:215], a[240:243], a[164:167], a[212:215]
s_waitcnt lgkmcnt(6)
ds_read_b64_tr_b16 a[236:237], v17 offset:12288
ds_read_b64_tr_b16 a[238:239], v17 offset:14336
v_mfma_f32_16x16x32_bf16 a[220:223], a[248:251], a[164:167], a[220:223]
ds_read_b64_tr_b16 a[240:241], v18 offset:8192
v_mfma_f32_16x16x32_bf16 a[220:223], a[252:255], a[172:175], a[220:223]
ds_read_b64_tr_b16 a[242:243], v18 offset:10240
v_mfma_f32_16x16x32_bf16 a[216:219], a[252:255], a[168:171], a[216:219]
ds_read_b64_tr_b16 a[244:245], v18 offset:12288
v_mfma_f32_16x16x32_bf16 a[216:219], a[248:251], a[160:163], a[216:219]
s_waitcnt lgkmcnt(7)
buffer_load_dwordx4 v29, s[40:43], s55 offen offset:1024 lds
v_mfma_f32_16x16x32_bf16 a[192:195], a[224:227], a[176:179], a[192:195]
s_bfe_u32 s55, 0x17111113, s64
ds_read_b64_tr_b16 a[246:247], v18 offset:14336
ds_read_b64_tr_b16 a[248:249], v19 offset:8192
v_mfma_f32_16x16x32_bf16 a[192:195], a[228:231], a[184:187], a[192:195]
s_lshl_b32 s55, s55, 18
ds_read_b64_tr_b16 a[250:251], v19 offset:10240
s_or_b32 s55, s55, 128
v_mfma_f32_16x16x32_bf16 a[196:199], a[228:231], a[188:191], a[196:199]
s_add_u32 m0, s52, 98304
ds_read_b64_tr_b16 a[252:253], v19 offset:12288
v_mfma_f32_16x16x32_bf16 a[196:199], a[224:227], a[180:183], a[196:199]
s_waitcnt vmcnt(21) lgkmcnt(7)
s_barrier
v_mfma_f32_16x16x32_bf16 a[204:207], a[232:235], a[180:183], a[204:207]
buffer_load_dwordx4 v28, s[40:43], s55 offen offset:0 lds
v_mfma_f32_16x16x32_bf16 a[204:207], a[236:239], a[188:191], a[204:207]
ds_read_b64_tr_b16 a[254:255], v19 offset:14336
ds_read_b64_tr_b16 a[224:225], v16 offset:16384
v_mfma_f32_16x16x32_bf16 a[200:203], a[236:239], a[184:187], a[200:203]
ds_read_b64_tr_b16 a[226:227], v16 offset:18432
ds_read_b64_tr_b16 a[228:229], v16 offset:20480
v_mfma_f32_16x16x32_bf16 a[200:203], a[232:235], a[176:179], a[200:203]
s_waitcnt lgkmcnt(7)
buffer_load_dwordx4 v29, s[40:43], s55 offen offset:1024 lds
v_mfma_f32_16x16x32_bf16 a[208:211], a[240:243], a[176:179], a[208:211]
s_xor_b32 s55, s55, 131072
ds_read_b64_tr_b16 a[230:231], v16 offset:22528
ds_read_b64_tr_b16 a[232:233], v17 offset:16384
v_mfma_f32_16x16x32_bf16 a[208:211], a[244:247], a[184:187], a[208:211]
s_add_u32 m0, s52, 106496
ds_read_b64_tr_b16 a[234:235], v17 offset:18432
v_mfma_f32_16x16x32_bf16 a[212:215], a[244:247], a[188:191], a[212:215]
ds_read_b64_tr_b16 a[236:237], v17 offset:20480
v_mfma_f32_16x16x32_bf16 a[212:215], a[240:243], a[180:183], a[212:215]
s_waitcnt lgkmcnt(7)
buffer_load_dwordx4 v28, s[40:43], s55 offen offset:0 lds
v_mfma_f32_16x16x32_bf16 a[220:223], a[248:251], a[180:183], a[220:223]
ds_read_b64_tr_b16 a[238:239], v17 offset:22528
ds_read_b64_tr_b16 a[240:241], v18 offset:16384
v_mfma_f32_16x16x32_bf16 a[220:223], a[252:255], a[188:191], a[220:223]
ds_read_b64_tr_b16 a[242:243], v18 offset:18432
v_mfma_f32_16x16x32_bf16 a[216:219], a[252:255], a[184:187], a[216:219]
ds_read_b64_tr_b16 a[244:245], v18 offset:20480
v_mfma_f32_16x16x32_bf16 a[216:219], a[248:251], a[176:179], a[216:219]
s_waitcnt vmcnt(16) lgkmcnt(7)
ds_read_b64_tr_b16 a[246:247], v18 offset:22528
v_mfma_f32_16x16x32_bf16 a[192:195], a[224:227], a[128:131], a[192:195]
buffer_load_dwordx4 v29, s[40:43], s55 offen offset:1024 lds
v_mfma_f32_16x16x32_bf16 a[192:195], a[228:231], a[136:139], a[192:195]
s_bfe_u32 s55, 0x13131519, s64
ds_read_b64_tr_b16 a[248:249], v19 offset:16384
ds_read_b64_tr_b16 a[250:251], v19 offset:18432
v_mfma_f32_16x16x32_bf16 a[196:199], a[228:231], a[140:143], a[196:199]
s_lshl_b32 s55, s55, 18
ds_read_b64_tr_b16 a[252:253], v19 offset:20480
s_or_b32 s55, s55, 128
v_mfma_f32_16x16x32_bf16 a[196:199], a[224:227], a[132:135], a[196:199]
s_waitcnt lgkmcnt(7)
ds_read_b64_tr_b16 a[254:255], v19 offset:22528
s_add_u32 m0, s52, 114688
v_mfma_f32_16x16x32_bf16 a[204:207], a[232:235], a[132:135], a[204:207]
buffer_load_dwordx4 v28, s[40:43], s55 offen offset:0 lds
v_mfma_f32_16x16x32_bf16 a[204:207], a[236:239], a[140:143], a[204:207]
ds_read_b64_tr_b16 a[224:225], v16 offset:24576
ds_read_b64_tr_b16 a[226:227], v16 offset:26624
v_mfma_f32_16x16x32_bf16 a[200:203], a[236:239], a[136:139], a[200:203]
ds_read_b64_tr_b16 a[228:229], v16 offset:28672
v_mfma_f32_16x16x32_bf16 a[200:203], a[232:235], a[128:131], a[200:203]
s_waitcnt lgkmcnt(7)
ds_read_b64_tr_b16 a[230:231], v16 offset:30720
v_mfma_f32_16x16x32_bf16 a[208:211], a[240:243], a[128:131], a[208:211]
ds_read_b64_tr_b16 a[232:233], v17 offset:24576
v_mfma_f32_16x16x32_bf16 a[208:211], a[244:247], a[136:139], a[208:211]
buffer_load_dwordx4 v29, s[40:43], s55 offen offset:1024 lds
v_mfma_f32_16x16x32_bf16 a[212:215], a[244:247], a[140:143], a[212:215]
s_xor_b32 s55, s55, 131072
ds_read_b64_tr_b16 a[234:235], v17 offset:26624
ds_read_b64_tr_b16 a[236:237], v17 offset:28672
v_mfma_f32_16x16x32_bf16 a[212:215], a[240:243], a[132:135], a[212:215]
s_waitcnt lgkmcnt(7)
ds_read_b64_tr_b16 a[238:239], v17 offset:30720
s_add_u32 m0, s52, 122880
v_mfma_f32_16x16x32_bf16 a[220:223], a[248:251], a[132:135], a[220:223]
ds_read_b64_tr_b16 a[240:241], v18 offset:24576
v_mfma_f32_16x16x32_bf16 a[220:223], a[252:255], a[140:143], a[220:223]
buffer_load_dwordx4 v28, s[40:43], s55 offen offset:0 lds
v_mfma_f32_16x16x32_bf16 a[216:219], a[252:255], a[136:139], a[216:219]
ds_read_b64_tr_b16 a[242:243], v18 offset:26624
ds_read_b64_tr_b16 a[244:245], v18 offset:28672
v_mfma_f32_16x16x32_bf16 a[216:219], a[248:251], a[128:131], a[216:219]
s_waitcnt lgkmcnt(7)
ds_read_b64_tr_b16 a[246:247], v18 offset:30720
v_mfma_f32_16x16x32_bf16 a[192:195], a[224:227], a[144:147], a[192:195]
pg_14_b:
s_cbranch_execz pg_back0
ds_read_b64_tr_b16 a[248:249], v19 offset:24576
v_mfma_f32_16x16x32_bf16 a[192:195], a[228:231], a[152:155], a[192:195]
ds_read_b64_tr_b16 a[250:251], v19 offset:26624
v_mfma_f32_16x16x32_bf16 a[196:199], a[228:231], a[156:159], a[196:199]
buffer_load_dwordx4 v29, s[40:43], s55 offen offset:1024 lds
v_mfma_f32_16x16x32_bf16 a[196:199], a[224:227], a[148:151], a[196:199]
s_waitcnt lgkmcnt(6)
ds_read_b64_tr_b16 a[252:253], v19 offset:28672
ds_read_b64_tr_b16 a[254:255], v19 offset:30720
v_mfma_f32_16x16x32_bf16 a[204:207], a[232:235], a[148:151], a[204:207]
s_bfe_u32 s55, 0x15171b15, s64
ds_read_b64_tr_b16 a[224:225], v16 offset:32768
s_lshl_b32 s55, s55, 18
v_mfma_f32_16x16x32_bf16 a[204:207], a[236:239], a[156:159], a[204:207]
s_or_b32 s55, s55, 128
ds_read_b64_tr_b16 a[226:227], v16 offset:34816
s_add_u32 m0, s52, 131072
v_mfma_f32_16x16x32_bf16 a[200:203], a[236:239], a[152:155], a[200:203]
buffer_load_dwordx4 v28, s[40:43], s55 offen offset:0 lds
v_mfma_f32_16x16x32_bf16 a[200:203], a[232:235], a[144:147], a[200:203]
s_waitcnt lgkmcnt(6)
ds_read_b64_tr_b16 a[228:229], v16 offset:36864
ds_read_b64_tr_b16 a[230:231], v16 offset:38912
v_mfma_f32_16x16x32_bf16 a[208:211], a[240:243], a[144:147], a[208:211]
ds_read_b64_tr_b16 a[232:233], v17 offset:32768
v_mfma_f32_16x16x32_bf16 a[208:211], a[244:247], a[152:155], a[208:211]
ds_read_b64_tr_b16 a[234:235], v17 offset:34816
v_mfma_f32_16x16x32_bf16 a[212:215], a[244:247], a[156:159], a[212:215]
ds_read_b64_tr_b16 a[236:237], v17 offset:36864
v_mfma_f32_16x16x32_bf16 a[212:215], a[240:243], a[148:151], a[212:215]
s_waitcnt lgkmcnt(7)
buffer_load_dwordx4 v29, s[40:43], s55 offen offset:1024 lds
v_mfma_f32_16x16x32_bf16 a[220:223], a[248:251], a[148:151], a[220:223]
s_xor_b32 s55, s55, 131072
ds_read_b64_tr_b16 a[238:239], v17 offset:38912
ds_read_b64_tr_b16 a[240:241], v18 offset:32768
v_mfma_f32_16x16x32_bf16 a[220:223], a[252:255], a[156:159], a[220:223]
s_add_u32 m0, s52, 139264
ds_read_b64_tr_b16 a[242:243], v18 offset:34816
v_mfma_f32_16x16x32_bf16 a[216:219], a[252:255], a[152:155], a[216:219]
ds_read_b64_tr_b16 a[244:245], v18 offset:36864
v_mfma_f32_16x16x32_bf16 a[216:219], a[248:251], a[144:147], a[216:219]
s_waitcnt vmcnt(15) lgkmcnt(7)
buffer_load_dwordx4 v28, s[40:43], s55 offen offset:0 lds
v_mfma_f32_16x16x32_bf16 a[192:195], a[224:227], a[96:99], a[192:195]
ds_read_b64_tr_b16 a[246:247], v18 offset:38912
ds_read_b64_tr_b16 a[248:249], v19 offset:32768
v_mfma_f32_16x16x32_bf16 a[192:195], a[228:231], a[104:107], a[192:195]
s_waitcnt vmcnt(15)
ds_read_b64_tr_b16 a[250:251], v19 offset:34816
v_cmp_ne_u32 vcc, v33, v32
s_nop 0
s_cbranch_vccnz ckO_spin_b
ckO_ok_b:
v_mfma_f32_16x16x32_bf16 a[196:199], a[228:231], a[108:111], a[196:199]
s_mov_b32 s4, 0x7f000000
s_cmp_eq_u32 s2, 0
s_cselect_b32 s4, 50397184, s4
ds_read_b64_tr_b16 a[252:253], v19 offset:36864
v_mfma_f32_16x16x32_bf16 a[196:199], a[224:227], a[100:103], a[196:199]
s_waitcnt lgkmcnt(7)
buffer_load_dwordx4 v29, s[40:43], s55 offen offset:1024 lds
v_mfma_f32_16x16x32_bf16 a[204:207], a[232:235], a[100:103], a[204:207]
buffer_store_dword v32, v30, s[24:27], s4 offen sc1
ds_read_b64_tr_b16 a[254:255], v19 offset:38912
s_bfe_u32 s55, 0x19191717, s64
s_lshl_b32 s55, s55, 18
v_mfma_f32_16x16x32_bf16 a[204:207], a[236:239], a[108:111], a[204:207]
s_or_b32 s55, s55, 128
ds_read_b64_tr_b16 a[224:225], v16 offset:40960
ds_read_b64_tr_b16 a[226:227], v16 offset:43008
v_mfma_f32_16x16x32_bf16 a[200:203], a[236:239], a[104:107], a[200:203]
s_add_u32 m0, s52, 147456
ds_read_b64_tr_b16 a[228:229], v16 offset:45056
s_lshl_b32 s6, s2, 2
v_mfma_f32_16x16x32_bf16 a[200:203], a[232:235], a[96:99], a[200:203]
s_waitcnt lgkmcnt(7)
ds_read_b64_tr_b16 a[230:231], v16 offset:47104
s_add_u32 s6, s6, s32
v_mfma_f32_16x16x32_bf16 a[208:211], a[240:243], a[96:99], a[208:211]
buffer_load_dwordx4 v28, s[40:43], s55 offen offset:0 lds
v_mfma_f32_16x16x32_bf16 a[208:211], a[244:247], a[104:107], a[208:211]
s_lshl_b32 s7, s6, 7
ds_read_b64_tr_b16 a[232:233], v17 offset:40960
ds_read_b64_tr_b16 a[234:235], v17 offset:43008
v_mfma_f32_16x16x32_bf16 a[212:215], a[244:247], a[108:111], a[212:215]
s_add_u32 s7, s7, 50462720
ds_read_b64_tr_b16 a[236:237], v17 offset:45056
s_lshl_b32 s6, s6, 13
v_mfma_f32_16x16x32_bf16 a[212:215], a[240:243], a[100:103], a[212:215]
s_waitcnt lgkmcnt(7)
ds_read_b64_tr_b16 a[238:239], v17 offset:47104
s_add_u32 s6, s6, 41943040
v_mfma_f32_16x16x32_bf16 a[220:223], a[248:251], a[100:103], a[220:223]
buffer_load_dwordx4 v29, s[40:43], s55 offen offset:1024 lds
v_mfma_f32_16x16x32_bf16 a[220:223], a[252:255], a[108:111], a[220:223]
s_xor_b32 s55, s55, 131072
ds_read_b64_tr_b16 a[240:241], v18 offset:40960
ds_read_b64_tr_b16 a[242:243], v18 offset:43008
v_mfma_f32_16x16x32_bf16 a[216:219], a[252:255], a[104:107], a[216:219]
s_add_u32 m0, s52, 65536
ds_read_b64_tr_b16 a[244:245], v18 offset:45056
v_mfma_f32_16x16x32_bf16 a[216:219], a[248:251], a[96:99], a[216:219]
s_waitcnt lgkmcnt(7)
ds_read_b64_tr_b16 a[246:247], v18 offset:47104
v_mfma_f32_16x16x32_bf16 a[192:195], a[224:227], a[112:115], a[192:195]
buffer_load_dwordx4 v28, s[40:43], s55 offen offset:0 lds
v_mfma_f32_16x16x32_bf16 a[192:195], a[228:231], a[120:123], a[192:195]
ds_read_b64_tr_b16 a[248:249], v19 offset:40960
ds_read_b64_tr_b16 a[250:251], v19 offset:43008
v_mfma_f32_16x16x32_bf16 a[196:199], a[228:231], a[124:127], a[196:199]
ds_read_b64_tr_b16 a[252:253], v19 offset:45056
v_mfma_f32_16x16x32_bf16 a[196:199], a[224:227], a[116:119], a[196:199]
s_waitcnt vmcnt(12) lgkmcnt(7)
s_barrier
v_mfma_f32_16x16x32_bf16 a[204:207], a[232:235], a[116:119], a[204:207]
buffer_load_dwordx4 v29, s[40:43], s55 offen offset:1024 lds
v_mfma_f32_16x16x32_bf16 a[204:207], a[236:239], a[124:127], a[204:207]
s_bfe_u32 s55, 0x1b1b191b, s64
ds_read_b64_tr_b16 a[254:255], v19 offset:47104
ds_read_b64_tr_b16 a[224:225], v16 offset:49152
v_accvgpr_read_b32 v160, a192
v_accvgpr_read_b32 v161, a193
v_accvgpr_read_b32 v162, a194
v_mfma_f32_16x16x32_bf16 a[200:203], a[236:239], a[120:123], a[200:203]
s_lshl_b32 s55, s55, 18
ds_read_b64_tr_b16 a[226:227], v16 offset:51200
v_accvgpr_read_b32 v163, a195
v_accvgpr_read_b32 v164, a196
v_accvgpr_read_b32 v165, a197
v_accvgpr_read_b32 v166, a198
v_mfma_f32_16x16x32_bf16 a[200:203], a[232:235], a[112:115], a[200:203]
s_waitcnt lgkmcnt(6)
ds_read_b64_tr_b16 a[228:229], v16 offset:53248
s_or_b32 s55, s55, 128
v_accvgpr_read_b32 v167, a199
v_cvt_pk_bf16_f32 v160, v160, v161
v_cvt_pk_bf16_f32 v161, v162, v163
v_mfma_f32_16x16x32_bf16 a[208:211], a[240:243], a[112:115], a[208:211]
s_add_u32 m0, s52, 73728
ds_read_b64_tr_b16 a[230:231], v16 offset:55296
v_cvt_pk_bf16_f32 v162, v164, v165
v_cvt_pk_bf16_f32 v163, v166, v167
v_accvgpr_read_b32 v168, a200
v_accvgpr_read_b32 v169, a201
v_mfma_f32_16x16x32_bf16 a[208:211], a[244:247], a[120:123], a[208:211]
ds_read_b64_tr_b16 a[232:233], v17 offset:49152
buffer_load_dwordx4 v28, s[40:43], s55 offen offset:0 lds
v_accvgpr_read_b32 v170, a202
v_accvgpr_read_b32 v171, a203
v_mfma_f32_16x16x32_bf16 a[212:215], a[244:247], a[124:127], a[212:215]
ds_read_b64_tr_b16 a[234:235], v17 offset:51200
v_accvgpr_read_b32 v172, a204
v_accvgpr_read_b32 v173, a205
v_accvgpr_read_b32 v174, a206
v_accvgpr_read_b32 v175, a207
v_mfma_f32_16x16x32_bf16 a[212:215], a[240:243], a[116:119], a[212:215]
s_waitcnt lgkmcnt(6)
ds_read_b64_tr_b16 a[236:237], v17 offset:53248
buffer_load_dwordx4 v29, s[40:43], s55 offen offset:1024 lds
v_cvt_pk_bf16_f32 v168, v168, v169
v_cvt_pk_bf16_f32 v169, v170, v171
v_mfma_f32_16x16x32_bf16 a[220:223], a[248:251], a[116:119], a[220:223]
s_xor_b32 s55, s55, 131072
ds_read_b64_tr_b16 a[238:239], v17 offset:55296
v_cvt_pk_bf16_f32 v170, v172, v173
v_cvt_pk_bf16_f32 v171, v174, v175
v_accvgpr_read_b32 v176, a208
v_accvgpr_read_b32 v177, a209
v_mfma_f32_16x16x32_bf16 a[220:223], a[252:255], a[124:127], a[220:223]
s_add_u32 m0, s52, 81920
ds_read_b64_tr_b16 a[240:241], v18 offset:49152
v_accvgpr_read_b32 v178, a210
v_accvgpr_read_b32 v179, a211
v_accvgpr_read_b32 v180, a212
v_accvgpr_read_b32 v181, a213
v_mfma_f32_16x16x32_bf16 a[216:219], a[252:255], a[120:123], a[216:219]
ds_read_b64_tr_b16 a[242:243], v18 offset:51200
buffer_load_dwordx4 v28, s[40:43], s55 offen offset:0 lds
v_accvgpr_read_b32 v182, a214
v_accvgpr_read_b32 v183, a215
v_mfma_f32_16x16x32_bf16 a[216:219], a[248:251], a[112:115], a[216:219]
s_waitcnt lgkmcnt(6)
ds_read_b64_tr_b16 a[244:245], v18 offset:53248
v_cvt_pk_bf16_f32 v176, v176, v177
v_cvt_pk_bf16_f32 v177, v178, v179
v_cvt_pk_bf16_f32 v178, v180, v181
v_cvt_pk_bf16_f32 v179, v182, v183
v_mfma_f32_16x16x32_bf16 v[64:67], a[224:227], a[0:3], v[64:67]
buffer_load_dwordx4 v29, s[40:43], s55 offen offset:1024 lds
v_mfma_f32_16x16x32_bf16 v[64:67], a[228:231], a[8:11], v[64:67]
s_bfe_u32 s55, 0x100, s64
ds_read_b64_tr_b16 a[246:247], v18 offset:55296
ds_read_b64_tr_b16 a[248:249], v19 offset:49152
v_accvgpr_read_b32 v184, a216
v_accvgpr_read_b32 v185, a217
v_accvgpr_read_b32 v186, a218
v_mfma_f32_16x16x32_bf16 v[68:71], a[228:231], a[12:15], v[68:71]
s_lshl_b32 s55, s55, 18
ds_read_b64_tr_b16 a[250:251], v19 offset:51200
v_accvgpr_read_b32 v187, a219
v_accvgpr_read_b32 v188, a220
v_accvgpr_read_b32 v189, a221
v_accvgpr_read_b32 v190, a222
v_mfma_f32_16x16x32_bf16 v[68:71], a[224:227], a[4:7], v[68:71]
s_waitcnt lgkmcnt(6)
ds_read_b64_tr_b16 a[252:253], v19 offset:53248
s_or_b32 s55, s55, 128
v_accvgpr_read_b32 v191, a223
v_cvt_pk_bf16_f32 v184, v184, v185
v_cvt_pk_bf16_f32 v185, v186, v187
v_mfma_f32_16x16x32_bf16 v[76:79], a[232:235], a[4:7], v[76:79]
s_add_u32 m0, s52, 90112
ds_read_b64_tr_b16 a[254:255], v19 offset:55296
v_cvt_pk_bf16_f32 v186, v188, v189
v_cvt_pk_bf16_f32 v187, v190, v191
v_mfma_f32_16x16x32_bf16 v[76:79], a[236:239], a[12:15], v[76:79]
buffer_store_dwordx4 v[160:163], v1, s[24:27], s6 offen offset:0 sc1
ds_read_b64_tr_b16 a[224:225], v16 offset:57344
v_mfma_f32_16x16x32_bf16 v[72:75], a[236:239], a[8:11], v[72:75]
ds_read_b64_tr_b16 a[226:227], v16 offset:59392
ds_read_b64_tr_b16 a[228:229], v16 offset:61440
v_mfma_f32_16x16x32_bf16 v[72:75], a[232:235], a[0:3], v[72:75]
s_waitcnt lgkmcnt(7)
ds_read_b64_tr_b16 a[230:231], v16 offset:63488
v_mfma_f32_16x16x32_bf16 v[80:83], a[240:243], a[0:3], v[80:83]
ds_read_b64_tr_b16 a[232:233], v17 offset:57344
v_mfma_f32_16x16x32_bf16 v[80:83], a[244:247], a[8:11], v[80:83]
buffer_store_dwordx4 v[168:171], v1, s[24:27], s6 offen offset:1024 sc1
ds_read_b64_tr_b16 a[234:235], v17 offset:59392
v_mfma_f32_16x16x32_bf16 v[84:87], a[244:247], a[12:15], v[84:87]
ds_read_b64_tr_b16 a[236:237], v17 offset:61440
v_mfma_f32_16x16x32_bf16 v[84:87], a[240:243], a[4:7], v[84:87]
s_waitcnt lgkmcnt(7)
ds_read_b64_tr_b16 a[238:239], v17 offset:63488
v_mfma_f32_16x16x32_bf16 v[92:95], a[248:251], a[4:7], v[92:95]
ds_read_b64_tr_b16 a[240:241], v18 offset:57344
v_mfma_f32_16x16x32_bf16 v[92:95], a[252:255], a[12:15], v[92:95]
ds_read_b64_tr_b16 a[242:243], v18 offset:59392
v_mfma_f32_16x16x32_bf16 v[88:91], a[252:255], a[8:11], v[88:91]
ds_read_b64_tr_b16 a[244:245], v18 offset:61440
v_mfma_f32_16x16x32_bf16 v[88:91], a[248:251], a[0:3], v[88:91]
s_waitcnt lgkmcnt(7)
buffer_load_dwordx4 v28, s[44:47], s55 offen offset:0 lds
v_mfma_f32_16x16x32_bf16 v[64:67], a[224:227], a[16:19], v[64:67]
ds_read_b64_tr_b16 a[246:247], v18 offset:63488
ds_read_b64_tr_b16 a[248:249], v19 offset:57344
v_mfma_f32_16x16x32_bf16 v[64:67], a[228:231], a[24:27], v[64:67]
ds_read_b64_tr_b16 a[250:251], v19 offset:59392
v_mfma_f32_16x16x32_bf16 v[68:71], a[228:231], a[28:31], v[68:71]
ds_read_b64_tr_b16 a[252:253], v19 offset:61440
v_mfma_f32_16x16x32_bf16 v[68:71], a[224:227], a[20:23], v[68:71]
s_waitcnt lgkmcnt(7)
ds_read_b64_tr_b16 a[254:255], v19 offset:63488
v_mfma_f32_16x16x32_bf16 v[76:79], a[232:235], a[20:23], v[76:79]
buffer_store_dwordx4 v[176:179], v1, s[24:27], s6 offen offset:2048 sc1
ds_read_b64_tr_b16 a[224:225], v20 offset:32768
v_mfma_f32_16x16x32_bf16 v[76:79], a[236:239], a[28:31], v[76:79]
ds_read_b64_tr_b16 a[226:227], v20 offset:34816
v_mfma_f32_16x16x32_bf16 v[72:75], a[236:239], a[24:27], v[72:75]
ds_read_b64_tr_b16 a[228:229], v20 offset:36864
v_mfma_f32_16x16x32_bf16 v[72:75], a[232:235], a[16:19], v[72:75]
s_waitcnt lgkmcnt(7)
ds_read_b64_tr_b16 a[230:231], v20 offset:38912
v_mfma_f32_16x16x32_bf16 v[80:83], a[240:243], a[16:19], v[80:83]
ds_read_b64_tr_b16 a[232:233], v21 offset:32768
v_mfma_f32_16x16x32_bf16 v[80:83], a[244:247], a[24:27], v[80:83]
buffer_store_dwordx4 v[184:187], v1, s[24:27], s6 offen offset:3072 sc1
ds_read_b64_tr_b16 a[234:235], v21 offset:34816
v_mfma_f32_16x16x32_bf16 v[84:87], a[244:247], a[28:31], v[84:87]
s_mov_b64 exec, 0
s_cmp_eq_u32 s32, 0
s_cbranch_scc1 pg_15_b
s_cmp_eq_u32 s32, 1
s_cbranch_scc1 pg_16_b
s_cmp_eq_u32 s32, 2
s_cbranch_scc1 pg_back1_b
s_branch pg_back1_b
pg_back1_b:
s_mov_b64 exec, -1
ds_read_b64_tr_b16 a[236:237], v21 offset:36864
v_mfma_f32_16x16x32_bf16 v[84:87], a[240:243], a[20:23], v[84:87]
s_waitcnt lgkmcnt(7)
ds_read_b64_tr_b16 a[238:239], v21 offset:38912
v_mfma_f32_16x16x32_bf16 v[92:95], a[248:251], a[20:23], v[92:95]
s_load_dword s101, s[92:93], 64812
ds_read_b64_tr_b16 a[240:241], v22 offset:32768
v_mfma_f32_16x16x32_bf16 v[92:95], a[252:255], a[28:31], v[92:95]
ds_read_b64_tr_b16 a[242:243], v22 offset:34816
v_mfma_f32_16x16x32_bf16 v[88:91], a[252:255], a[24:27], v[88:91]
ds_read_b64_tr_b16 a[244:245], v22 offset:36864
v_mfma_f32_16x16x32_bf16 v[88:91], a[248:251], a[16:19], v[88:91]
s_waitcnt lgkmcnt(7)
buffer_load_dwordx4 v29, s[44:47], s55 offen offset:1024 lds
v_mfma_f32_16x16x32_bf16 v[64:67], a[224:227], a[32:35], v[64:67]
s_xor_b32 s55, s55, 131072
ds_read_b64_tr_b16 a[246:247], v22 offset:38912
ds_read_b64_tr_b16 a[248:249], v23 offset:32768
v_mfma_f32_16x16x32_bf16 v[64:67], a[228:231], a[40:43], v[64:67]
s_add_u32 m0, s52, 0
ds_read_b64_tr_b16 a[250:251], v23 offset:34816
v_mfma_f32_16x16x32_bf16 v[68:71], a[228:231], a[44:47], v[68:71]
ds_read_b64_tr_b16 a[252:253], v23 offset:36864
v_mfma_f32_16x16x32_bf16 v[68:71], a[224:227], a[36:39], v[68:71]
s_waitcnt lgkmcnt(7)
ds_read_b64_tr_b16 a[254:255], v23 offset:38912
v_mfma_f32_16x16x32_bf16 v[76:79], a[232:235], a[36:39], v[76:79]
buffer_load_dwordx4 v28, s[44:47], s55 offen offset:0 lds
v_mfma_f32_16x16x32_bf16 v[76:79], a[236:239], a[44:47], v[76:79]
ds_read_b64_tr_b16 a[224:225], v20 offset:40960
ds_read_b64_tr_b16 a[226:227], v20 offset:43008
v_mfma_f32_16x16x32_bf16 v[72:75], a[236:239], a[40:43], v[72:75]
ds_read_b64_tr_b16 a[228:229], v20 offset:45056
v_mfma_f32_16x16x32_bf16 v[72:75], a[232:235], a[32:35], v[72:75]
s_waitcnt lgkmcnt(7)
ds_read_b64_tr_b16 a[230:231], v20 offset:47104
v_mfma_f32_16x16x32_bf16 v[80:83], a[240:243], a[32:35], v[80:83]
buffer_load_dwordx4 v29, s[44:47], s55 offen offset:1024 lds
v_mfma_f32_16x16x32_bf16 v[80:83], a[244:247], a[40:43], v[80:83]
s_bfe_u32 s54, 0x100, s64
ds_read_b64_tr_b16 a[232:233], v21 offset:40960
ds_read_b64_tr_b16 a[234:235], v21 offset:43008
v_mfma_f32_16x16x32_bf16 v[84:87], a[244:247], a[44:47], v[84:87]
s_lshl_b32 s54, s54, 13
ds_read_b64_tr_b16 a[236:237], v21 offset:45056
s_add_u32 s54, s54, s71
v_mfma_f32_16x16x32_bf16 v[84:87], a[240:243], a[36:39], v[84:87]
s_waitcnt lgkmcnt(7)
ds_read_b64_tr_b16 a[238:239], v21 offset:47104
v_mfma_f32_16x16x32_bf16 v[92:95], a[248:251], a[36:39], v[92:95]
ds_read_b64_tr_b16 a[240:241], v22 offset:40960
v_mfma_f32_16x16x32_bf16 v[92:95], a[252:255], a[44:47], v[92:95]
buffer_load_dwordx4 a[192:195], v1, s[24:27], s54 offen offset:0 sc1
v_mfma_f32_16x16x32_bf16 v[88:91], a[252:255], a[40:43], v[88:91]
ds_read_b64_tr_b16 a[242:243], v22 offset:43008
ds_read_b64_tr_b16 a[244:245], v22 offset:45056
v_mfma_f32_16x16x32_bf16 v[88:91], a[248:251], a[32:35], v[88:91]
s_waitcnt lgkmcnt(7)
ds_read_b64_tr_b16 a[246:247], v22 offset:47104
v_mfma_f32_16x16x32_bf16 v[64:67], a[224:227], a[48:51], v[64:67]
ds_read_b64_tr_b16 a[248:249], v23 offset:40960
v_mfma_f32_16x16x32_bf16 v[64:67], a[228:231], a[56:59], v[64:67]
buffer_load_dwordx4 a[196:199], v1, s[24:27], s54 offen offset:1024 sc1
v_mfma_f32_16x16x32_bf16 v[68:71], a[228:231], a[60:63], v[68:71]
ds_read_b64_tr_b16 a[250:251], v23 offset:43008
ds_read_b64_tr_b16 a[252:253], v23 offset:45056
v_mfma_f32_16x16x32_bf16 v[68:71], a[224:227], a[52:55], v[68:71]
s_waitcnt vmcnt(19) lgkmcnt(7)
s_barrier
v_mfma_f32_16x16x32_bf16 v[76:79], a[232:235], a[52:55], v[76:79]
ds_read_b64_tr_b16 a[254:255], v23 offset:47104
ds_read_b64_tr_b16 a[224:225], v20 offset:49152
v_mfma_f32_16x16x32_bf16 v[76:79], a[236:239], a[60:63], v[76:79]
buffer_load_dwordx4 a[200:203], v1, s[24:27], s54 offen offset:2048 sc1
v_mfma_f32_16x16x32_bf16 v[72:75], a[236:239], a[56:59], v[72:75]
ds_read_b64_tr_b16 a[226:227], v20 offset:51200
ds_read_b64_tr_b16 a[228:229], v20 offset:53248
v_mfma_f32_16x16x32_bf16 v[72:75], a[232:235], a[48:51], v[72:75]
s_waitcnt lgkmcnt(7)
ds_read_b64_tr_b16 a[230:231], v20 offset:55296
v_mfma_f32_16x16x32_bf16 v[80:83], a[240:243], a[48:51], v[80:83]
ds_read_b64_tr_b16 a[232:233], v21 offset:49152
v_mfma_f32_16x16x32_bf16 v[80:83], a[244:247], a[56:59], v[80:83]
buffer_load_dwordx4 a[204:207], v1, s[24:27], s54 offen offset:3072 sc1
v_mfma_f32_16x16x32_bf16 v[84:87], a[244:247], a[60:63], v[84:87]
ds_read_b64_tr_b16 a[234:235], v21 offset:51200
ds_read_b64_tr_b16 a[236:237], v21 offset:53248
v_mfma_f32_16x16x32_bf16 v[84:87], a[240:243], a[52:55], v[84:87]
s_waitcnt lgkmcnt(7)
ds_read_b64_tr_b16 a[238:239], v21 offset:55296
v_mfma_f32_16x16x32_bf16 v[92:95], a[248:251], a[52:55], v[92:95]
ds_read_b64_tr_b16 a[240:241], v22 offset:49152
v_mfma_f32_16x16x32_bf16 v[92:95], a[252:255], a[60:63], v[92:95]
ds_read_b64_tr_b16 a[242:243], v22 offset:51200
v_mfma_f32_16x16x32_bf16 v[88:91], a[252:255], a[56:59], v[88:91]
buffer_load_dwordx4 a[208:211], v2, s[24:27], s54 offen offset:0 sc1
v_mfma_f32_16x16x32_bf16 v[88:91], a[248:251], a[48:51], v[88:91]
s_waitcnt lgkmcnt(6)
ds_read_b64_tr_b16 a[244:245], v22 offset:53248
ds_read_b64_tr_b16 a[246:247], v22 offset:55296
v_mfma_f32_16x16x32_bf16 v[64:67], a[224:227], a[64:67], v[64:67]
ds_read_b64_tr_b16 a[248:249], v23 offset:49152
v_mfma_f32_16x16x32_bf16 v[64:67], a[228:231], a[72:75], v[64:67]
ds_read_b64_tr_b16 a[250:251], v23 offset:51200
v_mfma_f32_16x16x32_bf16 v[68:71], a[228:231], a[76:79], v[68:71]
buffer_load_dwordx4 a[212:215], v2, s[24:27], s54 offen offset:1024 sc1
v_mfma_f32_16x16x32_bf16 v[68:71], a[224:227], a[68:71], v[68:71]
s_waitcnt lgkmcnt(6)
ds_read_b64_tr_b16 a[252:253], v23 offset:53248
ds_read_b64_tr_b16 a[254:255], v23 offset:55296
v_mfma_f32_16x16x32_bf16 v[76:79], a[232:235], a[68:71], v[76:79]
ds_read_b64_tr_b16 a[224:225], v20 offset:57344
v_mfma_f32_16x16x32_bf16 v[76:79], a[236:239], a[76:79], v[76:79]
ds_read_b64_tr_b16 a[226:227], v20 offset:59392
v_mfma_f32_16x16x32_bf16 v[72:75], a[236:239], a[72:75], v[72:75]
ds_read_b64_tr_b16 a[228:229], v20 offset:61440
v_mfma_f32_16x16x32_bf16 v[72:75], a[232:235], a[64:67], v[72:75]
s_waitcnt lgkmcnt(7)
buffer_load_dwordx4 a[216:219], v2, s[24:27], s54 offen offset:2048 sc1
v_mfma_f32_16x16x32_bf16 v[80:83], a[240:243], a[64:67], v[80:83]
ds_read_b64_tr_b16 a[230:231], v20 offset:63488
ds_read_b64_tr_b16 a[232:233], v21 offset:57344
v_mfma_f32_16x16x32_bf16 v[80:83], a[244:247], a[72:75], v[80:83]
ds_read_b64_tr_b16 a[234:235], v21 offset:59392
v_mfma_f32_16x16x32_bf16 v[84:87], a[244:247], a[76:79], v[84:87]
ds_read_b64_tr_b16 a[236:237], v21 offset:61440
v_mfma_f32_16x16x32_bf16 v[84:87], a[240:243], a[68:71], v[84:87]
s_waitcnt lgkmcnt(7)
buffer_load_dwordx4 a[220:223], v2, s[24:27], s54 offen offset:3072 sc1
v_mfma_f32_16x16x32_bf16 v[92:95], a[248:251], a[68:71], v[92:95]
s_bfe_u32 s55, 0x1020001, s64
ds_read_b64_tr_b16 a[238:239], v21 offset:63488
ds_read_b64_tr_b16 a[240:241], v22 offset:57344
v_mfma_f32_16x16x32_bf16 v[92:95], a[252:255], a[76:79], v[92:95]
s_lshl_b32 s55, s55, 18
ds_read_b64_tr_b16 a[242:243], v22 offset:59392
s_or_b32 s55, s55, 128
v_mfma_f32_16x16x32_bf16 v[88:91], a[252:255], a[72:75], v[88:91]
s_add_u32 m0, s52, 8192
ds_read_b64_tr_b16 a[244:245], v22 offset:61440
v_mfma_f32_16x16x32_bf16 v[88:91], a[248:251], a[64:67], v[88:91]
s_waitcnt lgkmcnt(7)
ds_read_b64_tr_b16 a[246:247], v22 offset:63488
v_mfma_f32_16x16x32_bf16 v[64:67], a[224:227], a[80:83], v[64:67]
buffer_load_dwordx4 v28, s[44:47], s55 offen offset:0 lds
v_mfma_f32_16x16x32_bf16 v[64:67], a[228:231], a[88:91], v[64:67]
ds_read_b64_tr_b16 a[248:249], v23 offset:57344
ds_read_b64_tr_b16 a[250:251], v23 offset:59392
v_mfma_f32_16x16x32_bf16 v[68:71], a[228:231], a[92:95], v[68:71]
ds_read_b64_tr_b16 a[252:253], v23 offset:61440
v_mfma_f32_16x16x32_bf16 v[68:71], a[224:227], a[84:87], v[68:71]
s_waitcnt lgkmcnt(7)
ds_read_b64_tr_b16 a[254:255], v23 offset:63488
v_mfma_f32_16x16x32_bf16 v[76:79], a[232:235], a[84:87], v[76:79]
buffer_load_dwordx4 v29, s[44:47], s55 offen offset:1024 lds
v_mfma_f32_16x16x32_bf16 v[76:79], a[236:239], a[92:95], v[76:79]
s_xor_b32 s55, s55, 131072
ds_read_b64_tr_b16 a[224:225], v24 offset:0
ds_read_b64_tr_b16 a[226:227], v24 offset:2048
v_mfma_f32_16x16x32_bf16 v[72:75], a[236:239], a[88:91], v[72:75]
s_add_u32 m0, s52, 16384
ds_read_b64_tr_b16 a[228:229], v24 offset:4096
v_mfma_f32_16x16x32_bf16 v[72:75], a[232:235], a[80:83], v[72:75]
s_waitcnt lgkmcnt(7)
ds_read_b64_tr_b16 a[230:231], v24 offset:6144
v_mfma_f32_16x16x32_bf16 v[80:83], a[240:243], a[80:83], v[80:83]
ds_read_b64_tr_b16 a[232:233], v25 offset:0
v_mfma_f32_16x16x32_bf16 v[80:83], a[244:247], a[88:91], v[80:83]
buffer_load_dwordx4 v28, s[44:47], s55 offen offset:0 lds
v_mfma_f32_16x16x32_bf16 v[84:87], a[244:247], a[92:95], v[84:87]
ds_read_b64_tr_b16 a[234:235], v25 offset:2048
ds_read_b64_tr_b16 a[236:237], v25 offset:4096
v_mfma_f32_16x16x32_bf16 v[84:87], a[240:243], a[84:87], v[84:87]
s_waitcnt lgkmcnt(7)
ds_read_b64_tr_b16 a[238:239], v25 offset:6144
v_mfma_f32_16x16x32_bf16 v[92:95], a[248:251], a[84:87], v[92:95]
ds_read_b64_tr_b16 a[240:241], v26 offset:0
v_mfma_f32_16x16x32_bf16 v[92:95], a[252:255], a[92:95], v[92:95]
buffer_load_dwordx4 v29, s[44:47], s55 offen offset:1024 lds
v_mfma_f32_16x16x32_bf16 v[88:91], a[252:255], a[88:91], v[88:91]
s_bfe_u32 s54, 0x1020001, s64
ds_read_b64_tr_b16 a[242:243], v26 offset:2048
ds_read_b64_tr_b16 a[244:245], v26 offset:4096
v_mfma_f32_16x16x32_bf16 v[88:91], a[248:251], a[80:83], v[88:91]
s_waitcnt lgkmcnt(7)
ds_read_b64_tr_b16 a[246:247], v26 offset:6144
s_lshl_b32 s54, s54, 13
v_mfma_f32_16x16x32_bf16 v[64:67], a[224:227], a[160:163], v[64:67]
s_add_u32 s54, s54, s71
ds_read_b64_tr_b16 a[248:249], v27 offset:0
s_waitcnt vmcnt(15)
v_mfma_f32_16x16x32_bf16 v[64:67], a[228:231], a[168:171], v[64:67]
buffer_store_dword v32, v30, s[24:27], s7 offen offset:0 sc1
ds_read_b64_tr_b16 a[250:251], v27 offset:2048
s_xor_b32 s7, s7, 512
s_xor_b32 s6, s6, 32768
v_mfma_f32_16x16x32_bf16 v[68:71], a[228:231], a[172:175], v[68:71]
ds_read_b64_tr_b16 a[252:253], v27 offset:4096
v_mfma_f32_16x16x32_bf16 v[68:71], a[224:227], a[164:167], v[68:71]
s_waitcnt lgkmcnt(7)
ds_read_b64_tr_b16 a[254:255], v27 offset:6144
v_mfma_f32_16x16x32_bf16 v[76:79], a[232:235], a[164:167], v[76:79]
ds_read_b64_tr_b16 a[224:225], v24 offset:8192
v_mfma_f32_16x16x32_bf16 v[76:79], a[236:239], a[172:175], v[76:79]
buffer_load_dwordx4 a[0:3], v1, s[24:27], s54 offen offset:0 sc1
v_mfma_f32_16x16x32_bf16 v[72:75], a[236:239], a[168:171], v[72:75]
ds_read_b64_tr_b16 a[226:227], v24 offset:10240
ds_read_b64_tr_b16 a[228:229], v24 offset:12288
v_mfma_f32_16x16x32_bf16 v[72:75], a[232:235], a[160:163], v[72:75]
s_waitcnt lgkmcnt(7)
ds_read_b64_tr_b16 a[230:231], v24 offset:14336
v_mfma_f32_16x16x32_bf16 v[80:83], a[240:243], a[160:163], v[80:83]
buffer_load_dwordx4 a[4:7], v1, s[24:27], s54 offen offset:1024 sc1
v_mfma_f32_16x16x32_bf16 v[80:83], a[244:247], a[168:171], v[80:83]
ds_read_b64_tr_b16 a[232:233], v25 offset:8192
ds_read_b64_tr_b16 a[234:235], v25 offset:10240
v_mfma_f32_16x16x32_bf16 v[84:87], a[244:247], a[172:175], v[84:87]
ds_read_b64_tr_b16 a[236:237], v25 offset:12288
v_mfma_f32_16x16x32_bf16 v[84:87], a[240:243], a[164:167], v[84:87]
s_waitcnt lgkmcnt(7)
ds_read_b64_tr_b16 a[238:239], v25 offset:14336
v_mfma_f32_16x16x32_bf16 v[92:95], a[248:251], a[164:167], v[92:95]
buffer_load_dwordx4 a[8:11], v1, s[24:27], s54 offen offset:2048 sc1
v_mfma_f32_16x16x32_bf16 v[92:95], a[252:255], a[172:175], v[92:95]
ds_read_b64_tr_b16 a[240:241], v26 offset:8192
ds_read_b64_tr_b16 a[242:243], v26 offset:10240
v_mfma_f32_16x16x32_bf16 v[88:91], a[252:255], a[168:171], v[88:91]
ds_read_b64_tr_b16 a[244:245], v26 offset:12288
v_mfma_f32_16x16x32_bf16 v[88:91], a[248:251], a[160:163], v[88:91]
s_waitcnt lgkmcnt(7)
ds_read_b64_tr_b16 a[246:247], v26 offset:14336
v_mfma_f32_16x16x32_bf16 v[64:67], a[224:227], a[176:179], v[64:67]
ds_read_b64_tr_b16 a[248:249], v27 offset:8192
v_mfma_f32_16x16x32_bf16 v[64:67], a[228:231], a[184:187], v[64:67]
buffer_load_dwordx4 a[12:15], v1, s[24:27], s54 offen offset:3072 sc1
v_mfma_f32_16x16x32_bf16 v[68:71], a[228:231], a[188:191], v[68:71]
ds_read_b64_tr_b16 a[250:251], v27 offset:10240
ds_read_b64_tr_b16 a[252:253], v27 offset:12288
v_mfma_f32_16x16x32_bf16 v[68:71], a[224:227], a[180:183], v[68:71]
s_waitcnt vmcnt(25) lgkmcnt(7)
s_barrier
v_mfma_f32_16x16x32_bf16 v[76:79], a[232:235], a[180:183], v[76:79]
ds_read_b64_tr_b16 a[254:255], v27 offset:14336
ds_read_b64_tr_b16 a[224:225], v24 offset:16384
v_mfma_f32_16x16x32_bf16 v[76:79], a[236:239], a[188:191], v[76:79]
buffer_load_dwordx4 a[16:19], v2, s[24:27], s54 offen offset:0 sc1
v_mfma_f32_16x16x32_bf16 v[72:75], a[236:239], a[184:187], v[72:75]
ds_read_b64_tr_b16 a[226:227], v24 offset:18432
ds_read_b64_tr_b16 a[228:229], v24 offset:20480
v_mfma_f32_16x16x32_bf16 v[72:75], a[232:235], a[176:179], v[72:75]
s_waitcnt lgkmcnt(7)
ds_read_b64_tr_b16 a[230:231], v24 offset:22528
v_mfma_f32_16x16x32_bf16 v[80:83], a[240:243], a[176:179], v[80:83]
ds_read_b64_tr_b16 a[232:233], v25 offset:16384
v_mfma_f32_16x16x32_bf16 v[80:83], a[244:247], a[184:187], v[80:83]
buffer_load_dwordx4 a[20:23], v2, s[24:27], s54 offen offset:1024 sc1
v_mfma_f32_16x16x32_bf16 v[84:87], a[244:247], a[188:191], v[84:87]
ds_read_b64_tr_b16 a[234:235], v25 offset:18432
ds_read_b64_tr_b16 a[236:237], v25 offset:20480
v_mfma_f32_16x16x32_bf16 v[84:87], a[240:243], a[180:183], v[84:87]
s_waitcnt lgkmcnt(7)
ds_read_b64_tr_b16 a[238:239], v25 offset:22528
v_mfma_f32_16x16x32_bf16 v[92:95], a[248:251], a[180:183], v[92:95]
ds_read_b64_tr_b16 a[240:241], v26 offset:16384
v_mfma_f32_16x16x32_bf16 v[92:95], a[252:255], a[188:191], v[92:95]
ds_read_b64_tr_b16 a[242:243], v26 offset:18432
v_mfma_f32_16x16x32_bf16 v[88:91], a[252:255], a[184:187], v[88:91]
buffer_load_dwordx4 a[24:27], v2, s[24:27], s54 offen offset:2048 sc1
v_mfma_f32_16x16x32_bf16 v[88:91], a[248:251], a[176:179], v[88:91]
s_waitcnt lgkmcnt(6)
ds_read_b64_tr_b16 a[244:245], v26 offset:20480
ds_read_b64_tr_b16 a[246:247], v26 offset:22528
v_mfma_f32_16x16x32_bf16 v[64:67], a[224:227], a[128:131], v[64:67]
pg_15_b:
s_cbranch_execz pg_back1_b
ds_read_b64_tr_b16 a[248:249], v27 offset:16384
v_mfma_f32_16x16x32_bf16 v[64:67], a[228:231], a[136:139], v[64:67]
ds_read_b64_tr_b16 a[250:251], v27 offset:18432
v_mfma_f32_16x16x32_bf16 v[68:71], a[228:231], a[140:143], v[68:71]
buffer_load_dwordx4 a[28:31], v2, s[24:27], s54 offen offset:3072 sc1
v_mfma_f32_16x16x32_bf16 v[68:71], a[224:227], a[132:135], v[68:71]
s_waitcnt lgkmcnt(6)
ds_read_b64_tr_b16 a[252:253], v27 offset:20480
ds_read_b64_tr_b16 a[254:255], v27 offset:22528
v_mfma_f32_16x16x32_bf16 v[76:79], a[232:235], a[132:135], v[76:79]
s_bfe_u32 s55, 0x3010202, s64
ds_read_b64_tr_b16 a[224:225], v20 offset:0
s_lshl_b32 s55, s55, 18
v_mfma_f32_16x16x32_bf16 v[76:79], a[236:239], a[140:143], v[76:79]
s_or_b32 s55, s55, 128
ds_read_b64_tr_b16 a[226:227], v20 offset:2048
s_add_u32 m0, s52, 24576
v_mfma_f32_16x16x32_bf16 v[72:75], a[236:239], a[136:139], v[72:75]
ds_read_b64_tr_b16 a[228:229], v20 offset:4096
v_mfma_f32_16x16x32_bf16 v[72:75], a[232:235], a[128:131], v[72:75]
s_waitcnt lgkmcnt(7)
buffer_load_dwordx4 v28, s[44:47], s55 offen offset:0 lds
v_mfma_f32_16x16x32_bf16 v[80:83], a[240:243], a[128:131], v[80:83]
buffer_load_dword v33, off, s[24:27], s7 offset:0 sc1
v_mfma_f32_16x16x32_bf16 v[80:83], a[244:247], a[136:139], v[80:83]
ds_read_b64_tr_b16 a[230:231], v20 offset:6144
ds_read_b64_tr_b16 a[232:233], v21 offset:0
v_mfma_f32_16x16x32_bf16 v[84:87], a[244:247], a[140:143], v[84:87]
ds_read_b64_tr_b16 a[234:235], v21 offset:2048
ds_read_b64_tr_b16 a[236:237], v21 offset:4096
v_mfma_f32_16x16x32_bf16 v[84:87], a[240:243], a[132:135], v[84:87]
s_waitcnt lgkmcnt(7)
ds_read_b64_tr_b16 a[238:239], v21 offset:6144
v_mfma_f32_16x16x32_bf16 v[92:95], a[248:251], a[132:135], v[92:95]
buffer_load_dwordx4 v29, s[44:47], s55 offen offset:1024 lds
v_mfma_f32_16x16x32_bf16 v[92:95], a[252:255], a[140:143], v[92:95]
s_xor_b32 s55, s55, 131072
ds_read_b64_tr_b16 a[240:241], v22 offset:0
ds_read_b64_tr_b16 a[242:243], v22 offset:2048
v_mfma_f32_16x16x32_bf16 v[88:91], a[252:255], a[136:139], v[88:91]
s_add_u32 m0, s52, 32768
ds_read_b64_tr_b16 a[244:245], v22 offset:4096
v_mfma_f32_16x16x32_bf16 v[88:91], a[248:251], a[128:131], v[88:91]
s_waitcnt lgkmcnt(7)
ds_read_b64_tr_b16 a[246:247], v22 offset:6144
v_mfma_f32_16x16x32_bf16 v[64:67], a[224:227], a[144:147], v[64:67]
buffer_load_dwordx4 v28, s[44:47], s55 offen offset:0 lds
v_mfma_f32_16x16x32_bf16 v[64:67], a[228:231], a[152:155], v[64:67]
ds_read_b64_tr_b16 a[248:249], v23 offset:0
ds_read_b64_tr_b16 a[250:251], v23 offset:2048
v_mfma_f32_16x16x32_bf16 v[68:71], a[228:231], a[156:159], v[68:71]
ds_read_b64_tr_b16 a[252:253], v23 offset:4096
v_mfma_f32_16x16x32_bf16 v[68:71], a[224:227], a[148:151], v[68:71]
s_waitcnt lgkmcnt(7)
ds_read_b64_tr_b16 a[254:255], v23 offset:6144
v_mfma_f32_16x16x32_bf16 v[76:79], a[232:235], a[148:151], v[76:79]
ds_read_b64_tr_b16 a[224:225], v20 offset:8192
v_mfma_f32_16x16x32_bf16 v[76:79], a[236:239], a[156:159], v[76:79]
buffer_load_dwordx4 v29, s[44:47], s55 offen offset:1024 lds
v_mfma_f32_16x16x32_bf16 v[72:75], a[236:239], a[152:155], v[72:75]
s_bfe_u32 s54, 0x3010202, s64
ds_read_b64_tr_b16 a[226:227], v20 offset:10240
ds_read_b64_tr_b16 a[228:229], v20 offset:12288
v_mfma_f32_16x16x32_bf16 v[72:75], a[232:235], a[144:147], v[72:75]
s_waitcnt lgkmcnt(7)
ds_read_b64_tr_b16 a[230:231], v20 offset:14336
s_lshl_b32 s54, s54, 13
v_mfma_f32_16x16x32_bf16 v[80:83], a[240:243], a[144:147], v[80:83]
s_add_u32 s54, s54, s71
ds_read_b64_tr_b16 a[232:233], v21 offset:8192
v_mfma_f32_16x16x32_bf16 v[80:83], a[244:247], a[152:155], v[80:83]
buffer_load_dwordx4 a[160:163], v1, s[24:27], s54 offen offset:0 sc1
v_mfma_f32_16x16x32_bf16 v[84:87], a[244:247], a[156:159], v[84:87]
ds_read_b64_tr_b16 a[234:235], v21 offset:10240
ds_read_b64_tr_b16 a[236:237], v21 offset:12288
v_mfma_f32_16x16x32_bf16 v[84:87], a[240:243], a[148:151], v[84:87]
s_waitcnt lgkmcnt(7)
ds_read_b64_tr_b16 a[238:239], v21 offset:14336
v_mfma_f32_16x16x32_bf16 v[92:95], a[248:251], a[148:151], v[92:95]
ds_read_b64_tr_b16 a[240:241], v22 offset:8192
v_mfma_f32_16x16x32_bf16 v[92:95], a[252:255], a[156:159], v[92:95]
ds_read_b64_tr_b16 a[242:243], v22 offset:10240
v_mfma_f32_16x16x32_bf16 v[88:91], a[252:255], a[152:155], v[88:91]
buffer_load_dwordx4 a[164:167], v1, s[24:27], s54 offen offset:1024 sc1
v_mfma_f32_16x16x32_bf16 v[88:91], a[248:251], a[144:147], v[88:91]
s_waitcnt lgkmcnt(6)
ds_read_b64_tr_b16 a[244:245], v22 offset:12288
ds_read_b64_tr_b16 a[246:247], v22 offset:14336
v_mfma_f32_16x16x32_bf16 v[64:67], a[224:227], a[96:99], v[64:67]
ds_read_b64_tr_b16 a[248:249], v23 offset:8192
v_mfma_f32_16x16x32_bf16 v[64:67], a[228:231], a[104:107], v[64:67]
ds_read_b64_tr_b16 a[250:251], v23 offset:10240
v_mfma_f32_16x16x32_bf16 v[68:71], a[228:231], a[108:111], v[68:71]
buffer_load_dwordx4 a[168:171], v1, s[24:27], s54 offen offset:2048 sc1
v_mfma_f32_16x16x32_bf16 v[68:71], a[224:227], a[100:103], v[68:71]
s_waitcnt lgkmcnt(6)
ds_read_b64_tr_b16 a[252:253], v23 offset:12288
ds_read_b64_tr_b16 a[254:255], v23 offset:14336
v_mfma_f32_16x16x32_bf16 v[76:79], a[232:235], a[100:103], v[76:79]
ds_read_b64_tr_b16 a[224:225], v20 offset:16384
v_mfma_f32_16x16x32_bf16 v[76:79], a[236:239], a[108:111], v[76:79]
ds_read_b64_tr_b16 a[226:227], v20 offset:18432
v_mfma_f32_16x16x32_bf16 v[72:75], a[236:239], a[104:107], v[72:75]
ds_read_b64_tr_b16 a[228:229], v20 offset:20480
v_mfma_f32_16x16x32_bf16 v[72:75], a[232:235], a[96:99], v[72:75]
s_waitcnt lgkmcnt(7)
buffer_load_dwordx4 a[172:175], v1, s[24:27], s54 offen offset:3072 sc1
v_mfma_f32_16x16x32_bf16 v[80:83], a[240:243], a[96:99], v[80:83]
ds_read_b64_tr_b16 a[230:231], v20 offset:22528
ds_read_b64_tr_b16 a[232:233], v21 offset:16384
v_mfma_f32_16x16x32_bf16 v[80:83], a[244:247], a[104:107], v[80:83]
ds_read_b64_tr_b16 a[234:235], v21 offset:18432
v_mfma_f32_16x16x32_bf16 v[84:87], a[244:247], a[108:111], v[84:87]
ds_read_b64_tr_b16 a[236:237], v21 offset:20480
v_mfma_f32_16x16x32_bf16 v[84:87], a[240:243], a[100:103], v[84:87]
s_waitcnt lgkmcnt(7)
buffer_load_dwordx4 a[176:179], v2, s[24:27], s54 offen offset:0 sc1
v_mfma_f32_16x16x32_bf16 v[92:95], a[248:251], a[100:103], v[92:95]
ds_read_b64_tr_b16 a[238:239], v21 offset:22528
ds_read_b64_tr_b16 a[240:241], v22 offset:16384
v_mfma_f32_16x16x32_bf16 v[92:95], a[252:255], a[108:111], v[92:95]
ds_read_b64_tr_b16 a[242:243], v22 offset:18432
v_mfma_f32_16x16x32_bf16 v[88:91], a[252:255], a[104:107], v[88:91]
ds_read_b64_tr_b16 a[244:245], v22 offset:20480
v_mfma_f32_16x16x32_bf16 v[88:91], a[248:251], a[96:99], v[88:91]
s_waitcnt lgkmcnt(7)
ds_read_b64_tr_b16 a[246:247], v22 offset:22528
v_mfma_f32_16x16x32_bf16 v[64:67], a[224:227], a[112:115], v[64:67]
buffer_load_dwordx4 a[180:183], v2, s[24:27], s54 offen offset:1024 sc1
v_mfma_f32_16x16x32_bf16 v[64:67], a[228:231], a[120:123], v[64:67]
ds_read_b64_tr_b16 a[248:249], v23 offset:16384
ds_read_b64_tr_b16 a[250:251], v23 offset:18432
v_mfma_f32_16x16x32_bf16 v[68:71], a[228:231], a[124:127], v[68:71]
ds_read_b64_tr_b16 a[252:253], v23 offset:20480
v_mfma_f32_16x16x32_bf16 v[68:71], a[224:227], a[116:119], v[68:71]
s_waitcnt vmcnt(32) lgkmcnt(7)
s_barrier
v_mfma_f32_16x16x32_bf16 v[76:79], a[232:235], a[116:119], v[76:79]
buffer_load_dwordx4 a[184:187], v2, s[24:27], s54 offen offset:2048 sc1
v_mfma_f32_16x16x32_bf16 v[76:79], a[236:239], a[124:127], v[76:79]
ds_read_b64_tr_b16 a[254:255], v23 offset:22528
ds_read_b64_tr_b16 a[224:225], v20 offset:24576
v_mfma_f32_16x16x32_bf16 v[72:75], a[236:239], a[120:123], v[72:75]
ds_read_b64_tr_b16 a[226:227], v20 offset:26624
ds_read_b64_tr_b16 a[228:229], v20 offset:28672
v_mfma_f32_16x16x32_bf16 v[72:75], a[232:235], a[112:115], v[72:75]
s_waitcnt lgkmcnt(7)
ds_read_b64_tr_b16 a[230:231], v20 offset:30720
v_mfma_f32_16x16x32_bf16 v[80:83], a[240:243], a[112:115], v[80:83]
buffer_load_dwordx4 a[188:191], v2, s[24:27], s54 offen offset:3072 sc1
v_mfma_f32_16x16x32_bf16 v[80:83], a[244:247], a[120:123], v[80:83]
s_bfe_u32 s55, 0x2030304, s64
ds_read_b64_tr_b16 a[232:233], v21 offset:24576
ds_read_b64_tr_b16 a[234:235], v21 offset:26624
v_mfma_f32_16x16x32_bf16 v[84:87], a[244:247], a[124:127], v[84:87]
s_lshl_b32 s55, s55, 18
ds_read_b64_tr_b16 a[236:237], v21 offset:28672
s_or_b32 s55, s55, 128
v_mfma_f32_16x16x32_bf16 v[84:87], a[240:243], a[116:119], v[84:87]
s_waitcnt lgkmcnt(7)
ds_read_b64_tr_b16 a[238:239], v21 offset:30720
s_add_u32 m0, s52, 40960
v_mfma_f32_16x16x32_bf16 v[92:95], a[248:251], a[116:119], v[92:95]
buffer_load_dwordx4 v28, s[44:47], s55 offen offset:0 lds
v_mfma_f32_16x16x32_bf16 v[92:95], a[252:255], a[124:127], v[92:95]
ds_read_b64_tr_b16 a[240:241], v22 offset:24576
ds_read_b64_tr_b16 a[242:243], v22 offset:26624
v_mfma_f32_16x16x32_bf16 v[88:91], a[252:255], a[120:123], v[88:91]
ds_read_b64_tr_b16 a[244:245], v22 offset:28672
v_mfma_f32_16x16x32_bf16 v[88:91], a[248:251], a[112:115], v[88:91]
s_waitcnt vmcnt(27) lgkmcnt(7)
ds_read_b64_tr_b16 a[246:247], v22 offset:30720
v_mfma_f32_16x16x32_bf16 v[96:99], a[224:227], a[192:195], 0
ds_read_b64_tr_b16 a[248:249], v23 offset:24576
v_mfma_f32_16x16x32_bf16 v[96:99], a[228:231], a[200:203], v[96:99]
buffer_load_dwordx4 v29, s[44:47], s55 offen offset:1024 lds
v_mfma_f32_16x16x32_bf16 v[100:103], a[228:231], a[204:207], 0
s_xor_b32 s55, s55, 131072
ds_read_b64_tr_b16 a[250:251], v23 offset:26624
ds_read_b64_tr_b16 a[252:253], v23 offset:28672
v_mfma_f32_16x16x32_bf16 v[100:103], a[224:227], a[196:199], v[100:103]
s_waitcnt lgkmcnt(7)
ds_read_b64_tr_b16 a[254:255], v23 offset:30720
s_add_u32 m0, s52, 49152
v_mfma_f32_16x16x32_bf16 v[108:111], a[232:235], a[196:199], 0
ds_read_b64_tr_b16 a[224:225], v16 offset:0
v_mfma_f32_16x16x32_bf16 v[108:111], a[236:239], a[204:207], v[108:111]
buffer_load_dwordx4 v28, s[44:47], s55 offen offset:0 lds
v_mfma_f32_16x16x32_bf16 v[104:107], a[236:239], a[200:203], 0
ds_read_b64_tr_b16 a[226:227], v16 offset:2048
ds_read_b64_tr_b16 a[228:229], v16 offset:4096
v_mfma_f32_16x16x32_bf16 v[104:107], a[232:235], a[192:195], v[104:107]
s_waitcnt lgkmcnt(7)
ds_read_b64_tr_b16 a[230:231], v16 offset:6144
v_mfma_f32_16x16x32_bf16 v[112:115], a[240:243], a[192:195], 0
s_waitcnt vmcnt(14)
ds_read_b64_tr_b16 a[232:233], v17 offset:0
v_cmp_ne_u32 vcc, v33, v32
s_nop 0
s_cbranch_vccnz ckE_spin_b
ckE_ok_b:
v_mfma_f32_16x16x32_bf16 v[112:115], a[244:247], a[200:203], v[112:115]
buffer_load_dwordx4 v[224:227], v1, s[24:27], s6 offen offset:0 sc1
v_mfma_f32_16x16x32_bf16 v[116:119], a[244:247], a[204:207], 0
ds_read_b64_tr_b16 a[234:235], v17 offset:2048
ds_read_b64_tr_b16 a[236:237], v17 offset:4096
v_mfma_f32_16x16x32_bf16 v[116:119], a[240:243], a[196:199], v[116:119]
s_waitcnt lgkmcnt(7)
ds_read_b64_tr_b16 a[238:239], v17 offset:6144
v_mfma_f32_16x16x32_bf16 v[124:127], a[248:251], a[196:199], 0
buffer_load_dwordx4 v[228:231], v1, s[24:27], s6 offen offset:1024 sc1
v_mfma_f32_16x16x32_bf16 v[124:127], a[252:255], a[204:207], v[124:127]
ds_read_b64_tr_b16 a[240:241], v18 offset:0
ds_read_b64_tr_b16 a[242:243], v18 offset:2048
v_mfma_f32_16x16x32_bf16 v[120:123], a[252:255], a[200:203], 0
ds_read_b64_tr_b16 a[244:245], v18 offset:4096
v_mfma_f32_16x16x32_bf16 v[120:123], a[248:251], a[192:195], v[120:123]
s_waitcnt lgkmcnt(7)
ds_read_b64_tr_b16 a[246:247], v18 offset:6144
v_mfma_f32_16x16x32_bf16 v[96:99], a[224:227], a[208:211], v[96:99]
buffer_load_dwordx4 v[232:235], v1, s[24:27], s6 offen offset:2048 sc1
v_mfma_f32_16x16x32_bf16 v[96:99], a[228:231], a[216:219], v[96:99]
ds_read_b64_tr_b16 a[248:249], v19 offset:0
ds_read_b64_tr_b16 a[250:251], v19 offset:2048
v_mfma_f32_16x16x32_bf16 v[100:103], a[228:231], a[220:223], v[100:103]
ds_read_b64_tr_b16 a[252:253], v19 offset:4096
v_mfma_f32_16x16x32_bf16 v[100:103], a[224:227], a[212:215], v[100:103]
s_waitcnt vmcnt(28) lgkmcnt(7)
s_barrier
v_mfma_f32_16x16x32_bf16 v[108:111], a[232:235], a[212:215], v[108:111]
buffer_load_dwordx4 v[236:239], v1, s[24:27], s6 offen offset:3072 sc1
v_mfma_f32_16x16x32_bf16 v[108:111], a[236:239], a[220:223], v[108:111]
ds_read_b64_tr_b16 a[254:255], v19 offset:6144
ds_read_b64_tr_b16 a[224:225], v16 offset:8192
v_mfma_f32_16x16x32_bf16 v[104:107], a[236:239], a[216:219], v[104:107]
ds_read_b64_tr_b16 a[226:227], v16 offset:10240
ds_read_b64_tr_b16 a[228:229], v16 offset:12288
v_mfma_f32_16x16x32_bf16 v[104:107], a[232:235], a[208:211], v[104:107]
s_waitcnt lgkmcnt(7)
buffer_load_dwordx4 v29, s[44:47], s55 offen offset:1024 lds
v_mfma_f32_16x16x32_bf16 v[112:115], a[240:243], a[208:211], v[112:115]
s_bfe_u32 s54, 0x2030304, s64
ds_read_b64_tr_b16 a[230:231], v16 offset:14336
ds_read_b64_tr_b16 a[232:233], v17 offset:8192
v_mfma_f32_16x16x32_bf16 v[112:115], a[244:247], a[216:219], v[112:115]
s_lshl_b32 s54, s54, 13
ds_read_b64_tr_b16 a[234:235], v17 offset:10240
s_add_u32 s54, s54, s71
v_mfma_f32_16x16x32_bf16 v[116:119], a[244:247], a[220:223], v[116:119]
ds_read_b64_tr_b16 a[236:237], v17 offset:12288
v_mfma_f32_16x16x32_bf16 v[116:119], a[240:243], a[212:215], v[116:119]
s_waitcnt lgkmcnt(7)
buffer_load_dwordx4 a[128:131], v1, s[24:27], s54 offen offset:0 sc1
v_mfma_f32_16x16x32_bf16 v[124:127], a[248:251], a[212:215], v[124:127]
ds_read_b64_tr_b16 a[238:239], v17 offset:14336
ds_read_b64_tr_b16 a[240:241], v18 offset:8192
v_mfma_f32_16x16x32_bf16 v[124:127], a[252:255], a[220:223], v[124:127]
ds_read_b64_tr_b16 a[242:243], v18 offset:10240
v_mfma_f32_16x16x32_bf16 v[120:123], a[252:255], a[216:219], v[120:123]
ds_read_b64_tr_b16 a[244:245], v18 offset:12288
v_mfma_f32_16x16x32_bf16 v[120:123], a[248:251], a[208:211], v[120:123]
s_waitcnt lgkmcnt(7)
buffer_load_dwordx4 a[132:135], v1, s[24:27], s54 offen offset:1024 sc1
v_mfma_f32_16x16x32_bf16 v[96:99], a[224:227], a[0:3], v[96:99]
ds_read_b64_tr_b16 a[246:247], v18 offset:14336
ds_read_b64_tr_b16 a[248:249], v19 offset:8192
v_mfma_f32_16x16x32_bf16 v[96:99], a[228:231], a[8:11], v[96:99]
ds_read_b64_tr_b16 a[250:251], v19 offset:10240
v_mfma_f32_16x16x32_bf16 v[100:103], a[228:231], a[12:15], v[100:103]
ds_read_b64_tr_b16 a[252:253], v19 offset:12288
v_mfma_f32_16x16x32_bf16 v[100:103], a[224:227], a[4:7], v[100:103]
s_waitcnt lgkmcnt(7)
buffer_load_dwordx4 a[136:139], v1, s[24:27], s54 offen offset:2048 sc1
v_mfma_f32_16x16x32_bf16 v[108:111], a[232:235], a[4:7], v[108:111]
ds_read_b64_tr_b16 a[254:255], v19 offset:14336
ds_read_b64_tr_b16 a[224:225], v16 offset:16384
v_mfma_f32_16x16x32_bf16 v[108:111], a[236:239], a[12:15], v[108:111]
s_load_dword s101, s[92:93], 64812
ds_read_b64_tr_b16 a[226:227], v16 offset:18432
v_mfma_f32_16x16x32_bf16 v[104:107], a[236:239], a[8:11], v[104:107]
ds_read_b64_tr_b16 a[228:229], v16 offset:20480
v_mfma_f32_16x16x32_bf16 v[104:107], a[232:235], a[0:3], v[104:107]
s_waitcnt lgkmcnt(7)
buffer_load_dwordx4 a[140:143], v1, s[24:27], s54 offen offset:3072 sc1
v_mfma_f32_16x16x32_bf16 v[112:115], a[240:243], a[0:3], v[112:115]
ds_read_b64_tr_b16 a[230:231], v16 offset:22528
ds_read_b64_tr_b16 a[232:233], v17 offset:16384
v_mfma_f32_16x16x32_bf16 v[112:115], a[244:247], a[8:11], v[112:115]
ds_read_b64_tr_b16 a[234:235], v17 offset:18432
v_mfma_f32_16x16x32_bf16 v[116:119], a[244:247], a[12:15], v[116:119]
ds_read_b64_tr_b16 a[236:237], v17 offset:20480
v_mfma_f32_16x16x32_bf16 v[116:119], a[240:243], a[4:7], v[116:119]
s_waitcnt lgkmcnt(7)
buffer_load_dwordx4 a[144:147], v2, s[24:27], s54 offen offset:0 sc1
v_mfma_f32_16x16x32_bf16 v[124:127], a[248:251], a[4:7], v[124:127]
ds_read_b64_tr_b16 a[238:239], v17 offset:22528
ds_read_b64_tr_b16 a[240:241], v18 offset:16384
v_mfma_f32_16x16x32_bf16 v[124:127], a[252:255], a[12:15], v[124:127]
ds_read_b64_tr_b16 a[242:243], v18 offset:18432
v_mfma_f32_16x16x32_bf16 v[120:123], a[252:255], a[8:11], v[120:123]
ds_read_b64_tr_b16 a[244:245], v18 offset:20480
v_mfma_f32_16x16x32_bf16 v[120:123], a[248:251], a[0:3], v[120:123]
s_waitcnt lgkmcnt(7)
buffer_load_dwordx4 a[148:151], v2, s[24:27], s54 offen offset:1024 sc1
v_mfma_f32_16x16x32_bf16 v[96:99], a[224:227], a[16:19], v[96:99]
ds_read_b64_tr_b16 a[246:247], v18 offset:22528
ds_read_b64_tr_b16 a[248:249], v19 offset:16384
v_mfma_f32_16x16x32_bf16 v[96:99], a[228:231], a[24:27], v[96:99]
ds_read_b64_tr_b16 a[250:251], v19 offset:18432
v_mfma_f32_16x16x32_bf16 v[100:103], a[228:231], a[28:31], v[100:103]
ds_read_b64_tr_b16 a[252:253], v19 offset:20480
v_mfma_f32_16x16x32_bf16 v[100:103], a[224:227], a[20:23], v[100:103]
s_waitcnt vmcnt(22) lgkmcnt(7)
s_barrier
v_mfma_f32_16x16x32_bf16 v[108:111], a[232:235], a[20:23], v[108:111]
buffer_load_dwordx4 a[152:155], v2, s[24:27], s54 offen offset:2048 sc1
v_mfma_f32_16x16x32_bf16 v[108:111], a[236:239], a[28:31], v[108:111]
ds_read_b64_tr_b16 a[254:255], v19 offset:22528
ds_read_b64_tr_b16 a[224:225], v16 offset:24576
v_mfma_f32_16x16x32_bf16 v[104:107], a[236:239], a[24:27], v[104:107]
ds_read_b64_tr_b16 a[226:227], v16 offset:26624
ds_read_b64_tr_b16 a[228:229], v16 offset:28672
v_mfma_f32_16x16x32_bf16 v[104:107], a[232:235], a[16:19], v[104:107]
s_waitcnt lgkmcnt(7)
buffer_load_dwordx4 a[156:159], v2, s[24:27], s54 offen offset:3072 sc1
v_mfma_f32_16x16x32_bf16 v[112:115], a[240:243], a[16:19], v[112:115]
s_bfe_u32 s55, 0x4040503, s64
ds_read_b64_tr_b16 a[230:231], v16 offset:30720
ds_read_b64_tr_b16 a[232:233], v17 offset:24576
v_mfma_f32_16x16x32_bf16 v[112:115], a[244:247], a[24:27], v[112:115]
s_lshl_b32 s55, s55, 18
ds_read_b64_tr_b16 a[234:235], v17 offset:26624
s_or_b32 s55, s55, 128
v_mfma_f32_16x16x32_bf16 v[116:119], a[244:247], a[28:31], v[116:119]
s_add_u32 m0, s52, 57344
ds_read_b64_tr_b16 a[236:237], v17 offset:28672
v_mfma_f32_16x16x32_bf16 v[116:119], a[240:243], a[20:23], v[116:119]
s_waitcnt lgkmcnt(7)
buffer_load_dwordx4 v28, s[44:47], s55 offen offset:0 lds
v_mfma_f32_16x16x32_bf16 v[124:127], a[248:251], a[20:23], v[124:127]
ds_read_b64_tr_b16 a[238:239], v17 offset:30720
ds_read_b64_tr_b16 a[240:241], v18 offset:24576
v_mfma_f32_16x16x32_bf16 v[124:127], a[252:255], a[28:31], v[124:127]
ds_read_b64_tr_b16 a[242:243], v18 offset:26624
v_mfma_f32_16x16x32_bf16 v[120:123], a[252:255], a[24:27], v[120:123]
ds_read_b64_tr_b16 a[244:245], v18 offset:28672
v_mfma_f32_16x16x32_bf16 v[120:123], a[248:251], a[16:19], v[120:123]
s_waitcnt vmcnt(17) lgkmcnt(7)
buffer_load_dwordx4 v29, s[44:47], s55 offen offset:1024 lds
v_mfma_f32_16x16x32_bf16 v[96:99], a[224:227], a[160:163], v[96:99]
s_xor_b32 s55, s55, 131072
ds_read_b64_tr_b16 a[246:247], v18 offset:30720
ds_read_b64_tr_b16 a[248:249], v19 offset:24576
v_mfma_f32_16x16x32_bf16 v[96:99], a[228:231], a[168:171], v[96:99]
s_add_u32 m0, s52, 98304
ds_read_b64_tr_b16 a[250:251], v19 offset:26624
v_mfma_f32_16x16x32_bf16 v[100:103], a[228:231], a[172:175], v[100:103]
ds_read_b64_tr_b16 a[252:253], v19 offset:28672
v_mfma_f32_16x16x32_bf16 v[100:103], a[224:227], a[164:167], v[100:103]
s_waitcnt lgkmcnt(7)
buffer_load_dwordx4 v28, s[44:47], s55 offen offset:0 lds
v_mfma_f32_16x16x32_bf16 v[108:111], a[232:235], a[164:167], v[108:111]
ds_read_b64_tr_b16 a[254:255], v19 offset:30720
ds_read_b64_tr_b16 a[224:225], v16 offset:32768
v_mfma_f32_16x16x32_bf16 v[108:111], a[236:239], a[172:175], v[108:111]
ds_read_b64_tr_b16 a[226:227], v16 offset:34816
v_mfma_f32_16x16x32_bf16 v[104:107], a[236:239], a[168:171], v[104:107]
s_waitcnt vmcnt(15)
ds_read_b64_tr_b16 a[228:229], v16 offset:36864
v_mfma_f32_16x16x16_bf16 v[64:67], v[38:39], v[224:225], v[64:67]
buffer_load_dwordx4 v29, s[44:47], s55 offen offset:1024 lds
v_mfma_f32_16x16x16_bf16 v[68:71], v[38:39], v[226:227], v[68:71]
s_bfe_u32 s54, 0x4040503, s64
s_lshl_b32 s54, s54, 13
s_add_u32 s54, s54, s71
s_waitcnt vmcnt(15)
v_mfma_f32_16x16x16_bf16 v[72:75], v[38:39], v[228:229], v[72:75]
v_mfma_f32_16x16x16_bf16 v[76:79], v[38:39], v[230:231], v[76:79]
s_waitcnt vmcnt(14)
buffer_load_dwordx4 a[192:195], v1, s[24:27], s54 offen offset:0 sc1
v_mfma_f32_16x16x16_bf16 v[80:83], v[38:39], v[232:233], v[80:83]
v_mul_f32 v160, s57, v64
v_mul_f32 v161, s57, v65
v_mfma_f32_16x16x16_bf16 v[84:87], v[38:39], v[234:235], v[84:87]
s_waitcnt vmcnt(14)
v_exp_f32 v160, v160
v_mfma_f32_16x16x16_bf16 v[88:91], v[38:39], v[236:237], v[88:91]
v_exp_f32 v161, v161
v_mfma_f32_16x16x16_bf16 v[92:95], v[38:39], v[238:239], v[92:95]
buffer_load_dwordx4 a[196:199], v1, s[24:27], s54 offen offset:1024 sc1
v_mfma_f32_16x16x32_bf16 v[104:107], a[232:235], a[160:163], v[104:107]
s_waitcnt lgkmcnt(7)
ds_read_b64_tr_b16 a[230:231], v16 offset:38912
v_mul_f32 v162, s57, v66
v_mul_f32 v163, s57, v67
v_mfma_f32_16x16x32_bf16 v[112:115], a[240:243], a[160:163], v[112:115]
ds_read_b64_tr_b16 a[232:233], v17 offset:32768
v_exp_f32 v162, v162
v_mfma_f32_16x16x32_bf16 v[112:115], a[244:247], a[168:171], v[112:115]
ds_read_b64_tr_b16 a[234:235], v17 offset:34816
v_exp_f32 v163, v163
v_mfma_f32_16x16x32_bf16 v[116:119], a[244:247], a[172:175], v[116:119]
ds_read_b64_tr_b16 a[236:237], v17 offset:36864
buffer_load_dwordx4 a[200:203], v1, s[24:27], s54 offen offset:2048 sc1
v_mfma_f32_16x16x32_bf16 v[116:119], a[240:243], a[164:167], v[116:119]
s_waitcnt lgkmcnt(7)
ds_read_b64_tr_b16 a[238:239], v17 offset:38912
v_mul_f32 v164, s57, v68
v_mul_f32 v165, s57, v69
v_mfma_f32_16x16x32_bf16 v[124:127], a[248:251], a[164:167], v[124:127]
ds_read_b64_tr_b16 a[240:241], v18 offset:32768
v_exp_f32 v164, v164
v_mfma_f32_16x16x32_bf16 v[124:127], a[252:255], a[172:175], v[124:127]
ds_read_b64_tr_b16 a[242:243], v18 offset:34816
buffer_load_dwordx4 a[204:207], v1, s[24:27], s54 offen offset:3072 sc1
v_mfma_f32_16x16x32_bf16 v[120:123], a[252:255], a[168:171], v[120:123]
ds_read_b64_tr_b16 a[244:245], v18 offset:36864
v_exp_f32 v165, v165
v_mfma_f32_16x16x32_bf16 v[120:123], a[248:251], a[160:163], v[120:123]
s_waitcnt lgkmcnt(7)
ds_read_b64_tr_b16 a[246:247], v18 offset:38912
v_mul_f32 v166, s57, v70
v_mul_f32 v167, s57, v71
v_mfma_f32_16x16x32_bf16 v[96:99], a[224:227], a[176:179], v[96:99]
ds_read_b64_tr_b16 a[248:249], v19 offset:32768
buffer_load_dwordx4 a[208:211], v2, s[24:27], s54 offen offset:0 sc1
v_mfma_f32_16x16x32_bf16 v[96:99], a[228:231], a[184:187], v[96:99]
ds_read_b64_tr_b16 a[250:251], v19 offset:34816
v_exp_f32 v166, v166
v_mfma_f32_16x16x32_bf16 v[100:103], a[228:231], a[188:191], v[100:103]
ds_read_b64_tr_b16 a[252:253], v19 offset:36864
v_exp_f32 v167, v167
v_mfma_f32_16x16x32_bf16 v[100:103], a[224:227], a[180:183], v[100:103]
s_waitcnt vmcnt(17) lgkmcnt(7)
s_barrier
v_add_f32 v160, 1.0, v160
v_mfma_f32_16x16x32_bf16 v[108:111], a[232:235], a[180:183], v[108:111]
ds_read_b64_tr_b16 a[254:255], v19 offset:38912
buffer_load_dwordx4 a[212:215], v2, s[24:27], s54 offen offset:1024 sc1
v_mfma_f32_16x16x32_bf16 v[108:111], a[236:239], a[188:191], v[108:111]
ds_read_b64_tr_b16 a[224:225], v16 offset:40960
v_rcp_f32 v160, v160
v_mfma_f32_16x16x32_bf16 v[104:107], a[236:239], a[184:187], v[104:107]
ds_read_b64_tr_b16 a[226:227], v16 offset:43008
buffer_load_dwordx4 a[216:219], v2, s[24:27], s54 offen offset:2048 sc1
v_mfma_f32_16x16x32_bf16 v[104:107], a[232:235], a[176:179], v[104:107]
s_waitcnt lgkmcnt(6)
ds_read_b64_tr_b16 a[228:229], v16 offset:45056
v_add_f32 v161, 1.0, v161
v_add_f32 v162, 1.0, v162
v_mfma_f32_16x16x32_bf16 v[112:115], a[240:243], a[176:179], v[112:115]
ds_read_b64_tr_b16 a[230:231], v16 offset:47104
v_rcp_f32 v161, v161
v_mfma_f32_16x16x32_bf16 v[112:115], a[244:247], a[184:187], v[112:115]
ds_read_b64_tr_b16 a[232:233], v17 offset:40960
buffer_load_dwordx4 a[220:223], v2, s[24:27], s54 offen offset:3072 sc1
v_mfma_f32_16x16x32_bf16 v[116:119], a[244:247], a[188:191], v[116:119]
s_bfe_u32 s55, 0x5060405, s64
ds_read_b64_tr_b16 a[234:235], v17 offset:43008
v_rcp_f32 v162, v162
v_mfma_f32_16x16x32_bf16 v[116:119], a[240:243], a[180:183], v[116:119]
s_waitcnt lgkmcnt(6)
ds_read_b64_tr_b16 a[236:237], v17 offset:45056
s_lshl_b32 s55, s55, 18
v_add_f32 v163, 1.0, v163
v_mfma_f32_16x16x32_bf16 v[124:127], a[248:251], a[180:183], v[124:127]
s_or_b32 s55, s55, 128
ds_read_b64_tr_b16 a[238:239], v17 offset:47104
v_rcp_f32 v163, v163
v_mfma_f32_16x16x32_bf16 v[124:127], a[252:255], a[188:191], v[124:127]
s_add_u32 m0, s52, 106496
ds_read_b64_tr_b16 a[240:241], v18 offset:40960
v_add_f32 v164, 1.0, v164
v_add_f32 v165, 1.0, v165
v_mfma_f32_16x16x32_bf16 v[120:123], a[252:255], a[184:187], v[120:123]
ds_read_b64_tr_b16 a[242:243], v18 offset:43008
buffer_load_dwordx4 v28, s[44:47], s55 offen offset:0 lds
v_mfma_f32_16x16x32_bf16 v[120:123], a[248:251], a[176:179], v[120:123]
s_waitcnt vmcnt(13) lgkmcnt(6)
ds_read_b64_tr_b16 a[244:245], v18 offset:45056
v_rcp_f32 v164, v164
v_mfma_f32_16x16x32_bf16 v[96:99], a[224:227], a[128:131], v[96:99]
ds_read_b64_tr_b16 a[246:247], v18 offset:47104
buffer_load_dwordx4 v29, s[44:47], s55 offen offset:1024 lds
v_mfma_f32_16x16x32_bf16 v[96:99], a[228:231], a[136:139], v[96:99]
s_xor_b32 s55, s55, 131072
ds_read_b64_tr_b16 a[248:249], v19 offset:40960
v_rcp_f32 v165, v165
v_mfma_f32_16x16x32_bf16 v[100:103], a[228:231], a[140:143], v[100:103]
s_add_u32 m0, s52, 114688
ds_read_b64_tr_b16 a[250:251], v19 offset:43008
v_add_f32 v166, 1.0, v166
v_add_f32 v167, 1.0, v167
v_mfma_f32_16x16x32_bf16 v[100:103], a[224:227], a[132:135], v[100:103]
s_waitcnt lgkmcnt(6)
ds_read_b64_tr_b16 a[252:253], v19 offset:45056
buffer_load_dwordx4 v28, s[44:47], s55 offen offset:0 lds
v_mfma_f32_16x16x32_bf16 v[108:111], a[232:235], a[132:135], v[108:111]
ds_read_b64_tr_b16 a[254:255], v19 offset:47104
v_rcp_f32 v166, v166
v_mfma_f32_16x16x32_bf16 v[108:111], a[236:239], a[140:143], v[108:111]
ds_read_b64_tr_b16 a[224:225], v16 offset:49152
v_rcp_f32 v167, v167
v_mfma_f32_16x16x32_bf16 v[104:107], a[236:239], a[136:139], v[104:107]
ds_read_b64_tr_b16 a[226:227], v16 offset:51200
v_mul_f32 v64, v64, v160
v_mul_f32 v65, v65, v161
v_mfma_f32_16x16x32_bf16 v[104:107], a[232:235], a[128:131], v[104:107]
s_waitcnt lgkmcnt(6)
ds_read_b64_tr_b16 a[228:229], v16 offset:53248
buffer_load_dwordx4 v29, s[44:47], s55 offen offset:1024 lds
v_mfma_f32_16x16x32_bf16 v[112:115], a[240:243], a[128:131], v[112:115]
s_bfe_u32 s54, 0x5060405, s64
ds_read_b64_tr_b16 a[230:231], v16 offset:55296
v_mul_f32 v66, v66, v162
v_mul_f32 v67, v67, v163
v_mfma_f32_16x16x32_bf16 v[112:115], a[244:247], a[136:139], v[112:115]
s_lshl_b32 s54, s54, 13
ds_read_b64_tr_b16 a[232:233], v17 offset:49152
v_mul_f32 v68, v68, v164
v_mul_f32 v69, v69, v165
v_mfma_f32_16x16x32_bf16 v[116:119], a[244:247], a[140:143], v[116:119]
s_add_u32 s54, s54, s71
ds_read_b64_tr_b16 a[234:235], v17 offset:51200
v_mul_f32 v70, v70, v166
v_mul_f32 v71, v71, v167
v_mfma_f32_16x16x32_bf16 v[116:119], a[240:243], a[132:135], v[116:119]
s_waitcnt lgkmcnt(6)
ds_read_b64_tr_b16 a[236:237], v17 offset:53248
buffer_load_dwordx4 a[160:163], v1, s[24:27], s54 offen offset:0 sc1
v_mfma_f32_16x16x32_bf16 v[124:127], a[248:251], a[132:135], v[124:127]
ds_read_b64_tr_b16 a[238:239], v17 offset:55296
v_mul_f32 v168, s57, v72
v_mul_f32 v169, s57, v73
v_mfma_f32_16x16x32_bf16 v[124:127], a[252:255], a[140:143], v[124:127]
ds_read_b64_tr_b16 a[240:241], v18 offset:49152
buffer_load_dwordx4 a[164:167], v1, s[24:27], s54 offen offset:1024 sc1
v_mfma_f32_16x16x32_bf16 v[120:123], a[252:255], a[136:139], v[120:123]
ds_read_b64_tr_b16 a[242:243], v18 offset:51200
v_exp_f32 v168, v168
v_mfma_f32_16x16x32_bf16 v[120:123], a[248:251], a[128:131], v[120:123]
s_waitcnt lgkmcnt(6)
ds_read_b64_tr_b16 a[244:245], v18 offset:53248
v_exp_f32 v169, v169
v_mfma_f32_16x16x32_bf16 v[96:99], a[224:227], a[144:147], v[96:99]
ds_read_b64_tr_b16 a[246:247], v18 offset:55296
buffer_load_dwordx4 a[168:171], v1, s[24:27], s54 offen offset:2048 sc1
v_mfma_f32_16x16x32_bf16 v[96:99], a[228:231], a[152:155], v[96:99]
ds_read_b64_tr_b16 a[248:249], v19 offset:49152
v_mul_f32 v170, s57, v74
v_mul_f32 v171, s57, v75
v_mfma_f32_16x16x32_bf16 v[100:103], a[228:231], a[156:159], v[100:103]
ds_read_b64_tr_b16 a[250:251], v19 offset:51200
v_exp_f32 v170, v170
v_mfma_f32_16x16x32_bf16 v[100:103], a[224:227], a[148:151], v[100:103]
s_waitcnt vmcnt(15) lgkmcnt(6)
s_barrier
v_mul_f32 v172, s57, v76
v_mfma_f32_16x16x32_bf16 v[108:111], a[232:235], a[148:151], v[108:111]
ds_read_b64_tr_b16 a[252:253], v19 offset:53248
ds_read_b64_tr_b16 a[254:255], v19 offset:55296
v_mul_f32 v173, s57, v77
v_mfma_f32_16x16x32_bf16 v[108:111], a[236:239], a[156:159], v[108:111]
ds_read_b64_tr_b16 a[224:225], v16 offset:57344
buffer_load_dwordx4 a[172:175], v1, s[24:27], s54 offen offset:3072 sc1
v_mfma_f32_16x16x32_bf16 v[104:107], a[236:239], a[152:155], v[104:107]
ds_read_b64_tr_b16 a[226:227], v16 offset:59392
v_exp_f32 v171, v171
v_mfma_f32_16x16x32_bf16 v[104:107], a[232:235], a[144:147], v[104:107]
s_waitcnt lgkmcnt(6)
ds_read_b64_tr_b16 a[228:229], v16 offset:61440
buffer_load_dwordx4 a[176:179], v2, s[24:27], s54 offen offset:0 sc1
v_mfma_f32_16x16x32_bf16 v[112:115], a[240:243], a[144:147], v[112:115]
pg_16_b:
s_cbranch_execz pg_back1_b
ds_read_b64_tr_b16 a[230:231], v16 offset:63488
v_exp_f32 v172, v172
v_mfma_f32_16x16x32_bf16 v[112:115], a[244:247], a[152:155], v[112:115]
ds_read_b64_tr_b16 a[232:233], v17 offset:57344
v_exp_f32 v173, v173
v_mfma_f32_16x16x32_bf16 v[116:119], a[244:247], a[156:159], v[116:119]
ds_read_b64_tr_b16 a[234:235], v17 offset:59392
buffer_load_dwordx4 a[180:183], v2, s[24:27], s54 offen offset:1024 sc1
v_mfma_f32_16x16x32_bf16 v[116:119], a[240:243], a[148:151], v[116:119]
s_waitcnt lgkmcnt(6)
ds_read_b64_tr_b16 a[236:237], v17 offset:61440
v_mul_f32 v174, s57, v78
v_mul_f32 v175, s57, v79
v_mfma_f32_16x16x32_bf16 v[124:127], a[248:251], a[148:151], v[124:127]
ds_read_b64_tr_b16 a[238:239], v17 offset:63488
v_exp_f32 v174, v174
v_mfma_f32_16x16x32_bf16 v[124:127], a[252:255], a[156:159], v[124:127]
ds_read_b64_tr_b16 a[240:241], v18 offset:57344
v_exp_f32 v175, v175
v_mfma_f32_16x16x32_bf16 v[120:123], a[252:255], a[152:155], v[120:123]
ds_read_b64_tr_b16 a[242:243], v18 offset:59392
buffer_load_dwordx4 a[184:187], v2, s[24:27], s54 offen offset:2048 sc1
v_mfma_f32_16x16x32_bf16 v[120:123], a[248:251], a[144:147], v[120:123]
s_waitcnt vmcnt(11) lgkmcnt(6)
ds_read_b64_tr_b16 a[244:245], v18 offset:61440
v_add_f32 v168, 1.0, v168
v_add_f32 v169, 1.0, v169
v_mfma_f32_16x16x32_bf16 v[96:99], a[224:227], a[192:195], v[96:99]
ds_read_b64_tr_b16 a[246:247], v18 offset:63488
v_rcp_f32 v168, v168
v_mfma_f32_16x16x32_bf16 v[96:99], a[228:231], a[200:203], v[96:99]
ds_read_b64_tr_b16 a[248:249], v19 offset:57344
buffer_load_dwordx4 a[188:191], v2, s[24:27], s54 offen offset:3072 sc1
v_mfma_f32_16x16x32_bf16 v[100:103], a[228:231], a[204:207], v[100:103]
s_bfe_u32 s55, 0x7050606, s64
ds_read_b64_tr_b16 a[250:251], v19 offset:59392
s_lshl_b32 s55, s55, 18
v_add_f32 v170, 1.0, v170
v_mfma_f32_16x16x32_bf16 v[100:103], a[224:227], a[196:199], v[100:103]
s_waitcnt lgkmcnt(6)
ds_read_b64_tr_b16 a[252:253], v19 offset:61440
s_or_b32 s55, s55, 128
v_add_f32 v171, 1.0, v171
v_mfma_f32_16x16x32_bf16 v[108:111], a[232:235], a[196:199], v[108:111]
s_add_u32 m0, s52, 122880
ds_read_b64_tr_b16 a[254:255], v19 offset:63488
v_rcp_f32 v169, v169
v_mfma_f32_16x16x32_bf16 v[108:111], a[236:239], a[204:207], v[108:111]
ds_read_b64_tr_b16 a[224:225], v20 offset:32768
buffer_load_dwordx4 v28, s[44:47], s55 offen offset:0 lds
v_mfma_f32_16x16x32_bf16 v[104:107], a[236:239], a[200:203], v[104:107]
ds_read_b64_tr_b16 a[226:227], v20 offset:34816
v_rcp_f32 v170, v170
v_mfma_f32_16x16x32_bf16 v[104:107], a[232:235], a[192:195], v[104:107]
s_waitcnt lgkmcnt(6)
ds_read_b64_tr_b16 a[228:229], v20 offset:36864
buffer_load_dwordx4 v29, s[44:47], s55 offen offset:1024 lds
v_mfma_f32_16x16x32_bf16 v[112:115], a[240:243], a[192:195], v[112:115]
s_xor_b32 s55, s55, 131072
ds_read_b64_tr_b16 a[230:231], v20 offset:38912
v_rcp_f32 v171, v171
v_mfma_f32_16x16x32_bf16 v[112:115], a[244:247], a[200:203], v[112:115]
s_add_u32 m0, s52, 131072
ds_read_b64_tr_b16 a[232:233], v21 offset:32768
v_add_f32 v172, 1.0, v172
v_add_f32 v173, 1.0, v173
v_mfma_f32_16x16x32_bf16 v[116:119], a[244:247], a[204:207], v[116:119]
ds_read_b64_tr_b16 a[234:235], v21 offset:34816
buffer_load_dwordx4 v28, s[44:47], s55 offen offset:0 lds
v_mfma_f32_16x16x32_bf16 v[116:119], a[240:243], a[196:199], v[116:119]
s_waitcnt lgkmcnt(6)
ds_read_b64_tr_b16 a[236:237], v21 offset:36864
v_rcp_f32 v172, v172
v_mfma_f32_16x16x32_bf16 v[124:127], a[248:251], a[196:199], v[124:127]
ds_read_b64_tr_b16 a[238:239], v21 offset:38912
v_rcp_f32 v173, v173
v_mfma_f32_16x16x32_bf16 v[124:127], a[252:255], a[204:207], v[124:127]
ds_read_b64_tr_b16 a[240:241], v22 offset:32768
v_add_f32 v174, 1.0, v174
v_add_f32 v175, 1.0, v175
v_mfma_f32_16x16x32_bf16 v[120:123], a[252:255], a[200:203], v[120:123]
ds_read_b64_tr_b16 a[242:243], v22 offset:34816
buffer_load_dwordx4 v29, s[44:47], s55 offen offset:1024 lds
v_mfma_f32_16x16x32_bf16 v[120:123], a[248:251], a[192:195], v[120:123]
s_waitcnt lgkmcnt(6)
ds_read_b64_tr_b16 a[244:245], v22 offset:36864
s_bfe_u32 s54, 0x7050606, s64
v_mul_f32 v72, v72, v168
v_mfma_f32_16x16x32_bf16 v[96:99], a[224:227], a[208:211], v[96:99]
s_lshl_b32 s54, s54, 13
ds_read_b64_tr_b16 a[246:247], v22 offset:38912
v_rcp_f32 v174, v174
v_mfma_f32_16x16x32_bf16 v[96:99], a[228:231], a[216:219], v[96:99]
s_add_u32 s54, s54, s71
ds_read_b64_tr_b16 a[248:249], v23 offset:32768
v_rcp_f32 v175, v175
v_mfma_f32_16x16x32_bf16 v[100:103], a[228:231], a[220:223], v[100:103]
ds_read_b64_tr_b16 a[250:251], v23 offset:34816
buffer_load_dwordx4 a[128:131], v1, s[24:27], s54 offen offset:0 sc1
v_mfma_f32_16x16x32_bf16 v[100:103], a[224:227], a[212:215], v[100:103]
s_waitcnt vmcnt(13) lgkmcnt(6)
s_barrier
v_mul_f32 v73, v73, v169
v_mfma_f32_16x16x32_bf16 v[108:111], a[232:235], a[212:215], v[108:111]
ds_read_b64_tr_b16 a[252:253], v23 offset:36864
ds_read_b64_tr_b16 a[254:255], v23 offset:38912
v_mul_f32 v74, v74, v170
v_mfma_f32_16x16x32_bf16 v[108:111], a[236:239], a[220:223], v[108:111]
ds_read_b64_tr_b16 a[224:225], v20 offset:40960
buffer_load_dwordx4 a[132:135], v1, s[24:27], s54 offen offset:1024 sc1
v_mfma_f32_16x16x32_bf16 v[104:107], a[236:239], a[216:219], v[104:107]
ds_read_b64_tr_b16 a[226:227], v20 offset:43008
v_mul_f32 v75, v75, v171
v_mul_f32 v76, v76, v172
v_mfma_f32_16x16x32_bf16 v[104:107], a[232:235], a[208:211], v[104:107]
s_waitcnt lgkmcnt(6)
ds_read_b64_tr_b16 a[228:229], v20 offset:45056
buffer_load_dwordx4 a[136:139], v1, s[24:27], s54 offen offset:2048 sc1
v_mfma_f32_16x16x32_bf16 v[112:115], a[240:243], a[208:211], v[112:115]
ds_read_b64_tr_b16 a[230:231], v20 offset:47104
v_mul_f32 v77, v77, v173
v_mul_f32 v78, v78, v174
v_mfma_f32_16x16x32_bf16 v[112:115], a[244:247], a[216:219], v[112:115]
ds_read_b64_tr_b16 a[232:233], v21 offset:40960
v_mul_f32 v79, v79, v175
v_mul_f32 v176, s57, v80
v_mfma_f32_16x16x32_bf16 v[116:119], a[244:247], a[220:223], v[116:119]
ds_read_b64_tr_b16 a[234:235], v21 offset:43008
buffer_load_dwordx4 a[140:143], v1, s[24:27], s54 offen offset:3072 sc1
v_mfma_f32_16x16x32_bf16 v[116:119], a[240:243], a[212:215], v[116:119]
s_waitcnt lgkmcnt(6)
ds_read_b64_tr_b16 a[236:237], v21 offset:45056
v_exp_f32 v176, v176
v_mfma_f32_16x16x32_bf16 v[124:127], a[248:251], a[212:215], v[124:127]
ds_read_b64_tr_b16 a[238:239], v21 offset:47104
v_mul_f32 v177, s57, v81
v_mul_f32 v178, s57, v82
v_mfma_f32_16x16x32_bf16 v[124:127], a[252:255], a[220:223], v[124:127]
ds_read_b64_tr_b16 a[240:241], v22 offset:40960
v_exp_f32 v177, v177
v_mfma_f32_16x16x32_bf16 v[120:123], a[252:255], a[216:219], v[120:123]
ds_read_b64_tr_b16 a[242:243], v22 offset:43008
buffer_load_dwordx4 a[144:147], v2, s[24:27], s54 offen offset:0 sc1
v_mfma_f32_16x16x32_bf16 v[120:123], a[248:251], a[208:211], v[120:123]
s_waitcnt vmcnt(9) lgkmcnt(6)
ds_read_b64_tr_b16 a[244:245], v22 offset:45056
v_exp_f32 v178, v178
v_mfma_f32_16x16x32_bf16 v[96:99], a[224:227], a[160:163], v[96:99]
ds_read_b64_tr_b16 a[246:247], v22 offset:47104
v_mul_f32 v179, s57, v83
v_mul_f32 v180, s57, v84
v_mfma_f32_16x16x32_bf16 v[96:99], a[228:231], a[168:171], v[96:99]
ds_read_b64_tr_b16 a[248:249], v23 offset:40960
buffer_load_dwordx4 a[148:151], v2, s[24:27], s54 offen offset:1024 sc1
v_mfma_f32_16x16x32_bf16 v[100:103], a[228:231], a[172:175], v[100:103]
ds_read_b64_tr_b16 a[250:251], v23 offset:43008
v_exp_f32 v179, v179
v_mfma_f32_16x16x32_bf16 v[100:103], a[224:227], a[164:167], v[100:103]
s_waitcnt lgkmcnt(6)
ds_read_b64_tr_b16 a[252:253], v23 offset:45056
v_exp_f32 v180, v180
v_mfma_f32_16x16x32_bf16 v[108:111], a[232:235], a[164:167], v[108:111]
ds_read_b64_tr_b16 a[254:255], v23 offset:47104
buffer_load_dwordx4 a[152:155], v2, s[24:27], s54 offen offset:2048 sc1
v_mfma_f32_16x16x32_bf16 v[108:111], a[236:239], a[172:175], v[108:111]
ds_read_b64_tr_b16 a[224:225], v20 offset:49152
v_mul_f32 v181, s57, v85
v_mul_f32 v182, s57, v86
v_mfma_f32_16x16x32_bf16 v[104:107], a[236:239], a[168:171], v[104:107]
ds_read_b64_tr_b16 a[226:227], v20 offset:51200
v_exp_f32 v181, v181
v_mfma_f32_16x16x32_bf16 v[104:107], a[232:235], a[160:163], v[104:107]
s_waitcnt lgkmcnt(6)
ds_read_b64_tr_b16 a[228:229], v20 offset:53248
buffer_load_dwordx4 a[156:159], v2, s[24:27], s54 offen offset:3072 sc1
v_mfma_f32_16x16x32_bf16 v[112:115], a[240:243], a[160:163], v[112:115]
s_bfe_u32 s55, 0x6070707, s64
ds_read_b64_tr_b16 a[230:231], v20 offset:55296
v_exp_f32 v182, v182
v_mfma_f32_16x16x32_bf16 v[112:115], a[244:247], a[168:171], v[112:115]
s_lshl_b32 s55, s55, 18
ds_read_b64_tr_b16 a[232:233], v21 offset:49152
v_mul_f32 v183, s57, v87
v_add_f32 v176, 1.0, v176
v_mfma_f32_16x16x32_bf16 v[116:119], a[244:247], a[172:175], v[116:119]
s_or_b32 s55, s55, 128
ds_read_b64_tr_b16 a[234:235], v21 offset:51200
s_add_u32 m0, s52, 139264
v_add_f32 v177, 1.0, v177
v_mfma_f32_16x16x32_bf16 v[116:119], a[240:243], a[164:167], v[116:119]
s_waitcnt lgkmcnt(6)
ds_read_b64_tr_b16 a[236:237], v21 offset:53248
buffer_load_dwordx4 v28, s[44:47], s55 offen offset:0 lds
v_mfma_f32_16x16x32_bf16 v[124:127], a[248:251], a[164:167], v[124:127]
ds_read_b64_tr_b16 a[238:239], v21 offset:55296
v_exp_f32 v183, v183
v_mfma_f32_16x16x32_bf16 v[124:127], a[252:255], a[172:175], v[124:127]
ds_read_b64_tr_b16 a[240:241], v22 offset:49152
v_rcp_f32 v176, v176
v_mfma_f32_16x16x32_bf16 v[120:123], a[252:255], a[168:171], v[120:123]
ds_read_b64_tr_b16 a[242:243], v22 offset:51200
buffer_load_dwordx4 v29, s[44:47], s55 offen offset:1024 lds
v_mfma_f32_16x16x32_bf16 v[120:123], a[248:251], a[160:163], v[120:123]
s_waitcnt lgkmcnt(6)
ds_read_b64_tr_b16 a[244:245], v22 offset:53248
v_rcp_f32 v177, v177
v_mfma_f32_16x16x32_bf16 v[96:99], a[224:227], a[176:179], v[96:99]
s_xor_b32 s55, s55, 131072
ds_read_b64_tr_b16 a[246:247], v22 offset:55296
v_add_f32 v178, 1.0, v178
v_add_f32 v179, 1.0, v179
v_mfma_f32_16x16x32_bf16 v[96:99], a[228:231], a[184:187], v[96:99]
s_add_u32 m0, s52, 147456
ds_read_b64_tr_b16 a[248:249], v23 offset:49152
v_rcp_f32 v178, v178
v_mfma_f32_16x16x32_bf16 v[100:103], a[228:231], a[188:191], v[100:103]
ds_read_b64_tr_b16 a[250:251], v23 offset:51200
buffer_load_dwordx4 v28, s[44:47], s55 offen offset:0 lds
v_mfma_f32_16x16x32_bf16 v[100:103], a[224:227], a[180:183], v[100:103]
s_waitcnt vmcnt(11) lgkmcnt(6)
s_barrier
v_add_f32 v180, 1.0, v180
v_mfma_f32_16x16x32_bf16 v[108:111], a[232:235], a[180:183], v[108:111]
ds_read_b64_tr_b16 a[252:253], v23 offset:53248
ds_read_b64_tr_b16 a[254:255], v23 offset:55296
v_add_f32 v181, 1.0, v181
v_mfma_f32_16x16x32_bf16 v[108:111], a[236:239], a[188:191], v[108:111]
ds_read_b64_tr_b16 a[224:225], v20 offset:57344
buffer_load_dwordx4 v29, s[44:47], s55 offen offset:1024 lds
v_mfma_f32_16x16x32_bf16 v[104:107], a[236:239], a[184:187], v[104:107]
s_bfe_u32 s54, 0x6070707, s64
ds_read_b64_tr_b16 a[226:227], v20 offset:59392
s_lshl_b32 s54, s54, 13
v_add_f32 v182, 1.0, v182
v_mfma_f32_16x16x32_bf16 v[104:107], a[232:235], a[176:179], v[104:107]
s_waitcnt lgkmcnt(6)
ds_read_b64_tr_b16 a[228:229], v20 offset:61440
s_add_u32 s54, s54, s71
v_add_f32 v183, 1.0, v183
v_mfma_f32_16x16x32_bf16 v[112:115], a[240:243], a[176:179], v[112:115]
ds_read_b64_tr_b16 a[230:231], v20 offset:63488
buffer_load_dwordx4 a[192:195], v1, s[24:27], s54 offen offset:0 sc1
v_mfma_f32_16x16x32_bf16 v[112:115], a[244:247], a[184:187], v[112:115]
ds_read_b64_tr_b16 a[232:233], v21 offset:57344
v_rcp_f32 v179, v179
v_mfma_f32_16x16x32_bf16 v[116:119], a[244:247], a[188:191], v[116:119]
ds_read_b64_tr_b16 a[234:235], v21 offset:59392
buffer_load_dwordx4 a[196:199], v1, s[24:27], s54 offen offset:1024 sc1
v_mfma_f32_16x16x32_bf16 v[116:119], a[240:243], a[180:183], v[116:119]
s_waitcnt lgkmcnt(6)
ds_read_b64_tr_b16 a[236:237], v21 offset:61440
v_rcp_f32 v180, v180
v_mfma_f32_16x16x32_bf16 v[124:127], a[248:251], a[180:183], v[124:127]
ds_read_b64_tr_b16 a[238:239], v21 offset:63488
v_rcp_f32 v181, v181
v_mfma_f32_16x16x32_bf16 v[124:127], a[252:255], a[188:191], v[124:127]
ds_read_b64_tr_b16 a[240:241], v22 offset:57344
v_rcp_f32 v182, v182
v_mfma_f32_16x16x32_bf16 v[120:123], a[252:255], a[184:187], v[120:123]
ds_read_b64_tr_b16 a[242:243], v22 offset:59392
buffer_load_dwordx4 a[200:203], v1, s[24:27], s54 offen offset:2048 sc1
v_mfma_f32_16x16x32_bf16 v[120:123], a[248:251], a[176:179], v[120:123]
s_waitcnt vmcnt(7) lgkmcnt(6)
ds_read_b64_tr_b16 a[244:245], v22 offset:61440
v_rcp_f32 v183, v183
v_mfma_f32_16x16x32_bf16 v[96:99], a[224:227], a[128:131], v[96:99]
ds_read_b64_tr_b16 a[246:247], v22 offset:63488
v_mul_f32 v80, v80, v176
v_mul_f32 v81, v81, v177
v_mfma_f32_16x16x32_bf16 v[96:99], a[228:231], a[136:139], v[96:99]
ds_read_b64_tr_b16 a[248:249], v23 offset:57344
buffer_load_dwordx4 a[204:207], v1, s[24:27], s54 offen offset:3072 sc1
v_mfma_f32_16x16x32_bf16 v[100:103], a[228:231], a[140:143], v[100:103]
ds_read_b64_tr_b16 a[250:251], v23 offset:59392
v_mul_f32 v82, v82, v178
v_mul_f32 v83, v83, v179
v_mfma_f32_16x16x32_bf16 v[100:103], a[224:227], a[132:135], v[100:103]
s_waitcnt lgkmcnt(6)
ds_read_b64_tr_b16 a[252:253], v23 offset:61440
v_mul_f32 v84, v84, v180
v_mul_f32 v85, v85, v181
v_mfma_f32_16x16x32_bf16 v[108:111], a[232:235], a[132:135], v[108:111]
ds_read_b64_tr_b16 a[254:255], v23 offset:63488
buffer_load_dwordx4 a[208:211], v2, s[24:27], s54 offen offset:0 sc1
v_mfma_f32_16x16x32_bf16 v[108:111], a[236:239], a[140:143], v[108:111]
ds_read_b64_tr_b16 a[224:225], v24 offset:0
v_mul_f32 v86, v86, v182
v_mul_f32 v87, v87, v183
v_mfma_f32_16x16x32_bf16 v[104:107], a[236:239], a[136:139], v[104:107]
ds_read_b64_tr_b16 a[226:227], v24 offset:2048
v_mul_f32 v184, s57, v88
v_mul_f32 v185, s57, v89
v_mfma_f32_16x16x32_bf16 v[104:107], a[232:235], a[128:131], v[104:107]
s_waitcnt lgkmcnt(6)
ds_read_b64_tr_b16 a[228:229], v24 offset:4096
buffer_load_dwordx4 a[212:215], v2, s[24:27], s54 offen offset:1024 sc1
v_mfma_f32_16x16x32_bf16 v[112:115], a[240:243], a[128:131], v[112:115]
ds_read_b64_tr_b16 a[230:231], v24 offset:6144
v_exp_f32 v184, v184
v_mfma_f32_16x16x32_bf16 v[112:115], a[244:247], a[136:139], v[112:115]
ds_read_b64_tr_b16 a[232:233], v25 offset:0
v_exp_f32 v185, v185
v_mfma_f32_16x16x32_bf16 v[116:119], a[244:247], a[140:143], v[116:119]
ds_read_b64_tr_b16 a[234:235], v25 offset:2048
buffer_load_dwordx4 a[216:219], v2, s[24:27], s54 offen offset:2048 sc1
v_mfma_f32_16x16x32_bf16 v[116:119], a[240:243], a[132:135], v[116:119]
s_waitcnt lgkmcnt(6)
ds_read_b64_tr_b16 a[236:237], v25 offset:4096
v_mul_f32 v186, s57, v90
v_mul_f32 v187, s57, v91
v_mfma_f32_16x16x32_bf16 v[124:127], a[248:251], a[132:135], v[124:127]
s_load_dword s101, s[92:93], 64812
ds_read_b64_tr_b16 a[238:239], v25 offset:6144
v_exp_f32 v186, v186
v_mfma_f32_16x16x32_bf16 v[124:127], a[252:255], a[140:143], v[124:127]
ds_read_b64_tr_b16 a[240:241], v26 offset:0
v_exp_f32 v187, v187
v_mfma_f32_16x16x32_bf16 v[120:123], a[252:255], a[136:139], v[120:123]
ds_read_b64_tr_b16 a[242:243], v26 offset:2048
buffer_load_dwordx4 a[220:223], v2, s[24:27], s54 offen offset:3072 sc1
v_mfma_f32_16x16x32_bf16 v[120:123], a[248:251], a[128:131], v[120:123]
s_waitcnt lgkmcnt(6)
ds_read_b64_tr_b16 a[244:245], v26 offset:4096
v_mul_f32 v188, s57, v92
v_mul_f32 v189, s57, v93
v_mfma_f32_16x16x32_bf16 v[96:99], a[224:227], a[144:147], v[96:99]
ds_read_b64_tr_b16 a[246:247], v26 offset:6144
v_exp_f32 v188, v188
v_mfma_f32_16x16x32_bf16 v[96:99], a[228:231], a[152:155], v[96:99]
ds_read_b64_tr_b16 a[248:249], v27 offset:0
v_exp_f32 v189, v189
v_mfma_f32_16x16x32_bf16 v[100:103], a[228:231], a[156:159], v[100:103]
ds_read_b64_tr_b16 a[250:251], v27 offset:2048
v_mul_f32 v190, s57, v94
v_mul_f32 v191, s57, v95
v_mfma_f32_16x16x32_bf16 v[100:103], a[224:227], a[148:151], v[100:103]
s_waitcnt vmcnt(8) lgkmcnt(6)
s_barrier
v_add_f32 v184, 1.0, v184
v_mfma_f32_16x16x32_bf16 v[108:111], a[232:235], a[148:151], v[108:111]
ds_read_b64_tr_b16 a[252:253], v27 offset:4096
ds_read_b64_tr_b16 a[254:255], v27 offset:6144
v_add_f32 v185, 1.0, v185
v_mfma_f32_16x16x32_bf16 v[108:111], a[236:239], a[156:159], v[108:111]
ds_read_b64_tr_b16 a[224:225], v24 offset:8192
v_exp_f32 v190, v190
v_mfma_f32_16x16x32_bf16 v[104:107], a[236:239], a[152:155], v[104:107]
ds_read_b64_tr_b16 a[226:227], v24 offset:10240
v_exp_f32 v191, v191
v_mfma_f32_16x16x32_bf16 v[104:107], a[232:235], a[144:147], v[104:107]
s_waitcnt lgkmcnt(6)
ds_read_b64_tr_b16 a[228:229], v24 offset:12288
v_rcp_f32 v184, v184
v_mfma_f32_16x16x32_bf16 v[112:115], a[240:243], a[144:147], v[112:115]
ds_read_b64_tr_b16 a[230:231], v24 offset:14336
v_rcp_f32 v185, v185
v_mfma_f32_16x16x32_bf16 v[112:115], a[244:247], a[152:155], v[112:115]
ds_read_b64_tr_b16 a[232:233], v25 offset:8192
v_add_f32 v186, 1.0, v186
v_add_f32 v187, 1.0, v187
v_mfma_f32_16x16x32_bf16 v[116:119], a[244:247], a[156:159], v[116:119]
ds_read_b64_tr_b16 a[234:235], v25 offset:10240
v_rcp_f32 v186, v186
v_mfma_f32_16x16x32_bf16 v[116:119], a[240:243], a[148:151], v[116:119]
s_waitcnt lgkmcnt(6)
ds_read_b64_tr_b16 a[236:237], v25 offset:12288
v_rcp_f32 v187, v187
v_mfma_f32_16x16x32_bf16 v[124:127], a[248:251], a[148:151], v[124:127]
ds_read_b64_tr_b16 a[238:239], v25 offset:14336
v_add_f32 v188, 1.0, v188
v_add_f32 v189, 1.0, v189
v_mfma_f32_16x16x32_bf16 v[124:127], a[252:255], a[156:159], v[124:127]
ds_read_b64_tr_b16 a[240:241], v24 offset:16384
v_rcp_f32 v188, v188
v_mfma_f32_16x16x32_bf16 v[120:123], a[252:255], a[152:155], v[120:123]
ds_read_b64_tr_b16 a[242:243], v24 offset:18432
v_rcp_f32 v189, v189
v_mfma_f32_16x16x32_bf16 v[120:123], a[248:251], a[144:147], v[120:123]
s_waitcnt vmcnt(0) lgkmcnt(6)
ds_read_b64_tr_b16 a[244:245], v24 offset:20480
v_add_f32 v190, 1.0, v190
v_add_f32 v191, 1.0, v191
v_mfma_f32_16x16x32_bf16 v[96:99], a[224:227], a[192:195], v[96:99]
ds_read_b64_tr_b16 a[246:247], v24 offset:22528
v_rcp_f32 v190, v190
v_mfma_f32_16x16x32_bf16 v[96:99], a[228:231], a[200:203], v[96:99]
ds_read_b64_tr_b16 a[248:249], v25 offset:16384
v_rcp_f32 v191, v191
v_mfma_f32_16x16x32_bf16 v[100:103], a[228:231], a[204:207], v[100:103]
ds_read_b64_tr_b16 a[250:251], v25 offset:18432
v_mul_f32 v88, v88, v184
v_mul_f32 v89, v89, v185
v_mfma_f32_16x16x32_bf16 v[100:103], a[224:227], a[196:199], v[100:103]
s_waitcnt lgkmcnt(6)
ds_read_b64_tr_b16 a[252:253], v25 offset:20480
v_mul_f32 v90, v90, v186
v_mul_f32 v91, v91, v187
v_mfma_f32_16x16x32_bf16 v[108:111], a[232:235], a[196:199], v[108:111]
ds_read_b64_tr_b16 a[254:255], v25 offset:22528
v_mul_f32 v92, v92, v188
v_mul_f32 v93, v93, v189
v_mfma_f32_16x16x32_bf16 v[108:111], a[236:239], a[204:207], v[108:111]
ds_read_b64_tr_b16 a[224:225], v26 offset:8192
v_mul_f32 v94, v94, v190
v_mul_f32 v95, v95, v191
v_mfma_f32_16x16x32_bf16 v[104:107], a[236:239], a[200:203], v[104:107]
ds_read_b64_tr_b16 a[226:227], v26 offset:10240
ds_read_b64_tr_b16 a[228:229], v26 offset:12288
v_mfma_f32_16x16x32_bf16 v[104:107], a[232:235], a[192:195], v[104:107]
s_waitcnt lgkmcnt(7)
ds_read_b64_tr_b16 a[230:231], v26 offset:14336
v_mfma_f32_16x16x32_bf16 v[96:99], a[240:243], a[208:211], v[96:99]
ds_read_b64_tr_b16 a[232:233], v27 offset:8192
v_mfma_f32_16x16x32_bf16 v[96:99], a[244:247], a[216:219], v[96:99]
ds_read_b64_tr_b16 a[234:235], v27 offset:10240
v_mfma_f32_16x16x32_bf16 v[100:103], a[244:247], a[220:223], v[100:103]
ds_read_b64_tr_b16 a[236:237], v27 offset:12288
v_mfma_f32_16x16x32_bf16 v[100:103], a[240:243], a[212:215], v[100:103]
s_waitcnt lgkmcnt(7)
ds_read_b64_tr_b16 a[238:239], v27 offset:14336
v_mfma_f32_16x16x32_bf16 v[108:111], a[248:251], a[212:215], v[108:111]
ds_read_b64_tr_b16 a[240:241], v26 offset:16384
v_mfma_f32_16x16x32_bf16 v[108:111], a[252:255], a[220:223], v[108:111]
ds_read_b64_tr_b16 a[242:243], v26 offset:18432
v_mfma_f32_16x16x32_bf16 v[104:107], a[252:255], a[216:219], v[104:107]
ds_read_b64_tr_b16 a[244:245], v26 offset:20480
v_mfma_f32_16x16x32_bf16 v[104:107], a[248:251], a[208:211], v[104:107]
s_waitcnt lgkmcnt(7)
ds_read_b64_tr_b16 a[246:247], v26 offset:22528
v_mfma_f32_16x16x32_bf16 v[112:115], a[224:227], a[192:195], v[112:115]
ds_read_b64_tr_b16 a[248:249], v27 offset:16384
v_fma_f32 v192, v96, v64, v192
v_fma_f32 v193, v97, v65, v193
v_mfma_f32_16x16x32_bf16 v[112:115], a[228:231], a[200:203], v[112:115]
ds_read_b64_tr_b16 a[250:251], v27 offset:18432
v_fma_f32 v194, v98, v66, v194
v_fma_f32 v195, v99, v67, v195
v_mfma_f32_16x16x32_bf16 v[116:119], a[228:231], a[204:207], v[116:119]
ds_read_b64_tr_b16 a[252:253], v27 offset:20480
v_fma_f32 v196, v100, v68, v196
v_fma_f32 v197, v101, v69, v197
v_mfma_f32_16x16x32_bf16 v[116:119], a[224:227], a[196:199], v[116:119]
s_waitcnt lgkmcnt(7)
ds_read_b64_tr_b16 a[254:255], v27 offset:22528
v_fma_f32 v198, v102, v70, v198
v_fma_f32 v199, v103, v71, v199
v_mfma_f32_16x16x32_bf16 v[124:127], a[232:235], a[196:199], v[124:127]
v_cvt_pk_bf16_f32 v4, v192, v193
v_cvt_pk_bf16_f32 v5, v194, v195
v_cvt_pk_bf16_f32 v8, v196, v197
v_mfma_f32_16x16x32_bf16 v[124:127], a[236:239], a[204:207], v[124:127]
v_cvt_pk_bf16_f32 v9, v198, v199
v_fma_f32 v200, v104, v72, v200
v_fma_f32 v201, v105, v73, v201
v_mfma_f32_16x16x32_bf16 v[120:123], a[236:239], a[200:203], v[120:123]
v_fma_f32 v202, v106, v74, v202
v_fma_f32 v203, v107, v75, v203
v_fma_f32 v204, v108, v76, v204
v_mfma_f32_16x16x32_bf16 v[120:123], a[232:235], a[192:195], v[120:123]
s_waitcnt lgkmcnt(4)
v_fma_f32 v205, v109, v77, v205
v_fma_f32 v206, v110, v78, v206
v_fma_f32 v207, v111, v79, v207
v_mfma_f32_16x16x32_bf16 v[112:115], a[240:243], a[208:211], v[112:115]
v_cvt_pk_bf16_f32 v6, v200, v201
v_cvt_pk_bf16_f32 v7, v202, v203
v_cvt_pk_bf16_f32 v10, v204, v205
v_mfma_f32_16x16x32_bf16 v[112:115], a[244:247], a[216:219], v[112:115]
v_cvt_pk_bf16_f32 v11, v206, v207
v_permlane16_swap_b32 v4, v6
v_mfma_f32_16x16x32_bf16 v[116:119], a[244:247], a[220:223], v[116:119]
v_permlane16_swap_b32 v5, v7
v_mfma_f32_16x16x32_bf16 v[116:119], a[240:243], a[212:215], v[116:119]
s_waitcnt lgkmcnt(0)
v_permlane16_swap_b32 v8, v10
v_mfma_f32_16x16x32_bf16 v[124:127], a[248:251], a[212:215], v[124:127]
buffer_store_dwordx4 v[4:7], v34, s[48:51], s65 offen offset:0 sc0 sc1
v_permlane16_swap_b32 v9, v11
v_mfma_f32_16x16x32_bf16 v[124:127], a[252:255], a[220:223], v[124:127]
v_mfma_f32_16x16x32_bf16 v[120:123], a[252:255], a[216:219], v[120:123]
v_mfma_f32_16x16x32_bf16 v[120:123], a[248:251], a[208:211], v[120:123]
buffer_store_dwordx4 v[8:11], v34, s[48:51], s5 offen offset:0 sc0 sc1
v_pk_fma_f32 v[208:209], v[112:113], v[80:81], v[208:209]
v_pk_fma_f32 v[210:211], v[114:115], v[82:83], v[210:211]
v_pk_fma_f32 v[212:213], v[116:117], v[84:85], v[212:213]
v_pk_fma_f32 v[214:215], v[118:119], v[86:87], v[214:215]
v_cvt_pk_bf16_f32 v12, v208, v209
v_cvt_pk_bf16_f32 v13, v210, v211
v_cvt_pk_bf16_f32 v56, v212, v213
v_cvt_pk_bf16_f32 v57, v214, v215
v_pk_fma_f32 v[216:217], v[120:121], v[88:89], v[216:217]
v_pk_fma_f32 v[218:219], v[122:123], v[90:91], v[218:219]
v_pk_fma_f32 v[220:221], v[124:125], v[92:93], v[220:221]
v_pk_fma_f32 v[222:223], v[126:127], v[94:95], v[222:223]
v_cvt_pk_bf16_f32 v14, v216, v217
v_cvt_pk_bf16_f32 v15, v218, v219
v_cvt_pk_bf16_f32 v58, v220, v221
v_cvt_pk_bf16_f32 v59, v222, v223
v_permlane16_swap_b32 v12, v14
v_permlane16_swap_b32 v13, v15
v_permlane16_swap_b32 v56, v58
v_permlane16_swap_b32 v57, v59
buffer_store_dwordx4 v[12:15], v34, s[48:51], s65 offen offset:64 sc0 sc1
buffer_store_dwordx4 v[56:59], v34, s[48:51], s5 offen offset:64 sc0 sc1
k_done_b:
s_endpgm
ckH_spin_b:
s_mov_b32 s98, 131072
ckH_again_b:
s_sleep 1
buffer_load_dword v33, v31, s[24:27], s62 offen offset:0 sc1
s_waitcnt vmcnt(0)
v_cmp_ne_u32 vcc, v33, v32
s_sub_u32 s98, s98, 1
s_cbranch_scc1 ckH_ok_b
s_cbranch_vccnz ckH_again_b
s_branch ckH_ok_b
ckS_spin_b:
s_mov_b32 s98, 131072
ckS_again_b:
s_sleep 1
buffer_load_dword v33, v31, s[24:27], s62 offen offset:128 sc1
s_waitcnt vmcnt(0)
v_cmp_ne_u32 vcc, v33, v32
s_sub_u32 s98, s98, 1
s_cbranch_scc1 ckS_ok_b
s_cbranch_vccnz ckS_again_b
s_branch ckS_ok_b
ckK_spin_b:
s_mov_b32 s98, 131072
ckK_again_b:
s_sleep 1
buffer_load_dword v33, v55, s[24:27], s6 offen offset:0 sc1
s_waitcnt vmcnt(0)
v_cmp_ne_u32 vcc, v33, v32
s_sub_u32 s98, s98, 1
s_cbranch_scc1 ckK_ok_b
s_cbranch_vccnz ckK_again_b
s_branch ckK_ok_b
ckO_spin_b:
s_mov_b32 s98, 131072
ckO_again_b:
s_sleep 1
buffer_load_dword v33, v31, s[24:27], s62 offen offset:256 sc1
s_waitcnt vmcnt(0)
v_cmp_ne_u32 vcc, v33, v32
s_sub_u32 s98, s98, 1
s_cbranch_scc1 ckO_ok_b
s_cbranch_vccnz ckO_again_b
s_branch ckO_ok_b
ckE_spin_b:
s_mov_b32 s98, 131072
ckE_again_b:
s_sleep 1
buffer_load_dword v33, off, s[24:27], s7 offset:0 sc1
s_waitcnt vmcnt(0)
v_cmp_ne_u32 vcc, v33, v32
s_sub_u32 s98, s98, 1
s_cbranch_scc1 ckE_ok_b
s_cbranch_vccnz ckE_again_b
s_branch ckE_ok_b
k_end:

.section .rodata,"a"
.p2align 6
.amdhsa_kernel recurrent_scan__linear_kernel_hedgehog__glu_gated_glu__prompt_kernel
  .amdhsa_next_free_vgpr 512
  .amdhsa_next_free_sgpr 102
  .amdhsa_accum_offset 256
  .amdhsa_group_segment_fixed_size 0
  .amdhsa_kernarg_size 88
  .amdhsa_user_sgpr_count 2
  .amdhsa_user_sgpr_kernarg_segment_ptr 1
  .amdhsa_system_sgpr_workgroup_id_x 1
.end_amdhsa_kernel
```
